```python
import torch

def _softmax(x, axis=-1):
    return torch.softmax(x, dim=axis)
def _gelu(x):
    return torch.nn.functional.gelu(x, approximate="tanh")
def _silu(x):
    return torch.nn.functional.silu(x)
def _sigmoid(x):
    return torch.sigmoid(x)
def _layernorm(x, axis=-1, eps=1e-5):
    m = x.mean(dim=axis, keepdim=True)
    v = x.var(dim=axis, keepdim=True, unbiased=False)
    return (x - m) / torch.sqrt(v + eps)
def _scatter_add(tgt, idx, src, axis=0):
    return tgt.clone().index_add_(axis, idx, src)
def _segment_sum(src, seg, n):
    out = torch.zeros((n,) + src.shape[1:], dtype=src.dtype)
    return out.index_add_(0, seg, src)
def _pad(x, pw):
    flat = tuple(v for pair in reversed(pw) for v in pair)
    return torch.nn.functional.pad(x, flat)

kernel_name = 'recurrent_scan__sliding_block_cached__moe_arch_mod__prompt'

def setup_inputs():

    _w = (lambda a: (lambda t: t.to(torch.bfloat16) if t.is_floating_point() else t)(torch.as_tensor(a)))
    def _A_setup():
        B, Sq, D = 1, 2048, 640
        Hq, Hkv, Sk, Dh = 32, 32, 2048, 192
        assert Hq % Hkv == 0, (Hq, Hkv)
        return {
            "x": _w((lambda *s: torch.randn(*s, dtype=torch.bfloat16) * 0.05)(B, Sq, D)),
            "k_cache": _w((lambda *s: torch.randn(*s, dtype=torch.bfloat16) * 0.8)(B, Hkv, Sk, Dh)),
            "v_cache": _w((lambda *s: torch.randn(*s, dtype=torch.bfloat16) * 0.2)(B, Hkv, Sk, Dh)),
            "wq": _w((lambda *s: torch.randn(*s, dtype=torch.bfloat16) * 0.8)(D, Hq * Dh) * (D ** -0.5)),
            "wo": _w((lambda *s: torch.randn(*s, dtype=torch.bfloat16) * 0.2)(Hq * Dh, D) * ((Hq * Dh) ** -0.5)),
        }
    _A_in = _A_setup()

    def _B_setup():
        B, S, D, F, C = 1, 2048, 640, 1536, 2
        return {
            "x": _w((lambda *s: torch.randn(*s, dtype=torch.bfloat16) * 0.05)(B, S, D)),
            "w_r": _w((lambda *s: torch.randn(*s, dtype=torch.bfloat16) * 0.2)(D)),
            "w_gate": _w((lambda *s: torch.randn(*s, dtype=torch.bfloat16) * 0.1)(D, F)),
            "w_up": _w((lambda *s: torch.randn(*s, dtype=torch.bfloat16) * 0.1)(D, F)),
            "w_down": _w((lambda *s: torch.randn(*s, dtype=torch.bfloat16) * 0.1)(F, D)),
        }
    _B_in = _B_setup()

    return {
        "A_x": _A_in["x"],
        "A_k_cache": _A_in["k_cache"],
        "A_v_cache": _A_in["v_cache"],
        "A_wq": _A_in["wq"],
        "A_wo": _A_in["wo"],
        "B_x": _B_in["x"],
        "B_w_r": _B_in["w_r"],
        "B_w_gate": _B_in["w_gate"],
        "B_w_up": _B_in["w_up"],
        "B_w_down": _B_in["w_down"],
    }

def reference(A_x, A_k_cache, A_v_cache, A_wq, A_wo, B_x, B_w_r, B_w_gate, B_w_up, B_w_down):
    def _A_ref(x, k_cache, v_cache, wq, wo):
        B, Sq, D = x.shape
        Hq, Dh = 32, 192
        Hkv, Sk = k_cache.shape[1], k_cache.shape[2]
        W = min(4096, max(256, Sk // 4))
        rep = Hq // Hkv
        q = (lambda x, *d: x.permute(*d))((x @ wq).reshape(B, Sq, Hq, Dh), 0, 2, 1, 3)
        k = (lambda x, n, axis: torch.repeat_interleave(x, n, dim=axis))(k_cache[:, :, Sk - W:, :], rep, axis=1)
        v = (lambda x, n, axis: torch.repeat_interleave(x, n, dim=axis))(v_cache[:, :, Sk - W:, :], rep, axis=1)
        scores = torch.einsum("bhqd,bhkd->bhqk", q, k) * (Dh ** -0.5)
        p = _softmax(scores, axis=-1)
        o = torch.einsum("bhqk,bhkd->bhqd", p, v)
        return (lambda x, *d: x.permute(*d))(o, 0, 2, 1, 3).reshape(B, Sq, Hq * Dh) @ wo

    def _B_ref(x, w_r, w_gate, w_up, w_down):
        B, S, D = x.shape
        C = 2
        r = x @ w_r
        idx = torch.argsort(-r, axis=-1)[:, :C]
        idx_e = (lambda x, n, axis: torch.repeat_interleave(x, n, dim=axis))(idx.reshape(B, C, 1), D, axis=2)
        x_sel = (lambda x, i, axis: torch.take_along_dim(x, i, dim=axis))(x, idx_e, axis=1)
        g = _silu(x_sel @ w_gate)
        u = x_sel @ w_up
        y = (g * u) @ w_down
        r_sel = _sigmoid((lambda x, i, axis: torch.take_along_dim(x, i, dim=axis))(r, idx, axis=1))
        y = y * r_sel.reshape(B, C, 1)
        b_off = (torch.arange(B) * S).reshape(B, 1)
        flat_idx = (idx + b_off).reshape(B * C)
        zero = (x * 0.0).reshape(B * S, D)
        upd = _scatter_add(zero, flat_idx, y.reshape(B * C, D), axis=0)
        return x + upd.reshape(B, S, D)

    x = A_x
    xn = _layernorm(x, axis=-1)
    s = _A_ref(xn, A_k_cache, A_v_cache, A_wq, A_wo)
    g = _silu(_B_ref(xn, B_w_r, B_w_gate, B_w_up, B_w_down))
    return x + s * g
```

```asm
; @launch grid=(256,1,1) block=(256,1,1) lds=163840
.amdgcn_target "amdgcn-amd-amdhsa--gfx950"
.text
.globl recurrent_scan__sliding_block_cached__moe_arch_mod__prompt_kernel
.p2align 12
.p2align 8
.type recurrent_scan__sliding_block_cached__moe_arch_mod__prompt_kernel,@function
recurrent_scan__sliding_block_cached__moe_arch_mod__prompt_kernel:
    s_cmp_ge_u32 s2, 256
    s_cbranch_scc1 main_end
    s_load_dwordx16 s[64:79], s[0:1], 0
    s_load_dwordx4 s[80:83], s[0:1], 64
    s_load_dwordx2 s[84:85], s[0:1], 80
    s_load_dwordx2 s[86:87], s[0:1], 96
    s_lshr_b32 s56, s2, 3
    s_lshl_b32 s56, s56, 10
    v_lshrrev_b32 v18, 5, v0
    v_lshlrev_b32 v18, 7, v18
    v_add_u32 v18, s56, v18
    s_getpc_b64 s[88:89]
code0:
    global_load_dword a252, v18, s[88:89]
    v_add_u32 v19, 32768, v18
    global_load_dword a252, v19, s[88:89]
    v_lshrrev_b32 v17, 6, v0
    v_lshlrev_b32 v17, 12, v17
    v_and_b32 v1, 63, v0
    v_lshl_add_u32 v17, v1, 4, v17
    v_lshrrev_b32 v29, 6, v0
    v_mov_b32 v16, v0
    v_readfirstlane_b32 s3, v29
    s_and_b32 s53, s2, 7
    s_lshr_b32 s52, s2, 5
    s_bfe_u32 s51, s2, 0x20003
    s_lshl_b32 s50, s53, 2
    s_add_u32 s50, s50, s51
    s_lshl_b32 s60, s2, 3
    s_lshl_b32 s56, s3, 1
    s_add_u32 s60, s60, s56
    v_bfe_u32 v240, v1, 2, 1
    v_add_u32 v240, s60, v240
    v_lshrrev_b32 v241, 3, v1
    v_lshlrev_b32 v241, 6, v241
    v_and_b32 v29, 3, v1
    v_lshl_add_u32 v241, v29, 4, v241
    v_mul_u32_u24 v242, 1280, v240
    v_add_u32 v242, v242, v241
    v_lshrrev_b32 v29, 4, v1
    v_lshlrev_b32 v29, 1, v29
    v_and_b32 v7, 7, v1
    v_xor_b32 v7, v7, v29
    v_lshlrev_b32 v7, 4, v7
    v_lshrrev_b32 v29, 5, v1
    v_lshlrev_b32 v29, 3, v29
    v_bfe_u32 v5, v1, 3, 2
    v_add_u32 v5, v5, v29
    v_mul_u32_u24 v2, 12288, v5
    v_add_u32 v2, v2, v7
    v_add_u32 v3, 196608, v2
    s_lshl_b32 s54, s52, 2
    s_add_u32 s54, s54, s3
    s_mul_i32 s49, s3, 6144
    s_lshr_b32 s59, s3, 1
    s_lshl_b32 s59, s59, 5
    s_and_b32 s56, s3, 1
    s_lshl_b32 s56, s56, 2
    s_add_u32 s59, s59, s56
    s_mul_i32 s36, s59, 12288
    s_mov_b32 s37, 786432
    s_add_u32 s45, s51, s52
    s_and_b32 s45, s45, 3
    s_lshl_b32 s45, s45, 2
    s_lshr_b32 s45, 0x5050, s45
    s_and_b32 s45, s45, 15
    s_mul_i32 s56, s45, 786432
    s_add_u32 s36, s36, s56
    s_lshl_b32 s45, s45, 13
    s_mul_i32 s56, s50, 384
    s_sub_u32 s57, 7864320, s56
    s_waitcnt lgkmcnt(0)
    s_mov_b32 s12, s64
    s_and_b32 s13, s65, 0xffff
    s_mov_b32 s14, 2621440
    s_mov_b32 s15, 0x00020000
    s_mov_b32 s16, s76
    s_and_b32 s17, s77, 0xffff
    s_mov_b32 s18, 1280
    s_mov_b32 s19, 0x00020000
    buffer_load_dwordx4 v[64:67], v242, s[12:15], 0 offen
    buffer_load_dwordx4 v[68:71], v242, s[12:15], 0 offen offset:512
    buffer_load_dwordx4 v[72:75], v242, s[12:15], 0 offen offset:1024
    v_mov_b32 v25, 3203072
    global_load_dword v26, v25, s[86:87] sc1
    s_lshr_b32 s44, s2, 3
    s_lshl_b32 s44, s44, 7
    s_add_u32 s44, s44, 4128768
    s_load_dword s28, s[86:87], s44 glc
    buffer_load_dwordx4 v[76:79], v241, s[16:19], 0 offen offset:0
    buffer_load_dwordx4 v[80:83], v241, s[16:19], 0 offen offset:512
    buffer_load_dwordx4 v[84:87], v241, s[16:19], 0 offen offset:1024
    s_add_u32 s8, s70, s56
    s_addc_u32 s9, s71, 0
    s_and_b32 s9, s9, 0xffff
    s_mov_b32 s10, s57
    s_mov_b32 s11, 0x00020000
    s_add_u32 m0, s49, 49152
    s_nop 0
    buffer_load_dwordx4 v2, s[8:11], s36 offen offset:0 lds
    s_add_u32 m0, s49, 50048
    s_nop 0
    buffer_load_dwordx4 v2, s[8:11], s36 offen offset:128 lds
    s_add_u32 m0, s49, 50944
    s_nop 0
    buffer_load_dwordx4 v2, s[8:11], s36 offen offset:256 lds
    s_add_u32 m0, s49, 52224
    s_nop 0
    buffer_load_dwordx4 v3, s[8:11], s36 offen offset:0 lds
    s_add_u32 m0, s49, 53120
    s_nop 0
    buffer_load_dwordx4 v3, s[8:11], s36 offen offset:128 lds
    s_add_u32 m0, s49, 54016
    s_nop 0
    buffer_load_dwordx4 v3, s[8:11], s36 offen offset:256 lds
    s_add_u32 s36, s36, s37
    s_sub_u32 s55, s36, 7864320
    s_min_u32 s36, s36, s55
    s_mov_b32 s24, s86
    s_and_b32 s25, s87, 0xffff
    s_mov_b32 s26, 268435456
    s_mov_b32 s27, 0x00020000
    v_lshrrev_b32 v243, 6, v240
    v_mul_u32_u24 v243, 81920, v243
    v_bfe_u32 v29, v240, 4, 2
    v_lshl_add_u32 v243, v29, 10, v243
    v_and_b32 v29, 15, v240
    v_lshl_add_u32 v243, v29, 6, v243
    v_lshrrev_b32 v29, 3, v1
    v_lshl_add_u32 v243, v29, 12, v243
    v_and_b32 v29, 3, v1
    v_lshl_add_u32 v243, v29, 4, v243
    s_mov_b32 s38, 0x3acccccd
    s_mov_b32 s39, 0x3727c5ac
    s_mov_b32 s41, 0
    s_mov_b32 s42, 32768
    s_mov_b32 s43, 65536
    v_bfe_u32 v29, v1, 2, 3
    v_lshlrev_b32 v8, 7, v29
    v_lshrrev_b32 v29, 1, v29
    v_xor_b32 v29, 0, v29
    v_lshl_add_u32 v8, v29, 5, v8
    v_and_b32 v29, 3, v1
    v_lshl_add_u32 v8, v29, 3, v8
    v_lshrrev_b32 v29, 5, v1
    v_mul_u32_u24 v29, 3072, v29
    v_add_u32 v8, v8, v29
    v_add_u32 v8, 49152, v8
    v_xor_b32 v9, 32, v8
    v_xor_b32 v10, 64, v8
    v_xor_b32 v11, 96, v8
    v_and_b32 v15, 15, v1
    v_lshlrev_b32 v15, 6, v15
    v_lshrrev_b32 v29, 4, v1
    v_lshl_add_u32 v15, v29, 4, v15
    s_and_b32 s56, s2, 1
    s_lshl_b32 s56, s56, 11
    v_add_u32 v15, s56, v15
    v_xor_b32 v14, 2048, v15
    s_mul_i32 s56, s54, 81920
    s_add_u32 s56, s56, 0
    s_add_u32 s20, s86, s56
    s_addc_u32 s21, s87, 0
    s_and_b32 s21, s21, 0xffff
    s_mov_b32 s22, 81920
    s_mov_b32 s23, 0x00020000
    s_lshl_b32 s46, s54, 7
    s_add_u32 s46, s46, 4128768
    s_mov_b32 s101, 0
    s_lshl_b32 s56, s53, 12
    s_add_u32 s46, s46, s56
    s_load_dword s31, s[86:87], s46 glc
    s_lshr_b32 s6, s2, 3
    s_lshl_b32 s6, s6, 7
    s_lshl_b32 s56, s53, 2
    s_add_u32 s6, s6, s56
    s_add_u32 s6, s6, 4128768
    s_cmp_eq_u32 s3, 0
    s_cselect_b32 s6, s6, 0x70000000
    v_lshlrev_b32 v20, 12, v1
    s_waitcnt vmcnt(10)
    v_lshlrev_b32 v96, 16, v64
    v_and_b32 v97, 0xffff0000, v64
    v_lshlrev_b32 v98, 16, v65
    v_and_b32 v99, 0xffff0000, v65
    v_lshlrev_b32 v100, 16, v66
    v_and_b32 v101, 0xffff0000, v66
    v_lshlrev_b32 v102, 16, v67
    v_and_b32 v103, 0xffff0000, v67
    v_lshlrev_b32 v104, 16, v68
    v_and_b32 v105, 0xffff0000, v68
    v_lshlrev_b32 v106, 16, v69
    v_and_b32 v107, 0xffff0000, v69
    v_lshlrev_b32 v108, 16, v70
    v_and_b32 v109, 0xffff0000, v70
    v_lshlrev_b32 v110, 16, v71
    v_and_b32 v111, 0xffff0000, v71
    v_lshlrev_b32 v112, 16, v72
    v_and_b32 v113, 0xffff0000, v72
    v_lshlrev_b32 v114, 16, v73
    v_and_b32 v115, 0xffff0000, v73
    v_lshlrev_b32 v116, 16, v74
    v_and_b32 v117, 0xffff0000, v74
    v_lshlrev_b32 v118, 16, v75
    v_and_b32 v119, 0xffff0000, v75
    v_pk_add_f32 v[120:121], v[96:97], v[98:99]
    v_pk_add_f32 v[122:123], v[100:101], v[102:103]
    v_pk_add_f32 v[120:121], v[120:121], v[104:105]
    v_pk_add_f32 v[122:123], v[122:123], v[106:107]
    v_pk_add_f32 v[120:121], v[120:121], v[108:109]
    v_pk_add_f32 v[122:123], v[122:123], v[110:111]
    s_mov_b32 exec_hi, 0
    v_pk_add_f32 v[120:121], v[120:121], v[112:113]
    v_pk_add_f32 v[122:123], v[122:123], v[114:115]
    v_pk_add_f32 v[120:121], v[120:121], v[116:117]
    v_pk_add_f32 v[122:123], v[122:123], v[118:119]
    s_mov_b64 exec, -1
    v_pk_add_f32 v[120:121], v[120:121], v[122:123]
    v_add_f32 v120, v120, v121
    s_nop 1
    v_add_f32_dpp v120, v120, v120 quad_perm:[1,0,3,2] row_mask:0xf bank_mask:0xf
    s_nop 1
    v_add_f32_dpp v120, v120, v120 quad_perm:[2,3,0,1] row_mask:0xf bank_mask:0xf
    s_nop 1
    v_add_f32_dpp v120, v120, v120 row_ror:8 row_mask:0xf bank_mask:0xf
    v_mov_b32 v124, v120
    s_nop 1
    v_permlane16_swap_b32 v120, v124
    s_nop 1
    v_add_f32 v120, v120, v124
    v_mov_b32 v124, v120
    s_nop 1
    v_permlane32_swap_b32 v120, v124
    s_nop 1
    v_add_f32 v120, v120, v124
    v_mul_f32 v126, s38, v120
    v_mul_f32 v128, s38, -v120
    v_mul_f32 v129, s38, -v120
    v_pk_add_f32 v[132:133], v[96:97], v[128:129]
    v_pk_mul_f32 v[120:121], v[132:133], v[132:133]
    v_pk_add_f32 v[134:135], v[98:99], v[128:129]
    v_pk_mul_f32 v[122:123], v[134:135], v[134:135]
    v_pk_add_f32 v[136:137], v[100:101], v[128:129]
    v_pk_fma_f32 v[120:121], v[136:137], v[136:137], v[120:121]
    v_pk_add_f32 v[138:139], v[102:103], v[128:129]
    v_pk_fma_f32 v[122:123], v[138:139], v[138:139], v[122:123]
    v_pk_add_f32 v[132:133], v[104:105], v[128:129]
    v_pk_fma_f32 v[120:121], v[132:133], v[132:133], v[120:121]
    v_pk_add_f32 v[134:135], v[106:107], v[128:129]
    v_pk_fma_f32 v[122:123], v[134:135], v[134:135], v[122:123]
    v_pk_add_f32 v[136:137], v[108:109], v[128:129]
    v_pk_fma_f32 v[120:121], v[136:137], v[136:137], v[120:121]
    v_pk_add_f32 v[138:139], v[110:111], v[128:129]
    v_pk_fma_f32 v[122:123], v[138:139], v[138:139], v[122:123]
    s_mov_b32 exec_hi, 0
    v_pk_add_f32 v[132:133], v[112:113], v[128:129]
    v_pk_fma_f32 v[120:121], v[132:133], v[132:133], v[120:121]
    v_pk_add_f32 v[134:135], v[114:115], v[128:129]
    v_pk_fma_f32 v[122:123], v[134:135], v[134:135], v[122:123]
    v_pk_add_f32 v[136:137], v[116:117], v[128:129]
    v_pk_fma_f32 v[120:121], v[136:137], v[136:137], v[120:121]
    v_pk_add_f32 v[138:139], v[118:119], v[128:129]
    v_pk_fma_f32 v[122:123], v[138:139], v[138:139], v[122:123]
    s_mov_b64 exec, -1
    v_pk_add_f32 v[120:121], v[120:121], v[122:123]
    v_add_f32 v120, v120, v121
    s_nop 1
    v_add_f32_dpp v120, v120, v120 quad_perm:[1,0,3,2] row_mask:0xf bank_mask:0xf
    s_nop 1
    v_add_f32_dpp v120, v120, v120 quad_perm:[2,3,0,1] row_mask:0xf bank_mask:0xf
    s_nop 1
    v_add_f32_dpp v120, v120, v120 row_ror:8 row_mask:0xf bank_mask:0xf
    v_mov_b32 v124, v120
    s_nop 1
    v_permlane16_swap_b32 v120, v124
    s_nop 1
    v_add_f32 v120, v120, v124
    v_mov_b32 v124, v120
    s_nop 1
    v_permlane32_swap_b32 v120, v124
    s_nop 1
    v_add_f32 v120, v120, v124
    v_mul_f32 v130, s38, v120
    v_cvt_pk_bf16_f32 v126, v126, v126
    v_and_b32 v126, 0xffff0000, v126
    v_cvt_pk_bf16_f32 v130, v130, v130
    v_and_b32 v130, 0xffff0000, v130
    v_add_f32 v130, s39, v130
    v_cvt_pk_bf16_f32 v130, v130, v130
    v_and_b32 v130, 0xffff0000, v130
    v_sqrt_f32 v130, v130
    v_sub_f32 v128, 0, v126
    v_cvt_pk_bf16_f32 v130, v130, v130
    v_and_b32 v130, 0xffff0000, v130
    v_rcp_f32 v127, v130
    v_sub_f32 v129, 0, v126
    v_mul_f32 v120, 0x3dd53b95, v127
    v_mul_f32 v121, 0x3dd53b95, v127
    v_mov_b32 v130, v127
    v_mov_b32 v131, v127
    v_pk_add_f32 v[96:97], v[96:97], v[128:129]
    v_pk_mul_f32 v[132:133], v[96:97], v[120:121]
    v_cvt_pk_bf16_f32 v144, v132, v133
    v_pk_add_f32 v[98:99], v[98:99], v[128:129]
    v_pk_mul_f32 v[134:135], v[98:99], v[120:121]
    v_cvt_pk_bf16_f32 v145, v134, v135
    v_pk_add_f32 v[100:101], v[100:101], v[128:129]
    v_pk_mul_f32 v[136:137], v[100:101], v[120:121]
    v_cvt_pk_bf16_f32 v146, v136, v137
    v_pk_add_f32 v[102:103], v[102:103], v[128:129]
    v_pk_mul_f32 v[138:139], v[102:103], v[120:121]
    v_cvt_pk_bf16_f32 v147, v138, v139
    buffer_store_dwordx4 v[144:147], v243, s[24:27], s41 offen sc1
    v_pk_add_f32 v[104:105], v[104:105], v[128:129]
    v_pk_mul_f32 v[132:133], v[104:105], v[120:121]
    v_cvt_pk_bf16_f32 v148, v132, v133
    v_pk_add_f32 v[106:107], v[106:107], v[128:129]
    v_pk_mul_f32 v[134:135], v[106:107], v[120:121]
    v_cvt_pk_bf16_f32 v149, v134, v135
    v_pk_add_f32 v[108:109], v[108:109], v[128:129]
    v_pk_mul_f32 v[136:137], v[108:109], v[120:121]
    v_cvt_pk_bf16_f32 v150, v136, v137
    v_pk_add_f32 v[110:111], v[110:111], v[128:129]
    v_pk_mul_f32 v[138:139], v[110:111], v[120:121]
    v_cvt_pk_bf16_f32 v151, v138, v139
    buffer_store_dwordx4 v[148:151], v243, s[24:27], s42 offen sc1
    v_pk_add_f32 v[112:113], v[112:113], v[128:129]
    v_pk_mul_f32 v[132:133], v[112:113], v[120:121]
    v_cvt_pk_bf16_f32 v152, v132, v133
    v_pk_add_f32 v[114:115], v[114:115], v[128:129]
    v_pk_mul_f32 v[134:135], v[114:115], v[120:121]
    v_cvt_pk_bf16_f32 v153, v134, v135
    v_pk_add_f32 v[116:117], v[116:117], v[128:129]
    v_pk_mul_f32 v[136:137], v[116:117], v[120:121]
    v_cvt_pk_bf16_f32 v154, v136, v137
    v_pk_add_f32 v[118:119], v[118:119], v[128:129]
    v_pk_mul_f32 v[138:139], v[118:119], v[120:121]
    v_cvt_pk_bf16_f32 v155, v138, v139
    s_mov_b32 exec_hi, 0
    buffer_store_dwordx4 v[152:155], v243, s[24:27], s43 offen sc1
    s_mov_b64 exec, -1
    s_mov_b64 exec, 0
    s_cmp_eq_u32 s3, 0
    s_cbranch_scc1 pg_0
    s_cmp_eq_u32 s3, 1
    s_cbranch_scc1 pg_1
    s_cmp_eq_u32 s3, 2
    s_cbranch_scc1 pg_2
    s_branch pg_3
pg_back:
    s_mov_b64 exec, -1
    s_waitcnt vmcnt(9)
    v_readfirstlane_b32 s7, v26
    v_cvt_pk_bf16_f32 v64, v96, v97
    v_lshlrev_b32 v96, 16, v64
    v_and_b32 v97, 0xffff0000, v64
    v_pk_mul_f32 v[96:97], v[96:97], v[130:131]
    v_cvt_pk_bf16_f32 v64, v96, v97
    v_lshlrev_b32 v96, 16, v64
    v_and_b32 v97, 0xffff0000, v64
    v_lshlrev_b32 v132, 16, v76
    v_and_b32 v133, 0xffff0000, v76
    v_pk_mul_f32 v[120:121], v[96:97], v[132:133]
    s_add_u32 m0, s49, 73728
    s_nop 0
    buffer_load_dwordx4 v2, s[8:11], s36 offen offset:0 lds
    s_add_u32 m0, s49, 74624
    s_nop 0
    buffer_load_dwordx4 v2, s[8:11], s36 offen offset:128 lds
    v_cvt_pk_bf16_f32 v65, v98, v99
    v_lshlrev_b32 v98, 16, v65
    v_and_b32 v99, 0xffff0000, v65
    v_pk_mul_f32 v[98:99], v[98:99], v[130:131]
    v_cvt_pk_bf16_f32 v65, v98, v99
    v_lshlrev_b32 v98, 16, v65
    v_and_b32 v99, 0xffff0000, v65
    v_lshlrev_b32 v134, 16, v77
    v_and_b32 v135, 0xffff0000, v77
    v_pk_mul_f32 v[122:123], v[98:99], v[134:135]
    s_add_u32 m0, s49, 75520
    s_nop 0
    buffer_load_dwordx4 v2, s[8:11], s36 offen offset:256 lds
    s_add_u32 m0, s49, 76800
    s_nop 0
    buffer_load_dwordx4 v3, s[8:11], s36 offen offset:0 lds
    v_cvt_pk_bf16_f32 v66, v100, v101
    v_lshlrev_b32 v100, 16, v66
    v_and_b32 v101, 0xffff0000, v66
    v_pk_mul_f32 v[100:101], v[100:101], v[130:131]
    v_cvt_pk_bf16_f32 v66, v100, v101
    v_lshlrev_b32 v100, 16, v66
    v_and_b32 v101, 0xffff0000, v66
    v_lshlrev_b32 v136, 16, v78
    v_and_b32 v137, 0xffff0000, v78
    v_pk_fma_f32 v[120:121], v[100:101], v[136:137], v[120:121]
    s_add_u32 m0, s49, 77696
    s_nop 0
    buffer_load_dwordx4 v3, s[8:11], s36 offen offset:128 lds
    s_add_u32 m0, s49, 78592
    s_nop 0
    buffer_load_dwordx4 v3, s[8:11], s36 offen offset:256 lds
    s_add_u32 s36, s36, s37
    s_sub_u32 s55, s36, 7864320
    s_min_u32 s36, s36, s55
    v_cvt_pk_bf16_f32 v67, v102, v103
    v_lshlrev_b32 v102, 16, v67
    v_and_b32 v103, 0xffff0000, v67
    v_pk_mul_f32 v[102:103], v[102:103], v[130:131]
    v_cvt_pk_bf16_f32 v67, v102, v103
    v_lshlrev_b32 v102, 16, v67
    v_and_b32 v103, 0xffff0000, v67
    v_lshlrev_b32 v138, 16, v79
    v_and_b32 v139, 0xffff0000, v79
    v_pk_fma_f32 v[122:123], v[102:103], v[138:139], v[122:123]
    s_add_u32 m0, s49, 98304
    s_nop 0
    buffer_load_dwordx4 v2, s[8:11], s36 offen offset:0 lds
    s_add_u32 m0, s49, 99200
    s_nop 0
    buffer_load_dwordx4 v2, s[8:11], s36 offen offset:128 lds
    v_cvt_pk_bf16_f32 v68, v104, v105
    v_lshlrev_b32 v104, 16, v68
    v_and_b32 v105, 0xffff0000, v68
    v_pk_mul_f32 v[104:105], v[104:105], v[130:131]
    v_cvt_pk_bf16_f32 v68, v104, v105
    v_lshlrev_b32 v104, 16, v68
    v_and_b32 v105, 0xffff0000, v68
    v_lshlrev_b32 v132, 16, v80
    v_and_b32 v133, 0xffff0000, v80
    v_pk_fma_f32 v[120:121], v[104:105], v[132:133], v[120:121]
    s_add_u32 m0, s49, 100096
    s_nop 0
    buffer_load_dwordx4 v2, s[8:11], s36 offen offset:256 lds
    s_add_u32 m0, s49, 101376
    s_nop 0
    buffer_load_dwordx4 v3, s[8:11], s36 offen offset:0 lds
    s_waitcnt vmcnt(10) lgkmcnt(0)
    s_lshr_b32 s7, s7, 4
    s_mul_i32 s7, s7, 0x2c9277b5
    s_add_u32 s7, s7, 0x6c564b05
    s_lshl_b32 s7, s7, 4
    s_barrier
    v_mov_b32 v21, s7
    s_mov_b64 exec, 0xff
    buffer_store_dword v21, v20, s[24:27], s6 offen sc1
    s_mov_b64 exec, 0x11
    v_lshlrev_b32 v29, 3, v240
    s_mov_b32 s56, 3211264
    buffer_store_dwordx2 v[126:127], v29, s[24:27], s56 offen sc1
    s_mov_b64 exec, -1
    v_cvt_pk_bf16_f32 v69, v106, v107
    v_lshlrev_b32 v106, 16, v69
    v_and_b32 v107, 0xffff0000, v69
    v_pk_mul_f32 v[106:107], v[106:107], v[130:131]
    v_cvt_pk_bf16_f32 v69, v106, v107
    v_lshlrev_b32 v106, 16, v69
    v_and_b32 v107, 0xffff0000, v69
    v_lshlrev_b32 v134, 16, v81
    v_and_b32 v135, 0xffff0000, v81
    v_pk_fma_f32 v[122:123], v[106:107], v[134:135], v[122:123]
    s_add_u32 m0, s49, 102272
    s_nop 0
    buffer_load_dwordx4 v3, s[8:11], s36 offen offset:128 lds
    s_add_u32 m0, s49, 103168
    s_nop 0
    buffer_load_dwordx4 v3, s[8:11], s36 offen offset:256 lds
    s_add_u32 s36, s36, s37
    s_sub_u32 s55, s36, 7864320
    s_min_u32 s36, s36, s55
    v_cvt_pk_bf16_f32 v70, v108, v109
    v_lshlrev_b32 v108, 16, v70
    v_and_b32 v109, 0xffff0000, v70
    v_pk_mul_f32 v[108:109], v[108:109], v[130:131]
    v_cvt_pk_bf16_f32 v70, v108, v109
    v_lshlrev_b32 v108, 16, v70
    v_and_b32 v109, 0xffff0000, v70
    v_lshlrev_b32 v136, 16, v82
    v_and_b32 v137, 0xffff0000, v82
    v_pk_fma_f32 v[120:121], v[108:109], v[136:137], v[120:121]
    s_add_u32 m0, s49, 122880
    s_nop 0
    buffer_load_dwordx4 v2, s[8:11], s36 offen offset:0 lds
    s_add_u32 m0, s49, 123776
    s_nop 0
    buffer_load_dwordx4 v2, s[8:11], s36 offen offset:128 lds
    v_cvt_pk_bf16_f32 v71, v110, v111
    v_lshlrev_b32 v110, 16, v71
    v_and_b32 v111, 0xffff0000, v71
    v_pk_mul_f32 v[110:111], v[110:111], v[130:131]
    v_cvt_pk_bf16_f32 v71, v110, v111
    v_lshlrev_b32 v110, 16, v71
    v_and_b32 v111, 0xffff0000, v71
    v_lshlrev_b32 v138, 16, v83
    v_and_b32 v139, 0xffff0000, v83
    v_pk_fma_f32 v[122:123], v[110:111], v[138:139], v[122:123]
    s_add_u32 m0, s49, 124672
    s_nop 0
    buffer_load_dwordx4 v2, s[8:11], s36 offen offset:256 lds
    s_add_u32 m0, s49, 125952
    s_nop 0
    buffer_load_dwordx4 v3, s[8:11], s36 offen offset:0 lds
    s_mov_b32 exec_hi, 0
    v_cvt_pk_bf16_f32 v72, v112, v113
    v_lshlrev_b32 v112, 16, v72
    v_and_b32 v113, 0xffff0000, v72
    v_pk_mul_f32 v[112:113], v[112:113], v[130:131]
    v_cvt_pk_bf16_f32 v72, v112, v113
    v_lshlrev_b32 v112, 16, v72
    v_and_b32 v113, 0xffff0000, v72
    v_lshlrev_b32 v132, 16, v84
    v_and_b32 v133, 0xffff0000, v84
    v_pk_fma_f32 v[120:121], v[112:113], v[132:133], v[120:121]
    s_branch page0
    .p2align 12
page0:
pg_0:
    s_cbranch_execz pg_4
    v_cvt_pk_bf16_f32 v73, v114, v115
    v_lshlrev_b32 v114, 16, v73
    v_and_b32 v115, 0xffff0000, v73
    v_pk_mul_f32 v[114:115], v[114:115], v[130:131]
    v_cvt_pk_bf16_f32 v73, v114, v115
    v_lshlrev_b32 v114, 16, v73
    v_and_b32 v115, 0xffff0000, v73
    v_lshlrev_b32 v134, 16, v85
    v_and_b32 v135, 0xffff0000, v85
    v_pk_fma_f32 v[122:123], v[114:115], v[134:135], v[122:123]
    v_cvt_pk_bf16_f32 v74, v116, v117
    v_lshlrev_b32 v116, 16, v74
    v_and_b32 v117, 0xffff0000, v74
    v_pk_mul_f32 v[116:117], v[116:117], v[130:131]
    v_cvt_pk_bf16_f32 v74, v116, v117
    v_lshlrev_b32 v116, 16, v74
    v_and_b32 v117, 0xffff0000, v74
    v_lshlrev_b32 v136, 16, v86
    v_and_b32 v137, 0xffff0000, v86
    v_pk_fma_f32 v[120:121], v[116:117], v[136:137], v[120:121]
    v_cvt_pk_bf16_f32 v75, v118, v119
    v_lshlrev_b32 v118, 16, v75
    v_and_b32 v119, 0xffff0000, v75
    v_pk_mul_f32 v[118:119], v[118:119], v[130:131]
    v_cvt_pk_bf16_f32 v75, v118, v119
    v_lshlrev_b32 v118, 16, v75
    v_and_b32 v119, 0xffff0000, v75
    v_lshlrev_b32 v138, 16, v87
    v_and_b32 v139, 0xffff0000, v87
    v_pk_fma_f32 v[122:123], v[118:119], v[138:139], v[122:123]
    s_mov_b64 exec, -1
    v_pk_add_f32 v[120:121], v[120:121], v[122:123]
    v_add_f32 v120, v120, v121
    s_nop 1
    v_add_f32_dpp v120, v120, v120 quad_perm:[1,0,3,2] row_mask:0xf bank_mask:0xf
    s_nop 1
    v_add_f32_dpp v120, v120, v120 quad_perm:[2,3,0,1] row_mask:0xf bank_mask:0xf
    s_nop 1
    v_add_f32_dpp v120, v120, v120 row_ror:8 row_mask:0xf bank_mask:0xf
    v_mov_b32 v124, v120
    s_nop 1
    v_permlane16_swap_b32 v120, v124
    s_nop 1
    v_add_f32 v120, v120, v124
    v_mov_b32 v124, v120
    s_nop 1
    v_permlane32_swap_b32 v120, v124
    s_nop 1
    v_add_f32 v120, v120, v124
    v_cvt_pk_bf16_f32 v120, v120, v120
    v_and_b32 v120, 0xffff0000, v120
    v_ashrrev_i32 v122, 31, v120
    v_or_b32 v122, 0x80000000, v122
    v_xor_b32 v120, v120, v122
    v_and_b32 v120, 0xffff0000, v120
    v_sub_u32 v122, 2047, v240
    v_or_b32 v120, v120, v122
    s_nop 1
    v_mov_b32_dpp v121, v120 row_ror:4 row_mask:0xf bank_mask:0xf
    v_mov_b32 v122, s7
    v_mov_b32 v123, s7
    s_lshl_b32 s56, s2, 2
    s_add_u32 s56, s56, s3
    s_lshl_b32 s56, s56, 4
    s_add_u32 s56, s56, 3162112
    v_mov_b32 v29, 0
    s_mov_b64 exec, 1
    s_waitcnt vmcnt(6)
    buffer_store_dwordx4 v[120:123], v29, s[24:27], s56 offen sc1
    s_mov_b64 exec, -1
    s_add_u32 m0, s49, 126848
    s_nop 0
    buffer_load_dwordx4 v3, s[8:11], s36 offen offset:128 lds
    s_add_u32 m0, s49, 127744
    s_nop 0
    buffer_load_dwordx4 v3, s[8:11], s36 offen offset:256 lds
    s_add_u32 s36, s36, s37
    s_sub_u32 s55, s36, 7864320
    s_min_u32 s36, s36, s55
spin_ln:
    s_load_dwordx8 s[28:35], s[86:87], s46 glc
    s_add_u32 s101, s101, 1
    s_cmp_gt_u32 s101, 0x2000000
    s_cselect_b32 s57, 0, -1
    s_waitcnt lgkmcnt(0)
    s_xor_b32 s56, s28, s7
    s_xor_b32 s29, s29, s7
    s_or_b32 s56, s56, s29
    s_xor_b32 s30, s30, s7
    s_or_b32 s56, s56, s30
    s_xor_b32 s31, s31, s7
    s_or_b32 s56, s56, s31
    s_xor_b32 s32, s32, s7
    s_or_b32 s56, s56, s32
    s_xor_b32 s33, s33, s7
    s_or_b32 s56, s56, s33
    s_xor_b32 s34, s34, s7
    s_or_b32 s56, s56, s34
    s_xor_b32 s35, s35, s7
    s_or_b32 s56, s56, s35
    s_and_b32 s56, s56, s57
    s_cbranch_scc1 spin_ln
    s_add_u32 s46, s45, 0
    s_sub_u32 s77, s46, 81920
    s_min_u32 s46, s46, s77
    buffer_load_dwordx4 a[160:163], v14, s[20:23], s46 offen offset:0 sc1
    buffer_load_dwordx4 a[164:167], v14, s[20:23], s46 offen offset:1024 sc1
    buffer_load_dwordx4 a[168:171], v15, s[20:23], s46 offen offset:0 sc1
    buffer_load_dwordx4 a[172:175], v15, s[20:23], s46 offen offset:1024 sc1
    s_add_u32 s46, s45, 4096
    s_sub_u32 s77, s46, 81920
    s_min_u32 s46, s46, s77
    buffer_load_dwordx4 a[176:179], v14, s[20:23], s46 offen offset:0 sc1
    buffer_load_dwordx4 a[180:183], v14, s[20:23], s46 offen offset:1024 sc1
    buffer_load_dwordx4 a[184:187], v15, s[20:23], s46 offen offset:0 sc1
    buffer_load_dwordx4 a[188:191], v15, s[20:23], s46 offen offset:1024 sc1
head_code:
    s_waitcnt vmcnt(32)
    s_barrier
    ds_read_b64_tr_b16 a[224:225], v8 offset:0
    ds_read_b64_tr_b16 a[226:227], v8 offset:6144
    ds_read_b64_tr_b16 a[228:229], v9 offset:0
    ds_read_b64_tr_b16 a[230:231], v9 offset:6144
    ds_read_b64_tr_b16 a[232:233], v10 offset:0
    ds_read_b64_tr_b16 a[234:235], v10 offset:6144
    ds_read_b64_tr_b16 a[236:237], v11 offset:0
    ds_read_b64_tr_b16 a[238:239], v11 offset:6144
    ds_read_b64_tr_b16 a[240:241], v8 offset:1024
    ds_read_b64_tr_b16 a[242:243], v8 offset:7168
    ds_read_b64_tr_b16 a[244:245], v9 offset:1024
    ds_read_b64_tr_b16 a[246:247], v9 offset:7168
    s_waitcnt vmcnt(7) lgkmcnt(10)
    v_mfma_f32_16x16x32_bf16 v[64:67], a[224:227], a[160:163], 0
    s_waitcnt vmcnt(6) lgkmcnt(8)
    s_add_u32 s46, s45, 8192
    s_sub_u32 s77, s46, 81920
    v_mfma_f32_16x16x32_bf16 v[68:71], a[228:231], a[160:163], 0
    s_waitcnt vmcnt(5)
    s_min_u32 s46, s46, s77
    v_mfma_f32_16x16x32_bf16 v[76:79], a[228:231], a[164:167], 0
    buffer_load_dwordx4 a[96:99], v14, s[20:23], s46 offen offset:0 sc1
    v_mfma_f32_16x16x32_bf16 v[72:75], a[224:227], a[164:167], 0
    s_waitcnt vmcnt(5)
    v_mfma_f32_16x16x32_bf16 v[80:83], a[224:227], a[168:171], 0
    v_mfma_f32_16x16x32_bf16 v[84:87], a[228:231], a[168:171], 0
    v_mfma_f32_16x16x32_bf16 v[92:95], a[228:231], a[172:175], 0
    s_waitcnt lgkmcnt(0)
    ds_read_b64_tr_b16 a[228:229], v11 offset:1024
    v_mfma_f32_16x16x32_bf16 v[88:91], a[224:227], a[172:175], 0
    ds_read_b64_tr_b16 a[230:231], v11 offset:7168
    v_mfma_f32_16x16x32_bf16 v[120:123], a[232:235], a[172:175], 0
    buffer_load_dwordx4 a[100:103], v14, s[20:23], s46 offen offset:1024 sc1
    v_mfma_f32_16x16x32_bf16 v[124:127], a[236:239], a[172:175], 0
    s_mul_i32 s56, s50, 786432
    ds_read_b64_tr_b16 a[224:225], v10 offset:1024
    v_mul_u32_u24 v56, 3072, v5
    v_mfma_f32_16x16x32_bf16 v[116:119], a[236:239], a[168:171], 0
    s_add_u32 s56, s56, 589824
    ds_read_b64_tr_b16 a[226:227], v10 offset:7168
    v_add_u32 v56, v56, v7
    v_mfma_f32_16x16x32_bf16 v[112:115], a[232:235], a[168:171], 0
    s_add_u32 s12, s66, s56
    s_addc_u32 s13, s67, 0
    v_add_u32 v57, 49152, v56
    v_mfma_f32_16x16x32_bf16 v[104:107], a[232:235], a[164:167], 0
    s_and_b32 s13, s13, 0xffff
    v_lshrrev_b32 v29, 3, v1
    v_mul_u32_u24 v31, 384, v29
    v_mfma_f32_16x16x32_bf16 v[108:111], a[236:239], a[164:167], 0
    s_mov_b32 s14, 196608
    v_add_u32 v6, v31, v7
    v_bfe_u32 v29, v1, 4, 1
    v_mfma_f32_16x16x32_bf16 v[100:103], a[236:239], a[160:163], 0
    s_mov_b32 s15, 0x00020000
    ds_read_b64_tr_b16 a[236:237], v9 offset:2048
    v_bfe_u32 v30, v1, 5, 1
    v_mfma_f32_16x16x32_bf16 v[96:99], a[232:235], a[160:163], 0
    buffer_load_dwordx4 a[104:107], v15, s[20:23], s46 offen offset:0 sc1
    v_mfma_f32_16x16x32_bf16 v[128:131], a[240:243], a[160:163], 0
    s_add_u32 s16, s68, s56
    s_addc_u32 s17, s69, 0
    v_lshl_add_u32 v29, v29, 1, v30
    v_mfma_f32_16x16x32_bf16 v[132:135], a[244:247], a[160:163], 0
    s_and_b32 s17, s17, 0xffff
    ds_read_b64_tr_b16 a[238:239], v9 offset:8192
    v_and_b32 v30, 7, v1
    v_mfma_f32_16x16x32_bf16 v[140:143], a[244:247], a[164:167], 0
    s_mov_b32 s18, 196608
    ds_read_b64_tr_b16 a[232:233], v8 offset:2048
    v_xor_b32 v30, v30, v29
    v_mfma_f32_16x16x32_bf16 v[136:139], a[240:243], a[164:167], 0
    s_mov_b32 s19, 0x00020000
    ds_read_b64_tr_b16 a[234:235], v8 offset:8192
    v_lshl_add_u32 v4, v30, 4, v31
    v_mfma_f32_16x16x32_bf16 v[144:147], a[240:243], a[168:171], 0
    s_mov_b32 s28, s78
    v_xor_b32 v30, 4, v30
    v_lshl_add_u32 v5, v30, 4, v31
    v_mfma_f32_16x16x32_bf16 v[148:151], a[244:247], a[168:171], 0
    buffer_load_dwordx4 a[108:111], v15, s[20:23], s46 offen offset:1024 sc1
    v_mfma_f32_16x16x32_bf16 v[156:159], a[244:247], a[172:175], 0
    s_waitcnt lgkmcnt(3)
    ds_read_b64_tr_b16 a[244:245], v11 offset:2048
    v_add_u32 v5, 3072, v5
    v_mfma_f32_16x16x32_bf16 v[152:155], a[240:243], a[172:175], 0
    s_add_u32 s46, s45, 12288
    ds_read_b64_tr_b16 a[246:247], v11 offset:8192
    v_bfe_u32 v30, v1, 1, 1
    v_mfma_f32_16x16x32_bf16 v[184:187], a[224:227], a[172:175], 0
    s_sub_u32 s77, s46, 81920
    ds_read_b64_tr_b16 a[240:241], v10 offset:2048
    v_bfe_u32 v31, v1, 2, 1
    v_mfma_f32_16x16x32_bf16 v[188:191], a[228:231], a[172:175], 0
    s_min_u32 s46, s46, s77
    ds_read_b64_tr_b16 a[242:243], v10 offset:8192
    v_lshl_add_u32 v30, v30, 1, v31
    v_mfma_f32_16x16x32_bf16 v[180:183], a[228:231], a[168:171], 0
    s_and_b32 s29, s79, 0xffff
    v_bfe_u32 v31, v1, 3, 1
    v_lshl_add_u32 v30, v31, 2, v30
    v_mfma_f32_16x16x32_bf16 v[176:179], a[224:227], a[168:171], 0
    s_mov_b32 s30, 1966080
    v_xor_b32 v30, v30, v29
    v_lshlrev_b32 v30, 4, v30
    v_mfma_f32_16x16x32_bf16 v[168:171], a[224:227], a[164:167], 0
    buffer_load_dwordx4 a[112:115], v14, s[20:23], s46 offen offset:0 sc1
    v_mfma_f32_16x16x32_bf16 v[172:175], a[228:231], a[164:167], 0
    s_waitcnt lgkmcnt(3)
    v_mul_u32_u24 v31, 3072, v31
    v_and_b32 v29, 7, v1
    v_mfma_f32_16x16x32_bf16 v[164:167], a[228:231], a[160:163], 0
    s_mov_b32 s31, 0x00020000
    ds_read_b64_tr_b16 a[228:229], v9 offset:12288
    v_lshl_add_u32 v31, v29, 7, v31
    v_mfma_f32_16x16x32_bf16 v[160:163], a[224:227], a[160:163], 0
    s_mov_b32 s32, s80
    ds_read_b64_tr_b16 a[230:231], v9 offset:18432
    v_add_u32 v12, v31, v30
    v_mfma_f32_16x16x32_bf16 v[192:195], a[232:235], a[160:163], 0
    s_and_b32 s33, s81, 0xffff
    ds_read_b64_tr_b16 a[224:225], v8 offset:12288
    v_xor_b32 v30, 64, v30
    v_mfma_f32_16x16x32_bf16 v[196:199], a[236:239], a[160:163], 0
    s_mov_b32 s34, 1966080
    ds_read_b64_tr_b16 a[226:227], v8 offset:18432
    v_add_u32 v13, v31, v30
    v_mfma_f32_16x16x32_bf16 v[204:207], a[236:239], a[164:167], 0
    buffer_load_dwordx4 a[116:119], v14, s[20:23], s46 offen offset:1024 sc1
    v_mfma_f32_16x16x32_bf16 v[200:203], a[232:235], a[164:167], 0
    s_mov_b32 s35, 0x00020000
    v_lshrrev_b32 v19, 5, v1
    v_lshlrev_b32 v19, 11, v19
    v_mfma_f32_16x16x32_bf16 v[208:211], a[232:235], a[168:171], 0
    s_min_u32 s58, s2, 239
    v_sub_u32 v19, 0xffffa000, v19
    s_mul_hi_u32 s56, s58, 178956971
    v_mfma_f32_16x16x32_bf16 v[212:215], a[236:239], a[168:171], 0
    s_waitcnt lgkmcnt(3)
    s_mul_i32 s57, s56, 24
    s_sub_u32 s57, s58, s57
    v_mfma_f32_16x16x32_bf16 v[220:223], a[236:239], a[172:175], 0
    s_lshl_b32 s60, s56, 6
    ds_read_b64_tr_b16 a[236:237], v11 offset:12288
    s_add_u32 s60, s60, s59
    v_mfma_f32_16x16x32_bf16 v[216:219], a[232:235], a[172:175], 0
    s_mul_i32 s60, s60, 3072
    ds_read_b64_tr_b16 a[238:239], v11 offset:18432
    s_lshl_b32 s44, s57, 7
    v_mfma_f32_16x16x32_bf16 v[248:251], a[240:243], a[172:175], 0
    s_add_u32 s60, s60, s44
    ds_read_b64_tr_b16 a[232:233], v10 offset:12288
    s_lshl_b32 s61, s56, 7
    v_mfma_f32_16x16x32_bf16 v[252:255], a[244:247], a[172:175], 0
    buffer_load_dwordx4 a[120:123], v15, s[20:23], s46 offen offset:0 sc1
    v_mfma_f32_16x16x32_bf16 v[244:247], a[244:247], a[168:171], 0
    s_mul_i32 s62, s56, 1536
    ds_read_b64_tr_b16 a[234:235], v10 offset:18432
    s_lshl_b32 s44, s57, 6
    v_mfma_f32_16x16x32_bf16 v[240:243], a[240:243], a[168:171], 0
    s_add_u32 s62, s62, s44
    s_lshl_b32 s44, s3, 4
    s_add_u32 s62, s62, s44
    v_mfma_f32_16x16x32_bf16 v[232:235], a[240:243], a[164:167], 0
    s_lshl_b32 s62, s62, 4
    s_add_u32 s62, s62, 3276800
    s_lshl_b32 s4, s2, 8
    v_mfma_f32_16x16x32_bf16 v[236:239], a[244:247], a[164:167], 0
    s_waitcnt vmcnt(10) lgkmcnt(3)
    s_lshl_b32 s44, s3, 2
    s_add_u32 s4, s4, s44
    v_mfma_f32_16x16x32_bf16 v[228:231], a[244:247], a[160:163], 0
    s_add_u32 s4, s4, 3932160
    ds_read_b64_tr_b16 a[244:245], v9 offset:13312
    s_lshl_b32 s5, s52, 3
    v_mfma_f32_16x16x32_bf16 v[224:227], a[240:243], a[160:163], 0
    buffer_load_dwordx4 a[124:127], v15, s[20:23], s46 offen offset:1024 sc1
    v_mfma_f32_16x16x32_bf16 v[64:67], a[224:227], a[176:179], v[64:67]
    s_waitcnt vmcnt(10)
    ds_read_b64_tr_b16 a[246:247], v9 offset:19456
    s_add_u32 s46, s45, 16384
    v_mfma_f32_16x16x32_bf16 v[68:71], a[228:231], a[176:179], v[68:71]
    s_waitcnt vmcnt(9)
    ds_read_b64_tr_b16 a[240:241], v8 offset:13312
    s_sub_u32 s77, s46, 81920
    v_mfma_f32_16x16x32_bf16 v[76:79], a[228:231], a[180:183], v[76:79]
    s_min_u32 s46, s46, s77
    ds_read_b64_tr_b16 a[242:243], v8 offset:19456
    s_add_u32 s5, s5, s53
    v_mfma_f32_16x16x32_bf16 v[72:75], a[224:227], a[180:183], v[72:75]
    s_waitcnt vmcnt(8)
    s_lshl_b32 s5, s5, 2
    s_add_u32 s5, s5, s3
    v_mfma_f32_16x16x32_bf16 v[80:83], a[224:227], a[184:187], v[80:83]
    s_lshl_b32 s5, s5, 7
    s_add_u32 s5, s5, 4096000
    s_lshl_b32 s76, s51, 2
    v_mfma_f32_16x16x32_bf16 v[84:87], a[228:231], a[184:187], v[84:87]
    s_waitcnt lgkmcnt(3)
    s_add_u32 s76, s76, s5
    s_mov_b32 s92, 0xbfb8aa3b
    v_mfma_f32_16x16x32_bf16 v[92:95], a[228:231], a[188:191], v[92:95]
    buffer_load_dwordx4 a[128:131], v14, s[20:23], s46 offen offset:0 sc1
    v_mfma_f32_16x16x32_bf16 v[88:91], a[224:227], a[188:191], v[88:91]
    s_lshl_b32 s44, s3, 12
    ds_read_b64_tr_b16 a[228:229], v11 offset:13312
    s_mov_b32 s38, s49
    v_mfma_f32_16x16x32_bf16 v[120:123], a[232:235], a[188:191], v[120:123]
    s_mul_i32 s40, s3, 3072
    ds_read_b64_tr_b16 a[230:231], v11 offset:19456
    s_mov_b32 s47, 3162112
    v_mfma_f32_16x16x32_bf16 v[124:127], a[236:239], a[188:191], v[124:127]
    s_lshl_b32 s63, s3, 10
    ds_read_b64_tr_b16 a[224:225], v10 offset:13312
    s_lshl_b32 s67, s2, 2
    v_mfma_f32_16x16x32_bf16 v[116:119], a[236:239], a[184:187], v[116:119]
    s_add_u32 s67, s67, s3
    ds_read_b64_tr_b16 a[226:227], v10 offset:19456
    s_lshl_b32 s67, s67, 7
    v_mfma_f32_16x16x32_bf16 v[112:115], a[232:235], a[184:187], v[112:115]
    s_add_u32 s67, s67, 4194304
    v_mfma_f32_16x16x32_bf16 v[104:107], a[232:235], a[180:183], v[104:107]
    buffer_load_dwordx4 a[132:135], v14, s[20:23], s46 offen offset:1024 sc1
    v_mfma_f32_16x16x32_bf16 v[108:111], a[236:239], a[180:183], v[108:111]
    s_waitcnt lgkmcnt(4)
    v_mfma_f32_16x16x32_bf16 v[100:103], a[236:239], a[176:179], v[100:103]
    ds_read_b64_tr_b16 a[236:237], v9 offset:14336
    v_mfma_f32_16x16x32_bf16 v[96:99], a[232:235], a[176:179], v[96:99]
    ds_read_b64_tr_b16 a[238:239], v9 offset:20480
    v_mfma_f32_16x16x32_bf16 v[128:131], a[240:243], a[176:179], v[128:131]
    ds_read_b64_tr_b16 a[232:233], v8 offset:14336
    v_mfma_f32_16x16x32_bf16 v[132:135], a[244:247], a[176:179], v[132:135]
    ds_read_b64_tr_b16 a[234:235], v8 offset:20480
    v_mfma_f32_16x16x32_bf16 v[140:143], a[244:247], a[180:183], v[140:143]
    v_mfma_f32_16x16x32_bf16 v[136:139], a[240:243], a[180:183], v[136:139]
    buffer_load_dwordx4 a[136:139], v15, s[20:23], s46 offen offset:0 sc1
    v_mfma_f32_16x16x32_bf16 v[144:147], a[240:243], a[184:187], v[144:147]
    v_mfma_f32_16x16x32_bf16 v[148:151], a[244:247], a[184:187], v[148:151]
    s_waitcnt lgkmcnt(3)
    v_mfma_f32_16x16x32_bf16 v[156:159], a[244:247], a[188:191], v[156:159]
    ds_read_b64_tr_b16 a[244:245], v11 offset:14336
    ds_read_b64_tr_b16 a[246:247], v11 offset:20480
    v_mfma_f32_16x16x32_bf16 v[152:155], a[240:243], a[188:191], v[152:155]
    ds_read_b64_tr_b16 a[240:241], v10 offset:14336
    ds_read_b64_tr_b16 a[242:243], v10 offset:20480
    v_mfma_f32_16x16x32_bf16 v[184:187], a[224:227], a[188:191], v[184:187]
    v_mfma_f32_16x16x32_bf16 v[188:191], a[228:231], a[188:191], v[188:191]
    buffer_load_dwordx4 a[140:143], v15, s[20:23], s46 offen offset:1024 sc1
    v_mfma_f32_16x16x32_bf16 v[180:183], a[228:231], a[184:187], v[180:183]
    s_add_u32 s46, s45, 20480
    s_sub_u32 s77, s46, 81920
    s_min_u32 s46, s46, s77
    v_mfma_f32_16x16x32_bf16 v[176:179], a[224:227], a[184:187], v[176:179]
    v_mfma_f32_16x16x32_bf16 v[168:171], a[224:227], a[180:183], v[168:171]
    v_mfma_f32_16x16x32_bf16 v[172:175], a[228:231], a[180:183], v[172:175]
    s_waitcnt lgkmcnt(2)
    v_mfma_f32_16x16x32_bf16 v[164:167], a[228:231], a[176:179], v[164:167]
    s_waitcnt lgkmcnt(0)
    s_barrier
    v_mfma_f32_16x16x32_bf16 v[160:163], a[224:227], a[176:179], v[160:163]
    ds_read_b64_tr_b16 a[224:225], v8 offset:24576
    v_mfma_f32_16x16x32_bf16 v[192:195], a[232:235], a[176:179], v[192:195]
    buffer_load_dwordx4 a[144:147], v14, s[20:23], s46 offen offset:0 sc1
    v_mfma_f32_16x16x32_bf16 v[196:199], a[236:239], a[176:179], v[196:199]
    ds_read_b64_tr_b16 a[226:227], v8 offset:30720
    v_mfma_f32_16x16x32_bf16 v[204:207], a[236:239], a[180:183], v[204:207]
    ds_read_b64_tr_b16 a[228:229], v8 offset:36864
    v_mfma_f32_16x16x32_bf16 v[200:203], a[232:235], a[180:183], v[200:203]
    ds_read_b64_tr_b16 a[230:231], v8 offset:43008
    v_mfma_f32_16x16x32_bf16 v[208:211], a[232:235], a[184:187], v[208:211]
    v_mfma_f32_16x16x32_bf16 v[212:215], a[236:239], a[184:187], v[212:215]
    v_mfma_f32_16x16x32_bf16 v[220:223], a[236:239], a[188:191], v[220:223]
    buffer_load_dwordx4 a[148:151], v14, s[20:23], s46 offen offset:1024 sc1
    v_mfma_f32_16x16x32_bf16 v[216:219], a[232:235], a[188:191], v[216:219]
    ds_read_b64_tr_b16 a[232:233], v9 offset:24576
    v_mfma_f32_16x16x32_bf16 v[248:251], a[240:243], a[188:191], v[248:251]
    ds_read_b64_tr_b16 a[234:235], v9 offset:30720
    v_mfma_f32_16x16x32_bf16 v[252:255], a[244:247], a[188:191], v[252:255]
    ds_read_b64_tr_b16 a[236:237], v9 offset:36864
    v_mfma_f32_16x16x32_bf16 v[244:247], a[244:247], a[184:187], v[244:247]
    ds_read_b64_tr_b16 a[238:239], v9 offset:43008
    v_mfma_f32_16x16x32_bf16 v[240:243], a[240:243], a[184:187], v[240:243]
    v_mfma_f32_16x16x32_bf16 v[232:235], a[240:243], a[180:183], v[232:235]
    v_mfma_f32_16x16x32_bf16 v[236:239], a[244:247], a[180:183], v[236:239]
    buffer_load_dwordx4 a[152:155], v15, s[20:23], s46 offen offset:0 sc1
    v_mfma_f32_16x16x32_bf16 v[228:231], a[244:247], a[176:179], v[228:231]
    s_waitcnt vmcnt(10) lgkmcnt(3)
    v_mfma_f32_16x16x32_bf16 v[224:227], a[240:243], a[176:179], v[224:227]
    s_waitcnt vmcnt(9)
    ds_read_b64_tr_b16 a[240:241], v10 offset:24576
    v_mfma_f32_16x16x32_bf16 v[64:67], a[224:227], a[96:99], v[64:67]
    ds_read_b64_tr_b16 a[242:243], v10 offset:30720
    v_mfma_f32_16x16x32_bf16 v[64:67], a[228:231], a[112:115], v[64:67]
    ds_read_b64_tr_b16 a[244:245], v10 offset:36864
    v_mfma_f32_16x16x32_bf16 v[72:75], a[228:231], a[116:119], v[72:75]
    s_waitcnt vmcnt(8)
    ds_read_b64_tr_b16 a[246:247], v10 offset:43008
    v_mfma_f32_16x16x32_bf16 v[72:75], a[224:227], a[100:103], v[72:75]
    buffer_load_dwordx4 a[156:159], v15, s[20:23], s46 offen offset:1024 sc1
    v_mfma_f32_16x16x32_bf16 v[80:83], a[224:227], a[104:107], v[80:83]
    s_waitcnt vmcnt(8)
    s_add_u32 s46, s45, 24576
    s_sub_u32 s77, s46, 81920
    v_mfma_f32_16x16x32_bf16 v[80:83], a[228:231], a[120:123], v[80:83]
    s_waitcnt lgkmcnt(4)
    s_min_u32 s46, s46, s77
    v_mfma_f32_16x16x32_bf16 v[88:91], a[228:231], a[124:127], v[88:91]
    v_mfma_f32_16x16x32_bf16 v[88:91], a[224:227], a[108:111], v[88:91]
    ds_read_b64_tr_b16 a[224:225], v11 offset:24576
    v_mfma_f32_16x16x32_bf16 v[92:95], a[232:235], a[108:111], v[92:95]
    ds_read_b64_tr_b16 a[226:227], v11 offset:30720
    v_mfma_f32_16x16x32_bf16 v[92:95], a[236:239], a[124:127], v[92:95]
    ds_read_b64_tr_b16 a[228:229], v11 offset:36864
    v_mfma_f32_16x16x32_bf16 v[84:87], a[236:239], a[120:123], v[84:87]
    buffer_load_dwordx4 a[192:195], v14, s[20:23], s46 offen offset:0 sc1
    v_mfma_f32_16x16x32_bf16 v[84:87], a[232:235], a[104:107], v[84:87]
    ds_read_b64_tr_b16 a[230:231], v11 offset:43008
    v_mfma_f32_16x16x32_bf16 v[76:79], a[232:235], a[100:103], v[76:79]
    v_mfma_f32_16x16x32_bf16 v[76:79], a[236:239], a[116:119], v[76:79]
    s_waitcnt lgkmcnt(4)
    v_mfma_f32_16x16x32_bf16 v[68:71], a[236:239], a[112:115], v[68:71]
    v_mfma_f32_16x16x32_bf16 v[68:71], a[232:235], a[96:99], v[68:71]
    ds_read_b64_tr_b16 a[232:233], v8 offset:25600
    v_mfma_f32_16x16x32_bf16 v[96:99], a[240:243], a[96:99], v[96:99]
    buffer_load_dwordx4 a[196:199], v14, s[20:23], s46 offen offset:1024 sc1
    v_mfma_f32_16x16x32_bf16 v[96:99], a[244:247], a[112:115], v[96:99]
    ds_read_b64_tr_b16 a[234:235], v8 offset:31744
    v_mfma_f32_16x16x32_bf16 v[104:107], a[244:247], a[116:119], v[104:107]
    ds_read_b64_tr_b16 a[236:237], v8 offset:37888
    v_mfma_f32_16x16x32_bf16 v[104:107], a[240:243], a[100:103], v[104:107]
    ds_read_b64_tr_b16 a[238:239], v8 offset:44032
    v_mfma_f32_16x16x32_bf16 v[112:115], a[240:243], a[104:107], v[112:115]
    v_mfma_f32_16x16x32_bf16 v[112:115], a[244:247], a[120:123], v[112:115]
    s_waitcnt lgkmcnt(4)
    v_mfma_f32_16x16x32_bf16 v[120:123], a[244:247], a[124:127], v[120:123]
    v_mfma_f32_16x16x32_bf16 v[120:123], a[240:243], a[108:111], v[120:123]
    buffer_load_dwordx4 a[200:203], v15, s[20:23], s46 offen offset:0 sc1
    v_mfma_f32_16x16x32_bf16 v[124:127], a[224:227], a[108:111], v[124:127]
    ds_read_b64_tr_b16 a[240:241], v9 offset:25600
    v_mfma_f32_16x16x32_bf16 v[124:127], a[228:231], a[124:127], v[124:127]
    ds_read_b64_tr_b16 a[242:243], v9 offset:31744
    v_mfma_f32_16x16x32_bf16 v[116:119], a[228:231], a[120:123], v[116:119]
    ds_read_b64_tr_b16 a[244:245], v9 offset:37888
    v_mfma_f32_16x16x32_bf16 v[116:119], a[224:227], a[104:107], v[116:119]
    ds_read_b64_tr_b16 a[246:247], v9 offset:44032
    v_mfma_f32_16x16x32_bf16 v[108:111], a[224:227], a[100:103], v[108:111]
    v_mfma_f32_16x16x32_bf16 v[108:111], a[228:231], a[116:119], v[108:111]
    buffer_load_dwordx4 a[204:207], v15, s[20:23], s46 offen offset:1024 sc1
    v_mfma_f32_16x16x32_bf16 v[100:103], a[228:231], a[112:115], v[100:103]
    s_waitcnt lgkmcnt(4)
    s_add_u32 m0, s49, 0
    v_mfma_f32_16x16x32_bf16 v[100:103], a[224:227], a[96:99], v[100:103]
    ds_read_b64_tr_b16 a[224:225], v10 offset:25600
    v_mfma_f32_16x16x32_bf16 v[128:131], a[232:235], a[96:99], v[128:131]
    ds_read_b64_tr_b16 a[226:227], v10 offset:31744
    v_mfma_f32_16x16x32_bf16 v[128:131], a[236:239], a[112:115], v[128:131]
    ds_read_b64_tr_b16 a[228:229], v10 offset:37888
    v_mfma_f32_16x16x32_bf16 v[136:139], a[236:239], a[116:119], v[136:139]
    ds_read_b64_tr_b16 a[230:231], v10 offset:44032
    v_mfma_f32_16x16x32_bf16 v[136:139], a[232:235], a[100:103], v[136:139]
    v_mfma_f32_16x16x32_bf16 v[144:147], a[232:235], a[104:107], v[144:147]
    buffer_load_dwordx4 v2, s[8:11], s36 offen offset:0 lds
    v_mfma_f32_16x16x32_bf16 v[144:147], a[236:239], a[120:123], v[144:147]
    s_waitcnt lgkmcnt(4)
    s_add_u32 m0, s49, 896
    v_mfma_f32_16x16x32_bf16 v[152:155], a[236:239], a[124:127], v[152:155]
    v_mfma_f32_16x16x32_bf16 v[152:155], a[232:235], a[108:111], v[152:155]
    ds_read_b64_tr_b16 a[232:233], v11 offset:25600
    v_mfma_f32_16x16x32_bf16 v[156:159], a[240:243], a[108:111], v[156:159]
    ds_read_b64_tr_b16 a[234:235], v11 offset:31744
    v_mfma_f32_16x16x32_bf16 v[156:159], a[244:247], a[124:127], v[156:159]
    ds_read_b64_tr_b16 a[236:237], v11 offset:37888
    v_mfma_f32_16x16x32_bf16 v[148:151], a[244:247], a[120:123], v[148:151]
    buffer_load_dwordx4 v2, s[8:11], s36 offen offset:128 lds
    v_mfma_f32_16x16x32_bf16 v[148:151], a[240:243], a[104:107], v[148:151]
    s_add_u32 m0, s49, 1792
    ds_read_b64_tr_b16 a[238:239], v11 offset:44032
    v_mfma_f32_16x16x32_bf16 v[140:143], a[240:243], a[100:103], v[140:143]
    v_mfma_f32_16x16x32_bf16 v[140:143], a[244:247], a[116:119], v[140:143]
    s_waitcnt lgkmcnt(4)
    v_mfma_f32_16x16x32_bf16 v[132:135], a[244:247], a[112:115], v[132:135]
    v_mfma_f32_16x16x32_bf16 v[132:135], a[240:243], a[96:99], v[132:135]
    ds_read_b64_tr_b16 a[240:241], v8 offset:26624
    v_mfma_f32_16x16x32_bf16 v[160:163], a[224:227], a[96:99], v[160:163]
    ds_read_b64_tr_b16 a[242:243], v8 offset:32768
    v_mfma_f32_16x16x32_bf16 v[160:163], a[228:231], a[112:115], v[160:163]
    buffer_load_dwordx4 v2, s[8:11], s36 offen offset:256 lds
    v_mfma_f32_16x16x32_bf16 v[168:171], a[228:231], a[116:119], v[168:171]
    s_add_u32 m0, s49, 3072
    ds_read_b64_tr_b16 a[244:245], v8 offset:38912
    v_mfma_f32_16x16x32_bf16 v[168:171], a[224:227], a[100:103], v[168:171]
    ds_read_b64_tr_b16 a[246:247], v8 offset:45056
    v_mfma_f32_16x16x32_bf16 v[176:179], a[224:227], a[104:107], v[176:179]
    v_add_u32 v8, 49152, v8
    v_mfma_f32_16x16x32_bf16 v[176:179], a[228:231], a[120:123], v[176:179]
    s_waitcnt lgkmcnt(4)
    v_mfma_f32_16x16x32_bf16 v[184:187], a[228:231], a[124:127], v[184:187]
    v_mfma_f32_16x16x32_bf16 v[184:187], a[224:227], a[108:111], v[184:187]
    buffer_load_dwordx4 v3, s[8:11], s36 offen offset:0 lds
    v_mfma_f32_16x16x32_bf16 v[188:191], a[232:235], a[108:111], v[188:191]
    s_add_u32 m0, s49, 3968
    ds_read_b64_tr_b16 a[224:225], v9 offset:26624
    v_mfma_f32_16x16x32_bf16 v[188:191], a[236:239], a[124:127], v[188:191]
    ds_read_b64_tr_b16 a[226:227], v9 offset:32768
    v_mfma_f32_16x16x32_bf16 v[180:183], a[236:239], a[120:123], v[180:183]
    ds_read_b64_tr_b16 a[228:229], v9 offset:38912
    v_mfma_f32_16x16x32_bf16 v[180:183], a[232:235], a[104:107], v[180:183]
    ds_read_b64_tr_b16 a[230:231], v9 offset:45056
    v_mfma_f32_16x16x32_bf16 v[172:175], a[232:235], a[100:103], v[172:175]
    v_add_u32 v9, 49152, v9
    v_mfma_f32_16x16x32_bf16 v[172:175], a[236:239], a[116:119], v[172:175]
    s_waitcnt lgkmcnt(4)
    v_mfma_f32_16x16x32_bf16 v[164:167], a[236:239], a[112:115], v[164:167]
    buffer_load_dwordx4 v3, s[8:11], s36 offen offset:128 lds
    v_mfma_f32_16x16x32_bf16 v[164:167], a[232:235], a[96:99], v[164:167]
    s_add_u32 m0, s49, 4864
    ds_read_b64_tr_b16 a[232:233], v10 offset:26624
    v_mfma_f32_16x16x32_bf16 v[192:195], a[240:243], a[96:99], v[192:195]
    ds_read_b64_tr_b16 a[234:235], v10 offset:32768
    v_mfma_f32_16x16x32_bf16 v[192:195], a[244:247], a[112:115], v[192:195]
    ds_read_b64_tr_b16 a[236:237], v10 offset:38912
    v_mfma_f32_16x16x32_bf16 v[200:203], a[244:247], a[116:119], v[200:203]
    ds_read_b64_tr_b16 a[238:239], v10 offset:45056
    v_mfma_f32_16x16x32_bf16 v[200:203], a[240:243], a[100:103], v[200:203]
    v_add_u32 v10, 49152, v10
    v_mfma_f32_16x16x32_bf16 v[208:211], a[240:243], a[104:107], v[208:211]
    buffer_load_dwordx4 v3, s[8:11], s36 offen offset:256 lds
    v_mfma_f32_16x16x32_bf16 v[208:211], a[244:247], a[120:123], v[208:211]
    s_waitcnt lgkmcnt(4)
    s_add_u32 s36, s36, s37
    s_sub_u32 s55, s36, 7864320
    v_mfma_f32_16x16x32_bf16 v[216:219], a[244:247], a[124:127], v[216:219]
    s_min_u32 s36, s36, s55
    s_add_u32 s46, s45, 28672
    s_sub_u32 s77, s46, 81920
    v_mfma_f32_16x16x32_bf16 v[216:219], a[240:243], a[108:111], v[216:219]
    s_min_u32 s46, s46, s77
    ds_read_b64_tr_b16 a[240:241], v11 offset:26624
    ds_read_b64_tr_b16 a[242:243], v11 offset:32768
    ds_read_b64_tr_b16 a[244:245], v11 offset:38912
    v_mfma_f32_16x16x32_bf16 v[220:223], a[224:227], a[108:111], v[220:223]
    ds_read_b64_tr_b16 a[246:247], v11 offset:45056
    v_mfma_f32_16x16x32_bf16 v[220:223], a[228:231], a[124:127], v[220:223]
    v_add_u32 v11, 49152, v11
    v_mfma_f32_16x16x32_bf16 v[212:215], a[228:231], a[120:123], v[212:215]
    v_mfma_f32_16x16x32_bf16 v[212:215], a[224:227], a[104:107], v[212:215]
    buffer_load_dwordx4 a[208:211], v14, s[20:23], s46 offen offset:0 sc1
    v_mfma_f32_16x16x32_bf16 v[204:207], a[224:227], a[100:103], v[204:207]
    v_mfma_f32_16x16x32_bf16 v[204:207], a[228:231], a[116:119], v[204:207]
    s_waitcnt lgkmcnt(4)
    v_mfma_f32_16x16x32_bf16 v[196:199], a[228:231], a[112:115], v[196:199]
    s_waitcnt lgkmcnt(0)
    s_barrier
    v_mfma_f32_16x16x32_bf16 v[196:199], a[224:227], a[96:99], v[196:199]
    ds_read_b64_tr_b16 a[224:225], v8 offset:0
    v_mfma_f32_16x16x32_bf16 v[224:227], a[232:235], a[96:99], v[224:227]
    ds_read_b64_tr_b16 a[226:227], v8 offset:6144
    v_mfma_f32_16x16x32_bf16 v[224:227], a[236:239], a[112:115], v[224:227]
    buffer_load_dwordx4 a[212:215], v14, s[20:23], s46 offen offset:1024 sc1
    v_mfma_f32_16x16x32_bf16 v[232:235], a[236:239], a[116:119], v[232:235]
    ds_read_b64_tr_b16 a[228:229], v8 offset:12288
    v_mfma_f32_16x16x32_bf16 v[232:235], a[232:235], a[100:103], v[232:235]
    ds_read_b64_tr_b16 a[230:231], v8 offset:18432
    v_mfma_f32_16x16x32_bf16 v[240:243], a[232:235], a[104:107], v[240:243]
    v_mov_b32 v23, 0
    v_mfma_f32_16x16x32_bf16 v[240:243], a[236:239], a[120:123], v[240:243]
    buffer_load_dword a252, v23, s[24:27], s67 offen sc1
    v_mfma_f32_16x16x32_bf16 v[248:251], a[236:239], a[124:127], v[248:251]
    v_mfma_f32_16x16x32_bf16 v[248:251], a[232:235], a[108:111], v[248:251]
    ds_read_b64_tr_b16 a[232:233], v9 offset:0
    v_mfma_f32_16x16x32_bf16 v[252:255], a[240:243], a[108:111], v[252:255]
    buffer_load_dwordx4 a[216:219], v15, s[20:23], s46 offen offset:0 sc1
    v_mfma_f32_16x16x32_bf16 v[252:255], a[244:247], a[124:127], v[252:255]
    ds_read_b64_tr_b16 a[234:235], v9 offset:6144
    v_mfma_f32_16x16x32_bf16 v[244:247], a[244:247], a[120:123], v[244:247]
pg_1:
    s_cbranch_execz pg_5
    ds_read_b64_tr_b16 a[236:237], v9 offset:12288
    v_mfma_f32_16x16x32_bf16 v[244:247], a[240:243], a[104:107], v[244:247]
    ds_read_b64_tr_b16 a[238:239], v9 offset:18432
    v_mfma_f32_16x16x32_bf16 v[236:239], a[240:243], a[100:103], v[236:239]
    v_mfma_f32_16x16x32_bf16 v[236:239], a[244:247], a[116:119], v[236:239]
    s_waitcnt vmcnt(21) lgkmcnt(4)
    v_mfma_f32_16x16x32_bf16 v[228:231], a[244:247], a[112:115], v[228:231]
    buffer_load_dwordx4 a[220:223], v15, s[20:23], s46 offen offset:1024 sc1
    v_mfma_f32_16x16x32_bf16 v[228:231], a[240:243], a[96:99], v[228:231]
    s_waitcnt vmcnt(17)
    ds_read_b64_tr_b16 a[240:241], v10 offset:0
    v_and_b32 v22, 1, v1
    v_mfma_f32_16x16x32_bf16 v[64:67], a[224:227], a[128:131], v[64:67]
    s_add_u32 s46, s45, 32768
    ds_read_b64_tr_b16 a[242:243], v10 offset:6144
    s_sub_u32 s77, s46, 81920
    v_mfma_f32_16x16x32_bf16 v[64:67], a[228:231], a[144:147], v[64:67]
    s_min_u32 s46, s46, s77
    ds_read_b64_tr_b16 a[244:245], v10 offset:12288
    s_sub_u32 s56, s5, s4
    v_mfma_f32_16x16x32_bf16 v[72:75], a[228:231], a[148:151], v[72:75]
    s_waitcnt vmcnt(16)
    ds_read_b64_tr_b16 a[246:247], v10 offset:18432
    s_sub_u32 s56, s56, 128
    v_mfma_f32_16x16x32_bf16 v[72:75], a[224:227], a[132:135], v[72:75]
    s_waitcnt vmcnt(15)
    v_mul_lo_u32 v22, v22, s56
    v_mfma_f32_16x16x32_bf16 v[80:83], a[224:227], a[136:139], v[80:83]
    buffer_load_dword a252, v22, s[24:27], s4 offen offset:128 sc1
    v_mfma_f32_16x16x32_bf16 v[80:83], a[228:231], a[152:155], v[80:83]
    buffer_load_dwordx4 a[0:3], v14, s[20:23], s46 offen offset:0 sc1
    v_mfma_f32_16x16x32_bf16 v[88:91], a[228:231], a[156:159], v[88:91]
    s_waitcnt lgkmcnt(3)
    v_mfma_f32_16x16x32_bf16 v[88:91], a[224:227], a[140:143], v[88:91]
    ds_read_b64_tr_b16 a[224:225], v11 offset:0
    v_mfma_f32_16x16x32_bf16 v[92:95], a[232:235], a[140:143], v[92:95]
    ds_read_b64_tr_b16 a[226:227], v11 offset:6144
    v_mfma_f32_16x16x32_bf16 v[92:95], a[236:239], a[156:159], v[92:95]
    ds_read_b64_tr_b16 a[228:229], v11 offset:12288
    v_mfma_f32_16x16x32_bf16 v[84:87], a[236:239], a[152:155], v[84:87]
    ds_read_b64_tr_b16 a[230:231], v11 offset:18432
    v_mfma_f32_16x16x32_bf16 v[84:87], a[232:235], a[136:139], v[84:87]
    buffer_load_dwordx4 a[4:7], v14, s[20:23], s46 offen offset:1024 sc1
    v_mfma_f32_16x16x32_bf16 v[76:79], a[232:235], a[132:135], v[76:79]
    v_mfma_f32_16x16x32_bf16 v[76:79], a[236:239], a[148:151], v[76:79]
    s_waitcnt lgkmcnt(4)
    v_mfma_f32_16x16x32_bf16 v[68:71], a[236:239], a[144:147], v[68:71]
    v_mfma_f32_16x16x32_bf16 v[68:71], a[232:235], a[128:131], v[68:71]
    ds_read_b64_tr_b16 a[232:233], v8 offset:1024
    v_mfma_f32_16x16x32_bf16 v[96:99], a[240:243], a[128:131], v[96:99]
    ds_read_b64_tr_b16 a[234:235], v8 offset:7168
    v_mfma_f32_16x16x32_bf16 v[96:99], a[244:247], a[144:147], v[96:99]
    ds_read_b64_tr_b16 a[236:237], v8 offset:13312
    v_mfma_f32_16x16x32_bf16 v[104:107], a[244:247], a[148:151], v[104:107]
    buffer_load_dwordx4 a[8:11], v15, s[20:23], s46 offen offset:0 sc1
    v_mfma_f32_16x16x32_bf16 v[104:107], a[240:243], a[132:135], v[104:107]
    ds_read_b64_tr_b16 a[238:239], v8 offset:19456
    v_mfma_f32_16x16x32_bf16 v[112:115], a[240:243], a[136:139], v[112:115]
    v_mfma_f32_16x16x32_bf16 v[112:115], a[244:247], a[152:155], v[112:115]
    s_waitcnt lgkmcnt(4)
    v_mfma_f32_16x16x32_bf16 v[120:123], a[244:247], a[156:159], v[120:123]
    v_mfma_f32_16x16x32_bf16 v[120:123], a[240:243], a[140:143], v[120:123]
    ds_read_b64_tr_b16 a[240:241], v9 offset:1024
    v_mfma_f32_16x16x32_bf16 v[124:127], a[224:227], a[140:143], v[124:127]
    buffer_load_dwordx4 a[12:15], v15, s[20:23], s46 offen offset:1024 sc1
    v_mfma_f32_16x16x32_bf16 v[124:127], a[228:231], a[156:159], v[124:127]
    s_add_u32 m0, s49, 24576
    ds_read_b64_tr_b16 a[242:243], v9 offset:7168
    v_mfma_f32_16x16x32_bf16 v[116:119], a[228:231], a[152:155], v[116:119]
    ds_read_b64_tr_b16 a[244:245], v9 offset:13312
    v_mfma_f32_16x16x32_bf16 v[116:119], a[224:227], a[136:139], v[116:119]
    ds_read_b64_tr_b16 a[246:247], v9 offset:19456
    v_mfma_f32_16x16x32_bf16 v[108:111], a[224:227], a[132:135], v[108:111]
    v_mfma_f32_16x16x32_bf16 v[108:111], a[228:231], a[148:151], v[108:111]
    s_waitcnt lgkmcnt(4)
    v_mfma_f32_16x16x32_bf16 v[100:103], a[228:231], a[144:147], v[100:103]
    v_mfma_f32_16x16x32_bf16 v[100:103], a[224:227], a[128:131], v[100:103]
    buffer_load_dwordx4 v2, s[8:11], s36 offen offset:0 lds
    v_mfma_f32_16x16x32_bf16 v[128:131], a[232:235], a[128:131], v[128:131]
    s_add_u32 m0, s49, 25472
    ds_read_b64_tr_b16 a[224:225], v10 offset:1024
    v_mfma_f32_16x16x32_bf16 v[128:131], a[236:239], a[144:147], v[128:131]
    ds_read_b64_tr_b16 a[226:227], v10 offset:7168
    v_mfma_f32_16x16x32_bf16 v[136:139], a[236:239], a[148:151], v[136:139]
    ds_read_b64_tr_b16 a[228:229], v10 offset:13312
    v_mfma_f32_16x16x32_bf16 v[136:139], a[232:235], a[132:135], v[136:139]
    ds_read_b64_tr_b16 a[230:231], v10 offset:19456
    v_mfma_f32_16x16x32_bf16 v[144:147], a[232:235], a[136:139], v[144:147]
    v_mfma_f32_16x16x32_bf16 v[144:147], a[236:239], a[152:155], v[144:147]
    buffer_load_dwordx4 v2, s[8:11], s36 offen offset:128 lds
    v_mfma_f32_16x16x32_bf16 v[152:155], a[236:239], a[156:159], v[152:155]
    buffer_load_dwordx4 v[32:35], v17, s[24:27], s47 offen offset:0 sc1
    v_mfma_f32_16x16x32_bf16 v[152:155], a[232:235], a[140:143], v[152:155]
    s_waitcnt lgkmcnt(3)
    ds_read_b64_tr_b16 a[232:233], v11 offset:1024
    s_add_u32 m0, s49, 26368
    v_mfma_f32_16x16x32_bf16 v[156:159], a[240:243], a[140:143], v[156:159]
    ds_read_b64_tr_b16 a[234:235], v11 offset:7168
    v_mfma_f32_16x16x32_bf16 v[156:159], a[244:247], a[156:159], v[156:159]
    ds_read_b64_tr_b16 a[236:237], v11 offset:13312
    v_mfma_f32_16x16x32_bf16 v[148:151], a[244:247], a[152:155], v[148:151]
    ds_read_b64_tr_b16 a[238:239], v11 offset:19456
    v_mfma_f32_16x16x32_bf16 v[148:151], a[240:243], a[136:139], v[148:151]
    v_mfma_f32_16x16x32_bf16 v[140:143], a[240:243], a[132:135], v[140:143]
    buffer_load_dwordx4 v2, s[8:11], s36 offen offset:256 lds
    v_mfma_f32_16x16x32_bf16 v[140:143], a[244:247], a[148:151], v[140:143]
    s_waitcnt lgkmcnt(4)
    s_add_u32 m0, s49, 27648
    v_mfma_f32_16x16x32_bf16 v[132:135], a[244:247], a[144:147], v[132:135]
    v_mfma_f32_16x16x32_bf16 v[132:135], a[240:243], a[128:131], v[132:135]
    ds_read_b64_tr_b16 a[240:241], v8 offset:2048
    v_mfma_f32_16x16x32_bf16 v[160:163], a[224:227], a[128:131], v[160:163]
    ds_read_b64_tr_b16 a[242:243], v8 offset:8192
    v_mfma_f32_16x16x32_bf16 v[160:163], a[228:231], a[144:147], v[160:163]
    ds_read_b64_tr_b16 a[244:245], v8 offset:14336
    v_mfma_f32_16x16x32_bf16 v[168:171], a[228:231], a[148:151], v[168:171]
    buffer_load_dwordx4 v3, s[8:11], s36 offen offset:0 lds
    v_mfma_f32_16x16x32_bf16 v[168:171], a[224:227], a[132:135], v[168:171]
    s_add_u32 m0, s49, 28544
    ds_read_b64_tr_b16 a[246:247], v8 offset:20480
    v_mfma_f32_16x16x32_bf16 v[176:179], a[224:227], a[136:139], v[176:179]
    buffer_load_dwordx4 v[36:39], v17, s[24:27], s47 offen offset:1024 sc1
    v_mfma_f32_16x16x32_bf16 v[176:179], a[228:231], a[152:155], v[176:179]
    s_waitcnt lgkmcnt(4)
    v_mfma_f32_16x16x32_bf16 v[184:187], a[228:231], a[156:159], v[184:187]
    v_mfma_f32_16x16x32_bf16 v[184:187], a[224:227], a[140:143], v[184:187]
    ds_read_b64_tr_b16 a[224:225], v9 offset:2048
    v_mfma_f32_16x16x32_bf16 v[188:191], a[232:235], a[140:143], v[188:191]
    ds_read_b64_tr_b16 a[226:227], v9 offset:8192
    v_mfma_f32_16x16x32_bf16 v[188:191], a[236:239], a[156:159], v[188:191]
    buffer_load_dwordx4 v3, s[8:11], s36 offen offset:128 lds
    v_mfma_f32_16x16x32_bf16 v[180:183], a[236:239], a[152:155], v[180:183]
    s_add_u32 m0, s49, 29440
    ds_read_b64_tr_b16 a[228:229], v9 offset:14336
    v_mfma_f32_16x16x32_bf16 v[180:183], a[232:235], a[136:139], v[180:183]
    ds_read_b64_tr_b16 a[230:231], v9 offset:20480
    v_mfma_f32_16x16x32_bf16 v[172:175], a[232:235], a[132:135], v[172:175]
    v_mfma_f32_16x16x32_bf16 v[172:175], a[236:239], a[148:151], v[172:175]
    s_waitcnt lgkmcnt(4)
    v_mfma_f32_16x16x32_bf16 v[164:167], a[236:239], a[144:147], v[164:167]
    v_mfma_f32_16x16x32_bf16 v[164:167], a[232:235], a[128:131], v[164:167]
    buffer_load_dwordx4 v3, s[8:11], s36 offen offset:256 lds
    v_mfma_f32_16x16x32_bf16 v[192:195], a[240:243], a[128:131], v[192:195]
    s_add_u32 s36, s36, s37
    ds_read_b64_tr_b16 a[232:233], v10 offset:2048
    s_sub_u32 s55, s36, 7864320
    v_mfma_f32_16x16x32_bf16 v[192:195], a[244:247], a[144:147], v[192:195]
    s_min_u32 s36, s36, s55
    ds_read_b64_tr_b16 a[234:235], v10 offset:8192
    s_add_u32 s46, s45, 36864
    v_mfma_f32_16x16x32_bf16 v[200:203], a[244:247], a[148:151], v[200:203]
    s_sub_u32 s77, s46, 81920
    ds_read_b64_tr_b16 a[236:237], v10 offset:14336
    s_min_u32 s46, s46, s77
    v_mfma_f32_16x16x32_bf16 v[200:203], a[240:243], a[132:135], v[200:203]
    ds_read_b64_tr_b16 a[238:239], v10 offset:20480
    v_mfma_f32_16x16x32_bf16 v[208:211], a[240:243], a[136:139], v[208:211]
    buffer_load_dwordx4 v[40:43], v17, s[24:27], s47 offen offset:2048 sc1
    v_mfma_f32_16x16x32_bf16 v[208:211], a[244:247], a[152:155], v[208:211]
    s_waitcnt lgkmcnt(4)
    v_mfma_f32_16x16x32_bf16 v[216:219], a[244:247], a[156:159], v[216:219]
    buffer_load_dwordx4 a[16:19], v14, s[20:23], s46 offen offset:0 sc1
    v_mfma_f32_16x16x32_bf16 v[216:219], a[240:243], a[140:143], v[216:219]
    ds_read_b64_tr_b16 a[240:241], v11 offset:2048
    ds_read_b64_tr_b16 a[242:243], v11 offset:8192
    ds_read_b64_tr_b16 a[244:245], v11 offset:14336
    v_mfma_f32_16x16x32_bf16 v[220:223], a[224:227], a[140:143], v[220:223]
    ds_read_b64_tr_b16 a[246:247], v11 offset:20480
    v_mfma_f32_16x16x32_bf16 v[220:223], a[228:231], a[156:159], v[220:223]
    v_mfma_f32_16x16x32_bf16 v[212:215], a[228:231], a[152:155], v[212:215]
    v_mfma_f32_16x16x32_bf16 v[212:215], a[224:227], a[136:139], v[212:215]
    v_mfma_f32_16x16x32_bf16 v[204:207], a[224:227], a[132:135], v[204:207]
    buffer_load_dwordx4 a[20:23], v14, s[20:23], s46 offen offset:1024 sc1
    v_mfma_f32_16x16x32_bf16 v[204:207], a[228:231], a[148:151], v[204:207]
    s_waitcnt lgkmcnt(4)
    v_mfma_f32_16x16x32_bf16 v[196:199], a[228:231], a[144:147], v[196:199]
    s_waitcnt lgkmcnt(0)
    s_barrier
    v_mfma_f32_16x16x32_bf16 v[196:199], a[224:227], a[128:131], v[196:199]
    ds_read_b64_tr_b16 a[224:225], v8 offset:24576
    v_mfma_f32_16x16x32_bf16 v[224:227], a[232:235], a[128:131], v[224:227]
    buffer_load_dwordx4 v[44:47], v17, s[24:27], s47 offen offset:3072 sc1
    v_mfma_f32_16x16x32_bf16 v[224:227], a[236:239], a[144:147], v[224:227]
    ds_read_b64_tr_b16 a[226:227], v8 offset:30720
    v_mfma_f32_16x16x32_bf16 v[232:235], a[236:239], a[148:151], v[232:235]
    ds_read_b64_tr_b16 a[228:229], v8 offset:36864
    v_mfma_f32_16x16x32_bf16 v[232:235], a[232:235], a[132:135], v[232:235]
    buffer_load_dwordx4 a[24:27], v15, s[20:23], s46 offen offset:0 sc1
    v_mfma_f32_16x16x32_bf16 v[240:243], a[232:235], a[136:139], v[240:243]
    ds_read_b64_tr_b16 a[230:231], v8 offset:43008
    v_mfma_f32_16x16x32_bf16 v[240:243], a[236:239], a[152:155], v[240:243]
    v_mfma_f32_16x16x32_bf16 v[248:251], a[236:239], a[156:159], v[248:251]
    v_mfma_f32_16x16x32_bf16 v[248:251], a[232:235], a[140:143], v[248:251]
    ds_read_b64_tr_b16 a[232:233], v9 offset:24576
    v_mfma_f32_16x16x32_bf16 v[252:255], a[240:243], a[140:143], v[252:255]
    ds_read_b64_tr_b16 a[234:235], v9 offset:30720
    v_mfma_f32_16x16x32_bf16 v[252:255], a[244:247], a[156:159], v[252:255]
    buffer_load_dwordx4 a[28:31], v15, s[20:23], s46 offen offset:1024 sc1
    v_mfma_f32_16x16x32_bf16 v[244:247], a[244:247], a[152:155], v[244:247]
    s_add_u32 s46, s45, 40960
    ds_read_b64_tr_b16 a[236:237], v9 offset:36864
    s_sub_u32 s77, s46, 81920
    v_mfma_f32_16x16x32_bf16 v[244:247], a[240:243], a[136:139], v[244:247]
    s_min_u32 s46, s46, s77
    ds_read_b64_tr_b16 a[238:239], v9 offset:43008
    v_mfma_f32_16x16x32_bf16 v[236:239], a[240:243], a[132:135], v[236:239]
    v_mfma_f32_16x16x32_bf16 v[236:239], a[244:247], a[148:151], v[236:239]
    s_waitcnt vmcnt(33) lgkmcnt(4)
    v_mfma_f32_16x16x32_bf16 v[228:231], a[244:247], a[144:147], v[228:231]
    s_waitcnt vmcnt(23)
    v_mfma_f32_16x16x32_bf16 v[228:231], a[240:243], a[128:131], v[228:231]
    s_waitcnt vmcnt(22)
    ds_read_b64_tr_b16 a[240:241], v10 offset:24576
    v_mfma_f32_16x16x32_bf16 v[64:67], a[224:227], a[192:195], v[64:67]
    buffer_load_dwordx4 a[32:35], v14, s[20:23], s46 offen offset:0 sc1
    v_mfma_f32_16x16x32_bf16 v[64:67], a[228:231], a[208:211], v[64:67]
    ds_read_b64_tr_b16 a[242:243], v10 offset:30720
    v_mfma_f32_16x16x32_bf16 v[72:75], a[228:231], a[212:215], v[72:75]
    s_waitcnt vmcnt(21)
    ds_read_b64_tr_b16 a[244:245], v10 offset:36864
    v_mfma_f32_16x16x32_bf16 v[72:75], a[224:227], a[196:199], v[72:75]
    s_waitcnt vmcnt(20)
    ds_read_b64_tr_b16 a[246:247], v10 offset:43008
    v_mfma_f32_16x16x32_bf16 v[80:83], a[224:227], a[200:203], v[80:83]
    v_mfma_f32_16x16x32_bf16 v[80:83], a[228:231], a[216:219], v[80:83]
    s_waitcnt lgkmcnt(4)
    v_mfma_f32_16x16x32_bf16 v[88:91], a[228:231], a[220:223], v[88:91]
    buffer_load_dwordx4 a[36:39], v14, s[20:23], s46 offen offset:1024 sc1
    v_mfma_f32_16x16x32_bf16 v[88:91], a[224:227], a[204:207], v[88:91]
    ds_read_b64_tr_b16 a[224:225], v11 offset:24576
    v_mfma_f32_16x16x32_bf16 v[92:95], a[232:235], a[204:207], v[92:95]
    ds_read_b64_tr_b16 a[226:227], v11 offset:30720
    v_mfma_f32_16x16x32_bf16 v[92:95], a[236:239], a[220:223], v[92:95]
    ds_read_b64_tr_b16 a[228:229], v11 offset:36864
    v_mfma_f32_16x16x32_bf16 v[84:87], a[236:239], a[216:219], v[84:87]
    ds_read_b64_tr_b16 a[230:231], v11 offset:43008
    v_mfma_f32_16x16x32_bf16 v[84:87], a[232:235], a[200:203], v[84:87]
    v_mfma_f32_16x16x32_bf16 v[76:79], a[232:235], a[196:199], v[76:79]
    v_mfma_f32_16x16x32_bf16 v[76:79], a[236:239], a[212:215], v[76:79]
    buffer_load_dwordx4 a[40:43], v15, s[20:23], s46 offen offset:0 sc1
    v_mfma_f32_16x16x32_bf16 v[68:71], a[236:239], a[208:211], v[68:71]
    s_waitcnt lgkmcnt(3)
    v_mfma_f32_16x16x32_bf16 v[68:71], a[232:235], a[192:195], v[68:71]
    ds_read_b64_tr_b16 a[232:233], v8 offset:25600
    v_mfma_f32_16x16x32_bf16 v[96:99], a[240:243], a[192:195], v[96:99]
    ds_read_b64_tr_b16 a[234:235], v8 offset:31744
    v_mfma_f32_16x16x32_bf16 v[96:99], a[244:247], a[208:211], v[96:99]
    ds_read_b64_tr_b16 a[236:237], v8 offset:37888
    v_mfma_f32_16x16x32_bf16 v[104:107], a[244:247], a[212:215], v[104:107]
    ds_read_b64_tr_b16 a[238:239], v8 offset:44032
    v_mfma_f32_16x16x32_bf16 v[104:107], a[240:243], a[196:199], v[104:107]
    buffer_load_dwordx4 a[44:47], v15, s[20:23], s46 offen offset:1024 sc1
    v_mfma_f32_16x16x32_bf16 v[112:115], a[240:243], a[200:203], v[112:115]
    s_add_u32 m0, s49, 49152
    v_mfma_f32_16x16x32_bf16 v[112:115], a[244:247], a[216:219], v[112:115]
    s_waitcnt lgkmcnt(4)
    v_mfma_f32_16x16x32_bf16 v[120:123], a[244:247], a[220:223], v[120:123]
    v_mfma_f32_16x16x32_bf16 v[120:123], a[240:243], a[204:207], v[120:123]
    ds_read_b64_tr_b16 a[240:241], v9 offset:25600
    v_mfma_f32_16x16x32_bf16 v[124:127], a[224:227], a[204:207], v[124:127]
    ds_read_b64_tr_b16 a[242:243], v9 offset:31744
    v_mfma_f32_16x16x32_bf16 v[124:127], a[228:231], a[220:223], v[124:127]
    ds_read_b64_tr_b16 a[244:245], v9 offset:37888
    v_mfma_f32_16x16x32_bf16 v[116:119], a[228:231], a[216:219], v[116:119]
    buffer_load_dwordx4 v2, s[8:11], s36 offen offset:0 lds
    v_mfma_f32_16x16x32_bf16 v[116:119], a[224:227], a[200:203], v[116:119]
    s_add_u32 m0, s49, 50048
    ds_read_b64_tr_b16 a[246:247], v9 offset:44032
    v_mfma_f32_16x16x32_bf16 v[108:111], a[224:227], a[196:199], v[108:111]
    v_mfma_f32_16x16x32_bf16 v[108:111], a[228:231], a[212:215], v[108:111]
    s_waitcnt lgkmcnt(4)
    v_mfma_f32_16x16x32_bf16 v[100:103], a[228:231], a[208:211], v[100:103]
    v_mfma_f32_16x16x32_bf16 v[100:103], a[224:227], a[192:195], v[100:103]
    ds_read_b64_tr_b16 a[224:225], v10 offset:25600
    v_mfma_f32_16x16x32_bf16 v[128:131], a[232:235], a[192:195], v[128:131]
    buffer_load_dwordx4 v2, s[8:11], s36 offen offset:128 lds
    v_mfma_f32_16x16x32_bf16 v[128:131], a[236:239], a[208:211], v[128:131]
    s_add_u32 m0, s49, 50944
    ds_read_b64_tr_b16 a[226:227], v10 offset:31744
    v_mfma_f32_16x16x32_bf16 v[136:139], a[236:239], a[212:215], v[136:139]
    ds_read_b64_tr_b16 a[228:229], v10 offset:37888
    v_mfma_f32_16x16x32_bf16 v[136:139], a[232:235], a[196:199], v[136:139]
    ds_read_b64_tr_b16 a[230:231], v10 offset:44032
    v_mfma_f32_16x16x32_bf16 v[144:147], a[232:235], a[200:203], v[144:147]
    v_mfma_f32_16x16x32_bf16 v[144:147], a[236:239], a[216:219], v[144:147]
    s_waitcnt lgkmcnt(4)
    v_mfma_f32_16x16x32_bf16 v[152:155], a[236:239], a[220:223], v[152:155]
    v_mfma_f32_16x16x32_bf16 v[152:155], a[232:235], a[204:207], v[152:155]
    buffer_load_dwordx4 v2, s[8:11], s36 offen offset:256 lds
    v_mfma_f32_16x16x32_bf16 v[156:159], a[240:243], a[204:207], v[156:159]
    s_add_u32 m0, s49, 52224
    ds_read_b64_tr_b16 a[232:233], v11 offset:25600
    v_mfma_f32_16x16x32_bf16 v[156:159], a[244:247], a[220:223], v[156:159]
    ds_read_b64_tr_b16 a[234:235], v11 offset:31744
    v_mfma_f32_16x16x32_bf16 v[148:151], a[244:247], a[216:219], v[148:151]
    ds_read_b64_tr_b16 a[236:237], v11 offset:37888
    v_mfma_f32_16x16x32_bf16 v[148:151], a[240:243], a[200:203], v[148:151]
    ds_read_b64_tr_b16 a[238:239], v11 offset:44032
    v_mfma_f32_16x16x32_bf16 v[140:143], a[240:243], a[196:199], v[140:143]
    v_mfma_f32_16x16x32_bf16 v[140:143], a[244:247], a[212:215], v[140:143]
    buffer_load_dwordx4 v3, s[8:11], s36 offen offset:0 lds
    v_mfma_f32_16x16x32_bf16 v[132:135], a[244:247], a[208:211], v[132:135]
    s_waitcnt lgkmcnt(4)
    s_add_u32 m0, s49, 53120
    v_mfma_f32_16x16x32_bf16 v[132:135], a[240:243], a[192:195], v[132:135]
    ds_read_b64_tr_b16 a[240:241], v8 offset:26624
    v_mfma_f32_16x16x32_bf16 v[160:163], a[224:227], a[192:195], v[160:163]
    ds_read_b64_tr_b16 a[242:243], v8 offset:32768
    v_mfma_f32_16x16x32_bf16 v[160:163], a[228:231], a[208:211], v[160:163]
    ds_read_b64_tr_b16 a[244:245], v8 offset:38912
    v_mfma_f32_16x16x32_bf16 v[168:171], a[228:231], a[212:215], v[168:171]
    ds_read_b64_tr_b16 a[246:247], v8 offset:45056
    v_mfma_f32_16x16x32_bf16 v[168:171], a[224:227], a[196:199], v[168:171]
    v_subrev_u32 v8, 98304, v8
    v_mfma_f32_16x16x32_bf16 v[176:179], a[224:227], a[200:203], v[176:179]
    buffer_load_dwordx4 v3, s[8:11], s36 offen offset:128 lds
    v_mfma_f32_16x16x32_bf16 v[176:179], a[228:231], a[216:219], v[176:179]
    s_waitcnt lgkmcnt(4)
    s_add_u32 m0, s49, 54016
    v_mfma_f32_16x16x32_bf16 v[184:187], a[228:231], a[220:223], v[184:187]
    v_mfma_f32_16x16x32_bf16 v[184:187], a[224:227], a[204:207], v[184:187]
    ds_read_b64_tr_b16 a[224:225], v9 offset:26624
    v_mfma_f32_16x16x32_bf16 v[188:191], a[232:235], a[204:207], v[188:191]
    ds_read_b64_tr_b16 a[226:227], v9 offset:32768
    v_mfma_f32_16x16x32_bf16 v[188:191], a[236:239], a[220:223], v[188:191]
    ds_read_b64_tr_b16 a[228:229], v9 offset:38912
    v_mfma_f32_16x16x32_bf16 v[180:183], a[236:239], a[216:219], v[180:183]
    buffer_load_dwordx4 v3, s[8:11], s36 offen offset:256 lds
    v_mfma_f32_16x16x32_bf16 v[180:183], a[232:235], a[200:203], v[180:183]
    s_add_u32 s36, s36, s37
    ds_read_b64_tr_b16 a[230:231], v9 offset:45056
    s_sub_u32 s55, s36, 7864320
    v_mfma_f32_16x16x32_bf16 v[172:175], a[232:235], a[196:199], v[172:175]
    s_min_u32 s36, s36, s55
    v_subrev_u32 v9, 98304, v9
    s_add_u32 s46, s45, 45056
    v_mfma_f32_16x16x32_bf16 v[172:175], a[236:239], a[212:215], v[172:175]
    s_waitcnt lgkmcnt(4)
    s_sub_u32 s77, s46, 81920
    s_min_u32 s46, s46, s77
    v_mfma_f32_16x16x32_bf16 v[164:167], a[236:239], a[208:211], v[164:167]
    s_waitcnt vmcnt(21)
    v_xor_b32 v34, s7, v34
    v_mfma_f32_16x16x32_bf16 v[164:167], a[232:235], a[192:195], v[164:167]
    s_waitcnt vmcnt(18)
    ds_read_b64_tr_b16 a[232:233], v10 offset:26624
    v_xor_b32 v38, s7, v38
    v_mfma_f32_16x16x32_bf16 v[192:195], a[240:243], a[192:195], v[192:195]
    s_waitcnt vmcnt(15)
    ds_read_b64_tr_b16 a[234:235], v10 offset:32768
    v_xor_b32 v42, s7, v42
    v_mfma_f32_16x16x32_bf16 v[192:195], a[244:247], a[208:211], v[192:195]
    buffer_load_dwordx4 a[48:51], v14, s[20:23], s46 offen offset:0 sc1
    v_mfma_f32_16x16x32_bf16 v[200:203], a[244:247], a[212:215], v[200:203]
    s_waitcnt vmcnt(13)
    ds_read_b64_tr_b16 a[236:237], v10 offset:38912
    v_xor_b32 v46, s7, v46
    v_mfma_f32_16x16x32_bf16 v[200:203], a[240:243], a[196:199], v[200:203]
    s_lshl_b32 s56, s3, 3
    ds_read_b64_tr_b16 a[238:239], v10 offset:45056
    v_or3_b32 v34, v34, v38, v42
    v_mfma_f32_16x16x32_bf16 v[208:211], a[240:243], a[200:203], v[208:211]
    s_add_u32 s56, s56, 147456
    v_or_b32 v34, v34, v46
    v_cmp_ne_u32 vcc, 0, v34
    v_mfma_f32_16x16x32_bf16 v[208:211], a[244:247], a[216:219], v[208:211]
    s_waitcnt lgkmcnt(4)
    v_subrev_u32 v10, 98304, v10
    v_mfma_f32_16x16x32_bf16 v[216:219], a[244:247], a[220:223], v[216:219]
    s_cbranch_vccnz spin_rec
spin_rec_ret:
    v_max_u32 v20, v32, v33
    v_mfma_f32_16x16x32_bf16 v[216:219], a[240:243], a[204:207], v[216:219]
    ds_read_b64_tr_b16 a[240:241], v11 offset:26624
    v_min_u32 v21, v32, v33
    ds_read_b64_tr_b16 a[242:243], v11 offset:32768
    v_mfma_f32_16x16x32_bf16 v[220:223], a[224:227], a[204:207], v[220:223]
    ds_read_b64_tr_b16 a[244:245], v11 offset:38912
    v_med3_u32 v21, v20, v21, v36
    ds_read_b64_tr_b16 a[246:247], v11 offset:45056
    v_mfma_f32_16x16x32_bf16 v[220:223], a[228:231], a[220:223], v[220:223]
    buffer_load_dwordx4 a[52:55], v14, s[20:23], s46 offen offset:1024 sc1
    v_mfma_f32_16x16x32_bf16 v[212:215], a[228:231], a[216:219], v[212:215]
    v_max_u32 v20, v20, v36
    v_med3_u32 v21, v20, v21, v37
    v_mfma_f32_16x16x32_bf16 v[212:215], a[224:227], a[200:203], v[212:215]
    v_max_u32 v20, v20, v37
    v_med3_u32 v21, v20, v21, v40
    v_mfma_f32_16x16x32_bf16 v[204:207], a[224:227], a[196:199], v[204:207]
    v_max_u32 v20, v20, v40
    v_med3_u32 v21, v20, v21, v41
    v_mfma_f32_16x16x32_bf16 v[204:207], a[228:231], a[212:215], v[204:207]
    s_waitcnt lgkmcnt(4)
    v_max_u32 v20, v20, v41
    v_med3_u32 v21, v20, v21, v44
    v_mfma_f32_16x16x32_bf16 v[196:199], a[228:231], a[208:211], v[196:199]
    s_waitcnt lgkmcnt(0)
    s_barrier
    v_mfma_f32_16x16x32_bf16 v[196:199], a[224:227], a[192:195], v[196:199]
    buffer_load_dwordx4 a[56:59], v15, s[20:23], s46 offen offset:0 sc1
    v_mfma_f32_16x16x32_bf16 v[224:227], a[232:235], a[192:195], v[224:227]
    ds_read_b64_tr_b16 a[224:225], v8 offset:0
    v_max_u32 v20, v20, v44
    v_mfma_f32_16x16x32_bf16 v[224:227], a[236:239], a[208:211], v[224:227]
    ds_read_b64_tr_b16 a[226:227], v8 offset:6144
    v_med3_u32 v21, v20, v21, v45
    v_mfma_f32_16x16x32_bf16 v[232:235], a[236:239], a[212:215], v[232:235]
    ds_read_b64_tr_b16 a[228:229], v8 offset:12288
    v_max_u32 v20, v20, v45
    v_mfma_f32_16x16x32_bf16 v[232:235], a[232:235], a[196:199], v[232:235]
    ds_read_b64_tr_b16 a[230:231], v8 offset:18432
    v_mov_b32_dpp v22, v20 row_ror:8 row_mask:0xf bank_mask:0xf
    v_mfma_f32_16x16x32_bf16 v[240:243], a[232:235], a[200:203], v[240:243]
    buffer_load_dwordx4 a[60:63], v15, s[20:23], s46 offen offset:1024 sc1
    v_mfma_f32_16x16x32_bf16 v[240:243], a[236:239], a[216:219], v[240:243]
    s_add_u32 s46, s45, 49152
    v_mov_b32_dpp v23, v21 row_ror:8 row_mask:0xf bank_mask:0xf
    v_min_u32 v24, v20, v22
    v_mfma_f32_16x16x32_bf16 v[248:251], a[236:239], a[220:223], v[248:251]
    s_sub_u32 s77, s46, 81920
    v_max_u32 v20, v20, v22
    v_max3_u32 v21, v24, v21, v23
    v_mfma_f32_16x16x32_bf16 v[248:251], a[232:235], a[204:207], v[248:251]
    s_min_u32 s46, s46, s77
    ds_read_b64_tr_b16 a[232:233], v9 offset:0
    v_mov_b32_dpp v22, v20 row_ror:4 row_mask:0xf bank_mask:0xf
    v_mfma_f32_16x16x32_bf16 v[252:255], a[240:243], a[204:207], v[252:255]
    ds_read_b64_tr_b16 a[234:235], v9 offset:6144
    v_mov_b32_dpp v23, v21 row_ror:4 row_mask:0xf bank_mask:0xf
    v_mfma_f32_16x16x32_bf16 v[252:255], a[244:247], a[220:223], v[252:255]
    ds_read_b64_tr_b16 a[236:237], v9 offset:12288
    v_min_u32 v24, v20, v22
    v_mfma_f32_16x16x32_bf16 v[244:247], a[244:247], a[216:219], v[244:247]
    ds_read_b64_tr_b16 a[238:239], v9 offset:18432
    v_max_u32 v20, v20, v22
    v_mfma_f32_16x16x32_bf16 v[244:247], a[240:243], a[200:203], v[244:247]
    buffer_load_dwordx4 a[64:67], v14, s[20:23], s46 offen offset:0 sc1
    v_mfma_f32_16x16x32_bf16 v[236:239], a[240:243], a[196:199], v[236:239]
    v_max3_u32 v21, v24, v21, v23
    v_mov_b32_dpp v22, v20 row_ror:2 row_mask:0xf bank_mask:0xf
    v_mfma_f32_16x16x32_bf16 v[236:239], a[244:247], a[212:215], v[236:239]
    s_waitcnt lgkmcnt(4)
    v_mov_b32_dpp v23, v21 row_ror:2 row_mask:0xf bank_mask:0xf
    v_min_u32 v24, v20, v22
    v_mfma_f32_16x16x32_bf16 v[228:231], a[244:247], a[208:211], v[228:231]
    v_max_u32 v20, v20, v22
    v_max3_u32 v21, v24, v21, v23
    v_mfma_f32_16x16x32_bf16 v[228:231], a[240:243], a[192:195], v[228:231]
    ds_read_b64_tr_b16 a[240:241], v10 offset:0
    v_mov_b32_dpp v22, v20 row_ror:1 row_mask:0xf bank_mask:0xf
    v_mfma_f32_16x16x32_bf16 v[64:67], a[224:227], a[0:3], v[64:67]
    ds_read_b64_tr_b16 a[242:243], v10 offset:6144
    v_mov_b32_dpp v23, v21 row_ror:1 row_mask:0xf bank_mask:0xf
    v_mfma_f32_16x16x32_bf16 v[64:67], a[228:231], a[16:19], v[64:67]
    buffer_load_dwordx4 a[68:71], v14, s[20:23], s46 offen offset:1024 sc1
    v_mfma_f32_16x16x32_bf16 v[72:75], a[228:231], a[20:23], v[72:75]
    s_waitcnt vmcnt(17)
    ds_read_b64_tr_b16 a[244:245], v10 offset:12288
    v_min_u32 v24, v20, v22
    v_mfma_f32_16x16x32_bf16 v[72:75], a[224:227], a[4:7], v[72:75]
    s_waitcnt vmcnt(16)
    ds_read_b64_tr_b16 a[246:247], v10 offset:18432
    v_max_u32 v20, v20, v22
    v_mfma_f32_16x16x32_bf16 v[80:83], a[224:227], a[8:11], v[80:83]
    v_max3_u32 v21, v24, v21, v23
    v_mov_b32 v22, v20
    v_mfma_f32_16x16x32_bf16 v[80:83], a[228:231], a[24:27], v[80:83]
    s_waitcnt lgkmcnt(4)
    v_permlane16_swap_b32 v20, v22
    v_mfma_f32_16x16x32_bf16 v[88:91], a[228:231], a[28:31], v[88:91]
    v_mov_b32 v23, v21
    v_min_u32 v24, v20, v22
    v_mfma_f32_16x16x32_bf16 v[88:91], a[224:227], a[12:15], v[88:91]
    v_permlane16_swap_b32 v21, v23
    v_mfma_f32_16x16x32_bf16 v[92:95], a[232:235], a[12:15], v[92:95]
    buffer_load_dwordx4 a[72:75], v15, s[20:23], s46 offen offset:0 sc1
    v_mfma_f32_16x16x32_bf16 v[92:95], a[236:239], a[28:31], v[92:95]
    v_max_u32 v20, v20, v22
    v_max3_u32 v21, v24, v21, v23
    v_mfma_f32_16x16x32_bf16 v[84:87], a[236:239], a[24:27], v[84:87]
    v_mov_b32 v22, v20
    v_mov_b32 v23, v21
    v_mfma_f32_16x16x32_bf16 v[84:87], a[232:235], a[8:11], v[84:87]
    v_permlane32_swap_b32 v20, v22
    v_mfma_f32_16x16x32_bf16 v[76:79], a[232:235], a[4:7], v[76:79]
    v_permlane32_swap_b32 v21, v23
    v_mfma_f32_16x16x32_bf16 v[76:79], a[236:239], a[20:23], v[76:79]
    s_waitcnt lgkmcnt(0)
    v_min_u32 v24, v20, v22
    v_max_u32 v20, v20, v22
    v_mfma_f32_16x16x32_bf16 v[68:71], a[236:239], a[16:19], v[68:71]
    buffer_load_dwordx4 a[76:79], v15, s[20:23], s46 offen offset:1024 sc1
    v_subrev_u32 v11, 98304, v11
    v_mfma_f32_16x16x32_bf16 v[68:71], a[232:235], a[0:3], v[68:71]
    s_add_u32 m0, s49, 73728
    ds_read_b64_tr_b16 a[224:225], v11 offset:0
    v_max3_u32 v21, v24, v21, v23
    v_mfma_f32_16x16x32_bf16 v[96:99], a[240:243], a[0:3], v[96:99]
    ds_read_b64_tr_b16 a[226:227], v11 offset:6144
    v_mov_b32 v22, s56
    v_mfma_f32_16x16x32_bf16 v[96:99], a[244:247], a[16:19], v[96:99]
    ds_write_b64 v22, v[20:21]
    ds_read_b64_tr_b16 a[228:229], v11 offset:12288
    v_mfma_f32_16x16x32_bf16 v[104:107], a[244:247], a[20:23], v[104:107]
    ds_read_b64_tr_b16 a[230:231], v11 offset:18432
    v_mov_b32 v23, 147456
    v_mfma_f32_16x16x32_bf16 v[104:107], a[240:243], a[4:7], v[104:107]
    ds_read_b64_tr_b16 a[232:233], v8 offset:1024
    v_mfma_f32_16x16x32_bf16 v[112:115], a[240:243], a[8:11], v[112:115]
    ds_read_b64_tr_b16 a[234:235], v8 offset:7168
    v_mfma_f32_16x16x32_bf16 v[112:115], a[244:247], a[24:27], v[112:115]
    buffer_load_dwordx4 v2, s[8:11], s36 offen offset:0 lds
    v_mfma_f32_16x16x32_bf16 v[120:123], a[244:247], a[28:31], v[120:123]
    s_add_u32 m0, s49, 74624
    ds_read_b64_tr_b16 a[236:237], v8 offset:13312
    v_mfma_f32_16x16x32_bf16 v[120:123], a[240:243], a[12:15], v[120:123]
    s_waitcnt lgkmcnt(6)
    ds_read_b64_tr_b16 a[238:239], v8 offset:19456
    v_mfma_f32_16x16x32_bf16 v[124:127], a[224:227], a[12:15], v[124:127]
    s_waitcnt lgkmcnt(4)
    ds_read_b64_tr_b16 a[240:241], v9 offset:1024
    v_mfma_f32_16x16x32_bf16 v[124:127], a[228:231], a[28:31], v[124:127]
    ds_read_b64_tr_b16 a[242:243], v9 offset:7168
    v_mfma_f32_16x16x32_bf16 v[116:119], a[228:231], a[24:27], v[116:119]
    ds_read_b64_tr_b16 a[244:245], v9 offset:13312
    v_mfma_f32_16x16x32_bf16 v[116:119], a[224:227], a[8:11], v[116:119]
    buffer_load_dwordx4 v2, s[8:11], s36 offen offset:128 lds
    v_mfma_f32_16x16x32_bf16 v[108:111], a[224:227], a[4:7], v[108:111]
    s_add_u32 m0, s49, 75520
    ds_read_b64_tr_b16 a[246:247], v9 offset:19456
    v_mfma_f32_16x16x32_bf16 v[108:111], a[228:231], a[20:23], v[108:111]
    s_waitcnt lgkmcnt(5)
    v_mfma_f32_16x16x32_bf16 v[100:103], a[228:231], a[16:19], v[100:103]
    s_waitcnt lgkmcnt(4)
    v_mfma_f32_16x16x32_bf16 v[100:103], a[224:227], a[0:3], v[100:103]
    ds_read_b64_tr_b16 a[224:225], v10 offset:1024
    v_mfma_f32_16x16x32_bf16 v[128:131], a[232:235], a[0:3], v[128:131]
    ds_read_b64_tr_b16 a[226:227], v10 offset:7168
    v_mfma_f32_16x16x32_bf16 v[128:131], a[236:239], a[16:19], v[128:131]
    ds_read_b64_tr_b16 a[228:229], v10 offset:13312
    v_mfma_f32_16x16x32_bf16 v[136:139], a[236:239], a[20:23], v[136:139]
    buffer_load_dwordx4 v2, s[8:11], s36 offen offset:256 lds
    v_mfma_f32_16x16x32_bf16 v[136:139], a[232:235], a[4:7], v[136:139]
    s_add_u32 m0, s49, 76800
    ds_read_b64_tr_b16 a[230:231], v10 offset:19456
    v_mfma_f32_16x16x32_bf16 v[144:147], a[232:235], a[8:11], v[144:147]
    v_mfma_f32_16x16x32_bf16 v[144:147], a[236:239], a[24:27], v[144:147]
    s_waitcnt lgkmcnt(4)
    v_mfma_f32_16x16x32_bf16 v[152:155], a[236:239], a[28:31], v[152:155]
    v_mfma_f32_16x16x32_bf16 v[152:155], a[232:235], a[12:15], v[152:155]
    ds_read_b64_tr_b16 a[232:233], v11 offset:1024
    v_mfma_f32_16x16x32_bf16 v[156:159], a[240:243], a[12:15], v[156:159]
    buffer_load_dwordx4 v3, s[8:11], s36 offen offset:0 lds
    v_mfma_f32_16x16x32_bf16 v[156:159], a[244:247], a[28:31], v[156:159]
    s_add_u32 m0, s49, 77696
    ds_read_b64_tr_b16 a[234:235], v11 offset:7168
    v_mfma_f32_16x16x32_bf16 v[148:151], a[244:247], a[24:27], v[148:151]
    ds_read_b64_tr_b16 a[236:237], v11 offset:13312
    v_mfma_f32_16x16x32_bf16 v[148:151], a[240:243], a[8:11], v[148:151]
pg_2:
    s_cbranch_execz pg_6
    ds_read_b64_tr_b16 a[238:239], v11 offset:19456
    v_mfma_f32_16x16x32_bf16 v[140:143], a[240:243], a[4:7], v[140:143]
    v_mfma_f32_16x16x32_bf16 v[140:143], a[244:247], a[20:23], v[140:143]
    s_waitcnt lgkmcnt(4)
    v_mfma_f32_16x16x32_bf16 v[132:135], a[244:247], a[16:19], v[132:135]
    v_mfma_f32_16x16x32_bf16 v[132:135], a[240:243], a[0:3], v[132:135]
    buffer_load_dwordx4 v3, s[8:11], s36 offen offset:128 lds
    v_mfma_f32_16x16x32_bf16 v[160:163], a[224:227], a[0:3], v[160:163]
    s_add_u32 m0, s49, 78592
    ds_read_b64_tr_b16 a[240:241], v8 offset:2048
    v_mfma_f32_16x16x32_bf16 v[160:163], a[228:231], a[16:19], v[160:163]
    ds_read_b64_tr_b16 a[242:243], v8 offset:8192
    v_mfma_f32_16x16x32_bf16 v[168:171], a[228:231], a[20:23], v[168:171]
    ds_read_b64_tr_b16 a[244:245], v8 offset:14336
    v_mfma_f32_16x16x32_bf16 v[168:171], a[224:227], a[4:7], v[168:171]
    ds_read_b64_tr_b16 a[246:247], v8 offset:20480
    v_mfma_f32_16x16x32_bf16 v[176:179], a[224:227], a[8:11], v[176:179]
    v_mfma_f32_16x16x32_bf16 v[176:179], a[228:231], a[24:27], v[176:179]
    buffer_load_dwordx4 v3, s[8:11], s36 offen offset:256 lds
    v_mfma_f32_16x16x32_bf16 v[184:187], a[228:231], a[28:31], v[184:187]
    s_waitcnt lgkmcnt(4)
    s_add_u32 s36, s36, s37
    s_sub_u32 s55, s36, 7864320
    v_mfma_f32_16x16x32_bf16 v[184:187], a[224:227], a[12:15], v[184:187]
    s_min_u32 s36, s36, s55
    ds_read_b64_tr_b16 a[224:225], v9 offset:2048
    s_add_u32 s46, s45, 53248
    v_mfma_f32_16x16x32_bf16 v[188:191], a[232:235], a[12:15], v[188:191]
    s_sub_u32 s77, s46, 81920
    ds_read_b64_tr_b16 a[226:227], v9 offset:8192
    s_min_u32 s46, s46, s77
    v_mfma_f32_16x16x32_bf16 v[188:191], a[236:239], a[28:31], v[188:191]
    ds_read_b64_tr_b16 a[228:229], v9 offset:14336
    v_mfma_f32_16x16x32_bf16 v[180:183], a[236:239], a[24:27], v[180:183]
    ds_read_b64_tr_b16 a[230:231], v9 offset:20480
    v_mfma_f32_16x16x32_bf16 v[180:183], a[232:235], a[8:11], v[180:183]
    v_mfma_f32_16x16x32_bf16 v[172:175], a[232:235], a[4:7], v[172:175]
    buffer_load_dwordx4 a[80:83], v14, s[20:23], s46 offen offset:0 sc1
    v_mfma_f32_16x16x32_bf16 v[172:175], a[236:239], a[20:23], v[172:175]
    s_waitcnt lgkmcnt(4)
    v_mfma_f32_16x16x32_bf16 v[164:167], a[236:239], a[16:19], v[164:167]
    v_mfma_f32_16x16x32_bf16 v[164:167], a[232:235], a[0:3], v[164:167]
    ds_read_b64_tr_b16 a[232:233], v10 offset:2048
    v_mfma_f32_16x16x32_bf16 v[192:195], a[240:243], a[0:3], v[192:195]
    ds_read_b64_tr_b16 a[234:235], v10 offset:8192
    v_mfma_f32_16x16x32_bf16 v[192:195], a[244:247], a[16:19], v[192:195]
    ds_read_b64_tr_b16 a[236:237], v10 offset:14336
    v_mfma_f32_16x16x32_bf16 v[200:203], a[244:247], a[20:23], v[200:203]
    buffer_load_dwordx4 a[84:87], v14, s[20:23], s46 offen offset:1024 sc1
    v_mfma_f32_16x16x32_bf16 v[200:203], a[240:243], a[4:7], v[200:203]
    ds_read_b64_tr_b16 a[238:239], v10 offset:20480
    v_mfma_f32_16x16x32_bf16 v[208:211], a[240:243], a[8:11], v[208:211]
    v_mfma_f32_16x16x32_bf16 v[208:211], a[244:247], a[24:27], v[208:211]
    s_waitcnt lgkmcnt(4)
    v_mfma_f32_16x16x32_bf16 v[216:219], a[244:247], a[28:31], v[216:219]
    v_mfma_f32_16x16x32_bf16 v[216:219], a[240:243], a[12:15], v[216:219]
    ds_read_b64_tr_b16 a[240:241], v11 offset:2048
    ds_read_b64_tr_b16 a[242:243], v11 offset:8192
    ds_read_b64_tr_b16 a[244:245], v11 offset:14336
    v_mfma_f32_16x16x32_bf16 v[220:223], a[224:227], a[12:15], v[220:223]
    ds_read_b64_tr_b16 a[246:247], v11 offset:20480
    v_mfma_f32_16x16x32_bf16 v[220:223], a[228:231], a[28:31], v[220:223]
    buffer_load_dwordx4 a[88:91], v15, s[20:23], s46 offen offset:0 sc1
    v_mfma_f32_16x16x32_bf16 v[212:215], a[228:231], a[24:27], v[212:215]
    v_mfma_f32_16x16x32_bf16 v[212:215], a[224:227], a[8:11], v[212:215]
    v_mfma_f32_16x16x32_bf16 v[204:207], a[224:227], a[4:7], v[204:207]
    v_mfma_f32_16x16x32_bf16 v[204:207], a[228:231], a[20:23], v[204:207]
    s_waitcnt lgkmcnt(4)
    v_mfma_f32_16x16x32_bf16 v[196:199], a[228:231], a[16:19], v[196:199]
    s_waitcnt lgkmcnt(0)
    s_barrier
    v_mfma_f32_16x16x32_bf16 v[196:199], a[224:227], a[0:3], v[196:199]
    buffer_load_dwordx4 a[92:95], v15, s[20:23], s46 offen offset:1024 sc1
    v_mfma_f32_16x16x32_bf16 v[224:227], a[232:235], a[0:3], v[224:227]
    s_add_u32 s46, s45, 57344
    ds_read_b128 v[32:35], v23 offset:0
    v_and_b32 v22, 1, v1
    v_mfma_f32_16x16x32_bf16 v[224:227], a[236:239], a[16:19], v[224:227]
    s_sub_u32 s77, s46, 81920
    ds_read_b128 v[36:39], v23 offset:16
    v_cmp_eq_u32 vcc, 1, v22
    v_mfma_f32_16x16x32_bf16 v[232:235], a[236:239], a[20:23], v[232:235]
    s_min_u32 s46, s46, s77
    ds_read_b64_tr_b16 a[224:225], v8 offset:24576
    v_lshrrev_b32 v24, 4, v1
    v_mfma_f32_16x16x32_bf16 v[232:235], a[232:235], a[4:7], v[232:235]
    ds_read_b64_tr_b16 a[226:227], v8 offset:30720
    v_bfe_u32 v26, v1, 2, 3
    v_mfma_f32_16x16x32_bf16 v[240:243], a[232:235], a[8:11], v[240:243]
    ds_read_b64_tr_b16 a[228:229], v8 offset:36864
    v_lshlrev_b32 v25, 7, v26
    v_mfma_f32_16x16x32_bf16 v[240:243], a[236:239], a[24:27], v[240:243]
    ds_read_b64_tr_b16 a[230:231], v8 offset:43008
    v_lshrrev_b32 v26, 1, v26
    v_mfma_f32_16x16x32_bf16 v[248:251], a[236:239], a[28:31], v[248:251]
    buffer_load_dwordx4 a[160:163], v14, s[20:23], s46 offen offset:0 sc1
    v_mfma_f32_16x16x32_bf16 v[248:251], a[232:235], a[12:15], v[248:251]
    s_waitcnt lgkmcnt(5)
    ds_read_b64_tr_b16 a[232:233], v9 offset:24576
    v_max_u32 v20, v32, v33
    v_mfma_f32_16x16x32_bf16 v[252:255], a[240:243], a[12:15], v[252:255]
    ds_read_b64_tr_b16 a[234:235], v9 offset:30720
    v_min_u32 v21, v32, v33
    v_mfma_f32_16x16x32_bf16 v[252:255], a[244:247], a[28:31], v[252:255]
    ds_read_b64_tr_b16 a[236:237], v9 offset:36864
    v_med3_u32 v21, v20, v21, v34
    v_mfma_f32_16x16x32_bf16 v[244:247], a[244:247], a[24:27], v[244:247]
    ds_read_b64_tr_b16 a[238:239], v9 offset:43008
    v_max_u32 v20, v20, v34
    v_mfma_f32_16x16x32_bf16 v[244:247], a[240:243], a[8:11], v[244:247]
    v_med3_u32 v21, v20, v21, v35
    v_max_u32 v20, v20, v35
    v_mfma_f32_16x16x32_bf16 v[236:239], a[240:243], a[4:7], v[236:239]
    buffer_load_dwordx4 a[164:167], v14, s[20:23], s46 offen offset:1024 sc1
    v_mfma_f32_16x16x32_bf16 v[236:239], a[244:247], a[20:23], v[236:239]
    s_waitcnt vmcnt(29) lgkmcnt(4)
    v_med3_u32 v21, v20, v21, v36
    v_max_u32 v20, v20, v36
    v_mfma_f32_16x16x32_bf16 v[228:231], a[244:247], a[16:19], v[228:231]
    s_waitcnt vmcnt(19)
    v_med3_u32 v21, v20, v21, v37
    v_max_u32 v20, v20, v37
    v_mfma_f32_16x16x32_bf16 v[228:231], a[240:243], a[0:3], v[228:231]
    s_waitcnt vmcnt(18)
    ds_read_b64_tr_b16 a[240:241], v10 offset:24576
    v_med3_u32 v21, v20, v21, v38
    v_mfma_f32_16x16x32_bf16 v[64:67], a[224:227], a[32:35], v[64:67]
    ds_read_b64_tr_b16 a[242:243], v10 offset:30720
    v_max_u32 v20, v20, v38
    v_mfma_f32_16x16x32_bf16 v[64:67], a[228:231], a[48:51], v[64:67]
    ds_read_b64_tr_b16 a[244:245], v10 offset:36864
    v_med3_u32 v21, v20, v21, v39
    v_mfma_f32_16x16x32_bf16 v[72:75], a[228:231], a[52:55], v[72:75]
    s_waitcnt vmcnt(17)
    ds_read_b64_tr_b16 a[246:247], v10 offset:43008
    v_max_u32 v20, v20, v39
    v_mfma_f32_16x16x32_bf16 v[72:75], a[224:227], a[36:39], v[72:75]
    buffer_load_dwordx4 a[168:171], v15, s[20:23], s46 offen offset:0 sc1
    v_mfma_f32_16x16x32_bf16 v[80:83], a[224:227], a[40:43], v[80:83]
    s_waitcnt vmcnt(17)
    v_readfirstlane_b32 s70, v20
    v_readfirstlane_b32 s71, v21
    v_mfma_f32_16x16x32_bf16 v[80:83], a[228:231], a[56:59], v[80:83]
    s_waitcnt lgkmcnt(4)
    v_cndmask_b32 v22, v20, v21, vcc
    v_and_b32 v22, 0x7ff, v22
    v_mfma_f32_16x16x32_bf16 v[88:91], a[228:231], a[60:63], v[88:91]
    v_sub_u32 v22, 2047, v22
    v_mul_u32_u24 v23, 1280, v22
    v_mfma_f32_16x16x32_bf16 v[88:91], a[224:227], a[44:47], v[88:91]
    ds_read_b64_tr_b16 a[224:225], v11 offset:24576
    v_lshl_add_u32 v23, v24, 4, v23
    v_mfma_f32_16x16x32_bf16 v[92:95], a[232:235], a[44:47], v[92:95]
    ds_read_b64_tr_b16 a[226:227], v11 offset:30720
    v_add_u32 v23, s61, v23
    v_mfma_f32_16x16x32_bf16 v[92:95], a[236:239], a[60:63], v[92:95]
    buffer_load_dwordx4 a[172:175], v15, s[20:23], s46 offen offset:1024 sc1
    v_mfma_f32_16x16x32_bf16 v[84:87], a[236:239], a[56:59], v[84:87]
    s_add_u32 m0, s49, 98304
    ds_read_b64_tr_b16 a[228:229], v11 offset:36864
    v_lshlrev_b32 v24, 3, v22
    v_mfma_f32_16x16x32_bf16 v[84:87], a[232:235], a[40:43], v[84:87]
    ds_read_b64_tr_b16 a[230:231], v11 offset:43008
    v_add_u32 v24, 3211264, v24
    v_mfma_f32_16x16x32_bf16 v[76:79], a[232:235], a[36:39], v[76:79]
    v_xor_b32 v26, s3, v26
    v_lshl_add_u32 v25, v26, 5, v25
    v_mfma_f32_16x16x32_bf16 v[76:79], a[236:239], a[52:55], v[76:79]
    s_waitcnt lgkmcnt(4)
    v_and_b32 v26, 3, v1
    v_lshl_add_u32 v25, v26, 3, v25
    v_mfma_f32_16x16x32_bf16 v[68:71], a[236:239], a[48:51], v[68:71]
    v_lshrrev_b32 v26, 5, v1
    v_mul_u32_u24 v26, 2048, v26
    v_mfma_f32_16x16x32_bf16 v[68:71], a[232:235], a[32:35], v[68:71]
    ds_read_b64_tr_b16 a[232:233], v8 offset:25600
    v_add_u32 v25, v25, v26
    v_mfma_f32_16x16x32_bf16 v[96:99], a[240:243], a[32:35], v[96:99]
    buffer_load_dwordx4 v2, s[8:11], s36 offen offset:0 lds
    v_mfma_f32_16x16x32_bf16 v[96:99], a[244:247], a[48:51], v[96:99]
    s_add_u32 m0, s49, 99200
    ds_read_b64_tr_b16 a[234:235], v8 offset:31744
    v_add_u32 v25, 147456, v25
    v_mfma_f32_16x16x32_bf16 v[104:107], a[244:247], a[52:55], v[104:107]
    ds_read_b64_tr_b16 a[236:237], v8 offset:37888
    v_lshlrev_b32 v26, 4, v1
    v_mfma_f32_16x16x32_bf16 v[104:107], a[240:243], a[36:39], v[104:107]
    ds_read_b64_tr_b16 a[238:239], v8 offset:44032
    v_cmp_gt_u32 vcc, 16, v1
    v_mfma_f32_16x16x32_bf16 v[112:115], a[240:243], a[40:43], v[112:115]
    v_mov_b32 v27, 0x7ffffff0
    v_cndmask_b32 v26, v27, v26, vcc
    v_mfma_f32_16x16x32_bf16 v[112:115], a[244:247], a[56:59], v[112:115]
    s_waitcnt lgkmcnt(4)
    v_min_u32 v27, 1, v1
    v_mfma_f32_16x16x32_bf16 v[120:123], a[244:247], a[60:63], v[120:123]
    buffer_load_dwordx4 v2, s[8:11], s36 offen offset:128 lds
    v_mfma_f32_16x16x32_bf16 v[120:123], a[240:243], a[44:47], v[120:123]
    s_add_u32 m0, s49, 100096
    ds_read_b64_tr_b16 a[240:241], v9 offset:25600
    v_mfma_f32_16x16x32_bf16 v[124:127], a[224:227], a[44:47], v[124:127]
    ds_read_b64_tr_b16 a[242:243], v9 offset:31744
    v_mfma_f32_16x16x32_bf16 v[124:127], a[228:231], a[60:63], v[124:127]
    ds_read_b64_tr_b16 a[244:245], v9 offset:37888
    v_mfma_f32_16x16x32_bf16 v[116:119], a[228:231], a[56:59], v[116:119]
    ds_read_b64_tr_b16 a[246:247], v9 offset:44032
    v_mfma_f32_16x16x32_bf16 v[116:119], a[224:227], a[40:43], v[116:119]
    v_lshlrev_b32 v27, 30, v27
    v_mfma_f32_16x16x32_bf16 v[108:111], a[224:227], a[36:39], v[108:111]
    v_mfma_f32_16x16x32_bf16 v[108:111], a[228:231], a[52:55], v[108:111]
    buffer_load_dwordx4 v2, s[8:11], s36 offen offset:256 lds
    v_mfma_f32_16x16x32_bf16 v[100:103], a[228:231], a[48:51], v[100:103]
    s_waitcnt lgkmcnt(3)
    s_add_u32 m0, s49, 101376
    v_mfma_f32_16x16x32_bf16 v[100:103], a[224:227], a[32:35], v[100:103]
    ds_read_b64_tr_b16 a[224:225], v10 offset:25600
    v_mfma_f32_16x16x32_bf16 v[128:131], a[232:235], a[32:35], v[128:131]
    ds_read_b64_tr_b16 a[226:227], v10 offset:31744
    v_mfma_f32_16x16x32_bf16 v[128:131], a[236:239], a[48:51], v[128:131]
    ds_read_b64_tr_b16 a[228:229], v10 offset:37888
    v_mfma_f32_16x16x32_bf16 v[136:139], a[236:239], a[52:55], v[136:139]
    ds_read_b64_tr_b16 a[230:231], v10 offset:44032
    v_mfma_f32_16x16x32_bf16 v[136:139], a[232:235], a[36:39], v[136:139]
    buffer_load_dwordx4 v3, s[8:11], s36 offen offset:0 lds
    v_mfma_f32_16x16x32_bf16 v[144:147], a[232:235], a[40:43], v[144:147]
    s_add_u32 m0, s49, 102272
    v_mfma_f32_16x16x32_bf16 v[144:147], a[236:239], a[56:59], v[144:147]
    s_waitcnt lgkmcnt(4)
    v_mfma_f32_16x16x32_bf16 v[152:155], a[236:239], a[60:63], v[152:155]
    v_mfma_f32_16x16x32_bf16 v[152:155], a[232:235], a[44:47], v[152:155]
    ds_read_b64_tr_b16 a[232:233], v11 offset:25600
    v_mfma_f32_16x16x32_bf16 v[156:159], a[240:243], a[44:47], v[156:159]
    ds_read_b64_tr_b16 a[234:235], v11 offset:31744
    v_mfma_f32_16x16x32_bf16 v[156:159], a[244:247], a[60:63], v[156:159]
    ds_read_b64_tr_b16 a[236:237], v11 offset:37888
    v_mfma_f32_16x16x32_bf16 v[148:151], a[244:247], a[56:59], v[148:151]
    buffer_load_dwordx4 v3, s[8:11], s36 offen offset:128 lds
    v_mfma_f32_16x16x32_bf16 v[148:151], a[240:243], a[40:43], v[148:151]
    s_add_u32 m0, s49, 103168
    ds_read_b64_tr_b16 a[238:239], v11 offset:44032
    v_mfma_f32_16x16x32_bf16 v[140:143], a[240:243], a[36:39], v[140:143]
    v_mfma_f32_16x16x32_bf16 v[140:143], a[244:247], a[52:55], v[140:143]
    s_waitcnt lgkmcnt(4)
    v_mfma_f32_16x16x32_bf16 v[132:135], a[244:247], a[48:51], v[132:135]
    v_mfma_f32_16x16x32_bf16 v[132:135], a[240:243], a[32:35], v[132:135]
    ds_read_b64_tr_b16 a[240:241], v8 offset:26624
    v_mfma_f32_16x16x32_bf16 v[160:163], a[224:227], a[32:35], v[160:163]
    buffer_load_dwordx4 v3, s[8:11], s36 offen offset:256 lds
    v_mfma_f32_16x16x32_bf16 v[160:163], a[228:231], a[48:51], v[160:163]
    s_add_u32 s36, s36, s37
    ds_read_b64_tr_b16 a[242:243], v8 offset:32768
    s_sub_u32 s55, s36, 7864320
    v_mfma_f32_16x16x32_bf16 v[168:171], a[228:231], a[52:55], v[168:171]
    global_load_dwordx4 v[48:51], v23, s[64:65]
    v_mfma_f32_16x16x32_bf16 v[168:171], a[224:227], a[36:39], v[168:171]
    global_load_dwordx4 v[52:55], v23, s[64:65] offset:64
    v_mfma_f32_16x16x32_bf16 v[176:179], a[224:227], a[40:43], v[176:179]
    buffer_load_dwordx2 v[40:41], v24, s[24:27], 0 offen sc1
    v_mfma_f32_16x16x32_bf16 v[176:179], a[228:231], a[56:59], v[176:179]
    s_waitcnt lgkmcnt(2)
    ds_read_b64_tr_b16 a[244:245], v8 offset:38912
    s_min_u32 s36, s36, s55
    v_mfma_f32_16x16x32_bf16 v[184:187], a[228:231], a[60:63], v[184:187]
    ds_read_b64_tr_b16 a[246:247], v8 offset:45056
    v_mfma_f32_16x16x32_bf16 v[184:187], a[224:227], a[44:47], v[184:187]
    ds_read_b64_tr_b16 a[224:225], v9 offset:26624
    v_mfma_f32_16x16x32_bf16 v[188:191], a[232:235], a[44:47], v[188:191]
    ds_read_b64_tr_b16 a[226:227], v9 offset:32768
    v_mfma_f32_16x16x32_bf16 v[188:191], a[236:239], a[60:63], v[188:191]
    ds_read_b64_tr_b16 a[228:229], v9 offset:38912
    v_mfma_f32_16x16x32_bf16 v[180:183], a[236:239], a[56:59], v[180:183]
    ds_read_b64_tr_b16 a[230:231], v9 offset:45056
    v_mfma_f32_16x16x32_bf16 v[180:183], a[232:235], a[40:43], v[180:183]
    v_add_u32 v8, 49152, v8
    v_mfma_f32_16x16x32_bf16 v[172:175], a[232:235], a[36:39], v[172:175]
    v_add_u32 v9, 49152, v9
    v_mfma_f32_16x16x32_bf16 v[172:175], a[236:239], a[52:55], v[172:175]
    s_waitcnt lgkmcnt(4)
    v_mfma_f32_16x16x32_bf16 v[164:167], a[236:239], a[48:51], v[164:167]
    v_mfma_f32_16x16x32_bf16 v[164:167], a[232:235], a[32:35], v[164:167]
    ds_read_b64_tr_b16 a[232:233], v10 offset:26624
    v_mfma_f32_16x16x32_bf16 v[192:195], a[240:243], a[32:35], v[192:195]
    ds_read_b64_tr_b16 a[234:235], v10 offset:32768
    v_mfma_f32_16x16x32_bf16 v[192:195], a[244:247], a[48:51], v[192:195]
    ds_read_b64_tr_b16 a[236:237], v10 offset:38912
    v_mfma_f32_16x16x32_bf16 v[200:203], a[244:247], a[52:55], v[200:203]
    ds_read_b64_tr_b16 a[238:239], v10 offset:45056
    v_mfma_f32_16x16x32_bf16 v[200:203], a[240:243], a[36:39], v[200:203]
    v_add_u32 v10, 49152, v10
    v_mfma_f32_16x16x32_bf16 v[208:211], a[240:243], a[40:43], v[208:211]
    v_mfma_f32_16x16x32_bf16 v[208:211], a[244:247], a[56:59], v[208:211]
    s_waitcnt lgkmcnt(4)
    v_mfma_f32_16x16x32_bf16 v[216:219], a[244:247], a[60:63], v[216:219]
    v_mfma_f32_16x16x32_bf16 v[216:219], a[240:243], a[44:47], v[216:219]
    ds_read_b64_tr_b16 a[240:241], v11 offset:26624
    ds_read_b64_tr_b16 a[242:243], v11 offset:32768
    ds_read_b64_tr_b16 a[244:245], v11 offset:38912
    v_mfma_f32_16x16x32_bf16 v[220:223], a[224:227], a[44:47], v[220:223]
    ds_read_b64_tr_b16 a[246:247], v11 offset:45056
    v_mfma_f32_16x16x32_bf16 v[220:223], a[228:231], a[60:63], v[220:223]
    s_add_u32 m0, s44, 147456
    v_add_u32 v11, 49152, v11
    v_mfma_f32_16x16x32_bf16 v[212:215], a[228:231], a[56:59], v[212:215]
    v_mfma_f32_16x16x32_bf16 v[212:215], a[224:227], a[40:43], v[212:215]
    v_mfma_f32_16x16x32_bf16 v[204:207], a[224:227], a[36:39], v[204:207]
    v_mfma_f32_16x16x32_bf16 v[204:207], a[228:231], a[52:55], v[204:207]
    s_waitcnt lgkmcnt(4)
    v_mfma_f32_16x16x32_bf16 v[196:199], a[228:231], a[48:51], v[196:199]
    s_waitcnt lgkmcnt(0)
    s_barrier
    v_mfma_f32_16x16x32_bf16 v[196:199], a[224:227], a[32:35], v[196:199]
    buffer_load_dwordx4 v56, s[28:31], s60 offen lds
    v_mfma_f32_16x16x32_bf16 v[224:227], a[232:235], a[32:35], v[224:227]
    s_add_u32 m0, s44, 148480
    ds_read_b64_tr_b16 a[224:225], v8 offset:0
    v_mfma_f32_16x16x32_bf16 v[224:227], a[236:239], a[48:51], v[224:227]
    ds_read_b64_tr_b16 a[226:227], v8 offset:6144
    v_mfma_f32_16x16x32_bf16 v[232:235], a[236:239], a[52:55], v[232:235]
    ds_read_b64_tr_b16 a[228:229], v8 offset:12288
    v_mfma_f32_16x16x32_bf16 v[232:235], a[232:235], a[36:39], v[232:235]
    ds_read_b64_tr_b16 a[230:231], v8 offset:18432
    v_mfma_f32_16x16x32_bf16 v[240:243], a[232:235], a[40:43], v[240:243]
    v_mfma_f32_16x16x32_bf16 v[240:243], a[236:239], a[56:59], v[240:243]
    buffer_load_dwordx4 v56, s[32:35], s60 offen lds
    v_mfma_f32_16x16x32_bf16 v[248:251], a[236:239], a[60:63], v[248:251]
    s_add_u32 m0, s44, 149504
    v_mfma_f32_16x16x32_bf16 v[248:251], a[232:235], a[44:47], v[248:251]
    ds_read_b64_tr_b16 a[232:233], v9 offset:0
    v_mfma_f32_16x16x32_bf16 v[252:255], a[240:243], a[44:47], v[252:255]
    ds_read_b64_tr_b16 a[234:235], v9 offset:6144
    v_mfma_f32_16x16x32_bf16 v[252:255], a[244:247], a[60:63], v[252:255]
    ds_read_b64_tr_b16 a[236:237], v9 offset:12288
    v_mfma_f32_16x16x32_bf16 v[244:247], a[244:247], a[56:59], v[244:247]
    ds_read_b64_tr_b16 a[238:239], v9 offset:18432
    v_mfma_f32_16x16x32_bf16 v[244:247], a[240:243], a[40:43], v[244:247]
    v_mfma_f32_16x16x32_bf16 v[236:239], a[240:243], a[36:39], v[236:239]
    buffer_load_dwordx4 v57, s[28:31], s60 offen lds
    v_mfma_f32_16x16x32_bf16 v[236:239], a[244:247], a[52:55], v[236:239]
    s_waitcnt vmcnt(29) lgkmcnt(4)
    s_add_u32 m0, s44, 150528
    v_mfma_f32_16x16x32_bf16 v[228:231], a[244:247], a[48:51], v[228:231]
    s_waitcnt vmcnt(19)
    v_mfma_f32_16x16x32_bf16 v[228:231], a[240:243], a[32:35], v[228:231]
    s_waitcnt vmcnt(18)
    ds_read_b64_tr_b16 a[240:241], v10 offset:0
    v_mfma_f32_16x16x32_bf16 v[64:67], a[224:227], a[64:67], v[64:67]
    ds_read_b64_tr_b16 a[242:243], v10 offset:6144
    v_mfma_f32_16x16x32_bf16 v[64:67], a[228:231], a[80:83], v[64:67]
    ds_read_b64_tr_b16 a[244:245], v10 offset:12288
    v_mfma_f32_16x16x32_bf16 v[72:75], a[228:231], a[84:87], v[72:75]
    buffer_load_dwordx4 v57, s[32:35], s60 offen lds
    v_mfma_f32_16x16x32_bf16 v[72:75], a[224:227], a[68:71], v[72:75]
    s_waitcnt vmcnt(17)
    ds_read_b64_tr_b16 a[246:247], v10 offset:18432
    s_add_u32 s46, s45, 61440
    v_mfma_f32_16x16x32_bf16 v[80:83], a[224:227], a[72:75], v[80:83]
    s_sub_u32 s77, s46, 81920
    s_min_u32 s46, s46, s77
    v_mfma_f32_16x16x32_bf16 v[80:83], a[228:231], a[88:91], v[80:83]
    s_waitcnt lgkmcnt(4)
    v_mfma_f32_16x16x32_bf16 v[88:91], a[228:231], a[92:95], v[88:91]
    v_mfma_f32_16x16x32_bf16 v[88:91], a[224:227], a[76:79], v[88:91]
    ds_read_b64_tr_b16 a[224:225], v11 offset:0
    v_mfma_f32_16x16x32_bf16 v[92:95], a[232:235], a[76:79], v[92:95]
    ds_read_b64_tr_b16 a[226:227], v11 offset:6144
    v_mfma_f32_16x16x32_bf16 v[92:95], a[236:239], a[92:95], v[92:95]
    buffer_load_dwordx4 a[176:179], v14, s[20:23], s46 offen offset:0 sc1
    v_mfma_f32_16x16x32_bf16 v[84:87], a[236:239], a[88:91], v[84:87]
    ds_read_b64_tr_b16 a[228:229], v11 offset:12288
    v_mfma_f32_16x16x32_bf16 v[84:87], a[232:235], a[72:75], v[84:87]
    ds_read_b64_tr_b16 a[230:231], v11 offset:18432
    v_mfma_f32_16x16x32_bf16 v[76:79], a[232:235], a[68:71], v[76:79]
    v_mfma_f32_16x16x32_bf16 v[76:79], a[236:239], a[84:87], v[76:79]
    s_waitcnt lgkmcnt(4)
    v_mfma_f32_16x16x32_bf16 v[68:71], a[236:239], a[80:83], v[68:71]
    v_mfma_f32_16x16x32_bf16 v[68:71], a[232:235], a[64:67], v[68:71]
    buffer_load_dwordx4 a[180:183], v14, s[20:23], s46 offen offset:1024 sc1
    v_mfma_f32_16x16x32_bf16 v[96:99], a[240:243], a[64:67], v[96:99]
    ds_read_b64_tr_b16 a[232:233], v8 offset:1024
    v_mfma_f32_16x16x32_bf16 v[96:99], a[244:247], a[80:83], v[96:99]
    ds_read_b64_tr_b16 a[234:235], v8 offset:7168
    v_mfma_f32_16x16x32_bf16 v[104:107], a[244:247], a[84:87], v[104:107]
    ds_read_b64_tr_b16 a[236:237], v8 offset:13312
    v_mfma_f32_16x16x32_bf16 v[104:107], a[240:243], a[68:71], v[104:107]
    ds_read_b64_tr_b16 a[238:239], v8 offset:19456
    v_mfma_f32_16x16x32_bf16 v[112:115], a[240:243], a[72:75], v[112:115]
    s_add_u32 s88, s88, 32768
    s_addc_u32 s89, s89, 0
    v_mfma_f32_16x16x32_bf16 v[112:115], a[244:247], a[88:91], v[112:115]
    s_waitcnt lgkmcnt(4)
    v_mfma_f32_16x16x32_bf16 v[120:123], a[244:247], a[92:95], v[120:123]
    buffer_load_dwordx4 a[184:187], v15, s[20:23], s46 offen offset:0 sc1
    v_mfma_f32_16x16x32_bf16 v[120:123], a[240:243], a[76:79], v[120:123]
    ds_read_b64_tr_b16 a[240:241], v9 offset:1024
    v_mfma_f32_16x16x32_bf16 v[124:127], a[224:227], a[76:79], v[124:127]
    global_load_dword a252, v18, s[88:89]
    v_mfma_f32_16x16x32_bf16 v[124:127], a[228:231], a[92:95], v[124:127]
    ds_read_b64_tr_b16 a[242:243], v9 offset:7168
    v_mfma_f32_16x16x32_bf16 v[116:119], a[228:231], a[88:91], v[116:119]
    ds_read_b64_tr_b16 a[244:245], v9 offset:13312
    v_mfma_f32_16x16x32_bf16 v[116:119], a[224:227], a[72:75], v[116:119]
    ds_read_b64_tr_b16 a[246:247], v9 offset:19456
    v_mfma_f32_16x16x32_bf16 v[108:111], a[224:227], a[68:71], v[108:111]
    buffer_load_dwordx4 a[188:191], v15, s[20:23], s46 offen offset:1024 sc1
    v_mfma_f32_16x16x32_bf16 v[108:111], a[228:231], a[84:87], v[108:111]
    s_waitcnt lgkmcnt(4)
    s_add_u32 s46, s45, 65536
    s_sub_u32 s77, s46, 81920
    v_mfma_f32_16x16x32_bf16 v[100:103], a[228:231], a[80:83], v[100:103]
    s_min_u32 s46, s46, s77
    v_mfma_f32_16x16x32_bf16 v[100:103], a[224:227], a[64:67], v[100:103]
    ds_read_b64_tr_b16 a[224:225], v10 offset:1024
    v_mfma_f32_16x16x32_bf16 v[128:131], a[232:235], a[64:67], v[128:131]
    ds_read_b64_tr_b16 a[226:227], v10 offset:7168
    v_mfma_f32_16x16x32_bf16 v[128:131], a[236:239], a[80:83], v[128:131]
    ds_read_b64_tr_b16 a[228:229], v10 offset:13312
    v_mfma_f32_16x16x32_bf16 v[136:139], a[236:239], a[84:87], v[136:139]
    ds_read_b64_tr_b16 a[230:231], v10 offset:19456
    v_mfma_f32_16x16x32_bf16 v[136:139], a[232:235], a[68:71], v[136:139]
    buffer_load_dwordx4 a[96:99], v14, s[20:23], s46 offen offset:0 sc1
    v_mfma_f32_16x16x32_bf16 v[144:147], a[232:235], a[72:75], v[144:147]
    v_mfma_f32_16x16x32_bf16 v[144:147], a[236:239], a[88:91], v[144:147]
    s_waitcnt lgkmcnt(4)
    v_mfma_f32_16x16x32_bf16 v[152:155], a[236:239], a[92:95], v[152:155]
    v_mfma_f32_16x16x32_bf16 v[152:155], a[232:235], a[76:79], v[152:155]
    ds_read_b64_tr_b16 a[232:233], v11 offset:1024
    v_mfma_f32_16x16x32_bf16 v[156:159], a[240:243], a[76:79], v[156:159]
    ds_read_b64_tr_b16 a[234:235], v11 offset:7168
    v_mfma_f32_16x16x32_bf16 v[156:159], a[244:247], a[92:95], v[156:159]
    buffer_load_dwordx4 a[100:103], v14, s[20:23], s46 offen offset:1024 sc1
    v_mfma_f32_16x16x32_bf16 v[148:151], a[244:247], a[88:91], v[148:151]
    ds_read_b64_tr_b16 a[236:237], v11 offset:13312
    v_mfma_f32_16x16x32_bf16 v[148:151], a[240:243], a[72:75], v[148:151]
    ds_read_b64_tr_b16 a[238:239], v11 offset:19456
    v_mfma_f32_16x16x32_bf16 v[140:143], a[240:243], a[68:71], v[140:143]
    v_mfma_f32_16x16x32_bf16 v[140:143], a[244:247], a[84:87], v[140:143]
    s_waitcnt lgkmcnt(4)
    v_mfma_f32_16x16x32_bf16 v[132:135], a[244:247], a[80:83], v[132:135]
    v_mfma_f32_16x16x32_bf16 v[132:135], a[240:243], a[64:67], v[132:135]
    ds_read_b64_tr_b16 a[240:241], v8 offset:2048
    v_mfma_f32_16x16x32_bf16 v[160:163], a[224:227], a[64:67], v[160:163]
    buffer_load_dwordx4 a[104:107], v15, s[20:23], s46 offen offset:0 sc1
    v_mfma_f32_16x16x32_bf16 v[160:163], a[228:231], a[80:83], v[160:163]
    ds_read_b64_tr_b16 a[242:243], v8 offset:8192
    v_mfma_f32_16x16x32_bf16 v[168:171], a[228:231], a[84:87], v[168:171]
    ds_read_b64_tr_b16 a[244:245], v8 offset:14336
    v_mfma_f32_16x16x32_bf16 v[168:171], a[224:227], a[68:71], v[168:171]
    ds_read_b64_tr_b16 a[246:247], v8 offset:20480
    v_mfma_f32_16x16x32_bf16 v[176:179], a[224:227], a[72:75], v[176:179]
    v_mfma_f32_16x16x32_bf16 v[176:179], a[228:231], a[88:91], v[176:179]
    s_waitcnt lgkmcnt(4)
    v_mfma_f32_16x16x32_bf16 v[184:187], a[228:231], a[92:95], v[184:187]
    buffer_load_dwordx4 a[108:111], v15, s[20:23], s46 offen offset:1024 sc1
    v_mfma_f32_16x16x32_bf16 v[184:187], a[224:227], a[76:79], v[184:187]
    s_add_u32 m0, s49, 122880
    ds_read_b64_tr_b16 a[224:225], v9 offset:2048
    v_mfma_f32_16x16x32_bf16 v[188:191], a[232:235], a[76:79], v[188:191]
    s_waitcnt vmcnt(15)
    ds_read_b64_tr_b16 a[226:227], v9 offset:8192
    v_lshlrev_b32 v42, 16, v48
    v_mfma_f32_16x16x32_bf16 v[188:191], a[236:239], a[92:95], v[188:191]
    s_waitcnt vmcnt(13)
    ds_read_b64_tr_b16 a[228:229], v9 offset:14336
    v_and_b32 v43, 0xffff0000, v48
    v_mfma_f32_16x16x32_bf16 v[180:183], a[236:239], a[88:91], v[180:183]
    ds_read_b64_tr_b16 a[230:231], v9 offset:20480
    v_sub_f32 v42, v42, v40
    v_mfma_f32_16x16x32_bf16 v[180:183], a[232:235], a[72:75], v[180:183]
    v_sub_f32 v43, v43, v40
    v_cvt_pk_bf16_f32 v44, v42, v43
    v_mfma_f32_16x16x32_bf16 v[172:175], a[232:235], a[68:71], v[172:175]
    v_lshlrev_b32 v42, 16, v44
    v_and_b32 v43, 0xffff0000, v44
    v_mfma_f32_16x16x32_bf16 v[172:175], a[236:239], a[84:87], v[172:175]
    buffer_load_dwordx4 v2, s[8:11], s36 offen offset:0 lds
    v_mfma_f32_16x16x32_bf16 v[164:167], a[236:239], a[80:83], v[164:167]
    s_waitcnt lgkmcnt(3)
    v_mul_f32 v42, v42, v41
    v_mul_f32 v43, v43, v41
    v_mfma_f32_16x16x32_bf16 v[164:167], a[232:235], a[64:67], v[164:167]
    s_add_u32 m0, s49, 123776
    ds_read_b64_tr_b16 a[232:233], v10 offset:2048
    v_cvt_pk_bf16_f32 v48, v42, v43
    v_mfma_f32_16x16x32_bf16 v[192:195], a[240:243], a[64:67], v[192:195]
    ds_read_b64_tr_b16 a[234:235], v10 offset:8192
    v_lshlrev_b32 v42, 16, v49
    v_mfma_f32_16x16x32_bf16 v[192:195], a[244:247], a[80:83], v[192:195]
    ds_read_b64_tr_b16 a[236:237], v10 offset:14336
    v_and_b32 v43, 0xffff0000, v49
    v_mfma_f32_16x16x32_bf16 v[200:203], a[244:247], a[84:87], v[200:203]
    ds_read_b64_tr_b16 a[238:239], v10 offset:20480
    v_sub_f32 v42, v42, v40
    v_mfma_f32_16x16x32_bf16 v[200:203], a[240:243], a[68:71], v[200:203]
    buffer_load_dwordx4 v2, s[8:11], s36 offen offset:128 lds
    v_mfma_f32_16x16x32_bf16 v[208:211], a[240:243], a[72:75], v[208:211]
    s_add_u32 m0, s49, 124672
    v_sub_f32 v43, v43, v40
    v_cvt_pk_bf16_f32 v44, v42, v43
    v_mfma_f32_16x16x32_bf16 v[208:211], a[244:247], a[88:91], v[208:211]
    s_waitcnt lgkmcnt(4)
    v_lshlrev_b32 v42, 16, v44
    v_and_b32 v43, 0xffff0000, v44
    v_mfma_f32_16x16x32_bf16 v[216:219], a[244:247], a[92:95], v[216:219]
    v_mul_f32 v42, v42, v41
    v_mul_f32 v43, v43, v41
    v_mfma_f32_16x16x32_bf16 v[216:219], a[240:243], a[76:79], v[216:219]
    ds_read_b64_tr_b16 a[240:241], v11 offset:2048
    v_cvt_pk_bf16_f32 v49, v42, v43
    ds_read_b64_tr_b16 a[242:243], v11 offset:8192
    v_mfma_f32_16x16x32_bf16 v[220:223], a[224:227], a[76:79], v[220:223]
    ds_read_b64_tr_b16 a[244:245], v11 offset:14336
    v_lshlrev_b32 v42, 16, v50
    ds_read_b64_tr_b16 a[246:247], v11 offset:20480
    v_mfma_f32_16x16x32_bf16 v[220:223], a[228:231], a[92:95], v[220:223]
    v_and_b32 v43, 0xffff0000, v50
    v_sub_f32 v42, v42, v40
    v_mfma_f32_16x16x32_bf16 v[212:215], a[228:231], a[88:91], v[212:215]
    buffer_load_dwordx4 v2, s[8:11], s36 offen offset:256 lds
    v_mfma_f32_16x16x32_bf16 v[212:215], a[224:227], a[72:75], v[212:215]
    s_add_u32 m0, s49, 125952
    v_sub_f32 v43, v43, v40
    v_cvt_pk_bf16_f32 v44, v42, v43
    v_mfma_f32_16x16x32_bf16 v[204:207], a[224:227], a[68:71], v[204:207]
    v_lshlrev_b32 v42, 16, v44
    v_and_b32 v43, 0xffff0000, v44
    v_mfma_f32_16x16x32_bf16 v[204:207], a[228:231], a[84:87], v[204:207]
    s_waitcnt lgkmcnt(4)
    v_mul_f32 v42, v42, v41
    v_mul_f32 v43, v43, v41
    v_mfma_f32_16x16x32_bf16 v[196:199], a[228:231], a[80:83], v[196:199]
    s_waitcnt vmcnt(12) lgkmcnt(0)
    s_barrier
    v_mfma_f32_16x16x32_bf16 v[196:199], a[224:227], a[64:67], v[196:199]
    ds_read_b64_tr_b16 a[224:225], v8 offset:24576
    v_cvt_pk_bf16_f32 v50, v42, v43
    v_mfma_f32_16x16x32_bf16 v[224:227], a[232:235], a[64:67], v[224:227]
    buffer_load_dwordx4 v3, s[8:11], s36 offen offset:0 lds
    v_mfma_f32_16x16x32_bf16 v[224:227], a[236:239], a[80:83], v[224:227]
    s_add_u32 m0, s49, 126848
    ds_read_b64_tr_b16 a[226:227], v8 offset:30720
    v_lshlrev_b32 v42, 16, v51
    v_mfma_f32_16x16x32_bf16 v[232:235], a[236:239], a[84:87], v[232:235]
    ds_read_b64_tr_b16 a[228:229], v8 offset:36864
    v_and_b32 v43, 0xffff0000, v51
    v_mfma_f32_16x16x32_bf16 v[232:235], a[232:235], a[68:71], v[232:235]
    ds_read_b64_tr_b16 a[230:231], v8 offset:43008
    v_sub_f32 v42, v42, v40
    v_mfma_f32_16x16x32_bf16 v[240:243], a[232:235], a[72:75], v[240:243]
    v_sub_f32 v43, v43, v40
    v_cvt_pk_bf16_f32 v44, v42, v43
    v_mfma_f32_16x16x32_bf16 v[240:243], a[236:239], a[88:91], v[240:243]
    v_lshlrev_b32 v42, 16, v44
    v_and_b32 v43, 0xffff0000, v44
    v_mfma_f32_16x16x32_bf16 v[248:251], a[236:239], a[92:95], v[248:251]
    v_mul_f32 v42, v42, v41
    v_mul_f32 v43, v43, v41
    v_mfma_f32_16x16x32_bf16 v[248:251], a[232:235], a[76:79], v[248:251]
    buffer_load_dwordx4 v3, s[8:11], s36 offen offset:128 lds
    v_mfma_f32_16x16x32_bf16 v[252:255], a[240:243], a[76:79], v[252:255]
    s_add_u32 m0, s49, 127744
    ds_read_b64_tr_b16 a[232:233], v9 offset:24576
    v_cvt_pk_bf16_f32 v51, v42, v43
    v_mfma_f32_16x16x32_bf16 v[252:255], a[244:247], a[92:95], v[252:255]
pg_3:
    s_cbranch_execz pg_7
    ds_read_b64_tr_b16 a[234:235], v9 offset:30720
    v_lshlrev_b32 v42, 16, v52
    v_mfma_f32_16x16x32_bf16 v[244:247], a[244:247], a[88:91], v[244:247]
    ds_read_b64_tr_b16 a[236:237], v9 offset:36864
    v_and_b32 v43, 0xffff0000, v52
    v_mfma_f32_16x16x32_bf16 v[244:247], a[240:243], a[72:75], v[244:247]
    ds_read_b64_tr_b16 a[238:239], v9 offset:43008
    v_sub_f32 v42, v42, v40
    v_mfma_f32_16x16x32_bf16 v[236:239], a[240:243], a[68:71], v[236:239]
    v_sub_f32 v43, v43, v40
    v_cvt_pk_bf16_f32 v44, v42, v43
    v_mfma_f32_16x16x32_bf16 v[236:239], a[244:247], a[84:87], v[236:239]
    buffer_load_dwordx4 v3, s[8:11], s36 offen offset:256 lds
    v_mfma_f32_16x16x32_bf16 v[228:231], a[244:247], a[80:83], v[228:231]
    s_waitcnt vmcnt(14) lgkmcnt(4)
    v_lshlrev_b32 v42, 16, v44
    v_and_b32 v43, 0xffff0000, v44
    v_mfma_f32_16x16x32_bf16 v[228:231], a[240:243], a[64:67], v[228:231]
    s_waitcnt vmcnt(13)
    ds_read_b64_tr_b16 a[240:241], v10 offset:24576
    v_mul_f32 v42, v42, v41
    v_mfma_f32_16x16x32_bf16 v[64:67], a[224:227], a[160:163], v[64:67]
    s_add_u32 s36, s36, s37
    ds_read_b64_tr_b16 a[242:243], v10 offset:30720
    v_mul_f32 v43, v43, v41
    v_mfma_f32_16x16x32_bf16 v[64:67], a[228:231], a[176:179], v[64:67]
    s_sub_u32 s55, s36, 7864320
    ds_read_b64_tr_b16 a[244:245], v10 offset:36864
    v_cvt_pk_bf16_f32 v52, v42, v43
    v_mfma_f32_16x16x32_bf16 v[72:75], a[228:231], a[180:183], v[72:75]
    s_waitcnt vmcnt(12)
    ds_read_b64_tr_b16 a[246:247], v10 offset:43008
    v_lshlrev_b32 v42, 16, v53
    v_mfma_f32_16x16x32_bf16 v[72:75], a[224:227], a[164:167], v[72:75]
    s_waitcnt vmcnt(10)
    v_and_b32 v43, 0xffff0000, v53
    v_sub_f32 v42, v42, v40
    v_mfma_f32_16x16x32_bf16 v[80:83], a[224:227], a[168:171], v[80:83]
    s_min_u32 s36, s36, s55
    v_sub_f32 v43, v43, v40
    v_cvt_pk_bf16_f32 v44, v42, v43
    v_mfma_f32_16x16x32_bf16 v[80:83], a[228:231], a[184:187], v[80:83]
    s_waitcnt lgkmcnt(4)
    v_lshlrev_b32 v42, 16, v44
    v_and_b32 v43, 0xffff0000, v44
    v_mfma_f32_16x16x32_bf16 v[88:91], a[228:231], a[188:191], v[88:91]
    s_add_u32 s46, s45, 69632
    v_mul_f32 v42, v42, v41
    v_mul_f32 v43, v43, v41
    v_mfma_f32_16x16x32_bf16 v[88:91], a[224:227], a[172:175], v[88:91]
    s_sub_u32 s77, s46, 81920
    ds_read_b64_tr_b16 a[224:225], v11 offset:24576
    v_cvt_pk_bf16_f32 v53, v42, v43
    v_mfma_f32_16x16x32_bf16 v[92:95], a[232:235], a[172:175], v[92:95]
    s_min_u32 s46, s46, s77
    ds_read_b64_tr_b16 a[226:227], v11 offset:30720
    v_lshlrev_b32 v42, 16, v54
    v_mfma_f32_16x16x32_bf16 v[92:95], a[236:239], a[188:191], v[92:95]
    buffer_load_dwordx4 a[112:115], v14, s[20:23], s46 offen offset:0 sc1
    v_mfma_f32_16x16x32_bf16 v[84:87], a[236:239], a[184:187], v[84:87]
    buffer_load_dwordx4 a[116:119], v14, s[20:23], s46 offen offset:1024 sc1
    v_mfma_f32_16x16x32_bf16 v[84:87], a[232:235], a[168:171], v[84:87]
    ds_read_b64_tr_b16 a[228:229], v11 offset:36864
    v_and_b32 v43, 0xffff0000, v54
    v_mfma_f32_16x16x32_bf16 v[76:79], a[232:235], a[164:167], v[76:79]
    ds_read_b64_tr_b16 a[230:231], v11 offset:43008
    v_sub_f32 v42, v42, v40
    v_mfma_f32_16x16x32_bf16 v[76:79], a[236:239], a[180:183], v[76:79]
    s_waitcnt lgkmcnt(4)
    v_sub_f32 v43, v43, v40
    v_cvt_pk_bf16_f32 v44, v42, v43
    v_mfma_f32_16x16x32_bf16 v[68:71], a[236:239], a[176:179], v[68:71]
    v_lshlrev_b32 v42, 16, v44
    v_and_b32 v43, 0xffff0000, v44
    v_mfma_f32_16x16x32_bf16 v[68:71], a[232:235], a[160:163], v[68:71]
    ds_read_b64_tr_b16 a[232:233], v8 offset:25600
    v_mul_f32 v42, v42, v41
    v_mfma_f32_16x16x32_bf16 v[96:99], a[240:243], a[160:163], v[96:99]
    ds_read_b64_tr_b16 a[234:235], v8 offset:31744
    v_mul_f32 v43, v43, v41
    v_mfma_f32_16x16x32_bf16 v[96:99], a[244:247], a[176:179], v[96:99]
    buffer_load_dwordx4 a[120:123], v15, s[20:23], s46 offen offset:0 sc1
    v_mfma_f32_16x16x32_bf16 v[104:107], a[244:247], a[180:183], v[104:107]
    ds_read_b64_tr_b16 a[236:237], v8 offset:37888
    v_cvt_pk_bf16_f32 v54, v42, v43
    v_mfma_f32_16x16x32_bf16 v[104:107], a[240:243], a[164:167], v[104:107]
    ds_read_b64_tr_b16 a[238:239], v8 offset:44032
    v_lshlrev_b32 v42, 16, v55
    v_mfma_f32_16x16x32_bf16 v[112:115], a[240:243], a[168:171], v[112:115]
    v_and_b32 v43, 0xffff0000, v55
    v_sub_f32 v42, v42, v40
    v_mfma_f32_16x16x32_bf16 v[112:115], a[244:247], a[184:187], v[112:115]
    s_waitcnt lgkmcnt(4)
    v_sub_f32 v43, v43, v40
    v_cvt_pk_bf16_f32 v44, v42, v43
    v_mfma_f32_16x16x32_bf16 v[120:123], a[244:247], a[188:191], v[120:123]
    v_lshlrev_b32 v42, 16, v44
    v_and_b32 v43, 0xffff0000, v44
    v_mfma_f32_16x16x32_bf16 v[120:123], a[240:243], a[172:175], v[120:123]
    buffer_load_dwordx4 a[124:127], v15, s[20:23], s46 offen offset:1024 sc1
    v_mfma_f32_16x16x32_bf16 v[124:127], a[224:227], a[172:175], v[124:127]
    s_add_u32 s46, s45, 73728
    ds_read_b64_tr_b16 a[240:241], v9 offset:25600
    v_mul_f32 v42, v42, v41
    v_mfma_f32_16x16x32_bf16 v[124:127], a[228:231], a[188:191], v[124:127]
    s_sub_u32 s77, s46, 81920
    ds_read_b64_tr_b16 a[242:243], v9 offset:31744
    v_mul_f32 v43, v43, v41
    v_mfma_f32_16x16x32_bf16 v[116:119], a[228:231], a[184:187], v[116:119]
    s_min_u32 s46, s46, s77
    ds_read_b64_tr_b16 a[244:245], v9 offset:37888
    v_cvt_pk_bf16_f32 v55, v42, v43
    v_mfma_f32_16x16x32_bf16 v[116:119], a[224:227], a[168:171], v[116:119]
    ds_read_b64_tr_b16 a[246:247], v9 offset:44032
    v_mfma_f32_16x16x32_bf16 v[108:111], a[224:227], a[164:167], v[108:111]
    v_mfma_f32_16x16x32_bf16 v[108:111], a[228:231], a[180:183], v[108:111]
    s_waitcnt lgkmcnt(4)
    v_mfma_f32_16x16x32_bf16 v[100:103], a[228:231], a[176:179], v[100:103]
    buffer_load_dwordx4 a[128:131], v14, s[20:23], s46 offen offset:0 sc1
    v_mfma_f32_16x16x32_bf16 v[100:103], a[224:227], a[160:163], v[100:103]
    ds_read_b64_tr_b16 a[224:225], v10 offset:25600
    v_mfma_f32_16x16x32_bf16 v[128:131], a[232:235], a[160:163], v[128:131]
    ds_read_b64_tr_b16 a[226:227], v10 offset:31744
    v_mfma_f32_16x16x32_bf16 v[128:131], a[236:239], a[176:179], v[128:131]
    ds_read_b64_tr_b16 a[228:229], v10 offset:37888
    v_mfma_f32_16x16x32_bf16 v[136:139], a[236:239], a[180:183], v[136:139]
    ds_read_b64_tr_b16 a[230:231], v10 offset:44032
    v_mfma_f32_16x16x32_bf16 v[136:139], a[232:235], a[164:167], v[136:139]
    v_mfma_f32_16x16x32_bf16 v[144:147], a[232:235], a[168:171], v[144:147]
    buffer_load_dwordx4 a[132:135], v14, s[20:23], s46 offen offset:1024 sc1
    v_mfma_f32_16x16x32_bf16 v[144:147], a[236:239], a[184:187], v[144:147]
    s_waitcnt lgkmcnt(4)
    v_mfma_f32_16x16x32_bf16 v[152:155], a[236:239], a[188:191], v[152:155]
    v_mfma_f32_16x16x32_bf16 v[152:155], a[232:235], a[172:175], v[152:155]
    ds_read_b64_tr_b16 a[232:233], v11 offset:25600
    v_mfma_f32_16x16x32_bf16 v[156:159], a[240:243], a[172:175], v[156:159]
    ds_read_b64_tr_b16 a[234:235], v11 offset:31744
    v_mfma_f32_16x16x32_bf16 v[156:159], a[244:247], a[188:191], v[156:159]
    ds_read_b64_tr_b16 a[236:237], v11 offset:37888
    v_mfma_f32_16x16x32_bf16 v[148:151], a[244:247], a[184:187], v[148:151]
    ds_read_b64_tr_b16 a[238:239], v11 offset:44032
    v_mfma_f32_16x16x32_bf16 v[148:151], a[240:243], a[168:171], v[148:151]
    buffer_load_dwordx4 a[136:139], v15, s[20:23], s46 offen offset:0 sc1
    v_mfma_f32_16x16x32_bf16 v[140:143], a[240:243], a[164:167], v[140:143]
    v_mfma_f32_16x16x32_bf16 v[140:143], a[244:247], a[180:183], v[140:143]
    s_waitcnt lgkmcnt(4)
    v_mfma_f32_16x16x32_bf16 v[132:135], a[244:247], a[176:179], v[132:135]
    v_mfma_f32_16x16x32_bf16 v[132:135], a[240:243], a[160:163], v[132:135]
    ds_read_b64_tr_b16 a[240:241], v8 offset:26624
    v_mfma_f32_16x16x32_bf16 v[160:163], a[224:227], a[160:163], v[160:163]
    ds_read_b64_tr_b16 a[242:243], v8 offset:32768
    v_mfma_f32_16x16x32_bf16 v[160:163], a[228:231], a[176:179], v[160:163]
    buffer_load_dwordx4 a[140:143], v15, s[20:23], s46 offen offset:1024 sc1
    v_mfma_f32_16x16x32_bf16 v[168:171], a[228:231], a[180:183], v[168:171]
    s_add_u32 s46, s45, 77824
    ds_read_b64_tr_b16 a[244:245], v8 offset:38912
    s_sub_u32 s77, s46, 81920
    v_mfma_f32_16x16x32_bf16 v[168:171], a[224:227], a[164:167], v[168:171]
    s_min_u32 s46, s46, s77
    ds_read_b64_tr_b16 a[246:247], v8 offset:45056
    v_mfma_f32_16x16x32_bf16 v[176:179], a[224:227], a[168:171], v[176:179]
    ds_read_b64_tr_b16 v[32:33], v25 offset:0
    v_mfma_f32_16x16x32_bf16 v[176:179], a[228:231], a[184:187], v[176:179]
    s_waitcnt lgkmcnt(5)
    ds_read_b64_tr_b16 v[34:35], v25 offset:4096
    v_mfma_f32_16x16x32_bf16 v[184:187], a[228:231], a[188:191], v[184:187]
    ds_read_b64_tr_b16 v[36:37], v25 offset:1024
    v_mfma_f32_16x16x32_bf16 v[184:187], a[224:227], a[172:175], v[184:187]
    ds_read_b64_tr_b16 v[38:39], v25 offset:5120
    v_mfma_f32_16x16x32_bf16 v[188:191], a[232:235], a[172:175], v[188:191]
    buffer_load_dwordx4 a[144:147], v14, s[20:23], s46 offen offset:0 sc1
    v_mfma_f32_16x16x32_bf16 v[188:191], a[236:239], a[188:191], v[188:191]
    ds_read_b64_tr_b16 v[40:41], v25 offset:8192
    v_mfma_f32_16x16x32_bf16 v[180:183], a[236:239], a[184:187], v[180:183]
    ds_read_b64_tr_b16 v[42:43], v25 offset:12288
    v_mfma_f32_16x16x32_bf16 v[180:183], a[232:235], a[168:171], v[180:183]
    ds_read_b64_tr_b16 v[44:45], v25 offset:9216
    v_mfma_f32_16x16x32_bf16 v[172:175], a[232:235], a[164:167], v[172:175]
    s_waitcnt lgkmcnt(5)
    ds_read_b64_tr_b16 v[46:47], v25 offset:13312
    ds_read_b64_tr_b16 a[224:225], v9 offset:26624
    v_mfma_f32_16x16x32_bf16 v[172:175], a[236:239], a[180:183], v[172:175]
    ds_read_b64_tr_b16 a[226:227], v9 offset:32768
    v_mfma_f32_16x16x32_bf16 v[164:167], a[236:239], a[176:179], v[164:167]
    ds_read_b64_tr_b16 a[228:229], v9 offset:38912
    v_mfma_f32_16x16x32_bf16 v[164:167], a[232:235], a[160:163], v[164:167]
    ds_read_b64_tr_b16 a[230:231], v9 offset:45056
    v_mfma_f32_16x16x32_bf16 v[192:195], a[240:243], a[160:163], v[192:195]
    ds_read_b64_tr_b16 a[232:233], v10 offset:26624
    v_mfma_f32_16x16x32_bf16 v[192:195], a[244:247], a[176:179], v[192:195]
    s_waitcnt lgkmcnt(7)
    ds_read_b64_tr_b16 a[234:235], v10 offset:32768
    v_mfma_f32_16x16x32_bf16 v[200:203], a[244:247], a[180:183], v[200:203]
    ds_read_b64_tr_b16 a[236:237], v10 offset:38912
    v_mfma_f32_16x16x32_bf16 v[200:203], a[240:243], a[164:167], v[200:203]
    ds_read_b64_tr_b16 a[238:239], v10 offset:45056
    v_mfma_f32_16x16x32_bf16 v[208:211], a[240:243], a[168:171], v[208:211]
    buffer_load_dwordx4 a[148:151], v14, s[20:23], s46 offen offset:1024 sc1
    v_mfma_f32_16x16x32_bf16 v[208:211], a[244:247], a[184:187], v[208:211]
    buffer_load_dwordx4 a[152:155], v15, s[20:23], s46 offen offset:0 sc1
    v_mfma_f32_16x16x32_bf16 v[216:219], a[244:247], a[188:191], v[216:219]
    s_waitcnt lgkmcnt(4)
    v_add_u32 v8, 49152, v8
    v_mfma_f32_16x16x32_bf16 v[216:219], a[240:243], a[172:175], v[216:219]
    ds_read_b64_tr_b16 a[240:241], v11 offset:26624
    ds_read_b64_tr_b16 a[242:243], v11 offset:32768
    ds_read_b64_tr_b16 a[244:245], v11 offset:38912
    v_mfma_f32_16x16x32_bf16 v[220:223], a[224:227], a[172:175], v[220:223]
    ds_read_b64_tr_b16 a[246:247], v11 offset:45056
    v_mfma_f32_16x16x32_bf16 v[220:223], a[228:231], a[188:191], v[220:223]
    v_add_u32 v9, 49152, v9
    v_mfma_f32_16x16x32_bf16 v[212:215], a[228:231], a[184:187], v[212:215]
    v_add_u32 v10, 49152, v10
    v_mfma_f32_16x16x32_bf16 v[212:215], a[224:227], a[168:171], v[212:215]
    buffer_load_dwordx4 a[156:159], v15, s[20:23], s46 offen offset:1024 sc1
    v_mfma_f32_16x16x32_bf16 v[204:207], a[224:227], a[164:167], v[204:207]
    s_add_u32 m0, s49, 0
    v_add_u32 v11, 49152, v11
    v_mfma_f32_16x16x32_bf16 v[204:207], a[228:231], a[180:183], v[204:207]
    s_waitcnt lgkmcnt(4)
    v_mfma_f32_16x16x32_bf16 v[196:199], a[228:231], a[176:179], v[196:199]
    s_waitcnt vmcnt(12) lgkmcnt(0)
    s_barrier
    v_mfma_f32_16x16x32_bf16 v[196:199], a[224:227], a[160:163], v[196:199]
    ds_read_b64_tr_b16 a[224:225], v8 offset:0
    v_mfma_f32_16x16x32_bf16 v[224:227], a[232:235], a[160:163], v[224:227]
    ds_read_b64_tr_b16 a[226:227], v8 offset:6144
    v_mfma_f32_16x16x32_bf16 v[224:227], a[236:239], a[176:179], v[224:227]
    ds_read_b64_tr_b16 a[228:229], v8 offset:12288
    v_mfma_f32_16x16x32_bf16 v[232:235], a[236:239], a[180:183], v[232:235]
    buffer_load_dwordx4 v4, s[12:15], s38 offen offset:0 lds
    v_mfma_f32_16x16x32_bf16 v[232:235], a[232:235], a[164:167], v[232:235]
    s_add_u32 m0, s49, 896
    ds_read_b64_tr_b16 a[230:231], v8 offset:18432
    v_mfma_f32_16x16x32_bf16 v[240:243], a[232:235], a[168:171], v[240:243]
    v_mfma_f32_16x16x32_bf16 v[240:243], a[236:239], a[184:187], v[240:243]
    v_mfma_f32_16x16x32_bf16 v[248:251], a[236:239], a[188:191], v[248:251]
    v_mfma_f32_16x16x32_bf16 v[248:251], a[232:235], a[172:175], v[248:251]
    ds_read_b64_tr_b16 a[232:233], v8 offset:24576
    v_mfma_f32_16x16x32_bf16 v[20:23], v[48:51], v[32:35], 0
    buffer_load_dwordx4 v4, s[12:15], s38 offen offset:128 lds
    v_mfma_f32_16x16x32_bf16 v[58:61], v[48:51], v[36:39], 0
    s_add_u32 m0, s49, 1792
    ds_read_b64_tr_b16 a[234:235], v8 offset:30720
    v_mfma_f32_16x16x32_bf16 v[20:23], v[52:55], v[40:43], v[20:23]
    ds_read_b64_tr_b16 a[236:237], v8 offset:36864
    v_mfma_f32_16x16x32_bf16 v[58:61], v[52:55], v[44:47], v[58:61]
    ds_read_b64_tr_b16 a[238:239], v8 offset:43008
    v_mfma_f32_16x16x32_bf16 v[252:255], a[240:243], a[172:175], v[252:255]
    s_mul_i32 s56, s53, 983040
    v_lshlrev_b32 v14, 4, v1
    v_min_u32 v15, 1, v1
    v_mfma_f32_16x16x32_bf16 v[252:255], a[244:247], a[188:191], v[252:255]
    s_mul_i32 s57, s51, 320
    v_lshlrev_b32 v15, 30, v15
    v_mov_b32 v22, v58
    v_mfma_f32_16x16x32_bf16 v[244:247], a[244:247], a[184:187], v[244:247]
    s_add_u32 s56, s56, s57
    v_mov_b32 v23, v59
    s_sub_u32 s57, 7864320, s56
    v_mfma_f32_16x16x32_bf16 v[244:247], a[240:243], a[168:171], v[244:247]
    buffer_store_dwordx4 v[20:23], v26, s[24:27], s62 offen sc1
    v_mov_b32 v26, s7
    v_mfma_f32_16x16x32_bf16 v[236:239], a[240:243], a[164:167], v[236:239]
    buffer_load_dwordx4 v4, s[12:15], s38 offen offset:256 lds
    v_mfma_f32_16x16x32_bf16 v[236:239], a[244:247], a[180:183], v[236:239]
    s_waitcnt lgkmcnt(1)
    v_lshrrev_b32 v21, 3, v1
    v_mul_u32_u24 v21, 1280, v21
    v_mfma_f32_16x16x32_bf16 v[228:231], a[244:247], a[176:179], v[228:231]
    s_waitcnt vmcnt(15)
    v_and_b32 v22, 16, v1
    v_lshlrev_b32 v22, 1, v22
    v_mfma_f32_16x16x32_bf16 v[228:231], a[240:243], a[160:163], v[228:231]
    s_waitcnt vmcnt(14)
    ds_read_b64_tr_b16 a[240:241], v9 offset:0
    v_and_b32 v20, 1, v1
    v_mfma_f32_16x16x32_bf16 v[64:67], a[224:227], a[96:99], v[64:67]
    s_add_u32 m0, s49, 3072
    ds_read_b64_tr_b16 a[242:243], v9 offset:6144
    v_mul_u32_u24 v20, 0xaaaa, v20
    v_mfma_f32_16x16x32_bf16 v[64:67], a[228:231], a[112:115], v[64:67]
    buffer_load_dwordx4 v5, s[12:15], s38 offen offset:0 lds
    v_mfma_f32_16x16x32_bf16 v[72:75], a[228:231], a[116:119], v[72:75]
    s_waitcnt vmcnt(14)
    ds_read_b64_tr_b16 a[244:245], v9 offset:12288
    v_add_u32 v20, 0x4444, v20
    v_mfma_f32_16x16x32_bf16 v[72:75], a[224:227], a[100:103], v[72:75]
    s_waitcnt vmcnt(13)
    ds_read_b64_tr_b16 a[246:247], v9 offset:18432
    s_add_u32 m0, s49, 3968
    v_mfma_f32_16x16x32_bf16 v[80:83], a[224:227], a[104:107], v[80:83]
    s_add_u32 s8, s72, s56
    s_addc_u32 s9, s73, 0
    s_and_b32 s9, s9, 0xffff
    v_mfma_f32_16x16x32_bf16 v[80:83], a[228:231], a[120:123], v[80:83]
    s_waitcnt vmcnt(9)
    s_mov_b32 s10, s57
    s_mov_b32 s11, 0x00020000
    v_mfma_f32_16x16x32_bf16 v[88:91], a[228:231], a[124:127], v[88:91]
    s_waitcnt vmcnt(5) lgkmcnt(3)
    s_mul_i32 s56, s53, 983040
    s_mov_b32 s34, 983040
    v_mfma_f32_16x16x32_bf16 v[88:91], a[224:227], a[108:111], v[88:91]
    s_add_u32 s32, s72, s56
    s_addc_u32 s33, s73, 0
    s_and_b32 s33, s33, 0xffff
    v_mfma_f32_16x16x32_bf16 v[88:91], a[232:235], a[140:143], v[88:91]
    buffer_load_dwordx4 v5, s[12:15], s38 offen offset:128 lds
    v_mfma_f32_16x16x32_bf16 v[88:91], a[236:239], a[156:159], v[88:91]
    s_add_u32 m0, s49, 4864
    ds_read_b64_tr_b16 a[224:225], v9 offset:24576
    s_mov_b32 s35, 0x00020000
    v_mfma_f32_16x16x32_bf16 v[80:83], a[236:239], a[152:155], v[80:83]
    s_mul_i32 s56, s53, 3145728
    ds_read_b64_tr_b16 a[226:227], v9 offset:30720
    s_add_u32 s56, s56, 16777216
    v_mfma_f32_16x16x32_bf16 v[80:83], a[232:235], a[136:139], v[80:83]
    s_add_u32 s20, s86, s56
    s_addc_u32 s21, s87, 0
    v_cvt_pk_bf16_f32 v88, v88, v89
    v_mfma_f32_16x16x32_bf16 v[72:75], a[232:235], a[132:135], v[72:75]
    s_and_b32 s21, s21, 0xffff
    ds_read_b64_tr_b16 a[228:229], v9 offset:36864
    v_cvt_pk_bf16_f32 v89, v90, v91
    v_mfma_f32_16x16x32_bf16 v[72:75], a[236:239], a[148:151], v[72:75]
    s_waitcnt lgkmcnt(3)
    ds_read_b64_tr_b16 a[230:231], v9 offset:43008
    v_cvt_pk_bf16_f32 v80, v80, v81
    v_mfma_f32_16x16x32_bf16 v[64:67], a[236:239], a[144:147], v[64:67]
    buffer_load_dwordx4 v5, s[12:15], s38 offen offset:256 lds
    v_mfma_f32_16x16x32_bf16 v[64:67], a[232:235], a[128:131], v[64:67]
    s_add_u32 s38, s38, 24576
    ds_read_b64_tr_b16 a[232:233], v10 offset:0
    v_cvt_pk_bf16_f32 v72, v72, v73
    v_mfma_f32_16x16x32_bf16 v[68:71], a[240:243], a[96:99], v[68:71]
    s_add_u32 m0, s49, 24576
    ds_read_b64_tr_b16 a[234:235], v10 offset:6144
    v_cvt_pk_bf16_f32 v73, v74, v75
    v_mfma_f32_16x16x32_bf16 v[68:71], a[244:247], a[112:115], v[68:71]
    s_mov_b32 s22, 3145728
    ds_read_b64_tr_b16 a[236:237], v10 offset:12288
    v_cvt_pk_bf16_f32 v64, v64, v65
    v_mfma_f32_16x16x32_bf16 v[76:79], a[244:247], a[116:119], v[76:79]
    s_mov_b32 s23, 0x00020000
    ds_read_b64_tr_b16 a[238:239], v10 offset:18432
    v_cvt_pk_bf16_f32 v65, v66, v67
    v_mfma_f32_16x16x32_bf16 v[76:79], a[240:243], a[100:103], v[76:79]
    s_lshl_b32 s55, s51, 5
    v_cvt_pk_bf16_f32 v81, v82, v83
    s_add_u32 s55, s55, s54
    v_mfma_f32_16x16x32_bf16 v[84:87], a[240:243], a[104:107], v[84:87]
    s_mul_i32 s55, s55, 24576
    s_lshr_b32 s50, s53, 1
    s_add_u32 s56, s51, 0
    v_mfma_f32_16x16x32_bf16 v[84:87], a[244:247], a[120:123], v[84:87]
    buffer_load_dwordx4 v4, s[12:15], s38 offen offset:0 lds
    v_mfma_f32_16x16x32_bf16 v[92:95], a[244:247], a[124:127], v[92:95]
    s_waitcnt lgkmcnt(3)
    s_add_u32 m0, s49, 25472
    s_and_b32 s56, s56, 3
    v_mfma_f32_16x16x32_bf16 v[92:95], a[240:243], a[108:111], v[92:95]
    s_mul_i32 s44, s56, 245760
    ds_read_b64_tr_b16 a[240:241], v10 offset:24576
    s_add_u32 s56, s51, 1
    v_mfma_f32_16x16x32_bf16 v[92:95], a[224:227], a[140:143], v[92:95]
    s_and_b32 s56, s56, 3
    ds_read_b64_tr_b16 a[242:243], v10 offset:30720
    s_mul_i32 s45, s56, 245760
    v_mfma_f32_16x16x32_bf16 v[92:95], a[228:231], a[156:159], v[92:95]
    s_lshl_b32 s56, s56, 5
    ds_read_b64_tr_b16 a[244:245], v10 offset:36864
    s_add_u32 s56, s56, s54
    v_mfma_f32_16x16x32_bf16 v[84:87], a[228:231], a[152:155], v[84:87]
    s_mul_i32 s59, s56, 24576
    ds_read_b64_tr_b16 a[246:247], v10 offset:43008
    s_add_u32 s56, s51, 2
    v_mfma_f32_16x16x32_bf16 v[84:87], a[224:227], a[136:139], v[84:87]
    buffer_load_dwordx4 v4, s[12:15], s38 offen offset:128 lds
    v_mfma_f32_16x16x32_bf16 v[76:79], a[224:227], a[132:135], v[76:79]
    s_add_u32 m0, s49, 26368
    v_cvt_pk_bf16_f32 v90, v92, v93
    v_cvt_pk_bf16_f32 v91, v94, v95
    v_mfma_f32_16x16x32_bf16 v[76:79], a[228:231], a[148:151], v[76:79]
    s_waitcnt lgkmcnt(4)
    v_permlane16_swap_b32 v88, v90
    v_mfma_f32_16x16x32_bf16 v[68:71], a[228:231], a[144:147], v[68:71]
    s_and_b32 s56, s56, 3
    v_permlane16_swap_b32 v89, v91
    v_mfma_f32_16x16x32_bf16 v[68:71], a[224:227], a[128:131], v[68:71]
    s_mul_i32 s46, s56, 245760
    ds_read_b64_tr_b16 a[224:225], v11 offset:0
    v_cvt_pk_bf16_f32 v74, v76, v77
    v_mfma_f32_16x16x32_bf16 v[96:99], a[232:235], a[96:99], v[96:99]
    s_lshl_b32 s56, s56, 5
    ds_read_b64_tr_b16 a[226:227], v11 offset:6144
    v_cvt_pk_bf16_f32 v75, v78, v79
    v_mfma_f32_16x16x32_bf16 v[96:99], a[236:239], a[112:115], v[96:99]
    s_add_u32 s56, s56, s54
    ds_read_b64_tr_b16 a[228:229], v11 offset:12288
    v_cvt_pk_bf16_f32 v66, v68, v69
    v_mfma_f32_16x16x32_bf16 v[104:107], a[236:239], a[116:119], v[104:107]
    buffer_load_dwordx4 v4, s[12:15], s38 offen offset:256 lds
    v_mfma_f32_16x16x32_bf16 v[104:107], a[232:235], a[100:103], v[104:107]
    s_add_u32 m0, s49, 27648
    ds_read_b64_tr_b16 a[230:231], v11 offset:18432
    v_cvt_pk_bf16_f32 v67, v70, v71
    v_mfma_f32_16x16x32_bf16 v[112:115], a[232:235], a[104:107], v[112:115]
    s_mul_i32 s60, s56, 24576
    v_permlane16_swap_b32 v64, v66
    v_mfma_f32_16x16x32_bf16 v[112:115], a[236:239], a[120:123], v[112:115]
    s_waitcnt lgkmcnt(4)
    v_permlane16_swap_b32 v65, v67
    v_mfma_f32_16x16x32_bf16 v[120:123], a[236:239], a[124:127], v[120:123]
    s_add_u32 s56, s51, 3
    v_permlane16_swap_b32 v72, v74
    v_mfma_f32_16x16x32_bf16 v[120:123], a[232:235], a[108:111], v[120:123]
    s_and_b32 s56, s56, 3
    ds_read_b64_tr_b16 a[232:233], v11 offset:24576
    v_cvt_pk_bf16_f32 v82, v84, v85
    v_mfma_f32_16x16x32_bf16 v[120:123], a[240:243], a[140:143], v[120:123]
    buffer_load_dwordx4 v5, s[12:15], s38 offen offset:0 lds
    v_mfma_f32_16x16x32_bf16 v[120:123], a[244:247], a[156:159], v[120:123]
    s_add_u32 m0, s49, 28544
    ds_read_b64_tr_b16 a[234:235], v11 offset:30720
    v_cvt_pk_bf16_f32 v83, v86, v87
    v_mfma_f32_16x16x32_bf16 v[112:115], a[244:247], a[152:155], v[112:115]
    s_mul_i32 s47, s56, 245760
    ds_read_b64_tr_b16 a[236:237], v11 offset:36864
    v_accvgpr_write_b32 a0, v64
    v_mfma_f32_16x16x32_bf16 v[112:115], a[240:243], a[136:139], v[112:115]
    s_lshl_b32 s56, s56, 5
    ds_read_b64_tr_b16 a[238:239], v11 offset:43008
    v_accvgpr_write_b32 a1, v65
    v_mfma_f32_16x16x32_bf16 v[104:107], a[240:243], a[132:135], v[104:107]
    s_add_u32 s56, s56, s54
    v_permlane16_swap_b32 v73, v75
    v_mfma_f32_16x16x32_bf16 v[104:107], a[244:247], a[148:151], v[104:107]
    s_waitcnt lgkmcnt(4)
    v_permlane16_swap_b32 v80, v82
    v_mfma_f32_16x16x32_bf16 v[96:99], a[244:247], a[144:147], v[96:99]
    s_mul_i32 s61, s56, 24576
    v_permlane16_swap_b32 v81, v83
    v_mfma_f32_16x16x32_bf16 v[96:99], a[240:243], a[128:131], v[96:99]
    buffer_load_dwordx4 v5, s[12:15], s38 offen offset:128 lds
    v_mfma_f32_16x16x32_bf16 v[100:103], a[224:227], a[96:99], v[100:103]
    s_add_u32 m0, s49, 29440
    ds_read_b64_tr_b16 a[240:241], v8 offset:1024
    v_accvgpr_write_b32 a2, v66
    v_mfma_f32_16x16x32_bf16 v[100:103], a[228:231], a[112:115], v[100:103]
    s_mov_b32 s72, s7
    ds_read_b64_tr_b16 a[242:243], v8 offset:7168
    v_accvgpr_write_b32 a3, v67
    v_mfma_f32_16x16x32_bf16 v[108:111], a[228:231], a[116:119], v[108:111]
    s_mov_b32 s73, s7
    ds_read_b64_tr_b16 a[244:245], v8 offset:13312
    v_accvgpr_write_b32 a4, v72
    v_mfma_f32_16x16x32_bf16 v[108:111], a[224:227], a[100:103], v[108:111]
    s_mov_b32 s74, s7
    ds_read_b64_tr_b16 a[246:247], v8 offset:19456
    v_accvgpr_write_b32 a5, v73
    v_mfma_f32_16x16x32_bf16 v[116:119], a[224:227], a[104:107], v[116:119]
    s_add_u32 s39, s40, 0
    v_accvgpr_write_b32 a6, v74
    v_accvgpr_write_b32 a7, v75
    v_mfma_f32_16x16x32_bf16 v[116:119], a[228:231], a[120:123], v[116:119]
    buffer_load_dwordx4 v5, s[12:15], s38 offen offset:256 lds
    v_mfma_f32_16x16x32_bf16 v[124:127], a[228:231], a[124:127], v[124:127]
    s_waitcnt lgkmcnt(4)
    v_accvgpr_write_b32 a8, v80
    v_accvgpr_write_b32 a9, v81
    v_mfma_f32_16x16x32_bf16 v[124:127], a[224:227], a[108:111], v[124:127]
    s_add_u32 s38, s38, 24576
    ds_read_b64_tr_b16 a[224:225], v8 offset:25600
    v_accvgpr_write_b32 a10, v82
    v_mfma_f32_16x16x32_bf16 v[124:127], a[232:235], a[140:143], v[124:127]
    s_add_u32 m0, s63, 73728
    ds_read_b64_tr_b16 a[226:227], v8 offset:31744
    v_accvgpr_write_b32 a11, v83
    v_mfma_f32_16x16x32_bf16 v[124:127], a[236:239], a[156:159], v[124:127]
    s_mov_b32 s75, s7
    ds_read_b64_tr_b16 a[228:229], v8 offset:37888
    v_accvgpr_write_b32 a12, v88
    v_mfma_f32_16x16x32_bf16 v[116:119], a[236:239], a[152:155], v[116:119]
    s_lshl_b32 s56, s50, 6
    ds_read_b64_tr_b16 a[230:231], v8 offset:44032
    v_accvgpr_write_b32 a13, v89
    v_mfma_f32_16x16x32_bf16 v[116:119], a[232:235], a[136:139], v[116:119]
    s_xor_b32 s56, s56, 192
    v_xor_b32 v2, s56, v7
    v_xor_b32 v3, 128, v2
    v_mfma_f32_16x16x32_bf16 v[108:111], a[232:235], a[132:135], v[108:111]
    buffer_load_dwordx4 v6, s[16:19], s39 offen lds
    v_mfma_f32_16x16x32_bf16 v[108:111], a[236:239], a[148:151], v[108:111]
    s_waitcnt lgkmcnt(4)
    v_accvgpr_write_b32 a14, v90
    v_accvgpr_write_b32 a15, v91
    v_mfma_f32_16x16x32_bf16 v[100:103], a[236:239], a[144:147], v[100:103]
    s_add_u32 s39, s40, 12288
    v_cvt_pk_bf16_f32 v96, v96, v97
    v_cvt_pk_bf16_f32 v97, v98, v99
    v_mfma_f32_16x16x32_bf16 v[100:103], a[232:235], a[128:131], v[100:103]
    s_add_u32 m0, s63, 77824
    ds_read_b64_tr_b16 a[232:233], v9 offset:1024
    v_cvt_pk_bf16_f32 v104, v104, v105
    v_mfma_f32_16x16x32_bf16 v[128:131], a[240:243], a[96:99], v[128:131]
    s_and_b32 s56, s51, 1
    ds_read_b64_tr_b16 a[234:235], v9 offset:7168
    v_cvt_pk_bf16_f32 v105, v106, v107
    v_mfma_f32_16x16x32_bf16 v[128:131], a[244:247], a[112:115], v[128:131]
    s_lshl_b32 s56, s56, 6
    ds_read_b64_tr_b16 a[236:237], v9 offset:13312
    v_cvt_pk_bf16_f32 v98, v100, v101
    v_mfma_f32_16x16x32_bf16 v[136:139], a[244:247], a[116:119], v[136:139]
    buffer_load_dwordx4 v6, s[16:19], s39 offen lds
    v_mfma_f32_16x16x32_bf16 v[136:139], a[240:243], a[100:103], v[136:139]
    s_add_u32 s39, s40, 24576
    ds_read_b64_tr_b16 a[238:239], v9 offset:19456
    v_cvt_pk_bf16_f32 v99, v102, v103
    v_mfma_f32_16x16x32_bf16 v[144:147], a[240:243], a[104:107], v[144:147]
    s_add_u32 m0, s63, 81920
    v_permlane16_swap_b32 v96, v98
    v_mfma_f32_16x16x32_bf16 v[144:147], a[244:247], a[120:123], v[144:147]
    s_waitcnt lgkmcnt(4)
    v_permlane16_swap_b32 v97, v99
    v_mfma_f32_16x16x32_bf16 v[152:155], a[244:247], a[124:127], v[152:155]
    s_mul_i32 s57, s3, 10240
    v_cvt_pk_bf16_f32 v106, v108, v109
    v_cvt_pk_bf16_f32 v107, v110, v111
    v_mfma_f32_16x16x32_bf16 v[152:155], a[240:243], a[108:111], v[152:155]
    s_add_u32 s56, s56, s57
    ds_read_b64_tr_b16 a[240:241], v9 offset:25600
    v_add_u32 v21, s56, v21
    v_mfma_f32_16x16x32_bf16 v[152:155], a[224:227], a[140:143], v[152:155]
    s_and_b32 s56, s51, 1
    ds_read_b64_tr_b16 a[242:243], v9 offset:31744
    v_add_u32 v2, v2, v21
    v_mfma_f32_16x16x32_bf16 v[152:155], a[228:231], a[156:159], v[152:155]
    buffer_load_dwordx4 v6, s[16:19], s39 offen lds
    v_mfma_f32_16x16x32_bf16 v[144:147], a[228:231], a[152:155], v[144:147]
    s_add_u32 s39, s40, 36864
    ds_read_b64_tr_b16 a[244:245], v9 offset:37888
    v_add_u32 v3, v3, v21
    v_mfma_f32_16x16x32_bf16 v[144:147], a[224:227], a[136:139], v[144:147]
    s_add_u32 m0, s63, 86016
    ds_read_b64_tr_b16 a[246:247], v9 offset:44032
    v_and_b32 v21, 3, v1
    v_mfma_f32_16x16x32_bf16 v[136:139], a[224:227], a[132:135], v[136:139]
    s_xor_b32 s56, s56, 1
    v_lshlrev_b32 v21, 4, v21
    v_xor_b32 v21, v21, v22
    v_mfma_f32_16x16x32_bf16 v[136:139], a[228:231], a[148:151], v[136:139]
    s_waitcnt lgkmcnt(4)
    v_lshrrev_b32 v22, 2, v1
    v_mul_u32_u24 v22, 1280, v22
    v_mfma_f32_16x16x32_bf16 v[128:131], a[228:231], a[144:147], v[128:131]
    s_lshl_b32 s56, s56, 8
    v_add_u32 v21, v21, v22
    v_min_u32 v22, 11, v1
    v_mfma_f32_16x16x32_bf16 v[128:131], a[224:227], a[128:131], v[128:131]
    buffer_load_dwordx4 v6, s[16:19], s39 offen lds
    v_mfma_f32_16x16x32_bf16 v[132:135], a[232:235], a[96:99], v[132:135]
    s_and_b32 s57, s3, 1
    ds_read_b64_tr_b16 a[224:225], v10 offset:1024
    v_lshlrev_b32 v22, 7, v22
    v_mfma_f32_16x16x32_bf16 v[132:135], a[236:239], a[112:115], v[132:135]
    s_mul_i32 s57, s57, 20480
    ds_read_b64_tr_b16 a[226:227], v10 offset:7168
    v_cvt_pk_bf16_f32 v112, v112, v113
    v_mfma_f32_16x16x32_bf16 v[140:143], a[236:239], a[116:119], v[140:143]
    s_add_u32 s56, s56, s57
    ds_read_b64_tr_b16 a[228:229], v10 offset:13312
    v_add_u32 v7, s56, v21
    v_mfma_f32_16x16x32_bf16 v[140:143], a[232:235], a[100:103], v[140:143]
    s_lshr_b32 s42, s2, 3
    ds_read_b64_tr_b16 a[230:231], v10 offset:19456
    v_mov_b32 v21, 0x3f803f80
    v_mfma_f32_16x16x32_bf16 v[148:151], a[232:235], a[104:107], v[148:151]
    s_lshl_b32 s42, s42, 2
    v_accvgpr_write_b32 a248, v21
    v_accvgpr_write_b32 a249, v21
    v_mfma_f32_16x16x32_bf16 v[148:151], a[236:239], a[120:123], v[148:151]
pg_4:
    s_cbranch_execz pg_8
    s_waitcnt lgkmcnt(4)
    v_accvgpr_write_b32 a250, v21
    v_accvgpr_write_b32 a251, v21
    v_mfma_f32_16x16x32_bf16 v[156:159], a[236:239], a[124:127], v[156:159]
    s_waitcnt vmcnt(14)
    v_permlane16_swap_b32 v104, v106
    v_mfma_f32_16x16x32_bf16 v[156:159], a[232:235], a[108:111], v[156:159]
    buffer_store_dword v26, v27, s[24:27], s4 offen offset:144 sc1
    v_mfma_f32_16x16x32_bf16 v[156:159], a[240:243], a[140:143], v[156:159]
    s_add_u32 s42, s42, s3
    ds_read_b64_tr_b16 a[232:233], v10 offset:25600
    v_cvt_pk_bf16_f32 v113, v114, v115
    v_mfma_f32_16x16x32_bf16 v[156:159], a[244:247], a[156:159], v[156:159]
    s_mul_i32 s42, s42, 7680
    ds_read_b64_tr_b16 a[234:235], v10 offset:31744
    v_cvt_pk_bf16_f32 v114, v116, v117
    v_mfma_f32_16x16x32_bf16 v[148:151], a[244:247], a[152:155], v[148:151]
    ds_read_b64_tr_b16 a[236:237], v10 offset:37888
    v_cvt_pk_bf16_f32 v115, v118, v119
    v_mfma_f32_16x16x32_bf16 v[148:151], a[240:243], a[136:139], v[148:151]
    ds_read_b64_tr_b16 a[238:239], v10 offset:44032
    v_accvgpr_write_b32 a16, v96
    v_mfma_f32_16x16x32_bf16 v[140:143], a[240:243], a[132:135], v[140:143]
    v_permlane16_swap_b32 v105, v107
    v_mfma_f32_16x16x32_bf16 v[140:143], a[244:247], a[148:151], v[140:143]
    s_waitcnt lgkmcnt(4)
    v_permlane16_swap_b32 v112, v114
    v_mfma_f32_16x16x32_bf16 v[132:135], a[244:247], a[144:147], v[132:135]
    v_permlane16_swap_b32 v113, v115
    v_mfma_f32_16x16x32_bf16 v[132:135], a[240:243], a[128:131], v[132:135]
    ds_read_b64_tr_b16 a[240:241], v11 offset:1024
    v_accvgpr_write_b32 a17, v97
    v_mfma_f32_16x16x32_bf16 v[160:163], a[224:227], a[96:99], v[160:163]
    ds_read_b64_tr_b16 a[242:243], v11 offset:7168
    v_accvgpr_write_b32 a18, v98
    v_mfma_f32_16x16x32_bf16 v[160:163], a[228:231], a[112:115], v[160:163]
    ds_read_b64_tr_b16 a[244:245], v11 offset:13312
    v_accvgpr_write_b32 a19, v99
    v_mfma_f32_16x16x32_bf16 v[168:171], a[228:231], a[116:119], v[168:171]
    ds_read_b64_tr_b16 a[246:247], v11 offset:19456
    v_cvt_pk_bf16_f32 v120, v120, v121
    v_mfma_f32_16x16x32_bf16 v[168:171], a[224:227], a[100:103], v[168:171]
    v_cvt_pk_bf16_f32 v121, v122, v123
    v_cvt_pk_bf16_f32 v122, v124, v125
    v_mfma_f32_16x16x32_bf16 v[176:179], a[224:227], a[104:107], v[176:179]
    v_cvt_pk_bf16_f32 v123, v126, v127
    v_accvgpr_write_b32 a20, v104
    v_mfma_f32_16x16x32_bf16 v[176:179], a[228:231], a[120:123], v[176:179]
    s_waitcnt lgkmcnt(4)
    v_permlane16_swap_b32 v120, v122
    v_mfma_f32_16x16x32_bf16 v[184:187], a[228:231], a[124:127], v[184:187]
    v_permlane16_swap_b32 v121, v123
    v_mfma_f32_16x16x32_bf16 v[184:187], a[224:227], a[108:111], v[184:187]
    ds_read_b64_tr_b16 a[224:225], v11 offset:25600
    v_accvgpr_write_b32 a21, v105
    v_mfma_f32_16x16x32_bf16 v[184:187], a[232:235], a[140:143], v[184:187]
    ds_read_b64_tr_b16 a[226:227], v11 offset:31744
    v_accvgpr_write_b32 a22, v106
    v_mfma_f32_16x16x32_bf16 v[184:187], a[236:239], a[156:159], v[184:187]
    ds_read_b64_tr_b16 a[228:229], v11 offset:37888
    v_accvgpr_write_b32 a23, v107
    v_mfma_f32_16x16x32_bf16 v[176:179], a[236:239], a[152:155], v[176:179]
    ds_read_b64_tr_b16 a[230:231], v11 offset:44032
    v_accvgpr_write_b32 a24, v112
    v_mfma_f32_16x16x32_bf16 v[176:179], a[232:235], a[136:139], v[176:179]
    v_accvgpr_write_b32 a25, v113
    v_accvgpr_write_b32 a26, v114
    v_mfma_f32_16x16x32_bf16 v[168:171], a[232:235], a[132:135], v[168:171]
    v_accvgpr_write_b32 a27, v115
    v_accvgpr_write_b32 a28, v120
    v_mfma_f32_16x16x32_bf16 v[168:171], a[236:239], a[148:151], v[168:171]
    s_waitcnt lgkmcnt(4)
    v_accvgpr_write_b32 a29, v121
    v_accvgpr_write_b32 a30, v122
    v_mfma_f32_16x16x32_bf16 v[160:163], a[236:239], a[144:147], v[160:163]
    v_accvgpr_write_b32 a31, v123
    v_cvt_pk_bf16_f32 v128, v128, v129
    v_mfma_f32_16x16x32_bf16 v[160:163], a[232:235], a[128:131], v[160:163]
    ds_read_b64_tr_b16 a[232:233], v8 offset:2048
    v_cvt_pk_bf16_f32 v129, v130, v131
    v_mfma_f32_16x16x32_bf16 v[164:167], a[240:243], a[96:99], v[164:167]
    ds_read_b64_tr_b16 a[234:235], v8 offset:8192
    v_cvt_pk_bf16_f32 v130, v132, v133
    v_mfma_f32_16x16x32_bf16 v[164:167], a[244:247], a[112:115], v[164:167]
    ds_read_b64_tr_b16 a[236:237], v8 offset:14336
    v_cvt_pk_bf16_f32 v131, v134, v135
    v_mfma_f32_16x16x32_bf16 v[172:175], a[244:247], a[116:119], v[172:175]
    ds_read_b64_tr_b16 a[238:239], v8 offset:20480
    v_cvt_pk_bf16_f32 v136, v136, v137
    v_mfma_f32_16x16x32_bf16 v[172:175], a[240:243], a[100:103], v[172:175]
    v_permlane16_swap_b32 v128, v130
    v_mfma_f32_16x16x32_bf16 v[180:183], a[240:243], a[104:107], v[180:183]
    v_permlane16_swap_b32 v129, v131
    v_mfma_f32_16x16x32_bf16 v[180:183], a[244:247], a[120:123], v[180:183]
    s_waitcnt lgkmcnt(4)
    v_cvt_pk_bf16_f32 v137, v138, v139
    v_cvt_pk_bf16_f32 v138, v140, v141
    v_mfma_f32_16x16x32_bf16 v[188:191], a[244:247], a[124:127], v[188:191]
    v_cvt_pk_bf16_f32 v139, v142, v143
    v_cvt_pk_bf16_f32 v144, v144, v145
    v_mfma_f32_16x16x32_bf16 v[188:191], a[240:243], a[108:111], v[188:191]
    ds_read_b64_tr_b16 a[240:241], v8 offset:26624
    v_cvt_pk_bf16_f32 v145, v146, v147
    v_mfma_f32_16x16x32_bf16 v[188:191], a[224:227], a[140:143], v[188:191]
    ds_read_b64_tr_b16 a[242:243], v8 offset:32768
    v_cvt_pk_bf16_f32 v146, v148, v149
    v_mfma_f32_16x16x32_bf16 v[188:191], a[228:231], a[156:159], v[188:191]
    ds_read_b64_tr_b16 a[244:245], v8 offset:38912
    v_cvt_pk_bf16_f32 v147, v150, v151
    v_mfma_f32_16x16x32_bf16 v[180:183], a[228:231], a[152:155], v[180:183]
    ds_read_b64_tr_b16 a[246:247], v8 offset:45056
    v_accvgpr_write_b32 a32, v128
    v_mfma_f32_16x16x32_bf16 v[180:183], a[224:227], a[136:139], v[180:183]
    v_permlane16_swap_b32 v136, v138
    v_mfma_f32_16x16x32_bf16 v[172:175], a[224:227], a[132:135], v[172:175]
    s_add_u32 s88, s88, code_end-code0-65536
    s_addc_u32 s89, s89, 0
    v_accvgpr_write_b32 a33, v129
    v_mfma_f32_16x16x32_bf16 v[172:175], a[228:231], a[148:151], v[172:175]
    s_waitcnt lgkmcnt(4)
    v_permlane16_swap_b32 v137, v139
    v_mfma_f32_16x16x32_bf16 v[164:167], a[228:231], a[144:147], v[164:167]
    v_permlane16_swap_b32 v144, v146
    v_mfma_f32_16x16x32_bf16 v[164:167], a[224:227], a[128:131], v[164:167]
    ds_read_b64_tr_b16 a[224:225], v9 offset:2048
    v_accvgpr_write_b32 a34, v130
    v_mfma_f32_16x16x32_bf16 v[192:195], a[232:235], a[96:99], v[192:195]
    global_load_dword a252, v18, s[88:89]
    v_mfma_f32_16x16x32_bf16 v[192:195], a[236:239], a[112:115], v[192:195]
    ds_read_b64_tr_b16 a[226:227], v9 offset:8192
    v_accvgpr_write_b32 a35, v131
    v_mfma_f32_16x16x32_bf16 v[200:203], a[236:239], a[116:119], v[200:203]
    ds_read_b64_tr_b16 a[228:229], v9 offset:14336
    v_cvt_pk_bf16_f32 v152, v152, v153
    v_mfma_f32_16x16x32_bf16 v[200:203], a[232:235], a[100:103], v[200:203]
    ds_read_b64_tr_b16 a[230:231], v9 offset:20480
    v_cvt_pk_bf16_f32 v153, v154, v155
    v_mfma_f32_16x16x32_bf16 v[208:211], a[232:235], a[104:107], v[208:211]
    v_permlane16_swap_b32 v145, v147
    v_mfma_f32_16x16x32_bf16 v[208:211], a[236:239], a[120:123], v[208:211]
    s_waitcnt lgkmcnt(4)
    v_cvt_pk_bf16_f32 v154, v156, v157
    v_cvt_pk_bf16_f32 v155, v158, v159
    v_mfma_f32_16x16x32_bf16 v[216:219], a[236:239], a[124:127], v[216:219]
    v_permlane16_swap_b32 v152, v154
    v_mfma_f32_16x16x32_bf16 v[216:219], a[232:235], a[108:111], v[216:219]
    ds_read_b64_tr_b16 a[232:233], v9 offset:26624
    v_accvgpr_write_b32 a36, v136
    v_mfma_f32_16x16x32_bf16 v[216:219], a[240:243], a[140:143], v[216:219]
    ds_read_b64_tr_b16 a[234:235], v9 offset:32768
    v_accvgpr_write_b32 a37, v137
    v_mfma_f32_16x16x32_bf16 v[216:219], a[244:247], a[156:159], v[216:219]
    ds_read_b64_tr_b16 a[236:237], v9 offset:38912
    v_accvgpr_write_b32 a38, v138
    v_mfma_f32_16x16x32_bf16 v[208:211], a[244:247], a[152:155], v[208:211]
    ds_read_b64_tr_b16 a[238:239], v9 offset:45056
    v_accvgpr_write_b32 a39, v139
    v_mfma_f32_16x16x32_bf16 v[208:211], a[240:243], a[136:139], v[208:211]
    v_permlane16_swap_b32 v153, v155
    v_mfma_f32_16x16x32_bf16 v[200:203], a[240:243], a[132:135], v[200:203]
    v_accvgpr_write_b32 a40, v144
    v_accvgpr_write_b32 a41, v145
    v_mfma_f32_16x16x32_bf16 v[200:203], a[244:247], a[148:151], v[200:203]
    s_waitcnt lgkmcnt(4)
    v_accvgpr_write_b32 a42, v146
    v_accvgpr_write_b32 a43, v147
    v_mfma_f32_16x16x32_bf16 v[192:195], a[244:247], a[144:147], v[192:195]
    v_accvgpr_write_b32 a44, v152
    v_accvgpr_write_b32 a45, v153
    v_mfma_f32_16x16x32_bf16 v[192:195], a[240:243], a[128:131], v[192:195]
    ds_read_b64_tr_b16 a[240:241], v10 offset:2048
    v_accvgpr_write_b32 a46, v154
    v_mfma_f32_16x16x32_bf16 v[196:199], a[224:227], a[96:99], v[196:199]
    ds_read_b64_tr_b16 a[242:243], v10 offset:8192
    v_accvgpr_write_b32 a47, v155
    v_mfma_f32_16x16x32_bf16 v[196:199], a[228:231], a[112:115], v[196:199]
    ds_read_b64_tr_b16 a[244:245], v10 offset:14336
    v_cvt_pk_bf16_f32 v160, v160, v161
    v_mfma_f32_16x16x32_bf16 v[204:207], a[228:231], a[116:119], v[204:207]
    ds_read_b64_tr_b16 a[246:247], v10 offset:20480
    v_cvt_pk_bf16_f32 v161, v162, v163
    v_mfma_f32_16x16x32_bf16 v[204:207], a[224:227], a[100:103], v[204:207]
    v_cvt_pk_bf16_f32 v162, v164, v165
    v_cvt_pk_bf16_f32 v163, v166, v167
    v_mfma_f32_16x16x32_bf16 v[212:215], a[224:227], a[104:107], v[212:215]
    v_permlane16_swap_b32 v160, v162
    v_mfma_f32_16x16x32_bf16 v[212:215], a[228:231], a[120:123], v[212:215]
    s_waitcnt lgkmcnt(4)
    v_permlane16_swap_b32 v161, v163
    v_mfma_f32_16x16x32_bf16 v[220:223], a[228:231], a[124:127], v[220:223]
    v_cvt_pk_bf16_f32 v168, v168, v169
    v_cvt_pk_bf16_f32 v169, v170, v171
    v_mfma_f32_16x16x32_bf16 v[220:223], a[224:227], a[108:111], v[220:223]
    ds_read_b64_tr_b16 a[224:225], v10 offset:26624
    v_cvt_pk_bf16_f32 v170, v172, v173
    v_mfma_f32_16x16x32_bf16 v[220:223], a[232:235], a[140:143], v[220:223]
    ds_read_b64_tr_b16 a[226:227], v10 offset:32768
    v_cvt_pk_bf16_f32 v171, v174, v175
    v_mfma_f32_16x16x32_bf16 v[220:223], a[236:239], a[156:159], v[220:223]
    ds_read_b64_tr_b16 a[228:229], v10 offset:38912
    v_cvt_pk_bf16_f32 v176, v176, v177
    v_mfma_f32_16x16x32_bf16 v[212:215], a[236:239], a[152:155], v[212:215]
    ds_read_b64_tr_b16 a[230:231], v10 offset:45056
    v_cvt_pk_bf16_f32 v177, v178, v179
    v_mfma_f32_16x16x32_bf16 v[212:215], a[232:235], a[136:139], v[212:215]
    v_permlane16_swap_b32 v168, v170
    v_mfma_f32_16x16x32_bf16 v[204:207], a[232:235], a[132:135], v[204:207]
    v_permlane16_swap_b32 v169, v171
    v_mfma_f32_16x16x32_bf16 v[204:207], a[236:239], a[148:151], v[204:207]
    s_waitcnt lgkmcnt(4)
    v_cvt_pk_bf16_f32 v178, v180, v181
    v_cvt_pk_bf16_f32 v179, v182, v183
    v_mfma_f32_16x16x32_bf16 v[196:199], a[236:239], a[144:147], v[196:199]
    v_permlane16_swap_b32 v176, v178
    v_mfma_f32_16x16x32_bf16 v[196:199], a[232:235], a[128:131], v[196:199]
    ds_read_b64_tr_b16 a[232:233], v11 offset:2048
    v_accvgpr_write_b32 a48, v160
    ds_read_b64_tr_b16 a[234:235], v11 offset:8192
    v_mfma_f32_16x16x32_bf16 v[224:227], a[240:243], a[96:99], v[224:227]
    ds_read_b64_tr_b16 a[236:237], v11 offset:14336
    v_accvgpr_write_b32 a49, v161
    ds_read_b64_tr_b16 a[238:239], v11 offset:20480
    v_mfma_f32_16x16x32_bf16 v[224:227], a[244:247], a[112:115], v[224:227]
    v_permlane16_swap_b32 v177, v179
    v_mfma_f32_16x16x32_bf16 v[232:235], a[244:247], a[116:119], v[232:235]
    v_accvgpr_write_b32 a50, v162
    v_accvgpr_write_b32 a51, v163
    v_mfma_f32_16x16x32_bf16 v[232:235], a[240:243], a[100:103], v[232:235]
    v_cvt_pk_bf16_f32 v184, v184, v185
    v_cvt_pk_bf16_f32 v185, v186, v187
    v_mfma_f32_16x16x32_bf16 v[240:243], a[240:243], a[104:107], v[240:243]
    v_cvt_pk_bf16_f32 v186, v188, v189
    v_cvt_pk_bf16_f32 v187, v190, v191
    v_mfma_f32_16x16x32_bf16 v[240:243], a[244:247], a[120:123], v[240:243]
    s_waitcnt lgkmcnt(4)
    v_permlane16_swap_b32 v184, v186
    v_mfma_f32_16x16x32_bf16 v[248:251], a[244:247], a[124:127], v[248:251]
    s_waitcnt vmcnt(12) lgkmcnt(0)
    s_barrier
    v_mfma_f32_16x16x32_bf16 v[248:251], a[240:243], a[108:111], v[248:251]
    s_add_u32 m0, s49, 49152
    ds_read_b128 a[184:187], v12 offset:0
    v_accvgpr_write_b32 a52, v168
    v_mfma_f32_16x16x32_bf16 v[248:251], a[224:227], a[140:143], v[248:251]
    ds_read_b128 a[188:191], v13 offset:0
    v_accvgpr_write_b32 a53, v169
    v_mfma_f32_16x16x32_bf16 v[248:251], a[228:231], a[156:159], v[248:251]
    ds_read_b128 a[192:195], v12 offset:1024
    v_accvgpr_write_b32 a54, v170
    v_mfma_f32_16x16x32_bf16 v[240:243], a[228:231], a[152:155], v[240:243]
    ds_read_b128 a[196:199], v13 offset:1024
    v_accvgpr_write_b32 a55, v171
    v_mfma_f32_16x16x32_bf16 v[240:243], a[224:227], a[136:139], v[240:243]
    ds_read_b128 a[200:203], v12 offset:2048
    v_accvgpr_write_b32 a56, v176
    v_mfma_f32_16x16x32_bf16 v[232:235], a[224:227], a[132:135], v[232:235]
    buffer_load_dwordx4 v4, s[12:15], s38 offen offset:0 lds
    v_mfma_f32_16x16x32_bf16 v[232:235], a[228:231], a[148:151], v[232:235]
    ds_read_b64_tr_b16 a[240:241], v11 offset:26624
    v_accvgpr_write_b32 a57, v177
    v_mfma_f32_16x16x32_bf16 v[224:227], a[228:231], a[144:147], v[224:227]
    ds_read_b64_tr_b16 a[242:243], v11 offset:32768
    v_accvgpr_write_b32 a58, v178
    v_mfma_f32_16x16x32_bf16 v[224:227], a[224:227], a[128:131], v[224:227]
    ds_read_b64_tr_b16 a[244:245], v11 offset:38912
    v_accvgpr_write_b32 a59, v179
    v_mfma_f32_16x16x32_bf16 v[228:231], a[232:235], a[96:99], v[228:231]
    ds_read_b64_tr_b16 a[246:247], v11 offset:45056
    v_accvgpr_write_b32 a60, v184
    v_mfma_f32_16x16x32_bf16 v[228:231], a[236:239], a[112:115], v[228:231]
    v_permlane16_swap_b32 v185, v187
    v_mfma_f32_16x16x32_bf16 v[236:239], a[236:239], a[116:119], v[236:239]
    s_add_u32 m0, s49, 50048
    v_accvgpr_write_b32 a61, v185
    v_accvgpr_write_b32 a62, v186
    v_mfma_f32_16x16x32_bf16 v[236:239], a[232:235], a[100:103], v[236:239]
    v_accvgpr_write_b32 a63, v187
    v_cvt_pk_bf16_f32 v192, v192, v193
    v_mfma_f32_16x16x32_bf16 v[244:247], a[232:235], a[104:107], v[244:247]
    v_cvt_pk_bf16_f32 v193, v194, v195
    v_cvt_pk_bf16_f32 v194, v196, v197
    v_mfma_f32_16x16x32_bf16 v[244:247], a[236:239], a[120:123], v[244:247]
    s_waitcnt lgkmcnt(2)
    v_permlane16_swap_b32 v192, v194
    v_mfma_f32_16x16x32_bf16 v[252:255], a[236:239], a[124:127], v[252:255]
    ds_read_b128 a[204:207], v13 offset:2048
    v_cvt_pk_bf16_f32 v195, v198, v199
    v_mfma_f32_16x16x32_bf16 v[252:255], a[232:235], a[108:111], v[252:255]
    s_waitcnt lgkmcnt(1)
    v_permlane16_swap_b32 v193, v195
    v_mfma_f32_16x16x32_bf16 v[252:255], a[240:243], a[140:143], v[252:255]
    buffer_load_dwordx4 v4, s[12:15], s38 offen offset:128 lds
    v_mfma_f32_16x16x32_bf16 v[252:255], a[244:247], a[156:159], v[252:255]
    v_cvt_pk_bf16_f32 v200, v200, v201
    v_cvt_pk_bf16_f32 v201, v202, v203
    v_mfma_f32_16x16x32_bf16 v[244:247], a[244:247], a[152:155], v[244:247]
    ds_read_b128 a[208:211], v12 offset:6144
    v_cvt_pk_bf16_f32 v202, v204, v205
    v_mfma_f32_16x16x32_bf16 v[244:247], a[240:243], a[136:139], v[244:247]
    ds_read_b128 a[212:215], v13 offset:6144
    v_cvt_pk_bf16_f32 v203, v206, v207
    v_mfma_f32_16x16x32_bf16 v[236:239], a[240:243], a[132:135], v[236:239]
    ds_read_b128 a[216:219], v12 offset:7168
    v_cvt_pk_bf16_f32 v208, v208, v209
    v_mfma_f32_16x16x32_bf16 v[236:239], a[244:247], a[148:151], v[236:239]
    ds_read_b128 a[220:223], v13 offset:7168
    v_cvt_pk_bf16_f32 v209, v210, v211
    v_mfma_f32_16x16x32_bf16 v[228:231], a[244:247], a[144:147], v[228:231]
    s_add_u32 m0, s49, 50944
    ds_read_b128 a[224:227], v12 offset:8192
    v_cvt_pk_bf16_f32 v210, v212, v213
    v_mfma_f32_16x16x32_bf16 v[228:231], a[240:243], a[128:131], v[228:231]
    ds_read_b128 a[228:231], v13 offset:8192
    v_cvt_pk_bf16_f32 v211, v214, v215
    v_mfma_f32_16x16x32_bf16 v[64:67], a[184:187], a[0:3], 0
    v_permlane16_swap_b32 v200, v202
    v_mfma_f32_16x16x32_bf16 v[64:67], a[188:191], a[16:19], v[64:67]
    v_permlane16_swap_b32 v201, v203
    v_mfma_f32_16x16x32_bf16 v[64:67], a[192:195], a[32:35], v[64:67]
    v_permlane16_swap_b32 v208, v210
    v_mfma_f32_16x16x32_bf16 v[64:67], a[196:199], a[48:51], v[64:67]
    v_permlane16_swap_b32 v209, v211
    v_accvgpr_write_b32 a64, v192
    v_accvgpr_write_b32 a65, v193
    v_accvgpr_write_b32 a66, v194
    v_accvgpr_write_b32 a67, v195
    s_nop 1
    v_mfma_f32_16x16x32_bf16 v[64:67], a[200:203], a[64:67], v[64:67]
    buffer_load_dwordx4 v4, s[12:15], s38 offen offset:256 lds
    v_accvgpr_write_b32 a68, v200
    v_accvgpr_write_b32 a69, v201
    v_accvgpr_write_b32 a70, v202
    v_accvgpr_write_b32 a71, v203
    s_nop 1
    v_mfma_f32_16x16x32_bf16 v[72:75], a[200:203], a[68:71], 0
    v_cvt_pk_bf16_f32 v216, v216, v217
    v_cvt_pk_bf16_f32 v217, v218, v219
    v_mfma_f32_16x16x32_bf16 v[72:75], a[196:199], a[52:55], v[72:75]
    v_cvt_pk_bf16_f32 v218, v220, v221
    v_cvt_pk_bf16_f32 v219, v222, v223
    v_mfma_f32_16x16x32_bf16 v[72:75], a[192:195], a[36:39], v[72:75]
    v_permlane16_swap_b32 v216, v218
    v_mfma_f32_16x16x32_bf16 v[72:75], a[188:191], a[20:23], v[72:75]
    v_permlane16_swap_b32 v217, v219
    v_mfma_f32_16x16x32_bf16 v[72:75], a[184:187], a[4:7], v[72:75]
    v_accvgpr_write_b32 a72, v208
    v_accvgpr_write_b32 a73, v209
    v_mfma_f32_16x16x32_bf16 v[80:83], a[184:187], a[8:11], 0
    s_add_u32 m0, s49, 52224
    v_accvgpr_write_b32 a74, v210
    v_accvgpr_write_b32 a75, v211
    v_mfma_f32_16x16x32_bf16 v[80:83], a[188:191], a[24:27], v[80:83]
    v_accvgpr_write_b32 a76, v216
    v_accvgpr_write_b32 a77, v217
    v_mfma_f32_16x16x32_bf16 v[80:83], a[192:195], a[40:43], v[80:83]
    v_accvgpr_write_b32 a78, v218
    v_accvgpr_write_b32 a79, v219
    v_mfma_f32_16x16x32_bf16 v[80:83], a[196:199], a[56:59], v[80:83]
    v_cvt_pk_bf16_f32 v224, v224, v225
    v_cvt_pk_bf16_f32 v225, v226, v227
    v_mfma_f32_16x16x32_bf16 v[80:83], a[200:203], a[72:75], v[80:83]
    v_cvt_pk_bf16_f32 v226, v228, v229
    v_cvt_pk_bf16_f32 v227, v230, v231
    v_mfma_f32_16x16x32_bf16 v[88:91], a[200:203], a[76:79], 0
    v_permlane16_swap_b32 v224, v226
    v_mfma_f32_16x16x32_bf16 v[88:91], a[196:199], a[60:63], v[88:91]
    buffer_load_dwordx4 v5, s[12:15], s38 offen offset:0 lds
    v_mfma_f32_16x16x32_bf16 v[88:91], a[192:195], a[44:47], v[88:91]
    s_waitcnt lgkmcnt(0)
    v_permlane16_swap_b32 v225, v227
    v_mfma_f32_16x16x32_bf16 v[88:91], a[188:191], a[28:31], v[88:91]
    v_cvt_pk_bf16_f32 v232, v232, v233
    v_cvt_pk_bf16_f32 v233, v234, v235
    v_mfma_f32_16x16x32_bf16 v[88:91], a[184:187], a[12:15], v[88:91]
    ds_read_b128 a[184:187], v12 offset:12288
    v_cvt_pk_bf16_f32 v234, v236, v237
    v_cvt_pk_bf16_f32 v235, v238, v239
    v_cvt_pk_bf16_f32 v240, v240, v241
    v_mfma_f32_16x16x32_bf16 v[64:67], a[204:207], v[224:227], v[64:67]
    ds_read_b128 a[188:191], v13 offset:12288
    v_cvt_pk_bf16_f32 v241, v242, v243
    v_permlane16_swap_b32 v232, v234
    v_permlane16_swap_b32 v233, v235
    s_nop 1
    v_mfma_f32_16x16x32_bf16 v[72:75], a[204:207], v[232:235], v[72:75]
    ds_read_b128 a[192:195], v12 offset:13312
    v_cvt_pk_bf16_f32 v242, v244, v245
    v_cvt_pk_bf16_f32 v243, v246, v247
    v_cvt_pk_bf16_f32 v248, v248, v249
    v_permlane16_swap_b32 v240, v242
    v_permlane16_swap_b32 v241, v243
    s_nop 1
    v_mfma_f32_16x16x32_bf16 v[80:83], a[204:207], v[240:243], v[80:83]
    s_add_u32 m0, s49, 53120
    ds_read_b128 a[196:199], v13 offset:13312
    v_cvt_pk_bf16_f32 v249, v250, v251
    v_cvt_pk_bf16_f32 v250, v252, v253
    v_cvt_pk_bf16_f32 v251, v254, v255
    v_accvgpr_write_b32 a80, v224
    v_permlane16_swap_b32 v248, v250
    v_permlane16_swap_b32 v249, v251
    s_nop 1
    v_mfma_f32_16x16x32_bf16 v[88:91], a[204:207], v[248:251], v[88:91]
    ds_read_b128 a[200:203], v12 offset:14336
    v_accvgpr_write_b32 a81, v225
    v_mfma_f32_16x16x32_bf16 v[24:27], a[208:211], a[0:3], 0
    ds_read_b128 a[204:207], v13 offset:14336
    v_accvgpr_write_b32 a82, v226
    v_mfma_f32_16x16x32_bf16 v[24:27], a[212:215], a[16:19], v[24:27]
    v_exp_f32 v64, v64
    v_mfma_f32_16x16x32_bf16 v[24:27], a[216:219], a[32:35], v[24:27]
    v_exp_f32 v65, v65
    v_mfma_f32_16x16x32_bf16 v[24:27], a[220:223], a[48:51], v[24:27]
    v_exp_f32 v66, v66
    v_mfma_f32_16x16x32_bf16 v[24:27], a[224:227], a[64:67], v[24:27]
    buffer_load_dwordx4 v5, s[12:15], s38 offen offset:128 lds
    v_accvgpr_write_b32 a83, v227
    s_nop 1
    v_mfma_f32_16x16x32_bf16 v[24:27], a[228:231], a[80:83], v[24:27]
    v_exp_f32 v67, v67
    v_accvgpr_write_b32 a84, v232
    v_accvgpr_write_b32 a85, v233
    v_accvgpr_write_b32 a86, v234
    v_accvgpr_write_b32 a87, v235
    s_nop 1
    v_mfma_f32_16x16x32_bf16 v[28:31], a[228:231], a[84:87], 0
    v_exp_f32 v72, v72
    v_mfma_f32_16x16x32_bf16 v[28:31], a[224:227], a[68:71], v[28:31]
    v_exp_f32 v73, v73
    v_mfma_f32_16x16x32_bf16 v[28:31], a[220:223], a[52:55], v[28:31]
    v_exp_f32 v74, v74
    v_mfma_f32_16x16x32_bf16 v[28:31], a[216:219], a[36:39], v[28:31]
    v_exp_f32 v75, v75
    v_mfma_f32_16x16x32_bf16 v[28:31], a[212:215], a[20:23], v[28:31]
    s_add_u32 m0, s49, 54016
    v_exp_f32 v80, v80
    v_mfma_f32_16x16x32_bf16 v[28:31], a[208:211], a[4:7], v[28:31]
    v_exp_f32 v81, v81
    v_mfma_f32_16x16x32_bf16 v[32:35], a[208:211], a[8:11], 0
    v_exp_f32 v82, v82
    v_mfma_f32_16x16x32_bf16 v[32:35], a[212:215], a[24:27], v[32:35]
    v_exp_f32 v83, v83
    v_mfma_f32_16x16x32_bf16 v[32:35], a[216:219], a[40:43], v[32:35]
    v_exp_f32 v88, v88
    v_mfma_f32_16x16x32_bf16 v[32:35], a[220:223], a[56:59], v[32:35]
    v_exp_f32 v89, v89
    v_mfma_f32_16x16x32_bf16 v[32:35], a[224:227], a[72:75], v[32:35]
    buffer_load_dwordx4 v5, s[12:15], s38 offen offset:256 lds
    v_accvgpr_write_b32 a88, v240
    v_accvgpr_write_b32 a89, v241
    v_accvgpr_write_b32 a90, v242
    v_accvgpr_write_b32 a91, v243
    s_nop 1
    v_mfma_f32_16x16x32_bf16 v[32:35], a[228:231], a[88:91], v[32:35]
    s_add_u32 s38, s38, 24576
    v_exp_f32 v90, v90
    v_accvgpr_write_b32 a92, v248
    v_accvgpr_write_b32 a93, v249
    v_accvgpr_write_b32 a94, v250
    v_accvgpr_write_b32 a95, v251
    s_nop 1
    v_mfma_f32_16x16x32_bf16 v[36:39], a[228:231], a[92:95], 0
    v_exp_f32 v91, v91
    v_mfma_f32_16x16x32_bf16 v[36:39], a[224:227], a[76:79], v[36:39]
    v_cvt_pk_bf16_f32 v64, v64, v65
    v_cvt_pk_bf16_f32 v65, v66, v67
    v_mfma_f32_16x16x32_bf16 v[36:39], a[220:223], a[60:63], v[36:39]
    s_add_u32 s39, s40, 49152
    v_exp_f32 v24, v24
    v_mfma_f32_16x16x32_bf16 v[36:39], a[216:219], a[44:47], v[36:39]
    s_waitcnt lgkmcnt(0)
    v_exp_f32 v25, v25
    v_mfma_f32_16x16x32_bf16 v[36:39], a[212:215], a[28:31], v[36:39]
    s_add_u32 m0, s63, 90112
    ds_read_b128 a[212:215], v13 offset:18432
    v_cvt_pk_bf16_f32 v72, v72, v73
    v_mfma_f32_16x16x32_bf16 v[36:39], a[208:211], a[12:15], v[36:39]
    ds_read_b128 a[220:223], v13 offset:19456
    v_cvt_pk_bf16_f32 v73, v74, v75
    v_mfma_f32_16x16x32_bf16 v[68:71], a[184:187], a[0:3], 0
    ds_read_b128 a[208:211], v12 offset:18432
    v_cvt_pk_bf16_f32 v80, v80, v81
    v_mfma_f32_16x16x32_bf16 v[68:71], a[188:191], a[16:19], v[68:71]
    ds_read_b128 a[216:219], v12 offset:19456
    v_cvt_pk_bf16_f32 v81, v82, v83
    v_mfma_f32_16x16x32_bf16 v[68:71], a[192:195], a[32:35], v[68:71]
    ds_read_b128 a[224:227], v12 offset:20480
    v_cvt_pk_bf16_f32 v88, v88, v89
    v_mfma_f32_16x16x32_bf16 v[68:71], a[196:199], a[48:51], v[68:71]
    ds_read_b128 a[228:231], v13 offset:20480
    v_cvt_pk_bf16_f32 v89, v90, v91
    v_mfma_f32_16x16x32_bf16 v[68:71], a[200:203], a[64:67], v[68:71]
    buffer_load_dwordx4 v6, s[16:19], s39 offen lds
    v_mfma_f32_16x16x32_bf16 v[68:71], a[204:207], a[80:83], v[68:71]
    v_exp_f32 v26, v26
    v_mfma_f32_16x16x32_bf16 v[76:79], a[204:207], a[84:87], 0
    v_exp_f32 v27, v27
    v_mfma_f32_16x16x32_bf16 v[76:79], a[200:203], a[68:71], v[76:79]
    v_exp_f32 v28, v28
    v_mfma_f32_16x16x32_bf16 v[76:79], a[196:199], a[52:55], v[76:79]
    s_add_u32 s39, s40, 61440
    v_exp_f32 v29, v29
    v_mfma_f32_16x16x32_bf16 v[76:79], a[192:195], a[36:39], v[76:79]
    v_exp_f32 v30, v30
    v_mfma_f32_16x16x32_bf16 v[76:79], a[188:191], a[20:23], v[76:79]
    s_add_u32 m0, s63, 94208
    v_exp_f32 v31, v31
    v_mfma_f32_16x16x32_bf16 v[76:79], a[184:187], a[4:7], v[76:79]
    v_cvt_pk_bf16_f32 v66, v24, v25
    v_cvt_pk_bf16_f32 v67, v26, v27
    v_mfma_f32_16x16x32_bf16 v[84:87], a[184:187], a[8:11], 0
    v_exp_f32 v32, v32
    v_mfma_f32_16x16x32_bf16 v[84:87], a[188:191], a[24:27], v[84:87]
    v_exp_f32 v33, v33
    v_mfma_f32_16x16x32_bf16 v[84:87], a[192:195], a[40:43], v[84:87]
    v_exp_f32 v34, v34
    v_mfma_f32_16x16x32_bf16 v[84:87], a[196:199], a[56:59], v[84:87]
    v_exp_f32 v35, v35
    v_mfma_f32_16x16x32_bf16 v[84:87], a[200:203], a[72:75], v[84:87]
    buffer_load_dwordx4 v6, s[16:19], s39 offen lds
    v_mfma_f32_16x16x32_bf16 v[84:87], a[204:207], a[88:91], v[84:87]
    v_cvt_pk_bf16_f32 v74, v28, v29
    v_cvt_pk_bf16_f32 v75, v30, v31
    v_mfma_f32_16x16x32_bf16 v[92:95], a[204:207], a[92:95], 0
    v_exp_f32 v36, v36
    v_mfma_f32_16x16x32_bf16 v[92:95], a[200:203], a[76:79], v[92:95]
    v_exp_f32 v37, v37
    v_mfma_f32_16x16x32_bf16 v[92:95], a[196:199], a[60:63], v[92:95]
    v_exp_f32 v38, v38
    v_mfma_f32_16x16x32_bf16 v[92:95], a[192:195], a[44:47], v[92:95]
    s_waitcnt lgkmcnt(0)
    v_exp_f32 v39, v39
    v_mfma_f32_16x16x32_bf16 v[92:95], a[188:191], a[28:31], v[92:95]
    s_add_u32 m0, s49, 0
    v_add_u32 v8, v19, v8
    v_add_u32 v9, v19, v9
    v_mfma_f32_16x16x32_bf16 v[92:95], a[184:187], a[12:15], v[92:95]
    v_add_u32 v10, v19, v10
    v_add_u32 v11, v19, v11
    v_mfma_f32_16x16x32_bf16 v[40:43], a[208:211], a[0:3], 0
    s_waitcnt vmcnt(13)
    v_cvt_pk_bf16_f32 v82, v32, v33
    v_cvt_pk_bf16_f32 v83, v34, v35
    v_mfma_f32_16x16x32_bf16 v[40:43], a[212:215], a[16:19], v[40:43]
    s_barrier
    v_mfma_f32_16x16x32_bf16 v[40:43], a[216:219], a[32:35], v[40:43]
    ds_read_b128 a[184:187], v12 offset:24576
    v_cvt_pk_bf16_f32 v90, v36, v37
    v_mfma_f32_16x16x32_bf16 v[40:43], a[220:223], a[48:51], v[40:43]
    ds_read_b128 a[188:191], v13 offset:24576
    v_cvt_pk_bf16_f32 v91, v38, v39
    v_mfma_f32_16x16x32_bf16 v[40:43], a[224:227], a[64:67], v[40:43]
    buffer_load_dwordx4 v4, s[12:15], s38 offen offset:0 lds
    v_mfma_f32_16x16x32_bf16 v[40:43], a[228:231], a[80:83], v[40:43]
    v_exp_f32 v68, v68
    v_mfma_f32_16x16x32_bf16 v[44:47], a[228:231], a[84:87], 0
    v_exp_f32 v69, v69
    v_mfma_f32_16x16x32_bf16 v[44:47], a[224:227], a[68:71], v[44:47]
    ds_read_b128 a[192:195], v12 offset:25600
    v_cvt_pk_bf16_f32 v68, v68, v69
    v_mfma_f32_16x16x32_bf16 v[44:47], a[220:223], a[52:55], v[44:47]
    v_exp_f32 v70, v70
    v_mfma_f32_16x16x32_bf16 v[44:47], a[216:219], a[36:39], v[44:47]
    v_exp_f32 v71, v71
    v_mfma_f32_16x16x32_bf16 v[44:47], a[212:215], a[20:23], v[44:47]
pg_5:
    s_cbranch_execz pg_9
    s_add_u32 m0, s49, 896
    ds_read_b128 a[196:199], v13 offset:25600
    v_cvt_pk_bf16_f32 v69, v70, v71
    v_mfma_f32_16x16x32_bf16 v[44:47], a[208:211], a[4:7], v[44:47]
    v_exp_f32 v76, v76
    v_mfma_f32_16x16x32_bf16 v[48:51], a[208:211], a[8:11], 0
    buffer_load_dword a252, v22, s[32:35], s42 offen offset:0
    v_mfma_f32_16x16x32_bf16 v[48:51], a[212:215], a[24:27], v[48:51]
    v_exp_f32 v77, v77
    v_mfma_f32_16x16x32_bf16 v[48:51], a[216:219], a[40:43], v[48:51]
    ds_read_b128 a[200:203], v12 offset:26624
    v_cvt_pk_bf16_f32 v76, v76, v77
    v_mfma_f32_16x16x32_bf16 v[48:51], a[220:223], a[56:59], v[48:51]
    v_exp_f32 v78, v78
    v_mfma_f32_16x16x32_bf16 v[48:51], a[224:227], a[72:75], v[48:51]
    buffer_load_dwordx4 v4, s[12:15], s38 offen offset:128 lds
    v_mfma_f32_16x16x32_bf16 v[48:51], a[228:231], a[88:91], v[48:51]
    v_exp_f32 v79, v79
    v_mfma_f32_16x16x32_bf16 v[52:55], a[228:231], a[92:95], 0
    ds_read_b128 a[204:207], v13 offset:26624
    v_cvt_pk_bf16_f32 v77, v78, v79
    v_mfma_f32_16x16x32_bf16 v[52:55], a[224:227], a[76:79], v[52:55]
    v_exp_f32 v84, v84
    v_mfma_f32_16x16x32_bf16 v[52:55], a[220:223], a[60:63], v[52:55]
    v_exp_f32 v85, v85
    v_mfma_f32_16x16x32_bf16 v[52:55], a[216:219], a[44:47], v[52:55]
    s_waitcnt lgkmcnt(1)
    v_exp_f32 v86, v86
    v_mfma_f32_16x16x32_bf16 v[52:55], a[212:215], a[28:31], v[52:55]
    s_add_u32 m0, s49, 1792
    ds_read_b128 a[212:215], v13 offset:30720
    v_cvt_pk_bf16_f32 v84, v84, v85
    v_mfma_f32_16x16x32_bf16 v[52:55], a[208:211], a[12:15], v[52:55]
    v_exp_f32 v87, v87
    v_mfma_f32_16x16x32_bf16 v[96:99], a[184:187], a[0:3], 0
    ds_read_b128 a[220:223], v13 offset:31744
    v_cvt_pk_bf16_f32 v85, v86, v87
    v_mfma_f32_16x16x32_bf16 v[96:99], a[188:191], a[16:19], v[96:99]
    v_exp_f32 v92, v92
    v_mfma_f32_16x16x32_bf16 v[96:99], a[192:195], a[32:35], v[96:99]
    s_waitcnt lgkmcnt(2)
    v_exp_f32 v93, v93
    v_mfma_f32_16x16x32_bf16 v[96:99], a[196:199], a[48:51], v[96:99]
    ds_read_b128 a[208:211], v12 offset:30720
    v_cvt_pk_bf16_f32 v92, v92, v93
    v_mfma_f32_16x16x32_bf16 v[96:99], a[200:203], a[64:67], v[96:99]
    buffer_load_dwordx4 v4, s[12:15], s38 offen offset:256 lds
    v_mfma_f32_16x16x32_bf16 v[96:99], a[204:207], a[80:83], v[96:99]
    v_exp_f32 v94, v94
    v_mfma_f32_16x16x32_bf16 v[104:107], a[204:207], a[84:87], 0
    v_exp_f32 v95, v95
    v_mfma_f32_16x16x32_bf16 v[104:107], a[200:203], a[68:71], v[104:107]
    ds_read_b128 a[216:219], v12 offset:31744
    v_cvt_pk_bf16_f32 v93, v94, v95
    v_mfma_f32_16x16x32_bf16 v[104:107], a[196:199], a[52:55], v[104:107]
    v_exp_f32 v40, v40
    v_mfma_f32_16x16x32_bf16 v[104:107], a[192:195], a[36:39], v[104:107]
    v_exp_f32 v41, v41
    v_mfma_f32_16x16x32_bf16 v[104:107], a[188:191], a[20:23], v[104:107]
    s_add_u32 m0, s49, 3072
    ds_read_b128 a[224:227], v12 offset:32768
    v_cvt_pk_bf16_f32 v70, v40, v41
    v_mfma_f32_16x16x32_bf16 v[104:107], a[184:187], a[4:7], v[104:107]
    v_exp_f32 v42, v42
    v_mfma_f32_16x16x32_bf16 v[112:115], a[184:187], a[8:11], 0
    v_exp_f32 v43, v43
    v_mfma_f32_16x16x32_bf16 v[112:115], a[188:191], a[24:27], v[112:115]
    ds_read_b128 a[228:231], v13 offset:32768
    v_cvt_pk_bf16_f32 v71, v42, v43
    v_mfma_f32_16x16x32_bf16 v[112:115], a[192:195], a[40:43], v[112:115]
    v_exp_f32 v44, v44
    v_mfma_f32_16x16x32_bf16 v[112:115], a[196:199], a[56:59], v[112:115]
    v_exp_f32 v45, v45
    v_mfma_f32_16x16x32_bf16 v[112:115], a[200:203], a[72:75], v[112:115]
    buffer_load_dwordx4 v5, s[12:15], s38 offen offset:0 lds
    v_mfma_f32_16x16x32_bf16 v[112:115], a[204:207], a[88:91], v[112:115]
    v_exp_f32 v46, v46
    v_mfma_f32_16x16x32_bf16 v[120:123], a[204:207], a[92:95], 0
    ds_read_b64_tr_b16 a[232:233], v8 offset:0
    v_cvt_pk_bf16_f32 v78, v44, v45
    v_mfma_f32_16x16x32_bf16 v[120:123], a[200:203], a[76:79], v[120:123]
    v_exp_f32 v47, v47
    v_mfma_f32_16x16x32_bf16 v[120:123], a[196:199], a[60:63], v[120:123]
    ds_read_b64_tr_b16 a[234:235], v8 offset:2048
    v_cvt_pk_bf16_f32 v79, v46, v47
    v_mfma_f32_16x16x32_bf16 v[120:123], a[192:195], a[44:47], v[120:123]
    s_waitcnt lgkmcnt(2)
    v_exp_f32 v48, v48
    v_mfma_f32_16x16x32_bf16 v[120:123], a[188:191], a[28:31], v[120:123]
    s_add_u32 m0, s49, 3968
    v_exp_f32 v49, v49
    v_mfma_f32_16x16x32_bf16 v[120:123], a[184:187], a[12:15], v[120:123]
    ds_read_b64_tr_b16 a[236:237], v9 offset:0
    v_cvt_pk_bf16_f32 v86, v48, v49
    v_mfma_f32_16x16x32_bf16 v[24:27], a[208:211], a[0:3], 0
    v_exp_f32 v50, v50
    v_mfma_f32_16x16x32_bf16 v[24:27], a[212:215], a[16:19], v[24:27]
    v_exp_f32 v51, v51
    v_mfma_f32_16x16x32_bf16 v[24:27], a[216:219], a[32:35], v[24:27]
    ds_read_b64_tr_b16 a[238:239], v9 offset:2048
    v_cvt_pk_bf16_f32 v87, v50, v51
    v_mfma_f32_16x16x32_bf16 v[24:27], a[220:223], a[48:51], v[24:27]
    v_exp_f32 v52, v52
    v_mfma_f32_16x16x32_bf16 v[24:27], a[224:227], a[64:67], v[24:27]
    buffer_load_dwordx4 v5, s[12:15], s38 offen offset:128 lds
    v_mfma_f32_16x16x32_bf16 v[24:27], a[228:231], a[80:83], v[24:27]
    v_exp_f32 v53, v53
    v_mfma_f32_16x16x32_bf16 v[28:31], a[228:231], a[84:87], 0
    ds_read_b128 a[184:187], v12 offset:36864
    v_cvt_pk_bf16_f32 v94, v52, v53
    v_mfma_f32_16x16x32_bf16 v[28:31], a[224:227], a[68:71], v[28:31]
    v_exp_f32 v54, v54
    v_mfma_f32_16x16x32_bf16 v[28:31], a[220:223], a[52:55], v[28:31]
    v_exp_f32 v55, v55
    v_mfma_f32_16x16x32_bf16 v[28:31], a[216:219], a[36:39], v[28:31]
    ds_read_b128 a[188:191], v13 offset:36864
    v_cvt_pk_bf16_f32 v95, v54, v55
    v_mfma_f32_16x16x32_bf16 v[28:31], a[212:215], a[20:23], v[28:31]
    s_add_u32 m0, s49, 4864
    v_exp_f32 v96, v96
    v_mfma_f32_16x16x32_bf16 v[28:31], a[208:211], a[4:7], v[28:31]
    v_exp_f32 v97, v97
    v_mfma_f32_16x16x32_bf16 v[32:35], a[208:211], a[8:11], 0
    ds_read_b128 a[192:195], v12 offset:37888
    v_cvt_pk_bf16_f32 v96, v96, v97
    v_mfma_f32_16x16x32_bf16 v[32:35], a[212:215], a[24:27], v[32:35]
    v_exp_f32 v98, v98
    v_mfma_f32_16x16x32_bf16 v[32:35], a[216:219], a[40:43], v[32:35]
    v_exp_f32 v99, v99
    v_mfma_f32_16x16x32_bf16 v[32:35], a[220:223], a[56:59], v[32:35]
    ds_read_b128 a[196:199], v13 offset:37888
    v_cvt_pk_bf16_f32 v97, v98, v99
    v_mfma_f32_16x16x32_bf16 v[32:35], a[224:227], a[72:75], v[32:35]
    buffer_load_dwordx4 v5, s[12:15], s38 offen offset:256 lds
    v_mfma_f32_16x16x32_bf16 v[32:35], a[228:231], a[88:91], v[32:35]
    s_add_u32 s38, s38, 24576
    v_exp_f32 v104, v104
    v_mfma_f32_16x16x32_bf16 v[36:39], a[228:231], a[92:95], 0
    v_exp_f32 v105, v105
    v_mfma_f32_16x16x32_bf16 v[36:39], a[224:227], a[76:79], v[36:39]
    ds_read_b128 a[200:203], v12 offset:38912
    v_cvt_pk_bf16_f32 v104, v104, v105
    v_mfma_f32_16x16x32_bf16 v[36:39], a[220:223], a[60:63], v[36:39]
    s_add_u32 s39, s40, 73728
    v_exp_f32 v106, v106
    v_mfma_f32_16x16x32_bf16 v[36:39], a[216:219], a[44:47], v[36:39]
    s_waitcnt lgkmcnt(2)
    v_exp_f32 v107, v107
    v_mfma_f32_16x16x32_bf16 v[36:39], a[212:215], a[28:31], v[36:39]
    s_add_u32 m0, s63, 98304
    ds_read_b128 a[204:207], v13 offset:38912
    v_cvt_pk_bf16_f32 v105, v106, v107
    v_mfma_f32_16x16x32_bf16 v[36:39], a[208:211], a[12:15], v[36:39]
    v_exp_f32 v112, v112
    v_mfma_f32_16x16x32_bf16 a[152:155], a[232:235], v[64:67], 0
    v_exp_f32 v113, v113
    v_mfma_f32_16x16x32_bf16 a[168:171], a[236:239], v[64:67], 0
    v_exp_f32 v114, v114
    v_mfma_f32_16x16x32_bf16 a[172:175], a[236:239], v[72:75], 0
    ds_read_b128 a[208:211], v12 offset:43008
    v_cvt_pk_bf16_f32 v112, v112, v113
    v_mfma_f32_16x16x32_bf16 a[156:159], a[232:235], v[72:75], 0
    v_exp_f32 v115, v115
    v_mfma_f32_16x16x32_bf16 a[160:163], a[232:235], v[80:83], 0
    buffer_load_dwordx4 v6, s[16:19], s39 offen lds
    v_mfma_f32_16x16x32_bf16 a[176:179], a[236:239], v[80:83], 0
    ds_read_b128 a[212:215], v13 offset:43008
    v_cvt_pk_bf16_f32 v113, v114, v115
    v_mfma_f32_16x16x32_bf16 a[180:183], a[236:239], v[88:91], 0
    v_exp_f32 v120, v120
    v_mfma_f32_16x16x32_bf16 a[164:167], a[232:235], v[88:91], 0
    v_exp_f32 v121, v121
    v_mfma_f32_16x16x32_bf16 v[100:103], a[184:187], a[0:3], 0
    s_waitcnt lgkmcnt(2)
    ds_read_b128 a[216:219], v12 offset:44032
    v_cvt_pk_bf16_f32 v120, v120, v121
    v_mfma_f32_16x16x32_bf16 v[100:103], a[188:191], a[16:19], v[100:103]
    s_add_u32 s39, s40, 86016
    v_exp_f32 v122, v122
    v_mfma_f32_16x16x32_bf16 v[100:103], a[192:195], a[32:35], v[100:103]
    s_add_u32 m0, s63, 102400
    v_exp_f32 v123, v123
    v_mfma_f32_16x16x32_bf16 v[100:103], a[196:199], a[48:51], v[100:103]
    ds_read_b128 a[220:223], v13 offset:44032
    v_cvt_pk_bf16_f32 v121, v122, v123
    v_mfma_f32_16x16x32_bf16 v[100:103], a[200:203], a[64:67], v[100:103]
    v_exp_f32 v24, v24
    v_mfma_f32_16x16x32_bf16 v[100:103], a[204:207], a[80:83], v[100:103]
    v_exp_f32 v25, v25
    v_mfma_f32_16x16x32_bf16 v[108:111], a[204:207], a[84:87], 0
    ds_read_b128 a[224:227], v12 offset:45056
    v_cvt_pk_bf16_f32 v98, v24, v25
    v_mfma_f32_16x16x32_bf16 v[108:111], a[200:203], a[68:71], v[108:111]
    v_exp_f32 v26, v26
    v_mfma_f32_16x16x32_bf16 v[108:111], a[196:199], a[52:55], v[108:111]
    buffer_load_dwordx4 v6, s[16:19], s39 offen lds
    v_mfma_f32_16x16x32_bf16 v[108:111], a[192:195], a[36:39], v[108:111]
    v_exp_f32 v27, v27
    v_mfma_f32_16x16x32_bf16 v[108:111], a[188:191], a[20:23], v[108:111]
    ds_read_b128 a[228:231], v13 offset:45056
    v_cvt_pk_bf16_f32 v99, v26, v27
    v_mfma_f32_16x16x32_bf16 v[108:111], a[184:187], a[4:7], v[108:111]
    v_exp_f32 v28, v28
    v_mfma_f32_16x16x32_bf16 v[116:119], a[184:187], a[8:11], 0
    v_exp_f32 v29, v29
    v_mfma_f32_16x16x32_bf16 v[116:119], a[188:191], a[24:27], v[116:119]
    v_exp_f32 v30, v30
    v_mfma_f32_16x16x32_bf16 v[116:119], a[192:195], a[40:43], v[116:119]
    v_exp_f32 v31, v31
    v_mfma_f32_16x16x32_bf16 v[116:119], a[196:199], a[56:59], v[116:119]
    v_exp_f32 v32, v32
    v_mfma_f32_16x16x32_bf16 v[116:119], a[200:203], a[72:75], v[116:119]
    v_exp_f32 v33, v33
    v_mfma_f32_16x16x32_bf16 v[116:119], a[204:207], a[88:91], v[116:119]
    v_exp_f32 v34, v34
    v_mfma_f32_16x16x32_bf16 v[124:127], a[204:207], a[92:95], 0
    v_exp_f32 v35, v35
    v_mfma_f32_16x16x32_bf16 v[124:127], a[200:203], a[76:79], v[124:127]
    v_cvt_pk_bf16_f32 v106, v28, v29
    v_cvt_pk_bf16_f32 v107, v30, v31
    v_mfma_f32_16x16x32_bf16 v[124:127], a[196:199], a[60:63], v[124:127]
    s_add_u32 m0, s49, 24576
    v_exp_f32 v36, v36
    v_mfma_f32_16x16x32_bf16 v[124:127], a[192:195], a[44:47], v[124:127]
    s_waitcnt lgkmcnt(0)
    v_exp_f32 v37, v37
    v_mfma_f32_16x16x32_bf16 v[124:127], a[188:191], a[28:31], v[124:127]
    v_exp_f32 v38, v38
    v_mfma_f32_16x16x32_bf16 v[124:127], a[184:187], a[12:15], v[124:127]
    v_exp_f32 v39, v39
    v_mfma_f32_16x16x32_bf16 v[40:43], a[208:211], a[0:3], 0
    s_waitcnt vmcnt(11)
    v_cvt_pk_bf16_f32 v114, v32, v33
    v_cvt_pk_bf16_f32 v115, v34, v35
    v_mfma_f32_16x16x32_bf16 v[40:43], a[212:215], a[16:19], v[40:43]
    s_barrier
    v_mfma_f32_16x16x32_bf16 v[40:43], a[216:219], a[32:35], v[40:43]
    buffer_load_dwordx4 v4, s[12:15], s38 offen offset:0 lds
    v_mfma_f32_16x16x32_bf16 v[40:43], a[220:223], a[48:51], v[40:43]
    ds_read_b64_tr_b16 a[240:241], v8 offset:4096
    v_cvt_pk_bf16_f32 v122, v36, v37
    v_mfma_f32_16x16x32_bf16 v[40:43], a[224:227], a[64:67], v[40:43]
    ds_read_b64_tr_b16 a[242:243], v8 offset:6144
    v_cvt_pk_bf16_f32 v123, v38, v39
    v_mfma_f32_16x16x32_bf16 v[40:43], a[228:231], a[80:83], v[40:43]
    v_exp_f32 v100, v100
    v_mfma_f32_16x16x32_bf16 v[44:47], a[228:231], a[84:87], 0
    v_exp_f32 v101, v101
    v_mfma_f32_16x16x32_bf16 v[44:47], a[224:227], a[68:71], v[44:47]
    ds_read_b64_tr_b16 a[244:245], v9 offset:4096
    v_cvt_pk_bf16_f32 v100, v100, v101
    v_mfma_f32_16x16x32_bf16 v[44:47], a[220:223], a[52:55], v[44:47]
    s_add_u32 m0, s49, 25472
    v_exp_f32 v102, v102
    v_mfma_f32_16x16x32_bf16 v[44:47], a[216:219], a[36:39], v[44:47]
    v_exp_f32 v103, v103
    v_mfma_f32_16x16x32_bf16 v[44:47], a[212:215], a[20:23], v[44:47]
    ds_read_b64_tr_b16 a[246:247], v9 offset:6144
    v_cvt_pk_bf16_f32 v101, v102, v103
    v_mfma_f32_16x16x32_bf16 v[44:47], a[208:211], a[4:7], v[44:47]
    v_exp_f32 v108, v108
    v_mfma_f32_16x16x32_bf16 v[48:51], a[208:211], a[8:11], 0
    buffer_load_dword a252, v22, s[32:35], s42 offen offset:1536
    s_add_u32 s42, s42, 3072
    v_mfma_f32_16x16x32_bf16 v[48:51], a[212:215], a[24:27], v[48:51]
    v_exp_f32 v109, v109
    v_mfma_f32_16x16x32_bf16 v[48:51], a[216:219], a[40:43], v[48:51]
    buffer_load_dwordx4 v4, s[12:15], s38 offen offset:128 lds
    v_mfma_f32_16x16x32_bf16 v[48:51], a[220:223], a[56:59], v[48:51]
    ds_read_b128 a[184:187], v12 offset:49152
    v_cvt_pk_bf16_f32 v108, v108, v109
    v_mfma_f32_16x16x32_bf16 v[48:51], a[224:227], a[72:75], v[48:51]
    v_exp_f32 v110, v110
    v_mfma_f32_16x16x32_bf16 v[48:51], a[228:231], a[88:91], v[48:51]
    v_exp_f32 v111, v111
    v_mfma_f32_16x16x32_bf16 v[52:55], a[228:231], a[92:95], 0
    ds_read_b128 a[188:191], v13 offset:49152
    v_cvt_pk_bf16_f32 v109, v110, v111
    v_mfma_f32_16x16x32_bf16 v[52:55], a[224:227], a[76:79], v[52:55]
    v_exp_f32 v116, v116
    v_mfma_f32_16x16x32_bf16 v[52:55], a[220:223], a[60:63], v[52:55]
    s_add_u32 m0, s49, 26368
    ds_read_b128 a[192:195], v12 offset:50176
    v_accvgpr_write_b32 a96, v64
    v_mfma_f32_16x16x32_bf16 v[52:55], a[216:219], a[44:47], v[52:55]
    s_waitcnt lgkmcnt(3)
    v_exp_f32 v117, v117
    v_mfma_f32_16x16x32_bf16 v[52:55], a[212:215], a[28:31], v[52:55]
    ds_read_b128 a[196:199], v13 offset:50176
    v_cvt_pk_bf16_f32 v116, v116, v117
    v_mfma_f32_16x16x32_bf16 v[52:55], a[208:211], a[12:15], v[52:55]
    v_exp_f32 v118, v118
    v_mfma_f32_16x16x32_bf16 a[164:167], a[240:243], v[92:95], a[164:167]
    v_exp_f32 v119, v119
    v_mfma_f32_16x16x32_bf16 a[180:183], a[244:247], v[92:95], a[180:183]
    ds_read_b128 a[200:203], v12 offset:51200
    v_cvt_pk_bf16_f32 v117, v118, v119
    v_mfma_f32_16x16x32_bf16 a[176:179], a[244:247], v[84:87], a[176:179]
    buffer_load_dwordx4 v4, s[12:15], s38 offen offset:256 lds
    v_mfma_f32_16x16x32_bf16 a[160:163], a[240:243], v[84:87], a[160:163]
    ds_read_b128 a[204:207], v13 offset:51200
    v_accvgpr_write_b32 a97, v65
    v_mfma_f32_16x16x32_bf16 a[156:159], a[240:243], v[76:79], a[156:159]
    v_exp_f32 v124, v124
    v_mfma_f32_16x16x32_bf16 a[172:175], a[244:247], v[76:79], a[172:175]
    s_waitcnt lgkmcnt(2)
    v_exp_f32 v125, v125
    v_mfma_f32_16x16x32_bf16 a[168:171], a[244:247], v[68:71], a[168:171]
    ds_read_b128 a[208:211], v12 offset:55296
    v_cvt_pk_bf16_f32 v124, v124, v125
    v_mfma_f32_16x16x32_bf16 a[152:155], a[240:243], v[68:71], a[152:155]
    v_exp_f32 v126, v126
    v_mfma_f32_16x16x32_bf16 v[128:131], a[184:187], a[0:3], 0
    s_add_u32 m0, s49, 27648
    v_exp_f32 v127, v127
    v_mfma_f32_16x16x32_bf16 v[128:131], a[188:191], a[16:19], v[128:131]
    s_waitcnt lgkmcnt(2)
    ds_read_b128 a[212:215], v13 offset:55296
    v_cvt_pk_bf16_f32 v125, v126, v127
    v_mfma_f32_16x16x32_bf16 v[128:131], a[192:195], a[32:35], v[128:131]
    s_waitcnt lgkmcnt(2)
    v_exp_f32 v40, v40
    v_mfma_f32_16x16x32_bf16 v[128:131], a[196:199], a[48:51], v[128:131]
    ds_read_b128 a[216:219], v12 offset:56320
    v_accvgpr_write_b32 a98, v66
    v_mfma_f32_16x16x32_bf16 v[128:131], a[200:203], a[64:67], v[128:131]
    v_exp_f32 v41, v41
    v_mfma_f32_16x16x32_bf16 v[128:131], a[204:207], a[80:83], v[128:131]
    ds_read_b128 a[220:223], v13 offset:56320
    v_cvt_pk_bf16_f32 v102, v40, v41
    v_mfma_f32_16x16x32_bf16 v[136:139], a[204:207], a[84:87], 0
    buffer_load_dwordx4 v5, s[12:15], s38 offen offset:0 lds
    v_mfma_f32_16x16x32_bf16 v[136:139], a[200:203], a[68:71], v[136:139]
    v_exp_f32 v42, v42
    v_mfma_f32_16x16x32_bf16 v[136:139], a[196:199], a[52:55], v[136:139]
    v_exp_f32 v43, v43
    v_mfma_f32_16x16x32_bf16 v[136:139], a[192:195], a[36:39], v[136:139]
    ds_read_b128 a[224:227], v12 offset:57344
    v_cvt_pk_bf16_f32 v103, v42, v43
    v_mfma_f32_16x16x32_bf16 v[136:139], a[188:191], a[20:23], v[136:139]
    v_exp_f32 v44, v44
    v_mfma_f32_16x16x32_bf16 v[136:139], a[184:187], a[4:7], v[136:139]
    ds_read_b128 a[228:231], v13 offset:57344
    v_accvgpr_write_b32 a99, v67
    v_mfma_f32_16x16x32_bf16 v[144:147], a[184:187], a[8:11], 0
    s_add_u32 m0, s49, 28544
    v_exp_f32 v45, v45
    v_mfma_f32_16x16x32_bf16 v[144:147], a[188:191], a[24:27], v[144:147]
    v_exp_f32 v46, v46
    v_mfma_f32_16x16x32_bf16 v[144:147], a[192:195], a[40:43], v[144:147]
    v_exp_f32 v47, v47
    v_mfma_f32_16x16x32_bf16 v[144:147], a[196:199], a[56:59], v[144:147]
    v_exp_f32 v48, v48
    v_mfma_f32_16x16x32_bf16 v[144:147], a[200:203], a[72:75], v[144:147]
    v_exp_f32 v49, v49
    v_mfma_f32_16x16x32_bf16 v[144:147], a[204:207], a[88:91], v[144:147]
    v_exp_f32 v50, v50
    v_mfma_f32_16x16x32_bf16 v[152:155], a[204:207], a[92:95], 0
    buffer_load_dwordx4 v5, s[12:15], s38 offen offset:128 lds
    v_mfma_f32_16x16x32_bf16 v[152:155], a[200:203], a[76:79], v[152:155]
    ds_read_b64_tr_b16 a[232:233], v8 offset:8192
    v_cvt_pk_bf16_f32 v110, v44, v45
    v_mfma_f32_16x16x32_bf16 v[152:155], a[196:199], a[60:63], v[152:155]
    ds_read_b64_tr_b16 a[234:235], v8 offset:10240
    v_cvt_pk_bf16_f32 v111, v46, v47
    v_mfma_f32_16x16x32_bf16 v[152:155], a[192:195], a[44:47], v[152:155]
    s_waitcnt lgkmcnt(2)
    ds_read_b64_tr_b16 a[236:237], v9 offset:8192
    v_cvt_pk_bf16_f32 v118, v48, v49
    v_mfma_f32_16x16x32_bf16 v[152:155], a[188:191], a[28:31], v[152:155]
    ds_read_b64_tr_b16 a[238:239], v9 offset:10240
    v_accvgpr_write_b32 a100, v68
    v_mfma_f32_16x16x32_bf16 v[152:155], a[184:187], a[12:15], v[152:155]
    v_exp_f32 v51, v51
    v_mfma_f32_16x16x32_bf16 v[24:27], a[208:211], a[0:3], 0
    s_add_u32 m0, s49, 29440
    v_exp_f32 v52, v52
    v_mfma_f32_16x16x32_bf16 v[24:27], a[212:215], a[16:19], v[24:27]
    v_exp_f32 v53, v53
    v_mfma_f32_16x16x32_bf16 v[24:27], a[216:219], a[32:35], v[24:27]
    ds_read_b128 a[184:187], v12 offset:61440
    v_cvt_pk_bf16_f32 v119, v50, v51
    v_mfma_f32_16x16x32_bf16 v[24:27], a[220:223], a[48:51], v[24:27]
    ds_read_b128 a[188:191], v13 offset:61440
    v_cvt_pk_bf16_f32 v126, v52, v53
    v_mfma_f32_16x16x32_bf16 v[24:27], a[224:227], a[64:67], v[24:27]
    ds_read_b128 a[192:195], v12 offset:62464
    v_accvgpr_write_b32 a101, v69
    v_mfma_f32_16x16x32_bf16 v[24:27], a[228:231], a[80:83], v[24:27]
    v_exp_f32 v54, v54
    v_mfma_f32_16x16x32_bf16 v[28:31], a[228:231], a[84:87], 0
    buffer_load_dwordx4 v5, s[12:15], s38 offen offset:256 lds
    v_mfma_f32_16x16x32_bf16 v[28:31], a[224:227], a[68:71], v[28:31]
    s_add_u32 s38, s38, 24576
    v_exp_f32 v55, v55
    v_mfma_f32_16x16x32_bf16 v[28:31], a[220:223], a[52:55], v[28:31]
    ds_read_b128 a[196:199], v13 offset:62464
    v_cvt_pk_bf16_f32 v127, v54, v55
    v_mfma_f32_16x16x32_bf16 v[28:31], a[216:219], a[36:39], v[28:31]
    v_exp_f32 v128, v128
    v_mfma_f32_16x16x32_bf16 v[28:31], a[212:215], a[20:23], v[28:31]
    s_add_u32 s39, s40, 98304
    ds_read_b128 a[200:203], v12 offset:63488
    v_add_u32 v12, 67584, v12
    v_mfma_f32_16x16x32_bf16 v[28:31], a[208:211], a[4:7], v[28:31]
    ds_read_b128 a[204:207], v13 offset:63488
    v_add_u32 v13, 67584, v13
    v_mfma_f32_16x16x32_bf16 v[32:35], a[208:211], a[8:11], 0
    s_add_u32 m0, s63, 106496
    v_exp_f32 v129, v129
    v_mfma_f32_16x16x32_bf16 v[32:35], a[212:215], a[24:27], v[32:35]
    v_exp_f32 v130, v130
    v_mfma_f32_16x16x32_bf16 v[32:35], a[216:219], a[40:43], v[32:35]
    v_exp_f32 v131, v131
    v_mfma_f32_16x16x32_bf16 v[32:35], a[220:223], a[56:59], v[32:35]
    v_exp_f32 v136, v136
    v_mfma_f32_16x16x32_bf16 v[32:35], a[224:227], a[72:75], v[32:35]
    v_exp_f32 v137, v137
    v_mfma_f32_16x16x32_bf16 v[32:35], a[228:231], a[88:91], v[32:35]
    v_exp_f32 v138, v138
    v_mfma_f32_16x16x32_bf16 v[36:39], a[228:231], a[92:95], 0
    buffer_load_dwordx4 v6, s[16:19], s39 offen lds
    v_mfma_f32_16x16x32_bf16 v[36:39], a[224:227], a[76:79], v[36:39]
    v_exp_f32 v139, v139
    v_mfma_f32_16x16x32_bf16 v[36:39], a[220:223], a[60:63], v[36:39]
    v_cvt_pk_bf16_f32 v128, v128, v129
    v_cvt_pk_bf16_f32 v129, v130, v131
    v_mfma_f32_16x16x32_bf16 v[36:39], a[216:219], a[44:47], v[36:39]
    s_waitcnt lgkmcnt(0)
    v_exp_f32 v144, v144
    v_mfma_f32_16x16x32_bf16 v[36:39], a[212:215], a[28:31], v[36:39]
    s_add_u32 s39, s40, 110592
    v_exp_f32 v145, v145
    v_mfma_f32_16x16x32_bf16 v[36:39], a[208:211], a[12:15], v[36:39]
    v_exp_f32 v146, v146
    v_mfma_f32_16x16x32_bf16 a[152:155], a[232:235], v[96:99], a[152:155]
    s_add_u32 m0, s63, 110592
    v_exp_f32 v147, v147
    v_mfma_f32_16x16x32_bf16 a[168:171], a[236:239], v[96:99], a[168:171]
    v_cvt_pk_bf16_f32 v136, v136, v137
    v_cvt_pk_bf16_f32 v137, v138, v139
    v_mfma_f32_16x16x32_bf16 a[172:175], a[236:239], v[104:107], a[172:175]
    ds_read_b128 a[208:211], v12 offset:0
    v_cvt_pk_bf16_f32 v144, v144, v145
    v_mfma_f32_16x16x32_bf16 a[156:159], a[232:235], v[104:107], a[156:159]
    ds_read_b128 a[212:215], v13 offset:0
    v_cvt_pk_bf16_f32 v145, v146, v147
    v_mfma_f32_16x16x32_bf16 a[160:163], a[232:235], v[112:115], a[160:163]
    ds_read_b128 a[216:219], v12 offset:1024
    v_accvgpr_write_b32 a102, v70
    v_mfma_f32_16x16x32_bf16 a[176:179], a[236:239], v[112:115], a[176:179]
    ds_read_b128 a[220:223], v13 offset:1024
    v_accvgpr_write_b32 a103, v71
    v_mfma_f32_16x16x32_bf16 a[180:183], a[236:239], v[120:123], a[180:183]
    buffer_load_dwordx4 v6, s[16:19], s39 offen lds
    v_mfma_f32_16x16x32_bf16 a[164:167], a[232:235], v[120:123], a[164:167]
    ds_read_b128 a[224:227], v12 offset:2048
    v_accvgpr_write_b32 a104, v72
    v_mfma_f32_16x16x32_bf16 v[132:135], a[184:187], a[0:3], 0
    ds_read_b128 a[228:231], v13 offset:2048
    v_subrev_u32 v12, 67584, v12
    v_mfma_f32_16x16x32_bf16 v[132:135], a[188:191], a[16:19], v[132:135]
    v_exp_f32 v152, v152
    v_mfma_f32_16x16x32_bf16 v[132:135], a[192:195], a[32:35], v[132:135]
    v_exp_f32 v153, v153
    v_mfma_f32_16x16x32_bf16 v[132:135], a[196:199], a[48:51], v[132:135]
    v_exp_f32 v154, v154
    v_mfma_f32_16x16x32_bf16 v[132:135], a[200:203], a[64:67], v[132:135]
    v_exp_f32 v155, v155
    v_mfma_f32_16x16x32_bf16 v[132:135], a[204:207], a[80:83], v[132:135]
    v_exp_f32 v24, v24
    v_mfma_f32_16x16x32_bf16 v[140:143], a[204:207], a[84:87], 0
    v_exp_f32 v25, v25
    v_mfma_f32_16x16x32_bf16 v[140:143], a[200:203], a[68:71], v[140:143]
    v_exp_f32 v26, v26
    v_mfma_f32_16x16x32_bf16 v[140:143], a[196:199], a[52:55], v[140:143]
    v_exp_f32 v27, v27
    v_mfma_f32_16x16x32_bf16 v[140:143], a[192:195], a[36:39], v[140:143]
    v_cvt_pk_bf16_f32 v152, v152, v153
    v_cvt_pk_bf16_f32 v153, v154, v155
    v_mfma_f32_16x16x32_bf16 v[140:143], a[188:191], a[20:23], v[140:143]
    v_exp_f32 v28, v28
    v_mfma_f32_16x16x32_bf16 v[140:143], a[184:187], a[4:7], v[140:143]
    v_exp_f32 v29, v29
    v_mfma_f32_16x16x32_bf16 v[148:151], a[184:187], a[8:11], 0
    v_exp_f32 v30, v30
    v_mfma_f32_16x16x32_bf16 v[148:151], a[188:191], a[24:27], v[148:151]
    v_exp_f32 v31, v31
    v_mfma_f32_16x16x32_bf16 v[148:151], a[192:195], a[40:43], v[148:151]
    v_cvt_pk_bf16_f32 v130, v24, v25
    v_cvt_pk_bf16_f32 v131, v26, v27
    v_mfma_f32_16x16x32_bf16 v[148:151], a[196:199], a[56:59], v[148:151]
    v_exp_f32 v32, v32
    v_mfma_f32_16x16x32_bf16 v[148:151], a[200:203], a[72:75], v[148:151]
    v_exp_f32 v33, v33
    v_mfma_f32_16x16x32_bf16 v[148:151], a[204:207], a[88:91], v[148:151]
    v_exp_f32 v34, v34
    v_mfma_f32_16x16x32_bf16 v[156:159], a[204:207], a[92:95], 0
    v_exp_f32 v35, v35
    v_mfma_f32_16x16x32_bf16 v[156:159], a[200:203], a[76:79], v[156:159]
    v_cvt_pk_bf16_f32 v138, v28, v29
    v_cvt_pk_bf16_f32 v139, v30, v31
    v_mfma_f32_16x16x32_bf16 v[156:159], a[196:199], a[60:63], v[156:159]
    s_add_u32 m0, s49, 49152
    v_exp_f32 v36, v36
    v_mfma_f32_16x16x32_bf16 v[156:159], a[192:195], a[44:47], v[156:159]
    s_waitcnt lgkmcnt(0)
    v_exp_f32 v37, v37
    v_mfma_f32_16x16x32_bf16 v[156:159], a[188:191], a[28:31], v[156:159]
    v_exp_f32 v38, v38
    v_mfma_f32_16x16x32_bf16 v[156:159], a[184:187], a[12:15], v[156:159]
    v_exp_f32 v39, v39
    v_mfma_f32_16x16x32_bf16 v[40:43], a[208:211], a[0:3], 0
    s_waitcnt vmcnt(11)
    v_cvt_pk_bf16_f32 v146, v32, v33
    v_cvt_pk_bf16_f32 v147, v34, v35
    v_mfma_f32_16x16x32_bf16 v[40:43], a[212:215], a[16:19], v[40:43]
    s_barrier
    v_mfma_f32_16x16x32_bf16 v[40:43], a[216:219], a[32:35], v[40:43]
    buffer_load_dwordx4 v4, s[12:15], s38 offen offset:0 lds
    v_mfma_f32_16x16x32_bf16 v[40:43], a[220:223], a[48:51], v[40:43]
    ds_read_b64_tr_b16 a[240:241], v8 offset:12288
    v_cvt_pk_bf16_f32 v154, v36, v37
    v_mfma_f32_16x16x32_bf16 v[40:43], a[224:227], a[64:67], v[40:43]
    ds_read_b64_tr_b16 a[242:243], v8 offset:14336
    v_cvt_pk_bf16_f32 v155, v38, v39
    v_mfma_f32_16x16x32_bf16 v[40:43], a[228:231], a[80:83], v[40:43]
    ds_read_b64_tr_b16 a[244:245], v9 offset:12288
    v_accvgpr_write_b32 a105, v73
    v_mfma_f32_16x16x32_bf16 v[44:47], a[228:231], a[84:87], 0
    ds_read_b64_tr_b16 a[246:247], v9 offset:14336
    v_subrev_u32 v13, 67584, v13
    v_mfma_f32_16x16x32_bf16 v[44:47], a[224:227], a[68:71], v[44:47]
    ds_read_b128 a[184:187], v12 offset:0
    v_accvgpr_write_b32 a106, v74
    v_mfma_f32_16x16x32_bf16 v[44:47], a[220:223], a[52:55], v[44:47]
    s_add_u32 m0, s49, 50048
    ds_read_b128 a[188:191], v13 offset:0
    v_accvgpr_write_b32 a107, v75
    v_mfma_f32_16x16x32_bf16 v[44:47], a[216:219], a[36:39], v[44:47]
    ds_read_b128 a[192:195], v12 offset:1024
    v_accvgpr_write_b32 a108, v76
    v_mfma_f32_16x16x32_bf16 v[44:47], a[212:215], a[20:23], v[44:47]
    ds_read_b128 a[196:199], v13 offset:1024
    v_accvgpr_write_b32 a109, v77
    v_mfma_f32_16x16x32_bf16 v[44:47], a[208:211], a[4:7], v[44:47]
    v_exp_f32 v132, v132
    v_mfma_f32_16x16x32_bf16 v[48:51], a[208:211], a[8:11], 0
    buffer_load_dword a252, v22, s[32:35], s42 offen offset:0
    v_mfma_f32_16x16x32_bf16 v[48:51], a[212:215], a[24:27], v[48:51]
    v_exp_f32 v133, v133
    v_mfma_f32_16x16x32_bf16 v[48:51], a[216:219], a[40:43], v[48:51]
    buffer_load_dwordx4 v4, s[12:15], s38 offen offset:128 lds
    v_mfma_f32_16x16x32_bf16 v[48:51], a[220:223], a[56:59], v[48:51]
    ds_read_b128 a[200:203], v12 offset:2048
    v_cvt_pk_bf16_f32 v132, v132, v133
    v_mfma_f32_16x16x32_bf16 v[48:51], a[224:227], a[72:75], v[48:51]
    v_exp_f32 v134, v134
    v_mfma_f32_16x16x32_bf16 v[48:51], a[228:231], a[88:91], v[48:51]
    ds_read_b128 a[204:207], v13 offset:2048
    v_accvgpr_write_b32 a110, v78
    v_mfma_f32_16x16x32_bf16 v[52:55], a[228:231], a[92:95], 0
    v_exp_f32 v135, v135
    v_mfma_f32_16x16x32_bf16 v[52:55], a[224:227], a[76:79], v[52:55]
    v_exp_f32 v140, v140
    v_mfma_f32_16x16x32_bf16 v[52:55], a[220:223], a[60:63], v[52:55]
    s_add_u32 m0, s49, 50944
    v_exp_f32 v141, v141
    v_mfma_f32_16x16x32_bf16 v[52:55], a[216:219], a[44:47], v[52:55]
    s_waitcnt lgkmcnt(2)
    v_exp_f32 v142, v142
    v_mfma_f32_16x16x32_bf16 v[52:55], a[212:215], a[28:31], v[52:55]
    v_exp_f32 v143, v143
    v_mfma_f32_16x16x32_bf16 v[52:55], a[208:211], a[12:15], v[52:55]
    v_exp_f32 v148, v148
    v_mfma_f32_16x16x32_bf16 a[164:167], a[240:243], v[124:127], a[164:167]
    v_exp_f32 v149, v149
    v_mfma_f32_16x16x32_bf16 a[180:183], a[244:247], v[124:127], a[180:183]
    v_cvt_pk_bf16_f32 v133, v134, v135
    v_cvt_pk_bf16_f32 v140, v140, v141
    v_mfma_f32_16x16x32_bf16 a[176:179], a[244:247], v[116:119], a[176:179]
    buffer_load_dwordx4 v4, s[12:15], s38 offen offset:256 lds
    v_mfma_f32_16x16x32_bf16 a[160:163], a[240:243], v[116:119], a[160:163]
    ds_read_b128 a[208:211], v12 offset:6144
    v_cvt_pk_bf16_f32 v141, v142, v143
    v_mfma_f32_16x16x32_bf16 a[156:159], a[240:243], v[108:111], a[156:159]
    ds_read_b128 a[212:215], v13 offset:6144
    v_cvt_pk_bf16_f32 v148, v148, v149
    v_mfma_f32_16x16x32_bf16 a[172:175], a[244:247], v[108:111], a[172:175]
pg_6:
    s_cbranch_execz pg_10
    ds_read_b128 a[216:219], v12 offset:7168
    v_accvgpr_write_b32 a111, v79
    v_mfma_f32_16x16x32_bf16 a[168:171], a[244:247], v[100:103], a[168:171]
    v_exp_f32 v150, v150
    v_mfma_f32_16x16x32_bf16 a[152:155], a[240:243], v[100:103], a[152:155]
    v_exp_f32 v151, v151
    v_mfma_f32_16x16x32_bf16 v[160:163], a[184:187], a[0:3], 0
    s_add_u32 m0, s49, 52224
    ds_read_b128 a[220:223], v13 offset:7168
    v_cvt_pk_bf16_f32 v149, v150, v151
    v_mfma_f32_16x16x32_bf16 v[160:163], a[188:191], a[16:19], v[160:163]
    s_waitcnt lgkmcnt(4)
    ds_read_b128 a[224:227], v12 offset:8192
    v_accvgpr_write_b32 a112, v80
    v_mfma_f32_16x16x32_bf16 v[160:163], a[192:195], a[32:35], v[160:163]
    v_exp_f32 v156, v156
    v_mfma_f32_16x16x32_bf16 v[160:163], a[196:199], a[48:51], v[160:163]
    v_exp_f32 v157, v157
    v_mfma_f32_16x16x32_bf16 v[160:163], a[200:203], a[64:67], v[160:163]
    ds_read_b128 a[228:231], v13 offset:8192
    v_cvt_pk_bf16_f32 v156, v156, v157
    v_mfma_f32_16x16x32_bf16 v[160:163], a[204:207], a[80:83], v[160:163]
    v_exp_f32 v158, v158
    v_mfma_f32_16x16x32_bf16 v[168:171], a[204:207], a[84:87], 0
    buffer_load_dwordx4 v5, s[12:15], s38 offen offset:0 lds
    v_mfma_f32_16x16x32_bf16 v[168:171], a[200:203], a[68:71], v[168:171]
    v_exp_f32 v159, v159
    v_mfma_f32_16x16x32_bf16 v[168:171], a[196:199], a[52:55], v[168:171]
    v_exp_f32 v40, v40
    v_mfma_f32_16x16x32_bf16 v[168:171], a[192:195], a[36:39], v[168:171]
    v_exp_f32 v41, v41
    v_mfma_f32_16x16x32_bf16 v[168:171], a[188:191], a[20:23], v[168:171]
    v_exp_f32 v42, v42
    v_mfma_f32_16x16x32_bf16 v[168:171], a[184:187], a[4:7], v[168:171]
    v_exp_f32 v43, v43
    v_mfma_f32_16x16x32_bf16 v[176:179], a[184:187], a[8:11], 0
    s_add_u32 m0, s49, 53120
    v_cvt_pk_bf16_f32 v157, v158, v159
    v_cvt_pk_bf16_f32 v134, v40, v41
    v_mfma_f32_16x16x32_bf16 v[176:179], a[188:191], a[24:27], v[176:179]
    v_exp_f32 v44, v44
    v_mfma_f32_16x16x32_bf16 v[176:179], a[192:195], a[40:43], v[176:179]
    v_exp_f32 v45, v45
    v_mfma_f32_16x16x32_bf16 v[176:179], a[196:199], a[56:59], v[176:179]
    v_exp_f32 v46, v46
    v_mfma_f32_16x16x32_bf16 v[176:179], a[200:203], a[72:75], v[176:179]
    v_exp_f32 v47, v47
    v_mfma_f32_16x16x32_bf16 v[176:179], a[204:207], a[88:91], v[176:179]
    v_cvt_pk_bf16_f32 v135, v42, v43
    v_cvt_pk_bf16_f32 v142, v44, v45
    v_mfma_f32_16x16x32_bf16 v[184:187], a[204:207], a[92:95], 0
    buffer_load_dwordx4 v5, s[12:15], s38 offen offset:128 lds
    v_mfma_f32_16x16x32_bf16 v[184:187], a[200:203], a[76:79], v[184:187]
    ds_read_b64_tr_b16 a[232:233], v8 offset:16384
    v_cvt_pk_bf16_f32 v143, v46, v47
    v_mfma_f32_16x16x32_bf16 v[184:187], a[196:199], a[60:63], v[184:187]
    ds_read_b64_tr_b16 a[234:235], v8 offset:18432
    v_accvgpr_write_b32 a113, v81
    v_mfma_f32_16x16x32_bf16 v[184:187], a[192:195], a[44:47], v[184:187]
    s_waitcnt lgkmcnt(2)
    ds_read_b64_tr_b16 a[236:237], v9 offset:16384
    v_accvgpr_write_b32 a114, v82
    v_mfma_f32_16x16x32_bf16 v[184:187], a[188:191], a[28:31], v[184:187]
    v_exp_f32 v48, v48
    v_mfma_f32_16x16x32_bf16 v[184:187], a[184:187], a[12:15], v[184:187]
    v_exp_f32 v49, v49
    v_mfma_f32_16x16x32_bf16 v[24:27], a[208:211], a[0:3], 0
    s_add_u32 m0, s49, 54016
    ds_read_b64_tr_b16 a[238:239], v9 offset:18432
    v_cvt_pk_bf16_f32 v150, v48, v49
    v_mfma_f32_16x16x32_bf16 v[24:27], a[212:215], a[16:19], v[24:27]
    v_exp_f32 v50, v50
    v_mfma_f32_16x16x32_bf16 v[24:27], a[216:219], a[32:35], v[24:27]
    ds_read_b128 a[184:187], v12 offset:12288
    v_accvgpr_write_b32 a115, v83
    v_mfma_f32_16x16x32_bf16 v[24:27], a[220:223], a[48:51], v[24:27]
    v_exp_f32 v51, v51
    v_mfma_f32_16x16x32_bf16 v[24:27], a[224:227], a[64:67], v[24:27]
    ds_read_b128 a[188:191], v13 offset:12288
    v_cvt_pk_bf16_f32 v151, v50, v51
    v_mfma_f32_16x16x32_bf16 v[24:27], a[228:231], a[80:83], v[24:27]
    v_exp_f32 v52, v52
    v_mfma_f32_16x16x32_bf16 v[28:31], a[228:231], a[84:87], 0
    buffer_load_dwordx4 v5, s[12:15], s38 offen offset:256 lds
    v_mfma_f32_16x16x32_bf16 v[28:31], a[224:227], a[68:71], v[28:31]
    s_add_u32 s38, s38, 24576
    v_exp_f32 v53, v53
    v_mfma_f32_16x16x32_bf16 v[28:31], a[220:223], a[52:55], v[28:31]
    ds_read_b128 a[192:195], v12 offset:13312
    v_cvt_pk_bf16_f32 v158, v52, v53
    v_mfma_f32_16x16x32_bf16 v[28:31], a[216:219], a[36:39], v[28:31]
    ds_read_b128 a[196:199], v13 offset:13312
    v_accvgpr_write_b32 a116, v84
    v_mfma_f32_16x16x32_bf16 v[28:31], a[212:215], a[20:23], v[28:31]
    s_add_u32 s39, s40, 122880
    v_exp_f32 v54, v54
    v_mfma_f32_16x16x32_bf16 v[28:31], a[208:211], a[4:7], v[28:31]
    v_exp_f32 v55, v55
    v_mfma_f32_16x16x32_bf16 v[32:35], a[208:211], a[8:11], 0
    s_add_u32 m0, s63, 114688
    ds_read_b128 a[200:203], v12 offset:14336
    v_cvt_pk_bf16_f32 v159, v54, v55
    v_mfma_f32_16x16x32_bf16 v[32:35], a[212:215], a[24:27], v[32:35]
    v_exp_f32 v160, v160
    v_mfma_f32_16x16x32_bf16 v[32:35], a[216:219], a[40:43], v[32:35]
    v_exp_f32 v161, v161
    v_mfma_f32_16x16x32_bf16 v[32:35], a[220:223], a[56:59], v[32:35]
    ds_read_b128 a[204:207], v13 offset:14336
    v_cvt_pk_bf16_f32 v160, v160, v161
    v_mfma_f32_16x16x32_bf16 v[32:35], a[224:227], a[72:75], v[32:35]
    v_exp_f32 v162, v162
    v_mfma_f32_16x16x32_bf16 v[32:35], a[228:231], a[88:91], v[32:35]
    v_exp_f32 v163, v163
    v_mfma_f32_16x16x32_bf16 v[36:39], a[228:231], a[92:95], 0
    buffer_load_dwordx4 v6, s[16:19], s39 offen lds
    v_mfma_f32_16x16x32_bf16 v[36:39], a[224:227], a[76:79], v[36:39]
    v_exp_f32 v168, v168
    v_mfma_f32_16x16x32_bf16 v[36:39], a[220:223], a[60:63], v[36:39]
    v_exp_f32 v169, v169
    v_mfma_f32_16x16x32_bf16 v[36:39], a[216:219], a[44:47], v[36:39]
    s_waitcnt lgkmcnt(1)
    v_exp_f32 v170, v170
    v_mfma_f32_16x16x32_bf16 v[36:39], a[212:215], a[28:31], v[36:39]
    s_add_u32 s39, s40, 135168
    v_exp_f32 v171, v171
    v_mfma_f32_16x16x32_bf16 v[36:39], a[208:211], a[12:15], v[36:39]
    v_exp_f32 v176, v176
    v_mfma_f32_16x16x32_bf16 a[152:155], a[232:235], v[128:131], a[152:155]
    s_add_u32 m0, s63, 118784
    v_cvt_pk_bf16_f32 v161, v162, v163
    v_cvt_pk_bf16_f32 v168, v168, v169
    v_mfma_f32_16x16x32_bf16 a[168:171], a[236:239], v[128:131], a[168:171]
    v_exp_f32 v177, v177
    v_mfma_f32_16x16x32_bf16 a[172:175], a[236:239], v[136:139], a[172:175]
    ds_read_b128 a[208:211], v12 offset:18432
    v_cvt_pk_bf16_f32 v169, v170, v171
    v_mfma_f32_16x16x32_bf16 a[156:159], a[232:235], v[136:139], a[156:159]
    ds_read_b128 a[212:215], v13 offset:18432
    v_cvt_pk_bf16_f32 v176, v176, v177
    v_mfma_f32_16x16x32_bf16 a[160:163], a[232:235], v[144:147], a[160:163]
    ds_read_b128 a[216:219], v12 offset:19456
    v_accvgpr_write_b32 a117, v85
    v_mfma_f32_16x16x32_bf16 a[176:179], a[236:239], v[144:147], a[176:179]
    ds_read_b128 a[220:223], v13 offset:19456
    v_accvgpr_write_b32 a118, v86
    v_mfma_f32_16x16x32_bf16 a[180:183], a[236:239], v[152:155], a[180:183]
    buffer_load_dwordx4 v6, s[16:19], s39 offen lds
    v_mfma_f32_16x16x32_bf16 a[164:167], a[232:235], v[152:155], a[164:167]
    ds_read_b128 a[224:227], v12 offset:20480
    v_accvgpr_write_b32 a119, v87
    v_mfma_f32_16x16x32_bf16 v[164:167], a[184:187], a[0:3], 0
    v_exp_f32 v178, v178
    v_mfma_f32_16x16x32_bf16 v[164:167], a[188:191], a[16:19], v[164:167]
    v_exp_f32 v179, v179
    v_mfma_f32_16x16x32_bf16 v[164:167], a[192:195], a[32:35], v[164:167]
    s_waitcnt lgkmcnt(3)
    ds_read_b128 a[228:231], v13 offset:20480
    v_cvt_pk_bf16_f32 v177, v178, v179
    v_mfma_f32_16x16x32_bf16 v[164:167], a[196:199], a[48:51], v[164:167]
    v_exp_f32 v184, v184
    v_mfma_f32_16x16x32_bf16 v[164:167], a[200:203], a[64:67], v[164:167]
    v_exp_f32 v185, v185
    v_mfma_f32_16x16x32_bf16 v[164:167], a[204:207], a[80:83], v[164:167]
    v_exp_f32 v186, v186
    v_mfma_f32_16x16x32_bf16 v[172:175], a[204:207], a[84:87], 0
    v_exp_f32 v187, v187
    v_mfma_f32_16x16x32_bf16 v[172:175], a[200:203], a[68:71], v[172:175]
    v_exp_f32 v24, v24
    v_mfma_f32_16x16x32_bf16 v[172:175], a[196:199], a[52:55], v[172:175]
    v_exp_f32 v25, v25
    v_mfma_f32_16x16x32_bf16 v[172:175], a[192:195], a[36:39], v[172:175]
    v_exp_f32 v26, v26
    v_mfma_f32_16x16x32_bf16 v[172:175], a[188:191], a[20:23], v[172:175]
    v_exp_f32 v27, v27
    v_mfma_f32_16x16x32_bf16 v[172:175], a[184:187], a[4:7], v[172:175]
    v_cvt_pk_bf16_f32 v184, v184, v185
    v_cvt_pk_bf16_f32 v185, v186, v187
    v_mfma_f32_16x16x32_bf16 v[180:183], a[184:187], a[8:11], 0
    v_exp_f32 v28, v28
    v_mfma_f32_16x16x32_bf16 v[180:183], a[188:191], a[24:27], v[180:183]
    v_exp_f32 v29, v29
    v_mfma_f32_16x16x32_bf16 v[180:183], a[192:195], a[40:43], v[180:183]
    v_exp_f32 v30, v30
    v_mfma_f32_16x16x32_bf16 v[180:183], a[196:199], a[56:59], v[180:183]
    v_exp_f32 v31, v31
    v_mfma_f32_16x16x32_bf16 v[180:183], a[200:203], a[72:75], v[180:183]
    v_cvt_pk_bf16_f32 v162, v24, v25
    v_cvt_pk_bf16_f32 v163, v26, v27
    v_mfma_f32_16x16x32_bf16 v[180:183], a[204:207], a[88:91], v[180:183]
    v_exp_f32 v32, v32
    v_mfma_f32_16x16x32_bf16 v[188:191], a[204:207], a[92:95], 0
    v_exp_f32 v33, v33
    v_mfma_f32_16x16x32_bf16 v[188:191], a[200:203], a[76:79], v[188:191]
    v_exp_f32 v34, v34
    v_mfma_f32_16x16x32_bf16 v[188:191], a[196:199], a[60:63], v[188:191]
    s_add_u32 m0, s49, 0
    v_exp_f32 v35, v35
    v_mfma_f32_16x16x32_bf16 v[188:191], a[192:195], a[44:47], v[188:191]
    v_cvt_pk_bf16_f32 v170, v28, v29
    v_cvt_pk_bf16_f32 v171, v30, v31
    v_mfma_f32_16x16x32_bf16 v[188:191], a[188:191], a[28:31], v[188:191]
    v_exp_f32 v36, v36
    v_mfma_f32_16x16x32_bf16 v[188:191], a[184:187], a[12:15], v[188:191]
    s_waitcnt lgkmcnt(0)
    v_exp_f32 v37, v37
    v_mfma_f32_16x16x32_bf16 v[40:43], a[208:211], a[0:3], 0
    s_waitcnt vmcnt(11)
    v_exp_f32 v38, v38
    v_mfma_f32_16x16x32_bf16 v[40:43], a[212:215], a[16:19], v[40:43]
    s_barrier
    v_mfma_f32_16x16x32_bf16 v[40:43], a[216:219], a[32:35], v[40:43]
    buffer_load_dwordx4 v4, s[12:15], s38 offen offset:0 lds
    v_mfma_f32_16x16x32_bf16 v[40:43], a[220:223], a[48:51], v[40:43]
    ds_read_b64_tr_b16 a[240:241], v8 offset:20480
    v_cvt_pk_bf16_f32 v178, v32, v33
    v_mfma_f32_16x16x32_bf16 v[40:43], a[224:227], a[64:67], v[40:43]
    ds_read_b64_tr_b16 a[242:243], v8 offset:22528
    v_cvt_pk_bf16_f32 v179, v34, v35
    v_mfma_f32_16x16x32_bf16 v[40:43], a[228:231], a[80:83], v[40:43]
    ds_read_b64_tr_b16 a[244:245], v9 offset:20480
    v_cvt_pk_bf16_f32 v186, v36, v37
    v_mfma_f32_16x16x32_bf16 v[44:47], a[228:231], a[84:87], 0
    ds_read_b64_tr_b16 a[246:247], v9 offset:22528
    v_accvgpr_write_b32 a120, v88
    v_mfma_f32_16x16x32_bf16 v[44:47], a[224:227], a[68:71], v[44:47]
    ds_read_b128 a[184:187], v12 offset:24576
    v_accvgpr_write_b32 a121, v89
    v_mfma_f32_16x16x32_bf16 v[44:47], a[220:223], a[52:55], v[44:47]
    s_add_u32 m0, s49, 896
    ds_read_b128 a[188:191], v13 offset:24576
    v_accvgpr_write_b32 a122, v90
    v_mfma_f32_16x16x32_bf16 v[44:47], a[216:219], a[36:39], v[44:47]
    ds_read_b128 a[192:195], v12 offset:25600
    v_accvgpr_write_b32 a123, v91
    v_mfma_f32_16x16x32_bf16 v[44:47], a[212:215], a[20:23], v[44:47]
    v_exp_f32 v39, v39
    v_mfma_f32_16x16x32_bf16 v[44:47], a[208:211], a[4:7], v[44:47]
    ds_read_b128 a[196:199], v13 offset:25600
    v_cvt_pk_bf16_f32 v187, v38, v39
    v_mfma_f32_16x16x32_bf16 v[48:51], a[208:211], a[8:11], 0
    buffer_load_dword a252, v22, s[32:35], s42 offen offset:1536
    s_add_u32 s42, s42, 3072
    v_mfma_f32_16x16x32_bf16 v[48:51], a[212:215], a[24:27], v[48:51]
    v_exp_f32 v164, v164
    v_mfma_f32_16x16x32_bf16 v[48:51], a[216:219], a[40:43], v[48:51]
    buffer_load_dwordx4 v4, s[12:15], s38 offen offset:128 lds
    v_mfma_f32_16x16x32_bf16 v[48:51], a[220:223], a[56:59], v[48:51]
    ds_read_b128 a[200:203], v12 offset:26624
    v_accvgpr_write_b32 a124, v92
    v_mfma_f32_16x16x32_bf16 v[48:51], a[224:227], a[72:75], v[48:51]
    v_exp_f32 v165, v165
    v_mfma_f32_16x16x32_bf16 v[48:51], a[228:231], a[88:91], v[48:51]
    ds_read_b128 a[204:207], v13 offset:26624
    v_cvt_pk_bf16_f32 v164, v164, v165
    v_mfma_f32_16x16x32_bf16 v[52:55], a[228:231], a[92:95], 0
    v_exp_f32 v166, v166
    v_mfma_f32_16x16x32_bf16 v[52:55], a[224:227], a[76:79], v[52:55]
    v_exp_f32 v167, v167
    v_mfma_f32_16x16x32_bf16 v[52:55], a[220:223], a[60:63], v[52:55]
    s_add_u32 m0, s49, 1792
    v_exp_f32 v172, v172
    v_mfma_f32_16x16x32_bf16 v[52:55], a[216:219], a[44:47], v[52:55]
    s_waitcnt lgkmcnt(2)
    v_exp_f32 v173, v173
    v_mfma_f32_16x16x32_bf16 v[52:55], a[212:215], a[28:31], v[52:55]
    v_exp_f32 v174, v174
    v_mfma_f32_16x16x32_bf16 v[52:55], a[208:211], a[12:15], v[52:55]
    v_exp_f32 v175, v175
    v_mfma_f32_16x16x32_bf16 a[164:167], a[240:243], v[156:159], a[164:167]
    v_exp_f32 v180, v180
    v_mfma_f32_16x16x32_bf16 a[180:183], a[244:247], v[156:159], a[180:183]
    v_exp_f32 v181, v181
    v_mfma_f32_16x16x32_bf16 a[176:179], a[244:247], v[148:151], a[176:179]
    buffer_load_dwordx4 v4, s[12:15], s38 offen offset:256 lds
    v_mfma_f32_16x16x32_bf16 a[160:163], a[240:243], v[148:151], a[160:163]
    ds_read_b128 a[208:211], v12 offset:30720
    v_cvt_pk_bf16_f32 v165, v166, v167
    v_mfma_f32_16x16x32_bf16 a[156:159], a[240:243], v[140:143], a[156:159]
    ds_read_b128 a[212:215], v13 offset:30720
    v_cvt_pk_bf16_f32 v172, v172, v173
    v_mfma_f32_16x16x32_bf16 a[172:175], a[244:247], v[140:143], a[172:175]
    ds_read_b128 a[216:219], v12 offset:31744
    v_cvt_pk_bf16_f32 v173, v174, v175
    v_mfma_f32_16x16x32_bf16 a[168:171], a[244:247], v[132:135], a[168:171]
    ds_read_b128 a[220:223], v13 offset:31744
    v_cvt_pk_bf16_f32 v180, v180, v181
    v_mfma_f32_16x16x32_bf16 a[152:155], a[240:243], v[132:135], a[152:155]
    ds_read_b128 a[224:227], v12 offset:32768
    v_accvgpr_write_b32 a125, v93
    v_mfma_f32_16x16x32_bf16 v[192:195], a[184:187], a[0:3], 0
    s_add_u32 m0, s49, 3072
    ds_read_b128 a[228:231], v13 offset:32768
    v_accvgpr_write_b32 a126, v94
    v_mfma_f32_16x16x32_bf16 v[192:195], a[188:191], a[16:19], v[192:195]
    s_waitcnt lgkmcnt(6)
    v_exp_f32 v182, v182
    v_mfma_f32_16x16x32_bf16 v[192:195], a[192:195], a[32:35], v[192:195]
    v_exp_f32 v183, v183
    v_mfma_f32_16x16x32_bf16 v[192:195], a[196:199], a[48:51], v[192:195]
    v_exp_f32 v188, v188
    v_mfma_f32_16x16x32_bf16 v[192:195], a[200:203], a[64:67], v[192:195]
    v_exp_f32 v189, v189
    v_mfma_f32_16x16x32_bf16 v[192:195], a[204:207], a[80:83], v[192:195]
    v_exp_f32 v190, v190
    v_mfma_f32_16x16x32_bf16 v[200:203], a[204:207], a[84:87], 0
    buffer_load_dwordx4 v5, s[12:15], s38 offen offset:0 lds
    v_mfma_f32_16x16x32_bf16 v[200:203], a[200:203], a[68:71], v[200:203]
    v_exp_f32 v191, v191
    v_mfma_f32_16x16x32_bf16 v[200:203], a[196:199], a[52:55], v[200:203]
    v_exp_f32 v40, v40
    v_mfma_f32_16x16x32_bf16 v[200:203], a[192:195], a[36:39], v[200:203]
    v_exp_f32 v41, v41
    v_mfma_f32_16x16x32_bf16 v[200:203], a[188:191], a[20:23], v[200:203]
    v_cvt_pk_bf16_f32 v181, v182, v183
    v_cvt_pk_bf16_f32 v188, v188, v189
    v_mfma_f32_16x16x32_bf16 v[200:203], a[184:187], a[4:7], v[200:203]
    v_exp_f32 v42, v42
    v_mfma_f32_16x16x32_bf16 v[208:211], a[184:187], a[8:11], 0
    s_add_u32 m0, s49, 3968
    v_exp_f32 v43, v43
    v_mfma_f32_16x16x32_bf16 v[208:211], a[188:191], a[24:27], v[208:211]
    v_cvt_pk_bf16_f32 v189, v190, v191
    v_cvt_pk_bf16_f32 v166, v40, v41
    v_mfma_f32_16x16x32_bf16 v[208:211], a[192:195], a[40:43], v[208:211]
    v_exp_f32 v44, v44
    v_mfma_f32_16x16x32_bf16 v[208:211], a[196:199], a[56:59], v[208:211]
    v_exp_f32 v45, v45
    v_mfma_f32_16x16x32_bf16 v[208:211], a[200:203], a[72:75], v[208:211]
    v_exp_f32 v46, v46
    v_mfma_f32_16x16x32_bf16 v[208:211], a[204:207], a[88:91], v[208:211]
    v_exp_f32 v47, v47
    v_mfma_f32_16x16x32_bf16 v[216:219], a[204:207], a[92:95], 0
    buffer_load_dwordx4 v5, s[12:15], s38 offen offset:128 lds
    v_mfma_f32_16x16x32_bf16 v[216:219], a[200:203], a[76:79], v[216:219]
    ds_read_b64_tr_b16 a[232:233], v8 offset:24576
    v_cvt_pk_bf16_f32 v167, v42, v43
    v_mfma_f32_16x16x32_bf16 v[216:219], a[196:199], a[60:63], v[216:219]
    ds_read_b64_tr_b16 a[234:235], v8 offset:26624
    v_cvt_pk_bf16_f32 v174, v44, v45
    v_mfma_f32_16x16x32_bf16 v[216:219], a[192:195], a[44:47], v[216:219]
    s_waitcnt lgkmcnt(2)
    ds_read_b64_tr_b16 a[236:237], v9 offset:24576
    v_cvt_pk_bf16_f32 v175, v46, v47
    v_mfma_f32_16x16x32_bf16 v[216:219], a[188:191], a[28:31], v[216:219]
    ds_read_b64_tr_b16 a[238:239], v9 offset:26624
    v_accvgpr_write_b32 a127, v95
    v_mfma_f32_16x16x32_bf16 v[216:219], a[184:187], a[12:15], v[216:219]
    v_exp_f32 v48, v48
    v_mfma_f32_16x16x32_bf16 v[24:27], a[208:211], a[0:3], 0
    s_add_u32 m0, s49, 4864
    v_exp_f32 v49, v49
    v_mfma_f32_16x16x32_bf16 v[24:27], a[212:215], a[16:19], v[24:27]
    v_exp_f32 v50, v50
    v_mfma_f32_16x16x32_bf16 v[24:27], a[216:219], a[32:35], v[24:27]
    ds_read_b128 a[184:187], v12 offset:36864
    v_cvt_pk_bf16_f32 v182, v48, v49
    v_mfma_f32_16x16x32_bf16 v[24:27], a[220:223], a[48:51], v[24:27]
    ds_read_b128 a[188:191], v13 offset:36864
    v_accvgpr_write_b32 a128, v96
    v_mfma_f32_16x16x32_bf16 v[24:27], a[224:227], a[64:67], v[24:27]
    ds_read_b128 a[192:195], v12 offset:37888
    v_accvgpr_write_b32 a129, v97
    v_mfma_f32_16x16x32_bf16 v[24:27], a[228:231], a[80:83], v[24:27]
    ds_read_b128 a[196:199], v13 offset:37888
    v_accvgpr_write_b32 a130, v98
    v_mfma_f32_16x16x32_bf16 v[28:31], a[228:231], a[84:87], 0
    buffer_load_dwordx4 v5, s[12:15], s38 offen offset:256 lds
    v_mfma_f32_16x16x32_bf16 v[28:31], a[224:227], a[68:71], v[28:31]
    s_add_u32 s38, s38, 24576
    v_exp_f32 v51, v51
    v_mfma_f32_16x16x32_bf16 v[28:31], a[220:223], a[52:55], v[28:31]
    ds_read_b128 a[200:203], v12 offset:38912
    v_cvt_pk_bf16_f32 v183, v50, v51
    v_mfma_f32_16x16x32_bf16 v[28:31], a[216:219], a[36:39], v[28:31]
    v_exp_f32 v52, v52
    v_mfma_f32_16x16x32_bf16 v[28:31], a[212:215], a[20:23], v[28:31]
    s_add_u32 s39, s40, 147456
    v_exp_f32 v53, v53
    v_mfma_f32_16x16x32_bf16 v[28:31], a[208:211], a[4:7], v[28:31]
    ds_read_b128 a[204:207], v13 offset:38912
    v_cvt_pk_bf16_f32 v190, v52, v53
    v_mfma_f32_16x16x32_bf16 v[32:35], a[208:211], a[8:11], 0
    s_add_u32 m0, s63, 122880
    v_exp_f32 v54, v54
    v_mfma_f32_16x16x32_bf16 v[32:35], a[212:215], a[24:27], v[32:35]
    v_exp_f32 v55, v55
    v_mfma_f32_16x16x32_bf16 v[32:35], a[216:219], a[40:43], v[32:35]
    v_exp_f32 v192, v192
    v_mfma_f32_16x16x32_bf16 v[32:35], a[220:223], a[56:59], v[32:35]
    v_exp_f32 v193, v193
    v_mfma_f32_16x16x32_bf16 v[32:35], a[224:227], a[72:75], v[32:35]
    v_exp_f32 v194, v194
    v_mfma_f32_16x16x32_bf16 v[32:35], a[228:231], a[88:91], v[32:35]
    v_exp_f32 v195, v195
    v_mfma_f32_16x16x32_bf16 v[36:39], a[228:231], a[92:95], 0
    buffer_load_dwordx4 v6, s[16:19], s39 offen lds
    v_mfma_f32_16x16x32_bf16 v[36:39], a[224:227], a[76:79], v[36:39]
    v_exp_f32 v200, v200
    v_mfma_f32_16x16x32_bf16 v[36:39], a[220:223], a[60:63], v[36:39]
    v_exp_f32 v201, v201
    v_mfma_f32_16x16x32_bf16 v[36:39], a[216:219], a[44:47], v[36:39]
    s_waitcnt lgkmcnt(0)
    v_cvt_pk_bf16_f32 v191, v54, v55
    v_cvt_pk_bf16_f32 v192, v192, v193
    v_mfma_f32_16x16x32_bf16 v[36:39], a[212:215], a[28:31], v[36:39]
    s_add_u32 s39, s40, 159744
    v_exp_f32 v202, v202
    v_mfma_f32_16x16x32_bf16 v[36:39], a[208:211], a[12:15], v[36:39]
    v_exp_f32 v203, v203
    v_mfma_f32_16x16x32_bf16 a[152:155], a[232:235], v[160:163], a[152:155]
    s_add_u32 m0, s63, 126976
    v_cvt_pk_bf16_f32 v193, v194, v195
    v_cvt_pk_bf16_f32 v200, v200, v201
    v_mfma_f32_16x16x32_bf16 a[168:171], a[236:239], v[160:163], a[168:171]
    v_exp_f32 v208, v208
    v_mfma_f32_16x16x32_bf16 a[172:175], a[236:239], v[168:171], a[172:175]
    ds_read_b128 a[208:211], v12 offset:43008
    v_cvt_pk_bf16_f32 v201, v202, v203
    v_mfma_f32_16x16x32_bf16 a[156:159], a[232:235], v[168:171], a[156:159]
    ds_read_b128 a[212:215], v13 offset:43008
    v_accvgpr_write_b32 a131, v99
    v_mfma_f32_16x16x32_bf16 a[160:163], a[232:235], v[176:179], a[160:163]
    ds_read_b128 a[216:219], v12 offset:44032
    v_accvgpr_write_b32 a132, v100
    v_mfma_f32_16x16x32_bf16 a[176:179], a[236:239], v[176:179], a[176:179]
    ds_read_b128 a[220:223], v13 offset:44032
    v_accvgpr_write_b32 a133, v101
    v_mfma_f32_16x16x32_bf16 a[180:183], a[236:239], v[184:187], a[180:183]
    buffer_load_dwordx4 v6, s[16:19], s39 offen lds
    v_mfma_f32_16x16x32_bf16 a[164:167], a[232:235], v[184:187], a[164:167]
    v_exp_f32 v209, v209
    v_mfma_f32_16x16x32_bf16 v[196:199], a[184:187], a[0:3], 0
    ds_read_b128 a[224:227], v12 offset:45056
    v_cvt_pk_bf16_f32 v208, v208, v209
    v_mfma_f32_16x16x32_bf16 v[196:199], a[188:191], a[16:19], v[196:199]
    v_exp_f32 v210, v210
    v_mfma_f32_16x16x32_bf16 v[196:199], a[192:195], a[32:35], v[196:199]
    v_exp_f32 v211, v211
    v_mfma_f32_16x16x32_bf16 v[196:199], a[196:199], a[48:51], v[196:199]
    ds_read_b128 a[228:231], v13 offset:45056
    v_cvt_pk_bf16_f32 v209, v210, v211
    v_mfma_f32_16x16x32_bf16 v[196:199], a[200:203], a[64:67], v[196:199]
    v_exp_f32 v216, v216
    v_mfma_f32_16x16x32_bf16 v[196:199], a[204:207], a[80:83], v[196:199]
    v_exp_f32 v217, v217
    v_mfma_f32_16x16x32_bf16 v[204:207], a[204:207], a[84:87], 0
    v_exp_f32 v218, v218
    v_mfma_f32_16x16x32_bf16 v[204:207], a[200:203], a[68:71], v[204:207]
    v_exp_f32 v219, v219
    v_mfma_f32_16x16x32_bf16 v[204:207], a[196:199], a[52:55], v[204:207]
    v_exp_f32 v24, v24
    v_mfma_f32_16x16x32_bf16 v[204:207], a[192:195], a[36:39], v[204:207]
    v_exp_f32 v25, v25
    v_mfma_f32_16x16x32_bf16 v[204:207], a[188:191], a[20:23], v[204:207]
    v_exp_f32 v26, v26
    v_mfma_f32_16x16x32_bf16 v[204:207], a[184:187], a[4:7], v[204:207]
    v_exp_f32 v27, v27
    v_mfma_f32_16x16x32_bf16 v[212:215], a[184:187], a[8:11], 0
    v_cvt_pk_bf16_f32 v216, v216, v217
    v_cvt_pk_bf16_f32 v217, v218, v219
    v_mfma_f32_16x16x32_bf16 v[212:215], a[188:191], a[24:27], v[212:215]
    v_exp_f32 v28, v28
    v_mfma_f32_16x16x32_bf16 v[212:215], a[192:195], a[40:43], v[212:215]
    v_exp_f32 v29, v29
    v_mfma_f32_16x16x32_bf16 v[212:215], a[196:199], a[56:59], v[212:215]
    v_exp_f32 v30, v30
    v_mfma_f32_16x16x32_bf16 v[212:215], a[200:203], a[72:75], v[212:215]
    v_exp_f32 v31, v31
    v_mfma_f32_16x16x32_bf16 v[212:215], a[204:207], a[88:91], v[212:215]
    v_cvt_pk_bf16_f32 v194, v24, v25
    v_cvt_pk_bf16_f32 v195, v26, v27
    v_mfma_f32_16x16x32_bf16 v[220:223], a[204:207], a[92:95], 0
    v_exp_f32 v32, v32
    v_mfma_f32_16x16x32_bf16 v[220:223], a[200:203], a[76:79], v[220:223]
    v_exp_f32 v33, v33
    v_mfma_f32_16x16x32_bf16 v[220:223], a[196:199], a[60:63], v[220:223]
    s_add_u32 m0, s49, 24576
    v_exp_f32 v34, v34
    v_mfma_f32_16x16x32_bf16 v[220:223], a[192:195], a[44:47], v[220:223]
    s_waitcnt lgkmcnt(0)
    v_exp_f32 v35, v35
    v_mfma_f32_16x16x32_bf16 v[220:223], a[188:191], a[28:31], v[220:223]
    v_cvt_pk_bf16_f32 v202, v28, v29
    v_cvt_pk_bf16_f32 v203, v30, v31
    v_mfma_f32_16x16x32_bf16 v[220:223], a[184:187], a[12:15], v[220:223]
    v_exp_f32 v36, v36
    v_mfma_f32_16x16x32_bf16 v[40:43], a[208:211], a[0:3], 0
    s_waitcnt vmcnt(11)
    v_exp_f32 v37, v37
    v_mfma_f32_16x16x32_bf16 v[40:43], a[212:215], a[16:19], v[40:43]
    s_barrier
    v_mfma_f32_16x16x32_bf16 v[40:43], a[216:219], a[32:35], v[40:43]
    buffer_load_dwordx4 v4, s[12:15], s38 offen offset:0 lds
    v_mfma_f32_16x16x32_bf16 v[40:43], a[220:223], a[48:51], v[40:43]
    ds_read_b64_tr_b16 a[240:241], v8 offset:28672
    v_cvt_pk_bf16_f32 v210, v32, v33
    v_mfma_f32_16x16x32_bf16 v[40:43], a[224:227], a[64:67], v[40:43]
    ds_read_b64_tr_b16 a[242:243], v8 offset:30720
    v_cvt_pk_bf16_f32 v211, v34, v35
    v_mfma_f32_16x16x32_bf16 v[40:43], a[228:231], a[80:83], v[40:43]
    ds_read_b64_tr_b16 a[244:245], v9 offset:28672
    v_cvt_pk_bf16_f32 v218, v36, v37
    v_mfma_f32_16x16x32_bf16 v[44:47], a[228:231], a[84:87], 0
    ds_read_b64_tr_b16 a[246:247], v9 offset:30720
    v_accvgpr_write_b32 a134, v102
    v_mfma_f32_16x16x32_bf16 v[44:47], a[224:227], a[68:71], v[44:47]
    ds_read_b128 a[184:187], v12 offset:49152
    v_accvgpr_write_b32 a135, v103
    v_mfma_f32_16x16x32_bf16 v[44:47], a[220:223], a[52:55], v[44:47]
    s_add_u32 m0, s49, 25472
    ds_read_b128 a[188:191], v13 offset:49152
    v_accvgpr_write_b32 a136, v104
    v_mfma_f32_16x16x32_bf16 v[44:47], a[216:219], a[36:39], v[44:47]
    ds_read_b128 a[192:195], v12 offset:50176
    v_accvgpr_write_b32 a137, v105
    v_mfma_f32_16x16x32_bf16 v[44:47], a[212:215], a[20:23], v[44:47]
    v_exp_f32 v38, v38
    v_mfma_f32_16x16x32_bf16 v[44:47], a[208:211], a[4:7], v[44:47]
    v_exp_f32 v39, v39
    v_mfma_f32_16x16x32_bf16 v[48:51], a[208:211], a[8:11], 0
    buffer_load_dword a252, v22, s[32:35], s42 offen offset:0
    v_mfma_f32_16x16x32_bf16 v[48:51], a[212:215], a[24:27], v[48:51]
    s_add_u32 s32, s7, 1
    ds_read_b128 a[196:199], v13 offset:50176
    v_cvt_pk_bf16_f32 v219, v38, v39
    v_mfma_f32_16x16x32_bf16 v[48:51], a[216:219], a[40:43], v[48:51]
    buffer_load_dwordx4 v4, s[12:15], s38 offen offset:128 lds
    v_mfma_f32_16x16x32_bf16 v[48:51], a[220:223], a[56:59], v[48:51]
    s_add_u32 s33, s7, 1
    ds_read_b128 a[200:203], v12 offset:51200
    v_accvgpr_write_b32 a138, v106
    v_mfma_f32_16x16x32_bf16 v[48:51], a[224:227], a[72:75], v[48:51]
    s_add_u32 s34, s7, 1
    v_exp_f32 v196, v196
    v_mfma_f32_16x16x32_bf16 v[48:51], a[228:231], a[88:91], v[48:51]
    s_add_u32 s35, s7, 1
    v_exp_f32 v197, v197
    v_mfma_f32_16x16x32_bf16 v[52:55], a[228:231], a[92:95], 0
    ds_read_b128 a[204:207], v13 offset:51200
    v_cvt_pk_bf16_f32 v196, v196, v197
    v_mfma_f32_16x16x32_bf16 v[52:55], a[224:227], a[76:79], v[52:55]
    v_exp_f32 v198, v198
    v_mfma_f32_16x16x32_bf16 v[52:55], a[220:223], a[60:63], v[52:55]
    s_add_u32 m0, s49, 26368
    v_exp_f32 v199, v199
    v_mfma_f32_16x16x32_bf16 v[52:55], a[216:219], a[44:47], v[52:55]
    s_waitcnt lgkmcnt(2)
    v_exp_f32 v204, v204
    v_mfma_f32_16x16x32_bf16 v[52:55], a[212:215], a[28:31], v[52:55]
    v_exp_f32 v205, v205
    v_mfma_f32_16x16x32_bf16 v[52:55], a[208:211], a[12:15], v[52:55]
    v_exp_f32 v206, v206
    v_mfma_f32_16x16x32_bf16 a[164:167], a[240:243], v[188:191], a[164:167]
    v_exp_f32 v207, v207
    v_mfma_f32_16x16x32_bf16 a[180:183], a[244:247], v[188:191], a[180:183]
    v_exp_f32 v212, v212
    v_mfma_f32_16x16x32_bf16 a[176:179], a[244:247], v[180:183], a[176:179]
    buffer_load_dwordx4 v4, s[12:15], s38 offen offset:256 lds
    v_mfma_f32_16x16x32_bf16 a[160:163], a[240:243], v[180:183], a[160:163]
    ds_read_b128 a[208:211], v12 offset:55296
    v_cvt_pk_bf16_f32 v197, v198, v199
    v_mfma_f32_16x16x32_bf16 a[156:159], a[240:243], v[172:175], a[156:159]
    ds_read_b128 a[212:215], v13 offset:55296
    v_cvt_pk_bf16_f32 v204, v204, v205
    v_mfma_f32_16x16x32_bf16 a[172:175], a[244:247], v[172:175], a[172:175]
    ds_read_b128 a[216:219], v12 offset:56320
    v_cvt_pk_bf16_f32 v205, v206, v207
    v_mfma_f32_16x16x32_bf16 a[168:171], a[244:247], v[164:167], a[168:171]
    ds_read_b128 a[220:223], v13 offset:56320
    v_accvgpr_write_b32 a139, v107
    v_mfma_f32_16x16x32_bf16 a[152:155], a[240:243], v[164:167], a[152:155]
    ds_read_b128 a[224:227], v12 offset:57344
    v_accvgpr_write_b32 a140, v108
    v_mfma_f32_16x16x32_bf16 v[224:227], a[184:187], a[0:3], 0
    s_add_u32 m0, s49, 27648
    v_exp_f32 v213, v213
    v_mfma_f32_16x16x32_bf16 v[224:227], a[188:191], a[16:19], v[224:227]
    s_waitcnt lgkmcnt(5)
    ds_read_b128 a[228:231], v13 offset:57344
    v_cvt_pk_bf16_f32 v212, v212, v213
    v_mfma_f32_16x16x32_bf16 v[224:227], a[192:195], a[32:35], v[224:227]
    v_exp_f32 v214, v214
    v_mfma_f32_16x16x32_bf16 v[224:227], a[196:199], a[48:51], v[224:227]
    v_exp_f32 v215, v215
    v_mfma_f32_16x16x32_bf16 v[224:227], a[200:203], a[64:67], v[224:227]
pg_7:
    s_cbranch_execz pg_11
    v_exp_f32 v220, v220
    v_mfma_f32_16x16x32_bf16 v[224:227], a[204:207], a[80:83], v[224:227]
    v_exp_f32 v221, v221
    v_mfma_f32_16x16x32_bf16 v[232:235], a[204:207], a[84:87], 0
    buffer_load_dwordx4 v5, s[12:15], s38 offen offset:0 lds
    v_mfma_f32_16x16x32_bf16 v[232:235], a[200:203], a[68:71], v[232:235]
    v_exp_f32 v222, v222
    v_mfma_f32_16x16x32_bf16 v[232:235], a[196:199], a[52:55], v[232:235]
    v_exp_f32 v223, v223
    v_mfma_f32_16x16x32_bf16 v[232:235], a[192:195], a[36:39], v[232:235]
    v_exp_f32 v40, v40
    v_mfma_f32_16x16x32_bf16 v[232:235], a[188:191], a[20:23], v[232:235]
    v_exp_f32 v41, v41
    v_mfma_f32_16x16x32_bf16 v[232:235], a[184:187], a[4:7], v[232:235]
    v_cvt_pk_bf16_f32 v213, v214, v215
    v_cvt_pk_bf16_f32 v220, v220, v221
    v_mfma_f32_16x16x32_bf16 v[240:243], a[184:187], a[8:11], 0
    s_add_u32 m0, s49, 28544
    v_exp_f32 v42, v42
    v_mfma_f32_16x16x32_bf16 v[240:243], a[188:191], a[24:27], v[240:243]
    v_exp_f32 v43, v43
    v_mfma_f32_16x16x32_bf16 v[240:243], a[192:195], a[40:43], v[240:243]
    v_cvt_pk_bf16_f32 v221, v222, v223
    v_cvt_pk_bf16_f32 v198, v40, v41
    v_mfma_f32_16x16x32_bf16 v[240:243], a[196:199], a[56:59], v[240:243]
    v_exp_f32 v44, v44
    v_mfma_f32_16x16x32_bf16 v[240:243], a[200:203], a[72:75], v[240:243]
    v_exp_f32 v45, v45
    v_mfma_f32_16x16x32_bf16 v[240:243], a[204:207], a[88:91], v[240:243]
    v_exp_f32 v46, v46
    v_mfma_f32_16x16x32_bf16 v[248:251], a[204:207], a[92:95], 0
    buffer_load_dwordx4 v5, s[12:15], s38 offen offset:128 lds
    v_mfma_f32_16x16x32_bf16 v[248:251], a[200:203], a[76:79], v[248:251]
    ds_read_b64_tr_b16 a[232:233], v8 offset:32768
    v_cvt_pk_bf16_f32 v199, v42, v43
    v_mfma_f32_16x16x32_bf16 v[248:251], a[196:199], a[60:63], v[248:251]
    ds_read_b64_tr_b16 a[234:235], v8 offset:34816
    v_cvt_pk_bf16_f32 v206, v44, v45
    v_mfma_f32_16x16x32_bf16 v[248:251], a[192:195], a[44:47], v[248:251]
    s_waitcnt lgkmcnt(2)
    ds_read_b64_tr_b16 a[236:237], v9 offset:32768
    v_accvgpr_write_b32 a141, v109
    v_mfma_f32_16x16x32_bf16 v[248:251], a[188:191], a[28:31], v[248:251]
    ds_read_b64_tr_b16 a[238:239], v9 offset:34816
    v_accvgpr_write_b32 a142, v110
    v_mfma_f32_16x16x32_bf16 v[248:251], a[184:187], a[12:15], v[248:251]
    v_exp_f32 v47, v47
    v_mfma_f32_16x16x32_bf16 v[24:27], a[208:211], a[0:3], 0
    s_add_u32 m0, s49, 29440
    v_exp_f32 v48, v48
    v_mfma_f32_16x16x32_bf16 v[24:27], a[212:215], a[16:19], v[24:27]
    v_exp_f32 v49, v49
    v_mfma_f32_16x16x32_bf16 v[24:27], a[216:219], a[32:35], v[24:27]
    ds_read_b128 a[184:187], v12 offset:61440
    v_cvt_pk_bf16_f32 v207, v46, v47
    v_mfma_f32_16x16x32_bf16 v[24:27], a[220:223], a[48:51], v[24:27]
    ds_read_b128 a[188:191], v13 offset:61440
    v_cvt_pk_bf16_f32 v214, v48, v49
    v_mfma_f32_16x16x32_bf16 v[24:27], a[224:227], a[64:67], v[24:27]
    ds_read_b128 a[192:195], v12 offset:62464
    v_accvgpr_write_b32 a143, v111
    v_mfma_f32_16x16x32_bf16 v[24:27], a[228:231], a[80:83], v[24:27]
    ds_read_b128 a[196:199], v13 offset:62464
    v_accvgpr_write_b32 a144, v112
    v_mfma_f32_16x16x32_bf16 v[28:31], a[228:231], a[84:87], 0
    buffer_load_dwordx4 v5, s[12:15], s38 offen offset:256 lds
    v_mfma_f32_16x16x32_bf16 v[28:31], a[224:227], a[68:71], v[28:31]
    s_add_u32 s38, s38, 24576
    v_exp_f32 v50, v50
    v_mfma_f32_16x16x32_bf16 v[28:31], a[220:223], a[52:55], v[28:31]
    v_exp_f32 v51, v51
    v_mfma_f32_16x16x32_bf16 v[28:31], a[216:219], a[36:39], v[28:31]
    ds_read_b128 a[200:203], v12 offset:63488
    v_cvt_pk_bf16_f32 v215, v50, v51
    v_mfma_f32_16x16x32_bf16 v[28:31], a[212:215], a[20:23], v[28:31]
    s_add_u32 s39, s40, 172032
    ds_read_b128 a[204:207], v13 offset:63488
    v_add_u32 v12, 67584, v12
    v_mfma_f32_16x16x32_bf16 v[28:31], a[208:211], a[4:7], v[28:31]
    v_exp_f32 v52, v52
    v_mfma_f32_16x16x32_bf16 v[32:35], a[208:211], a[8:11], 0
    s_add_u32 m0, s63, 131072
    v_exp_f32 v53, v53
    v_mfma_f32_16x16x32_bf16 v[32:35], a[212:215], a[24:27], v[32:35]
    v_exp_f32 v54, v54
    v_mfma_f32_16x16x32_bf16 v[32:35], a[216:219], a[40:43], v[32:35]
    v_exp_f32 v55, v55
    v_mfma_f32_16x16x32_bf16 v[32:35], a[220:223], a[56:59], v[32:35]
    v_cvt_pk_bf16_f32 v222, v52, v53
    v_cvt_pk_bf16_f32 v223, v54, v55
    v_mfma_f32_16x16x32_bf16 v[32:35], a[224:227], a[72:75], v[32:35]
    v_exp_f32 v224, v224
    v_mfma_f32_16x16x32_bf16 v[32:35], a[228:231], a[88:91], v[32:35]
    v_exp_f32 v225, v225
    v_mfma_f32_16x16x32_bf16 v[36:39], a[228:231], a[92:95], 0
    buffer_load_dwordx4 v6, s[16:19], s39 offen lds
    v_mfma_f32_16x16x32_bf16 v[36:39], a[224:227], a[76:79], v[36:39]
    v_exp_f32 v226, v226
    v_mfma_f32_16x16x32_bf16 v[36:39], a[220:223], a[60:63], v[36:39]
    v_exp_f32 v227, v227
    v_mfma_f32_16x16x32_bf16 v[36:39], a[216:219], a[44:47], v[36:39]
    s_waitcnt lgkmcnt(0)
    v_exp_f32 v232, v232
    v_mfma_f32_16x16x32_bf16 v[36:39], a[212:215], a[28:31], v[36:39]
    s_add_u32 s39, s40, 184320
    v_exp_f32 v233, v233
    v_mfma_f32_16x16x32_bf16 v[36:39], a[208:211], a[12:15], v[36:39]
    v_exp_f32 v234, v234
    v_mfma_f32_16x16x32_bf16 a[152:155], a[232:235], v[192:195], a[152:155]
    s_add_u32 m0, s63, 135168
    v_exp_f32 v235, v235
    v_mfma_f32_16x16x32_bf16 a[168:171], a[236:239], v[192:195], a[168:171]
    v_cvt_pk_bf16_f32 v224, v224, v225
    v_cvt_pk_bf16_f32 v225, v226, v227
    v_mfma_f32_16x16x32_bf16 a[172:175], a[236:239], v[200:203], a[172:175]
    ds_read_b128 a[208:211], v12 offset:0
    v_cvt_pk_bf16_f32 v232, v232, v233
    v_mfma_f32_16x16x32_bf16 a[156:159], a[232:235], v[200:203], a[156:159]
    v_exp_f32 v240, v240
    v_mfma_f32_16x16x32_bf16 a[160:163], a[232:235], v[208:211], a[160:163]
    v_exp_f32 v241, v241
    v_mfma_f32_16x16x32_bf16 a[176:179], a[236:239], v[208:211], a[176:179]
    v_exp_f32 v242, v242
    v_mfma_f32_16x16x32_bf16 a[180:183], a[236:239], v[216:219], a[180:183]
    buffer_load_dwordx4 v6, s[16:19], s39 offen lds
    v_mfma_f32_16x16x32_bf16 a[164:167], a[232:235], v[216:219], a[164:167]
    v_exp_f32 v243, v243
    v_mfma_f32_16x16x32_bf16 v[228:231], a[184:187], a[0:3], 0
    v_cvt_pk_bf16_f32 v233, v234, v235
    v_cvt_pk_bf16_f32 v240, v240, v241
    v_mfma_f32_16x16x32_bf16 v[228:231], a[188:191], a[16:19], v[228:231]
    v_exp_f32 v248, v248
    v_mfma_f32_16x16x32_bf16 v[228:231], a[192:195], a[32:35], v[228:231]
    v_exp_f32 v249, v249
    v_mfma_f32_16x16x32_bf16 v[228:231], a[196:199], a[48:51], v[228:231]
    v_exp_f32 v250, v250
    v_mfma_f32_16x16x32_bf16 v[228:231], a[200:203], a[64:67], v[228:231]
    v_exp_f32 v251, v251
    v_mfma_f32_16x16x32_bf16 v[228:231], a[204:207], a[80:83], v[228:231]
    v_cvt_pk_bf16_f32 v241, v242, v243
    v_cvt_pk_bf16_f32 v248, v248, v249
    v_mfma_f32_16x16x32_bf16 v[236:239], a[204:207], a[84:87], 0
    v_exp_f32 v24, v24
    v_mfma_f32_16x16x32_bf16 v[236:239], a[200:203], a[68:71], v[236:239]
    v_exp_f32 v25, v25
    v_mfma_f32_16x16x32_bf16 v[236:239], a[196:199], a[52:55], v[236:239]
    v_exp_f32 v26, v26
    v_mfma_f32_16x16x32_bf16 v[236:239], a[192:195], a[36:39], v[236:239]
    v_exp_f32 v27, v27
    v_mfma_f32_16x16x32_bf16 v[236:239], a[188:191], a[20:23], v[236:239]
    v_cvt_pk_bf16_f32 v249, v250, v251
    v_cvt_pk_bf16_f32 v226, v24, v25
    v_mfma_f32_16x16x32_bf16 v[236:239], a[184:187], a[4:7], v[236:239]
    v_exp_f32 v28, v28
    v_mfma_f32_16x16x32_bf16 v[244:247], a[184:187], a[8:11], 0
    v_exp_f32 v29, v29
    v_mfma_f32_16x16x32_bf16 v[244:247], a[188:191], a[24:27], v[244:247]
    v_exp_f32 v30, v30
    v_add_u32 v13, 67584, v13
    v_mfma_f32_16x16x32_bf16 v[244:247], a[192:195], a[40:43], v[244:247]
    ds_read_b128 a[212:215], v13 offset:0
    v_cvt_pk_bf16_f32 v227, v26, v27
    v_mfma_f32_16x16x32_bf16 v[244:247], a[196:199], a[56:59], v[244:247]
    ds_read_b128 a[216:219], v12 offset:1024
    v_cvt_pk_bf16_f32 v234, v28, v29
    v_mfma_f32_16x16x32_bf16 v[244:247], a[200:203], a[72:75], v[244:247]
    ds_read_b128 a[220:223], v13 offset:1024
    v_accvgpr_write_b32 a145, v113
    v_mfma_f32_16x16x32_bf16 v[244:247], a[204:207], a[88:91], v[244:247]
    ds_read_b128 a[224:227], v12 offset:2048
    v_accvgpr_write_b32 a146, v114
    v_mfma_f32_16x16x32_bf16 v[252:255], a[204:207], a[92:95], 0
    s_add_u32 s39, s40, 128
    ds_read_b128 a[228:231], v13 offset:2048
    v_accvgpr_write_b32 a147, v115
    v_mfma_f32_16x16x32_bf16 v[252:255], a[200:203], a[76:79], v[252:255]
    v_exp_f32 v31, v31
    v_mfma_f32_16x16x32_bf16 v[252:255], a[196:199], a[60:63], v[252:255]
    s_add_u32 m0, s63, 49152
    v_exp_f32 v32, v32
    v_mfma_f32_16x16x32_bf16 v[252:255], a[192:195], a[44:47], v[252:255]
    s_waitcnt lgkmcnt(4)
    v_exp_f32 v33, v33
    v_mfma_f32_16x16x32_bf16 v[252:255], a[188:191], a[28:31], v[252:255]
    v_exp_f32 v34, v34
    v_mfma_f32_16x16x32_bf16 v[252:255], a[184:187], a[12:15], v[252:255]
    s_waitcnt lgkmcnt(2)
    v_exp_f32 v35, v35
    v_mfma_f32_16x16x32_bf16 v[40:43], a[208:211], a[0:3], 0
    s_waitcnt vmcnt(11) lgkmcnt(0)
    v_cvt_pk_bf16_f32 v235, v30, v31
    v_cvt_pk_bf16_f32 v242, v32, v33
    v_mfma_f32_16x16x32_bf16 v[40:43], a[212:215], a[16:19], v[40:43]
    s_barrier
    v_mfma_f32_16x16x32_bf16 v[40:43], a[216:219], a[32:35], v[40:43]
    buffer_load_dwordx4 v6, s[16:19], s39 offen lds
    v_mfma_f32_16x16x32_bf16 v[40:43], a[220:223], a[48:51], v[40:43]
    ds_read_b64_tr_b16 a[240:241], v8 offset:36864
    v_cvt_pk_bf16_f32 v243, v34, v35
    v_mfma_f32_16x16x32_bf16 v[40:43], a[224:227], a[64:67], v[40:43]
    ds_read_b64_tr_b16 a[242:243], v8 offset:38912
    v_subrev_u32 v12, 67584, v12
    v_mfma_f32_16x16x32_bf16 v[40:43], a[228:231], a[80:83], v[40:43]
    ds_read_b64_tr_b16 a[244:245], v9 offset:36864
    v_accvgpr_write_b32 a148, v116
    v_mfma_f32_16x16x32_bf16 v[44:47], a[228:231], a[84:87], 0
    s_add_u32 s39, s40, 12416
    ds_read_b64_tr_b16 a[246:247], v9 offset:38912
    v_subrev_u32 v13, 67584, v13
    v_mfma_f32_16x16x32_bf16 v[44:47], a[224:227], a[68:71], v[44:47]
    ds_read_b128 a[184:187], v12 offset:0
    v_accvgpr_write_b32 a149, v117
    v_mfma_f32_16x16x32_bf16 v[44:47], a[220:223], a[52:55], v[44:47]
    s_add_u32 m0, s63, 53248
    ds_read_b128 a[188:191], v13 offset:0
    v_accvgpr_write_b32 a150, v118
    v_mfma_f32_16x16x32_bf16 v[44:47], a[216:219], a[36:39], v[44:47]
    ds_read_b128 a[192:195], v12 offset:1024
    v_accvgpr_write_b32 a151, v119
    v_mfma_f32_16x16x32_bf16 v[44:47], a[212:215], a[20:23], v[44:47]
    v_exp_f32 v36, v36
    v_mfma_f32_16x16x32_bf16 v[44:47], a[208:211], a[4:7], v[44:47]
    v_exp_f32 v37, v37
    v_mfma_f32_16x16x32_bf16 v[48:51], a[208:211], a[8:11], 0
    s_lshl_b32 s42, s54, 4
    ds_read_b128 a[196:199], v13 offset:1024
    v_cvt_pk_bf16_f32 v250, v36, v37
    v_mfma_f32_16x16x32_bf16 v[48:51], a[212:215], a[24:27], v[48:51]
    s_mul_i32 s42, s42, 384
    ds_read_b128 a[200:203], v12 offset:2048
    v_and_b32 v22, 15, v1
    v_mfma_f32_16x16x32_bf16 v[48:51], a[216:219], a[40:43], v[48:51]
    buffer_load_dwordx4 v6, s[16:19], s39 offen lds
    v_mfma_f32_16x16x32_bf16 v[48:51], a[220:223], a[56:59], v[48:51]
    ds_read_b128 a[204:207], v13 offset:2048
    v_mul_u32_u24 v22, 384, v22
    v_mfma_f32_16x16x32_bf16 v[48:51], a[224:227], a[72:75], v[48:51]
    buffer_load_dword a252, v22, s[16:19], s42 offen offset:256
    v_mfma_f32_16x16x32_bf16 v[48:51], a[228:231], a[88:91], v[48:51]
    v_exp_f32 v38, v38
    v_mfma_f32_16x16x32_bf16 v[52:55], a[228:231], a[92:95], 0
    s_add_u32 s39, s40, 24704
    v_exp_f32 v39, v39
    v_mfma_f32_16x16x32_bf16 v[52:55], a[224:227], a[76:79], v[52:55]
    v_exp_f32 v228, v228
    v_mfma_f32_16x16x32_bf16 v[52:55], a[220:223], a[60:63], v[52:55]
    s_add_u32 m0, s63, 57344
    v_exp_f32 v229, v229
    v_mfma_f32_16x16x32_bf16 v[52:55], a[216:219], a[44:47], v[52:55]
    s_waitcnt lgkmcnt(1)
    v_exp_f32 v230, v230
    v_mfma_f32_16x16x32_bf16 v[52:55], a[212:215], a[28:31], v[52:55]
    v_exp_f32 v231, v231
    v_mfma_f32_16x16x32_bf16 v[52:55], a[208:211], a[12:15], v[52:55]
    v_exp_f32 v236, v236
    v_mfma_f32_16x16x32_bf16 a[164:167], a[240:243], v[220:223], a[164:167]
    v_exp_f32 v237, v237
    v_mfma_f32_16x16x32_bf16 a[180:183], a[244:247], v[220:223], a[180:183]
    v_exp_f32 v238, v238
    v_mfma_f32_16x16x32_bf16 a[176:179], a[244:247], v[212:215], a[176:179]
    buffer_load_dwordx4 v6, s[16:19], s39 offen lds
    v_mfma_f32_16x16x32_bf16 a[160:163], a[240:243], v[212:215], a[160:163]
    ds_read_b128 a[208:211], v12 offset:6144
    v_cvt_pk_bf16_f32 v251, v38, v39
    v_mfma_f32_16x16x32_bf16 a[156:159], a[240:243], v[204:207], a[156:159]
    ds_read_b128 a[212:215], v13 offset:6144
    v_cvt_pk_bf16_f32 v228, v228, v229
    v_mfma_f32_16x16x32_bf16 a[172:175], a[244:247], v[204:207], a[172:175]
    ds_read_b128 a[216:219], v12 offset:7168
    v_cvt_pk_bf16_f32 v229, v230, v231
    v_mfma_f32_16x16x32_bf16 a[168:171], a[244:247], v[196:199], a[168:171]
    s_add_u32 s39, s40, 36992
    ds_read_b128 a[220:223], v13 offset:7168
    v_cvt_pk_bf16_f32 v236, v236, v237
    v_mfma_f32_16x16x32_bf16 a[152:155], a[240:243], v[196:199], a[152:155]
    v_exp_f32 v239, v239
    v_mfma_f32_16x16x32_bf16 v[56:59], a[184:187], a[0:3], 0
    s_add_u32 m0, s63, 61440
    ds_read_b128 a[224:227], v12 offset:8192
    v_cvt_pk_bf16_f32 v237, v238, v239
    v_mfma_f32_16x16x32_bf16 v[56:59], a[188:191], a[16:19], v[56:59]
    v_exp_f32 v244, v244
    v_mfma_f32_16x16x32_bf16 v[56:59], a[192:195], a[32:35], v[56:59]
    s_waitcnt lgkmcnt(4)
    v_exp_f32 v245, v245
    v_mfma_f32_16x16x32_bf16 v[56:59], a[196:199], a[48:51], v[56:59]
    ds_read_b128 a[228:231], v13 offset:8192
    v_cvt_pk_bf16_f32 v244, v244, v245
    v_mfma_f32_16x16x32_bf16 v[56:59], a[200:203], a[64:67], v[56:59]
    v_exp_f32 v246, v246
    v_mfma_f32_16x16x32_bf16 v[56:59], a[204:207], a[80:83], v[56:59]
    v_exp_f32 v247, v247
    v_mfma_f32_16x16x32_bf16 v[64:67], a[204:207], a[84:87], 0
    buffer_load_dwordx4 v6, s[16:19], s39 offen lds
    v_mfma_f32_16x16x32_bf16 v[64:67], a[200:203], a[68:71], v[64:67]
    v_exp_f32 v252, v252
    v_mfma_f32_16x16x32_bf16 v[64:67], a[196:199], a[52:55], v[64:67]
    v_exp_f32 v253, v253
    v_mfma_f32_16x16x32_bf16 v[64:67], a[192:195], a[36:39], v[64:67]
    v_exp_f32 v254, v254
    v_mfma_f32_16x16x32_bf16 v[64:67], a[188:191], a[20:23], v[64:67]
    v_exp_f32 v255, v255
    v_mfma_f32_16x16x32_bf16 v[64:67], a[184:187], a[4:7], v[64:67]
    v_exp_f32 v40, v40
    v_mfma_f32_16x16x32_bf16 v[72:75], a[184:187], a[8:11], 0
    v_exp_f32 v41, v41
    v_mfma_f32_16x16x32_bf16 v[72:75], a[188:191], a[24:27], v[72:75]
    v_exp_f32 v42, v42
    v_mfma_f32_16x16x32_bf16 v[72:75], a[192:195], a[40:43], v[72:75]
    v_exp_f32 v43, v43
    v_mfma_f32_16x16x32_bf16 v[72:75], a[196:199], a[56:59], v[72:75]
    v_cvt_pk_bf16_f32 v245, v246, v247
    v_cvt_pk_bf16_f32 v252, v252, v253
    v_mfma_f32_16x16x32_bf16 v[72:75], a[200:203], a[72:75], v[72:75]
    v_exp_f32 v44, v44
    v_mfma_f32_16x16x32_bf16 v[72:75], a[204:207], a[88:91], v[72:75]
    v_exp_f32 v45, v45
    v_mfma_f32_16x16x32_bf16 v[80:83], a[204:207], a[92:95], 0
    ds_read_b64_tr_b16 a[232:233], v8 offset:40960
    v_cvt_pk_bf16_f32 v253, v254, v255
    v_mfma_f32_16x16x32_bf16 v[80:83], a[200:203], a[76:79], v[80:83]
    ds_read_b64_tr_b16 a[234:235], v8 offset:43008
    v_cvt_pk_bf16_f32 v230, v40, v41
    v_mfma_f32_16x16x32_bf16 v[80:83], a[196:199], a[60:63], v[80:83]
    ds_read_b64_tr_b16 a[236:237], v9 offset:40960
    v_cvt_pk_bf16_f32 v231, v42, v43
    v_mfma_f32_16x16x32_bf16 v[80:83], a[192:195], a[44:47], v[80:83]
    ds_read_b64_tr_b16 a[238:239], v9 offset:43008
    v_cvt_pk_bf16_f32 v238, v44, v45
    v_mfma_f32_16x16x32_bf16 v[80:83], a[188:191], a[28:31], v[80:83]
    s_waitcnt lgkmcnt(4)
    v_exp_f32 v46, v46
    v_mfma_f32_16x16x32_bf16 v[80:83], a[184:187], a[12:15], v[80:83]
    v_exp_f32 v47, v47
    v_mfma_f32_16x16x32_bf16 v[24:27], a[208:211], a[0:3], 0
    v_exp_f32 v48, v48
    v_mfma_f32_16x16x32_bf16 v[24:27], a[212:215], a[16:19], v[24:27]
    v_exp_f32 v49, v49
    v_mfma_f32_16x16x32_bf16 v[24:27], a[216:219], a[32:35], v[24:27]
    ds_read_b128 a[184:187], v12 offset:12288
    v_cvt_pk_bf16_f32 v239, v46, v47
    v_mfma_f32_16x16x32_bf16 v[24:27], a[220:223], a[48:51], v[24:27]
    ds_read_b128 a[188:191], v13 offset:12288
    v_cvt_pk_bf16_f32 v246, v48, v49
    v_mfma_f32_16x16x32_bf16 v[24:27], a[224:227], a[64:67], v[24:27]
    v_exp_f32 v50, v50
    v_mfma_f32_16x16x32_bf16 v[24:27], a[228:231], a[80:83], v[24:27]
    v_exp_f32 v51, v51
    v_mfma_f32_16x16x32_bf16 v[28:31], a[228:231], a[84:87], 0
    ds_read_b128 a[192:195], v12 offset:13312
    v_cvt_pk_bf16_f32 v247, v50, v51
    v_mfma_f32_16x16x32_bf16 v[28:31], a[224:227], a[68:71], v[28:31]
    v_exp_f32 v52, v52
    v_mfma_f32_16x16x32_bf16 v[28:31], a[220:223], a[52:55], v[28:31]
    v_exp_f32 v53, v53
    v_mfma_f32_16x16x32_bf16 v[28:31], a[216:219], a[36:39], v[28:31]
    ds_read_b128 a[196:199], v13 offset:13312
    v_cvt_pk_bf16_f32 v254, v52, v53
    v_mfma_f32_16x16x32_bf16 v[28:31], a[212:215], a[20:23], v[28:31]
    v_exp_f32 v54, v54
    v_mfma_f32_16x16x32_bf16 v[28:31], a[208:211], a[4:7], v[28:31]
    v_exp_f32 v55, v55
    v_mfma_f32_16x16x32_bf16 v[32:35], a[208:211], a[8:11], 0
    ds_read_b128 a[200:203], v12 offset:14336
    v_cvt_pk_bf16_f32 v255, v54, v55
    v_mfma_f32_16x16x32_bf16 v[32:35], a[212:215], a[24:27], v[32:35]
    v_exp_f32 v56, v56
    v_mfma_f32_16x16x32_bf16 v[32:35], a[216:219], a[40:43], v[32:35]
    v_exp_f32 v57, v57
    v_mfma_f32_16x16x32_bf16 v[32:35], a[220:223], a[56:59], v[32:35]
    ds_read_b128 a[204:207], v13 offset:14336
    v_cvt_pk_bf16_f32 v56, v56, v57
    v_mfma_f32_16x16x32_bf16 v[32:35], a[224:227], a[72:75], v[32:35]
    v_exp_f32 v58, v58
    v_mfma_f32_16x16x32_bf16 v[32:35], a[228:231], a[88:91], v[32:35]
    v_exp_f32 v59, v59
    v_mfma_f32_16x16x32_bf16 v[36:39], a[228:231], a[92:95], 0
    v_exp_f32 v64, v64
    v_mfma_f32_16x16x32_bf16 v[36:39], a[224:227], a[76:79], v[36:39]
    v_exp_f32 v65, v65
    v_mfma_f32_16x16x32_bf16 v[36:39], a[220:223], a[60:63], v[36:39]
    v_exp_f32 v66, v66
    v_mfma_f32_16x16x32_bf16 v[36:39], a[216:219], a[44:47], v[36:39]
    s_waitcnt lgkmcnt(1)
    v_exp_f32 v67, v67
    v_mfma_f32_16x16x32_bf16 v[36:39], a[212:215], a[28:31], v[36:39]
    v_exp_f32 v72, v72
    v_mfma_f32_16x16x32_bf16 v[36:39], a[208:211], a[12:15], v[36:39]
    v_exp_f32 v73, v73
    v_mfma_f32_16x16x32_bf16 a[152:155], a[232:235], v[224:227], a[152:155]
    v_exp_f32 v74, v74
    v_mfma_f32_16x16x32_bf16 a[168:171], a[236:239], v[224:227], a[168:171]
    v_exp_f32 v75, v75
    v_mfma_f32_16x16x32_bf16 a[172:175], a[236:239], v[232:235], a[172:175]
    ds_read_b128 a[208:211], v12 offset:18432
    v_cvt_pk_bf16_f32 v57, v58, v59
    v_mfma_f32_16x16x32_bf16 a[156:159], a[232:235], v[232:235], a[156:159]
    ds_read_b128 a[212:215], v13 offset:18432
    v_cvt_pk_bf16_f32 v64, v64, v65
    v_mfma_f32_16x16x32_bf16 a[160:163], a[232:235], v[240:243], a[160:163]
    ds_read_b128 a[216:219], v12 offset:19456
    v_cvt_pk_bf16_f32 v65, v66, v67
    v_mfma_f32_16x16x32_bf16 a[176:179], a[236:239], v[240:243], a[176:179]
    ds_read_b128 a[220:223], v13 offset:19456
    v_cvt_pk_bf16_f32 v72, v72, v73
    v_mfma_f32_16x16x32_bf16 a[180:183], a[236:239], v[248:251], a[180:183]
    ds_read_b128 a[224:227], v12 offset:20480
    v_cvt_pk_bf16_f32 v73, v74, v75
    v_mfma_f32_16x16x32_bf16 a[164:167], a[232:235], v[248:251], a[164:167]
    v_exp_f32 v80, v80
    v_mfma_f32_16x16x32_bf16 v[60:63], a[184:187], a[0:3], 0
    v_exp_f32 v81, v81
    v_mfma_f32_16x16x32_bf16 v[60:63], a[188:191], a[16:19], v[60:63]
    ds_read_b128 a[228:231], v13 offset:20480
    v_cvt_pk_bf16_f32 v80, v80, v81
    v_mfma_f32_16x16x32_bf16 v[60:63], a[192:195], a[32:35], v[60:63]
    s_waitcnt lgkmcnt(4)
    v_exp_f32 v82, v82
    v_mfma_f32_16x16x32_bf16 v[60:63], a[196:199], a[48:51], v[60:63]
    v_exp_f32 v83, v83
    v_mfma_f32_16x16x32_bf16 v[60:63], a[200:203], a[64:67], v[60:63]
    v_exp_f32 v24, v24
    v_mfma_f32_16x16x32_bf16 v[60:63], a[204:207], a[80:83], v[60:63]
    v_exp_f32 v25, v25
    v_mfma_f32_16x16x32_bf16 v[68:71], a[204:207], a[84:87], 0
    v_exp_f32 v26, v26
    v_mfma_f32_16x16x32_bf16 v[68:71], a[200:203], a[68:71], v[68:71]
    v_exp_f32 v27, v27
    v_mfma_f32_16x16x32_bf16 v[68:71], a[196:199], a[52:55], v[68:71]
    v_exp_f32 v28, v28
    v_mfma_f32_16x16x32_bf16 v[68:71], a[192:195], a[36:39], v[68:71]
    v_exp_f32 v29, v29
    v_mfma_f32_16x16x32_bf16 v[68:71], a[188:191], a[20:23], v[68:71]
    v_cvt_pk_bf16_f32 v81, v82, v83
    v_cvt_pk_bf16_f32 v58, v24, v25
    v_mfma_f32_16x16x32_bf16 v[68:71], a[184:187], a[4:7], v[68:71]
    v_exp_f32 v30, v30
    v_mfma_f32_16x16x32_bf16 v[76:79], a[184:187], a[8:11], 0
    v_exp_f32 v31, v31
    v_mfma_f32_16x16x32_bf16 v[76:79], a[188:191], a[24:27], v[76:79]
    v_exp_f32 v32, v32
    v_mfma_f32_16x16x32_bf16 v[76:79], a[192:195], a[40:43], v[76:79]
    v_exp_f32 v33, v33
    v_mfma_f32_16x16x32_bf16 v[76:79], a[196:199], a[56:59], v[76:79]
    v_cvt_pk_bf16_f32 v59, v26, v27
    v_cvt_pk_bf16_f32 v66, v28, v29
    v_mfma_f32_16x16x32_bf16 v[76:79], a[200:203], a[72:75], v[76:79]
    v_exp_f32 v34, v34
    v_mfma_f32_16x16x32_bf16 v[76:79], a[204:207], a[88:91], v[76:79]
    v_exp_f32 v35, v35
    v_mfma_f32_16x16x32_bf16 v[84:87], a[204:207], a[92:95], 0
    s_add_u32 s39, s40, 49280
    v_exp_f32 v36, v36
    v_mfma_f32_16x16x32_bf16 v[84:87], a[200:203], a[76:79], v[84:87]
    v_exp_f32 v37, v37
    v_mfma_f32_16x16x32_bf16 v[84:87], a[196:199], a[60:63], v[84:87]
    s_add_u32 m0, s63, 0
    v_cvt_pk_bf16_f32 v67, v30, v31
    v_cvt_pk_bf16_f32 v74, v32, v33
    v_mfma_f32_16x16x32_bf16 v[84:87], a[192:195], a[44:47], v[84:87]
    v_exp_f32 v38, v38
    v_mfma_f32_16x16x32_bf16 v[84:87], a[188:191], a[28:31], v[84:87]
    v_exp_f32 v39, v39
    v_mfma_f32_16x16x32_bf16 v[84:87], a[184:187], a[12:15], v[84:87]
    s_waitcnt lgkmcnt(0)
    v_exp_f32 v60, v60
    v_mfma_f32_16x16x32_bf16 v[40:43], a[208:211], a[0:3], 0
    s_waitcnt vmcnt(7)
    v_exp_f32 v61, v61
    v_mfma_f32_16x16x32_bf16 v[40:43], a[212:215], a[16:19], v[40:43]
    s_barrier
    v_mfma_f32_16x16x32_bf16 v[40:43], a[216:219], a[32:35], v[40:43]
    buffer_load_dwordx4 v6, s[16:19], s39 offen lds
    v_mfma_f32_16x16x32_bf16 v[40:43], a[220:223], a[48:51], v[40:43]
    ds_read_b64_tr_b16 a[240:241], v8 offset:45056
    v_cvt_pk_bf16_f32 v75, v34, v35
    v_mfma_f32_16x16x32_bf16 v[40:43], a[224:227], a[64:67], v[40:43]
    ds_read_b64_tr_b16 a[242:243], v8 offset:47104
    v_cvt_pk_bf16_f32 v82, v36, v37
    v_mfma_f32_16x16x32_bf16 v[40:43], a[228:231], a[80:83], v[40:43]
    ds_read_b64_tr_b16 a[244:245], v9 offset:45056
    v_cvt_pk_bf16_f32 v83, v38, v39
    v_mfma_f32_16x16x32_bf16 v[44:47], a[228:231], a[84:87], 0
    s_add_u32 s39, s40, 61568
    ds_read_b64_tr_b16 a[246:247], v9 offset:47104
    v_cvt_pk_bf16_f32 v60, v60, v61
    v_mfma_f32_16x16x32_bf16 v[44:47], a[224:227], a[68:71], v[44:47]
    v_exp_f32 v62, v62
    v_mfma_f32_16x16x32_bf16 v[44:47], a[220:223], a[52:55], v[44:47]
    s_add_u32 m0, s63, 4096
    v_exp_f32 v63, v63
    v_mfma_f32_16x16x32_bf16 v[44:47], a[216:219], a[36:39], v[44:47]
    ds_read_b128 a[184:187], v12 offset:24576
    v_cvt_pk_bf16_f32 v61, v62, v63
    v_mfma_f32_16x16x32_bf16 v[44:47], a[212:215], a[20:23], v[44:47]
    v_exp_f32 v68, v68
    v_mfma_f32_16x16x32_bf16 v[44:47], a[208:211], a[4:7], v[44:47]
    v_exp_f32 v69, v69
    v_mfma_f32_16x16x32_bf16 v[48:51], a[208:211], a[8:11], 0
    s_mov_b32 s28, s82
    ds_read_b128 a[188:191], v13 offset:24576
    v_cvt_pk_bf16_f32 v68, v68, v69
    v_mfma_f32_16x16x32_bf16 v[48:51], a[212:215], a[24:27], v[48:51]
    s_and_b32 s29, s83, 0xffff
    ds_read_b128 a[192:195], v12 offset:25600
    v_and_b32 v22, 15, v1
    v_mfma_f32_16x16x32_bf16 v[48:51], a[216:219], a[40:43], v[48:51]
    buffer_load_dwordx4 v6, s[16:19], s39 offen lds
    v_mfma_f32_16x16x32_bf16 v[48:51], a[220:223], a[56:59], v[48:51]
    s_mov_b32 s30, 1966080
    ds_read_b128 a[196:199], v13 offset:25600
    v_mul_u32_u24 v22, 1280, v22
    v_mfma_f32_16x16x32_bf16 v[48:51], a[224:227], a[72:75], v[48:51]
    s_mov_b32 s31, 0x00020000
    v_exp_f32 v70, v70
    v_mfma_f32_16x16x32_bf16 v[48:51], a[228:231], a[88:91], v[48:51]
    s_mul_hi_u32 s48, s58, 429496730
    v_exp_f32 v71, v71
    v_mfma_f32_16x16x32_bf16 v[52:55], a[228:231], a[92:95], 0
    s_add_u32 s39, s40, 73856
    ds_read_b128 a[200:203], v12 offset:26624
    v_cvt_pk_bf16_f32 v69, v70, v71
    v_mfma_f32_16x16x32_bf16 v[52:55], a[224:227], a[76:79], v[52:55]
    s_mul_i32 s42, s48, 80640
    v_exp_f32 v76, v76
    v_mfma_f32_16x16x32_bf16 v[52:55], a[220:223], a[60:63], v[52:55]
    s_add_u32 m0, s63, 8192
    v_exp_f32 v77, v77
    v_mfma_f32_16x16x32_bf16 v[52:55], a[216:219], a[44:47], v[52:55]
    s_waitcnt lgkmcnt(2)
    ds_read_b128 a[204:207], v13 offset:26624
    v_cvt_pk_bf16_f32 v76, v76, v77
    v_mfma_f32_16x16x32_bf16 v[52:55], a[212:215], a[28:31], v[52:55]
    s_lshl_b32 s56, s58, 7
    v_exp_f32 v78, v78
    v_mfma_f32_16x16x32_bf16 v[52:55], a[208:211], a[12:15], v[52:55]
    s_add_u32 s42, s42, s56
    v_exp_f32 v79, v79
    v_mfma_f32_16x16x32_bf16 a[164:167], a[240:243], v[252:255], a[164:167]
    s_mul_i32 s56, s3, 20480
    v_exp_f32 v84, v84
    v_mfma_f32_16x16x32_bf16 a[180:183], a[244:247], v[252:255], a[180:183]
    s_add_u32 s42, s42, s56
    v_exp_f32 v85, v85
    v_mfma_f32_16x16x32_bf16 a[176:179], a[244:247], v[244:247], a[176:179]
    buffer_load_dword a252, v22, s[28:31], s42 offen
    v_mfma_f32_16x16x32_bf16 a[160:163], a[240:243], v[244:247], a[160:163]
    buffer_load_dwordx4 v6, s[16:19], s39 offen lds
    v_mfma_f32_16x16x32_bf16 a[156:159], a[240:243], v[236:239], a[156:159]
    s_add_u32 s56, s7, 1
    ds_read_b128 a[208:211], v12 offset:30720
    v_cvt_pk_bf16_f32 v77, v78, v79
    v_mfma_f32_16x16x32_bf16 a[172:175], a[244:247], v[236:239], a[172:175]
    ds_read_b128 a[212:215], v13 offset:30720
    v_cvt_pk_bf16_f32 v84, v84, v85
    v_mfma_f32_16x16x32_bf16 a[168:171], a[244:247], v[228:231], a[168:171]
    s_add_u32 s39, s40, 86144
    ds_read_b128 a[216:219], v12 offset:31744
    v_mov_b32 v4, s56
    v_mfma_f32_16x16x32_bf16 a[152:155], a[240:243], v[228:231], a[152:155]
    s_add_u32 s56, s7, 2
    v_exp_f32 v86, v86
    v_mfma_f32_16x16x32_bf16 v[88:91], a[184:187], a[0:3], 0
    s_waitcnt lgkmcnt(3)
    v_exp_f32 v87, v87
    v_mfma_f32_16x16x32_bf16 v[88:91], a[188:191], a[16:19], v[88:91]
    s_add_u32 m0, s63, 12288
    ds_read_b128 a[220:223], v13 offset:31744
    v_cvt_pk_bf16_f32 v85, v86, v87
    v_mfma_f32_16x16x32_bf16 v[88:91], a[192:195], a[32:35], v[88:91]
    v_exp_f32 v40, v40
    v_mfma_f32_16x16x32_bf16 v[88:91], a[196:199], a[48:51], v[88:91]
    v_exp_f32 v41, v41
    v_mfma_f32_16x16x32_bf16 v[88:91], a[200:203], a[64:67], v[88:91]
    ds_read_b128 a[224:227], v12 offset:32768
    v_cvt_pk_bf16_f32 v62, v40, v41
    v_mfma_f32_16x16x32_bf16 v[88:91], a[204:207], a[80:83], v[88:91]
    v_exp_f32 v42, v42
    v_mfma_f32_16x16x32_bf16 v[96:99], a[204:207], a[84:87], 0
    buffer_load_dwordx4 v6, s[16:19], s39 offen lds
    v_mfma_f32_16x16x32_bf16 v[96:99], a[200:203], a[68:71], v[96:99]
    v_exp_f32 v43, v43
    v_mfma_f32_16x16x32_bf16 v[96:99], a[196:199], a[52:55], v[96:99]
    ds_read_b128 a[228:231], v13 offset:32768
    v_cvt_pk_bf16_f32 v63, v42, v43
    v_mfma_f32_16x16x32_bf16 v[96:99], a[192:195], a[36:39], v[96:99]
    v_exp_f32 v44, v44
    v_mfma_f32_16x16x32_bf16 v[96:99], a[188:191], a[20:23], v[96:99]
    s_add_u32 s39, s40, 98432
    v_exp_f32 v45, v45
    v_mfma_f32_16x16x32_bf16 v[96:99], a[184:187], a[4:7], v[96:99]
    v_exp_f32 v46, v46
    v_mfma_f32_16x16x32_bf16 v[104:107], a[184:187], a[8:11], 0
    s_add_u32 m0, s63, 16384
    v_exp_f32 v47, v47
    v_mfma_f32_16x16x32_bf16 v[104:107], a[188:191], a[24:27], v[104:107]
pg_8:
    s_cbranch_execz pg_12
    v_exp_f32 v48, v48
    v_mfma_f32_16x16x32_bf16 v[104:107], a[192:195], a[40:43], v[104:107]
    v_exp_f32 v49, v49
    v_mfma_f32_16x16x32_bf16 v[104:107], a[196:199], a[56:59], v[104:107]
    v_exp_f32 v50, v50
    v_mfma_f32_16x16x32_bf16 v[104:107], a[200:203], a[72:75], v[104:107]
    v_exp_f32 v51, v51
    v_mfma_f32_16x16x32_bf16 v[104:107], a[204:207], a[88:91], v[104:107]
    v_cvt_pk_bf16_f32 v70, v44, v45
    v_cvt_pk_bf16_f32 v71, v46, v47
    v_mfma_f32_16x16x32_bf16 v[112:115], a[204:207], a[92:95], 0
    buffer_load_dwordx4 v6, s[16:19], s39 offen lds
    v_mfma_f32_16x16x32_bf16 v[112:115], a[200:203], a[76:79], v[112:115]
    ds_read_b64_tr_b16 a[232:233], v8 offset:49152
    v_cvt_pk_bf16_f32 v78, v48, v49
    v_mfma_f32_16x16x32_bf16 v[112:115], a[196:199], a[60:63], v[112:115]
    ds_read_b64_tr_b16 a[234:235], v8 offset:51200
    v_cvt_pk_bf16_f32 v79, v50, v51
    v_mfma_f32_16x16x32_bf16 v[112:115], a[192:195], a[44:47], v[112:115]
    s_waitcnt lgkmcnt(2)
    v_exp_f32 v52, v52
    v_mfma_f32_16x16x32_bf16 v[112:115], a[188:191], a[28:31], v[112:115]
    s_add_u32 s39, s40, 110720
    v_exp_f32 v53, v53
    v_mfma_f32_16x16x32_bf16 v[112:115], a[184:187], a[12:15], v[112:115]
    ds_read_b64_tr_b16 a[236:237], v9 offset:49152
    v_cvt_pk_bf16_f32 v86, v52, v53
    v_mfma_f32_16x16x32_bf16 v[24:27], a[208:211], a[0:3], 0
    s_add_u32 m0, s63, 20480
    v_exp_f32 v54, v54
    v_mfma_f32_16x16x32_bf16 v[24:27], a[212:215], a[16:19], v[24:27]
    v_exp_f32 v55, v55
    v_mfma_f32_16x16x32_bf16 v[24:27], a[216:219], a[32:35], v[24:27]
    ds_read_b64_tr_b16 a[238:239], v9 offset:51200
    v_cvt_pk_bf16_f32 v87, v54, v55
    v_mfma_f32_16x16x32_bf16 v[24:27], a[220:223], a[48:51], v[24:27]
    v_exp_f32 v88, v88
    v_mfma_f32_16x16x32_bf16 v[24:27], a[224:227], a[64:67], v[24:27]
    v_exp_f32 v89, v89
    v_mfma_f32_16x16x32_bf16 v[24:27], a[228:231], a[80:83], v[24:27]
    ds_read_b128 a[184:187], v12 offset:36864
    v_cvt_pk_bf16_f32 v88, v88, v89
    v_mfma_f32_16x16x32_bf16 v[28:31], a[228:231], a[84:87], 0
    buffer_load_dwordx4 v6, s[16:19], s39 offen lds
    v_mfma_f32_16x16x32_bf16 v[28:31], a[224:227], a[68:71], v[28:31]
    v_exp_f32 v90, v90
    v_mfma_f32_16x16x32_bf16 v[28:31], a[220:223], a[52:55], v[28:31]
    v_exp_f32 v91, v91
    v_mfma_f32_16x16x32_bf16 v[28:31], a[216:219], a[36:39], v[28:31]
    ds_read_b128 a[188:191], v13 offset:36864
    v_cvt_pk_bf16_f32 v89, v90, v91
    v_mfma_f32_16x16x32_bf16 v[28:31], a[212:215], a[20:23], v[28:31]
    v_exp_f32 v96, v96
    v_mfma_f32_16x16x32_bf16 v[28:31], a[208:211], a[4:7], v[28:31]
    v_exp_f32 v97, v97
    v_mfma_f32_16x16x32_bf16 v[32:35], a[208:211], a[8:11], 0
    ds_read_b128 a[192:195], v12 offset:37888
    v_cvt_pk_bf16_f32 v96, v96, v97
    v_mfma_f32_16x16x32_bf16 v[32:35], a[212:215], a[24:27], v[32:35]
    v_exp_f32 v98, v98
    v_mfma_f32_16x16x32_bf16 v[32:35], a[216:219], a[40:43], v[32:35]
    v_exp_f32 v99, v99
    v_mfma_f32_16x16x32_bf16 v[32:35], a[220:223], a[56:59], v[32:35]
    ds_read_b128 a[196:199], v13 offset:37888
    v_cvt_pk_bf16_f32 v97, v98, v99
    v_mfma_f32_16x16x32_bf16 v[32:35], a[224:227], a[72:75], v[32:35]
    v_exp_f32 v104, v104
    v_mfma_f32_16x16x32_bf16 v[32:35], a[228:231], a[88:91], v[32:35]
    v_exp_f32 v105, v105
    v_mfma_f32_16x16x32_bf16 v[36:39], a[228:231], a[92:95], 0
    ds_read_b128 a[200:203], v12 offset:38912
    v_cvt_pk_bf16_f32 v104, v104, v105
    v_mfma_f32_16x16x32_bf16 v[36:39], a[224:227], a[76:79], v[36:39]
    v_exp_f32 v106, v106
    v_mfma_f32_16x16x32_bf16 v[36:39], a[220:223], a[60:63], v[36:39]
    v_exp_f32 v107, v107
    v_mfma_f32_16x16x32_bf16 v[36:39], a[216:219], a[44:47], v[36:39]
    s_waitcnt lgkmcnt(2)
    ds_read_b128 a[204:207], v13 offset:38912
    v_cvt_pk_bf16_f32 v105, v106, v107
    v_mfma_f32_16x16x32_bf16 v[36:39], a[212:215], a[28:31], v[36:39]
    v_exp_f32 v112, v112
    v_mfma_f32_16x16x32_bf16 v[36:39], a[208:211], a[12:15], v[36:39]
    v_exp_f32 v113, v113
    v_mfma_f32_16x16x32_bf16 a[152:155], a[232:235], v[56:59], a[152:155]
    v_exp_f32 v114, v114
    v_mfma_f32_16x16x32_bf16 a[168:171], a[236:239], v[56:59], a[168:171]
    v_exp_f32 v115, v115
    v_mfma_f32_16x16x32_bf16 a[172:175], a[236:239], v[64:67], a[172:175]
    ds_read_b128 a[208:211], v12 offset:43008
    v_cvt_pk_bf16_f32 v112, v112, v113
    v_mfma_f32_16x16x32_bf16 a[156:159], a[232:235], v[64:67], a[156:159]
    ds_read_b128 a[212:215], v13 offset:43008
    v_cvt_pk_bf16_f32 v113, v114, v115
    v_mfma_f32_16x16x32_bf16 a[160:163], a[232:235], v[72:75], a[160:163]
    v_exp_f32 v24, v24
    v_mfma_f32_16x16x32_bf16 a[176:179], a[236:239], v[72:75], a[176:179]
    v_exp_f32 v25, v25
    v_mfma_f32_16x16x32_bf16 a[180:183], a[236:239], v[80:83], a[180:183]
    ds_read_b128 a[216:219], v12 offset:44032
    v_cvt_pk_bf16_f32 v90, v24, v25
    v_mfma_f32_16x16x32_bf16 a[164:167], a[232:235], v[80:83], a[164:167]
    ds_read_b128 a[220:223], v13 offset:44032
    v_mov_b32 v24, 0
    v_mfma_f32_16x16x32_bf16 v[92:95], a[184:187], a[0:3], 0
    s_waitcnt lgkmcnt(4)
    ds_read_b128 a[224:227], v12 offset:45056
    v_mov_b32 v25, 0
    v_mfma_f32_16x16x32_bf16 v[92:95], a[188:191], a[16:19], v[92:95]
    v_exp_f32 v26, v26
    v_mfma_f32_16x16x32_bf16 v[92:95], a[192:195], a[32:35], v[92:95]
    v_exp_f32 v27, v27
    v_mfma_f32_16x16x32_bf16 v[92:95], a[196:199], a[48:51], v[92:95]
    ds_read_b128 a[228:231], v13 offset:45056
    v_cvt_pk_bf16_f32 v91, v26, v27
    v_mfma_f32_16x16x32_bf16 v[92:95], a[200:203], a[64:67], v[92:95]
    v_exp_f32 v28, v28
    v_mfma_f32_16x16x32_bf16 v[92:95], a[204:207], a[80:83], v[92:95]
    v_exp_f32 v29, v29
    v_mfma_f32_16x16x32_bf16 v[100:103], a[204:207], a[84:87], 0
    v_exp_f32 v30, v30
    v_mfma_f32_16x16x32_bf16 v[100:103], a[200:203], a[68:71], v[100:103]
    v_exp_f32 v31, v31
    v_mfma_f32_16x16x32_bf16 v[100:103], a[196:199], a[52:55], v[100:103]
    v_exp_f32 v32, v32
    v_mfma_f32_16x16x32_bf16 v[100:103], a[192:195], a[36:39], v[100:103]
    v_exp_f32 v33, v33
    v_mfma_f32_16x16x32_bf16 v[100:103], a[188:191], a[20:23], v[100:103]
    v_exp_f32 v34, v34
    v_mfma_f32_16x16x32_bf16 v[100:103], a[184:187], a[4:7], v[100:103]
    v_exp_f32 v35, v35
    v_mfma_f32_16x16x32_bf16 v[108:111], a[184:187], a[8:11], 0
    v_cvt_pk_bf16_f32 v98, v28, v29
    v_cvt_pk_bf16_f32 v99, v30, v31
    v_mfma_f32_16x16x32_bf16 v[108:111], a[188:191], a[24:27], v[108:111]
    v_exp_f32 v36, v36
    v_mfma_f32_16x16x32_bf16 v[108:111], a[192:195], a[40:43], v[108:111]
    v_exp_f32 v37, v37
    v_mfma_f32_16x16x32_bf16 v[108:111], a[196:199], a[56:59], v[108:111]
    v_exp_f32 v38, v38
    v_mfma_f32_16x16x32_bf16 v[108:111], a[200:203], a[72:75], v[108:111]
    v_exp_f32 v39, v39
    v_mfma_f32_16x16x32_bf16 v[108:111], a[204:207], a[88:91], v[108:111]
    v_cvt_pk_bf16_f32 v106, v32, v33
    v_cvt_pk_bf16_f32 v107, v34, v35
    v_mfma_f32_16x16x32_bf16 v[116:119], a[204:207], a[92:95], 0
    s_add_u32 s39, s40, 123008
    v_cvt_pk_bf16_f32 v114, v36, v37
    v_cvt_pk_bf16_f32 v115, v38, v39
    v_mfma_f32_16x16x32_bf16 v[116:119], a[200:203], a[76:79], v[116:119]
    v_exp_f32 v92, v92
    v_mfma_f32_16x16x32_bf16 v[116:119], a[196:199], a[60:63], v[116:119]
    s_add_u32 m0, s63, 24576
    v_exp_f32 v93, v93
    v_mfma_f32_16x16x32_bf16 v[116:119], a[192:195], a[44:47], v[116:119]
    s_waitcnt lgkmcnt(0)
    v_exp_f32 v94, v94
    v_mfma_f32_16x16x32_bf16 v[116:119], a[188:191], a[28:31], v[116:119]
    v_exp_f32 v95, v95
    v_mfma_f32_16x16x32_bf16 v[116:119], a[184:187], a[12:15], v[116:119]
    v_exp_f32 v100, v100
    v_mfma_f32_16x16x32_bf16 v[40:43], a[208:211], a[0:3], 0
    s_waitcnt vmcnt(12)
    v_exp_f32 v101, v101
    v_mfma_f32_16x16x32_bf16 v[40:43], a[212:215], a[16:19], v[40:43]
    s_barrier
    v_mfma_f32_16x16x32_bf16 v[40:43], a[216:219], a[32:35], v[40:43]
    buffer_load_dwordx4 v6, s[16:19], s39 offen lds
    v_mfma_f32_16x16x32_bf16 v[40:43], a[220:223], a[48:51], v[40:43]
    s_add_u32 s39, s40, 135296
    ds_read_b64_tr_b16 a[240:241], v8 offset:53248
    v_cvt_pk_bf16_f32 v92, v92, v93
    v_mfma_f32_16x16x32_bf16 v[40:43], a[224:227], a[64:67], v[40:43]
    s_add_u32 m0, s63, 28672
    ds_read_b64_tr_b16 a[242:243], v8 offset:55296
    v_cvt_pk_bf16_f32 v93, v94, v95
    v_mfma_f32_16x16x32_bf16 v[40:43], a[228:231], a[80:83], v[40:43]
    ds_read_b64_tr_b16 a[244:245], v9 offset:53248
    v_cvt_pk_bf16_f32 v100, v100, v101
    v_mfma_f32_16x16x32_bf16 v[44:47], a[228:231], a[84:87], 0
    ds_read_b64_tr_b16 a[246:247], v9 offset:55296
    v_mov_b32 v28, 0
    v_mfma_f32_16x16x32_bf16 v[44:47], a[224:227], a[68:71], v[44:47]
    v_exp_f32 v102, v102
    v_mfma_f32_16x16x32_bf16 v[44:47], a[220:223], a[52:55], v[44:47]
    v_exp_f32 v103, v103
    v_mfma_f32_16x16x32_bf16 v[44:47], a[216:219], a[36:39], v[44:47]
    v_exp_f32 v108, v108
    v_mfma_f32_16x16x32_bf16 v[44:47], a[212:215], a[20:23], v[44:47]
    buffer_load_dwordx4 v6, s[16:19], s39 offen lds
    v_mfma_f32_16x16x32_bf16 v[44:47], a[208:211], a[4:7], v[44:47]
    s_add_u32 s39, s40, 147584
    v_exp_f32 v109, v109
    v_mfma_f32_16x16x32_bf16 v[48:51], a[208:211], a[8:11], 0
    s_add_u32 m0, s63, 32768
    v_exp_f32 v110, v110
    v_mfma_f32_16x16x32_bf16 v[48:51], a[212:215], a[24:27], v[48:51]
    v_exp_f32 v111, v111
    v_mfma_f32_16x16x32_bf16 v[48:51], a[216:219], a[40:43], v[48:51]
    v_cvt_pk_bf16_f32 v101, v102, v103
    v_cvt_pk_bf16_f32 v108, v108, v109
    v_mfma_f32_16x16x32_bf16 v[48:51], a[220:223], a[56:59], v[48:51]
    v_exp_f32 v116, v116
    v_mfma_f32_16x16x32_bf16 v[48:51], a[224:227], a[72:75], v[48:51]
    v_exp_f32 v117, v117
    v_mfma_f32_16x16x32_bf16 v[48:51], a[228:231], a[88:91], v[48:51]
    v_exp_f32 v118, v118
    v_mfma_f32_16x16x32_bf16 v[52:55], a[228:231], a[92:95], 0
    buffer_load_dwordx4 v6, s[16:19], s39 offen lds
    v_mfma_f32_16x16x32_bf16 v[52:55], a[224:227], a[76:79], v[52:55]
    s_add_u32 s39, s40, 159872
    v_exp_f32 v119, v119
    v_mfma_f32_16x16x32_bf16 v[52:55], a[220:223], a[60:63], v[52:55]
    s_add_u32 m0, s63, 36864
    v_cvt_pk_bf16_f32 v109, v110, v111
    v_cvt_pk_bf16_f32 v116, v116, v117
    v_mfma_f32_16x16x32_bf16 v[52:55], a[216:219], a[44:47], v[52:55]
    s_waitcnt lgkmcnt(0)
    v_exp_f32 v40, v40
    v_mfma_f32_16x16x32_bf16 v[52:55], a[212:215], a[28:31], v[52:55]
    v_exp_f32 v41, v41
    v_mfma_f32_16x16x32_bf16 v[52:55], a[208:211], a[12:15], v[52:55]
    v_exp_f32 v42, v42
    v_mfma_f32_16x16x32_bf16 a[164:167], a[240:243], v[84:87], a[164:167]
    v_exp_f32 v43, v43
    v_mfma_f32_16x16x32_bf16 a[180:183], a[244:247], v[84:87], a[180:183]
    v_cvt_pk_bf16_f32 v117, v118, v119
    v_cvt_pk_bf16_f32 v94, v40, v41
    v_mfma_f32_16x16x32_bf16 a[176:179], a[244:247], v[76:79], a[176:179]
    buffer_load_dwordx4 v6, s[16:19], s39 offen lds
    v_mfma_f32_16x16x32_bf16 a[160:163], a[240:243], v[76:79], a[160:163]
    s_add_u32 s39, s40, 172160
    v_exp_f32 v44, v44
    v_mfma_f32_16x16x32_bf16 a[156:159], a[240:243], v[68:71], a[156:159]
    s_add_u32 m0, s63, 40960
    v_exp_f32 v45, v45
    v_mfma_f32_16x16x32_bf16 a[172:175], a[244:247], v[68:71], a[172:175]
    v_exp_f32 v46, v46
    v_mfma_f32_16x16x32_bf16 a[168:171], a[244:247], v[60:63], a[168:171]
    v_exp_f32 v47, v47
    v_mfma_f32_16x16x32_bf16 a[152:155], a[240:243], v[60:63], a[152:155]
    v_cvt_pk_bf16_f32 v95, v42, v43
    v_cvt_pk_bf16_f32 v102, v44, v45
    v_smfmac_f32_16x16x64_bf16 v[24:27], a[248:251], a[96:103], v20
    v_cvt_pk_bf16_f32 v103, v46, v47
    v_mov_b32 v29, 0
    s_nop 1
    v_smfmac_f32_16x16x64_bf16 v[28:31], a[248:251], a[104:111], v20
    v_mov_b32 v32, 0
    v_mov_b32 v33, 0
    s_nop 1
    v_smfmac_f32_16x16x64_bf16 v[32:35], a[248:251], a[112:119], v20
    buffer_load_dwordx4 v6, s[16:19], s39 offen lds
    v_mov_b32 v36, 0
    v_mov_b32 v37, 0
    s_nop 1
    v_smfmac_f32_16x16x64_bf16 v[36:39], a[248:251], a[120:127], v20
    s_add_u32 s39, s40, 184448
    ds_read_b64_tr_b16 a[232:233], v8 offset:57344
    v_smfmac_f32_16x16x64_bf16 v[24:27], a[248:251], a[128:135], v20
    s_add_u32 m0, s63, 45056
    ds_read_b64_tr_b16 a[234:235], v8 offset:59392
    v_smfmac_f32_16x16x64_bf16 v[28:31], a[248:251], a[136:143], v20
    ds_read_b64_tr_b16 a[236:237], v9 offset:57344
    v_smfmac_f32_16x16x64_bf16 v[32:35], a[248:251], a[144:151], v20
    ds_read_b64_tr_b16 a[238:239], v9 offset:59392
    v_smfmac_f32_16x16x64_bf16 v[36:39], a[248:251], v[120:127], v20
    v_smfmac_f32_16x16x64_bf16 v[24:27], a[248:251], v[128:135], v20
    v_smfmac_f32_16x16x64_bf16 v[28:31], a[248:251], v[136:143], v20
    v_smfmac_f32_16x16x64_bf16 v[32:35], a[248:251], v[144:151], v20
    buffer_load_dwordx4 v6, s[16:19], s39 offen lds
    v_smfmac_f32_16x16x64_bf16 v[36:39], a[248:251], v[152:159], v20
    s_add_u32 s38, s44, 0
    ds_read_b64_tr_b16 a[240:241], v8 offset:61440
    s_add_u32 s36, s44, 40960
    v_smfmac_f32_16x16x64_bf16 v[24:27], a[248:251], v[160:167], v20
    s_cmp_lt_u32 s3, 2
    s_cselect_b32 s38, s38, s36
    s_add_u32 m0, s63, 155648
    v_smfmac_f32_16x16x64_bf16 v[28:31], a[248:251], v[168:175], v20
    ds_read_b64_tr_b16 a[242:243], v8 offset:63488
    v_smfmac_f32_16x16x64_bf16 v[32:35], a[248:251], v[176:183], v20
    ds_read_b64_tr_b16 a[244:245], v9 offset:61440
    v_smfmac_f32_16x16x64_bf16 v[36:39], a[248:251], v[184:191], v20
    ds_read_b64_tr_b16 a[246:247], v9 offset:63488
    v_smfmac_f32_16x16x64_bf16 v[24:27], a[248:251], v[192:199], v20
    v_smfmac_f32_16x16x64_bf16 v[28:31], a[248:251], v[200:207], v20
    v_smfmac_f32_16x16x64_bf16 v[32:35], a[248:251], v[208:215], v20
    buffer_load_dwordx4 v7, s[8:11], s38 offen lds
    v_smfmac_f32_16x16x64_bf16 v[36:39], a[248:251], v[216:223], v20
    s_add_u32 s38, s44, 0
    ds_read_b64_tr_b16 a[184:185], v10 offset:0
    v_smfmac_f32_16x16x64_bf16 v[24:27], a[248:251], v[224:231], v20
    s_add_u32 m0, s63, 139264
    ds_read_b64_tr_b16 a[186:187], v10 offset:2048
    v_smfmac_f32_16x16x64_bf16 v[28:31], a[248:251], v[232:239], v20
    ds_read_b64_tr_b16 a[188:189], v10 offset:4096
    v_smfmac_f32_16x16x64_bf16 v[32:35], a[248:251], v[240:247], v20
    s_waitcnt lgkmcnt(3)
    ds_read_b64_tr_b16 a[190:191], v10 offset:6144
    v_smfmac_f32_16x16x64_bf16 v[36:39], a[248:251], v[248:255], v20
    v_smfmac_f32_16x16x64_bf16 v[24:27], a[248:251], v[56:63], v20
    v_smfmac_f32_16x16x64_bf16 v[28:31], a[248:251], v[64:71], v20
    v_smfmac_f32_16x16x64_bf16 v[32:35], a[248:251], v[72:79], v20
    buffer_load_dwordx4 v2, s[8:11], s38 offen lds
    v_smfmac_f32_16x16x64_bf16 v[36:39], a[248:251], v[80:87], v20
    s_add_u32 s38, s44, 0
    ds_read_b64_tr_b16 a[192:193], v10 offset:8192
    v_smfmac_f32_16x16x64_bf16 v[24:27], a[248:251], v[88:95], v20
    s_add_u32 m0, s63, 143360
    ds_read_b64_tr_b16 a[194:195], v10 offset:10240
    v_smfmac_f32_16x16x64_bf16 v[28:31], a[248:251], v[96:103], v20
    ds_read_b64_tr_b16 a[196:197], v10 offset:12288
    v_exp_f32 v48, v48
    v_exp_f32 v49, v49
    v_exp_f32 v50, v50
    v_exp_f32 v51, v51
    v_cvt_pk_bf16_f32 v110, v48, v49
    v_cvt_pk_bf16_f32 v111, v50, v51
    s_nop 1
    v_smfmac_f32_16x16x64_bf16 v[32:35], a[248:251], v[104:111], v20
    ds_read_b64_tr_b16 a[198:199], v10 offset:14336
    v_add_f32 v24, v24, v25
    v_exp_f32 v52, v52
    v_exp_f32 v53, v53
    v_exp_f32 v54, v54
    v_exp_f32 v55, v55
    v_cvt_pk_bf16_f32 v118, v52, v53
    v_cvt_pk_bf16_f32 v119, v54, v55
    s_nop 1
    v_smfmac_f32_16x16x64_bf16 v[36:39], a[248:251], v[112:119], v20
    v_add_f32 v28, v28, v29
    v_mfma_f32_16x16x32_bf16 a[152:155], a[232:235], v[88:91], a[152:155]
    v_rcp_f32 v16, v24
    v_mfma_f32_16x16x32_bf16 a[168:171], a[236:239], v[88:91], a[168:171]
    v_rcp_f32 v17, v28
    v_mfma_f32_16x16x32_bf16 a[172:175], a[236:239], v[96:99], a[172:175]
    buffer_load_dwordx4 v3, s[8:11], s38 offen lds
    v_mfma_f32_16x16x32_bf16 a[156:159], a[232:235], v[96:99], a[156:159]
    s_add_u32 s38, s44, 40960
    ds_read_b64_tr_b16 a[200:201], v10 offset:16384
    v_add_f32 v32, v32, v33
    v_mfma_f32_16x16x32_bf16 a[160:163], a[232:235], v[104:107], a[160:163]
    s_add_u32 m0, s63, 147456
    ds_read_b64_tr_b16 a[202:203], v10 offset:18432
    v_add_f32 v36, v36, v37
    v_mfma_f32_16x16x32_bf16 a[176:179], a[236:239], v[104:107], a[176:179]
    ds_read_b64_tr_b16 a[204:205], v10 offset:20480
    v_max3_f32 v21, v24, v28, v32
    v_mfma_f32_16x16x32_bf16 a[180:183], a[236:239], v[112:115], a[180:183]
    s_waitcnt lgkmcnt(3)
    ds_read_b64_tr_b16 a[206:207], v10 offset:22528
    v_max3_f32 v21, v21, v36, v16
    v_mfma_f32_16x16x32_bf16 a[164:167], a[232:235], v[112:115], a[164:167]
    v_rcp_f32 v18, v32
    v_mfma_f32_16x16x32_bf16 a[164:167], a[240:243], v[116:119], a[164:167]
    v_rcp_f32 v19, v36
    v_mfma_f32_16x16x32_bf16 a[180:183], a[244:247], v[116:119], a[180:183]
    v_max3_f32 v21, v21, v17, v18
    v_max_f32 v21, v21, v19
    v_mfma_f32_16x16x32_bf16 a[176:179], a[244:247], v[108:111], a[176:179]
    buffer_load_dwordx4 v2, s[8:11], s38 offen lds
    v_mfma_f32_16x16x32_bf16 a[160:163], a[240:243], v[108:111], a[160:163]
    s_add_u32 s38, s44, 40960
    ds_read_b64_tr_b16 a[208:209], v10 offset:24576
    v_cmp_nge_f32 vcc, 0x5f800000, v21
    v_mfma_f32_16x16x32_bf16 a[156:159], a[240:243], v[100:103], a[156:159]
    s_add_u32 m0, s63, 151552
    ds_read_b64_tr_b16 a[210:211], v10 offset:26624
    v_mfma_f32_16x16x32_bf16 a[172:175], a[244:247], v[100:103], a[172:175]
    ds_read_b64_tr_b16 a[212:213], v10 offset:28672
    v_mfma_f32_16x16x32_bf16 a[168:171], a[244:247], v[92:95], a[168:171]
    ds_read_b64_tr_b16 a[214:215], v10 offset:30720
    v_mfma_f32_16x16x32_bf16 a[152:155], a[240:243], v[92:95], a[152:155]
    s_cbranch_vccnz rare
rare_ret:
    v_mfma_f32_16x16x32_bf16 v[40:43], a[184:187], a[96:99], 0
    v_subrev_u32 v8, 73728, v8
    v_subrev_u32 v9, 73728, v9
    v_mfma_f32_16x16x32_bf16 v[40:43], a[188:191], a[100:103], v[40:43]
    v_mfma_f32_16x16x32_bf16 v[44:47], a[188:191], a[108:111], 0
    s_barrier
    v_mfma_f32_16x16x32_bf16 v[44:47], a[184:187], a[104:107], v[44:47]
    buffer_load_dwordx4 v3, s[8:11], s38 offen lds
    v_mfma_f32_16x16x32_bf16 v[48:51], a[184:187], a[112:115], 0
    v_accvgpr_read_b32 v21, a152
    v_accvgpr_read_b32 v22, a153
    v_mfma_f32_16x16x32_bf16 v[48:51], a[188:191], a[116:119], v[48:51]
    v_accvgpr_read_b32 v23, a154
    v_accvgpr_read_b32 v5, a155
    v_mfma_f32_16x16x32_bf16 v[52:55], a[188:191], a[124:127], 0
    v_mul_f32 v21, v16, v21
    v_mul_f32 v22, v16, v22
    v_mfma_f32_16x16x32_bf16 v[52:55], a[184:187], a[120:123], v[52:55]
    ds_read_b64_tr_b16 a[184:185], v10 offset:32768
    v_mul_f32 v23, v16, v23
    v_mfma_f32_16x16x32_bf16 v[52:55], a[192:195], v[120:123], v[52:55]
    ds_read_b64_tr_b16 a[186:187], v10 offset:34816
    v_mul_f32 v5, v16, v5
    v_mfma_f32_16x16x32_bf16 v[52:55], a[196:199], v[124:127], v[52:55]
    ds_read_b64_tr_b16 a[188:189], v10 offset:36864
    v_cvt_pk_bf16_f32 v21, v21, v22
    v_mfma_f32_16x16x32_bf16 v[48:51], a[196:199], a[148:151], v[48:51]
    s_waitcnt lgkmcnt(3)
    ds_read_b64_tr_b16 a[190:191], v10 offset:38912
    v_cvt_pk_bf16_f32 v22, v23, v5
    v_mfma_f32_16x16x32_bf16 v[48:51], a[192:195], a[144:147], v[48:51]
    v_accvgpr_write_b32 a0, v21
    v_accvgpr_write_b32 a1, v22
    v_mfma_f32_16x16x32_bf16 v[44:47], a[192:195], a[136:139], v[44:47]
    v_accvgpr_read_b32 v21, a168
    v_accvgpr_read_b32 v22, a169
    v_mfma_f32_16x16x32_bf16 v[44:47], a[196:199], a[140:143], v[44:47]
    v_accvgpr_read_b32 v23, a170
    v_accvgpr_read_b32 v5, a171
    v_mfma_f32_16x16x32_bf16 v[40:43], a[196:199], a[132:135], v[40:43]
    v_mul_f32 v21, v16, v21
    v_mul_f32 v22, v16, v22
    v_mfma_f32_16x16x32_bf16 v[40:43], a[192:195], a[128:131], v[40:43]
    ds_read_b64_tr_b16 a[192:193], v10 offset:40960
    v_mul_f32 v23, v16, v23
    v_mfma_f32_16x16x32_bf16 v[40:43], a[200:203], v[128:131], v[40:43]
    ds_read_b64_tr_b16 a[194:195], v10 offset:43008
    v_mul_f32 v5, v16, v5
    v_mfma_f32_16x16x32_bf16 v[40:43], a[204:207], v[132:135], v[40:43]
    ds_read_b64_tr_b16 a[196:197], v10 offset:45056
    v_cvt_pk_bf16_f32 v21, v21, v22
    v_mfma_f32_16x16x32_bf16 v[44:47], a[204:207], v[140:143], v[44:47]
    ds_read_b64_tr_b16 a[198:199], v10 offset:47104
    v_cvt_pk_bf16_f32 v22, v23, v5
    v_mfma_f32_16x16x32_bf16 v[44:47], a[200:203], v[136:139], v[44:47]
    v_accvgpr_write_b32 a2, v21
    v_accvgpr_write_b32 a3, v22
    v_mfma_f32_16x16x32_bf16 v[48:51], a[200:203], v[144:147], v[48:51]
    buffer_store_dwordx4 a[0:3], v14, s[20:23], s55 offen offset:0 sc1
    v_accvgpr_read_b32 v21, a156
    v_mfma_f32_16x16x32_bf16 v[48:51], a[204:207], v[148:151], v[48:51]
    v_accvgpr_read_b32 v22, a157
    v_accvgpr_read_b32 v23, a158
    v_mfma_f32_16x16x32_bf16 v[52:55], a[204:207], v[156:159], v[52:55]
    v_accvgpr_read_b32 v5, a159
    v_mul_f32 v21, v17, v21
    v_mfma_f32_16x16x32_bf16 v[52:55], a[200:203], v[152:155], v[52:55]
    ds_read_b64_tr_b16 a[200:201], v10 offset:49152
    v_mul_f32 v22, v17, v22
    v_mfma_f32_16x16x32_bf16 v[52:55], a[208:211], v[184:187], v[52:55]
    ds_read_b64_tr_b16 a[202:203], v10 offset:51200
    v_mul_f32 v23, v17, v23
    v_mfma_f32_16x16x32_bf16 v[52:55], a[212:215], v[188:191], v[52:55]
    ds_read_b64_tr_b16 a[204:205], v10 offset:53248
    v_mul_f32 v5, v17, v5
    v_mfma_f32_16x16x32_bf16 v[48:51], a[212:215], v[180:183], v[48:51]
    s_waitcnt lgkmcnt(3)
    ds_read_b64_tr_b16 a[206:207], v10 offset:55296
    v_cvt_pk_bf16_f32 v21, v21, v22
    v_mfma_f32_16x16x32_bf16 v[48:51], a[208:211], v[176:179], v[48:51]
    v_cvt_pk_bf16_f32 v22, v23, v5
    v_accvgpr_write_b32 a4, v21
    v_mfma_f32_16x16x32_bf16 v[44:47], a[208:211], v[168:171], v[44:47]
    v_accvgpr_write_b32 a5, v22
    v_accvgpr_read_b32 v21, a172
    v_mfma_f32_16x16x32_bf16 v[44:47], a[212:215], v[172:175], v[44:47]
    v_accvgpr_read_b32 v22, a173
    v_accvgpr_read_b32 v23, a174
    v_mfma_f32_16x16x32_bf16 v[40:43], a[212:215], v[164:167], v[40:43]
    v_accvgpr_read_b32 v5, a175
    v_mul_f32 v21, v17, v21
    v_mfma_f32_16x16x32_bf16 v[40:43], a[208:211], v[160:163], v[40:43]
    ds_read_b64_tr_b16 a[208:209], v10 offset:57344
    v_mul_f32 v22, v17, v22
    v_mfma_f32_16x16x32_bf16 v[40:43], a[184:187], v[192:195], v[40:43]
    ds_read_b64_tr_b16 a[210:211], v10 offset:59392
    v_mul_f32 v23, v17, v23
    v_mfma_f32_16x16x32_bf16 v[40:43], a[188:191], v[196:199], v[40:43]
    ds_read_b64_tr_b16 a[212:213], v10 offset:61440
    v_mul_f32 v5, v17, v5
    v_mfma_f32_16x16x32_bf16 v[44:47], a[188:191], v[204:207], v[44:47]
    ds_read_b64_tr_b16 a[214:215], v10 offset:63488
    v_cvt_pk_bf16_f32 v21, v21, v22
    v_mfma_f32_16x16x32_bf16 v[44:47], a[184:187], v[200:203], v[44:47]
    v_cvt_pk_bf16_f32 v22, v23, v5
    v_accvgpr_write_b32 a6, v21
    v_mfma_f32_16x16x32_bf16 v[48:51], a[184:187], v[208:211], v[48:51]
    v_accvgpr_write_b32 a7, v22
    v_accvgpr_read_b32 v21, a160
    v_mfma_f32_16x16x32_bf16 v[48:51], a[188:191], v[212:215], v[48:51]
    buffer_store_dwordx4 a[4:7], v14, s[20:23], s55 offen offset:1024 sc1
    v_accvgpr_read_b32 v22, a161
    v_mfma_f32_16x16x32_bf16 v[52:55], a[188:191], v[220:223], v[52:55]
    v_accvgpr_read_b32 v23, a162
    v_accvgpr_read_b32 v5, a163
    v_mfma_f32_16x16x32_bf16 v[52:55], a[184:187], v[216:219], v[52:55]
    ds_read_b64_tr_b16 a[184:185], v11 offset:0
    v_mul_f32 v21, v18, v21
    v_mfma_f32_16x16x32_bf16 v[52:55], a[192:195], v[248:251], v[52:55]
    ds_read_b64_tr_b16 a[186:187], v11 offset:2048
    v_mul_f32 v22, v18, v22
    v_mfma_f32_16x16x32_bf16 v[52:55], a[196:199], v[252:255], v[52:55]
    ds_read_b64_tr_b16 a[188:189], v11 offset:4096
    v_mul_f32 v23, v18, v23
    v_mfma_f32_16x16x32_bf16 v[48:51], a[196:199], v[244:247], v[48:51]
    s_waitcnt lgkmcnt(3)
    ds_read_b64_tr_b16 a[190:191], v11 offset:6144
    v_mul_f32 v5, v18, v5
    v_mfma_f32_16x16x32_bf16 v[48:51], a[192:195], v[240:243], v[48:51]
    v_cvt_pk_bf16_f32 v21, v21, v22
    v_cvt_pk_bf16_f32 v22, v23, v5
    v_mfma_f32_16x16x32_bf16 v[44:47], a[192:195], v[232:235], v[44:47]
    v_accvgpr_write_b32 a8, v21
    v_accvgpr_write_b32 a9, v22
    v_mfma_f32_16x16x32_bf16 v[44:47], a[196:199], v[236:239], v[44:47]
    v_accvgpr_read_b32 v21, a176
    v_accvgpr_read_b32 v22, a177
    v_mfma_f32_16x16x32_bf16 v[40:43], a[196:199], v[228:231], v[40:43]
    v_accvgpr_read_b32 v23, a178
    v_accvgpr_read_b32 v5, a179
    v_mfma_f32_16x16x32_bf16 v[40:43], a[192:195], v[224:227], v[40:43]
    ds_read_b64_tr_b16 a[192:193], v11 offset:8192
    v_mul_f32 v21, v18, v21
    v_mfma_f32_16x16x32_bf16 v[40:43], a[200:203], v[56:59], v[40:43]
    ds_read_b64_tr_b16 a[194:195], v11 offset:10240
    v_mul_f32 v22, v18, v22
    v_mfma_f32_16x16x32_bf16 v[40:43], a[204:207], v[60:63], v[40:43]
    ds_read_b64_tr_b16 a[196:197], v11 offset:12288
    v_mul_f32 v23, v18, v23
    v_mfma_f32_16x16x32_bf16 v[44:47], a[204:207], v[68:71], v[44:47]
    ds_read_b64_tr_b16 a[198:199], v11 offset:14336
    v_mul_f32 v5, v18, v5
    v_mfma_f32_16x16x32_bf16 v[44:47], a[200:203], v[64:67], v[44:47]
    v_cvt_pk_bf16_f32 v21, v21, v22
    v_cvt_pk_bf16_f32 v22, v23, v5
    v_mfma_f32_16x16x32_bf16 v[48:51], a[200:203], v[72:75], v[48:51]
    v_accvgpr_write_b32 a10, v21
    v_accvgpr_write_b32 a11, v22
    v_mfma_f32_16x16x32_bf16 v[48:51], a[204:207], v[76:79], v[48:51]
    buffer_store_dwordx4 a[8:11], v14, s[20:23], s55 offen offset:2048 sc1
    v_accvgpr_read_b32 v21, a164
    v_mfma_f32_16x16x32_bf16 v[52:55], a[204:207], v[84:87], v[52:55]
    v_accvgpr_read_b32 v22, a165
    v_accvgpr_read_b32 v23, a166
    v_mfma_f32_16x16x32_bf16 v[52:55], a[200:203], v[80:83], v[52:55]
    ds_read_b64_tr_b16 a[200:201], v11 offset:16384
    v_accvgpr_read_b32 v5, a167
    v_mfma_f32_16x16x32_bf16 v[52:55], a[208:211], v[112:115], v[52:55]
    ds_read_b64_tr_b16 a[202:203], v11 offset:18432
    v_mul_f32 v21, v19, v21
    v_mfma_f32_16x16x32_bf16 v[52:55], a[212:215], v[116:119], v[52:55]
    ds_read_b64_tr_b16 a[204:205], v11 offset:20480
    v_mul_f32 v22, v19, v22
    v_mfma_f32_16x16x32_bf16 v[48:51], a[212:215], v[108:111], v[48:51]
    s_waitcnt lgkmcnt(3)
    ds_read_b64_tr_b16 a[206:207], v11 offset:22528
    v_mul_f32 v23, v19, v23
    v_mfma_f32_16x16x32_bf16 v[48:51], a[208:211], v[104:107], v[48:51]
    v_mul_f32 v5, v19, v5
    v_cvt_pk_bf16_f32 v21, v21, v22
    v_mfma_f32_16x16x32_bf16 v[44:47], a[208:211], v[96:99], v[44:47]
    v_cvt_pk_bf16_f32 v22, v23, v5
    v_accvgpr_write_b32 a12, v21
    v_mfma_f32_16x16x32_bf16 v[44:47], a[212:215], v[100:103], v[44:47]
    v_accvgpr_write_b32 a13, v22
    v_accvgpr_read_b32 v21, a180
    v_mfma_f32_16x16x32_bf16 v[40:43], a[212:215], v[92:95], v[40:43]
    v_accvgpr_read_b32 v22, a181
    v_accvgpr_read_b32 v23, a182
    v_mfma_f32_16x16x32_bf16 v[40:43], a[208:211], v[88:91], v[40:43]
    ds_read_b64_tr_b16 a[208:209], v11 offset:24576
    v_accvgpr_read_b32 v5, a183
    v_mfma_f32_16x16x32_bf16 v[24:27], a[184:187], a[96:99], 0
    ds_read_b64_tr_b16 a[210:211], v11 offset:26624
    v_mul_f32 v21, v19, v21
    v_mfma_f32_16x16x32_bf16 v[24:27], a[188:191], a[100:103], v[24:27]
    ds_read_b64_tr_b16 a[212:213], v11 offset:28672
    v_mul_f32 v22, v19, v22
    v_mfma_f32_16x16x32_bf16 v[28:31], a[188:191], a[108:111], 0
    ds_read_b64_tr_b16 a[214:215], v11 offset:30720
    v_mul_f32 v23, v19, v23
    v_mfma_f32_16x16x32_bf16 v[28:31], a[184:187], a[104:107], v[28:31]
    v_mul_f32 v5, v19, v5
    v_cvt_pk_bf16_f32 v21, v21, v22
    v_mfma_f32_16x16x32_bf16 v[32:35], a[184:187], a[112:115], 0
    v_cvt_pk_bf16_f32 v22, v23, v5
    v_accvgpr_write_b32 a14, v21
    v_mfma_f32_16x16x32_bf16 v[32:35], a[188:191], a[116:119], v[32:35]
pg_9:
    s_cbranch_execz pg_13
    v_accvgpr_write_b32 a15, v22
    v_mul_f32 v40, v16, v40
    v_mfma_f32_16x16x32_bf16 v[36:39], a[188:191], a[124:127], 0
    buffer_store_dwordx4 a[12:15], v14, s[20:23], s55 offen offset:3072 sc1
    v_mul_f32 v41, v16, v41
    v_mfma_f32_16x16x32_bf16 v[36:39], a[184:187], a[120:123], v[36:39]
    s_add_u32 s55, s55, 4096
    ds_read_b64_tr_b16 a[184:185], v11 offset:32768
    v_mul_f32 v42, v16, v42
    v_mfma_f32_16x16x32_bf16 v[36:39], a[192:195], v[120:123], v[36:39]
    ds_read_b64_tr_b16 a[186:187], v11 offset:34816
    v_mul_f32 v43, v16, v43
    v_mfma_f32_16x16x32_bf16 v[36:39], a[196:199], v[124:127], v[36:39]
    ds_read_b64_tr_b16 a[188:189], v11 offset:36864
    v_cvt_pk_bf16_f32 v40, v40, v41
    v_mfma_f32_16x16x32_bf16 v[32:35], a[196:199], a[148:151], v[32:35]
    s_waitcnt lgkmcnt(3)
    ds_read_b64_tr_b16 a[190:191], v11 offset:38912
    v_cvt_pk_bf16_f32 v41, v42, v43
    v_mfma_f32_16x16x32_bf16 v[32:35], a[192:195], a[144:147], v[32:35]
    v_accvgpr_write_b32 a16, v40
    v_accvgpr_write_b32 a17, v41
    v_mfma_f32_16x16x32_bf16 v[28:31], a[192:195], a[136:139], v[28:31]
    v_mul_f32 v44, v17, v44
    v_mul_f32 v45, v17, v45
    v_mfma_f32_16x16x32_bf16 v[28:31], a[196:199], a[140:143], v[28:31]
    v_mul_f32 v46, v17, v46
    v_mul_f32 v47, v17, v47
    v_mfma_f32_16x16x32_bf16 v[24:27], a[196:199], a[132:135], v[24:27]
    v_cvt_pk_bf16_f32 v44, v44, v45
    v_cvt_pk_bf16_f32 v45, v46, v47
    v_mfma_f32_16x16x32_bf16 v[24:27], a[192:195], a[128:131], v[24:27]
    ds_read_b64_tr_b16 a[192:193], v11 offset:40960
    v_accvgpr_write_b32 a20, v44
    v_mfma_f32_16x16x32_bf16 v[24:27], a[200:203], v[128:131], v[24:27]
    ds_read_b64_tr_b16 a[194:195], v11 offset:43008
    v_accvgpr_write_b32 a21, v45
    v_mfma_f32_16x16x32_bf16 v[24:27], a[204:207], v[132:135], v[24:27]
    ds_read_b64_tr_b16 a[196:197], v11 offset:45056
    v_mul_f32 v48, v18, v48
    v_mfma_f32_16x16x32_bf16 v[28:31], a[204:207], v[140:143], v[28:31]
    ds_read_b64_tr_b16 a[198:199], v11 offset:47104
    v_mul_f32 v49, v18, v49
    v_mfma_f32_16x16x32_bf16 v[28:31], a[200:203], v[136:139], v[28:31]
    v_mul_f32 v50, v18, v50
    v_mul_f32 v51, v18, v51
    v_mfma_f32_16x16x32_bf16 v[32:35], a[200:203], v[144:147], v[32:35]
    v_cvt_pk_bf16_f32 v48, v48, v49
    v_cvt_pk_bf16_f32 v49, v50, v51
    v_mfma_f32_16x16x32_bf16 v[32:35], a[204:207], v[148:151], v[32:35]
    v_accvgpr_write_b32 a24, v48
    v_accvgpr_write_b32 a25, v49
    v_mfma_f32_16x16x32_bf16 v[36:39], a[204:207], v[156:159], v[36:39]
    v_mul_f32 v52, v19, v52
    v_mul_f32 v53, v19, v53
    v_mfma_f32_16x16x32_bf16 v[36:39], a[200:203], v[152:155], v[36:39]
    ds_read_b64_tr_b16 a[200:201], v11 offset:49152
    v_mul_f32 v54, v19, v54
    v_mfma_f32_16x16x32_bf16 v[36:39], a[208:211], v[184:187], v[36:39]
    ds_read_b64_tr_b16 a[202:203], v11 offset:51200
    v_mul_f32 v55, v19, v55
    v_mfma_f32_16x16x32_bf16 v[36:39], a[212:215], v[188:191], v[36:39]
    ds_read_b64_tr_b16 a[204:205], v11 offset:53248
    v_cvt_pk_bf16_f32 v52, v52, v53
    v_mfma_f32_16x16x32_bf16 v[32:35], a[212:215], v[180:183], v[32:35]
    s_waitcnt lgkmcnt(3)
    ds_read_b64_tr_b16 a[206:207], v11 offset:55296
    v_cvt_pk_bf16_f32 v53, v54, v55
    v_mfma_f32_16x16x32_bf16 v[32:35], a[208:211], v[176:179], v[32:35]
    v_accvgpr_write_b32 a28, v52
    v_accvgpr_write_b32 a29, v53
    v_mfma_f32_16x16x32_bf16 v[28:31], a[208:211], v[168:171], v[28:31]
    v_subrev_u32 v10, 73728, v10
    v_mfma_f32_16x16x32_bf16 v[28:31], a[212:215], v[172:175], v[28:31]
    v_mfma_f32_16x16x32_bf16 v[24:27], a[212:215], v[164:167], v[24:27]
    v_mfma_f32_16x16x32_bf16 v[24:27], a[208:211], v[160:163], v[24:27]
    ds_read_b64_tr_b16 a[208:209], v11 offset:57344
    v_mfma_f32_16x16x32_bf16 v[24:27], a[184:187], v[192:195], v[24:27]
    ds_read_b64_tr_b16 a[210:211], v11 offset:59392
    v_mfma_f32_16x16x32_bf16 v[24:27], a[188:191], v[196:199], v[24:27]
    ds_read_b64_tr_b16 a[212:213], v11 offset:61440
    v_mfma_f32_16x16x32_bf16 v[28:31], a[188:191], v[204:207], v[28:31]
    ds_read_b64_tr_b16 a[214:215], v11 offset:63488
    v_mfma_f32_16x16x32_bf16 v[28:31], a[184:187], v[200:203], v[28:31]
    s_add_u32 s39, s40, 256
    v_subrev_u32 v11, 73728, v11
    v_mfma_f32_16x16x32_bf16 v[32:35], a[184:187], v[208:211], v[32:35]
    v_mfma_f32_16x16x32_bf16 v[32:35], a[188:191], v[212:215], v[32:35]
    s_add_u32 m0, s63, 73728
    v_mfma_f32_16x16x32_bf16 v[36:39], a[188:191], v[220:223], v[36:39]
    v_mfma_f32_16x16x32_bf16 v[36:39], a[184:187], v[216:219], v[36:39]
    v_mfma_f32_16x16x32_bf16 v[36:39], a[192:195], v[248:251], v[36:39]
    v_mfma_f32_16x16x32_bf16 v[36:39], a[196:199], v[252:255], v[36:39]
    s_waitcnt vmcnt(17) lgkmcnt(0)
    v_mfma_f32_16x16x32_bf16 v[32:35], a[196:199], v[244:247], v[32:35]
    s_barrier
    v_mfma_f32_16x16x32_bf16 v[32:35], a[192:195], v[240:243], v[32:35]
    buffer_load_dwordx4 v6, s[16:19], s39 offen lds
    v_mfma_f32_16x16x32_bf16 v[28:31], a[192:195], v[232:235], v[28:31]
    ds_read_b64_tr_b16 a[184:185], v8 offset:49152
    v_mfma_f32_16x16x32_bf16 v[28:31], a[196:199], v[236:239], v[28:31]
    ds_read_b64_tr_b16 a[186:187], v8 offset:51200
    v_mfma_f32_16x16x32_bf16 v[24:27], a[196:199], v[228:231], v[24:27]
    ds_read_b64_tr_b16 a[188:189], v8 offset:53248
    v_mfma_f32_16x16x32_bf16 v[24:27], a[192:195], v[224:227], v[24:27]
    s_add_u32 s39, s40, 12544
    ds_read_b64_tr_b16 a[190:191], v8 offset:55296
    v_mfma_f32_16x16x32_bf16 v[24:27], a[200:203], v[56:59], v[24:27]
    ds_read_b64_tr_b16 a[192:193], v8 offset:57344
    v_mfma_f32_16x16x32_bf16 v[24:27], a[204:207], v[60:63], v[24:27]
    s_add_u32 m0, s63, 77824
    ds_read_b64_tr_b16 a[194:195], v8 offset:59392
    v_mfma_f32_16x16x32_bf16 v[28:31], a[204:207], v[68:71], v[28:31]
    ds_read_b64_tr_b16 a[196:197], v8 offset:61440
    v_mfma_f32_16x16x32_bf16 v[28:31], a[200:203], v[64:67], v[28:31]
    ds_read_b64_tr_b16 a[198:199], v8 offset:63488
    v_mfma_f32_16x16x32_bf16 v[32:35], a[200:203], v[72:75], v[32:35]
    v_mfma_f32_16x16x32_bf16 v[32:35], a[204:207], v[76:79], v[32:35]
    v_mfma_f32_16x16x32_bf16 v[36:39], a[204:207], v[84:87], v[36:39]
    v_mfma_f32_16x16x32_bf16 v[36:39], a[200:203], v[80:83], v[36:39]
    buffer_load_dwordx4 v6, s[16:19], s39 offen lds
    v_mfma_f32_16x16x32_bf16 v[36:39], a[208:211], v[112:115], v[36:39]
    ds_read_b64_tr_b16 a[200:201], v8 offset:0
    v_mfma_f32_16x16x32_bf16 v[36:39], a[212:215], v[116:119], v[36:39]
    ds_read_b64_tr_b16 a[202:203], v8 offset:2048
    v_mfma_f32_16x16x32_bf16 v[32:35], a[212:215], v[108:111], v[32:35]
    ds_read_b64_tr_b16 a[204:205], v8 offset:4096
    v_mfma_f32_16x16x32_bf16 v[32:35], a[208:211], v[104:107], v[32:35]
    s_waitcnt lgkmcnt(3)
    ds_read_b64_tr_b16 a[206:207], v8 offset:6144
    s_add_u32 s39, s40, 24832
    v_mfma_f32_16x16x32_bf16 v[28:31], a[208:211], v[96:99], v[28:31]
    v_mul_f32 v36, v19, v36
    v_mfma_f32_16x16x32_bf16 v[28:31], a[212:215], v[100:103], v[28:31]
    s_add_u32 m0, s63, 81920
    v_mul_f32 v37, v19, v37
    v_mul_f32 v32, v18, v32
    v_mfma_f32_16x16x32_bf16 v[24:27], a[212:215], v[92:95], v[24:27]
    v_mul_f32 v33, v18, v33
    v_mfma_f32_16x16x32_bf16 v[24:27], a[208:211], v[88:91], v[24:27]
    ds_read_b64_tr_b16 a[208:209], v8 offset:8192
    v_mfma_f32_16x16x32_bf16 v[40:43], a[184:187], a[96:99], 0
    ds_read_b64_tr_b16 a[210:211], v8 offset:10240
    v_mul_f32 v28, v17, v28
    v_mfma_f32_16x16x32_bf16 v[40:43], a[188:191], a[100:103], v[40:43]
    ds_read_b64_tr_b16 a[212:213], v8 offset:12288
    v_mul_f32 v29, v17, v29
    v_mfma_f32_16x16x32_bf16 v[44:47], a[188:191], a[108:111], 0
    ds_read_b64_tr_b16 a[214:215], v8 offset:14336
    v_mul_f32 v24, v16, v24
    v_mfma_f32_16x16x32_bf16 v[44:47], a[184:187], a[104:107], v[44:47]
    buffer_load_dwordx4 v6, s[16:19], s39 offen lds
    v_mfma_f32_16x16x32_bf16 v[48:51], a[184:187], a[112:115], 0
    v_mul_f32 v25, v16, v25
    v_mul_f32 v26, v16, v26
    v_mfma_f32_16x16x32_bf16 v[48:51], a[188:191], a[116:119], v[48:51]
    v_mul_f32 v27, v16, v27
    v_cvt_pk_bf16_f32 v24, v24, v25
    v_mfma_f32_16x16x32_bf16 v[52:55], a[188:191], a[124:127], 0
    v_cvt_pk_bf16_f32 v25, v26, v27
    v_accvgpr_write_b32 a18, v24
    v_mfma_f32_16x16x32_bf16 v[52:55], a[184:187], a[120:123], v[52:55]
    s_add_u32 s39, s40, 37120
    v_accvgpr_write_b32 a19, v25
    v_mul_f32 v30, v17, v30
    v_mfma_f32_16x16x32_bf16 v[52:55], a[192:195], v[120:123], v[52:55]
    buffer_store_dwordx4 a[16:19], v14, s[20:23], s55 offen offset:0 sc1
    v_mul_f32 v31, v17, v31
    v_mfma_f32_16x16x32_bf16 v[52:55], a[196:199], v[124:127], v[52:55]
    s_add_u32 m0, s63, 86016
    v_cvt_pk_bf16_f32 v28, v28, v29
    v_cvt_pk_bf16_f32 v29, v30, v31
    v_mfma_f32_16x16x32_bf16 v[48:51], a[196:199], a[148:151], v[48:51]
    v_accvgpr_write_b32 a22, v28
    v_accvgpr_write_b32 a23, v29
    v_mfma_f32_16x16x32_bf16 v[48:51], a[192:195], a[144:147], v[48:51]
    buffer_store_dwordx4 a[20:23], v14, s[20:23], s55 offen offset:1024 sc1
    v_mul_f32 v34, v18, v34
    v_mfma_f32_16x16x32_bf16 v[44:47], a[192:195], a[136:139], v[44:47]
    v_mul_f32 v35, v18, v35
    v_mfma_f32_16x16x32_bf16 v[44:47], a[196:199], a[140:143], v[44:47]
    s_waitcnt lgkmcnt(0)
    v_cvt_pk_bf16_f32 v32, v32, v33
    v_mfma_f32_16x16x32_bf16 v[40:43], a[196:199], a[132:135], v[40:43]
    v_cvt_pk_bf16_f32 v33, v34, v35
    v_accvgpr_write_b32 a26, v32
    v_mfma_f32_16x16x32_bf16 v[40:43], a[192:195], a[128:131], v[40:43]
    buffer_load_dwordx4 v6, s[16:19], s39 offen lds
    v_mfma_f32_16x16x32_bf16 v[40:43], a[200:203], v[128:131], v[40:43]
    v_accvgpr_write_b32 a27, v33
    v_mfma_f32_16x16x32_bf16 v[40:43], a[204:207], v[132:135], v[40:43]
    buffer_store_dwordx4 a[24:27], v14, s[20:23], s55 offen offset:2048 sc1
    v_mul_f32 v38, v19, v38
    v_mfma_f32_16x16x32_bf16 v[44:47], a[204:207], v[140:143], v[44:47]
    v_mul_f32 v39, v19, v39
    v_mfma_f32_16x16x32_bf16 v[44:47], a[200:203], v[136:139], v[44:47]
    s_waitcnt vmcnt(16)
    v_cvt_pk_bf16_f32 v36, v36, v37
    s_add_u32 s39, s40, 49408
    v_mfma_f32_16x16x32_bf16 v[48:51], a[200:203], v[144:147], v[48:51]
    s_barrier
    v_mfma_f32_16x16x32_bf16 v[48:51], a[204:207], v[148:151], v[48:51]
    s_add_u32 m0, s63, 90112
    ds_read_b64_tr_b16 a[184:185], v8 offset:16384
    v_cvt_pk_bf16_f32 v37, v38, v39
    v_mfma_f32_16x16x32_bf16 v[52:55], a[204:207], v[156:159], v[52:55]
    s_waitcnt vmcnt(7)
    ds_read_b64_tr_b16 a[186:187], v8 offset:18432
    v_accvgpr_write_b32 a30, v36
    v_mfma_f32_16x16x32_bf16 v[52:55], a[200:203], v[152:155], v[52:55]
    buffer_store_dword v4, v15, s[24:27], s76 offen sc1
    v_mfma_f32_16x16x32_bf16 v[52:55], a[208:211], v[184:187], v[52:55]
    ds_read_b64_tr_b16 a[188:189], v8 offset:20480
    v_mov_b32 v4, s56
    v_mfma_f32_16x16x32_bf16 v[52:55], a[212:215], v[188:191], v[52:55]
    s_add_u32 s56, s7, 3
    ds_read_b64_tr_b16 a[190:191], v8 offset:22528
    v_accvgpr_write_b32 a31, v37
    v_mfma_f32_16x16x32_bf16 v[48:51], a[212:215], v[180:183], v[48:51]
    buffer_store_dwordx4 a[28:31], v14, s[20:23], s55 offen offset:3072 sc1
    v_mfma_f32_16x16x32_bf16 v[48:51], a[208:211], v[176:179], v[48:51]
    buffer_load_dwordx4 v6, s[16:19], s39 offen lds
    v_mfma_f32_16x16x32_bf16 v[44:47], a[208:211], v[168:171], v[44:47]
    s_add_u32 s55, s55, 4096
    ds_read_b64_tr_b16 a[192:193], v8 offset:24576
    v_mfma_f32_16x16x32_bf16 v[44:47], a[212:215], v[172:175], v[44:47]
    s_waitcnt lgkmcnt(3)
    ds_read_b64_tr_b16 a[194:195], v8 offset:26624
    v_mfma_f32_16x16x32_bf16 v[40:43], a[212:215], v[164:167], v[40:43]
    ds_read_b64_tr_b16 a[196:197], v8 offset:28672
    v_mfma_f32_16x16x32_bf16 v[40:43], a[208:211], v[160:163], v[40:43]
    s_add_u32 s39, s40, 61696
    ds_read_b64_tr_b16 a[198:199], v8 offset:30720
    v_mfma_f32_16x16x32_bf16 v[40:43], a[184:187], v[192:195], v[40:43]
    s_waitcnt lgkmcnt(4)
    ds_read_b64_tr_b16 a[200:201], v8 offset:32768
    v_mfma_f32_16x16x32_bf16 v[40:43], a[188:191], v[196:199], v[40:43]
    s_add_u32 m0, s63, 94208
    ds_read_b64_tr_b16 a[202:203], v8 offset:34816
    v_mfma_f32_16x16x32_bf16 v[44:47], a[188:191], v[204:207], v[44:47]
    ds_read_b64_tr_b16 a[204:205], v8 offset:36864
    v_mfma_f32_16x16x32_bf16 v[44:47], a[184:187], v[200:203], v[44:47]
    ds_read_b64_tr_b16 a[206:207], v8 offset:38912
    v_mfma_f32_16x16x32_bf16 v[48:51], a[184:187], v[208:211], v[48:51]
    ds_read_b64_tr_b16 a[208:209], v8 offset:40960
    v_mfma_f32_16x16x32_bf16 v[48:51], a[188:191], v[212:215], v[48:51]
    s_waitcnt lgkmcnt(6)
    ds_read_b64_tr_b16 a[210:211], v8 offset:43008
    v_mfma_f32_16x16x32_bf16 v[52:55], a[188:191], v[220:223], v[52:55]
    s_waitcnt lgkmcnt(6)
    ds_read_b64_tr_b16 a[212:213], v8 offset:45056
    v_mfma_f32_16x16x32_bf16 v[52:55], a[184:187], v[216:219], v[52:55]
    buffer_load_dwordx4 v6, s[16:19], s39 offen lds
    v_mfma_f32_16x16x32_bf16 v[52:55], a[192:195], v[248:251], v[52:55]
    ds_read_b64_tr_b16 a[214:215], v8 offset:47104
    v_mfma_f32_16x16x32_bf16 v[52:55], a[196:199], v[252:255], v[52:55]
    ds_read_b64_tr_b16 a[184:185], v9 offset:49152
    v_mfma_f32_16x16x32_bf16 v[48:51], a[196:199], v[244:247], v[48:51]
    ds_read_b64_tr_b16 a[186:187], v9 offset:51200
    v_mfma_f32_16x16x32_bf16 v[48:51], a[192:195], v[240:243], v[48:51]
    s_add_u32 s39, s40, 73984
    ds_read_b64_tr_b16 a[188:189], v9 offset:53248
    v_mfma_f32_16x16x32_bf16 v[44:47], a[192:195], v[232:235], v[44:47]
    s_waitcnt lgkmcnt(5)
    ds_read_b64_tr_b16 a[190:191], v9 offset:55296
    v_mfma_f32_16x16x32_bf16 v[44:47], a[196:199], v[236:239], v[44:47]
    s_add_u32 m0, s63, 98304
    v_add_u32 v8, 73728, v8
    v_mfma_f32_16x16x32_bf16 v[40:43], a[196:199], v[228:231], v[40:43]
    v_mfma_f32_16x16x32_bf16 v[40:43], a[192:195], v[224:227], v[40:43]
    ds_read_b64_tr_b16 a[192:193], v9 offset:57344
    v_mfma_f32_16x16x32_bf16 v[40:43], a[200:203], v[56:59], v[40:43]
    ds_read_b64_tr_b16 a[194:195], v9 offset:59392
    v_mfma_f32_16x16x32_bf16 v[40:43], a[204:207], v[60:63], v[40:43]
    ds_read_b64_tr_b16 a[196:197], v9 offset:61440
    v_mfma_f32_16x16x32_bf16 v[44:47], a[204:207], v[68:71], v[44:47]
    ds_read_b64_tr_b16 a[198:199], v9 offset:63488
    v_mfma_f32_16x16x32_bf16 v[44:47], a[200:203], v[64:67], v[44:47]
    buffer_load_dwordx4 v6, s[16:19], s39 offen lds
    v_mfma_f32_16x16x32_bf16 v[48:51], a[200:203], v[72:75], v[48:51]
    v_mfma_f32_16x16x32_bf16 v[48:51], a[204:207], v[76:79], v[48:51]
    v_mfma_f32_16x16x32_bf16 v[52:55], a[204:207], v[84:87], v[52:55]
    s_waitcnt lgkmcnt(3)
    v_mfma_f32_16x16x32_bf16 v[52:55], a[200:203], v[80:83], v[52:55]
    s_add_u32 s39, s40, 86272
    ds_read_b64_tr_b16 a[200:201], v9 offset:0
    v_mfma_f32_16x16x32_bf16 v[52:55], a[208:211], v[112:115], v[52:55]
    ds_read_b64_tr_b16 a[202:203], v9 offset:2048
    v_mfma_f32_16x16x32_bf16 v[52:55], a[212:215], v[116:119], v[52:55]
    s_add_u32 m0, s63, 102400
    ds_read_b64_tr_b16 a[204:205], v9 offset:4096
    v_mfma_f32_16x16x32_bf16 v[48:51], a[212:215], v[108:111], v[48:51]
    ds_read_b64_tr_b16 a[206:207], v9 offset:6144
    v_mfma_f32_16x16x32_bf16 v[48:51], a[208:211], v[104:107], v[48:51]
    v_mfma_f32_16x16x32_bf16 v[44:47], a[208:211], v[96:99], v[44:47]
    v_mfma_f32_16x16x32_bf16 v[44:47], a[212:215], v[100:103], v[44:47]
    v_mfma_f32_16x16x32_bf16 v[40:43], a[212:215], v[92:95], v[40:43]
    v_mul_f32 v52, v19, v52
    v_mfma_f32_16x16x32_bf16 v[40:43], a[208:211], v[88:91], v[40:43]
    buffer_load_dwordx4 v6, s[16:19], s39 offen lds
    v_mfma_f32_16x16x32_bf16 v[24:27], a[184:187], a[96:99], 0
    ds_read_b64_tr_b16 a[208:209], v9 offset:8192
    v_mul_f32 v48, v18, v48
    v_mfma_f32_16x16x32_bf16 v[24:27], a[188:191], a[100:103], v[24:27]
    ds_read_b64_tr_b16 a[210:211], v9 offset:10240
    v_mul_f32 v44, v17, v44
    v_mfma_f32_16x16x32_bf16 v[28:31], a[188:191], a[108:111], 0
    ds_read_b64_tr_b16 a[212:213], v9 offset:12288
    v_mul_f32 v40, v16, v40
    v_mfma_f32_16x16x32_bf16 v[28:31], a[184:187], a[104:107], v[28:31]
    s_add_u32 s39, s40, 98560
    ds_read_b64_tr_b16 a[214:215], v9 offset:14336
    v_mul_f32 v41, v16, v41
    v_mfma_f32_16x16x32_bf16 v[32:35], a[184:187], a[112:115], 0
    s_waitcnt lgkmcnt(4)
    v_mul_f32 v42, v16, v42
    v_mul_f32 v43, v16, v43
    v_mfma_f32_16x16x32_bf16 v[32:35], a[188:191], a[116:119], v[32:35]
    s_add_u32 m0, s63, 106496
    v_cvt_pk_bf16_f32 v40, v40, v41
    v_cvt_pk_bf16_f32 v41, v42, v43
    v_mfma_f32_16x16x32_bf16 v[36:39], a[188:191], a[124:127], 0
    v_accvgpr_write_b32 a32, v40
    v_accvgpr_write_b32 a33, v41
    v_mfma_f32_16x16x32_bf16 v[36:39], a[184:187], a[120:123], v[36:39]
    ds_read_b64_tr_b16 a[184:185], v9 offset:16384
    v_mul_f32 v45, v17, v45
    v_mfma_f32_16x16x32_bf16 v[36:39], a[192:195], v[120:123], v[36:39]
    s_add_u32 s77, s7, 1
    ds_read_b64_tr_b16 a[186:187], v9 offset:18432
    v_mul_f32 v46, v17, v46
    v_mfma_f32_16x16x32_bf16 v[36:39], a[196:199], v[124:127], v[36:39]
    ds_read_b64_tr_b16 a[188:189], v9 offset:20480
    v_mul_f32 v47, v17, v47
    v_mfma_f32_16x16x32_bf16 v[32:35], a[196:199], a[148:151], v[32:35]
    ds_read_b64_tr_b16 a[190:191], v9 offset:22528
    v_cvt_pk_bf16_f32 v44, v44, v45
    v_mfma_f32_16x16x32_bf16 v[32:35], a[192:195], a[144:147], v[32:35]
    buffer_load_dwordx4 v6, s[16:19], s39 offen lds
    v_mfma_f32_16x16x32_bf16 v[28:31], a[192:195], a[136:139], v[28:31]
    s_load_dwordx4 s[72:75], s[86:87], s5 glc
    v_cvt_pk_bf16_f32 v45, v46, v47
    v_accvgpr_write_b32 a36, v44
    v_mfma_f32_16x16x32_bf16 v[28:31], a[196:199], a[140:143], v[28:31]
    v_accvgpr_write_b32 a37, v45
    v_mfma_f32_16x16x32_bf16 v[24:27], a[196:199], a[132:135], v[24:27]
    v_mul_f32 v49, v18, v49
    v_mul_f32 v50, v18, v50
    v_mfma_f32_16x16x32_bf16 v[24:27], a[192:195], a[128:131], v[24:27]
    s_add_u32 s39, s40, 110848
    ds_read_b64_tr_b16 a[192:193], v9 offset:24576
    v_mul_f32 v51, v18, v51
    v_mfma_f32_16x16x32_bf16 v[24:27], a[200:203], v[128:131], v[24:27]
    ds_read_b64_tr_b16 a[194:195], v9 offset:26624
    v_cvt_pk_bf16_f32 v48, v48, v49
    v_mfma_f32_16x16x32_bf16 v[24:27], a[204:207], v[132:135], v[24:27]
    s_add_u32 m0, s63, 110592
    ds_read_b64_tr_b16 a[196:197], v9 offset:28672
    v_cvt_pk_bf16_f32 v49, v50, v51
    v_mfma_f32_16x16x32_bf16 v[28:31], a[204:207], v[140:143], v[28:31]
    s_waitcnt lgkmcnt(3)
    ds_read_b64_tr_b16 a[198:199], v9 offset:30720
    v_accvgpr_write_b32 a40, v48
    v_mfma_f32_16x16x32_bf16 v[28:31], a[200:203], v[136:139], v[28:31]
    v_accvgpr_write_b32 a41, v49
    v_mfma_f32_16x16x32_bf16 v[32:35], a[200:203], v[144:147], v[32:35]
    v_mul_f32 v53, v19, v53
    v_mul_f32 v54, v19, v54
    v_mfma_f32_16x16x32_bf16 v[32:35], a[204:207], v[148:151], v[32:35]
    v_mul_f32 v55, v19, v55
    v_cvt_pk_bf16_f32 v52, v52, v53
    v_mfma_f32_16x16x32_bf16 v[36:39], a[204:207], v[156:159], v[36:39]
    v_cvt_pk_bf16_f32 v53, v54, v55
    v_accvgpr_write_b32 a44, v52
    v_mfma_f32_16x16x32_bf16 v[36:39], a[200:203], v[152:155], v[36:39]
    buffer_load_dwordx4 v6, s[16:19], s39 offen lds
    v_mfma_f32_16x16x32_bf16 v[36:39], a[208:211], v[184:187], v[36:39]
    ds_read_b64_tr_b16 a[200:201], v9 offset:32768
    v_accvgpr_write_b32 a45, v53
    v_mfma_f32_16x16x32_bf16 v[36:39], a[212:215], v[188:191], v[36:39]
    ds_read_b64_tr_b16 a[202:203], v9 offset:34816
    v_mfma_f32_16x16x32_bf16 v[32:35], a[212:215], v[180:183], v[32:35]
    ds_read_b64_tr_b16 a[204:205], v9 offset:36864
    v_mfma_f32_16x16x32_bf16 v[32:35], a[208:211], v[176:179], v[32:35]
    s_add_u32 s39, s40, 123136
    ds_read_b64_tr_b16 a[206:207], v9 offset:38912
    v_mfma_f32_16x16x32_bf16 v[28:31], a[208:211], v[168:171], v[28:31]
    v_mfma_f32_16x16x32_bf16 v[28:31], a[212:215], v[172:175], v[28:31]
    s_add_u32 m0, s63, 114688
    v_mfma_f32_16x16x32_bf16 v[24:27], a[212:215], v[164:167], v[24:27]
    v_mfma_f32_16x16x32_bf16 v[24:27], a[208:211], v[160:163], v[24:27]
    ds_read_b64_tr_b16 a[208:209], v9 offset:40960
    v_mfma_f32_16x16x32_bf16 v[24:27], a[184:187], v[192:195], v[24:27]
    ds_read_b64_tr_b16 a[210:211], v9 offset:43008
    v_mfma_f32_16x16x32_bf16 v[24:27], a[188:191], v[196:199], v[24:27]
    ds_read_b64_tr_b16 a[212:213], v9 offset:45056
    v_mfma_f32_16x16x32_bf16 v[28:31], a[188:191], v[204:207], v[28:31]
    s_waitcnt lgkmcnt(3)
    ds_read_b64_tr_b16 a[214:215], v9 offset:47104
    v_mfma_f32_16x16x32_bf16 v[28:31], a[184:187], v[200:203], v[28:31]
    buffer_load_dwordx4 v6, s[16:19], s39 offen lds
    v_mfma_f32_16x16x32_bf16 v[32:35], a[184:187], v[208:211], v[32:35]
    v_add_u32 v9, 73728, v9
    v_mfma_f32_16x16x32_bf16 v[32:35], a[188:191], v[212:215], v[32:35]
    v_mfma_f32_16x16x32_bf16 v[36:39], a[188:191], v[220:223], v[36:39]
    v_mfma_f32_16x16x32_bf16 v[36:39], a[184:187], v[216:219], v[36:39]
    s_add_u32 s39, s40, 135424
    ds_read_b64_tr_b16 a[184:185], v10 offset:49152
    v_mfma_f32_16x16x32_bf16 v[36:39], a[192:195], v[248:251], v[36:39]
    ds_read_b64_tr_b16 a[186:187], v10 offset:51200
    v_mfma_f32_16x16x32_bf16 v[36:39], a[196:199], v[252:255], v[36:39]
    s_add_u32 m0, s63, 118784
    ds_read_b64_tr_b16 a[188:189], v10 offset:53248
    v_mfma_f32_16x16x32_bf16 v[32:35], a[196:199], v[244:247], v[32:35]
    s_barrier
    v_mfma_f32_16x16x32_bf16 v[32:35], a[192:195], v[240:243], v[32:35]
    s_waitcnt vmcnt(7)
    ds_read_b64_tr_b16 a[190:191], v10 offset:55296
    v_mfma_f32_16x16x32_bf16 v[28:31], a[192:195], v[232:235], v[28:31]
    buffer_store_dword v4, v15, s[24:27], s76 offen sc1
    v_mfma_f32_16x16x32_bf16 v[28:31], a[196:199], v[236:239], v[28:31]
    v_mov_b32 v4, s56
    v_mfma_f32_16x16x32_bf16 v[24:27], a[196:199], v[228:231], v[24:27]
    s_add_u32 s56, s7, 4
    v_mfma_f32_16x16x32_bf16 v[24:27], a[192:195], v[224:227], v[24:27]
    buffer_load_dwordx4 v6, s[16:19], s39 offen lds
    v_mfma_f32_16x16x32_bf16 v[24:27], a[200:203], v[56:59], v[24:27]
    ds_read_b64_tr_b16 a[192:193], v10 offset:57344
    v_mfma_f32_16x16x32_bf16 v[24:27], a[204:207], v[60:63], v[24:27]
    ds_read_b64_tr_b16 a[194:195], v10 offset:59392
    v_mfma_f32_16x16x32_bf16 v[28:31], a[204:207], v[68:71], v[28:31]
    ds_read_b64_tr_b16 a[196:197], v10 offset:61440
    v_mfma_f32_16x16x32_bf16 v[28:31], a[200:203], v[64:67], v[28:31]
    s_waitcnt lgkmcnt(3)
    ds_read_b64_tr_b16 a[198:199], v10 offset:63488
    s_add_u32 s39, s40, 147712
    v_mfma_f32_16x16x32_bf16 v[32:35], a[200:203], v[72:75], v[32:35]
    v_mfma_f32_16x16x32_bf16 v[32:35], a[204:207], v[76:79], v[32:35]
    s_add_u32 m0, s63, 122880
    v_mfma_f32_16x16x32_bf16 v[36:39], a[204:207], v[84:87], v[36:39]
    v_mfma_f32_16x16x32_bf16 v[36:39], a[200:203], v[80:83], v[36:39]
    ds_read_b64_tr_b16 a[200:201], v10 offset:0
    v_mfma_f32_16x16x32_bf16 v[36:39], a[208:211], v[112:115], v[36:39]
    ds_read_b64_tr_b16 a[202:203], v10 offset:2048
    v_mfma_f32_16x16x32_bf16 v[36:39], a[212:215], v[116:119], v[36:39]
    ds_read_b64_tr_b16 a[204:205], v10 offset:4096
    v_mfma_f32_16x16x32_bf16 v[32:35], a[212:215], v[108:111], v[32:35]
    s_sub_u32 s78, s72, s77
    ds_read_b64_tr_b16 a[206:207], v10 offset:6144
    s_sub_u32 s79, s73, s77
    v_mfma_f32_16x16x32_bf16 v[32:35], a[208:211], v[104:107], v[32:35]
    buffer_load_dwordx4 v6, s[16:19], s39 offen lds
    v_mfma_f32_16x16x32_bf16 v[28:31], a[208:211], v[96:99], v[28:31]
    s_max_u32 s78, s78, s79
    v_mul_f32 v36, v19, v36
    s_sub_u32 s79, s74, s77
    v_mfma_f32_16x16x32_bf16 v[28:31], a[212:215], v[100:103], v[28:31]
    s_max_u32 s78, s78, s79
    v_mul_f32 v37, v19, v37
    v_mul_f32 v32, v18, v32
    v_mfma_f32_16x16x32_bf16 v[24:27], a[212:215], v[92:95], v[24:27]
    s_sub_u32 s79, s75, s77
    v_mul_f32 v33, v18, v33
    s_max_u32 s78, s78, s79
    v_mfma_f32_16x16x32_bf16 v[24:27], a[208:211], v[88:91], v[24:27]
    s_cmp_gt_u32 s78, 5
    s_cbranch_scc1 spin_o0
spin_o0_ret:
    v_mul_f32 v28, v17, v28
    v_mfma_f32_16x16x32_bf16 v[40:43], a[184:187], a[96:99], 0
    s_add_u32 s37, s59, 0
    ds_read_b64_tr_b16 a[208:209], v10 offset:8192
    v_lshrrev_b32 v22, 2, v1
    v_mfma_f32_16x16x32_bf16 v[40:43], a[188:191], a[100:103], v[40:43]
    s_add_u32 s39, s40, 160000
    ds_read_b64_tr_b16 a[210:211], v10 offset:10240
    v_min_u32 v22, 9, v22
    v_mfma_f32_16x16x32_bf16 v[44:47], a[188:191], a[108:111], 0
    s_add_u32 m0, s63, 126976
    ds_read_b64_tr_b16 a[212:213], v10 offset:12288
    v_mul_u32_u24 v22, 6144, v22
    v_mfma_f32_16x16x32_bf16 v[44:47], a[184:187], a[104:107], v[44:47]
    s_waitcnt lgkmcnt(3)
    ds_read_b64_tr_b16 a[214:215], v10 offset:14336
    v_and_b32 v23, 3, v1
    v_mfma_f32_16x16x32_bf16 v[48:51], a[184:187], a[112:115], 0
    buffer_load_dwordx4 a[216:219], v14, s[20:23], s37 offen offset:0 sc1
    v_mfma_f32_16x16x32_bf16 v[48:51], a[188:191], a[116:119], v[48:51]
    s_lshl_b32 s42, s48, 8
    v_lshl_add_u32 v22, v23, 2, v22
    v_mul_f32 v24, v16, v24
    v_mfma_f32_16x16x32_bf16 v[52:55], a[188:191], a[124:127], 0
    s_add_u32 s42, s42, 3932304
    v_mul_f32 v25, v16, v25
    v_mul_f32 v26, v16, v26
    v_mfma_f32_16x16x32_bf16 v[52:55], a[184:187], a[120:123], v[52:55]
    buffer_load_dword v23, v22, s[24:27], s42 offen sc1
    v_mfma_f32_16x16x32_bf16 v[52:55], a[192:195], v[120:123], v[52:55]
    buffer_load_dwordx4 v6, s[16:19], s39 offen lds
    v_mfma_f32_16x16x32_bf16 v[52:55], a[196:199], v[124:127], v[52:55]
    buffer_load_dwordx4 a[220:223], v14, s[20:23], s37 offen offset:1024 sc1
    v_mfma_f32_16x16x32_bf16 v[48:51], a[196:199], a[148:151], v[48:51]
    ds_read_b64_tr_b16 a[184:185], v10 offset:16384
    v_mul_f32 v27, v16, v27
    v_mfma_f32_16x16x32_bf16 v[48:51], a[192:195], a[144:147], v[48:51]
    s_add_u32 s39, s40, 172288
    ds_read_b64_tr_b16 a[186:187], v10 offset:18432
    v_cvt_pk_bf16_f32 v24, v24, v25
    v_mfma_f32_16x16x32_bf16 v[44:47], a[192:195], a[136:139], v[44:47]
    ds_read_b64_tr_b16 a[188:189], v10 offset:20480
    v_cvt_pk_bf16_f32 v25, v26, v27
    v_mfma_f32_16x16x32_bf16 v[44:47], a[196:199], a[140:143], v[44:47]
    s_add_u32 m0, s63, 131072
    ds_read_b64_tr_b16 a[190:191], v10 offset:22528
    v_accvgpr_write_b32 a34, v24
    v_mfma_f32_16x16x32_bf16 v[40:43], a[196:199], a[132:135], v[40:43]
    buffer_load_dwordx4 a[224:227], v14, s[20:23], s37 offen offset:2048 sc1
    v_mfma_f32_16x16x32_bf16 v[40:43], a[192:195], a[128:131], v[40:43]
    ds_read_b64_tr_b16 a[192:193], v10 offset:24576
    v_accvgpr_write_b32 a35, v25
    v_mfma_f32_16x16x32_bf16 v[40:43], a[200:203], v[128:131], v[40:43]
    buffer_store_dwordx4 a[32:35], v14, s[20:23], s55 offen offset:0 sc1
    v_mul_f32 v29, v17, v29
    v_mfma_f32_16x16x32_bf16 v[40:43], a[204:207], v[132:135], v[40:43]
    ds_read_b64_tr_b16 a[194:195], v10 offset:26624
    v_mul_f32 v30, v17, v30
    v_mfma_f32_16x16x32_bf16 v[44:47], a[204:207], v[140:143], v[44:47]
    ds_read_b64_tr_b16 a[196:197], v10 offset:28672
    v_mul_f32 v31, v17, v31
    v_mfma_f32_16x16x32_bf16 v[44:47], a[200:203], v[136:139], v[44:47]
    s_waitcnt lgkmcnt(4)
    ds_read_b64_tr_b16 a[198:199], v10 offset:30720
    v_cvt_pk_bf16_f32 v28, v28, v29
    v_mfma_f32_16x16x32_bf16 v[48:51], a[200:203], v[144:147], v[48:51]
    buffer_load_dwordx4 a[228:231], v14, s[20:23], s37 offen offset:3072 sc1
    v_mfma_f32_16x16x32_bf16 v[48:51], a[204:207], v[148:151], v[48:51]
    buffer_load_dwordx4 v6, s[16:19], s39 offen lds
    v_mfma_f32_16x16x32_bf16 v[52:55], a[204:207], v[156:159], v[52:55]
    v_cvt_pk_bf16_f32 v29, v30, v31
    v_accvgpr_write_b32 a38, v28
    v_mfma_f32_16x16x32_bf16 v[52:55], a[200:203], v[152:155], v[52:55]
    s_add_u32 s39, s40, 184576
    ds_read_b64_tr_b16 a[200:201], v10 offset:32768
    v_accvgpr_write_b32 a39, v29
    v_mfma_f32_16x16x32_bf16 v[52:55], a[208:211], v[184:187], v[52:55]
    buffer_store_dwordx4 a[36:39], v14, s[20:23], s55 offen offset:1024 sc1
    v_mul_f32 v34, v18, v34
    v_mfma_f32_16x16x32_bf16 v[52:55], a[212:215], v[188:191], v[52:55]
    s_add_u32 m0, s63, 135168
    ds_read_b64_tr_b16 a[202:203], v10 offset:34816
    v_mul_f32 v35, v18, v35
    v_mfma_f32_16x16x32_bf16 v[48:51], a[212:215], v[180:183], v[48:51]
    s_add_u32 s40, s7, 1
    ds_read_b64_tr_b16 a[204:205], v10 offset:36864
    v_cvt_pk_bf16_f32 v32, v32, v33
    v_mfma_f32_16x16x32_bf16 v[48:51], a[208:211], v[176:179], v[48:51]
    ds_read_b64_tr_b16 a[206:207], v10 offset:38912
    v_cvt_pk_bf16_f32 v33, v34, v35
    v_mfma_f32_16x16x32_bf16 v[44:47], a[208:211], v[168:171], v[44:47]
    v_accvgpr_write_b32 a42, v32
    v_accvgpr_write_b32 a43, v33
    v_mfma_f32_16x16x32_bf16 v[44:47], a[212:215], v[172:175], v[44:47]
    buffer_store_dwordx4 a[40:43], v14, s[20:23], s55 offen offset:2048 sc1
    v_mul_f32 v38, v19, v38
    v_mfma_f32_16x16x32_bf16 v[40:43], a[212:215], v[164:167], v[40:43]
    s_waitcnt lgkmcnt(3)
    v_mul_f32 v39, v19, v39
    v_cvt_pk_bf16_f32 v36, v36, v37
    v_mfma_f32_16x16x32_bf16 v[40:43], a[208:211], v[160:163], v[40:43]
pg_10:
    s_cbranch_execz pg_14
    buffer_load_dwordx4 v6, s[16:19], s39 offen lds
    v_mfma_f32_16x16x32_bf16 v[40:43], a[184:187], v[192:195], v[40:43]
    s_add_u32 s39, s7, 1
    ds_read_b64_tr_b16 a[208:209], v10 offset:40960
    v_cvt_pk_bf16_f32 v37, v38, v39
    v_mfma_f32_16x16x32_bf16 v[40:43], a[188:191], v[196:199], v[40:43]
    ds_read_b64_tr_b16 a[210:211], v10 offset:43008
    v_accvgpr_write_b32 a46, v36
    v_mfma_f32_16x16x32_bf16 v[44:47], a[188:191], v[204:207], v[44:47]
    ds_read_b64_tr_b16 a[212:213], v10 offset:45056
    v_accvgpr_write_b32 a47, v37
    v_mfma_f32_16x16x32_bf16 v[44:47], a[184:187], v[200:203], v[44:47]
    buffer_store_dwordx4 a[44:47], v14, s[20:23], s55 offen offset:3072 sc1
    v_mov_b32 v6, s7
    v_mfma_f32_16x16x32_bf16 v[48:51], a[184:187], v[208:211], v[48:51]
    s_add_u32 s55, s55, 4096
    ds_read_b64_tr_b16 a[214:215], v10 offset:47104
    v_mfma_f32_16x16x32_bf16 v[48:51], a[188:191], v[212:215], v[48:51]
    v_add_u32 v10, 73728, v10
    v_mfma_f32_16x16x32_bf16 v[52:55], a[188:191], v[220:223], v[52:55]
    v_mfma_f32_16x16x32_bf16 v[52:55], a[184:187], v[216:219], v[52:55]
    ds_read_b64_tr_b16 a[184:185], v11 offset:49152
    v_mfma_f32_16x16x32_bf16 v[52:55], a[192:195], v[248:251], v[52:55]
    ds_read_b64_tr_b16 a[186:187], v11 offset:51200
    v_mfma_f32_16x16x32_bf16 v[52:55], a[196:199], v[252:255], v[52:55]
    s_add_u32 s77, s7, 2
    ds_read_b64_tr_b16 a[188:189], v11 offset:53248
    v_mfma_f32_16x16x32_bf16 v[48:51], a[196:199], v[244:247], v[48:51]
    s_add_u32 s37, s60, 0
    ds_read_b64_tr_b16 a[190:191], v11 offset:55296
    v_mfma_f32_16x16x32_bf16 v[48:51], a[192:195], v[240:243], v[48:51]
    s_waitcnt lgkmcnt(4)
    v_mfma_f32_16x16x32_bf16 v[44:47], a[192:195], v[232:235], v[44:47]
    v_mfma_f32_16x16x32_bf16 v[44:47], a[196:199], v[236:239], v[44:47]
    s_load_dwordx4 s[72:75], s[86:87], s5 glc
    v_mfma_f32_16x16x32_bf16 v[40:43], a[196:199], v[228:231], v[40:43]
    v_mfma_f32_16x16x32_bf16 v[40:43], a[192:195], v[224:227], v[40:43]
    ds_read_b64_tr_b16 a[192:193], v11 offset:57344
    v_mfma_f32_16x16x32_bf16 v[40:43], a[200:203], v[56:59], v[40:43]
    buffer_load_dwordx4 a[232:235], v14, s[20:23], s37 offen offset:0 sc1
    v_mfma_f32_16x16x32_bf16 v[40:43], a[204:207], v[60:63], v[40:43]
    ds_read_b64_tr_b16 a[194:195], v11 offset:59392
    v_mfma_f32_16x16x32_bf16 v[44:47], a[204:207], v[68:71], v[44:47]
    ds_read_b64_tr_b16 a[196:197], v11 offset:61440
    v_mfma_f32_16x16x32_bf16 v[44:47], a[200:203], v[64:67], v[44:47]
    ds_read_b64_tr_b16 a[198:199], v11 offset:63488
    v_mfma_f32_16x16x32_bf16 v[48:51], a[200:203], v[72:75], v[48:51]
    v_mfma_f32_16x16x32_bf16 v[48:51], a[204:207], v[76:79], v[48:51]
    buffer_load_dwordx4 a[236:239], v14, s[20:23], s37 offen offset:1024 sc1
    v_mfma_f32_16x16x32_bf16 v[52:55], a[204:207], v[84:87], v[52:55]
    v_mfma_f32_16x16x32_bf16 v[52:55], a[200:203], v[80:83], v[52:55]
    ds_read_b64_tr_b16 a[200:201], v11 offset:0
    v_mfma_f32_16x16x32_bf16 v[52:55], a[208:211], v[112:115], v[52:55]
    ds_read_b64_tr_b16 a[202:203], v11 offset:2048
    v_mfma_f32_16x16x32_bf16 v[52:55], a[212:215], v[116:119], v[52:55]
    ds_read_b64_tr_b16 a[204:205], v11 offset:4096
    v_mfma_f32_16x16x32_bf16 v[48:51], a[212:215], v[108:111], v[48:51]
    s_waitcnt lgkmcnt(3)
    ds_read_b64_tr_b16 a[206:207], v11 offset:6144
    v_mfma_f32_16x16x32_bf16 v[48:51], a[208:211], v[104:107], v[48:51]
    buffer_load_dwordx4 a[240:243], v14, s[20:23], s37 offen offset:2048 sc1
    v_mfma_f32_16x16x32_bf16 v[44:47], a[208:211], v[96:99], v[44:47]
    v_mfma_f32_16x16x32_bf16 v[44:47], a[212:215], v[100:103], v[44:47]
    v_mul_f32 v52, v19, v52
    v_mfma_f32_16x16x32_bf16 v[40:43], a[212:215], v[92:95], v[40:43]
    v_mul_f32 v53, v19, v53
    v_mfma_f32_16x16x32_bf16 v[40:43], a[208:211], v[88:91], v[40:43]
    buffer_load_dwordx4 a[244:247], v14, s[20:23], s37 offen offset:3072 sc1
    v_mfma_f32_16x16x32_bf16 v[24:27], a[184:187], a[96:99], 0
    s_add_u32 s37, s61, 0
    ds_read_b64_tr_b16 a[208:209], v11 offset:8192
    v_mul_f32 v44, v17, v44
    v_mfma_f32_16x16x32_bf16 v[24:27], a[188:191], a[100:103], v[24:27]
    ds_read_b64_tr_b16 a[210:211], v11 offset:10240
    v_mul_f32 v45, v17, v45
    v_mfma_f32_16x16x32_bf16 v[28:31], a[188:191], a[108:111], 0
    ds_read_b64_tr_b16 a[212:213], v11 offset:12288
    v_mul_f32 v40, v16, v40
    v_mfma_f32_16x16x32_bf16 v[28:31], a[184:187], a[104:107], v[28:31]
    s_waitcnt vmcnt(14)
    ds_read_b64_tr_b16 a[214:215], v11 offset:14336
    v_cmp_ne_u32 vcc, s7, v23
    v_mfma_f32_16x16x32_bf16 v[32:35], a[184:187], a[112:115], 0
    buffer_load_dwordx4 a[152:155], v14, s[20:23], s37 offen offset:0 sc1
    v_mfma_f32_16x16x32_bf16 v[32:35], a[188:191], a[116:119], v[32:35]
    s_cbranch_vccnz spin_gu
spin_gu_ret:
    v_mul_f32 v41, v16, v41
    v_mfma_f32_16x16x32_bf16 v[36:39], a[188:191], a[124:127], 0
    s_add_u32 s42, s7, 1
    v_mul_f32 v42, v16, v42
    v_mul_f32 v43, v16, v43
    v_mfma_f32_16x16x32_bf16 v[36:39], a[184:187], a[120:123], v[36:39]
    ds_read_b64_tr_b16 a[184:185], v11 offset:16384
    v_cvt_pk_bf16_f32 v40, v40, v41
    v_mfma_f32_16x16x32_bf16 v[36:39], a[192:195], v[120:123], v[36:39]
    ds_read_b64_tr_b16 a[186:187], v11 offset:18432
    v_cvt_pk_bf16_f32 v41, v42, v43
    v_mfma_f32_16x16x32_bf16 v[36:39], a[196:199], v[124:127], v[36:39]
    buffer_load_dwordx4 a[156:159], v14, s[20:23], s37 offen offset:1024 sc1
    v_mfma_f32_16x16x32_bf16 v[32:35], a[196:199], a[148:151], v[32:35]
    ds_read_b64_tr_b16 a[188:189], v11 offset:20480
    v_accvgpr_write_b32 a48, v40
    v_mfma_f32_16x16x32_bf16 v[32:35], a[192:195], a[144:147], v[32:35]
    s_waitcnt lgkmcnt(3)
    ds_read_b64_tr_b16 a[190:191], v11 offset:22528
    v_accvgpr_write_b32 a49, v41
    v_mfma_f32_16x16x32_bf16 v[28:31], a[192:195], a[136:139], v[28:31]
    v_mul_f32 v46, v17, v46
    v_mul_f32 v47, v17, v47
    v_mfma_f32_16x16x32_bf16 v[28:31], a[196:199], a[140:143], v[28:31]
    v_cvt_pk_bf16_f32 v44, v44, v45
    v_cvt_pk_bf16_f32 v45, v46, v47
    v_mfma_f32_16x16x32_bf16 v[24:27], a[196:199], a[132:135], v[24:27]
    buffer_load_dwordx4 a[160:163], v14, s[20:23], s37 offen offset:2048 sc1
    v_mfma_f32_16x16x32_bf16 v[24:27], a[192:195], a[128:131], v[24:27]
    ds_read_b64_tr_b16 a[192:193], v11 offset:24576
    v_accvgpr_write_b32 a52, v44
    v_mfma_f32_16x16x32_bf16 v[24:27], a[200:203], v[128:131], v[24:27]
    ds_read_b64_tr_b16 a[194:195], v11 offset:26624
    v_accvgpr_write_b32 a53, v45
    v_mfma_f32_16x16x32_bf16 v[24:27], a[204:207], v[132:135], v[24:27]
    ds_read_b64_tr_b16 a[196:197], v11 offset:28672
    v_mul_f32 v48, v18, v48
    v_mfma_f32_16x16x32_bf16 v[28:31], a[204:207], v[140:143], v[28:31]
    ds_read_b64_tr_b16 a[198:199], v11 offset:30720
    v_mul_f32 v49, v18, v49
    v_mfma_f32_16x16x32_bf16 v[28:31], a[200:203], v[136:139], v[28:31]
    buffer_load_dwordx4 a[164:167], v14, s[20:23], s37 offen offset:3072 sc1
    v_mfma_f32_16x16x32_bf16 v[32:35], a[200:203], v[144:147], v[32:35]
    v_mul_f32 v50, v18, v50
    v_mul_f32 v51, v18, v51
    v_mfma_f32_16x16x32_bf16 v[32:35], a[204:207], v[148:151], v[32:35]
    v_cvt_pk_bf16_f32 v48, v48, v49
    v_cvt_pk_bf16_f32 v49, v50, v51
    v_mfma_f32_16x16x32_bf16 v[36:39], a[204:207], v[156:159], v[36:39]
    v_accvgpr_write_b32 a56, v48
    v_accvgpr_write_b32 a57, v49
    v_mfma_f32_16x16x32_bf16 v[36:39], a[200:203], v[152:155], v[36:39]
    ds_read_b64_tr_b16 a[200:201], v11 offset:32768
    v_mul_f32 v54, v19, v54
    v_mfma_f32_16x16x32_bf16 v[36:39], a[208:211], v[184:187], v[36:39]
    ds_read_b64_tr_b16 a[202:203], v11 offset:34816
    v_mul_f32 v55, v19, v55
    v_mfma_f32_16x16x32_bf16 v[36:39], a[212:215], v[188:191], v[36:39]
    ds_read_b64_tr_b16 a[204:205], v11 offset:36864
    v_cvt_pk_bf16_f32 v52, v52, v53
    v_mfma_f32_16x16x32_bf16 v[32:35], a[212:215], v[180:183], v[32:35]
    s_waitcnt lgkmcnt(3)
    ds_read_b64_tr_b16 a[206:207], v11 offset:38912
    v_cvt_pk_bf16_f32 v53, v54, v55
    v_mfma_f32_16x16x32_bf16 v[32:35], a[208:211], v[176:179], v[32:35]
    s_sub_u32 s78, s72, s77
    v_accvgpr_write_b32 a60, v52
    v_accvgpr_write_b32 a61, v53
    v_mfma_f32_16x16x32_bf16 v[28:31], a[208:211], v[168:171], v[28:31]
    s_sub_u32 s79, s73, s77
    v_cmp_gt_u32 vcc, 16, v1
    s_max_u32 s78, s78, s79
    v_mfma_f32_16x16x32_bf16 v[28:31], a[212:215], v[172:175], v[28:31]
    s_sub_u32 s79, s74, s77
    s_max_u32 s78, s78, s79
    s_sub_u32 s79, s75, s77
    v_mfma_f32_16x16x32_bf16 v[24:27], a[212:215], v[164:167], v[24:27]
    s_max_u32 s78, s78, s79
    v_mfma_f32_16x16x32_bf16 v[24:27], a[208:211], v[160:163], v[24:27]
    s_cmp_gt_u32 s78, 4
    s_cbranch_scc1 spin_o1
spin_o1_ret:
    s_add_u32 s37, s59, 4096
    v_mfma_f32_16x16x32_bf16 v[24:27], a[184:187], v[192:195], v[24:27]
    ds_read_b64_tr_b16 a[208:209], v11 offset:40960
    v_mfma_f32_16x16x32_bf16 v[24:27], a[188:191], v[196:199], v[24:27]
    ds_read_b64_tr_b16 a[210:211], v11 offset:43008
    v_mfma_f32_16x16x32_bf16 v[28:31], a[188:191], v[204:207], v[28:31]
    ds_read_b64_tr_b16 a[212:213], v11 offset:45056
    v_mfma_f32_16x16x32_bf16 v[28:31], a[184:187], v[200:203], v[28:31]
    s_add_u32 s38, s44, 81920
    ds_read_b64_tr_b16 a[214:215], v11 offset:47104
    s_add_u32 s36, s44, 122880
    v_mfma_f32_16x16x32_bf16 v[32:35], a[184:187], v[208:211], v[32:35]
    s_cmp_lt_u32 s3, 2
    s_cselect_b32 s38, s38, s36
    v_mfma_f32_16x16x32_bf16 v[32:35], a[188:191], v[212:215], v[32:35]
    buffer_load_dwordx4 a[168:171], v14, s[20:23], s37 offen offset:0 sc1
    v_mfma_f32_16x16x32_bf16 v[36:39], a[188:191], v[220:223], v[36:39]
    s_add_u32 m0, s63, 16384
    v_add_u32 v11, 73728, v11
    v_mfma_f32_16x16x32_bf16 v[36:39], a[184:187], v[216:219], v[36:39]
    v_mfma_f32_16x16x32_bf16 v[36:39], a[192:195], v[248:251], v[36:39]
    v_mfma_f32_16x16x32_bf16 v[36:39], a[196:199], v[252:255], v[36:39]
    s_waitcnt vmcnt(10) lgkmcnt(0)
    v_mfma_f32_16x16x32_bf16 v[32:35], a[196:199], v[244:247], v[32:35]
    s_barrier
    v_mfma_f32_16x16x32_bf16 v[32:35], a[192:195], v[240:243], v[32:35]
    buffer_load_dwordx4 a[172:175], v14, s[20:23], s37 offen offset:1024 sc1
    v_mfma_f32_16x16x32_bf16 v[28:31], a[192:195], v[232:235], v[28:31]
    buffer_load_dwordx4 v7, s[8:11], s38 offen lds
    v_mfma_f32_16x16x32_bf16 v[28:31], a[196:199], v[236:239], v[28:31]
    ds_read_b64_tr_b16 a[184:185], v8 offset:0
    v_mfma_f32_16x16x32_bf16 v[24:27], a[196:199], v[228:231], v[24:27]
    ds_read_b64_tr_b16 a[186:187], v8 offset:2048
    v_mfma_f32_16x16x32_bf16 v[24:27], a[192:195], v[224:227], v[24:27]
    buffer_load_dwordx4 a[176:179], v14, s[20:23], s37 offen offset:2048 sc1
    v_mfma_f32_16x16x32_bf16 v[24:27], a[200:203], v[56:59], v[24:27]
    s_add_u32 s38, s44, 81920
    ds_read_b64_tr_b16 a[188:189], v8 offset:4096
    v_mfma_f32_16x16x32_bf16 v[24:27], a[204:207], v[60:63], v[24:27]
    s_add_u32 m0, s63, 0
    ds_read_b64_tr_b16 a[190:191], v8 offset:6144
    v_mfma_f32_16x16x32_bf16 v[28:31], a[204:207], v[68:71], v[28:31]
    ds_read_b64_tr_b16 a[192:193], v8 offset:8192
    v_mfma_f32_16x16x32_bf16 v[28:31], a[200:203], v[64:67], v[28:31]
    s_waitcnt vmcnt(12)
    ds_read_b64_tr_b16 a[194:195], v8 offset:10240
    v_mfma_f32_16x16x32_bf16 v[32:35], a[200:203], v[72:75], v[32:35]
    buffer_store_dword v4, v15, s[24:27], s76 offen sc1
    v_mfma_f32_16x16x32_bf16 v[32:35], a[204:207], v[76:79], v[32:35]
    buffer_load_dwordx4 a[180:183], v14, s[20:23], s37 offen offset:3072 sc1
    v_mfma_f32_16x16x32_bf16 v[36:39], a[204:207], v[84:87], v[36:39]
    ds_read_b64_tr_b16 a[196:197], v8 offset:12288
    v_mfma_f32_16x16x32_bf16 v[36:39], a[200:203], v[80:83], v[36:39]
    buffer_load_dwordx4 v2, s[8:11], s38 offen lds
    v_mfma_f32_16x16x32_bf16 v[36:39], a[208:211], v[112:115], v[36:39]
    ds_read_b64_tr_b16 a[198:199], v8 offset:14336
    v_mfma_f32_16x16x32_bf16 v[36:39], a[212:215], v[116:119], v[36:39]
    ds_read_b64_tr_b16 a[200:201], v8 offset:16384
    v_mfma_f32_16x16x32_bf16 v[32:35], a[212:215], v[108:111], v[32:35]
    ds_read_b64_tr_b16 a[202:203], v8 offset:18432
    v_mfma_f32_16x16x32_bf16 v[32:35], a[208:211], v[104:107], v[32:35]
    s_add_u32 s38, s44, 81920
    ds_read_b64_tr_b16 a[204:205], v8 offset:20480
    v_mfma_f32_16x16x32_bf16 v[28:31], a[208:211], v[96:99], v[28:31]
    s_waitcnt lgkmcnt(5)
    ds_read_b64_tr_b16 a[206:207], v8 offset:22528
    v_mfma_f32_16x16x32_bf16 v[28:31], a[212:215], v[100:103], v[28:31]
    s_add_u32 m0, s63, 4096
    v_mov_b32 v4, s56
    v_mul_f32 v32, v18, v32
    v_mfma_f32_16x16x32_bf16 v[24:27], a[212:215], v[92:95], v[24:27]
    s_add_u32 s56, s7, 5
    v_mul_f32 v33, v18, v33
    v_mul_f32 v34, v18, v34
    v_mfma_f32_16x16x32_bf16 v[24:27], a[208:211], v[88:91], v[24:27]
    ds_read_b64_tr_b16 a[208:209], v8 offset:24576
    v_mul_f32 v28, v17, v28
    v_mfma_f32_16x16x32_bf16 v[40:43], a[184:187], a[96:99], 0
    ds_read_b64_tr_b16 a[210:211], v8 offset:26624
    v_mul_f32 v29, v17, v29
    v_mfma_f32_16x16x32_bf16 v[40:43], a[188:191], a[100:103], v[40:43]
    ds_read_b64_tr_b16 a[212:213], v8 offset:28672
    v_mul_f32 v30, v17, v30
    v_mfma_f32_16x16x32_bf16 v[44:47], a[188:191], a[108:111], 0
    ds_read_b64_tr_b16 a[214:215], v8 offset:30720
    v_mul_f32 v24, v16, v24
    v_mfma_f32_16x16x32_bf16 v[44:47], a[184:187], a[104:107], v[44:47]
    buffer_load_dwordx4 v3, s[8:11], s38 offen lds
    v_mfma_f32_16x16x32_bf16 v[48:51], a[184:187], a[112:115], 0
    v_mul_f32 v25, v16, v25
    v_mul_f32 v26, v16, v26
    v_mfma_f32_16x16x32_bf16 v[48:51], a[188:191], a[116:119], v[48:51]
    v_mul_f32 v27, v16, v27
    v_cvt_pk_bf16_f32 v24, v24, v25
    v_mfma_f32_16x16x32_bf16 v[52:55], a[188:191], a[124:127], 0
    s_waitcnt lgkmcnt(3)
    v_cvt_pk_bf16_f32 v25, v26, v27
    v_accvgpr_write_b32 a50, v24
    v_mfma_f32_16x16x32_bf16 v[52:55], a[184:187], a[120:123], v[52:55]
    s_add_u32 s38, s44, 122880
    ds_read_b64_tr_b16 a[184:185], v8 offset:32768
    v_accvgpr_write_b32 a51, v25
    v_mfma_f32_16x16x32_bf16 v[52:55], a[192:195], v[120:123], v[52:55]
    buffer_store_dwordx4 a[48:51], v14, s[20:23], s55 offen offset:0 sc1
    v_mul_f32 v31, v17, v31
    v_mfma_f32_16x16x32_bf16 v[52:55], a[196:199], v[124:127], v[52:55]
    s_add_u32 m0, s63, 8192
    ds_read_b64_tr_b16 a[186:187], v8 offset:34816
    v_cvt_pk_bf16_f32 v28, v28, v29
    v_mfma_f32_16x16x32_bf16 v[48:51], a[196:199], a[148:151], v[48:51]
    ds_read_b64_tr_b16 a[188:189], v8 offset:36864
    v_cvt_pk_bf16_f32 v29, v30, v31
    v_mfma_f32_16x16x32_bf16 v[48:51], a[192:195], a[144:147], v[48:51]
    ds_read_b64_tr_b16 a[190:191], v8 offset:38912
    v_accvgpr_write_b32 a54, v28
    v_mfma_f32_16x16x32_bf16 v[44:47], a[192:195], a[136:139], v[44:47]
    v_accvgpr_write_b32 a55, v29
    v_mfma_f32_16x16x32_bf16 v[44:47], a[196:199], a[140:143], v[44:47]
    buffer_store_dwordx4 a[52:55], v14, s[20:23], s55 offen offset:1024 sc1
    v_mul_f32 v35, v18, v35
    v_mfma_f32_16x16x32_bf16 v[40:43], a[196:199], a[132:135], v[40:43]
    v_cvt_pk_bf16_f32 v32, v32, v33
    v_cvt_pk_bf16_f32 v33, v34, v35
    v_mfma_f32_16x16x32_bf16 v[40:43], a[192:195], a[128:131], v[40:43]
    buffer_load_dwordx4 v2, s[8:11], s38 offen lds
    v_mfma_f32_16x16x32_bf16 v[40:43], a[200:203], v[128:131], v[40:43]
    ds_read_b64_tr_b16 a[192:193], v8 offset:40960
    v_accvgpr_write_b32 a58, v32
    v_mfma_f32_16x16x32_bf16 v[40:43], a[204:207], v[132:135], v[40:43]
    ds_read_b64_tr_b16 a[194:195], v8 offset:43008
    v_accvgpr_write_b32 a59, v33
    v_mfma_f32_16x16x32_bf16 v[44:47], a[204:207], v[140:143], v[44:47]
    buffer_store_dwordx4 a[56:59], v14, s[20:23], s55 offen offset:2048 sc1
    v_mul_f32 v36, v19, v36
    v_mfma_f32_16x16x32_bf16 v[44:47], a[200:203], v[136:139], v[44:47]
    s_add_u32 s38, s44, 122880
    ds_read_b64_tr_b16 a[196:197], v8 offset:45056
    v_mfma_f32_16x16x32_bf16 v[48:51], a[200:203], v[144:147], v[48:51]
    ds_read_b64_tr_b16 a[198:199], v8 offset:47104
    v_mul_f32 v37, v19, v37
    v_mfma_f32_16x16x32_bf16 v[48:51], a[204:207], v[148:151], v[48:51]
    s_waitcnt lgkmcnt(4)
    v_mul_f32 v38, v19, v38
    v_mul_f32 v39, v19, v39
    v_mfma_f32_16x16x32_bf16 v[52:55], a[204:207], v[156:159], v[52:55]
    s_add_u32 m0, s63, 12288
    v_cvt_pk_bf16_f32 v36, v36, v37
    v_cvt_pk_bf16_f32 v37, v38, v39
    v_mfma_f32_16x16x32_bf16 v[52:55], a[200:203], v[152:155], v[52:55]
    ds_read_b64_tr_b16 a[200:201], v8 offset:49152
    v_accvgpr_write_b32 a62, v36
    v_mfma_f32_16x16x32_bf16 v[52:55], a[208:211], v[184:187], v[52:55]
    ds_read_b64_tr_b16 a[202:203], v8 offset:51200
    v_accvgpr_write_b32 a63, v37
    v_mfma_f32_16x16x32_bf16 v[52:55], a[212:215], v[188:191], v[52:55]
    buffer_store_dwordx4 a[60:63], v14, s[20:23], s55 offen offset:3072 sc1
    v_mfma_f32_16x16x32_bf16 v[48:51], a[212:215], v[180:183], v[48:51]
    s_add_u32 s55, s55, 4096
    ds_read_b64_tr_b16 a[204:205], v8 offset:53248
    v_mfma_f32_16x16x32_bf16 v[48:51], a[208:211], v[176:179], v[48:51]
    buffer_load_dwordx4 v3, s[8:11], s38 offen lds
    v_mfma_f32_16x16x32_bf16 v[44:47], a[208:211], v[168:171], v[44:47]
    ds_read_b64_tr_b16 a[206:207], v8 offset:55296
    v_mfma_f32_16x16x32_bf16 v[44:47], a[212:215], v[172:175], v[44:47]
    v_mfma_f32_16x16x32_bf16 v[40:43], a[212:215], v[164:167], v[40:43]
    v_mfma_f32_16x16x32_bf16 v[40:43], a[208:211], v[160:163], v[40:43]
    s_add_u32 s38, s44, 163840
    ds_read_b64_tr_b16 a[208:209], v8 offset:57344
    s_add_u32 s36, s45, 0
    v_mfma_f32_16x16x32_bf16 v[40:43], a[184:187], v[192:195], v[40:43]
    s_cmp_lt_u32 s3, 2
    s_cselect_b32 s38, s38, s36
    v_mfma_f32_16x16x32_bf16 v[40:43], a[188:191], v[196:199], v[40:43]
    s_add_u32 m0, s63, 36864
    ds_read_b64_tr_b16 a[210:211], v8 offset:59392
    v_mfma_f32_16x16x32_bf16 v[44:47], a[188:191], v[204:207], v[44:47]
    ds_read_b64_tr_b16 a[212:213], v8 offset:61440
    v_mfma_f32_16x16x32_bf16 v[44:47], a[184:187], v[200:203], v[44:47]
    s_waitcnt lgkmcnt(3)
    ds_read_b64_tr_b16 a[214:215], v8 offset:63488
    v_mfma_f32_16x16x32_bf16 v[48:51], a[184:187], v[208:211], v[48:51]
    v_add_u32 v8, 65536, v8
    v_mfma_f32_16x16x32_bf16 v[48:51], a[188:191], v[212:215], v[48:51]
    v_mfma_f32_16x16x32_bf16 v[52:55], a[188:191], v[220:223], v[52:55]
    v_mfma_f32_16x16x32_bf16 v[52:55], a[184:187], v[216:219], v[52:55]
    buffer_load_dwordx4 v7, s[8:11], s38 offen lds
    v_mfma_f32_16x16x32_bf16 v[52:55], a[192:195], v[248:251], v[52:55]
    ds_read_b64_tr_b16 a[184:185], v9 offset:0
    v_mfma_f32_16x16x32_bf16 v[52:55], a[196:199], v[252:255], v[52:55]
    ds_read_b64_tr_b16 a[186:187], v9 offset:2048
    v_mfma_f32_16x16x32_bf16 v[48:51], a[196:199], v[244:247], v[48:51]
    ds_read_b64_tr_b16 a[188:189], v9 offset:4096
    v_mfma_f32_16x16x32_bf16 v[48:51], a[192:195], v[240:243], v[48:51]
    s_add_u32 s38, s44, 163840
    ds_read_b64_tr_b16 a[190:191], v9 offset:6144
    v_mfma_f32_16x16x32_bf16 v[44:47], a[192:195], v[232:235], v[44:47]
    v_mfma_f32_16x16x32_bf16 v[44:47], a[196:199], v[236:239], v[44:47]
    s_add_u32 m0, s63, 20480
    v_mfma_f32_16x16x32_bf16 v[40:43], a[196:199], v[228:231], v[40:43]
    v_mfma_f32_16x16x32_bf16 v[40:43], a[192:195], v[224:227], v[40:43]
    ds_read_b64_tr_b16 a[192:193], v9 offset:8192
    v_mfma_f32_16x16x32_bf16 v[40:43], a[200:203], v[56:59], v[40:43]
    ds_read_b64_tr_b16 a[194:195], v9 offset:10240
    v_mfma_f32_16x16x32_bf16 v[40:43], a[204:207], v[60:63], v[40:43]
    ds_read_b64_tr_b16 a[196:197], v9 offset:12288
    v_mfma_f32_16x16x32_bf16 v[44:47], a[204:207], v[68:71], v[44:47]
    s_waitcnt lgkmcnt(3)
    ds_read_b64_tr_b16 a[198:199], v9 offset:14336
    v_mfma_f32_16x16x32_bf16 v[44:47], a[200:203], v[64:67], v[44:47]
    buffer_load_dwordx4 v2, s[8:11], s38 offen lds
    v_mfma_f32_16x16x32_bf16 v[48:51], a[200:203], v[72:75], v[48:51]
    v_mfma_f32_16x16x32_bf16 v[48:51], a[204:207], v[76:79], v[48:51]
    v_mfma_f32_16x16x32_bf16 v[52:55], a[204:207], v[84:87], v[52:55]
    v_mfma_f32_16x16x32_bf16 v[52:55], a[200:203], v[80:83], v[52:55]
    s_add_u32 s38, s44, 163840
    ds_read_b64_tr_b16 a[200:201], v9 offset:16384
    v_mfma_f32_16x16x32_bf16 v[52:55], a[208:211], v[112:115], v[52:55]
    ds_read_b64_tr_b16 a[202:203], v9 offset:18432
    v_mfma_f32_16x16x32_bf16 v[52:55], a[212:215], v[116:119], v[52:55]
    s_add_u32 m0, s63, 24576
    ds_read_b64_tr_b16 a[204:205], v9 offset:20480
    v_mfma_f32_16x16x32_bf16 v[48:51], a[212:215], v[108:111], v[48:51]
    ds_read_b64_tr_b16 a[206:207], v9 offset:22528
    v_mfma_f32_16x16x32_bf16 v[48:51], a[208:211], v[104:107], v[48:51]
    v_mfma_f32_16x16x32_bf16 v[44:47], a[208:211], v[96:99], v[44:47]
    v_mfma_f32_16x16x32_bf16 v[44:47], a[212:215], v[100:103], v[44:47]
    v_mfma_f32_16x16x32_bf16 v[40:43], a[212:215], v[92:95], v[40:43]
    v_mul_f32 v52, v19, v52
    v_mfma_f32_16x16x32_bf16 v[40:43], a[208:211], v[88:91], v[40:43]
    buffer_load_dwordx4 v3, s[8:11], s38 offen lds
    v_mfma_f32_16x16x32_bf16 v[24:27], a[184:187], a[96:99], 0
    ds_read_b64_tr_b16 a[208:209], v9 offset:24576
    v_mul_f32 v48, v18, v48
    v_mfma_f32_16x16x32_bf16 v[24:27], a[188:191], a[100:103], v[24:27]
    ds_read_b64_tr_b16 a[210:211], v9 offset:26624
    v_mul_f32 v44, v17, v44
    v_mfma_f32_16x16x32_bf16 v[28:31], a[188:191], a[108:111], 0
    ds_read_b64_tr_b16 a[212:213], v9 offset:28672
    v_mul_f32 v40, v16, v40
    v_mfma_f32_16x16x32_bf16 v[28:31], a[184:187], a[104:107], v[28:31]
    s_waitcnt lgkmcnt(3)
    ds_read_b64_tr_b16 a[214:215], v9 offset:30720
    v_mul_f32 v41, v16, v41
    v_mfma_f32_16x16x32_bf16 v[32:35], a[184:187], a[112:115], 0
    s_add_u32 s38, s45, 0
    v_mul_f32 v42, v16, v42
    v_mul_f32 v43, v16, v43
    v_mfma_f32_16x16x32_bf16 v[32:35], a[188:191], a[116:119], v[32:35]
    s_add_u32 m0, s63, 28672
    v_cvt_pk_bf16_f32 v40, v40, v41
    v_cvt_pk_bf16_f32 v41, v42, v43
    v_mfma_f32_16x16x32_bf16 v[36:39], a[188:191], a[124:127], 0
    v_accvgpr_write_b32 a64, v40
    v_accvgpr_write_b32 a65, v41
    v_mfma_f32_16x16x32_bf16 v[36:39], a[184:187], a[120:123], v[36:39]
    ds_read_b64_tr_b16 a[184:185], v9 offset:32768
    v_mul_f32 v45, v17, v45
    v_mfma_f32_16x16x32_bf16 v[36:39], a[192:195], v[120:123], v[36:39]
    ds_read_b64_tr_b16 a[186:187], v9 offset:34816
    v_mul_f32 v46, v17, v46
    v_mfma_f32_16x16x32_bf16 v[36:39], a[196:199], v[124:127], v[36:39]
    ds_read_b64_tr_b16 a[188:189], v9 offset:36864
    v_mul_f32 v47, v17, v47
    v_mfma_f32_16x16x32_bf16 v[32:35], a[196:199], a[148:151], v[32:35]
    ds_read_b64_tr_b16 a[190:191], v9 offset:38912
    v_cvt_pk_bf16_f32 v44, v44, v45
    v_mfma_f32_16x16x32_bf16 v[32:35], a[192:195], a[144:147], v[32:35]
    buffer_load_dwordx4 v2, s[8:11], s38 offen lds
    v_mfma_f32_16x16x32_bf16 v[28:31], a[192:195], a[136:139], v[28:31]
    v_cvt_pk_bf16_f32 v45, v46, v47
    v_accvgpr_write_b32 a68, v44
    v_mfma_f32_16x16x32_bf16 v[28:31], a[196:199], a[140:143], v[28:31]
    v_accvgpr_write_b32 a69, v45
    v_mfma_f32_16x16x32_bf16 v[24:27], a[196:199], a[132:135], v[24:27]
    v_mul_f32 v49, v18, v49
    v_mul_f32 v50, v18, v50
    v_mfma_f32_16x16x32_bf16 v[24:27], a[192:195], a[128:131], v[24:27]
    s_add_u32 s38, s45, 0
    ds_read_b64_tr_b16 a[192:193], v9 offset:40960
    v_mul_f32 v51, v18, v51
    v_mfma_f32_16x16x32_bf16 v[24:27], a[200:203], v[128:131], v[24:27]
    ds_read_b64_tr_b16 a[194:195], v9 offset:43008
    v_cvt_pk_bf16_f32 v48, v48, v49
    v_mfma_f32_16x16x32_bf16 v[24:27], a[204:207], v[132:135], v[24:27]
    s_add_u32 m0, s63, 32768
    ds_read_b64_tr_b16 a[196:197], v9 offset:45056
    v_cvt_pk_bf16_f32 v49, v50, v51
    v_mfma_f32_16x16x32_bf16 v[28:31], a[204:207], v[140:143], v[28:31]
    s_waitcnt lgkmcnt(3)
    ds_read_b64_tr_b16 a[198:199], v9 offset:47104
    v_accvgpr_write_b32 a72, v48
    v_mfma_f32_16x16x32_bf16 v[28:31], a[200:203], v[136:139], v[28:31]
    v_accvgpr_write_b32 a73, v49
    v_mfma_f32_16x16x32_bf16 v[32:35], a[200:203], v[144:147], v[32:35]
    v_mul_f32 v53, v19, v53
    v_mul_f32 v54, v19, v54
    v_mfma_f32_16x16x32_bf16 v[32:35], a[204:207], v[148:151], v[32:35]
    v_mul_f32 v55, v19, v55
    v_cvt_pk_bf16_f32 v52, v52, v53
    v_mfma_f32_16x16x32_bf16 v[36:39], a[204:207], v[156:159], v[36:39]
    v_cvt_pk_bf16_f32 v53, v54, v55
    v_accvgpr_write_b32 a76, v52
    v_mfma_f32_16x16x32_bf16 v[36:39], a[200:203], v[152:155], v[36:39]
    buffer_load_dwordx4 v3, s[8:11], s38 offen lds
    v_mfma_f32_16x16x32_bf16 v[36:39], a[208:211], v[184:187], v[36:39]
    ds_read_b64_tr_b16 a[200:201], v9 offset:49152
    v_accvgpr_write_b32 a77, v53
    v_mfma_f32_16x16x32_bf16 v[36:39], a[212:215], v[188:191], v[36:39]
    ds_read_b64_tr_b16 a[202:203], v9 offset:51200
    v_mfma_f32_16x16x32_bf16 v[32:35], a[212:215], v[180:183], v[32:35]
    ds_read_b64_tr_b16 a[204:205], v9 offset:53248
    v_mfma_f32_16x16x32_bf16 v[32:35], a[208:211], v[176:179], v[32:35]
    s_add_u32 s38, s46, 0
    ds_read_b64_tr_b16 a[206:207], v9 offset:55296
    s_add_u32 s36, s47, 0
    v_mfma_f32_16x16x32_bf16 v[28:31], a[208:211], v[168:171], v[28:31]
    s_cmp_lt_u32 s3, 2
    s_cselect_b32 s38, s38, s36
    v_mfma_f32_16x16x32_bf16 v[28:31], a[212:215], v[172:175], v[28:31]
    s_add_u32 m0, s63, 57344
    v_mfma_f32_16x16x32_bf16 v[24:27], a[212:215], v[164:167], v[24:27]
    v_mfma_f32_16x16x32_bf16 v[24:27], a[208:211], v[160:163], v[24:27]
    ds_read_b64_tr_b16 a[208:209], v9 offset:57344
    v_mfma_f32_16x16x32_bf16 v[24:27], a[184:187], v[192:195], v[24:27]
    ds_read_b64_tr_b16 a[210:211], v9 offset:59392
    v_mfma_f32_16x16x32_bf16 v[24:27], a[188:191], v[196:199], v[24:27]
    ds_read_b64_tr_b16 a[212:213], v9 offset:61440
    v_mfma_f32_16x16x32_bf16 v[28:31], a[188:191], v[204:207], v[28:31]
    s_waitcnt lgkmcnt(3)
    ds_read_b64_tr_b16 a[214:215], v9 offset:63488
    v_mfma_f32_16x16x32_bf16 v[28:31], a[184:187], v[200:203], v[28:31]
    buffer_load_dwordx4 v7, s[8:11], s38 offen lds
    v_mfma_f32_16x16x32_bf16 v[32:35], a[184:187], v[208:211], v[32:35]
    v_add_u32 v9, 65536, v9
    v_mfma_f32_16x16x32_bf16 v[32:35], a[188:191], v[212:215], v[32:35]
    v_mfma_f32_16x16x32_bf16 v[36:39], a[188:191], v[220:223], v[36:39]
    v_mfma_f32_16x16x32_bf16 v[36:39], a[184:187], v[216:219], v[36:39]
    s_add_u32 s38, s46, 0
    ds_read_b64_tr_b16 a[184:185], v10 offset:0
    v_mfma_f32_16x16x32_bf16 v[36:39], a[192:195], v[248:251], v[36:39]
    ds_read_b64_tr_b16 a[186:187], v10 offset:2048
    v_mfma_f32_16x16x32_bf16 v[36:39], a[196:199], v[252:255], v[36:39]
    s_add_u32 m0, s63, 40960
    ds_read_b64_tr_b16 a[188:189], v10 offset:4096
    v_mfma_f32_16x16x32_bf16 v[32:35], a[196:199], v[244:247], v[32:35]
    s_barrier
    v_mfma_f32_16x16x32_bf16 v[32:35], a[192:195], v[240:243], v[32:35]
    s_waitcnt vmcnt(7)
    ds_read_b64_tr_b16 a[190:191], v10 offset:6144
    v_mfma_f32_16x16x32_bf16 v[28:31], a[192:195], v[232:235], v[28:31]
    buffer_store_dword v4, v15, s[24:27], s76 offen sc1
    v_mfma_f32_16x16x32_bf16 v[28:31], a[196:199], v[236:239], v[28:31]
    v_mov_b32 v4, s56
    v_mfma_f32_16x16x32_bf16 v[24:27], a[196:199], v[228:231], v[24:27]
    v_mfma_f32_16x16x32_bf16 v[24:27], a[192:195], v[224:227], v[24:27]
    buffer_load_dwordx4 v2, s[8:11], s38 offen lds
    v_mfma_f32_16x16x32_bf16 v[24:27], a[200:203], v[56:59], v[24:27]
    ds_read_b64_tr_b16 a[192:193], v10 offset:8192
    v_mfma_f32_16x16x32_bf16 v[24:27], a[204:207], v[60:63], v[24:27]
    ds_read_b64_tr_b16 a[194:195], v10 offset:10240
    v_mfma_f32_16x16x32_bf16 v[28:31], a[204:207], v[68:71], v[28:31]
    ds_read_b64_tr_b16 a[196:197], v10 offset:12288
    v_mfma_f32_16x16x32_bf16 v[28:31], a[200:203], v[64:67], v[28:31]
    s_waitcnt lgkmcnt(3)
    ds_read_b64_tr_b16 a[198:199], v10 offset:14336
    s_add_u32 s38, s46, 0
    v_mfma_f32_16x16x32_bf16 v[32:35], a[200:203], v[72:75], v[32:35]
    v_mfma_f32_16x16x32_bf16 v[32:35], a[204:207], v[76:79], v[32:35]
    s_add_u32 m0, s63, 45056
    v_mfma_f32_16x16x32_bf16 v[36:39], a[204:207], v[84:87], v[36:39]
    v_mfma_f32_16x16x32_bf16 v[36:39], a[200:203], v[80:83], v[36:39]
    ds_read_b64_tr_b16 a[200:201], v10 offset:16384
    v_mfma_f32_16x16x32_bf16 v[36:39], a[208:211], v[112:115], v[36:39]
    ds_read_b64_tr_b16 a[202:203], v10 offset:18432
    v_mfma_f32_16x16x32_bf16 v[36:39], a[212:215], v[116:119], v[36:39]
    ds_read_b64_tr_b16 a[204:205], v10 offset:20480
    v_mfma_f32_16x16x32_bf16 v[32:35], a[212:215], v[108:111], v[32:35]
    ds_read_b64_tr_b16 a[206:207], v10 offset:22528
    v_mfma_f32_16x16x32_bf16 v[32:35], a[208:211], v[104:107], v[32:35]
    buffer_load_dwordx4 v3, s[8:11], s38 offen lds
    v_mfma_f32_16x16x32_bf16 v[28:31], a[208:211], v[96:99], v[28:31]
    v_mfma_f32_16x16x32_bf16 v[28:31], a[212:215], v[100:103], v[28:31]
    v_mfma_f32_16x16x32_bf16 v[24:27], a[212:215], v[92:95], v[24:27]
    v_mul_f32 v36, v19, v36
    v_mfma_f32_16x16x32_bf16 v[24:27], a[208:211], v[88:91], v[24:27]
    s_add_u32 s38, s47, 0
    ds_read_b64_tr_b16 a[208:209], v10 offset:24576
    v_mul_f32 v32, v18, v32
    v_mfma_f32_16x16x32_bf16 v[40:43], a[184:187], a[96:99], 0
    s_mul_i32 s57, s48, 10
    ds_read_b64_tr_b16 a[210:211], v10 offset:26624
    v_lshrrev_b32 v5, 5, v1
    v_mfma_f32_16x16x32_bf16 v[40:43], a[188:191], a[100:103], v[40:43]
    s_add_u32 m0, s63, 49152
    ds_read_b64_tr_b16 a[212:213], v10 offset:28672
    v_lshlrev_b32 v5, 3, v5
    v_mfma_f32_16x16x32_bf16 v[44:47], a[188:191], a[108:111], 0
pg_11:
    s_cbranch_execz pg_15
    s_waitcnt lgkmcnt(3)
    ds_read_b64_tr_b16 a[214:215], v10 offset:30720
    v_bfe_u32 v22, v1, 3, 2
    v_mfma_f32_16x16x32_bf16 v[44:47], a[184:187], a[104:107], v[44:47]
    s_sub_u32 s57, s58, s57
    v_add_u32 v22, v22, v5
    v_mul_u32_u24 v22, 1280, v22
    v_mfma_f32_16x16x32_bf16 v[48:51], a[184:187], a[112:115], 0
    s_mul_i32 s62, s48, 1280
    v_lshrrev_b32 v5, 4, v1
    v_lshlrev_b32 v5, 1, v5
    v_mfma_f32_16x16x32_bf16 v[48:51], a[188:191], a[116:119], v[48:51]
    s_lshl_b32 s56, s57, 6
    v_and_b32 v23, 7, v1
    v_xor_b32 v23, v23, v5
    v_mfma_f32_16x16x32_bf16 v[52:55], a[188:191], a[124:127], 0
    s_add_u32 s62, s62, s56
    v_lshlrev_b32 v23, 4, v23
    v_add_u32 v22, v22, v23
    v_mfma_f32_16x16x32_bf16 v[52:55], a[184:187], a[120:123], v[52:55]
    buffer_load_dwordx4 v2, s[8:11], s38 offen lds
    v_mfma_f32_16x16x32_bf16 v[52:55], a[192:195], v[120:123], v[52:55]
    s_lshl_b32 s56, s3, 4
    ds_read_b64_tr_b16 a[184:185], v10 offset:32768
    v_add_u32 v23, 20480, v22
    v_mfma_f32_16x16x32_bf16 v[52:55], a[196:199], v[124:127], v[52:55]
    s_add_u32 s62, s62, s56
    ds_read_b64_tr_b16 a[186:187], v10 offset:34816
    v_mul_f32 v24, v16, v24
    v_mfma_f32_16x16x32_bf16 v[48:51], a[196:199], a[148:151], v[48:51]
    s_lshl_b32 s62, s62, 2
    ds_read_b64_tr_b16 a[188:189], v10 offset:36864
    v_mul_f32 v25, v16, v25
    v_mfma_f32_16x16x32_bf16 v[48:51], a[192:195], a[144:147], v[48:51]
    s_add_u32 s38, s47, 0
    ds_read_b64_tr_b16 a[190:191], v10 offset:38912
    v_mul_f32 v26, v16, v26
    v_mfma_f32_16x16x32_bf16 v[44:47], a[192:195], a[136:139], v[44:47]
    s_add_u32 s62, s62, 3670016
    v_mul_f32 v27, v16, v27
    v_cvt_pk_bf16_f32 v24, v24, v25
    v_mfma_f32_16x16x32_bf16 v[44:47], a[196:199], a[140:143], v[44:47]
    s_add_u32 m0, s63, 53248
    v_cvt_pk_bf16_f32 v25, v26, v27
    v_accvgpr_write_b32 a66, v24
    v_mfma_f32_16x16x32_bf16 v[40:43], a[196:199], a[132:135], v[40:43]
    s_lshl_b32 s41, s48, 6
    v_accvgpr_write_b32 a67, v25
    v_mul_f32 v28, v17, v28
    v_mfma_f32_16x16x32_bf16 v[40:43], a[192:195], a[128:131], v[40:43]
    buffer_store_dwordx4 a[64:67], v14, s[20:23], s55 offen offset:0 sc1
    v_mul_f32 v29, v17, v29
    v_mfma_f32_16x16x32_bf16 v[40:43], a[200:203], v[128:131], v[40:43]
    s_lshr_b32 s56, s3, 1
    ds_read_b64_tr_b16 a[192:193], v10 offset:40960
    v_mul_f32 v30, v17, v30
    v_mfma_f32_16x16x32_bf16 v[40:43], a[204:207], v[132:135], v[40:43]
    s_lshl_b32 s56, s56, 5
    ds_read_b64_tr_b16 a[194:195], v10 offset:43008
    v_mul_f32 v31, v17, v31
    v_mfma_f32_16x16x32_bf16 v[44:47], a[204:207], v[140:143], v[44:47]
    s_add_u32 s41, s41, s56
    ds_read_b64_tr_b16 a[196:197], v10 offset:45056
    v_cvt_pk_bf16_f32 v28, v28, v29
    v_mfma_f32_16x16x32_bf16 v[44:47], a[200:203], v[136:139], v[44:47]
    s_waitcnt lgkmcnt(3)
    ds_read_b64_tr_b16 a[198:199], v10 offset:47104
    v_cvt_pk_bf16_f32 v29, v30, v31
    v_mfma_f32_16x16x32_bf16 v[48:51], a[200:203], v[144:147], v[48:51]
    buffer_load_dwordx4 v3, s[8:11], s38 offen lds
    v_mfma_f32_16x16x32_bf16 v[48:51], a[204:207], v[148:151], v[48:51]
    s_and_b32 s56, s3, 1
    v_accvgpr_write_b32 a70, v28
    v_accvgpr_write_b32 a71, v29
    v_mfma_f32_16x16x32_bf16 v[52:55], a[204:207], v[156:159], v[52:55]
    buffer_store_dwordx4 a[68:71], v14, s[20:23], s55 offen offset:1024 sc1
    v_mul_f32 v33, v18, v33
    v_mfma_f32_16x16x32_bf16 v[52:55], a[200:203], v[152:155], v[52:55]
    s_lshl_b32 s56, s56, 2
    ds_read_b64_tr_b16 a[200:201], v10 offset:49152
    v_mul_f32 v34, v18, v34
    v_mfma_f32_16x16x32_bf16 v[52:55], a[208:211], v[184:187], v[52:55]
    s_add_u32 s41, s41, s56
    ds_read_b64_tr_b16 a[202:203], v10 offset:51200
    v_mul_f32 v35, v18, v35
    v_mfma_f32_16x16x32_bf16 v[52:55], a[212:215], v[188:191], v[52:55]
    s_add_u32 s56, s3, 0
    ds_read_b64_tr_b16 a[204:205], v10 offset:53248
    v_cvt_pk_bf16_f32 v32, v32, v33
    v_mfma_f32_16x16x32_bf16 v[48:51], a[212:215], v[180:183], v[48:51]
    s_min_u32 s56, s56, 9
    ds_read_b64_tr_b16 a[206:207], v10 offset:55296
    v_cvt_pk_bf16_f32 v33, v34, v35
    v_mfma_f32_16x16x32_bf16 v[48:51], a[208:211], v[176:179], v[48:51]
    s_mul_i32 s38, s56, 24576
    v_accvgpr_write_b32 a74, v32
    v_accvgpr_write_b32 a75, v33
    v_mfma_f32_16x16x32_bf16 v[44:47], a[208:211], v[168:171], v[44:47]
    buffer_store_dwordx4 a[72:75], v14, s[20:23], s55 offen offset:2048 sc1
    v_mul_f32 v37, v19, v37
    v_mfma_f32_16x16x32_bf16 v[44:47], a[212:215], v[172:175], v[44:47]
    s_lshl_b32 s56, s56, 10
    v_mul_f32 v38, v19, v38
    v_mul_f32 v39, v19, v39
    v_mfma_f32_16x16x32_bf16 v[40:43], a[212:215], v[164:167], v[40:43]
    s_add_u32 m0, s56, 61440
    v_cvt_pk_bf16_f32 v36, v36, v37
    v_cvt_pk_bf16_f32 v37, v38, v39
    v_mfma_f32_16x16x32_bf16 v[40:43], a[208:211], v[160:163], v[40:43]
    s_mul_i32 s41, s41, 1280
    ds_read_b64_tr_b16 a[208:209], v10 offset:57344
    v_accvgpr_write_b32 a78, v36
    v_mfma_f32_16x16x32_bf16 v[40:43], a[184:187], v[192:195], v[40:43]
    s_lshl_b32 s57, s57, 7
    ds_read_b64_tr_b16 a[210:211], v10 offset:59392
    v_accvgpr_write_b32 a79, v37
    v_mfma_f32_16x16x32_bf16 v[40:43], a[188:191], v[196:199], v[40:43]
    buffer_store_dwordx4 a[76:79], v14, s[20:23], s55 offen offset:3072 sc1
    v_mfma_f32_16x16x32_bf16 v[44:47], a[188:191], v[204:207], v[44:47]
    s_add_u32 s56, s3, 4
    ds_read_b64_tr_b16 a[212:213], v10 offset:61440
    s_min_u32 s56, s56, 9
    v_mfma_f32_16x16x32_bf16 v[44:47], a[184:187], v[200:203], v[44:47]
    s_waitcnt lgkmcnt(3)
    ds_read_b64_tr_b16 a[214:215], v10 offset:63488
    s_add_u32 s55, s55, 4096
    v_mfma_f32_16x16x32_bf16 v[48:51], a[184:187], v[208:211], v[48:51]
    s_add_u32 s41, s41, s57
    v_add_u32 v10, 65536, v10
    s_lshl_b32 s57, s48, 10
    v_mfma_f32_16x16x32_bf16 v[48:51], a[188:191], v[212:215], v[48:51]
    s_add_u32 s38, s38, s57
    s_add_u32 s38, s38, 3276800
    s_lshl_b32 s57, s48, 10
    v_mfma_f32_16x16x32_bf16 v[52:55], a[188:191], v[220:223], v[52:55]
    buffer_load_dwordx4 v14, s[24:27], s38 offen sc1 lds
    v_mfma_f32_16x16x32_bf16 v[52:55], a[184:187], v[216:219], v[52:55]
    s_mul_i32 s38, s56, 24576
    ds_read_b64_tr_b16 a[184:185], v11 offset:0
    s_add_u32 s38, s38, s57
    v_mfma_f32_16x16x32_bf16 v[52:55], a[192:195], v[248:251], v[52:55]
    s_add_u32 s38, s38, 3276800
    ds_read_b64_tr_b16 a[186:187], v11 offset:2048
    s_lshl_b32 s56, s56, 10
    v_mfma_f32_16x16x32_bf16 v[52:55], a[196:199], v[252:255], v[52:55]
    s_add_u32 m0, s56, 61440
    ds_read_b64_tr_b16 a[188:189], v11 offset:4096
    s_lshl_b32 s43, s3, 11
    v_mfma_f32_16x16x32_bf16 v[48:51], a[196:199], v[244:247], v[48:51]
    buffer_load_dwordx4 v14, s[24:27], s38 offen sc1 lds
    v_mfma_f32_16x16x32_bf16 v[48:51], a[192:195], v[240:243], v[48:51]
    s_add_u32 s56, s3, 8
    ds_read_b64_tr_b16 a[190:191], v11 offset:6144
    s_min_u32 s56, s56, 9
    v_mfma_f32_16x16x32_bf16 v[44:47], a[192:195], v[232:235], v[44:47]
    s_mul_i32 s38, s56, 24576
    s_lshl_b32 s57, s48, 10
    s_add_u32 s38, s38, s57
    v_mfma_f32_16x16x32_bf16 v[44:47], a[196:199], v[236:239], v[44:47]
    s_add_u32 s38, s38, 3276800
    s_lshl_b32 s56, s56, 10
    s_add_u32 m0, s56, 61440
    v_mfma_f32_16x16x32_bf16 v[40:43], a[196:199], v[228:231], v[40:43]
    s_add_u32 s56, s7, 6
    v_lshrrev_b32 v12, 2, v1
    v_mfma_f32_16x16x32_bf16 v[40:43], a[192:195], v[224:227], v[40:43]
    ds_read_b64_tr_b16 a[192:193], v11 offset:8192
    v_mfma_f32_16x16x32_bf16 v[40:43], a[200:203], v[56:59], v[40:43]
    s_add_u32 s77, s7, 3
    ds_read_b64_tr_b16 a[194:195], v11 offset:10240
    v_mfma_f32_16x16x32_bf16 v[40:43], a[204:207], v[60:63], v[40:43]
    ds_read_b64_tr_b16 a[196:197], v11 offset:12288
    v_mfma_f32_16x16x32_bf16 v[44:47], a[204:207], v[68:71], v[44:47]
    s_waitcnt lgkmcnt(3)
    ds_read_b64_tr_b16 a[198:199], v11 offset:14336
    v_mfma_f32_16x16x32_bf16 v[44:47], a[200:203], v[64:67], v[44:47]
    buffer_load_dwordx4 v14, s[24:27], s38 offen sc1 lds
    v_mfma_f32_16x16x32_bf16 v[48:51], a[200:203], v[72:75], v[48:51]
    s_load_dwordx4 s[72:75], s[86:87], s5 glc
    v_lshlrev_b32 v12, 6, v12
    v_mfma_f32_16x16x32_bf16 v[48:51], a[204:207], v[76:79], v[48:51]
    v_and_b32 v21, 3, v1
    v_mfma_f32_16x16x32_bf16 v[52:55], a[204:207], v[84:87], v[52:55]
    v_lshl_add_u32 v12, v21, 3, v12
    v_mfma_f32_16x16x32_bf16 v[52:55], a[200:203], v[80:83], v[52:55]
    ds_read_b64_tr_b16 a[200:201], v11 offset:16384
    v_mfma_f32_16x16x32_bf16 v[52:55], a[208:211], v[112:115], v[52:55]
    ds_read_b64_tr_b16 a[202:203], v11 offset:18432
    v_mfma_f32_16x16x32_bf16 v[52:55], a[212:215], v[116:119], v[52:55]
    ds_read_b64_tr_b16 a[204:205], v11 offset:20480
    v_mfma_f32_16x16x32_bf16 v[48:51], a[212:215], v[108:111], v[48:51]
    ds_read_b64_tr_b16 a[206:207], v11 offset:22528
    v_mfma_f32_16x16x32_bf16 v[48:51], a[208:211], v[104:107], v[48:51]
    v_and_b32 v21, 16, v1
    v_mfma_f32_16x16x32_bf16 v[44:47], a[208:211], v[96:99], v[44:47]
    v_lshl_add_u32 v12, v21, 1, v12
    v_mfma_f32_16x16x32_bf16 v[44:47], a[212:215], v[100:103], v[44:47]
    v_mul_f32 v52, v19, v52
    v_mfma_f32_16x16x32_bf16 v[40:43], a[212:215], v[92:95], v[40:43]
    s_add_u32 s37, s60, 4096
    v_mul_f32 v53, v19, v53
    v_mul_f32 v48, v18, v48
    v_mfma_f32_16x16x32_bf16 v[40:43], a[208:211], v[88:91], v[40:43]
    ds_read_b64_tr_b16 a[208:209], v11 offset:24576
    v_mul_f32 v49, v18, v49
    v_mfma_f32_16x16x32_bf16 v[24:27], a[184:187], a[96:99], 0
    ds_read_b64_tr_b16 a[210:211], v11 offset:26624
    v_mul_f32 v44, v17, v44
    v_mfma_f32_16x16x32_bf16 v[24:27], a[188:191], a[100:103], v[24:27]
    ds_read_b64_tr_b16 a[212:213], v11 offset:28672
    v_mul_f32 v45, v17, v45
    v_mfma_f32_16x16x32_bf16 v[28:31], a[188:191], a[108:111], 0
    s_waitcnt lgkmcnt(3)
    ds_read_b64_tr_b16 a[214:215], v11 offset:30720
    v_mul_f32 v40, v16, v40
    v_mfma_f32_16x16x32_bf16 v[28:31], a[184:187], a[104:107], v[28:31]
    v_mul_f32 v41, v16, v41
    v_mul_f32 v42, v16, v42
    v_mfma_f32_16x16x32_bf16 v[32:35], a[184:187], a[112:115], 0
    buffer_load_dwordx4 a[96:99], v14, s[20:23], s37 offen offset:0 sc1
    v_mfma_f32_16x16x32_bf16 v[32:35], a[188:191], a[116:119], v[32:35]
    v_mul_f32 v43, v16, v43
    v_cvt_pk_bf16_f32 v40, v40, v41
    v_mfma_f32_16x16x32_bf16 v[36:39], a[188:191], a[124:127], 0
    v_cvt_pk_bf16_f32 v41, v42, v43
    v_accvgpr_write_b32 a80, v40
    v_mfma_f32_16x16x32_bf16 v[36:39], a[184:187], a[120:123], v[36:39]
    ds_read_b64_tr_b16 a[184:185], v11 offset:32768
    v_accvgpr_write_b32 a81, v41
    v_mfma_f32_16x16x32_bf16 v[36:39], a[192:195], v[120:123], v[36:39]
    ds_read_b64_tr_b16 a[186:187], v11 offset:34816
    v_mul_f32 v46, v17, v46
    v_mfma_f32_16x16x32_bf16 v[36:39], a[196:199], v[124:127], v[36:39]
    buffer_load_dwordx4 a[100:103], v14, s[20:23], s37 offen offset:1024 sc1
    v_mfma_f32_16x16x32_bf16 v[32:35], a[196:199], a[148:151], v[32:35]
    ds_read_b64_tr_b16 a[188:189], v11 offset:36864
    v_mul_f32 v47, v17, v47
    v_mfma_f32_16x16x32_bf16 v[32:35], a[192:195], a[144:147], v[32:35]
    ds_read_b64_tr_b16 a[190:191], v11 offset:38912
    v_cvt_pk_bf16_f32 v44, v44, v45
    v_mfma_f32_16x16x32_bf16 v[28:31], a[192:195], a[136:139], v[28:31]
    v_cvt_pk_bf16_f32 v45, v46, v47
    v_accvgpr_write_b32 a84, v44
    v_mfma_f32_16x16x32_bf16 v[28:31], a[196:199], a[140:143], v[28:31]
    v_accvgpr_write_b32 a85, v45
    v_mul_f32 v50, v18, v50
    v_mfma_f32_16x16x32_bf16 v[24:27], a[196:199], a[132:135], v[24:27]
    buffer_load_dwordx4 a[104:107], v14, s[20:23], s37 offen offset:2048 sc1
    v_mfma_f32_16x16x32_bf16 v[24:27], a[192:195], a[128:131], v[24:27]
    ds_read_b64_tr_b16 a[192:193], v11 offset:40960
    v_mul_f32 v51, v18, v51
    v_mfma_f32_16x16x32_bf16 v[24:27], a[200:203], v[128:131], v[24:27]
    ds_read_b64_tr_b16 a[194:195], v11 offset:43008
    v_cvt_pk_bf16_f32 v48, v48, v49
    v_mfma_f32_16x16x32_bf16 v[24:27], a[204:207], v[132:135], v[24:27]
    ds_read_b64_tr_b16 a[196:197], v11 offset:45056
    v_cvt_pk_bf16_f32 v49, v50, v51
    v_mfma_f32_16x16x32_bf16 v[28:31], a[204:207], v[140:143], v[28:31]
    s_waitcnt lgkmcnt(3)
    ds_read_b64_tr_b16 a[198:199], v11 offset:47104
    v_accvgpr_write_b32 a88, v48
    v_mfma_f32_16x16x32_bf16 v[28:31], a[200:203], v[136:139], v[28:31]
    buffer_load_dwordx4 a[108:111], v14, s[20:23], s37 offen offset:3072 sc1
    v_mfma_f32_16x16x32_bf16 v[32:35], a[200:203], v[144:147], v[32:35]
    s_add_u32 s37, s61, 4096
    v_accvgpr_write_b32 a89, v49
    v_mul_f32 v54, v19, v54
    v_mfma_f32_16x16x32_bf16 v[32:35], a[204:207], v[148:151], v[32:35]
    v_mul_f32 v55, v19, v55
    v_cvt_pk_bf16_f32 v52, v52, v53
    v_mfma_f32_16x16x32_bf16 v[36:39], a[204:207], v[156:159], v[36:39]
    v_cvt_pk_bf16_f32 v53, v54, v55
    v_accvgpr_write_b32 a92, v52
    v_mfma_f32_16x16x32_bf16 v[36:39], a[200:203], v[152:155], v[36:39]
    ds_read_b64_tr_b16 a[200:201], v11 offset:49152
    v_accvgpr_write_b32 a93, v53
    v_mfma_f32_16x16x32_bf16 v[36:39], a[208:211], v[184:187], v[36:39]
    buffer_load_dwordx4 a[112:115], v14, s[20:23], s37 offen offset:0 sc1
    v_mfma_f32_16x16x32_bf16 v[36:39], a[212:215], v[188:191], v[36:39]
    ds_read_b64_tr_b16 a[202:203], v11 offset:51200
    v_mfma_f32_16x16x32_bf16 v[32:35], a[212:215], v[180:183], v[32:35]
    ds_read_b64_tr_b16 a[204:205], v11 offset:53248
    v_mfma_f32_16x16x32_bf16 v[32:35], a[208:211], v[176:179], v[32:35]
    ds_read_b64_tr_b16 a[206:207], v11 offset:55296
    v_mfma_f32_16x16x32_bf16 v[28:31], a[208:211], v[168:171], v[28:31]
    v_add_u32 v12, 98304, v12
    v_mfma_f32_16x16x32_bf16 v[28:31], a[212:215], v[172:175], v[28:31]
    buffer_load_dwordx4 a[116:119], v14, s[20:23], s37 offen offset:1024 sc1
    v_mfma_f32_16x16x32_bf16 v[24:27], a[212:215], v[164:167], v[24:27]
    v_lshrrev_b32 v13, 2, v1
    v_mfma_f32_16x16x32_bf16 v[24:27], a[208:211], v[160:163], v[24:27]
    ds_read_b64_tr_b16 a[208:209], v11 offset:57344
    v_mfma_f32_16x16x32_bf16 v[24:27], a[184:187], v[192:195], v[24:27]
    ds_read_b64_tr_b16 a[210:211], v11 offset:59392
    v_mfma_f32_16x16x32_bf16 v[24:27], a[188:191], v[196:199], v[24:27]
    ds_read_b64_tr_b16 a[212:213], v11 offset:61440
    v_mfma_f32_16x16x32_bf16 v[28:31], a[188:191], v[204:207], v[28:31]
    s_waitcnt lgkmcnt(3)
    ds_read_b64_tr_b16 a[214:215], v11 offset:63488
    s_sub_u32 s78, s72, s77
    v_mfma_f32_16x16x32_bf16 v[28:31], a[184:187], v[200:203], v[28:31]
    buffer_load_dwordx4 a[120:123], v14, s[20:23], s37 offen offset:2048 sc1
    v_mfma_f32_16x16x32_bf16 v[32:35], a[184:187], v[208:211], v[32:35]
    s_sub_u32 s79, s73, s77
    v_lshlrev_b32 v13, 6, v13
    s_max_u32 s78, s78, s79
    v_mfma_f32_16x16x32_bf16 v[32:35], a[188:191], v[212:215], v[32:35]
    s_sub_u32 s79, s74, s77
    v_and_b32 v21, 3, v1
    s_max_u32 s78, s78, s79
    v_mfma_f32_16x16x32_bf16 v[36:39], a[188:191], v[220:223], v[36:39]
    s_sub_u32 s79, s75, s77
    v_lshl_add_u32 v13, v21, 3, v13
    s_max_u32 s78, s78, s79
    v_mfma_f32_16x16x32_bf16 v[36:39], a[184:187], v[216:219], v[36:39]
    buffer_load_dwordx4 a[124:127], v14, s[20:23], s37 offen offset:3072 sc1
    v_mfma_f32_16x16x32_bf16 v[36:39], a[192:195], v[248:251], v[36:39]
    s_cmp_gt_u32 s78, 3
    s_cbranch_scc1 spin_o2
spin_o2_ret:
    s_add_u32 s37, s59, 8192
    v_mfma_f32_16x16x32_bf16 v[36:39], a[196:199], v[252:255], v[36:39]
    s_waitcnt lgkmcnt(0)
    v_and_b32 v21, 16, v1
    v_lshl_add_u32 v13, v21, 1, v13
    v_mfma_f32_16x16x32_bf16 v[32:35], a[196:199], v[244:247], v[32:35]
    s_barrier
    v_mfma_f32_16x16x32_bf16 v[32:35], a[192:195], v[240:243], v[32:35]
    s_add_u32 m0, s43, 114688
    ds_read_b64_tr_b16 a[184:185], v12 offset:57344
    v_xor_b32 v13, 32, v13
    v_mfma_f32_16x16x32_bf16 v[28:31], a[192:195], v[232:235], v[28:31]
    buffer_load_dwordx4 a[128:131], v14, s[20:23], s37 offen offset:0 sc1
    v_mfma_f32_16x16x32_bf16 v[28:31], a[196:199], v[236:239], v[28:31]
    buffer_load_dwordx4 v22, s[28:31], s41 offen lds
    v_mfma_f32_16x16x32_bf16 v[24:27], a[196:199], v[228:231], v[24:27]
    ds_read_b64_tr_b16 a[186:187], v12 offset:58368
    v_add_u32 v13, 98304, v13
    v_mfma_f32_16x16x32_bf16 v[24:27], a[192:195], v[224:227], v[24:27]
    s_add_u32 m0, s43, 115712
    ds_read_b64_tr_b16 a[188:189], v13 offset:57344
    v_mfma_f32_16x16x32_bf16 v[24:27], a[200:203], v[56:59], v[24:27]
    s_add_u32 s43, s7, 1
    ds_read_b64_tr_b16 a[190:191], v13 offset:58368
    v_mfma_f32_16x16x32_bf16 v[24:27], a[204:207], v[60:63], v[24:27]
    buffer_load_dwordx4 a[132:135], v14, s[20:23], s37 offen offset:1024 sc1
    v_mfma_f32_16x16x32_bf16 v[28:31], a[204:207], v[68:71], v[28:31]
    s_waitcnt vmcnt(14)
    ds_read_b64_tr_b16 a[192:193], v8 offset:0
    v_mfma_f32_16x16x32_bf16 v[28:31], a[200:203], v[64:67], v[28:31]
    buffer_store_dword v4, v15, s[24:27], s76 offen sc1
    v_mfma_f32_16x16x32_bf16 v[32:35], a[200:203], v[72:75], v[32:35]
    ds_read_b64_tr_b16 a[194:195], v8 offset:2048
    v_mfma_f32_16x16x32_bf16 v[32:35], a[204:207], v[76:79], v[32:35]
    buffer_load_dwordx4 v23, s[28:31], s41 offen lds
    v_mfma_f32_16x16x32_bf16 v[36:39], a[204:207], v[84:87], v[36:39]
    buffer_load_dwordx4 a[136:139], v14, s[20:23], s37 offen offset:2048 sc1
    v_mfma_f32_16x16x32_bf16 v[36:39], a[200:203], v[80:83], v[36:39]
    s_add_u32 s38, s45, 40960
    ds_read_b64_tr_b16 a[196:197], v9 offset:0
    v_add_u32 v11, 65536, v11
    v_mfma_f32_16x16x32_bf16 v[36:39], a[208:211], v[112:115], v[36:39]
    s_add_u32 s36, s44, 204800
    ds_read_b64_tr_b16 a[198:199], v9 offset:2048
    s_add_u32 m0, s63, 90112
    v_mfma_f32_16x16x32_bf16 v[36:39], a[212:215], v[116:119], v[36:39]
    s_cmp_lt_u32 s3, 2
    s_cselect_b32 s38, s38, s36
    v_mfma_f32_16x16x32_bf16 v[32:35], a[212:215], v[108:111], v[32:35]
    s_add_u32 s28, s7, 1
    ds_read_b64_tr_b16 a[204:205], v11 offset:0
    v_mfma_f32_16x16x32_bf16 v[32:35], a[208:211], v[104:107], v[32:35]
    buffer_load_dwordx4 a[140:143], v14, s[20:23], s37 offen offset:3072 sc1
    v_mfma_f32_16x16x32_bf16 v[28:31], a[208:211], v[96:99], v[28:31]
    s_add_u32 s29, s7, 1
    ds_read_b64_tr_b16 a[206:207], v11 offset:2048
    v_mfma_f32_16x16x32_bf16 v[28:31], a[212:215], v[100:103], v[28:31]
    s_waitcnt lgkmcnt(4)
    ds_read_b64_tr_b16 a[200:201], v10 offset:0
    v_mfma_f32_16x16x32_bf16 v[24:27], a[212:215], v[92:95], v[24:27]
    buffer_load_dwordx4 v7, s[8:11], s38 offen lds
    v_mfma_f32_16x16x32_bf16 v[24:27], a[208:211], v[88:91], v[24:27]
    s_add_u32 s38, s45, 40960
    ds_read_b64_tr_b16 a[202:203], v10 offset:2048
    v_mov_b32 v4, s56
    v_mfma_f32_16x16x32_bf16 v[96:99], a[184:187], a[0:3], 0
    s_lshl_b32 s56, s3, 8
    ds_read_b64_tr_b16 a[208:209], v8 offset:4096
    v_mul_f32 v28, v17, v28
    v_mfma_f32_16x16x32_bf16 v[100:103], a[188:191], a[0:3], 0
    s_add_u32 m0, s63, 73728
    ds_read_b64_tr_b16 a[210:211], v8 offset:6144
    v_mul_f32 v24, v16, v24
    v_mfma_f32_16x16x32_bf16 v[108:111], a[188:191], a[4:7], 0
    s_add_u32 s56, s56, 71680
    ds_read_b64_tr_b16 a[212:213], v9 offset:4096
    v_mul_f32 v25, v16, v25
    v_mfma_f32_16x16x32_bf16 v[104:107], a[184:187], a[4:7], 0
    s_add_u32 s30, s7, 1
    ds_read_b64_tr_b16 a[214:215], v9 offset:6144
    v_mul_f32 v26, v16, v26
    v_mfma_f32_16x16x32_bf16 v[112:115], a[184:187], a[8:11], 0
    s_add_u32 s31, s7, 1
    v_mul_f32 v27, v16, v27
    v_cvt_pk_bf16_f32 v24, v24, v25
    v_mfma_f32_16x16x32_bf16 v[116:119], a[188:191], a[8:11], 0
    s_add_u32 s41, s7, 1
    v_cvt_pk_bf16_f32 v25, v26, v27
    v_accvgpr_write_b32 a82, v24
    v_mfma_f32_16x16x32_bf16 v[124:127], a[188:191], a[12:15], 0
    s_waitcnt lgkmcnt(4)
    ds_read_b64_tr_b16 a[188:189], v11 offset:4096
    v_accvgpr_write_b32 a83, v25
    v_mfma_f32_16x16x32_bf16 v[120:123], a[184:187], a[12:15], 0
    buffer_store_dwordx4 a[80:83], v14, s[20:23], s55 offen offset:0 sc1
    v_mul_f32 v29, v17, v29
    v_mfma_f32_16x16x32_bf16 v[152:155], a[192:195], a[12:15], 0
    buffer_load_dwordx4 v2, s[8:11], s38 offen lds
    v_mfma_f32_16x16x32_bf16 v[156:159], a[196:199], a[12:15], 0
    s_add_u32 s38, s45, 40960
    ds_read_b64_tr_b16 a[190:191], v11 offset:6144
    v_mul_f32 v30, v17, v30
    v_mfma_f32_16x16x32_bf16 v[148:151], a[196:199], a[8:11], 0
    s_add_u32 m0, s63, 77824
    ds_read_b64_tr_b16 a[184:185], v10 offset:4096
    v_mul_f32 v31, v17, v31
    v_mfma_f32_16x16x32_bf16 v[144:147], a[192:195], a[8:11], 0
    ds_read_b64_tr_b16 a[186:187], v10 offset:6144
    v_cvt_pk_bf16_f32 v28, v28, v29
    v_mfma_f32_16x16x32_bf16 v[136:139], a[192:195], a[4:7], 0
    v_cvt_pk_bf16_f32 v29, v30, v31
    v_accvgpr_write_b32 a86, v28
    v_mfma_f32_16x16x32_bf16 v[140:143], a[196:199], a[4:7], 0
    v_accvgpr_write_b32 a87, v29
    v_mul_f32 v32, v18, v32
    v_mfma_f32_16x16x32_bf16 v[132:135], a[196:199], a[0:3], 0
    buffer_store_dwordx4 a[84:87], v14, s[20:23], s55 offen offset:1024 sc1
    v_mul_f32 v33, v18, v33
    v_mfma_f32_16x16x32_bf16 v[128:131], a[192:195], a[0:3], 0
    ds_read_b64_tr_b16 a[196:197], v13 offset:59392
    v_mul_f32 v34, v18, v34
    v_mfma_f32_16x16x32_bf16 v[160:163], a[200:203], a[0:3], 0
    buffer_load_dwordx4 v3, s[8:11], s38 offen lds
    v_mfma_f32_16x16x32_bf16 v[164:167], a[204:207], a[0:3], 0
    s_add_u32 s38, s44, 204800
    ds_read_b64_tr_b16 a[198:199], v13 offset:60416
    v_mul_f32 v35, v18, v35
    v_mfma_f32_16x16x32_bf16 v[172:175], a[204:207], a[4:7], 0
    ds_read_b64_tr_b16 a[192:193], v12 offset:59392
    v_cvt_pk_bf16_f32 v32, v32, v33
    v_mfma_f32_16x16x32_bf16 v[168:171], a[200:203], a[4:7], 0
    s_waitcnt lgkmcnt(3)
    ds_read_b64_tr_b16 a[194:195], v12 offset:60416
    v_cvt_pk_bf16_f32 v33, v34, v35
    v_mfma_f32_16x16x32_bf16 v[176:179], a[200:203], a[8:11], 0
    s_add_u32 m0, s63, 81920
    v_accvgpr_write_b32 a90, v32
    v_accvgpr_write_b32 a91, v33
    v_mfma_f32_16x16x32_bf16 v[180:183], a[204:207], a[8:11], 0
    buffer_store_dwordx4 a[88:91], v14, s[20:23], s55 offen offset:2048 sc1
    v_mul_f32 v36, v19, v36
    v_mfma_f32_16x16x32_bf16 v[188:191], a[204:207], a[12:15], 0
    v_mul_f32 v37, v19, v37
    v_mul_f32 v38, v19, v38
    v_mfma_f32_16x16x32_bf16 v[184:187], a[200:203], a[12:15], 0
    ds_read_b64_tr_b16 a[200:201], v8 offset:8192
    v_mul_f32 v39, v19, v39
    v_mfma_f32_16x16x32_bf16 v[216:219], a[208:211], a[12:15], 0
    ds_read_b64_tr_b16 a[202:203], v8 offset:10240
    v_cvt_pk_bf16_f32 v36, v36, v37
    v_mfma_f32_16x16x32_bf16 v[220:223], a[212:215], a[12:15], 0
    buffer_load_dwordx4 v2, s[8:11], s38 offen lds
    v_mfma_f32_16x16x32_bf16 v[212:215], a[212:215], a[8:11], 0
    s_add_u32 s38, s44, 204800
    ds_read_b64_tr_b16 a[204:205], v9 offset:8192
    v_cvt_pk_bf16_f32 v37, v38, v39
    v_mfma_f32_16x16x32_bf16 v[208:211], a[208:211], a[8:11], 0
    ds_read_b64_tr_b16 a[206:207], v9 offset:10240
    v_accvgpr_write_b32 a94, v36
    v_mfma_f32_16x16x32_bf16 v[200:203], a[208:211], a[4:7], 0
    s_add_u32 m0, s63, 86016
    v_accvgpr_write_b32 a95, v37
    v_mfma_f32_16x16x32_bf16 v[204:207], a[212:215], a[4:7], 0
    buffer_store_dwordx4 a[92:95], v14, s[20:23], s55 offen offset:3072 sc1
    v_subrev_u32 v12, 81920, v12
    v_mfma_f32_16x16x32_bf16 v[196:199], a[212:215], a[0:3], 0
    s_add_u32 s55, s55, 4096
    ds_read_b64_tr_b16 a[212:213], v11 offset:8192
    v_mfma_f32_16x16x32_bf16 v[192:195], a[208:211], a[0:3], 0
    ds_read_b64_tr_b16 a[214:215], v11 offset:10240
    v_mfma_f32_16x16x32_bf16 v[224:227], a[184:187], a[0:3], 0
    ds_read_b64_tr_b16 a[208:209], v10 offset:8192
    v_mfma_f32_16x16x32_bf16 v[228:231], a[188:191], a[0:3], 0
    s_waitcnt lgkmcnt(4)
    ds_read_b64_tr_b16 a[210:211], v10 offset:10240
    v_mfma_f32_16x16x32_bf16 v[236:239], a[188:191], a[4:7], 0
    buffer_load_dwordx4 v3, s[8:11], s38 offen lds
    v_mfma_f32_16x16x32_bf16 v[232:235], a[184:187], a[4:7], 0
    s_add_u32 s37, s60, 8192
    v_subrev_u32 v13, 81920, v13
    s_add_u32 s38, s46, 40960
    v_mfma_f32_16x16x32_bf16 v[240:243], a[184:187], a[8:11], 0
    s_add_u32 s36, s47, 40960
    v_mfma_f32_16x16x32_bf16 v[244:247], a[188:191], a[8:11], 0
    s_cmp_lt_u32 s3, 2
    s_cselect_b32 s38, s38, s36
    s_add_u32 m0, s63, 110592
    v_mfma_f32_16x16x32_bf16 v[252:255], a[188:191], a[12:15], 0
    v_mfma_f32_16x16x32_bf16 v[248:251], a[184:187], a[12:15], 0
    ds_read_b64_tr_b16 a[184:185], v8 offset:12288
    v_mfma_f32_16x16x32_bf16 v[120:123], a[192:195], a[28:31], v[120:123]
    buffer_load_dwordx4 a[0:3], v14, s[20:23], s37 offen offset:0 sc1
    v_mfma_f32_16x16x32_bf16 v[124:127], a[196:199], a[28:31], v[124:127]
    ds_read_b64_tr_b16 a[186:187], v8 offset:14336
    v_mfma_f32_16x16x32_bf16 v[116:119], a[196:199], a[24:27], v[116:119]
    ds_read_b64_tr_b16 a[188:189], v9 offset:12288
    v_mfma_f32_16x16x32_bf16 v[112:115], a[192:195], a[24:27], v[112:115]
    buffer_load_dwordx4 v7, s[8:11], s38 offen lds
    v_mfma_f32_16x16x32_bf16 v[104:107], a[192:195], a[20:23], v[104:107]
    s_add_u32 s38, s46, 40960
    ds_read_b64_tr_b16 a[190:191], v9 offset:14336
    v_mfma_f32_16x16x32_bf16 v[108:111], a[196:199], a[20:23], v[108:111]
    buffer_load_dwordx4 a[4:7], v14, s[20:23], s37 offen offset:1024 sc1
    v_mfma_f32_16x16x32_bf16 v[100:103], a[196:199], a[16:19], v[100:103]
    s_waitcnt lgkmcnt(3)
    ds_read_b64_tr_b16 a[196:197], v11 offset:12288
    s_add_u32 m0, s63, 94208
    v_mfma_f32_16x16x32_bf16 v[96:99], a[192:195], a[16:19], v[96:99]
    ds_read_b64_tr_b16 a[198:199], v11 offset:14336
    v_mfma_f32_16x16x32_bf16 v[128:131], a[200:203], a[16:19], v[128:131]
    ds_read_b64_tr_b16 a[192:193], v10 offset:12288
    v_mfma_f32_16x16x32_bf16 v[132:135], a[204:207], a[16:19], v[132:135]
    ds_read_b64_tr_b16 a[194:195], v10 offset:14336
    v_mfma_f32_16x16x32_bf16 v[140:143], a[204:207], a[20:23], v[140:143]
    buffer_load_dwordx4 a[8:11], v14, s[20:23], s37 offen offset:2048 sc1
    v_mfma_f32_16x16x32_bf16 v[136:139], a[200:203], a[20:23], v[136:139]
    v_subrev_u32 v8, 139264, v8
    v_mfma_f32_16x16x32_bf16 v[144:147], a[200:203], a[24:27], v[144:147]
    buffer_load_dwordx4 v2, s[8:11], s38 offen lds
    v_mfma_f32_16x16x32_bf16 v[148:151], a[204:207], a[24:27], v[148:151]
    s_add_u32 s38, s46, 40960
    v_subrev_u32 v9, 139264, v9
    v_mfma_f32_16x16x32_bf16 v[156:159], a[204:207], a[28:31], v[156:159]
    v_add_u32 v21, 61440, v14
    v_mfma_f32_16x16x32_bf16 v[152:155], a[200:203], a[28:31], v[152:155]
    buffer_load_dwordx4 a[12:15], v14, s[20:23], s37 offen offset:3072 sc1
    v_mfma_f32_16x16x32_bf16 v[184:187], a[208:211], a[28:31], v[184:187]
    s_add_u32 m0, s63, 98304
    v_subrev_u32 v11, 139264, v11
    v_mfma_f32_16x16x32_bf16 v[188:191], a[212:215], a[28:31], v[188:191]
    s_waitcnt vmcnt(30) lgkmcnt(0)
    v_subrev_u32 v10, 139264, v10
    v_mfma_f32_16x16x32_bf16 v[180:183], a[212:215], a[24:27], v[180:183]
    s_barrier
    v_mfma_f32_16x16x32_bf16 v[176:179], a[208:211], a[24:27], v[176:179]
    ds_read_b64_tr_b16 a[200:201], v12 offset:0
    v_mfma_f32_16x16x32_bf16 v[168:171], a[208:211], a[20:23], v[168:171]
    s_add_u32 s77, s7, 4
    ds_read_b64_tr_b16 a[202:203], v12 offset:1024
    v_mfma_f32_16x16x32_bf16 v[172:175], a[212:215], a[20:23], v[172:175]
    buffer_load_dwordx4 v3, s[8:11], s38 offen lds
    v_mfma_f32_16x16x32_bf16 v[164:167], a[212:215], a[16:19], v[164:167]
    s_add_u32 s38, s47, 40960
    ds_read_b64_tr_b16 a[204:205], v13 offset:0
    v_mfma_f32_16x16x32_bf16 v[160:163], a[208:211], a[16:19], v[160:163]
    ds_read_b64_tr_b16 a[206:207], v13 offset:1024
    v_mfma_f32_16x16x32_bf16 v[192:195], a[184:187], a[16:19], v[192:195]
    s_add_u32 m0, s63, 102400
    ds_read_b64_tr_b16 a[208:209], v8 offset:0
    s_load_dwordx4 s[72:75], s[86:87], s5 glc
    v_mfma_f32_16x16x32_bf16 v[196:199], a[188:191], a[16:19], v[196:199]
    ds_read_b64_tr_b16 a[210:211], v8 offset:2048
    v_mfma_f32_16x16x32_bf16 v[204:207], a[188:191], a[20:23], v[204:207]
    ds_read_b64_tr_b16 a[212:213], v9 offset:0
    v_mfma_f32_16x16x32_bf16 v[200:203], a[184:187], a[20:23], v[200:203]
    ds_read_b64_tr_b16 a[214:215], v9 offset:2048
    v_mfma_f32_16x16x32_bf16 v[208:211], a[184:187], a[24:27], v[208:211]
    ds_read_b128 v[56:59], v21 offset:0
    v_mfma_f32_16x16x32_bf16 v[212:215], a[188:191], a[24:27], v[212:215]
pg_12:
    s_cbranch_execz pg_16
    ds_read_b128 v[60:63], v21 offset:1024
    v_mfma_f32_16x16x32_bf16 v[220:223], a[188:191], a[28:31], v[220:223]
    buffer_load_dwordx4 v2, s[8:11], s38 offen lds
    v_mfma_f32_16x16x32_bf16 v[216:219], a[184:187], a[28:31], v[216:219]
    s_add_u32 s38, s47, 40960
    ds_read_b128 v[64:67], v21 offset:2048
    v_mfma_f32_16x16x32_bf16 v[248:251], a[192:195], a[28:31], v[248:251]
    s_waitcnt lgkmcnt(5)
    ds_read_b64_tr_b16 a[188:189], v11 offset:0
    v_mfma_f32_16x16x32_bf16 v[252:255], a[196:199], a[28:31], v[252:255]
    s_add_u32 m0, s63, 106496
    ds_read_b64_tr_b16 a[190:191], v11 offset:2048
    v_mfma_f32_16x16x32_bf16 v[244:247], a[196:199], a[24:27], v[244:247]
    s_add_u32 s37, s61, 8192
    ds_read_b64_tr_b16 a[184:185], v10 offset:0
    v_mfma_f32_16x16x32_bf16 v[240:243], a[192:195], a[24:27], v[240:243]
    ds_read_b64_tr_b16 a[186:187], v10 offset:2048
    v_mfma_f32_16x16x32_bf16 v[232:235], a[192:195], a[20:23], v[232:235]
    s_waitcnt lgkmcnt(5)
    ds_read_b128 v[68:71], v21 offset:3072
    v_add_f32 v56, v56, v60
    v_mfma_f32_16x16x32_bf16 v[236:239], a[196:199], a[20:23], v[236:239]
    ds_read_b128 v[72:75], v21 offset:4096
    v_add_f32 v57, v57, v61
    v_mfma_f32_16x16x32_bf16 v[228:231], a[196:199], a[16:19], v[228:231]
    s_waitcnt lgkmcnt(6)
    v_add_f32 v58, v58, v62
    v_add_f32 v59, v59, v63
    v_mfma_f32_16x16x32_bf16 v[224:227], a[192:195], a[16:19], v[224:227]
    buffer_load_dwordx4 v3, s[8:11], s38 offen lds
    v_mfma_f32_16x16x32_bf16 v[96:99], a[200:203], a[32:35], v[96:99]
    buffer_load_dwordx4 a[16:19], v14, s[20:23], s37 offen offset:0 sc1
    v_mfma_f32_16x16x32_bf16 v[100:103], a[204:207], a[32:35], v[100:103]
    ds_read_b128 v[76:79], v21 offset:5120
    v_add_f32 v56, v56, v64
    v_mfma_f32_16x16x32_bf16 v[108:111], a[204:207], a[36:39], v[108:111]
    ds_read_b64_tr_b16 a[192:193], v8 offset:4096
    v_add_f32 v57, v57, v65
    v_mfma_f32_16x16x32_bf16 v[104:107], a[200:203], a[36:39], v[104:107]
    s_waitcnt lgkmcnt(3)
    ds_read_b64_tr_b16 a[194:195], v8 offset:6144
    v_add_f32 v58, v58, v66
    v_mfma_f32_16x16x32_bf16 v[112:115], a[200:203], a[40:43], v[112:115]
    ds_read_b64_tr_b16 a[196:197], v9 offset:4096
    v_add_f32 v59, v59, v67
    v_mfma_f32_16x16x32_bf16 v[116:119], a[204:207], a[40:43], v[116:119]
    buffer_load_dwordx4 a[20:23], v14, s[20:23], s37 offen offset:1024 sc1
    v_mfma_f32_16x16x32_bf16 v[124:127], a[204:207], a[44:47], v[124:127]
    ds_read_b64_tr_b16 a[198:199], v9 offset:6144
    v_add_f32 v56, v56, v68
    v_mfma_f32_16x16x32_bf16 v[120:123], a[200:203], a[44:47], v[120:123]
    s_waitcnt lgkmcnt(5)
    ds_read_b128 v[80:83], v21 offset:6144
    v_add_f32 v57, v57, v69
    v_mfma_f32_16x16x32_bf16 v[152:155], a[208:211], a[44:47], v[152:155]
    ds_read_b128 v[84:87], v21 offset:7168
    v_add_f32 v58, v58, v70
    v_mfma_f32_16x16x32_bf16 v[156:159], a[212:215], a[44:47], v[156:159]
    ds_read_b64_tr_b16 a[204:205], v11 offset:4096
    v_add_f32 v59, v59, v71
    v_mfma_f32_16x16x32_bf16 v[148:151], a[212:215], a[40:43], v[148:151]
    buffer_load_dwordx4 a[24:27], v14, s[20:23], s37 offen offset:2048 sc1
    v_mfma_f32_16x16x32_bf16 v[144:147], a[208:211], a[40:43], v[144:147]
    ds_read_b64_tr_b16 a[206:207], v11 offset:6144
    v_add_f32 v56, v56, v72
    v_mfma_f32_16x16x32_bf16 v[136:139], a[208:211], a[36:39], v[136:139]
    s_waitcnt lgkmcnt(5)
    ds_read_b64_tr_b16 a[200:201], v10 offset:4096
    v_add_f32 v57, v57, v73
    v_mfma_f32_16x16x32_bf16 v[140:143], a[212:215], a[36:39], v[140:143]
    ds_read_b64_tr_b16 a[202:203], v10 offset:6144
    v_add_f32 v58, v58, v74
    v_mfma_f32_16x16x32_bf16 v[132:135], a[212:215], a[32:35], v[132:135]
    ds_read_b128 v[88:91], v21 offset:8192
    v_add_f32 v59, v59, v75
    v_mfma_f32_16x16x32_bf16 v[128:131], a[208:211], a[32:35], v[128:131]
    buffer_load_dwordx4 a[28:31], v14, s[20:23], s37 offen offset:3072 sc1
    v_mfma_f32_16x16x32_bf16 v[160:163], a[184:187], a[32:35], v[160:163]
    ds_read_b128 v[92:95], v21 offset:9216
    v_add_f32 v56, v56, v76
    v_mfma_f32_16x16x32_bf16 v[164:167], a[188:191], a[32:35], v[164:167]
    s_waitcnt lgkmcnt(5)
    ds_read_b64_tr_b16 a[212:213], v13 offset:2048
    v_add_f32 v57, v57, v77
    v_mfma_f32_16x16x32_bf16 v[172:175], a[188:191], a[36:39], v[172:175]
    ds_read_b64_tr_b16 a[214:215], v13 offset:3072
    v_add_f32 v58, v58, v78
    v_mfma_f32_16x16x32_bf16 v[168:171], a[184:187], a[36:39], v[168:171]
    ds_read_b64_tr_b16 a[208:209], v12 offset:2048
    v_add_f32 v59, v59, v79
    v_mfma_f32_16x16x32_bf16 v[176:179], a[184:187], a[40:43], v[176:179]
    ds_read_b64_tr_b16 a[210:211], v12 offset:3072
    v_add_f32 v56, v56, v80
    v_mfma_f32_16x16x32_bf16 v[180:183], a[188:191], a[40:43], v[180:183]
    v_add_f32 v57, v57, v81
    v_add_f32 v58, v58, v82
    v_mfma_f32_16x16x32_bf16 v[188:191], a[188:191], a[44:47], v[188:191]
    v_add_f32 v59, v59, v83
    v_add_f32 v56, v56, v84
    v_mfma_f32_16x16x32_bf16 v[184:187], a[184:187], a[44:47], v[184:187]
    s_waitcnt lgkmcnt(4)
    ds_read_b64_tr_b16 a[184:185], v8 offset:8192
    v_add_f32 v57, v57, v85
    v_mfma_f32_16x16x32_bf16 v[216:219], a[192:195], a[44:47], v[216:219]
    ds_read_b64_tr_b16 a[186:187], v8 offset:10240
    v_add_f32 v58, v58, v86
    v_mfma_f32_16x16x32_bf16 v[220:223], a[196:199], a[44:47], v[220:223]
    ds_read_b64_tr_b16 a[188:189], v9 offset:8192
    v_add_f32 v59, v59, v87
    v_mfma_f32_16x16x32_bf16 v[212:215], a[196:199], a[40:43], v[212:215]
    ds_read_b64_tr_b16 a[190:191], v9 offset:10240
    v_add_f32 v56, v56, v88
    v_mfma_f32_16x16x32_bf16 v[208:211], a[192:195], a[40:43], v[208:211]
    v_add_f32 v57, v57, v89
    v_add_f32 v58, v58, v90
    v_mfma_f32_16x16x32_bf16 v[200:203], a[192:195], a[36:39], v[200:203]
    v_add_f32 v59, v59, v91
    v_add_f32 v56, v56, v92
    v_mfma_f32_16x16x32_bf16 v[204:207], a[196:199], a[36:39], v[204:207]
    s_waitcnt vmcnt(14)
    v_add_f32 v57, v57, v93
    v_add_f32 v58, v58, v94
    v_mfma_f32_16x16x32_bf16 v[196:199], a[196:199], a[32:35], v[196:199]
    buffer_store_dword v4, v15, s[24:27], s76 offen sc1
    v_mfma_f32_16x16x32_bf16 v[192:195], a[192:195], a[32:35], v[192:195]
    s_sub_u32 s78, s72, s77
    ds_read_b64_tr_b16 a[196:197], v11 offset:8192
    v_add_f32 v59, v59, v95
    v_mfma_f32_16x16x32_bf16 v[224:227], a[200:203], a[32:35], v[224:227]
    s_sub_u32 s79, s73, s77
    ds_read_b64_tr_b16 a[198:199], v11 offset:10240
    v_cvt_pk_bf16_f32 v56, v56, v56
    v_mfma_f32_16x16x32_bf16 v[228:231], a[204:207], a[32:35], v[228:231]
    s_max_u32 s78, s78, s79
    ds_read_b64_tr_b16 a[192:193], v10 offset:8192
    v_and_b32 v56, 0xffff0000, v56
    v_mfma_f32_16x16x32_bf16 v[236:239], a[204:207], a[36:39], v[236:239]
    s_waitcnt lgkmcnt(3)
    ds_read_b64_tr_b16 a[194:195], v10 offset:10240
    v_cvt_pk_bf16_f32 v57, v57, v57
    v_mfma_f32_16x16x32_bf16 v[232:235], a[200:203], a[36:39], v[232:235]
    s_sub_u32 s79, s74, s77
    v_and_b32 v57, 0xffff0000, v57
    v_cvt_pk_bf16_f32 v58, v58, v58
    v_mfma_f32_16x16x32_bf16 v[240:243], a[200:203], a[40:43], v[240:243]
    s_max_u32 s78, s78, s79
    v_and_b32 v58, 0xffff0000, v58
    v_cvt_pk_bf16_f32 v59, v59, v59
    v_mfma_f32_16x16x32_bf16 v[244:247], a[204:207], a[40:43], v[244:247]
    s_sub_u32 s79, s75, s77
    v_and_b32 v59, 0xffff0000, v59
    v_mul_f32 v60, s92, v56
    v_mfma_f32_16x16x32_bf16 v[252:255], a[204:207], a[44:47], v[252:255]
    s_max_u32 s78, s78, s79
    v_exp_f32 v60, v60
    v_mfma_f32_16x16x32_bf16 v[248:251], a[200:203], a[44:47], v[248:251]
    s_cmp_gt_u32 s78, 2
    s_cbranch_scc1 spin_o3
spin_o3_ret:
    v_add_f32 v60, 1.0, v60
    v_mfma_f32_16x16x32_bf16 v[120:123], a[208:211], a[60:63], v[120:123]
    s_add_u32 s37, s59, 12288
    ds_read_b64_tr_b16 a[200:201], v8 offset:12288
    v_mul_f32 v61, s92, v57
    v_mfma_f32_16x16x32_bf16 v[124:127], a[212:215], a[60:63], v[124:127]
    buffer_load_dwordx4 a[32:35], v14, s[20:23], s37 offen offset:0 sc1
    v_mfma_f32_16x16x32_bf16 v[116:119], a[212:215], a[56:59], v[116:119]
    ds_read_b64_tr_b16 a[202:203], v8 offset:14336
    v_lshlrev_b32 v64, 1, v1
    v_mfma_f32_16x16x32_bf16 v[112:115], a[208:211], a[56:59], v[112:115]
    ds_read_b64_tr_b16 a[204:205], v9 offset:12288
    v_add_u32 v64, s56, v64
    v_mfma_f32_16x16x32_bf16 v[104:107], a[208:211], a[52:55], v[104:107]
    ds_read_b64_tr_b16 a[206:207], v9 offset:14336
    v_and_b32 v65, 1, v1
    v_mfma_f32_16x16x32_bf16 v[108:111], a[212:215], a[52:55], v[108:111]
    buffer_load_dwordx4 a[36:39], v14, s[20:23], s37 offen offset:1024 sc1
    v_mfma_f32_16x16x32_bf16 v[100:103], a[212:215], a[48:51], v[100:103]
    ds_read_b64_tr_b16 a[212:213], v11 offset:12288
    v_lshlrev_b32 v65, 7, v65
    v_mfma_f32_16x16x32_bf16 v[96:99], a[208:211], a[48:51], v[96:99]
    ds_read_b64_tr_b16 a[214:215], v11 offset:14336
    v_lshrrev_b32 v67, 4, v1
    v_mfma_f32_16x16x32_bf16 v[128:131], a[184:187], a[48:51], v[128:131]
    ds_read_b64_tr_b16 a[208:209], v10 offset:12288
    v_lshl_add_u32 v65, v67, 4, v65
    v_mfma_f32_16x16x32_bf16 v[132:135], a[188:191], a[48:51], v[132:135]
    s_waitcnt lgkmcnt(5)
    ds_read_b64_tr_b16 a[210:211], v10 offset:14336
    v_add_u32 v65, s56, v65
    v_mfma_f32_16x16x32_bf16 v[140:143], a[188:191], a[52:55], v[140:143]
    buffer_load_dwordx4 a[40:43], v14, s[20:23], s37 offen offset:2048 sc1
    v_mfma_f32_16x16x32_bf16 v[136:139], a[184:187], a[52:55], v[136:139]
    v_rcp_f32 v60, v60
    v_mfma_f32_16x16x32_bf16 v[144:147], a[184:187], a[56:59], v[144:147]
    v_exp_f32 v61, v61
    v_mfma_f32_16x16x32_bf16 v[148:151], a[188:191], a[56:59], v[148:151]
    v_mul_f32 v56, v56, v60
    v_cvt_pk_bf16_f32 v56, v56, v56
    v_mfma_f32_16x16x32_bf16 v[156:159], a[188:191], a[60:63], v[156:159]
    v_and_b32 v56, 0xffff0000, v56
    v_mul_f32 v56, v56, v58
    v_mfma_f32_16x16x32_bf16 v[152:155], a[184:187], a[60:63], v[152:155]
    buffer_load_dwordx4 a[44:47], v14, s[20:23], s37 offen offset:3072 sc1
    v_mfma_f32_16x16x32_bf16 v[184:187], a[192:195], a[60:63], v[184:187]
    v_add_f32 v61, 1.0, v61
    v_bfe_u32 v67, v1, 2, 3
    v_mfma_f32_16x16x32_bf16 v[188:191], a[196:199], a[60:63], v[188:191]
    s_waitcnt lgkmcnt(0)
    v_rcp_f32 v61, v61
    v_mfma_f32_16x16x32_bf16 v[180:183], a[196:199], a[56:59], v[180:183]
    s_barrier
    v_mfma_f32_16x16x32_bf16 v[176:179], a[192:195], a[56:59], v[176:179]
    ds_read_b64_tr_b16 a[184:185], v12 offset:20480
    v_mul_f32 v57, v57, v61
    v_mfma_f32_16x16x32_bf16 v[168:171], a[192:195], a[52:55], v[168:171]
    s_mov_b32 s12, s64
    ds_read_b64_tr_b16 a[186:187], v12 offset:21504
    v_cvt_pk_bf16_f32 v57, v57, v57
    v_mfma_f32_16x16x32_bf16 v[172:175], a[196:199], a[52:55], v[172:175]
    s_and_b32 s13, s65, 0xffff
    ds_read_b64_tr_b16 a[188:189], v13 offset:20480
    v_and_b32 v57, 0xffff0000, v57
    v_mfma_f32_16x16x32_bf16 v[164:167], a[196:199], a[48:51], v[164:167]
    s_mov_b32 s14, 2621440
    ds_read_b64_tr_b16 a[190:191], v13 offset:21504
    v_mul_f32 v57, v57, v59
    v_mfma_f32_16x16x32_bf16 v[160:163], a[192:195], a[48:51], v[160:163]
    s_mov_b32 s15, 0x00020000
    ds_read_b64_tr_b16 a[192:193], v8 offset:20480
    v_cvt_pk_bf16_f32 v56, v56, v57
    v_mfma_f32_16x16x32_bf16 v[192:195], a[200:203], a[48:51], v[192:195]
    ds_write_b16 v64, v56
    v_mfma_f32_16x16x32_bf16 v[196:199], a[204:207], a[48:51], v[196:199]
    ds_write_b16_d16_hi v64, v56 offset:128
    v_mfma_f32_16x16x32_bf16 v[204:207], a[204:207], a[52:55], v[204:207]
    s_mov_b32 s16, s84
    ds_read_b128 v[68:71], v65
    v_lshlrev_b32 v66, 7, v67
    v_mfma_f32_16x16x32_bf16 v[200:203], a[200:203], a[52:55], v[200:203]
    s_and_b32 s17, s85, 0xffff
    ds_read_b128 v[72:75], v65 offset:64
    v_lshrrev_b32 v67, 1, v67
    v_mfma_f32_16x16x32_bf16 v[208:211], a[200:203], a[56:59], v[208:211]
    s_mov_b32 s18, 2621440
    ds_read_b64_tr_b16 a[194:195], v8 offset:22528
    v_xor_b32 v67, s3, v67
    v_mfma_f32_16x16x32_bf16 v[212:215], a[204:207], a[56:59], v[212:215]
    s_mov_b32 s19, 0x00020000
    ds_read_b64_tr_b16 a[196:197], v9 offset:20480
    v_lshl_add_u32 v66, v67, 5, v66
    v_mfma_f32_16x16x32_bf16 v[220:223], a[204:207], a[60:63], v[220:223]
    s_waitcnt lgkmcnt(6)
    ds_read_b64_tr_b16 a[198:199], v9 offset:22528
    v_and_b32 v67, 3, v1
    v_mfma_f32_16x16x32_bf16 v[216:219], a[200:203], a[60:63], v[216:219]
    s_lshl_b32 s56, s54, 1
    ds_read_b64_tr_b16 a[204:205], v11 offset:20480
    v_lshl_add_u32 v66, v67, 3, v66
    v_mfma_f32_16x16x32_bf16 v[248:251], a[208:211], a[60:63], v[248:251]
    s_add_u32 s38, s45, 81920
    ds_read_b64_tr_b16 a[206:207], v11 offset:22528
    v_lshrrev_b32 v67, 5, v1
    v_mfma_f32_16x16x32_bf16 v[252:255], a[212:215], a[60:63], v[252:255]
    s_add_u32 s36, s46, 81920
    ds_read_b64_tr_b16 a[200:201], v10 offset:20480
    v_mul_u32_u24 v67, 1024, v67
    v_mfma_f32_16x16x32_bf16 v[244:247], a[212:215], a[56:59], v[244:247]
    s_add_u32 s37, s60, 12288
    ds_read_b64_tr_b16 a[202:203], v10 offset:22528
    v_add_u32 v66, v66, v67
    v_mfma_f32_16x16x32_bf16 v[240:243], a[208:211], a[56:59], v[240:243]
    s_waitcnt lgkmcnt(6)
    v_add_u32 v66, 114688, v66
    v_lshlrev_b32 v62, 2, v1
    v_mfma_f32_16x16x32_bf16 v[232:235], a[208:211], a[52:55], v[232:235]
    s_cmp_lt_u32 s3, 2
    s_cselect_b32 s38, s38, s36
    v_mov_b32 v67, 0x7ffffff0
    v_mfma_f32_16x16x32_bf16 v[236:239], a[212:215], a[52:55], v[236:239]
    s_add_u32 m0, s63, 139264
    v_cndmask_b32 v62, v67, v62, vcc
    v_and_b32 v5, 15, v1
    v_mfma_f32_16x16x32_bf16 v[228:231], a[212:215], a[48:51], v[228:231]
    s_and_b32 s57, s53, 1
    v_bfe_u32 v20, v1, 4, 1
    v_bfe_u32 v21, v1, 5, 1
    v_mfma_f32_16x16x32_bf16 v[224:227], a[208:211], a[48:51], v[224:227]
    s_add_u32 s56, s56, s57
    ds_read_b64_tr_b16 a[208:209], v8 offset:24576
    v_lshl_add_u32 v20, v20, 1, v21
    v_mfma_f32_16x16x32_bf16 v[96:99], a[184:187], a[64:67], v[96:99]
    buffer_load_dwordx4 a[48:51], v14, s[20:23], s37 offen offset:0 sc1
    v_mfma_f32_16x16x32_bf16 v[100:103], a[188:191], a[64:67], v[100:103]
    buffer_load_dwordx4 v7, s[8:11], s38 offen lds
    v_mfma_f32_16x16x32_bf16 v[108:111], a[188:191], a[68:71], v[108:111]
    s_lshl_b32 s56, s56, 5
    ds_read_b64_tr_b16 a[210:211], v8 offset:26624
    v_add_u32 v5, s56, v5
    v_mfma_f32_16x16x32_bf16 v[104:107], a[184:187], a[68:71], v[104:107]
    s_mul_i32 s56, s51, 320
    ds_read_b64_tr_b16 a[212:213], v9 offset:24576
    v_mul_u32_u24 v4, 1280, v5
    v_mfma_f32_16x16x32_bf16 v[112:115], a[184:187], a[72:75], v[112:115]
    s_and_b32 s57, s51, 1
    ds_read_b64_tr_b16 a[214:215], v9 offset:26624
    v_lshl_add_u32 v4, v20, 4, v4
    v_mfma_f32_16x16x32_bf16 v[116:119], a[188:191], a[72:75], v[116:119]
    buffer_load_dwordx4 a[52:55], v14, s[20:23], s37 offen offset:1024 sc1
    v_mfma_f32_16x16x32_bf16 v[124:127], a[188:191], a[76:79], v[124:127]
    s_waitcnt lgkmcnt(3)
    ds_read_b64_tr_b16 a[188:189], v11 offset:24576
    v_lshlrev_b32 v20, 3, v5
    v_mfma_f32_16x16x32_bf16 v[120:123], a[184:187], a[76:79], v[120:123]
    s_add_u32 s64, s57, s50
    ds_read_b64_tr_b16 a[190:191], v11 offset:26624
    v_add_u32 v20, 3211264, v20
    v_mfma_f32_16x16x32_bf16 v[152:155], a[192:195], a[76:79], v[152:155]
    s_lshl_b32 s64, s64, 6
    ds_read_b64_tr_b16 a[184:185], v10 offset:24576
    s_add_u32 s64, s64, s56
    v_mfma_f32_16x16x32_bf16 v[156:159], a[196:199], a[76:79], v[156:159]
    s_add_u32 s65, s64, 20480
    ds_read_b64_tr_b16 a[186:187], v10 offset:26624
    s_xor_b32 s57, s57, 1
    v_mfma_f32_16x16x32_bf16 v[148:151], a[196:199], a[72:75], v[148:151]
    buffer_load_dwordx4 a[56:59], v14, s[20:23], s37 offen offset:2048 sc1
    v_mfma_f32_16x16x32_bf16 v[144:147], a[192:195], a[72:75], v[144:147]
    s_lshl_b32 s57, s57, 8
    s_add_u32 s68, s56, s57
    s_add_u32 s69, s68, 20480
    v_mfma_f32_16x16x32_bf16 v[136:139], a[192:195], a[68:71], v[136:139]
    s_add_u32 s38, s47, 81920
    s_add_u32 s36, s45, 122880
    v_mfma_f32_16x16x32_bf16 v[140:143], a[196:199], a[68:71], v[140:143]
    s_cmp_lt_u32 s3, 2
    s_cselect_b32 s38, s38, s36
    v_mfma_f32_16x16x32_bf16 v[132:135], a[196:199], a[64:67], v[132:135]
    s_add_u32 m0, s63, 143360
    ds_read_b64_tr_b16 a[196:197], v13 offset:22528
    v_mfma_f32_16x16x32_bf16 v[128:131], a[192:195], a[64:67], v[128:131]
    buffer_load_dwordx4 a[60:63], v14, s[20:23], s37 offen offset:3072 sc1
    v_mfma_f32_16x16x32_bf16 v[160:163], a[200:203], a[64:67], v[160:163]
    s_cmp_eq_u32 s50, s3
    s_cselect_b32 s66, -1, 0
    s_andn2_b32 s56, 0x70000000, s66
    v_mfma_f32_16x16x32_bf16 v[164:167], a[204:207], a[64:67], v[164:167]
    s_andn2_b32 s80, 0xff00, s66
    ds_read_b64_tr_b16 a[198:199], v13 offset:23552
    v_or_b32 v21, s56, v4
    v_mfma_f32_16x16x32_bf16 v[172:175], a[204:207], a[68:71], v[172:175]
    s_or_b32 s80, s80, 0x101
    ds_read_b64_tr_b16 a[192:193], v12 offset:22528
    v_mfma_f32_16x16x32_bf16 v[168:171], a[200:203], a[68:71], v[168:171]
    ds_read_b64_tr_b16 a[194:195], v12 offset:23552
    v_mfma_f32_16x16x32_bf16 v[176:179], a[200:203], a[72:75], v[176:179]
    s_waitcnt lgkmcnt(4)
    v_mfma_f32_16x16x32_bf16 v[180:183], a[204:207], a[72:75], v[180:183]
    buffer_load_dwordx4 v7, s[8:11], s38 offen lds
    v_mfma_f32_16x16x32_bf16 v[188:191], a[204:207], a[76:79], v[188:191]
    buffer_load_dwordx2 v[16:17], v20, s[24:27], 0 offen offset:0 sc1
    v_mfma_f32_16x16x32_bf16 v[184:187], a[200:203], a[76:79], v[184:187]
    s_add_u32 s77, s7, 5
    ds_read_b64_tr_b16 a[200:201], v8 offset:28672
    v_mfma_f32_16x16x32_bf16 v[216:219], a[208:211], a[76:79], v[216:219]
    s_load_dwordx4 s[72:75], s[86:87], s5 glc
    ds_read_b64_tr_b16 a[202:203], v8 offset:30720
    v_mfma_f32_16x16x32_bf16 v[220:223], a[212:215], a[76:79], v[220:223]
    ds_read_b64_tr_b16 a[204:205], v9 offset:28672
    v_mfma_f32_16x16x32_bf16 v[212:215], a[212:215], a[72:75], v[212:215]
    ds_read_b64_tr_b16 a[206:207], v9 offset:30720
    v_mfma_f32_16x16x32_bf16 v[208:211], a[208:211], a[72:75], v[208:211]
    buffer_load_dwordx2 v[18:19], v20, s[24:27], 0 offen offset:128 sc1
    v_mfma_f32_16x16x32_bf16 v[200:203], a[208:211], a[68:71], v[200:203]
    v_mfma_f32_16x16x32_bf16 v[204:207], a[212:215], a[68:71], v[204:207]
    v_mfma_f32_16x16x32_bf16 v[196:199], a[212:215], a[64:67], v[196:199]
    ds_read_b64_tr_b16 a[212:213], v11 offset:28672
    v_mfma_f32_16x16x32_bf16 v[192:195], a[208:211], a[64:67], v[192:195]
    ds_read_b64_tr_b16 a[214:215], v11 offset:30720
    v_mfma_f32_16x16x32_bf16 v[224:227], a[184:187], a[64:67], v[224:227]
    s_add_u32 s38, s46, 122880
    ds_read_b64_tr_b16 a[208:209], v10 offset:28672
    s_add_u32 s36, s47, 122880
    v_mfma_f32_16x16x32_bf16 v[228:231], a[188:191], a[64:67], v[228:231]
    s_waitcnt lgkmcnt(3)
    ds_read_b64_tr_b16 a[210:211], v10 offset:30720
    v_mfma_f32_16x16x32_bf16 v[236:239], a[188:191], a[68:71], v[236:239]
    buffer_load_dwordx4 v[24:27], v4, s[12:15], s64 offen
    v_mfma_f32_16x16x32_bf16 v[232:235], a[184:187], a[68:71], v[232:235]
    s_add_u32 s37, s61, 12288
    s_add_u32 m0, s63, 147456
    v_mfma_f32_16x16x32_bf16 v[240:243], a[184:187], a[72:75], v[240:243]
    s_cmp_lt_u32 s3, 2
    s_cselect_b32 s38, s38, s36
    v_mfma_f32_16x16x32_bf16 v[244:247], a[188:191], a[72:75], v[244:247]
    v_mfma_f32_16x16x32_bf16 v[252:255], a[188:191], a[76:79], v[252:255]
    v_mfma_f32_16x16x32_bf16 v[248:251], a[184:187], a[76:79], v[248:251]
    ds_read_b64_tr_b16 a[184:185], v8 offset:32768
    v_mfma_f32_16x16x32_bf16 v[120:123], a[192:195], a[228:231], v[120:123]
    buffer_load_dwordx4 a[64:67], v14, s[20:23], s37 offen offset:0 sc1
    v_mfma_f32_16x16x32_bf16 v[124:127], a[196:199], a[228:231], v[124:127]
    buffer_load_dwordx4 v7, s[8:11], s38 offen lds
    v_mfma_f32_16x16x32_bf16 v[116:119], a[196:199], a[224:227], v[116:119]
    buffer_load_dwordx4 v[28:31], v4, s[12:15], s65 offen
    v_mfma_f32_16x16x32_bf16 v[112:115], a[192:195], a[224:227], v[112:115]
    ds_read_b64_tr_b16 a[186:187], v8 offset:34816
    v_mfma_f32_16x16x32_bf16 v[104:107], a[192:195], a[220:223], v[104:107]
    ds_read_b64_tr_b16 a[188:189], v9 offset:32768
    v_mfma_f32_16x16x32_bf16 v[108:111], a[196:199], a[220:223], v[108:111]
    buffer_load_dwordx4 a[68:71], v14, s[20:23], s37 offen offset:1024 sc1
    v_mfma_f32_16x16x32_bf16 v[100:103], a[196:199], a[216:219], v[100:103]
    ds_read_b64_tr_b16 a[190:191], v9 offset:34816
    v_mfma_f32_16x16x32_bf16 v[96:99], a[192:195], a[216:219], v[96:99]
    ds_read_b64_tr_b16 a[196:197], v11 offset:32768
    v_mfma_f32_16x16x32_bf16 v[128:131], a[200:203], a[216:219], v[128:131]
    buffer_load_dwordx4 v[32:35], v21, s[12:15], s68 offen
    v_mfma_f32_16x16x32_bf16 v[132:135], a[204:207], a[216:219], v[132:135]
    ds_read_b64_tr_b16 a[198:199], v11 offset:34816
    v_mfma_f32_16x16x32_bf16 v[140:143], a[204:207], a[220:223], v[140:143]
    ds_read_b64_tr_b16 a[192:193], v10 offset:32768
    v_mfma_f32_16x16x32_bf16 v[136:139], a[200:203], a[220:223], v[136:139]
    s_waitcnt lgkmcnt(4)
    ds_read_b64_tr_b16 a[194:195], v10 offset:34816
    v_mfma_f32_16x16x32_bf16 v[144:147], a[200:203], a[224:227], v[144:147]
    buffer_load_dwordx4 a[72:75], v14, s[20:23], s37 offen offset:2048 sc1
    v_mfma_f32_16x16x32_bf16 v[148:151], a[204:207], a[224:227], v[148:151]
    s_add_u32 s38, s45, 163840
    s_add_u32 s36, s46, 163840
    v_mfma_f32_16x16x32_bf16 v[156:159], a[204:207], a[228:231], v[156:159]
    s_cmp_lt_u32 s3, 2
    s_cselect_b32 s38, s38, s36
    s_add_u32 m0, s63, 151552
    v_mfma_f32_16x16x32_bf16 v[152:155], a[200:203], a[228:231], v[152:155]
    buffer_load_dwordx4 a[76:79], v14, s[20:23], s37 offen offset:3072 sc1
    v_mfma_f32_16x16x32_bf16 v[184:187], a[208:211], a[228:231], v[184:187]
    buffer_load_dwordx4 v[36:39], v21, s[12:15], s69 offen
    v_mfma_f32_16x16x32_bf16 v[188:191], a[212:215], a[228:231], v[188:191]
    s_waitcnt lgkmcnt(0)
    v_mfma_f32_16x16x32_bf16 v[180:183], a[212:215], a[224:227], v[180:183]
    s_barrier
    v_mfma_f32_16x16x32_bf16 v[176:179], a[208:211], a[224:227], v[176:179]
    ds_read_b64_tr_b16 a[200:201], v12 offset:40960
    v_mfma_f32_16x16x32_bf16 v[168:171], a[208:211], a[220:223], v[168:171]
    buffer_load_dwordx4 v7, s[8:11], s38 offen lds
    v_mfma_f32_16x16x32_bf16 v[172:175], a[212:215], a[220:223], v[172:175]
    ds_read_b64_tr_b16 a[202:203], v12 offset:41984
    v_mfma_f32_16x16x32_bf16 v[164:167], a[212:215], a[216:219], v[164:167]
    ds_read_b64_tr_b16 a[204:205], v13 offset:40960
    v_mfma_f32_16x16x32_bf16 v[160:163], a[208:211], a[216:219], v[160:163]
    ds_read_b64_tr_b16 a[206:207], v13 offset:41984
    v_mfma_f32_16x16x32_bf16 v[192:195], a[184:187], a[216:219], v[192:195]
    ds_read_b64_tr_b16 a[208:209], v8 offset:40960
    v_mfma_f32_16x16x32_bf16 v[196:199], a[188:191], a[216:219], v[196:199]
    ds_read_b64_tr_b16 a[210:211], v8 offset:43008
    v_mfma_f32_16x16x32_bf16 v[204:207], a[188:191], a[220:223], v[204:207]
    ds_read_b64_tr_b16 a[212:213], v9 offset:40960
    v_mfma_f32_16x16x32_bf16 v[200:203], a[184:187], a[220:223], v[200:203]
    ds_read_b64_tr_b16 a[214:215], v9 offset:43008
    v_mfma_f32_16x16x32_bf16 v[208:211], a[184:187], a[224:227], v[208:211]
    v_mfma_f32_16x16x32_bf16 v[212:215], a[188:191], a[224:227], v[212:215]
    v_mfma_f32_16x16x32_bf16 v[220:223], a[188:191], a[228:231], v[220:223]
    s_sub_u32 s78, s72, s77
    ds_read_b64_tr_b16 a[188:189], v11 offset:40960
    s_sub_u32 s79, s73, s77
    v_mfma_f32_16x16x32_bf16 v[216:219], a[184:187], a[228:231], v[216:219]
    s_max_u32 s78, s78, s79
    ds_read_b64_tr_b16 a[190:191], v11 offset:43008
    s_sub_u32 s79, s74, s77
    v_mfma_f32_16x16x32_bf16 v[248:251], a[192:195], a[228:231], v[248:251]
    s_max_u32 s78, s78, s79
    ds_read_b64_tr_b16 a[184:185], v10 offset:40960
    s_sub_u32 s79, s75, s77
    v_mfma_f32_16x16x32_bf16 v[252:255], a[196:199], a[228:231], v[252:255]
    s_waitcnt lgkmcnt(4)
    ds_read_b64_tr_b16 a[186:187], v10 offset:43008
    s_max_u32 s78, s78, s79
    v_mfma_f32_16x16x32_bf16 v[244:247], a[196:199], a[224:227], v[244:247]
    s_cmp_gt_u32 s78, 1
    s_cbranch_scc1 spin_o4
spin_o4_ret:
    s_add_u32 s37, s59, 16384
    v_mfma_f32_16x16x32_bf16 v[240:243], a[192:195], a[224:227], v[240:243]
    s_add_u32 s38, s47, 163840
    s_add_u32 s36, s45, 204800
    s_add_u32 m0, s63, 155648
    v_mfma_f32_16x16x32_bf16 v[232:235], a[192:195], a[220:223], v[232:235]
    s_cmp_lt_u32 s3, 2
    s_cselect_b32 s38, s38, s36
    v_mfma_f32_16x16x32_bf16 v[236:239], a[196:199], a[220:223], v[236:239]
    v_mfma_f32_16x16x32_bf16 v[228:231], a[196:199], a[216:219], v[228:231]
    v_mfma_f32_16x16x32_bf16 v[224:227], a[192:195], a[216:219], v[224:227]
    ds_read_b64_tr_b16 a[192:193], v8 offset:45056
    v_mfma_f32_16x16x32_bf16 v[96:99], a[200:203], a[232:235], v[96:99]
    buffer_load_dwordx4 a[216:219], v14, s[20:23], s37 offen offset:0 sc1
    v_mfma_f32_16x16x32_bf16 v[100:103], a[204:207], a[232:235], v[100:103]
    buffer_load_dwordx4 v7, s[8:11], s38 offen lds
    v_mfma_f32_16x16x32_bf16 v[108:111], a[204:207], a[236:239], v[108:111]
    ds_read_b64_tr_b16 a[194:195], v8 offset:47104
    v_mfma_f32_16x16x32_bf16 v[104:107], a[200:203], a[236:239], v[104:107]
    ds_read_b64_tr_b16 a[196:197], v9 offset:45056
    v_mfma_f32_16x16x32_bf16 v[112:115], a[200:203], a[240:243], v[112:115]
    ds_read_b64_tr_b16 a[198:199], v9 offset:47104
    v_mfma_f32_16x16x32_bf16 v[116:119], a[204:207], a[240:243], v[116:119]
    buffer_load_dwordx4 a[220:223], v14, s[20:23], s37 offen offset:1024 sc1
    v_mfma_f32_16x16x32_bf16 v[124:127], a[204:207], a[244:247], v[124:127]
    s_waitcnt lgkmcnt(3)
    ds_read_b64_tr_b16 v[76:77], v66 offset:0
    v_mfma_f32_16x16x32_bf16 v[120:123], a[200:203], a[244:247], v[120:123]
    ds_read_b64_tr_b16 v[78:79], v66 offset:2048
    v_mfma_f32_16x16x32_bf16 v[152:155], a[208:211], a[244:247], v[152:155]
    ds_read_b64_tr_b16 v[80:81], v66 offset:4096
    v_mfma_f32_16x16x32_bf16 v[156:159], a[212:215], a[244:247], v[156:159]
    ds_read_b64_tr_b16 v[82:83], v66 offset:6144
    v_mfma_f32_16x16x32_bf16 v[148:151], a[212:215], a[240:243], v[148:151]
    buffer_load_dwordx4 a[224:227], v14, s[20:23], s37 offen offset:2048 sc1
    v_mfma_f32_16x16x32_bf16 v[144:147], a[208:211], a[240:243], v[144:147]
    ds_read_b64_tr_b16 a[204:205], v11 offset:45056
    v_mfma_f32_16x16x32_bf16 v[136:139], a[208:211], a[236:239], v[136:139]
    s_add_u32 s38, s46, 204800
    ds_read_b64_tr_b16 a[206:207], v11 offset:47104
    s_add_u32 s36, s47, 204800
    v_mfma_f32_16x16x32_bf16 v[140:143], a[212:215], a[236:239], v[140:143]
    s_cmp_lt_u32 s3, 2
    s_cselect_b32 s38, s38, s36
    v_mfma_f32_16x16x32_bf16 v[132:135], a[212:215], a[232:235], v[132:135]
    s_add_u32 m0, s63, 159744
    ds_read_b64_tr_b16 a[200:201], v10 offset:45056
    v_mfma_f32_16x16x32_bf16 v[128:131], a[208:211], a[232:235], v[128:131]
    buffer_load_dwordx4 a[228:231], v14, s[20:23], s37 offen offset:3072 sc1
    v_mfma_f32_16x16x32_bf16 v[160:163], a[184:187], a[232:235], v[160:163]
    s_add_u32 s36, s7, 1
    ds_read_b64_tr_b16 a[202:203], v10 offset:47104
    v_mfma_f32_16x16x32_bf16 v[164:167], a[188:191], a[232:235], v[164:167]
    s_waitcnt lgkmcnt(4)
    ds_read_b64_tr_b16 a[212:213], v13 offset:43008
    v_mfma_f32_16x16x32_bf16 v[172:175], a[188:191], a[236:239], v[172:175]
    ds_read_b64_tr_b16 a[214:215], v13 offset:44032
    v_mfma_f32_16x16x32_bf16 v[168:171], a[184:187], a[236:239], v[168:171]
    ds_read_b64_tr_b16 a[208:209], v12 offset:43008
    v_mfma_f32_16x16x32_bf16 v[176:179], a[184:187], a[240:243], v[176:179]
    buffer_load_dwordx4 v7, s[8:11], s38 offen lds
    v_mfma_f32_16x16x32_bf16 v[180:183], a[188:191], a[240:243], v[180:183]
    ds_read_b64_tr_b16 a[210:211], v12 offset:44032
    v_mfma_f32_16x16x32_bf16 v[188:191], a[188:191], a[244:247], v[188:191]
    v_add_u32 v12, 73728, v12
    v_mfma_f32_16x16x32_bf16 v[184:187], a[184:187], a[244:247], v[184:187]
    ds_read_b64_tr_b16 a[184:185], v8 offset:49152
    v_mfma_f32_16x16x32_bf16 v[216:219], a[192:195], a[244:247], v[216:219]
    ds_read_b64_tr_b16 a[186:187], v8 offset:51200
    v_mfma_f32_16x16x32_bf16 v[220:223], a[196:199], a[244:247], v[220:223]
    ds_read_b64_tr_b16 a[188:189], v9 offset:49152
    v_mfma_f32_16x16x32_bf16 v[212:215], a[196:199], a[240:243], v[212:215]
    s_waitcnt lgkmcnt(4)
    ds_read_b64_tr_b16 a[190:191], v9 offset:51200
    v_mfma_f32_16x16x32_bf16 v[208:211], a[192:195], a[240:243], v[208:211]
    v_add_u32 v13, 73728, v13
    v_mfma_f32_16x16x32_bf16 v[200:203], a[192:195], a[236:239], v[200:203]
    v_mfma_f32_16x16x32_bf16 v[204:207], a[196:199], a[236:239], v[204:207]
    v_mfma_f32_16x16x32_bf16 v[196:199], a[196:199], a[232:235], v[196:199]
    ds_read_b64_tr_b16 a[196:197], v11 offset:49152
    v_mfma_f32_16x16x32_bf16 v[192:195], a[192:195], a[232:235], v[192:195]
    ds_read_b64_tr_b16 a[198:199], v11 offset:51200
    v_mfma_f32_16x16x32_bf16 v[84:87], v[68:71], v[76:79], 0
    ds_read_b64_tr_b16 a[192:193], v10 offset:49152
    v_mfma_f32_16x16x32_bf16 v[84:87], v[72:75], v[80:83], v[84:87]
    ds_read_b64_tr_b16 a[194:195], v10 offset:51200
    v_mfma_f32_16x16x32_bf16 v[224:227], a[200:203], a[232:235], v[224:227]
    v_mfma_f32_16x16x32_bf16 v[228:231], a[204:207], a[232:235], v[228:231]
    v_mfma_f32_16x16x32_bf16 v[236:239], a[204:207], a[236:239], v[236:239]
    s_add_u32 s37, s60, 16384
    v_mfma_f32_16x16x32_bf16 v[232:235], a[200:203], a[236:239], v[232:235]
    v_mfma_f32_16x16x32_bf16 v[240:243], a[200:203], a[240:243], v[240:243]
    v_mfma_f32_16x16x32_bf16 v[244:247], a[204:207], a[240:243], v[244:247]
    buffer_store_dword v84, v62, s[24:27], s62 offen sc1
    v_mfma_f32_16x16x32_bf16 v[252:255], a[204:207], a[244:247], v[252:255]
    buffer_store_dword v85, v62, s[24:27], s62 offen offset:2560 sc1
    v_mfma_f32_16x16x32_bf16 v[248:251], a[200:203], a[244:247], v[248:251]
    s_waitcnt lgkmcnt(0)
    ds_read_b64_tr_b16 a[200:201], v8 offset:53248
    v_mfma_f32_16x16x32_bf16 v[120:123], a[208:211], a[164:167], v[120:123]
    buffer_load_dwordx4 a[232:235], v14, s[20:23], s37 offen offset:0 sc1
    v_mfma_f32_16x16x32_bf16 v[124:127], a[212:215], a[164:167], v[124:127]
    ds_read_b64_tr_b16 a[202:203], v8 offset:55296
    v_mfma_f32_16x16x32_bf16 v[116:119], a[212:215], a[160:163], v[116:119]
pg_13:
    s_cbranch_execz pg_back
    ds_read_b64_tr_b16 a[204:205], v9 offset:53248
    v_mfma_f32_16x16x32_bf16 v[112:115], a[208:211], a[160:163], v[112:115]
    ds_read_b64_tr_b16 a[206:207], v9 offset:55296
    v_mfma_f32_16x16x32_bf16 v[104:107], a[208:211], a[156:159], v[104:107]
    v_add_u32 v8, 73728, v8
    v_mfma_f32_16x16x32_bf16 v[108:111], a[212:215], a[156:159], v[108:111]
    buffer_load_dwordx4 a[236:239], v14, s[20:23], s37 offen offset:1024 sc1
    v_mfma_f32_16x16x32_bf16 v[100:103], a[212:215], a[152:155], v[100:103]
    ds_read_b64_tr_b16 a[212:213], v11 offset:53248
    v_mfma_f32_16x16x32_bf16 v[96:99], a[208:211], a[152:155], v[96:99]
    ds_read_b64_tr_b16 a[214:215], v11 offset:55296
    v_mfma_f32_16x16x32_bf16 v[128:131], a[184:187], a[152:155], v[128:131]
    ds_read_b64_tr_b16 a[208:209], v10 offset:53248
    v_mfma_f32_16x16x32_bf16 v[132:135], a[188:191], a[152:155], v[132:135]
    ds_read_b64_tr_b16 a[210:211], v10 offset:55296
    v_mfma_f32_16x16x32_bf16 v[140:143], a[188:191], a[156:159], v[140:143]
    buffer_load_dwordx4 a[240:243], v14, s[20:23], s37 offen offset:2048 sc1
    v_mfma_f32_16x16x32_bf16 v[136:139], a[184:187], a[156:159], v[136:139]
    s_add_u32 s38, s45, 81920
    v_add_u32 v9, 73728, v9
    v_mfma_f32_16x16x32_bf16 v[144:147], a[184:187], a[160:163], v[144:147]
    s_add_u32 m0, s63, 0
    v_add_u32 v11, 73728, v11
    v_mfma_f32_16x16x32_bf16 v[148:151], a[188:191], a[160:163], v[148:151]
    v_add_u32 v10, 73728, v10
    v_mfma_f32_16x16x32_bf16 v[156:159], a[188:191], a[164:167], v[156:159]
    v_mfma_f32_16x16x32_bf16 v[152:155], a[184:187], a[164:167], v[152:155]
    buffer_load_dwordx4 a[244:247], v14, s[20:23], s37 offen offset:3072 sc1
    v_mfma_f32_16x16x32_bf16 v[184:187], a[192:195], a[164:167], v[184:187]
    v_mfma_f32_16x16x32_bf16 v[188:191], a[196:199], a[164:167], v[188:191]
    s_waitcnt vmcnt(48)
    v_mfma_f32_16x16x32_bf16 v[180:183], a[196:199], a[160:163], v[180:183]
    s_barrier
    v_mfma_f32_16x16x32_bf16 v[176:179], a[192:195], a[160:163], v[176:179]
    buffer_load_dwordx4 v2, s[8:11], s38 offen lds
    v_mfma_f32_16x16x32_bf16 v[168:171], a[192:195], a[156:159], v[168:171]
    s_add_u32 s77, s7, 6
    ds_read_b64_tr_b16 a[184:185], v12 offset:0
    v_mfma_f32_16x16x32_bf16 v[172:175], a[196:199], a[156:159], v[172:175]
    s_waitcnt lgkmcnt(1)
    ds_read_b64_tr_b16 a[186:187], v12 offset:1024
    v_mfma_f32_16x16x32_bf16 v[164:167], a[196:199], a[152:155], v[164:167]
    s_waitcnt vmcnt(22)
    ds_read_b64_tr_b16 a[188:189], v13 offset:0
    v_mfma_f32_16x16x32_bf16 v[160:163], a[192:195], a[152:155], v[160:163]
    ds_read_b64_tr_b16 a[190:191], v13 offset:1024
    v_mfma_f32_16x16x32_bf16 v[192:195], a[200:203], a[152:155], v[192:195]
    s_add_u32 s38, s46, 81920
    ds_read_b64_tr_b16 a[192:193], v8 offset:0
    s_load_dwordx4 s[72:75], s[86:87], s5 glc
    v_mfma_f32_16x16x32_bf16 v[196:199], a[204:207], a[152:155], v[196:199]
    ds_read_b64_tr_b16 a[194:195], v8 offset:2048
    v_mfma_f32_16x16x32_bf16 v[204:207], a[204:207], a[156:159], v[204:207]
    s_add_u32 m0, s63, 4096
    ds_read_b64_tr_b16 a[196:197], v9 offset:0
    v_mfma_f32_16x16x32_bf16 v[200:203], a[200:203], a[156:159], v[200:203]
    ds_read_b64_tr_b16 a[198:199], v9 offset:2048
    v_mfma_f32_16x16x32_bf16 v[208:211], a[200:203], a[160:163], v[208:211]
    v_permlane16_swap_b32 v24, v26
    v_mfma_f32_16x16x32_bf16 v[212:215], a[204:207], a[160:163], v[212:215]
    v_permlane16_swap_b32 v25, v27
    v_mfma_f32_16x16x32_bf16 v[220:223], a[204:207], a[164:167], v[220:223]
    s_waitcnt vmcnt(19)
    ds_read_b64_tr_b16 a[204:205], v11 offset:0
    v_lshlrev_b32 v20, 16, v24
    v_mfma_f32_16x16x32_bf16 v[216:219], a[200:203], a[164:167], v[216:219]
    ds_read_b64_tr_b16 a[206:207], v11 offset:2048
    v_and_b32 v21, 0xffff0000, v24
    v_mfma_f32_16x16x32_bf16 v[248:251], a[208:211], a[164:167], v[248:251]
    buffer_load_dwordx4 v2, s[8:11], s38 offen lds
    v_mfma_f32_16x16x32_bf16 v[252:255], a[212:215], a[164:167], v[252:255]
    ds_read_b64_tr_b16 a[200:201], v10 offset:0
    v_sub_f32 v20, v20, v16
    v_mfma_f32_16x16x32_bf16 v[244:247], a[212:215], a[160:163], v[244:247]
    s_waitcnt lgkmcnt(3)
    ds_read_b64_tr_b16 a[202:203], v10 offset:2048
    v_sub_f32 v21, v21, v16
    v_mfma_f32_16x16x32_bf16 v[240:243], a[208:211], a[160:163], v[240:243]
    s_add_u32 s37, s61, 16384
    v_cvt_pk_bf16_f32 v22, v20, v21
    v_lshlrev_b32 v20, 16, v22
    v_mfma_f32_16x16x32_bf16 v[232:235], a[208:211], a[156:159], v[232:235]
    s_waitcnt vmcnt(18)
    v_and_b32 v21, 0xffff0000, v22
    v_mul_f32 v20, v20, v17
    v_mfma_f32_16x16x32_bf16 v[236:239], a[212:215], a[156:159], v[236:239]
    v_mul_f32 v21, v21, v17
    v_cvt_pk_bf16_f32 v22, v20, v21
    v_mfma_f32_16x16x32_bf16 v[228:231], a[212:215], a[152:155], v[228:231]
    s_add_u32 s38, s47, 81920
    v_lshlrev_b32 v20, 16, v22
    v_and_b32 v21, 0xffff0000, v22
    v_mfma_f32_16x16x32_bf16 v[224:227], a[208:211], a[152:155], v[224:227]
    ds_read_b64_tr_b16 a[208:209], v8 offset:4096
    v_mul_f32 v23, s92, v20
    v_mfma_f32_16x16x32_bf16 v[96:99], a[184:187], a[168:171], v[96:99]
    buffer_load_dwordx4 a[152:155], v14, s[20:23], s37 offen offset:0 sc1
    v_mfma_f32_16x16x32_bf16 v[100:103], a[188:191], a[168:171], v[100:103]
    s_add_u32 m0, s63, 8192
    ds_read_b64_tr_b16 a[210:211], v8 offset:6144
    v_mul_f32 v92, s92, v21
    v_mfma_f32_16x16x32_bf16 v[108:111], a[188:191], a[172:175], v[108:111]
    ds_read_b64_tr_b16 a[212:213], v9 offset:4096
    v_mfma_f32_16x16x32_bf16 v[104:107], a[184:187], a[172:175], v[104:107]
    ds_read_b64_tr_b16 a[214:215], v9 offset:6144
    v_mfma_f32_16x16x32_bf16 v[112:115], a[184:187], a[176:179], v[112:115]
    s_waitcnt vmcnt(16)
    v_exp_f32 v23, v23
    v_mfma_f32_16x16x32_bf16 v[116:119], a[188:191], a[176:179], v[116:119]
    buffer_load_dwordx4 a[156:159], v14, s[20:23], s37 offen offset:1024 sc1
    v_mfma_f32_16x16x32_bf16 v[124:127], a[188:191], a[180:183], v[124:127]
    buffer_load_dwordx4 v2, s[8:11], s38 offen lds
    v_mfma_f32_16x16x32_bf16 v[120:123], a[184:187], a[180:183], v[120:123]
    ds_read_b64_tr_b16 a[188:189], v11 offset:4096
    v_add_f32 v23, 1.0, v23
    v_mfma_f32_16x16x32_bf16 v[152:155], a[192:195], a[180:183], v[152:155]
    ds_read_b64_tr_b16 a[190:191], v11 offset:6144
    v_mfma_f32_16x16x32_bf16 v[156:159], a[196:199], a[180:183], v[156:159]
    ds_read_b64_tr_b16 a[184:185], v10 offset:4096
    v_mfma_f32_16x16x32_bf16 v[148:151], a[196:199], a[176:179], v[148:151]
    s_waitcnt lgkmcnt(3)
    ds_read_b64_tr_b16 a[186:187], v10 offset:6144
    v_mfma_f32_16x16x32_bf16 v[144:147], a[192:195], a[176:179], v[144:147]
    buffer_load_dwordx4 a[160:163], v14, s[20:23], s37 offen offset:2048 sc1
    v_mfma_f32_16x16x32_bf16 v[136:139], a[192:195], a[172:175], v[136:139]
    s_add_u32 s38, s45, 122880
    v_exp_f32 v92, v92
    v_mfma_f32_16x16x32_bf16 v[140:143], a[196:199], a[172:175], v[140:143]
    v_rcp_f32 v23, v23
    v_mfma_f32_16x16x32_bf16 v[132:135], a[196:199], a[168:171], v[132:135]
    s_add_u32 m0, s63, 12288
    ds_read_b64_tr_b16 a[196:197], v13 offset:2048
    v_add_f32 v92, 1.0, v92
    v_mfma_f32_16x16x32_bf16 v[128:131], a[192:195], a[168:171], v[128:131]
    buffer_load_dwordx4 a[164:167], v14, s[20:23], s37 offen offset:3072 sc1
    v_mfma_f32_16x16x32_bf16 v[160:163], a[200:203], a[168:171], v[160:163]
    ds_read_b64_tr_b16 a[198:199], v13 offset:3072
    v_mul_f32 v20, v20, v23
    v_mfma_f32_16x16x32_bf16 v[164:167], a[204:207], a[168:171], v[164:167]
    ds_read_b64_tr_b16 a[192:193], v12 offset:2048
    v_mfma_f32_16x16x32_bf16 v[172:175], a[204:207], a[172:175], v[172:175]
    ds_read_b64_tr_b16 a[194:195], v12 offset:3072
    v_mfma_f32_16x16x32_bf16 v[168:171], a[200:203], a[172:175], v[168:171]
    v_rcp_f32 v92, v92
    v_mfma_f32_16x16x32_bf16 v[176:179], a[200:203], a[176:179], v[176:179]
    buffer_load_dwordx4 v2, s[8:11], s38 offen lds
    v_mfma_f32_16x16x32_bf16 v[180:183], a[204:207], a[176:179], v[180:183]
    v_mul_f32 v21, v21, v92
    v_cvt_pk_bf16_f32 v40, v20, v21
    v_mfma_f32_16x16x32_bf16 v[188:191], a[204:207], a[180:183], v[188:191]
    v_lshlrev_b32 v20, 16, v25
    v_and_b32 v21, 0xffff0000, v25
    v_mfma_f32_16x16x32_bf16 v[184:187], a[200:203], a[180:183], v[184:187]
    ds_read_b64_tr_b16 a[200:201], v8 offset:8192
    v_sub_f32 v20, v20, v16
    v_mfma_f32_16x16x32_bf16 v[216:219], a[208:211], a[180:183], v[216:219]
    ds_read_b64_tr_b16 a[202:203], v8 offset:10240
    v_sub_f32 v21, v21, v16
    v_mfma_f32_16x16x32_bf16 v[220:223], a[212:215], a[180:183], v[220:223]
    ds_read_b64_tr_b16 a[204:205], v9 offset:8192
    v_cvt_pk_bf16_f32 v22, v20, v21
    v_mfma_f32_16x16x32_bf16 v[212:215], a[212:215], a[176:179], v[212:215]
    s_waitcnt lgkmcnt(3)
    ds_read_b64_tr_b16 a[206:207], v9 offset:10240
    v_lshlrev_b32 v20, 16, v22
    v_mfma_f32_16x16x32_bf16 v[208:211], a[208:211], a[176:179], v[208:211]
    s_add_u32 s38, s46, 122880
    v_and_b32 v21, 0xffff0000, v22
    v_mul_f32 v20, v20, v17
    v_mfma_f32_16x16x32_bf16 v[200:203], a[208:211], a[172:175], v[200:203]
    s_add_u32 m0, s63, 16384
    v_mul_f32 v21, v21, v17
    v_cvt_pk_bf16_f32 v22, v20, v21
    v_mfma_f32_16x16x32_bf16 v[204:207], a[212:215], a[172:175], v[204:207]
    v_lshlrev_b32 v20, 16, v22
    v_and_b32 v21, 0xffff0000, v22
    v_mfma_f32_16x16x32_bf16 v[196:199], a[212:215], a[168:171], v[196:199]
    s_sub_u32 s78, s72, s77
    ds_read_b64_tr_b16 a[212:213], v11 offset:8192
    v_mul_f32 v23, s92, v20
    v_mfma_f32_16x16x32_bf16 v[192:195], a[208:211], a[168:171], v[192:195]
    s_sub_u32 s79, s73, s77
    ds_read_b64_tr_b16 a[214:215], v11 offset:10240
    v_mul_f32 v92, s92, v21
    v_mfma_f32_16x16x32_bf16 v[224:227], a[184:187], a[168:171], v[224:227]
    s_max_u32 s78, s78, s79
    ds_read_b64_tr_b16 a[208:209], v10 offset:8192
    s_sub_u32 s79, s74, s77
    v_mfma_f32_16x16x32_bf16 v[228:231], a[188:191], a[168:171], v[228:231]
    s_max_u32 s78, s78, s79
    ds_read_b64_tr_b16 a[210:211], v10 offset:10240
    s_sub_u32 s79, s75, s77
    v_mfma_f32_16x16x32_bf16 v[236:239], a[188:191], a[172:175], v[236:239]
    buffer_load_dwordx4 v2, s[8:11], s38 offen lds
    v_mfma_f32_16x16x32_bf16 v[232:235], a[184:187], a[172:175], v[232:235]
    s_max_u32 s78, s78, s79
    v_exp_f32 v23, v23
    v_mfma_f32_16x16x32_bf16 v[240:243], a[184:187], a[176:179], v[240:243]
    s_cmp_gt_u32 s78, 0
    s_cbranch_scc1 spin_o5
spin_o5_ret:
    v_add_f32 v23, 1.0, v23
    v_mfma_f32_16x16x32_bf16 v[244:247], a[188:191], a[176:179], v[244:247]
    s_add_u32 s37, s59, 20480
    v_exp_f32 v92, v92
    v_mfma_f32_16x16x32_bf16 v[252:255], a[188:191], a[180:183], v[252:255]
    s_waitcnt vmcnt(13)
    v_rcp_f32 v23, v23
    v_mfma_f32_16x16x32_bf16 v[248:251], a[184:187], a[180:183], v[248:251]
    buffer_store_dword v6, v15, s[24:27], s4 offen offset:160 sc1
    v_mfma_f32_16x16x32_bf16 v[120:123], a[192:195], a[92:95], v[120:123]
    buffer_load_dwordx4 a[168:171], v14, s[20:23], s37 offen offset:0 sc1
    v_mfma_f32_16x16x32_bf16 v[124:127], a[196:199], a[92:95], v[124:127]
    s_add_u32 s38, s47, 122880
    ds_read_b64_tr_b16 a[184:185], v8 offset:12288
    v_add_f32 v92, 1.0, v92
    v_mfma_f32_16x16x32_bf16 v[116:119], a[196:199], a[88:91], v[116:119]
    s_add_u32 m0, s63, 20480
    ds_read_b64_tr_b16 a[186:187], v8 offset:14336
    v_mul_f32 v20, v20, v23
    v_mfma_f32_16x16x32_bf16 v[112:115], a[192:195], a[88:91], v[112:115]
    ds_read_b64_tr_b16 a[188:189], v9 offset:12288
    v_mfma_f32_16x16x32_bf16 v[104:107], a[192:195], a[84:87], v[104:107]
    s_waitcnt lgkmcnt(3)
    ds_read_b64_tr_b16 a[190:191], v9 offset:14336
    v_mfma_f32_16x16x32_bf16 v[108:111], a[196:199], a[84:87], v[108:111]
    buffer_load_dwordx4 a[172:175], v14, s[20:23], s37 offen offset:1024 sc1
    v_mfma_f32_16x16x32_bf16 v[100:103], a[196:199], a[80:83], v[100:103]
    ds_read_b64_tr_b16 a[196:197], v11 offset:12288
    v_mfma_f32_16x16x32_bf16 v[96:99], a[192:195], a[80:83], v[96:99]
    ds_read_b64_tr_b16 a[198:199], v11 offset:14336
    v_mfma_f32_16x16x32_bf16 v[128:131], a[200:203], a[80:83], v[128:131]
    buffer_load_dwordx4 v2, s[8:11], s38 offen lds
    v_mfma_f32_16x16x32_bf16 v[132:135], a[204:207], a[80:83], v[132:135]
    ds_read_b64_tr_b16 a[192:193], v10 offset:12288
    v_mfma_f32_16x16x32_bf16 v[140:143], a[204:207], a[84:87], v[140:143]
    buffer_load_dwordx4 a[176:179], v14, s[20:23], s37 offen offset:2048 sc1
    v_mfma_f32_16x16x32_bf16 v[136:139], a[200:203], a[84:87], v[136:139]
    ds_read_b64_tr_b16 a[194:195], v10 offset:14336
    v_mfma_f32_16x16x32_bf16 v[144:147], a[200:203], a[88:91], v[144:147]
    v_rcp_f32 v92, v92
    v_mfma_f32_16x16x32_bf16 v[148:151], a[204:207], a[88:91], v[148:151]
    v_mul_f32 v21, v21, v92
    v_cvt_pk_bf16_f32 v41, v20, v21
    v_mfma_f32_16x16x32_bf16 v[156:159], a[204:207], a[92:95], v[156:159]
    s_add_u32 s38, s45, 163840
    v_lshlrev_b32 v20, 16, v26
    v_and_b32 v21, 0xffff0000, v26
    v_mfma_f32_16x16x32_bf16 v[152:155], a[200:203], a[92:95], v[152:155]
    buffer_load_dwordx4 a[180:183], v14, s[20:23], s37 offen offset:3072 sc1
    v_mfma_f32_16x16x32_bf16 v[184:187], a[208:211], a[92:95], v[184:187]
    s_add_u32 m0, s63, 24576
    v_sub_f32 v20, v20, v16
    v_sub_f32 v21, v21, v16
    v_mfma_f32_16x16x32_bf16 v[188:191], a[212:215], a[92:95], v[188:191]
    v_cvt_pk_bf16_f32 v22, v20, v21
    v_lshlrev_b32 v20, 16, v22
    v_mfma_f32_16x16x32_bf16 v[180:183], a[212:215], a[88:91], v[180:183]
    s_barrier
    v_mfma_f32_16x16x32_bf16 v[176:179], a[208:211], a[88:91], v[176:179]
    ds_read_b64_tr_b16 a[200:201], v12 offset:20480
    v_and_b32 v21, 0xffff0000, v22
    v_mfma_f32_16x16x32_bf16 v[168:171], a[208:211], a[84:87], v[168:171]
    ds_read_b64_tr_b16 a[202:203], v12 offset:21504
    v_mul_f32 v20, v20, v17
    v_mfma_f32_16x16x32_bf16 v[172:175], a[212:215], a[84:87], v[172:175]
    s_waitcnt lgkmcnt(2)
    ds_read_b64_tr_b16 a[204:205], v13 offset:20480
    v_mul_f32 v21, v21, v17
    v_mfma_f32_16x16x32_bf16 v[164:167], a[212:215], a[80:83], v[164:167]
    buffer_load_dwordx4 v2, s[8:11], s38 offen lds
    v_mfma_f32_16x16x32_bf16 v[160:163], a[208:211], a[80:83], v[160:163]
    ds_read_b64_tr_b16 a[206:207], v13 offset:21504
    v_cvt_pk_bf16_f32 v22, v20, v21
    v_mfma_f32_16x16x32_bf16 v[192:195], a[184:187], a[80:83], v[192:195]
    ds_read_b64_tr_b16 a[208:209], v8 offset:20480
    v_lshlrev_b32 v20, 16, v22
    v_mfma_f32_16x16x32_bf16 v[196:199], a[188:191], a[80:83], v[196:199]
    ds_read_b64_tr_b16 a[210:211], v8 offset:22528
    v_and_b32 v21, 0xffff0000, v22
    v_mfma_f32_16x16x32_bf16 v[204:207], a[188:191], a[84:87], v[204:207]
    ds_read_b64_tr_b16 a[212:213], v9 offset:20480
    v_mul_f32 v23, s92, v20
    v_mfma_f32_16x16x32_bf16 v[200:203], a[184:187], a[84:87], v[200:203]
    ds_read_b64_tr_b16 a[214:215], v9 offset:22528
    v_mul_f32 v92, s92, v21
    v_mfma_f32_16x16x32_bf16 v[208:211], a[184:187], a[88:91], v[208:211]
    s_add_u32 s38, s46, 163840
    v_exp_f32 v23, v23
    v_mfma_f32_16x16x32_bf16 v[212:215], a[188:191], a[88:91], v[212:215]
    v_exp_f32 v92, v92
    v_mfma_f32_16x16x32_bf16 v[220:223], a[188:191], a[92:95], v[220:223]
    s_add_u32 m0, s63, 28672
    ds_read_b64_tr_b16 a[188:189], v11 offset:20480
    v_add_f32 v23, 1.0, v23
    v_mfma_f32_16x16x32_bf16 v[216:219], a[184:187], a[92:95], v[216:219]
    ds_read_b64_tr_b16 a[190:191], v11 offset:22528
    v_add_f32 v92, 1.0, v92
    v_mfma_f32_16x16x32_bf16 v[248:251], a[192:195], a[92:95], v[248:251]
    ds_read_b64_tr_b16 a[184:185], v10 offset:20480
    v_mfma_f32_16x16x32_bf16 v[252:255], a[196:199], a[92:95], v[252:255]
    s_waitcnt lgkmcnt(4)
    ds_read_b64_tr_b16 a[186:187], v10 offset:22528
    v_mfma_f32_16x16x32_bf16 v[244:247], a[196:199], a[88:91], v[244:247]
    s_add_u32 s37, s60, 20480
    v_rcp_f32 v23, v23
    v_mfma_f32_16x16x32_bf16 v[240:243], a[192:195], a[88:91], v[240:243]
    v_rcp_f32 v92, v92
    v_mfma_f32_16x16x32_bf16 v[232:235], a[192:195], a[84:87], v[232:235]
    buffer_load_dwordx4 v2, s[8:11], s38 offen lds
    v_mfma_f32_16x16x32_bf16 v[236:239], a[196:199], a[84:87], v[236:239]
    v_mul_f32 v20, v20, v23
    v_mul_f32 v21, v21, v92
    v_mfma_f32_16x16x32_bf16 v[228:231], a[196:199], a[80:83], v[228:231]
    v_cvt_pk_bf16_f32 v42, v20, v21
    v_lshlrev_b32 v20, 16, v27
    v_mfma_f32_16x16x32_bf16 v[224:227], a[192:195], a[80:83], v[224:227]
    ds_read_b64_tr_b16 a[192:193], v8 offset:24576
    v_and_b32 v21, 0xffff0000, v27
    v_mfma_f32_16x16x32_bf16 v[96:99], a[200:203], a[96:99], v[96:99]
    buffer_load_dwordx4 a[80:83], v14, s[20:23], s37 offen offset:0 sc1
    v_mfma_f32_16x16x32_bf16 v[100:103], a[204:207], a[96:99], v[100:103]
    ds_read_b64_tr_b16 a[194:195], v8 offset:26624
    v_sub_f32 v20, v20, v16
    v_mfma_f32_16x16x32_bf16 v[108:111], a[204:207], a[100:103], v[108:111]
    s_add_u32 s38, s47, 163840
    ds_read_b64_tr_b16 a[196:197], v9 offset:24576
    v_sub_f32 v21, v21, v16
    v_mfma_f32_16x16x32_bf16 v[104:107], a[200:203], a[100:103], v[104:107]
    ds_read_b64_tr_b16 a[198:199], v9 offset:26624
    v_cvt_pk_bf16_f32 v22, v20, v21
    v_mfma_f32_16x16x32_bf16 v[112:115], a[200:203], a[104:107], v[112:115]
    s_add_u32 m0, s63, 32768
    v_lshlrev_b32 v20, 16, v22
    v_and_b32 v21, 0xffff0000, v22
    v_mfma_f32_16x16x32_bf16 v[116:119], a[204:207], a[104:107], v[116:119]
    buffer_load_dwordx4 a[84:87], v14, s[20:23], s37 offen offset:1024 sc1
    v_mfma_f32_16x16x32_bf16 v[124:127], a[204:207], a[108:111], v[124:127]
    s_waitcnt lgkmcnt(3)
    ds_read_b64_tr_b16 a[204:205], v11 offset:24576
    v_mul_f32 v20, v20, v17
    v_mfma_f32_16x16x32_bf16 v[120:123], a[200:203], a[108:111], v[120:123]
    ds_read_b64_tr_b16 a[206:207], v11 offset:26624
    v_mul_f32 v21, v21, v17
    v_mfma_f32_16x16x32_bf16 v[152:155], a[208:211], a[108:111], v[152:155]
    ds_read_b64_tr_b16 a[200:201], v10 offset:24576
    v_cvt_pk_bf16_f32 v22, v20, v21
    v_mfma_f32_16x16x32_bf16 v[156:159], a[212:215], a[108:111], v[156:159]
    ds_read_b64_tr_b16 a[202:203], v10 offset:26624
    v_lshlrev_b32 v20, 16, v22
    v_mfma_f32_16x16x32_bf16 v[148:151], a[212:215], a[104:107], v[148:151]
    buffer_load_dwordx4 a[88:91], v14, s[20:23], s37 offen offset:2048 sc1
    v_mfma_f32_16x16x32_bf16 v[144:147], a[208:211], a[104:107], v[144:147]
    buffer_load_dwordx4 v2, s[8:11], s38 offen lds
    v_mfma_f32_16x16x32_bf16 v[136:139], a[208:211], a[100:103], v[136:139]
    v_and_b32 v21, 0xffff0000, v22
    v_mul_f32 v23, s92, v20
    v_mfma_f32_16x16x32_bf16 v[140:143], a[212:215], a[100:103], v[140:143]
    v_exp_f32 v23, v23
    v_mfma_f32_16x16x32_bf16 v[132:135], a[212:215], a[96:99], v[132:135]
    ds_read_b64_tr_b16 a[212:213], v13 offset:22528
    v_mul_f32 v92, s92, v21
    v_mfma_f32_16x16x32_bf16 v[128:131], a[208:211], a[96:99], v[128:131]
    buffer_load_dwordx4 a[92:95], v14, s[20:23], s37 offen offset:3072 sc1
    v_mfma_f32_16x16x32_bf16 v[160:163], a[184:187], a[96:99], v[160:163]
    s_add_u32 s38, s45, 204800
    ds_read_b64_tr_b16 a[214:215], v13 offset:23552
    v_add_f32 v23, 1.0, v23
    v_mfma_f32_16x16x32_bf16 v[164:167], a[188:191], a[96:99], v[164:167]
    ds_read_b64_tr_b16 a[208:209], v12 offset:22528
    v_mfma_f32_16x16x32_bf16 v[172:175], a[188:191], a[100:103], v[172:175]
    s_add_u32 m0, s63, 36864
    ds_read_b64_tr_b16 a[210:211], v12 offset:23552
    v_mfma_f32_16x16x32_bf16 v[168:171], a[184:187], a[100:103], v[168:171]
    s_waitcnt lgkmcnt(4)
    v_exp_f32 v92, v92
    v_mfma_f32_16x16x32_bf16 v[176:179], a[184:187], a[104:107], v[176:179]
    v_rcp_f32 v23, v23
    v_mfma_f32_16x16x32_bf16 v[180:183], a[188:191], a[104:107], v[180:183]
    v_permlane16_swap_b32 v28, v30
    v_mfma_f32_16x16x32_bf16 v[188:191], a[188:191], a[108:111], v[188:191]
    v_permlane16_swap_b32 v29, v31
    v_mfma_f32_16x16x32_bf16 v[184:187], a[184:187], a[108:111], v[184:187]
    ds_read_b64_tr_b16 a[184:185], v8 offset:28672
    v_add_f32 v92, 1.0, v92
    v_mfma_f32_16x16x32_bf16 v[216:219], a[192:195], a[108:111], v[216:219]
    buffer_load_dwordx4 v2, s[8:11], s38 offen lds
    v_mfma_f32_16x16x32_bf16 v[220:223], a[196:199], a[108:111], v[220:223]
    ds_read_b64_tr_b16 a[186:187], v8 offset:30720
    v_mul_f32 v20, v20, v23
    v_mfma_f32_16x16x32_bf16 v[212:215], a[196:199], a[104:107], v[212:215]
    ds_read_b64_tr_b16 a[188:189], v9 offset:28672
    v_mfma_f32_16x16x32_bf16 v[208:211], a[192:195], a[104:107], v[208:211]
    ds_read_b64_tr_b16 a[190:191], v9 offset:30720
    v_mfma_f32_16x16x32_bf16 v[200:203], a[192:195], a[100:103], v[200:203]
    v_rcp_f32 v92, v92
    v_mfma_f32_16x16x32_bf16 v[204:207], a[196:199], a[100:103], v[204:207]
    v_mul_f32 v21, v21, v92
    v_cvt_pk_bf16_f32 v43, v20, v21
    v_mfma_f32_16x16x32_bf16 v[196:199], a[196:199], a[96:99], v[196:199]
    s_add_u32 s38, s46, 204800
    ds_read_b64_tr_b16 a[196:197], v11 offset:28672
    v_lshlrev_b32 v20, 16, v28
    v_mfma_f32_16x16x32_bf16 v[192:195], a[192:195], a[96:99], v[192:195]
    ds_read_b64_tr_b16 a[198:199], v11 offset:30720
    v_and_b32 v21, 0xffff0000, v28
    v_mfma_f32_16x16x32_bf16 v[224:227], a[200:203], a[96:99], v[224:227]
    s_add_u32 m0, s63, 40960
    ds_read_b64_tr_b16 a[192:193], v10 offset:28672
    v_sub_f32 v20, v20, v18
    v_mfma_f32_16x16x32_bf16 v[228:231], a[204:207], a[96:99], v[228:231]
    s_waitcnt lgkmcnt(4)
    ds_read_b64_tr_b16 a[194:195], v10 offset:30720
    v_sub_f32 v21, v21, v18
    v_mfma_f32_16x16x32_bf16 v[236:239], a[204:207], a[100:103], v[236:239]
    s_add_u32 s37, s61, 20480
    v_cvt_pk_bf16_f32 v22, v20, v21
    v_lshlrev_b32 v20, 16, v22
    v_mfma_f32_16x16x32_bf16 v[232:235], a[200:203], a[100:103], v[232:235]
    v_and_b32 v21, 0xffff0000, v22
    v_mul_f32 v20, v20, v19
    v_mfma_f32_16x16x32_bf16 v[240:243], a[200:203], a[104:107], v[240:243]
    v_mul_f32 v21, v21, v19
    v_cvt_pk_bf16_f32 v22, v20, v21
    v_mfma_f32_16x16x32_bf16 v[244:247], a[204:207], a[104:107], v[244:247]
    v_lshlrev_b32 v20, 16, v22
    v_and_b32 v21, 0xffff0000, v22
    v_mfma_f32_16x16x32_bf16 v[252:255], a[204:207], a[108:111], v[252:255]
    buffer_load_dwordx4 v2, s[8:11], s38 offen lds
    v_mfma_f32_16x16x32_bf16 v[248:251], a[200:203], a[108:111], v[248:251]
    ds_read_b64_tr_b16 a[200:201], v8 offset:32768
    v_mul_f32 v23, s92, v20
    v_mfma_f32_16x16x32_bf16 v[120:123], a[208:211], a[124:127], v[120:123]
    buffer_load_dwordx4 a[96:99], v14, s[20:23], s37 offen offset:0 sc1
    v_mfma_f32_16x16x32_bf16 v[124:127], a[212:215], a[124:127], v[124:127]
    ds_read_b64_tr_b16 a[202:203], v8 offset:34816
    v_mul_f32 v92, s92, v21
    v_mfma_f32_16x16x32_bf16 v[116:119], a[212:215], a[120:123], v[116:119]
    ds_read_b64_tr_b16 a[204:205], v9 offset:32768
    v_mfma_f32_16x16x32_bf16 v[112:115], a[208:211], a[120:123], v[112:115]
    ds_read_b64_tr_b16 a[206:207], v9 offset:34816
    v_mfma_f32_16x16x32_bf16 v[104:107], a[208:211], a[116:119], v[104:107]
    s_add_u32 s38, s47, 204800
    v_exp_f32 v23, v23
    v_mfma_f32_16x16x32_bf16 v[108:111], a[212:215], a[116:119], v[108:111]
    buffer_load_dwordx4 a[100:103], v14, s[20:23], s37 offen offset:1024 sc1
    v_mfma_f32_16x16x32_bf16 v[100:103], a[212:215], a[112:115], v[100:103]
    s_waitcnt lgkmcnt(3)
    ds_read_b64_tr_b16 a[212:213], v11 offset:32768
    v_add_f32 v23, 1.0, v23
    v_mfma_f32_16x16x32_bf16 v[96:99], a[208:211], a[112:115], v[96:99]
    s_add_u32 m0, s63, 45056
    ds_read_b64_tr_b16 a[214:215], v11 offset:34816
    v_mfma_f32_16x16x32_bf16 v[128:131], a[184:187], a[112:115], v[128:131]
    ds_read_b64_tr_b16 a[208:209], v10 offset:32768
    v_mfma_f32_16x16x32_bf16 v[132:135], a[188:191], a[112:115], v[132:135]
    ds_read_b64_tr_b16 a[210:211], v10 offset:34816
    v_mfma_f32_16x16x32_bf16 v[140:143], a[188:191], a[116:119], v[140:143]
    buffer_load_dwordx4 a[104:107], v14, s[20:23], s37 offen offset:2048 sc1
    v_mfma_f32_16x16x32_bf16 v[136:139], a[184:187], a[116:119], v[136:139]
    v_exp_f32 v92, v92
    v_mfma_f32_16x16x32_bf16 v[144:147], a[184:187], a[120:123], v[144:147]
    buffer_load_dwordx4 v2, s[8:11], s38 offen lds
    v_mfma_f32_16x16x32_bf16 v[148:151], a[188:191], a[120:123], v[148:151]
    v_rcp_f32 v23, v23
    v_mfma_f32_16x16x32_bf16 v[156:159], a[188:191], a[124:127], v[156:159]
    v_add_f32 v92, 1.0, v92
    v_mul_f32 v20, v20, v23
    v_mfma_f32_16x16x32_bf16 v[152:155], a[184:187], a[124:127], v[152:155]
    buffer_load_dwordx4 a[108:111], v14, s[20:23], s37 offen offset:3072 sc1
    v_mfma_f32_16x16x32_bf16 v[184:187], a[192:195], a[124:127], v[184:187]
    v_rcp_f32 v92, v92
    v_mfma_f32_16x16x32_bf16 v[188:191], a[196:199], a[124:127], v[188:191]
    s_waitcnt lgkmcnt(0)
    v_mul_f32 v21, v21, v92
    v_cvt_pk_bf16_f32 v44, v20, v21
    v_mfma_f32_16x16x32_bf16 v[180:183], a[196:199], a[120:123], v[180:183]
    s_barrier
    v_mfma_f32_16x16x32_bf16 v[176:179], a[192:195], a[120:123], v[176:179]
    ds_read_b64_tr_b16 a[184:185], v12 offset:49152
    v_lshlrev_b32 v20, 16, v29
    v_mfma_f32_16x16x32_bf16 v[168:171], a[192:195], a[116:119], v[168:171]
    ds_read_b64_tr_b16 a[186:187], v12 offset:50176
    v_and_b32 v21, 0xffff0000, v29
    v_mfma_f32_16x16x32_bf16 v[172:175], a[196:199], a[116:119], v[172:175]
    ds_read_b64_tr_b16 a[188:189], v12 offset:51200
    v_sub_f32 v20, v20, v18
    v_mfma_f32_16x16x32_bf16 v[164:167], a[196:199], a[112:115], v[164:167]
    ds_read_b64_tr_b16 a[190:191], v12 offset:52224
    v_sub_f32 v21, v21, v18
    v_mfma_f32_16x16x32_bf16 v[160:163], a[192:195], a[112:115], v[160:163]
    ds_read_b64_tr_b16 a[192:193], v13 offset:49152
    v_cvt_pk_bf16_f32 v22, v20, v21
    v_mfma_f32_16x16x32_bf16 v[192:195], a[200:203], a[112:115], v[192:195]
    ds_read_b64_tr_b16 a[194:195], v13 offset:50176
    v_lshlrev_b32 v20, 16, v22
    v_mfma_f32_16x16x32_bf16 v[196:199], a[204:207], a[112:115], v[196:199]
    ds_read_b64_tr_b16 a[196:197], v13 offset:51200
    v_and_b32 v21, 0xffff0000, v22
    v_mfma_f32_16x16x32_bf16 v[204:207], a[204:207], a[116:119], v[204:207]
    ds_read_b64_tr_b16 a[198:199], v13 offset:52224
    v_mul_f32 v20, v20, v19
    v_mfma_f32_16x16x32_bf16 v[200:203], a[200:203], a[116:119], v[200:203]
    v_mul_f32 v21, v21, v19
    v_cvt_pk_bf16_f32 v22, v20, v21
    v_mfma_f32_16x16x32_bf16 v[208:211], a[200:203], a[120:123], v[208:211]
    v_lshlrev_b32 v20, 16, v22
    v_and_b32 v21, 0xffff0000, v22
    v_mfma_f32_16x16x32_bf16 v[212:215], a[204:207], a[120:123], v[212:215]
    v_mul_f32 v23, s92, v20
    v_mul_f32 v92, s92, v21
    v_mfma_f32_16x16x32_bf16 v[220:223], a[204:207], a[124:127], v[220:223]
    v_exp_f32 v23, v23
    v_mfma_f32_16x16x32_bf16 v[216:219], a[200:203], a[124:127], v[216:219]
    ds_read_b64_tr_b16 a[200:201], v12 offset:53248
    v_add_f32 v23, 1.0, v23
    v_mfma_f32_16x16x32_bf16 v[248:251], a[208:211], a[124:127], v[248:251]
    ds_read_b64_tr_b16 a[202:203], v12 offset:54272
    v_mfma_f32_16x16x32_bf16 v[252:255], a[212:215], a[124:127], v[252:255]
    ds_read_b64_tr_b16 a[204:205], v12 offset:55296
    v_mfma_f32_16x16x32_bf16 v[244:247], a[212:215], a[120:123], v[244:247]
    s_waitcnt lgkmcnt(3)
    ds_read_b64_tr_b16 a[206:207], v12 offset:56320
    v_mfma_f32_16x16x32_bf16 v[240:243], a[208:211], a[120:123], v[240:243]
    v_exp_f32 v92, v92
    v_mfma_f32_16x16x32_bf16 v[232:235], a[208:211], a[116:119], v[232:235]
    v_rcp_f32 v23, v23
    v_mfma_f32_16x16x32_bf16 v[236:239], a[212:215], a[116:119], v[236:239]
    v_add_f32 v92, 1.0, v92
    v_mul_f32 v20, v20, v23
    v_mfma_f32_16x16x32_bf16 v[228:231], a[212:215], a[112:115], v[228:231]
    v_rcp_f32 v92, v92
    v_mfma_f32_16x16x32_bf16 v[224:227], a[208:211], a[112:115], v[224:227]
    ds_read_b64_tr_b16 a[208:209], v13 offset:53248
    v_mul_f32 v21, v21, v92
    v_mfma_f32_16x16x32_bf16 v[96:99], a[184:187], a[128:131], v[96:99]
    ds_read_b64_tr_b16 a[210:211], v13 offset:54272
    v_cvt_pk_bf16_f32 v45, v20, v21
    v_mfma_f32_16x16x32_bf16 v[96:99], a[188:191], a[0:3], v[96:99]
    ds_read_b64_tr_b16 a[212:213], v13 offset:55296
    v_lshlrev_b32 v20, 16, v30
    v_mfma_f32_16x16x32_bf16 v[104:107], a[188:191], a[4:7], v[104:107]
    ds_read_b64_tr_b16 a[214:215], v13 offset:56320
    v_and_b32 v21, 0xffff0000, v30
    v_mfma_f32_16x16x32_bf16 v[104:107], a[184:187], a[132:135], v[104:107]
    v_sub_f32 v20, v20, v18
    v_sub_f32 v21, v21, v18
    v_mfma_f32_16x16x32_bf16 v[112:115], a[184:187], a[136:139], v[112:115]
    v_cvt_pk_bf16_f32 v22, v20, v21
    v_lshlrev_b32 v20, 16, v22
    v_mfma_f32_16x16x32_bf16 v[112:115], a[188:191], a[8:11], v[112:115]
    v_and_b32 v21, 0xffff0000, v22
    v_mul_f32 v20, v20, v19
    v_mfma_f32_16x16x32_bf16 v[120:123], a[188:191], a[12:15], v[120:123]
    v_mul_f32 v21, v21, v19
    v_cvt_pk_bf16_f32 v22, v20, v21
    v_mfma_f32_16x16x32_bf16 v[120:123], a[184:187], a[140:143], v[120:123]
    ds_read_b64_tr_b16 a[184:185], v12 offset:57344
    v_lshlrev_b32 v20, 16, v22
    v_mfma_f32_16x16x32_bf16 v[124:127], a[192:195], a[140:143], v[124:127]
    ds_read_b64_tr_b16 a[186:187], v12 offset:58368
    v_and_b32 v21, 0xffff0000, v22
    v_mfma_f32_16x16x32_bf16 v[124:127], a[196:199], a[12:15], v[124:127]
    ds_read_b64_tr_b16 a[188:189], v12 offset:59392
    v_mul_f32 v23, s92, v20
    v_mfma_f32_16x16x32_bf16 v[116:119], a[196:199], a[8:11], v[116:119]
    s_waitcnt lgkmcnt(3)
    ds_read_b64_tr_b16 a[190:191], v12 offset:60416
    v_mul_f32 v92, s92, v21
    v_mfma_f32_16x16x32_bf16 v[116:119], a[192:195], a[136:139], v[116:119]
    s_add_u32 s38, s45, 81920
    v_exp_f32 v23, v23
    v_mfma_f32_16x16x32_bf16 v[108:111], a[192:195], a[132:135], v[108:111]
    s_add_u32 m0, s63, 135168
    v_exp_f32 v92, v92
    v_mfma_f32_16x16x32_bf16 v[108:111], a[196:199], a[4:7], v[108:111]
    s_mul_i32 s60, s54, 20
    v_add_f32 v23, 1.0, v23
    v_add_f32 v92, 1.0, v92
    v_mfma_f32_16x16x32_bf16 v[100:103], a[196:199], a[0:3], v[100:103]
    s_mul_i32 s56, s51, 5
    v_rcp_f32 v23, v23
    v_mfma_f32_16x16x32_bf16 v[100:103], a[192:195], a[128:131], v[100:103]
    s_add_u32 s60, s60, s56
    ds_read_b64_tr_b16 a[192:193], v13 offset:57344
    v_mul_f32 v20, v20, v23
    v_mfma_f32_16x16x32_bf16 v[96:99], a[200:203], a[16:19], v[96:99]
    s_lshl_b32 s60, s60, 1
    ds_read_b64_tr_b16 a[194:195], v13 offset:58368
    v_mfma_f32_16x16x32_bf16 v[96:99], a[204:207], a[32:35], v[96:99]
    s_and_b32 s56, s53, 1
    ds_read_b64_tr_b16 a[196:197], v13 offset:59392
    v_mfma_f32_16x16x32_bf16 v[104:107], a[204:207], a[36:39], v[104:107]
pg_14:
    s_cbranch_execz pg_back
    buffer_load_dwordx4 v3, s[8:11], s38 offen lds
    v_mfma_f32_16x16x32_bf16 v[104:107], a[200:203], a[20:23], v[104:107]
    s_add_u32 s60, s60, s56
    ds_read_b64_tr_b16 a[198:199], v13 offset:60416
    v_mfma_f32_16x16x32_bf16 v[112:115], a[200:203], a[24:27], v[112:115]
    s_lshl_b32 s60, s60, 11
    v_rcp_f32 v92, v92
    v_mfma_f32_16x16x32_bf16 v[112:115], a[204:207], a[40:43], v[112:115]
    s_add_u32 s37, s60, 50331648
    v_mul_f32 v21, v21, v92
    v_cvt_pk_bf16_f32 v46, v20, v21
    v_mfma_f32_16x16x32_bf16 v[120:123], a[204:207], a[44:47], v[120:123]
    s_add_u32 s38, s46, 81920
    v_lshlrev_b32 v20, 16, v31
    v_and_b32 v21, 0xffff0000, v31
    v_mfma_f32_16x16x32_bf16 v[120:123], a[200:203], a[28:31], v[120:123]
    s_xor_b32 s59, s60, 2048
    ds_read_b64_tr_b16 a[200:201], v12 offset:61440
    v_sub_f32 v20, v20, v18
    v_mfma_f32_16x16x32_bf16 v[124:127], a[208:211], a[28:31], v[124:127]
    s_add_u32 m0, s63, 131072
    ds_read_b64_tr_b16 a[202:203], v12 offset:62464
    v_sub_f32 v21, v21, v18
    v_mfma_f32_16x16x32_bf16 v[124:127], a[212:215], a[44:47], v[124:127]
    s_mul_i32 s57, s53, 2622464
    ds_read_b64_tr_b16 a[204:205], v12 offset:63488
    v_cvt_pk_bf16_f32 v22, v20, v21
    v_mfma_f32_16x16x32_bf16 v[116:119], a[212:215], a[40:43], v[116:119]
    s_waitcnt lgkmcnt(3)
    ds_read_b64_tr_b16 a[206:207], v12 offset:64512
    v_lshlrev_b32 v20, 16, v22
    v_mfma_f32_16x16x32_bf16 v[116:119], a[208:211], a[24:27], v[116:119]
    s_add_u32 s57, s57, 50331648
    v_and_b32 v21, 0xffff0000, v22
    v_mul_f32 v20, v20, v19
    v_mfma_f32_16x16x32_bf16 v[108:111], a[208:211], a[20:23], v[108:111]
    s_add_u32 s59, s59, s57
    v_mul_f32 v21, v21, v19
    v_cvt_pk_bf16_f32 v22, v20, v21
    v_mfma_f32_16x16x32_bf16 v[108:111], a[212:215], a[36:39], v[108:111]
    s_add_u32 s60, s60, s57
    v_lshlrev_b32 v20, 16, v22
    v_and_b32 v21, 0xffff0000, v22
    v_mfma_f32_16x16x32_bf16 v[100:103], a[212:215], a[32:35], v[100:103]
    buffer_load_dwordx4 v3, s[8:11], s38 offen lds
    v_mfma_f32_16x16x32_bf16 v[100:103], a[208:211], a[16:19], v[100:103]
    s_andn2_b32 s61, s2, 7
    ds_read_b64_tr_b16 a[208:209], v13 offset:61440
    v_mul_f32 v23, s92, v20
    v_mfma_f32_16x16x32_bf16 v[96:99], a[184:187], a[48:51], v[96:99]
    s_lshl_b32 s61, s61, 2
    ds_read_b64_tr_b16 a[210:211], v13 offset:62464
    v_mul_f32 v92, s92, v21
    v_mfma_f32_16x16x32_bf16 v[96:99], a[188:191], a[64:67], v[96:99]
    s_add_u32 s61, s61, s3
    ds_read_b64_tr_b16 a[212:213], v13 offset:63488
    v_add_u32 v12, 65536, v12
    v_mfma_f32_16x16x32_bf16 v[104:107], a[188:191], a[68:71], v[104:107]
    s_add_u32 s38, s47, 81920
    ds_read_b64_tr_b16 a[214:215], v13 offset:64512
    v_xor_b32 v7, s56, v1
    v_mfma_f32_16x16x32_bf16 v[104:107], a[184:187], a[52:55], v[104:107]
    s_lshl_b32 s61, s61, 7
    v_exp_f32 v23, v23
    v_mfma_f32_16x16x32_bf16 v[112:115], a[184:187], a[56:59], v[112:115]
    s_add_u32 m0, s63, 126976
    v_exp_f32 v92, v92
    v_mfma_f32_16x16x32_bf16 v[112:115], a[188:191], a[72:75], v[112:115]
    s_add_u32 s61, s61, 4194304
    v_permlane16_swap_b32 v32, v34
    v_mfma_f32_16x16x32_bf16 v[120:123], a[188:191], a[76:79], v[120:123]
    v_permlane16_swap_b32 v33, v35
    v_mfma_f32_16x16x32_bf16 v[120:123], a[184:187], a[60:63], v[120:123]
    ds_read_b64_tr_b16 a[184:185], v12 offset:0
    v_add_f32 v23, 1.0, v23
    v_mfma_f32_16x16x32_bf16 v[124:127], a[192:195], a[60:63], v[124:127]
    ds_read_b64_tr_b16 a[186:187], v12 offset:1024
    v_add_f32 v92, 1.0, v92
    v_mfma_f32_16x16x32_bf16 v[124:127], a[196:199], a[76:79], v[124:127]
    ds_read_b64_tr_b16 a[188:189], v12 offset:2048
    v_lshlrev_b32 v7, 2, v7
    v_mfma_f32_16x16x32_bf16 v[116:119], a[196:199], a[72:75], v[116:119]
    s_waitcnt lgkmcnt(3)
    ds_read_b64_tr_b16 a[190:191], v12 offset:3072
    v_lshl_add_u32 v7, v1, 9, v7
    v_mfma_f32_16x16x32_bf16 v[116:119], a[192:195], a[56:59], v[116:119]
    buffer_load_dwordx4 v3, s[8:11], s38 offen lds
    v_mfma_f32_16x16x32_bf16 v[108:111], a[192:195], a[52:55], v[108:111]
    v_rcp_f32 v23, v23
    v_mfma_f32_16x16x32_bf16 v[108:111], a[196:199], a[68:71], v[108:111]
    v_rcp_f32 v92, v92
    v_mfma_f32_16x16x32_bf16 v[100:103], a[196:199], a[64:67], v[100:103]
    s_waitcnt vmcnt(35)
    v_mul_f32 v20, v20, v23
    v_mul_f32 v21, v21, v92
    v_mfma_f32_16x16x32_bf16 v[100:103], a[192:195], a[48:51], v[100:103]
    s_waitcnt vmcnt(34)
    v_cvt_pk_bf16_f32 v47, v20, v21
    v_lshlrev_b32 v20, 16, v32
    v_mfma_f32_16x16x32_bf16 v[96:99], a[200:203], a[216:219], v[96:99]
    s_add_u32 s38, s45, 122880
    v_and_b32 v21, 0xffff0000, v32
    v_sub_f32 v20, v20, v16
    v_mfma_f32_16x16x32_bf16 v[96:99], a[204:207], a[232:235], v[96:99]
    s_add_u32 m0, s63, 122880
    v_sub_f32 v21, v21, v16
    v_cvt_pk_bf16_f32 v22, v20, v21
    v_mfma_f32_16x16x32_bf16 v[104:107], a[204:207], a[236:239], v[104:107]
    s_waitcnt vmcnt(33)
    v_lshlrev_b32 v20, 16, v22
    v_and_b32 v21, 0xffff0000, v22
    v_mfma_f32_16x16x32_bf16 v[104:107], a[200:203], a[220:223], v[104:107]
    s_waitcnt vmcnt(32)
    v_mul_f32 v20, v20, v17
    v_mul_f32 v21, v21, v17
    v_mfma_f32_16x16x32_bf16 v[112:115], a[200:203], a[224:227], v[112:115]
    v_cvt_pk_bf16_f32 v22, v20, v21
    v_lshlrev_b32 v20, 16, v22
    v_mfma_f32_16x16x32_bf16 v[112:115], a[204:207], a[240:243], v[112:115]
    v_and_b32 v21, 0xffff0000, v22
    v_mul_f32 v23, s92, v20
    v_mfma_f32_16x16x32_bf16 v[120:123], a[204:207], a[244:247], v[120:123]
    buffer_load_dwordx4 v3, s[8:11], s38 offen lds
    v_mfma_f32_16x16x32_bf16 v[120:123], a[200:203], a[228:231], v[120:123]
    ds_read_b64_tr_b16 a[200:201], v12 offset:4096
    v_mul_f32 v92, s92, v21
    v_mfma_f32_16x16x32_bf16 v[124:127], a[208:211], a[228:231], v[124:127]
    ds_read_b64_tr_b16 a[202:203], v12 offset:5120
    v_lshrrev_b32 v88, 1, v1
    v_mfma_f32_16x16x32_bf16 v[124:127], a[212:215], a[244:247], v[124:127]
    ds_read_b64_tr_b16 a[204:205], v12 offset:6144
    v_min_u32 v88, 1, v88
    v_mfma_f32_16x16x32_bf16 v[116:119], a[212:215], a[240:243], v[116:119]
    s_add_u32 s38, s46, 122880
    ds_read_b64_tr_b16 a[206:207], v12 offset:7168
    v_lshl_or_b32 v7, v88, 30, v7
    v_mfma_f32_16x16x32_bf16 v[116:119], a[208:211], a[224:227], v[116:119]
    v_exp_f32 v23, v23
    v_mfma_f32_16x16x32_bf16 v[108:111], a[208:211], a[220:223], v[108:111]
    s_add_u32 m0, s63, 118784
    v_exp_f32 v92, v92
    v_mfma_f32_16x16x32_bf16 v[108:111], a[212:215], a[236:239], v[108:111]
    s_waitcnt vmcnt(30) lgkmcnt(4)
    v_add_f32 v23, 1.0, v23
    v_add_f32 v92, 1.0, v92
    v_mfma_f32_16x16x32_bf16 v[100:103], a[212:215], a[232:235], v[100:103]
    s_waitcnt vmcnt(22)
    v_rcp_f32 v23, v23
    v_add_u32 v13, 65536, v13
    v_mfma_f32_16x16x32_bf16 v[100:103], a[208:211], a[216:219], v[100:103]
    s_waitcnt vmcnt(21)
    ds_read_b64_tr_b16 a[192:193], v13 offset:0
    v_mul_f32 v20, v20, v23
    v_mfma_f32_16x16x32_bf16 v[96:99], a[184:187], a[152:155], v[96:99]
    ds_read_b64_tr_b16 a[194:195], v13 offset:1024
    v_mfma_f32_16x16x32_bf16 v[96:99], a[188:191], a[168:171], v[96:99]
    ds_read_b64_tr_b16 a[196:197], v13 offset:2048
    v_mfma_f32_16x16x32_bf16 v[104:107], a[188:191], a[172:175], v[104:107]
    s_waitcnt vmcnt(19)
    ds_read_b64_tr_b16 a[198:199], v13 offset:3072
    v_mfma_f32_16x16x32_bf16 v[104:107], a[184:187], a[156:159], v[104:107]
    buffer_load_dwordx4 v3, s[8:11], s38 offen lds
    v_mfma_f32_16x16x32_bf16 v[112:115], a[184:187], a[160:163], v[112:115]
    s_waitcnt vmcnt(19)
    ds_read_b64_tr_b16 a[208:209], v13 offset:4096
    v_mfma_f32_16x16x32_bf16 v[112:115], a[188:191], a[176:179], v[112:115]
    ds_read_b64_tr_b16 a[210:211], v13 offset:5120
    v_mfma_f32_16x16x32_bf16 v[120:123], a[188:191], a[180:183], v[120:123]
    s_add_u32 s38, s47, 122880
    ds_read_b64_tr_b16 a[212:213], v13 offset:6144
    v_mfma_f32_16x16x32_bf16 v[120:123], a[184:187], a[164:167], v[120:123]
    s_waitcnt lgkmcnt(5)
    ds_read_b64_tr_b16 a[214:215], v13 offset:7168
    v_mfma_f32_16x16x32_bf16 v[124:127], a[192:195], a[164:167], v[124:127]
    s_waitcnt lgkmcnt(4)
    v_rcp_f32 v92, v92
    v_mfma_f32_16x16x32_bf16 v[124:127], a[196:199], a[180:183], v[124:127]
    s_add_u32 m0, s63, 114688
    v_mul_f32 v21, v21, v92
    v_cvt_pk_bf16_f32 v48, v20, v21
    v_mfma_f32_16x16x32_bf16 v[116:119], a[196:199], a[176:179], v[116:119]
    s_barrier
    v_mfma_f32_16x16x32_bf16 v[116:119], a[192:195], a[160:163], v[116:119]
    v_lshlrev_b32 v20, 16, v33
    v_and_b32 v21, 0xffff0000, v33
    v_mfma_f32_16x16x32_bf16 v[108:111], a[192:195], a[156:159], v[108:111]
    v_sub_f32 v20, v20, v16
    v_sub_f32 v21, v21, v16
    v_mfma_f32_16x16x32_bf16 v[108:111], a[196:199], a[172:175], v[108:111]
    s_waitcnt vmcnt(16)
    v_cvt_pk_bf16_f32 v22, v20, v21
    v_lshlrev_b32 v20, 16, v22
    v_mfma_f32_16x16x32_bf16 v[100:103], a[196:199], a[168:171], v[100:103]
    buffer_load_dwordx4 v3, s[8:11], s38 offen lds
    v_mfma_f32_16x16x32_bf16 v[100:103], a[192:195], a[152:155], v[100:103]
    s_waitcnt vmcnt(9)
    v_and_b32 v21, 0xffff0000, v22
    v_mul_f32 v20, v20, v17
    v_mfma_f32_16x16x32_bf16 v[96:99], a[200:203], a[80:83], v[96:99]
    v_mul_f32 v21, v21, v17
    v_cvt_pk_bf16_f32 v22, v20, v21
    v_mfma_f32_16x16x32_bf16 v[96:99], a[204:207], a[96:99], v[96:99]
    v_lshlrev_b32 v20, 16, v22
    v_and_b32 v21, 0xffff0000, v22
    v_mfma_f32_16x16x32_bf16 v[104:107], a[204:207], a[100:103], v[104:107]
    s_waitcnt vmcnt(8)
    v_mul_f32 v23, s92, v20
    v_mul_f32 v92, s92, v21
    v_mfma_f32_16x16x32_bf16 v[104:107], a[200:203], a[84:87], v[104:107]
    s_waitcnt vmcnt(6)
    v_cvt_pk_bf16_f32 v96, v96, v97
    v_cvt_pk_bf16_f32 v97, v98, v99
    v_mfma_f32_16x16x32_bf16 v[112:115], a[200:203], a[88:91], v[112:115]
    s_add_u32 s38, s45, 163840
    v_exp_f32 v23, v23
    v_mfma_f32_16x16x32_bf16 v[112:115], a[204:207], a[104:107], v[112:115]
    s_waitcnt lgkmcnt(0)
    v_cvt_pk_bf16_f32 v104, v104, v105
    v_cvt_pk_bf16_f32 v105, v106, v107
    v_mfma_f32_16x16x32_bf16 v[120:123], a[204:207], a[108:111], v[120:123]
    s_add_u32 m0, s63, 110592
    v_exp_f32 v92, v92
    v_mfma_f32_16x16x32_bf16 v[120:123], a[200:203], a[92:95], v[120:123]
    s_add_u32 s78, s59, 16384
    v_add_f32 v23, 1.0, v23
    v_add_f32 v92, 1.0, v92
    v_subrev_u32 v8, 73728, v8
    v_mfma_f32_16x16x32_bf16 v[124:127], a[208:211], a[92:95], v[124:127]
    s_and_b32 s56, s66, 0x70000000
    ds_read_b64_tr_b16 a[184:185], v8 offset:0
    v_subrev_u32 v9, 73728, v9
    v_mfma_f32_16x16x32_bf16 v[124:127], a[212:215], a[108:111], v[124:127]
    s_add_u32 s79, s60, 16384
    ds_read_b64_tr_b16 a[186:187], v8 offset:2048
    ds_read_b64_tr_b16 a[188:189], v8 offset:4096
    v_mfma_f32_16x16x32_bf16 v[116:119], a[212:215], a[104:107], v[116:119]
    s_or_b32 s79, s79, s56
    ds_read_b64_tr_b16 a[190:191], v8 offset:6144
    v_mfma_f32_16x16x32_bf16 v[116:119], a[208:211], a[88:91], v[116:119]
    buffer_load_dwordx4 v3, s[8:11], s38 offen lds
    v_mfma_f32_16x16x32_bf16 v[108:111], a[208:211], a[84:87], v[108:111]
    s_xor_b32 s56, s50, s3
    ds_read_b64_tr_b16 a[192:193], v9 offset:0
    v_mfma_f32_16x16x32_bf16 v[108:111], a[212:215], a[100:103], v[108:111]
    s_lshl_b32 s56, s56, 3
    ds_read_b64_tr_b16 a[194:195], v9 offset:2048
    v_mfma_f32_16x16x32_bf16 v[100:103], a[212:215], a[96:99], v[100:103]
    s_add_u32 s38, s46, 163840
    ds_read_b64_tr_b16 a[196:197], v9 offset:4096
    v_mfma_f32_16x16x32_bf16 v[100:103], a[208:211], a[80:83], v[100:103]
    s_waitcnt lgkmcnt(5)
    ds_read_b64_tr_b16 a[198:199], v9 offset:6144
    v_cvt_pk_bf16_f32 v106, v108, v109
    v_mfma_f32_16x16x32_bf16 v[128:131], a[184:187], a[128:131], v[128:131]
    s_waitcnt lgkmcnt(4)
    ds_read_b64_tr_b16 a[200:201], v8 offset:8192
    v_cvt_pk_bf16_f32 v107, v110, v111
    v_mfma_f32_16x16x32_bf16 v[128:131], a[188:191], a[0:3], v[128:131]
    s_add_u32 m0, s63, 106496
    ds_read_b64_tr_b16 a[202:203], v8 offset:10240
    v_cvt_pk_bf16_f32 v98, v100, v101
    v_mfma_f32_16x16x32_bf16 v[136:139], a[188:191], a[4:7], v[136:139]
    s_add_u32 s77, s61, s56
    ds_read_b64_tr_b16 a[204:205], v8 offset:12288
    v_cvt_pk_bf16_f32 v99, v102, v103
    v_mfma_f32_16x16x32_bf16 v[136:139], a[184:187], a[132:135], v[136:139]
    buffer_store_dwordx4 v[96:99], v14, s[24:27], s78 offen offset:0 sc1
    v_cvt_pk_bf16_f32 v100, v112, v113
    v_mfma_f32_16x16x32_bf16 v[144:147], a[184:187], a[136:139], v[144:147]
    s_add_u32 s77, s77, s63
    ds_read_b64_tr_b16 a[206:207], v8 offset:14336
    v_cvt_pk_bf16_f32 v101, v114, v115
    v_mfma_f32_16x16x32_bf16 v[144:147], a[188:191], a[8:11], v[144:147]
    s_waitcnt lgkmcnt(5)
    ds_read_b64_tr_b16 a[208:209], v9 offset:8192
    v_cvt_pk_bf16_f32 v102, v116, v117
    v_mfma_f32_16x16x32_bf16 v[152:155], a[188:191], a[12:15], v[152:155]
    buffer_load_dwordx4 v3, s[8:11], s38 offen lds
    v_mfma_f32_16x16x32_bf16 v[152:155], a[184:187], a[140:143], v[152:155]
    buffer_store_dwordx4 v[104:107], v14, s[24:27], s78 offen offset:1024 sc1
    v_cvt_pk_bf16_f32 v103, v118, v119
    v_mfma_f32_16x16x32_bf16 v[156:159], a[192:195], a[140:143], v[156:159]
    s_waitcnt lgkmcnt(3)
    ds_read_b64_tr_b16 a[210:211], v9 offset:10240
    v_cvt_pk_bf16_f32 v108, v120, v121
    v_mfma_f32_16x16x32_bf16 v[156:159], a[196:199], a[12:15], v[156:159]
    s_lshl_b32 s56, s50, 12
    ds_read_b64_tr_b16 a[212:213], v9 offset:12288
    v_cvt_pk_bf16_f32 v109, v122, v123
    v_mfma_f32_16x16x32_bf16 v[148:151], a[196:199], a[8:11], v[148:151]
    s_add_u32 s38, s47, 163840
    ds_read_b64_tr_b16 a[214:215], v9 offset:14336
    v_cvt_pk_bf16_f32 v110, v124, v125
    v_mfma_f32_16x16x32_bf16 v[148:151], a[192:195], a[136:139], v[148:151]
    s_add_u32 s48, s37, s56
    ds_read_b64_tr_b16 a[184:185], v8 offset:16384
    v_cvt_pk_bf16_f32 v111, v126, v127
    v_mfma_f32_16x16x32_bf16 v[140:143], a[192:195], a[132:135], v[140:143]
    s_add_u32 m0, s63, 102400
    ds_read_b64_tr_b16 a[186:187], v8 offset:18432
    v_mfma_f32_16x16x32_bf16 v[140:143], a[196:199], a[4:7], v[140:143]
    ds_read_b64_tr_b16 a[188:189], v8 offset:20480
    v_mfma_f32_16x16x32_bf16 v[132:135], a[196:199], a[0:3], v[132:135]
    s_waitcnt lgkmcnt(6)
    ds_read_b64_tr_b16 a[190:191], v8 offset:22528
    v_mfma_f32_16x16x32_bf16 v[132:135], a[192:195], a[128:131], v[132:135]
    buffer_store_dwordx4 v[100:103], v14, s[24:27], s79 offen offset:0 sc1
    v_subrev_u32 v10, 73728, v10
    v_mfma_f32_16x16x32_bf16 v[128:131], a[200:203], a[16:19], v[128:131]
    ds_read_b64_tr_b16 a[192:193], v9 offset:16384
    v_mfma_f32_16x16x32_bf16 v[128:131], a[204:207], a[32:35], v[128:131]
    ds_read_b64_tr_b16 a[194:195], v9 offset:18432
    v_mfma_f32_16x16x32_bf16 v[136:139], a[204:207], a[36:39], v[136:139]
    buffer_load_dwordx4 v3, s[8:11], s38 offen lds
    v_mfma_f32_16x16x32_bf16 v[136:139], a[200:203], a[20:23], v[136:139]
    ds_read_b64_tr_b16 a[196:197], v9 offset:20480
    v_mfma_f32_16x16x32_bf16 v[144:147], a[200:203], a[24:27], v[144:147]
    ds_read_b64_tr_b16 a[198:199], v9 offset:22528
    v_mfma_f32_16x16x32_bf16 v[144:147], a[204:207], a[40:43], v[144:147]
    s_waitcnt lgkmcnt(4)
    v_rcp_f32 v23, v23
    v_mfma_f32_16x16x32_bf16 v[152:155], a[204:207], a[44:47], v[152:155]
    s_add_u32 s38, s45, 204800
    v_rcp_f32 v92, v92
    v_mfma_f32_16x16x32_bf16 v[152:155], a[200:203], a[28:31], v[152:155]
    buffer_store_dwordx4 v[108:111], v14, s[24:27], s79 offen offset:1024 sc1
    v_mul_f32 v20, v20, v23
    v_mfma_f32_16x16x32_bf16 v[156:159], a[208:211], a[28:31], v[156:159]
    s_add_u32 m0, s63, 98304
    v_mul_f32 v21, v21, v92
    v_cvt_pk_bf16_f32 v49, v20, v21
    v_mfma_f32_16x16x32_bf16 v[156:159], a[212:215], a[44:47], v[156:159]
    v_lshlrev_b32 v20, 16, v34
    v_and_b32 v21, 0xffff0000, v34
    v_mfma_f32_16x16x32_bf16 v[148:151], a[212:215], a[40:43], v[148:151]
    s_barrier
    v_mfma_f32_16x16x32_bf16 v[148:151], a[208:211], a[24:27], v[148:151]
    ds_read_b64_tr_b16 a[200:201], v8 offset:24576
    v_sub_f32 v20, v20, v16
    v_mfma_f32_16x16x32_bf16 v[140:143], a[208:211], a[20:23], v[140:143]
    ds_read_b64_tr_b16 a[202:203], v8 offset:26624
    v_sub_f32 v21, v21, v16
    v_mfma_f32_16x16x32_bf16 v[140:143], a[212:215], a[36:39], v[140:143]
    ds_read_b64_tr_b16 a[204:205], v8 offset:28672
    v_cvt_pk_bf16_f32 v22, v20, v21
    v_mfma_f32_16x16x32_bf16 v[132:135], a[212:215], a[32:35], v[132:135]
    buffer_load_dwordx4 v3, s[8:11], s38 offen lds
    v_mfma_f32_16x16x32_bf16 v[132:135], a[208:211], a[16:19], v[132:135]
    ds_read_b64_tr_b16 a[206:207], v8 offset:30720
    v_lshlrev_b32 v20, 16, v22
    v_mfma_f32_16x16x32_bf16 v[128:131], a[184:187], a[48:51], v[128:131]
    ds_read_b64_tr_b16 a[208:209], v9 offset:24576
    v_and_b32 v21, 0xffff0000, v22
    v_mfma_f32_16x16x32_bf16 v[128:131], a[188:191], a[64:67], v[128:131]
    ds_read_b64_tr_b16 a[210:211], v9 offset:26624
    v_mul_f32 v20, v20, v17
    v_mfma_f32_16x16x32_bf16 v[136:139], a[188:191], a[68:71], v[136:139]
    s_add_u32 s38, s46, 204800
    ds_read_b64_tr_b16 a[212:213], v9 offset:28672
    v_mul_f32 v21, v21, v17
    v_mfma_f32_16x16x32_bf16 v[136:139], a[184:187], a[52:55], v[136:139]
    s_waitcnt lgkmcnt(5)
    ds_read_b64_tr_b16 a[214:215], v9 offset:30720
    v_cvt_pk_bf16_f32 v22, v20, v21
    v_mfma_f32_16x16x32_bf16 v[144:147], a[184:187], a[56:59], v[144:147]
    s_add_u32 m0, s63, 94208
    v_lshlrev_b32 v20, 16, v22
    v_and_b32 v21, 0xffff0000, v22
    v_mfma_f32_16x16x32_bf16 v[144:147], a[188:191], a[72:75], v[144:147]
    v_mul_f32 v23, s92, v20
    v_mul_f32 v92, s92, v21
    v_mfma_f32_16x16x32_bf16 v[152:155], a[188:191], a[76:79], v[152:155]
    v_exp_f32 v23, v23
    v_mfma_f32_16x16x32_bf16 v[152:155], a[184:187], a[60:63], v[152:155]
    ds_read_b64_tr_b16 a[184:185], v8 offset:32768
    v_add_f32 v23, 1.0, v23
    v_mfma_f32_16x16x32_bf16 v[156:159], a[192:195], a[60:63], v[156:159]
    ds_read_b64_tr_b16 a[186:187], v8 offset:34816
    v_mfma_f32_16x16x32_bf16 v[156:159], a[196:199], a[76:79], v[156:159]
    ds_read_b64_tr_b16 a[188:189], v8 offset:36864
    v_mfma_f32_16x16x32_bf16 v[148:151], a[196:199], a[72:75], v[148:151]
    buffer_load_dwordx4 v3, s[8:11], s38 offen lds
    v_mfma_f32_16x16x32_bf16 v[148:151], a[192:195], a[56:59], v[148:151]
    ds_read_b64_tr_b16 a[190:191], v8 offset:38912
    v_mfma_f32_16x16x32_bf16 v[140:143], a[192:195], a[52:55], v[140:143]
    v_exp_f32 v92, v92
    v_mfma_f32_16x16x32_bf16 v[140:143], a[196:199], a[68:71], v[140:143]
    v_rcp_f32 v23, v23
    v_mfma_f32_16x16x32_bf16 v[132:135], a[196:199], a[64:67], v[132:135]
    s_waitcnt lgkmcnt(3)
    v_add_f32 v92, 1.0, v92
    v_mul_f32 v20, v20, v23
    v_mfma_f32_16x16x32_bf16 v[132:135], a[192:195], a[48:51], v[132:135]
    s_add_u32 s38, s47, 204800
    ds_read_b64_tr_b16 a[192:193], v9 offset:32768
    v_mfma_f32_16x16x32_bf16 v[128:131], a[200:203], a[216:219], v[128:131]
    s_add_u32 m0, s63, 90112
    ds_read_b64_tr_b16 a[194:195], v9 offset:34816
    v_mfma_f32_16x16x32_bf16 v[128:131], a[204:207], a[232:235], v[128:131]
    s_add_u32 s63, s37, 16384
    ds_read_b64_tr_b16 a[196:197], v9 offset:36864
    v_mfma_f32_16x16x32_bf16 v[136:139], a[204:207], a[236:239], v[136:139]
    s_add_u32 s37, s7, 1
    ds_read_b64_tr_b16 a[198:199], v9 offset:38912
    v_mfma_f32_16x16x32_bf16 v[136:139], a[200:203], a[220:223], v[136:139]
    v_rcp_f32 v92, v92
    v_mfma_f32_16x16x32_bf16 v[144:147], a[200:203], a[224:227], v[144:147]
    v_mul_f32 v21, v21, v92
    v_cvt_pk_bf16_f32 v50, v20, v21
    v_mfma_f32_16x16x32_bf16 v[144:147], a[204:207], a[240:243], v[144:147]
    v_lshlrev_b32 v20, 16, v35
    v_and_b32 v21, 0xffff0000, v35
    v_mfma_f32_16x16x32_bf16 v[152:155], a[204:207], a[244:247], v[152:155]
    buffer_load_dwordx4 v3, s[8:11], s38 offen lds
    v_mfma_f32_16x16x32_bf16 v[152:155], a[200:203], a[228:231], v[152:155]
    s_add_u32 s38, s7, 1
    ds_read_b64_tr_b16 a[200:201], v8 offset:40960
    v_sub_f32 v20, v20, v16
    v_mfma_f32_16x16x32_bf16 v[156:159], a[208:211], a[228:231], v[156:159]
    ds_read_b64_tr_b16 a[202:203], v8 offset:43008
    v_sub_f32 v21, v21, v16
    v_mfma_f32_16x16x32_bf16 v[156:159], a[212:215], a[244:247], v[156:159]
    ds_read_b64_tr_b16 a[204:205], v8 offset:45056
    v_cvt_pk_bf16_f32 v22, v20, v21
    v_mfma_f32_16x16x32_bf16 v[148:151], a[212:215], a[240:243], v[148:151]
    ds_read_b64_tr_b16 a[206:207], v8 offset:47104
    v_lshlrev_b32 v20, 16, v22
    v_mfma_f32_16x16x32_bf16 v[148:151], a[208:211], a[224:227], v[148:151]
    s_waitcnt lgkmcnt(4)
    v_and_b32 v21, 0xffff0000, v22
    v_mul_f32 v20, v20, v17
    v_mfma_f32_16x16x32_bf16 v[140:143], a[208:211], a[220:223], v[140:143]
    v_mul_f32 v21, v21, v17
    v_cvt_pk_bf16_f32 v22, v20, v21
    v_mfma_f32_16x16x32_bf16 v[140:143], a[212:215], a[236:239], v[140:143]
    v_lshlrev_b32 v20, 16, v22
    v_and_b32 v21, 0xffff0000, v22
    v_mfma_f32_16x16x32_bf16 v[132:135], a[212:215], a[232:235], v[132:135]
    v_mul_f32 v23, s92, v20
    v_mul_f32 v92, s92, v21
    v_mfma_f32_16x16x32_bf16 v[132:135], a[208:211], a[216:219], v[132:135]
    ds_read_b64_tr_b16 a[208:209], v9 offset:40960
    v_mfma_f32_16x16x32_bf16 v[128:131], a[184:187], a[152:155], v[128:131]
    ds_read_b64_tr_b16 a[210:211], v9 offset:43008
    v_mfma_f32_16x16x32_bf16 v[128:131], a[188:191], a[168:171], v[128:131]
    ds_read_b64_tr_b16 a[212:213], v9 offset:45056
    v_mfma_f32_16x16x32_bf16 v[136:139], a[188:191], a[172:175], v[136:139]
    ds_read_b64_tr_b16 a[214:215], v9 offset:47104
    v_mfma_f32_16x16x32_bf16 v[136:139], a[184:187], a[156:159], v[136:139]
    v_exp_f32 v23, v23
    v_mfma_f32_16x16x32_bf16 v[144:147], a[184:187], a[160:163], v[144:147]
    v_exp_f32 v92, v92
    v_mfma_f32_16x16x32_bf16 v[144:147], a[188:191], a[176:179], v[144:147]
    v_permlane16_swap_b32 v36, v38
    v_mfma_f32_16x16x32_bf16 v[152:155], a[188:191], a[180:183], v[152:155]
    v_permlane16_swap_b32 v37, v39
    v_mfma_f32_16x16x32_bf16 v[152:155], a[184:187], a[164:167], v[152:155]
    ds_read_b64_tr_b16 a[184:185], v10 offset:0
    v_add_f32 v23, 1.0, v23
    v_mfma_f32_16x16x32_bf16 v[156:159], a[192:195], a[164:167], v[156:159]
    ds_read_b64_tr_b16 a[186:187], v10 offset:2048
    v_add_f32 v92, 1.0, v92
    v_mfma_f32_16x16x32_bf16 v[156:159], a[196:199], a[180:183], v[156:159]
    ds_read_b64_tr_b16 a[188:189], v10 offset:4096
    v_mfma_f32_16x16x32_bf16 v[148:151], a[196:199], a[176:179], v[148:151]
    s_waitcnt lgkmcnt(3)
    ds_read_b64_tr_b16 a[190:191], v10 offset:6144
    v_mfma_f32_16x16x32_bf16 v[148:151], a[192:195], a[160:163], v[148:151]
    v_rcp_f32 v23, v23
    v_mfma_f32_16x16x32_bf16 v[140:143], a[192:195], a[156:159], v[140:143]
    v_rcp_f32 v92, v92
    v_mfma_f32_16x16x32_bf16 v[140:143], a[196:199], a[172:175], v[140:143]
    v_mul_f32 v20, v20, v23
    v_mul_f32 v21, v21, v92
    v_mfma_f32_16x16x32_bf16 v[132:135], a[196:199], a[168:171], v[132:135]
    v_cvt_pk_bf16_f32 v51, v20, v21
    v_lshlrev_b32 v20, 16, v36
    v_mfma_f32_16x16x32_bf16 v[132:135], a[192:195], a[152:155], v[132:135]
    v_and_b32 v21, 0xffff0000, v36
    v_sub_f32 v20, v20, v18
    v_mfma_f32_16x16x32_bf16 v[128:131], a[200:203], a[80:83], v[128:131]
    v_sub_f32 v21, v21, v18
    v_cvt_pk_bf16_f32 v22, v20, v21
    v_mfma_f32_16x16x32_bf16 v[128:131], a[204:207], a[96:99], v[128:131]
    v_lshlrev_b32 v20, 16, v22
    v_and_b32 v21, 0xffff0000, v22
    v_mfma_f32_16x16x32_bf16 v[136:139], a[204:207], a[100:103], v[136:139]
    v_mul_f32 v20, v20, v19
    v_mul_f32 v21, v21, v19
    v_mfma_f32_16x16x32_bf16 v[136:139], a[200:203], a[84:87], v[136:139]
    v_cvt_pk_bf16_f32 v22, v20, v21
    v_lshlrev_b32 v20, 16, v22
    v_mfma_f32_16x16x32_bf16 v[144:147], a[200:203], a[88:91], v[144:147]
    v_cvt_pk_bf16_f32 v128, v128, v129
    v_cvt_pk_bf16_f32 v129, v130, v131
    v_mfma_f32_16x16x32_bf16 v[144:147], a[204:207], a[104:107], v[144:147]
    s_xor_b32 s56, s50, 3
    v_and_b32 v21, 0xffff0000, v22
    v_cvt_pk_bf16_f32 v136, v136, v137
    v_mfma_f32_16x16x32_bf16 v[152:155], a[204:207], a[108:111], v[152:155]
    s_lshl_b32 s56, s56, 12
    v_cvt_pk_bf16_f32 v137, v138, v139
    v_mul_f32 v23, s92, v20
    v_mfma_f32_16x16x32_bf16 v[152:155], a[200:203], a[92:95], v[152:155]
    s_add_u32 s78, s59, s56
    ds_read_b64_tr_b16 a[200:201], v10 offset:8192
    v_cvt_pk_bf16_f32 v144, v144, v145
    v_mfma_f32_16x16x32_bf16 v[156:159], a[208:211], a[92:95], v[156:159]
    s_add_u32 s79, s60, s56
    ds_read_b64_tr_b16 a[202:203], v10 offset:10240
    v_cvt_pk_bf16_f32 v145, v146, v147
    v_mfma_f32_16x16x32_bf16 v[156:159], a[212:215], a[108:111], v[156:159]
    s_xor_b32 s56, s50, 3
    ds_read_b64_tr_b16 a[204:205], v10 offset:12288
    v_cvt_pk_bf16_f32 v152, v152, v153
    v_mfma_f32_16x16x32_bf16 v[148:151], a[212:215], a[104:107], v[148:151]
    s_lshl_b32 s56, s56, 10
    ds_read_b64_tr_b16 a[206:207], v10 offset:14336
    v_cvt_pk_bf16_f32 v153, v154, v155
    v_mfma_f32_16x16x32_bf16 v[148:151], a[208:211], a[88:91], v[148:151]
    v_cvt_pk_bf16_f32 v154, v156, v157
    v_cvt_pk_bf16_f32 v155, v158, v159
    v_mfma_f32_16x16x32_bf16 v[140:143], a[208:211], a[84:87], v[140:143]
    v_exp_f32 v23, v23
    v_mfma_f32_16x16x32_bf16 v[140:143], a[212:215], a[100:103], v[140:143]
    s_waitcnt lgkmcnt(4)
    v_mul_f32 v92, s92, v21
    v_add_f32 v23, 1.0, v23
    v_mfma_f32_16x16x32_bf16 v[132:135], a[212:215], a[96:99], v[132:135]
    s_waitcnt vmcnt(3)
    v_cvt_pk_bf16_f32 v146, v148, v149
    v_cvt_pk_bf16_f32 v147, v150, v151
    v_mfma_f32_16x16x32_bf16 v[132:135], a[208:211], a[80:83], v[132:135]
    buffer_store_dword v6, v7, s[24:27], s77 offen offset:32 sc1
    v_subrev_u32 v11, 73728, v11
    v_mfma_f32_16x16x32_bf16 v[160:163], a[184:187], a[128:131], v[160:163]
    s_add_u32 s77, s61, s56
    ds_read_b64_tr_b16 a[192:193], v11 offset:0
    v_cvt_pk_bf16_f32 v138, v140, v141
    v_mfma_f32_16x16x32_bf16 v[160:163], a[188:191], a[0:3], v[160:163]
    ds_read_b64_tr_b16 a[194:195], v11 offset:2048
    v_cvt_pk_bf16_f32 v130, v132, v133
    ds_read_b64_tr_b16 a[196:197], v11 offset:4096
    v_mfma_f32_16x16x32_bf16 v[168:171], a[188:191], a[4:7], v[168:171]
    ds_read_b64_tr_b16 a[198:199], v11 offset:6144
    v_cvt_pk_bf16_f32 v131, v134, v135
    v_mfma_f32_16x16x32_bf16 v[168:171], a[184:187], a[132:135], v[168:171]
    buffer_store_dwordx4 v[128:131], v14, s[24:27], s78 offen offset:0 sc1
    v_cvt_pk_bf16_f32 v139, v142, v143
    v_mfma_f32_16x16x32_bf16 v[176:179], a[184:187], a[136:139], v[176:179]
    ds_read_b64_tr_b16 a[208:209], v11 offset:8192
    v_mfma_f32_16x16x32_bf16 v[176:179], a[188:191], a[8:11], v[176:179]
    ds_read_b64_tr_b16 a[210:211], v11 offset:10240
    v_mfma_f32_16x16x32_bf16 v[184:187], a[188:191], a[12:15], v[184:187]
    ds_read_b64_tr_b16 a[212:213], v11 offset:12288
    v_mfma_f32_16x16x32_bf16 v[184:187], a[184:187], a[140:143], v[184:187]
    s_waitcnt lgkmcnt(5)
    ds_read_b64_tr_b16 a[214:215], v11 offset:14336
    v_mfma_f32_16x16x32_bf16 v[188:191], a[192:195], a[140:143], v[188:191]
    s_waitcnt lgkmcnt(4)
    ds_read_b64_tr_b16 a[184:185], v10 offset:16384
    v_mfma_f32_16x16x32_bf16 v[188:191], a[196:199], a[12:15], v[188:191]
    buffer_store_dwordx4 v[136:139], v14, s[24:27], s78 offen offset:1024 sc1
    v_add_u32 v8, 90112, v8
    v_mfma_f32_16x16x32_bf16 v[180:183], a[196:199], a[8:11], v[180:183]
    ds_read_b64_tr_b16 a[186:187], v10 offset:18432
    v_mfma_f32_16x16x32_bf16 v[180:183], a[192:195], a[136:139], v[180:183]
    ds_read_b64_tr_b16 a[188:189], v10 offset:20480
    v_mfma_f32_16x16x32_bf16 v[172:175], a[192:195], a[132:135], v[172:175]
    ds_read_b64_tr_b16 a[190:191], v10 offset:22528
    v_mfma_f32_16x16x32_bf16 v[172:175], a[196:199], a[4:7], v[172:175]
    v_exp_f32 v92, v92
    v_mfma_f32_16x16x32_bf16 v[164:167], a[196:199], a[0:3], v[164:167]
    v_rcp_f32 v23, v23
    v_mfma_f32_16x16x32_bf16 v[164:167], a[192:195], a[128:131], v[164:167]
    buffer_store_dwordx4 v[144:147], v14, s[24:27], s79 offen offset:0 sc1
    v_add_f32 v92, 1.0, v92
    v_mfma_f32_16x16x32_bf16 v[160:163], a[200:203], a[16:19], v[160:163]
    ds_read_b64_tr_b16 a[192:193], v11 offset:16384
    v_mul_f32 v20, v20, v23
    v_mfma_f32_16x16x32_bf16 v[160:163], a[204:207], a[32:35], v[160:163]
    ds_read_b64_tr_b16 a[194:195], v11 offset:18432
    v_mfma_f32_16x16x32_bf16 v[168:171], a[204:207], a[36:39], v[168:171]
    ds_read_b64_tr_b16 a[196:197], v11 offset:20480
    v_mfma_f32_16x16x32_bf16 v[168:171], a[200:203], a[20:23], v[168:171]
    s_waitcnt lgkmcnt(3)
    ds_read_b64_tr_b16 a[198:199], v11 offset:22528
    v_mfma_f32_16x16x32_bf16 v[176:179], a[200:203], a[24:27], v[176:179]
    v_rcp_f32 v92, v92
    v_mfma_f32_16x16x32_bf16 v[176:179], a[204:207], a[40:43], v[176:179]
    v_mul_f32 v21, v21, v92
    v_cvt_pk_bf16_f32 v52, v20, v21
    v_mfma_f32_16x16x32_bf16 v[184:187], a[204:207], a[44:47], v[184:187]
    v_lshlrev_b32 v20, 16, v37
    v_and_b32 v21, 0xffff0000, v37
    v_mfma_f32_16x16x32_bf16 v[184:187], a[200:203], a[28:31], v[184:187]
pg_15:
    s_cbranch_execz pg_back
    buffer_store_dwordx4 v[152:155], v14, s[24:27], s79 offen offset:1024 sc1
    v_sub_f32 v20, v20, v18
    v_mfma_f32_16x16x32_bf16 v[188:191], a[208:211], a[28:31], v[188:191]
    ds_read_b64_tr_b16 a[200:201], v10 offset:24576
    v_sub_f32 v21, v21, v18
    v_mfma_f32_16x16x32_bf16 v[188:191], a[212:215], a[44:47], v[188:191]
    ds_read_b64_tr_b16 a[202:203], v10 offset:26624
    v_cvt_pk_bf16_f32 v22, v20, v21
    v_mfma_f32_16x16x32_bf16 v[180:183], a[212:215], a[40:43], v[180:183]
    ds_read_b64_tr_b16 a[204:205], v10 offset:28672
    v_lshlrev_b32 v20, 16, v22
    v_mfma_f32_16x16x32_bf16 v[180:183], a[208:211], a[24:27], v[180:183]
    ds_read_b64_tr_b16 a[206:207], v10 offset:30720
    v_and_b32 v21, 0xffff0000, v22
    v_mfma_f32_16x16x32_bf16 v[172:175], a[208:211], a[20:23], v[172:175]
    v_mul_f32 v20, v20, v19
    v_mul_f32 v21, v21, v19
    v_mfma_f32_16x16x32_bf16 v[172:175], a[212:215], a[36:39], v[172:175]
    v_cvt_pk_bf16_f32 v22, v20, v21
    v_lshlrev_b32 v20, 16, v22
    v_mfma_f32_16x16x32_bf16 v[164:167], a[212:215], a[32:35], v[164:167]
    v_and_b32 v21, 0xffff0000, v22
    v_mul_f32 v23, s92, v20
    v_mfma_f32_16x16x32_bf16 v[164:167], a[208:211], a[16:19], v[164:167]
    ds_read_b64_tr_b16 a[208:209], v11 offset:24576
    v_mul_f32 v92, s92, v21
    v_mfma_f32_16x16x32_bf16 v[160:163], a[184:187], a[48:51], v[160:163]
    ds_read_b64_tr_b16 a[210:211], v11 offset:26624
    v_mfma_f32_16x16x32_bf16 v[160:163], a[188:191], a[64:67], v[160:163]
    ds_read_b64_tr_b16 a[212:213], v11 offset:28672
    v_mfma_f32_16x16x32_bf16 v[168:171], a[188:191], a[68:71], v[168:171]
    s_waitcnt lgkmcnt(3)
    ds_read_b64_tr_b16 a[214:215], v11 offset:30720
    v_mfma_f32_16x16x32_bf16 v[168:171], a[184:187], a[52:55], v[168:171]
    v_exp_f32 v23, v23
    v_mfma_f32_16x16x32_bf16 v[176:179], a[184:187], a[56:59], v[176:179]
    v_exp_f32 v92, v92
    v_mfma_f32_16x16x32_bf16 v[176:179], a[188:191], a[72:75], v[176:179]
    v_add_f32 v23, 1.0, v23
    v_add_f32 v92, 1.0, v92
    v_mfma_f32_16x16x32_bf16 v[184:187], a[188:191], a[76:79], v[184:187]
    v_rcp_f32 v23, v23
    v_mfma_f32_16x16x32_bf16 v[184:187], a[184:187], a[60:63], v[184:187]
    ds_read_b64_tr_b16 a[184:185], v10 offset:32768
    v_mul_f32 v20, v20, v23
    v_mfma_f32_16x16x32_bf16 v[188:191], a[192:195], a[60:63], v[188:191]
    s_load_dwordx16 s[28:43], s[86:87], s67 glc
    ds_read_b64_tr_b16 a[186:187], v10 offset:34816
    v_mfma_f32_16x16x32_bf16 v[188:191], a[196:199], a[76:79], v[188:191]
    ds_read_b64_tr_b16 a[188:189], v10 offset:36864
    v_mfma_f32_16x16x32_bf16 v[180:183], a[196:199], a[72:75], v[180:183]
    ds_read_b64_tr_b16 a[190:191], v10 offset:38912
    v_mfma_f32_16x16x32_bf16 v[180:183], a[192:195], a[56:59], v[180:183]
    v_rcp_f32 v92, v92
    v_mfma_f32_16x16x32_bf16 v[172:175], a[192:195], a[52:55], v[172:175]
    v_mul_f32 v21, v21, v92
    v_cvt_pk_bf16_f32 v53, v20, v21
    v_mfma_f32_16x16x32_bf16 v[172:175], a[196:199], a[68:71], v[172:175]
    v_lshlrev_b32 v20, 16, v38
    v_and_b32 v21, 0xffff0000, v38
    v_mfma_f32_16x16x32_bf16 v[164:167], a[196:199], a[64:67], v[164:167]
    v_sub_f32 v20, v20, v18
    v_sub_f32 v21, v21, v18
    v_mfma_f32_16x16x32_bf16 v[164:167], a[192:195], a[48:51], v[164:167]
    ds_read_b64_tr_b16 a[192:193], v11 offset:32768
    v_cvt_pk_bf16_f32 v22, v20, v21
    v_mfma_f32_16x16x32_bf16 v[160:163], a[200:203], a[216:219], v[160:163]
    ds_read_b64_tr_b16 a[194:195], v11 offset:34816
    v_lshlrev_b32 v20, 16, v22
    v_mfma_f32_16x16x32_bf16 v[160:163], a[204:207], a[232:235], v[160:163]
    ds_read_b64_tr_b16 a[196:197], v11 offset:36864
    v_and_b32 v21, 0xffff0000, v22
    v_mfma_f32_16x16x32_bf16 v[168:171], a[204:207], a[236:239], v[168:171]
    s_waitcnt lgkmcnt(3)
    ds_read_b64_tr_b16 a[198:199], v11 offset:38912
    v_mul_f32 v20, v20, v19
    v_mfma_f32_16x16x32_bf16 v[168:171], a[200:203], a[220:223], v[168:171]
    v_mul_f32 v21, v21, v19
    v_cvt_pk_bf16_f32 v22, v20, v21
    v_mfma_f32_16x16x32_bf16 v[176:179], a[200:203], a[224:227], v[176:179]
    v_lshlrev_b32 v20, 16, v22
    v_and_b32 v21, 0xffff0000, v22
    v_mfma_f32_16x16x32_bf16 v[176:179], a[204:207], a[240:243], v[176:179]
    v_mul_f32 v23, s92, v20
    v_mul_f32 v92, s92, v21
    v_mfma_f32_16x16x32_bf16 v[184:187], a[204:207], a[244:247], v[184:187]
    v_exp_f32 v23, v23
    v_mfma_f32_16x16x32_bf16 v[184:187], a[200:203], a[228:231], v[184:187]
    ds_read_b64_tr_b16 a[200:201], v10 offset:40960
    v_add_f32 v23, 1.0, v23
    v_mfma_f32_16x16x32_bf16 v[188:191], a[208:211], a[228:231], v[188:191]
    ds_read_b64_tr_b16 a[202:203], v10 offset:43008
    v_mfma_f32_16x16x32_bf16 v[188:191], a[212:215], a[244:247], v[188:191]
    ds_read_b64_tr_b16 a[204:205], v10 offset:45056
    v_mfma_f32_16x16x32_bf16 v[180:183], a[212:215], a[240:243], v[180:183]
    ds_read_b64_tr_b16 a[206:207], v10 offset:47104
    v_mfma_f32_16x16x32_bf16 v[180:183], a[208:211], a[224:227], v[180:183]
    v_exp_f32 v92, v92
    v_mfma_f32_16x16x32_bf16 v[172:175], a[208:211], a[220:223], v[172:175]
    v_rcp_f32 v23, v23
    v_mfma_f32_16x16x32_bf16 v[172:175], a[212:215], a[236:239], v[172:175]
    v_add_f32 v92, 1.0, v92
    v_mul_f32 v20, v20, v23
    v_mfma_f32_16x16x32_bf16 v[164:167], a[212:215], a[232:235], v[164:167]
    v_rcp_f32 v92, v92
    v_mfma_f32_16x16x32_bf16 v[164:167], a[208:211], a[216:219], v[164:167]
    ds_read_b64_tr_b16 a[208:209], v11 offset:40960
    v_mul_f32 v21, v21, v92
    v_mfma_f32_16x16x32_bf16 v[160:163], a[184:187], a[152:155], v[160:163]
    ds_read_b64_tr_b16 a[210:211], v11 offset:43008
    v_cvt_pk_bf16_f32 v54, v20, v21
    v_mfma_f32_16x16x32_bf16 v[160:163], a[188:191], a[168:171], v[160:163]
    ds_read_b64_tr_b16 a[212:213], v11 offset:45056
    v_lshlrev_b32 v20, 16, v39
    v_mfma_f32_16x16x32_bf16 v[168:171], a[188:191], a[172:175], v[168:171]
    s_waitcnt lgkmcnt(3)
    ds_read_b64_tr_b16 a[214:215], v11 offset:47104
    v_and_b32 v21, 0xffff0000, v39
    v_mfma_f32_16x16x32_bf16 v[168:171], a[184:187], a[156:159], v[168:171]
    v_sub_f32 v20, v20, v18
    v_sub_f32 v21, v21, v18
    v_mfma_f32_16x16x32_bf16 v[176:179], a[184:187], a[160:163], v[176:179]
    v_cvt_pk_bf16_f32 v22, v20, v21
    v_lshlrev_b32 v20, 16, v22
    v_mfma_f32_16x16x32_bf16 v[176:179], a[188:191], a[176:179], v[176:179]
    v_and_b32 v21, 0xffff0000, v22
    v_mul_f32 v20, v20, v19
    v_mfma_f32_16x16x32_bf16 v[184:187], a[188:191], a[180:183], v[184:187]
    v_mul_f32 v21, v21, v19
    v_cvt_pk_bf16_f32 v22, v20, v21
    v_mfma_f32_16x16x32_bf16 v[184:187], a[184:187], a[164:167], v[184:187]
    v_lshlrev_b32 v20, 16, v22
    v_and_b32 v21, 0xffff0000, v22
    v_mfma_f32_16x16x32_bf16 v[188:191], a[192:195], a[164:167], v[188:191]
    v_mul_f32 v23, s92, v20
    v_mul_f32 v92, s92, v21
    v_mfma_f32_16x16x32_bf16 v[188:191], a[196:199], a[180:183], v[188:191]
    v_exp_f32 v23, v23
    v_mfma_f32_16x16x32_bf16 v[180:183], a[196:199], a[176:179], v[180:183]
    s_barrier
    v_mfma_f32_16x16x32_bf16 v[180:183], a[192:195], a[160:163], v[180:183]
    ds_read_b64_tr_b16 a[184:185], v8 offset:45056
    v_add_f32 v23, 1.0, v23
    v_mfma_f32_16x16x32_bf16 v[172:175], a[192:195], a[156:159], v[172:175]
    ds_read_b64_tr_b16 a[186:187], v8 offset:47104
    v_mfma_f32_16x16x32_bf16 v[172:175], a[196:199], a[172:175], v[172:175]
    ds_read_b64_tr_b16 a[188:189], v8 offset:40960
    v_mfma_f32_16x16x32_bf16 v[164:167], a[196:199], a[168:171], v[164:167]
    ds_read_b64_tr_b16 a[190:191], v8 offset:43008
    v_add_u32 v9, 90112, v9
    v_mfma_f32_16x16x32_bf16 v[164:167], a[192:195], a[152:155], v[164:167]
    ds_read_b64_tr_b16 a[192:193], v9 offset:45056
    v_mfma_f32_16x16x32_bf16 v[160:163], a[200:203], a[80:83], v[160:163]
    ds_read_b64_tr_b16 a[194:195], v9 offset:47104
    v_mfma_f32_16x16x32_bf16 v[160:163], a[204:207], a[96:99], v[160:163]
    ds_read_b64_tr_b16 a[196:197], v9 offset:40960
    v_mfma_f32_16x16x32_bf16 v[168:171], a[204:207], a[100:103], v[168:171]
    s_waitcnt lgkmcnt(6)
    ds_read_b64_tr_b16 a[198:199], v9 offset:43008
    v_mfma_f32_16x16x32_bf16 v[168:171], a[200:203], a[84:87], v[168:171]
    v_exp_f32 v92, v92
    v_mfma_f32_16x16x32_bf16 v[176:179], a[200:203], a[88:91], v[176:179]
    v_rcp_f32 v23, v23
    v_mfma_f32_16x16x32_bf16 v[176:179], a[204:207], a[104:107], v[176:179]
    s_xor_b32 s56, s50, 2
    v_cvt_pk_bf16_f32 v160, v160, v161
    v_cvt_pk_bf16_f32 v161, v162, v163
    v_mfma_f32_16x16x32_bf16 v[184:187], a[204:207], a[108:111], v[184:187]
    s_lshl_b32 s56, s56, 12
    v_cvt_pk_bf16_f32 v168, v168, v169
    v_cvt_pk_bf16_f32 v169, v170, v171
    v_mfma_f32_16x16x32_bf16 v[184:187], a[200:203], a[92:95], v[184:187]
    s_add_u32 s78, s59, s56
    ds_read_b64_tr_b16 a[200:201], v8 offset:36864
    v_cvt_pk_bf16_f32 v176, v176, v177
    v_mfma_f32_16x16x32_bf16 v[188:191], a[208:211], a[92:95], v[188:191]
    s_xor_b32 s81, s53, 1
    ds_read_b64_tr_b16 a[202:203], v8 offset:38912
    v_cvt_pk_bf16_f32 v177, v178, v179
    v_mfma_f32_16x16x32_bf16 v[188:191], a[212:215], a[108:111], v[188:191]
    s_mul_i32 s81, s81, 2622464
    ds_read_b64_tr_b16 a[204:205], v8 offset:32768
    v_cvt_pk_bf16_f32 v184, v184, v185
    v_mfma_f32_16x16x32_bf16 v[180:183], a[212:215], a[104:107], v[180:183]
    s_add_u32 s81, s81, s63
    ds_read_b64_tr_b16 a[206:207], v8 offset:34816
    v_cvt_pk_bf16_f32 v185, v186, v187
    v_mfma_f32_16x16x32_bf16 v[180:183], a[208:211], a[88:91], v[180:183]
    s_waitcnt lgkmcnt(4)
    v_cvt_pk_bf16_f32 v186, v188, v189
    v_cvt_pk_bf16_f32 v187, v190, v191
    v_mfma_f32_16x16x32_bf16 v[172:175], a[208:211], a[84:87], v[172:175]
    s_cmp_eq_u32 s37, s7
    s_cselect_b32 s81, s81, 0x70000000
    s_cselect_b32 s57, 512, 0
    v_mfma_f32_16x16x32_bf16 v[172:175], a[212:215], a[100:103], v[172:175]
    s_or_b32 s80, s80, s57
    v_cvt_pk_bf16_f32 v178, v180, v181
    v_cvt_pk_bf16_f32 v179, v182, v183
    v_mfma_f32_16x16x32_bf16 v[164:167], a[212:215], a[96:99], v[164:167]
    s_waitcnt vmcnt(0)
    v_add_f32 v92, 1.0, v92
    v_mul_f32 v20, v20, v23
    v_mfma_f32_16x16x32_bf16 v[164:167], a[208:211], a[80:83], v[164:167]
    buffer_store_dword v6, v7, s[24:27], s77 offen offset:24 sc1
    v_mfma_f32_16x16x32_bf16 v[192:195], a[184:187], a[128:131], v[192:195]
    buffer_load_dwordx4 v[56:59], v14, s[24:27], s81 offen offset:0 sc1
    v_mfma_f32_16x16x32_bf16 v[192:195], a[188:191], a[0:3], v[192:195]
    s_add_u32 s79, s60, s56
    ds_read_b64_tr_b16 a[208:209], v9 offset:36864
    v_cvt_pk_bf16_f32 v170, v172, v173
    v_mfma_f32_16x16x32_bf16 v[200:203], a[188:191], a[4:7], v[200:203]
    s_xor_b32 s56, s50, 2
    ds_read_b64_tr_b16 a[210:211], v9 offset:38912
    v_cvt_pk_bf16_f32 v162, v164, v165
    v_mfma_f32_16x16x32_bf16 v[200:203], a[184:187], a[132:135], v[200:203]
    buffer_load_dwordx4 v[60:63], v14, s[24:27], s81 offen offset:1024 sc1
    v_mfma_f32_16x16x32_bf16 v[208:211], a[184:187], a[136:139], v[208:211]
    s_xor_b32 s81, s53, 2
    ds_read_b64_tr_b16 a[212:213], v9 offset:32768
    v_cvt_pk_bf16_f32 v163, v166, v167
    v_mfma_f32_16x16x32_bf16 v[208:211], a[188:191], a[8:11], v[208:211]
    buffer_store_dwordx4 v[160:163], v14, s[24:27], s78 offen offset:0 sc1
    v_cvt_pk_bf16_f32 v171, v174, v175
    v_mfma_f32_16x16x32_bf16 v[216:219], a[188:191], a[12:15], v[216:219]
    s_mul_i32 s81, s81, 2622464
    ds_read_b64_tr_b16 a[214:215], v9 offset:34816
    s_add_u32 s81, s81, s63
    v_mfma_f32_16x16x32_bf16 v[216:219], a[184:187], a[140:143], v[216:219]
    buffer_store_dwordx4 v[168:171], v14, s[24:27], s78 offen offset:1024 sc1
    v_add_u32 v10, 90112, v10
    v_mfma_f32_16x16x32_bf16 v[220:223], a[192:195], a[140:143], v[220:223]
    s_cmp_eq_u32 s38, s7
    s_cselect_b32 s81, s81, 0x70000000
    s_cselect_b32 s57, 1024, 0
    v_mfma_f32_16x16x32_bf16 v[220:223], a[196:199], a[12:15], v[220:223]
    buffer_load_dwordx4 v[64:67], v14, s[24:27], s81 offen offset:0 sc1
    v_mfma_f32_16x16x32_bf16 v[212:215], a[196:199], a[8:11], v[212:215]
    buffer_load_dwordx4 v[68:71], v14, s[24:27], s81 offen offset:1024 sc1
    v_mfma_f32_16x16x32_bf16 v[212:215], a[192:195], a[136:139], v[212:215]
    s_or_b32 s80, s80, s57
    ds_read_b64_tr_b16 a[184:185], v8 offset:28672
    s_xor_b32 s81, s53, 3
    v_mfma_f32_16x16x32_bf16 v[204:207], a[192:195], a[132:135], v[204:207]
    s_mul_i32 s81, s81, 2622464
    ds_read_b64_tr_b16 a[186:187], v8 offset:30720
    s_add_u32 s81, s81, s63
    v_mfma_f32_16x16x32_bf16 v[204:207], a[196:199], a[4:7], v[204:207]
    s_waitcnt lgkmcnt(2)
    ds_read_b64_tr_b16 a[188:189], v8 offset:24576
    s_lshl_b32 s56, s56, 10
    v_mfma_f32_16x16x32_bf16 v[196:199], a[196:199], a[0:3], v[196:199]
    s_cmp_eq_u32 s39, s7
    s_cselect_b32 s81, s81, 0x70000000
    s_cselect_b32 s57, 2048, 0
    v_mfma_f32_16x16x32_bf16 v[196:199], a[192:195], a[128:131], v[196:199]
    buffer_store_dwordx4 v[176:179], v14, s[24:27], s79 offen offset:0 sc1
    v_add_u32 v11, 90112, v11
    v_mfma_f32_16x16x32_bf16 v[192:195], a[200:203], a[16:19], v[192:195]
    buffer_load_dwordx4 v[72:75], v14, s[24:27], s81 offen offset:0 sc1
    v_mfma_f32_16x16x32_bf16 v[192:195], a[204:207], a[32:35], v[192:195]
    buffer_load_dwordx4 v[76:79], v14, s[24:27], s81 offen offset:1024 sc1
    v_mfma_f32_16x16x32_bf16 v[200:203], a[204:207], a[36:39], v[200:203]
    s_load_dwordx16 s[28:43], s[86:87], s67 glc
    ds_read_b64_tr_b16 a[190:191], v8 offset:26624
    s_or_b32 s80, s80, s57
    v_mfma_f32_16x16x32_bf16 v[200:203], a[200:203], a[20:23], v[200:203]
    s_xor_b32 s81, s53, 4
    ds_read_b64_tr_b16 a[192:193], v9 offset:28672
    s_mul_i32 s81, s81, 2622464
    v_mfma_f32_16x16x32_bf16 v[208:211], a[200:203], a[24:27], v[208:211]
    s_add_u32 s81, s81, s63
    ds_read_b64_tr_b16 a[194:195], v9 offset:30720
    s_add_u32 s77, s61, s56
    v_mfma_f32_16x16x32_bf16 v[208:211], a[204:207], a[40:43], v[208:211]
    s_cmp_eq_u32 s40, s7
    s_cselect_b32 s81, s81, 0x70000000
    s_cselect_b32 s57, 4096, 0
    v_mfma_f32_16x16x32_bf16 v[216:219], a[204:207], a[44:47], v[216:219]
    buffer_load_dwordx4 v[80:83], v14, s[24:27], s81 offen offset:0 sc1
    v_mfma_f32_16x16x32_bf16 v[216:219], a[200:203], a[28:31], v[216:219]
    buffer_store_dwordx4 v[184:187], v14, s[24:27], s79 offen offset:1024 sc1
    v_mfma_f32_16x16x32_bf16 v[220:223], a[208:211], a[28:31], v[220:223]
    buffer_load_dwordx4 v[84:87], v14, s[24:27], s81 offen offset:1024 sc1
    v_mfma_f32_16x16x32_bf16 v[220:223], a[212:215], a[44:47], v[220:223]
    s_or_b32 s80, s80, s57
    ds_read_b64_tr_b16 a[196:197], v9 offset:24576
    s_xor_b32 s81, s53, 5
    v_mfma_f32_16x16x32_bf16 v[212:215], a[212:215], a[40:43], v[212:215]
    s_barrier
    v_mfma_f32_16x16x32_bf16 v[212:215], a[208:211], a[24:27], v[212:215]
    s_mul_i32 s81, s81, 2622464
    ds_read_b64_tr_b16 a[198:199], v9 offset:26624
    s_add_u32 s81, s81, s63
    v_mfma_f32_16x16x32_bf16 v[204:207], a[208:211], a[20:23], v[204:207]
    s_cmp_eq_u32 s41, s7
    s_cselect_b32 s81, s81, 0x70000000
    s_cselect_b32 s57, 8192, 0
    v_mfma_f32_16x16x32_bf16 v[204:207], a[212:215], a[36:39], v[204:207]
    buffer_load_dwordx4 v[88:91], v14, s[24:27], s81 offen offset:0 sc1
    v_mfma_f32_16x16x32_bf16 v[196:199], a[212:215], a[32:35], v[196:199]
    s_waitcnt lgkmcnt(2)
    ds_read_b64_tr_b16 a[200:201], v8 offset:20480
    v_mov_b32 v186, 0
    v_mfma_f32_16x16x32_bf16 v[196:199], a[208:211], a[16:19], v[196:199]
    s_or_b32 s80, s80, s57
    ds_read_b64_tr_b16 a[202:203], v8 offset:22528
    v_mov_b32 v187, 0
    v_mfma_f32_16x16x32_bf16 v[192:195], a[184:187], a[48:51], v[192:195]
    s_and_b32 s56, s70, 0x7ff
    ds_read_b64_tr_b16 a[204:205], v8 offset:16384
    v_mov_b32 v188, 0
    v_mfma_f32_16x16x32_bf16 v[192:195], a[188:191], a[64:67], v[192:195]
    s_sub_u32 s56, 2047, s56
    ds_read_b64_tr_b16 a[206:207], v8 offset:18432
    v_mov_b32 v189, 0
    v_mfma_f32_16x16x32_bf16 v[200:203], a[188:191], a[68:71], v[200:203]
    s_and_b32 s47, s71, 0x7ff
    ds_read_b64_tr_b16 a[208:209], v9 offset:20480
    v_cmp_eq_u32 s[8:9], s56, v5
    v_mfma_f32_16x16x32_bf16 v[200:203], a[184:187], a[52:55], v[200:203]
    s_sub_u32 s47, 2047, s47
    ds_read_b64_tr_b16 a[210:211], v9 offset:22528
    v_cmp_eq_u32 s[20:21], s47, v5
    v_mfma_f32_16x16x32_bf16 v[208:211], a[184:187], a[56:59], v[208:211]
    s_or_b64 s[8:9], s[8:9], s[20:21]
    ds_read_b64_tr_b16 a[212:213], v9 offset:16384
    v_lshrrev_b32 v3, 1, v1
    v_mfma_f32_16x16x32_bf16 v[208:211], a[188:191], a[72:75], v[208:211]
    s_lshr_b32 s44, s64, 7
    ds_read_b64_tr_b16 a[214:215], v9 offset:18432
    v_min_u32 v3, 23, v3
    v_mfma_f32_16x16x32_bf16 v[216:219], a[188:191], a[76:79], v[216:219]
    s_waitcnt lgkmcnt(6)
    v_rcp_f32 v92, v92
    v_mfma_f32_16x16x32_bf16 v[216:219], a[184:187], a[60:63], v[216:219]
    s_lshl_b32 s44, s44, 8
    ds_read_b64_tr_b16 a[184:185], v8 offset:12288
    v_mul_f32 v21, v21, v92
    v_mfma_f32_16x16x32_bf16 v[220:223], a[192:195], a[60:63], v[220:223]
    buffer_load_dwordx4 v[92:95], v14, s[24:27], s81 offen offset:1024 sc1
    v_mfma_f32_16x16x32_bf16 v[220:223], a[196:199], a[76:79], v[220:223]
    s_xor_b32 s81, s53, 6
    ds_read_b64_tr_b16 a[186:187], v8 offset:14336
    v_cvt_pk_bf16_f32 v55, v20, v21
    v_mfma_f32_16x16x32_bf16 v[212:215], a[196:199], a[72:75], v[212:215]
    s_mul_i32 s81, s81, 2622464
    ds_read_b64_tr_b16 a[188:189], v8 offset:8192
    v_bfe_u32 v20, v1, 2, 2
    v_mfma_f32_16x16x32_bf16 v[212:215], a[192:195], a[56:59], v[212:215]
    s_add_u32 s81, s81, s63
    ds_read_b64_tr_b16 a[190:191], v8 offset:10240
    v_lshrrev_b32 v21, 4, v1
    v_mfma_f32_16x16x32_bf16 v[204:207], a[192:195], a[52:55], v[204:207]
    s_cmp_eq_u32 s42, s7
    s_cselect_b32 s81, s81, 0x70000000
    s_cselect_b32 s57, 16384, 0
    v_mfma_f32_16x16x32_bf16 v[204:207], a[196:199], a[68:71], v[204:207]
    buffer_load_dwordx4 v[96:99], v14, s[24:27], s81 offen offset:0 sc1
    v_mfma_f32_16x16x32_bf16 v[196:199], a[196:199], a[64:67], v[196:199]
    buffer_load_dwordx4 v[100:103], v14, s[24:27], s81 offen offset:1024 sc1
    v_mfma_f32_16x16x32_bf16 v[196:199], a[192:195], a[48:51], v[196:199]
    s_waitcnt lgkmcnt(3)
    ds_read_b64_tr_b16 a[192:193], v9 offset:12288
    v_cmp_eq_u32 vcc, v20, v21
    v_mfma_f32_16x16x32_bf16 v[192:195], a[200:203], a[216:219], v[192:195]
    s_or_b32 s80, s80, s57
    ds_read_b64_tr_b16 a[194:195], v9 offset:14336
    v_and_b32 v20, 1, v1
    v_mfma_f32_16x16x32_bf16 v[192:195], a[204:207], a[232:235], v[192:195]
    s_xor_b32 s81, s53, 7
    ds_read_b64_tr_b16 a[196:197], v9 offset:8192
    v_lshlrev_b32 v20, 4, v20
    v_mfma_f32_16x16x32_bf16 v[200:203], a[204:207], a[236:239], v[200:203]
    s_mul_i32 s81, s81, 2622464
    ds_read_b64_tr_b16 a[198:199], v9 offset:10240
    v_mov_b32 v21, 0x3f80
    v_mfma_f32_16x16x32_bf16 v[200:203], a[200:203], a[220:223], v[200:203]
    s_add_u32 s81, s81, s63
    v_lshlrev_b32 v20, v20, v21
    v_cndmask_b32 v20, 0, v20, vcc
    v_mfma_f32_16x16x32_bf16 v[208:211], a[200:203], a[224:227], v[208:211]
    s_cmp_eq_u32 s43, s7
    s_cselect_b32 s81, s81, 0x70000000
    s_cselect_b32 s57, 32768, 0
    v_mfma_f32_16x16x32_bf16 v[208:211], a[204:207], a[240:243], v[208:211]
    buffer_load_dwordx4 v[104:107], v14, s[24:27], s81 offen offset:0 sc1
    v_mfma_f32_16x16x32_bf16 v[216:219], a[204:207], a[244:247], v[216:219]
    buffer_load_dwordx4 v[108:111], v14, s[24:27], s81 offen offset:1024 sc1
    v_mfma_f32_16x16x32_bf16 v[216:219], a[200:203], a[228:231], v[216:219]
    s_or_b32 s80, s80, s57
    ds_read_b64_tr_b16 a[200:201], v8 offset:4096
    v_and_b32 v21, 2, v1
    v_mfma_f32_16x16x32_bf16 v[220:223], a[208:211], a[228:231], v[220:223]
    s_lshr_b32 s45, s68, 7
    ds_read_b64_tr_b16 a[202:203], v8 offset:6144
    v_cmp_eq_u32 vcc, 0, v21
    v_mfma_f32_16x16x32_bf16 v[220:223], a[212:215], a[244:247], v[220:223]
    s_lshl_b32 s45, s45, 8
    ds_read_b64_tr_b16 a[204:205], v8 offset:0
    v_cndmask_b32 v184, 0, v20, vcc
    v_mfma_f32_16x16x32_bf16 v[212:215], a[212:215], a[240:243], v[212:215]
    ds_read_b64_tr_b16 a[206:207], v8 offset:2048
    v_sub_u32 v185, v20, v184
    v_mfma_f32_16x16x32_bf16 v[212:215], a[208:211], a[224:227], v[212:215]
    s_waitcnt lgkmcnt(4)
    v_mov_b32 v190, v184
    v_mov_b32 v191, v185
    v_mfma_f32_16x16x32_bf16 v[204:207], a[208:211], a[220:223], v[204:207]
    v_add_u32 v20, 16, v5
    v_cmp_eq_u32 s[10:11], s56, v20
    v_mfma_f32_16x16x32_bf16 v[204:207], a[212:215], a[236:239], v[204:207]
    s_bfe_u32 s56, s64, 0x10006
    v_cmp_eq_u32 s[22:23], s47, v20
    v_mul_u32_u24 v3, 2560, v3
    v_mfma_f32_16x16x32_bf16 v[196:199], a[212:215], a[232:235], v[196:199]
    s_xor_b32 s81, s53, 6
    v_and_b32 v20, 1, v1
    v_lshl_add_u32 v3, v20, 2, v3
    v_mfma_f32_16x16x32_bf16 v[196:199], a[208:211], a[216:219], v[196:199]
    s_mul_i32 s81, s81, 2622464
    ds_read_b64_tr_b16 a[208:209], v9 offset:4096
    s_add_u32 s81, s81, s48
    v_mfma_f32_16x16x32_bf16 v[192:195], a[184:187], a[152:155], v[192:195]
    s_or_b64 s[10:11], s[10:11], s[22:23]
    ds_read_b64_tr_b16 a[210:211], v9 offset:6144
    s_or_b32 s46, s8, s10
    v_mfma_f32_16x16x32_bf16 v[192:195], a[188:191], a[168:171], v[192:195]
    s_lshl_b32 s56, s56, 3
    ds_read_b64_tr_b16 a[212:213], v9 offset:0
    s_add_u32 s44, s44, s56
    v_mfma_f32_16x16x32_bf16 v[200:203], a[188:191], a[172:175], v[200:203]
    s_add_u32 s44, s44, 3932320
    ds_read_b64_tr_b16 a[214:215], v9 offset:2048
    s_bfe_u32 s56, s68, 0x10006
    v_mfma_f32_16x16x32_bf16 v[200:203], a[184:187], a[156:159], v[200:203]
    s_lshl_b32 s56, s56, 3
    s_add_u32 s45, s45, s56
    s_add_u32 s45, s45, 3932320
    v_mfma_f32_16x16x32_bf16 v[208:211], a[184:187], a[160:163], v[208:211]
    s_cmp_lg_u32 s46, 0
    s_cselect_b32 s44, s44, 0x70000000
    s_cselect_b32 s45, s45, 0x70000000
    v_mfma_f32_16x16x32_bf16 v[208:211], a[188:191], a[176:179], v[208:211]
    buffer_load_dword v22, v3, s[24:27], s44 offen sc1
    v_mfma_f32_16x16x32_bf16 v[216:219], a[188:191], a[180:183], v[216:219]
    buffer_load_dword v23, v3, s[24:27], s45 offen sc1
    v_mfma_f32_16x16x32_bf16 v[216:219], a[184:187], a[164:167], v[216:219]
    s_load_dwordx16 s[28:43], s[86:87], s67 glc
    ds_read_b64_tr_b16 a[184:185], v10 offset:45056
    v_mfma_f32_16x16x32_bf16 v[220:223], a[192:195], a[164:167], v[220:223]
    s_cmp_eq_u32 s34, s7
    s_cselect_b32 s81, s81, 0x70000000
    s_cselect_b32 s57, 64, 0
    v_mfma_f32_16x16x32_bf16 v[220:223], a[196:199], a[180:183], v[220:223]
    buffer_load_dwordx4 v[128:131], v14, s[24:27], s81 offen offset:0 sc1
    v_mfma_f32_16x16x32_bf16 v[212:215], a[196:199], a[176:179], v[212:215]
    buffer_load_dwordx4 v[132:135], v14, s[24:27], s81 offen offset:1024 sc1
    v_mfma_f32_16x16x32_bf16 v[212:215], a[192:195], a[160:163], v[212:215]
    s_or_b32 s80, s80, s57
    ds_read_b64_tr_b16 a[186:187], v10 offset:47104
    s_xor_b32 s81, s53, 7
    v_mfma_f32_16x16x32_bf16 v[204:207], a[192:195], a[156:159], v[204:207]
    s_mul_i32 s81, s81, 2622464
    ds_read_b64_tr_b16 a[188:189], v10 offset:40960
    s_add_u32 s81, s81, s48
    v_mfma_f32_16x16x32_bf16 v[204:207], a[196:199], a[172:175], v[204:207]
    s_waitcnt lgkmcnt(3)
    ds_read_b64_tr_b16 a[190:191], v10 offset:43008
    v_mfma_f32_16x16x32_bf16 v[196:199], a[196:199], a[168:171], v[196:199]
    s_cmp_eq_u32 s35, s7
    s_cselect_b32 s81, s81, 0x70000000
    s_cselect_b32 s57, 128, 0
    v_mfma_f32_16x16x32_bf16 v[196:199], a[192:195], a[152:155], v[196:199]
    buffer_load_dwordx4 v[136:139], v14, s[24:27], s81 offen offset:0 sc1
    v_mfma_f32_16x16x32_bf16 v[192:195], a[200:203], a[80:83], v[192:195]
    buffer_load_dwordx4 v[140:143], v14, s[24:27], s81 offen offset:1024 sc1
    v_mfma_f32_16x16x32_bf16 v[192:195], a[204:207], a[96:99], v[192:195]
    s_or_b32 s80, s80, s57
    ds_read_b64_tr_b16 a[192:193], v11 offset:45056
    v_mfma_f32_16x16x32_bf16 v[200:203], a[204:207], a[100:103], v[200:203]
    ds_read_b64_tr_b16 a[194:195], v11 offset:47104
    v_mfma_f32_16x16x32_bf16 v[200:203], a[200:203], a[84:87], v[200:203]
    ds_read_b64_tr_b16 a[196:197], v11 offset:40960
    v_mfma_f32_16x16x32_bf16 v[208:211], a[200:203], a[88:91], v[208:211]
    ds_read_b64_tr_b16 a[198:199], v11 offset:43008
    v_cvt_pk_bf16_f32 v192, v192, v193
    v_mfma_f32_16x16x32_bf16 v[208:211], a[204:207], a[104:107], v[208:211]
    s_xor_b32 s56, s50, 1
    v_cvt_pk_bf16_f32 v193, v194, v195
    v_mfma_f32_16x16x32_bf16 v[216:219], a[204:207], a[108:111], v[216:219]
    s_lshl_b32 s56, s56, 12
    v_cvt_pk_bf16_f32 v200, v200, v201
    v_cvt_pk_bf16_f32 v201, v202, v203
    v_mfma_f32_16x16x32_bf16 v[216:219], a[200:203], a[92:95], v[216:219]
    s_add_u32 s78, s59, s56
    ds_read_b64_tr_b16 a[200:201], v10 offset:36864
    v_cvt_pk_bf16_f32 v208, v208, v209
    v_mfma_f32_16x16x32_bf16 v[220:223], a[208:211], a[92:95], v[220:223]
    s_add_u32 s79, s60, s56
    ds_read_b64_tr_b16 a[202:203], v10 offset:38912
    v_cvt_pk_bf16_f32 v209, v210, v211
    v_mfma_f32_16x16x32_bf16 v[220:223], a[212:215], a[108:111], v[220:223]
    s_xor_b32 s56, s50, 1
    ds_read_b64_tr_b16 a[204:205], v10 offset:32768
    v_cvt_pk_bf16_f32 v216, v216, v217
    v_mfma_f32_16x16x32_bf16 v[212:215], a[212:215], a[104:107], v[212:215]
    s_waitcnt lgkmcnt(4)
    ds_read_b64_tr_b16 a[206:207], v10 offset:34816
    v_cvt_pk_bf16_f32 v217, v218, v219
    v_mfma_f32_16x16x32_bf16 v[212:215], a[208:211], a[88:91], v[212:215]
    s_lshl_b32 s56, s56, 10
    v_cvt_pk_bf16_f32 v218, v220, v221
    v_cvt_pk_bf16_f32 v219, v222, v223
    v_mfma_f32_16x16x32_bf16 v[204:207], a[208:211], a[84:87], v[204:207]
    v_lshlrev_b32 v220, 16, v46
    v_mfma_f32_16x16x32_bf16 v[204:207], a[212:215], a[100:103], v[204:207]
    s_waitcnt vmcnt(13)
    v_and_b32 v221, 0xffff0000, v46
    v_cvt_pk_bf16_f32 v210, v212, v213
    v_mfma_f32_16x16x32_bf16 v[196:199], a[212:215], a[96:99], v[196:199]
    buffer_store_dword v6, v7, s[24:27], s77 offen offset:16 sc1
    v_mfma_f32_16x16x32_bf16 v[196:199], a[208:211], a[80:83], v[196:199]
    s_add_u32 s77, s61, s56
    ds_read_b64_tr_b16 a[208:209], v11 offset:36864
    v_cvt_pk_bf16_f32 v202, v204, v205
    v_mfma_f32_16x16x32_bf16 v[224:227], a[184:187], a[128:131], v[224:227]
    ds_read_b64_tr_b16 a[210:211], v11 offset:38912
    v_cvt_pk_bf16_f32 v203, v206, v207
    v_mfma_f32_16x16x32_bf16 v[224:227], a[188:191], a[0:3], v[224:227]
    ds_read_b64_tr_b16 a[212:213], v11 offset:32768
    v_cvt_pk_bf16_f32 v194, v196, v197
    v_mfma_f32_16x16x32_bf16 v[232:235], a[188:191], a[4:7], v[232:235]
    s_waitcnt lgkmcnt(3)
    ds_read_b64_tr_b16 a[214:215], v11 offset:34816
    v_cvt_pk_bf16_f32 v195, v198, v199
    v_mfma_f32_16x16x32_bf16 v[232:235], a[184:187], a[132:135], v[232:235]
    buffer_store_dwordx4 v[192:195], v14, s[24:27], s78 offen offset:0 sc1
    v_cvt_pk_bf16_f32 v211, v214, v215
    v_mfma_f32_16x16x32_bf16 v[236:239], a[192:195], a[132:135], v[236:239]
    ds_read_b64_tr_b16 a[184:185], v10 offset:28672
    v_lshlrev_b32 v192, 16, v24
    v_mfma_f32_16x16x32_bf16 v[236:239], a[196:199], a[4:7], v[236:239]
    ds_read_b64_tr_b16 a[186:187], v10 offset:30720
    v_and_b32 v193, 0xffff0000, v24
    v_mfma_f32_16x16x32_bf16 v[228:231], a[196:199], a[0:3], v[228:231]
    ds_read_b64_tr_b16 a[188:189], v10 offset:24576
    v_lshlrev_b32 v194, 16, v25
    v_mfma_f32_16x16x32_bf16 v[228:231], a[192:195], a[128:131], v[228:231]
    buffer_store_dwordx4 v[200:203], v14, s[24:27], s78 offen offset:1024 sc1
    v_and_b32 v195, 0xffff0000, v25
    v_mfma_f32_16x16x32_bf16 v[224:227], a[200:203], a[16:19], v[224:227]
    ds_read_b64_tr_b16 a[190:191], v10 offset:26624
    v_lshlrev_b32 v196, 16, v26
    v_mfma_f32_16x16x32_bf16 v[224:227], a[204:207], a[32:35], v[224:227]
    s_waitcnt lgkmcnt(4)
    ds_read_b64_tr_b16 a[192:193], v11 offset:28672
    v_and_b32 v197, 0xffff0000, v26
    v_mfma_f32_16x16x32_bf16 v[232:235], a[204:207], a[36:39], v[232:235]
    ds_read_b64_tr_b16 a[194:195], v11 offset:30720
    v_lshlrev_b32 v212, 16, v42
    v_mfma_f32_16x16x32_bf16 v[232:235], a[200:203], a[20:23], v[232:235]
    ds_read_b64_tr_b16 a[196:197], v11 offset:24576
    v_and_b32 v213, 0xffff0000, v42
    v_mfma_f32_16x16x32_bf16 v[236:239], a[208:211], a[20:23], v[236:239]
    ds_read_b64_tr_b16 a[198:199], v11 offset:26624
    v_lshlrev_b32 v198, 16, v27
    v_mfma_f32_16x16x32_bf16 v[236:239], a[212:215], a[36:39], v[236:239]
    s_waitcnt lgkmcnt(5)
    ds_read_b64_tr_b16 a[200:201], v10 offset:20480
    v_and_b32 v199, 0xffff0000, v27
    v_mfma_f32_16x16x32_bf16 v[228:231], a[212:215], a[32:35], v[228:231]
    ds_read_b64_tr_b16 a[202:203], v10 offset:22528
    v_lshlrev_b32 v214, 16, v43
    v_mfma_f32_16x16x32_bf16 v[228:231], a[208:211], a[16:19], v[228:231]
    buffer_store_dwordx4 v[208:211], v14, s[24:27], s79 offen offset:0 sc1
    v_and_b32 v215, 0xffff0000, v43
    v_mfma_f32_16x16x32_bf16 v[224:227], a[184:187], a[48:51], v[224:227]
    s_waitcnt lgkmcnt(5)
    ds_read_b64_tr_b16 a[204:205], v10 offset:16384
    v_lshlrev_b32 v208, 16, v40
    v_mfma_f32_16x16x32_bf16 v[224:227], a[188:191], a[64:67], v[224:227]
    s_waitcnt lgkmcnt(5)
    ds_read_b64_tr_b16 a[206:207], v10 offset:18432
    v_and_b32 v209, 0xffff0000, v40
    v_mfma_f32_16x16x32_bf16 v[232:235], a[188:191], a[68:71], v[232:235]
    s_load_dwordx16 s[28:43], s[86:87], s67 glc
    ds_read_b64_tr_b16 a[208:209], v11 offset:20480
    v_lshlrev_b32 v210, 16, v41
    v_mfma_f32_16x16x32_bf16 v[232:235], a[184:187], a[52:55], v[232:235]
    s_waitcnt lgkmcnt(5)
    ds_read_b64_tr_b16 a[210:211], v11 offset:22528
    v_and_b32 v211, 0xffff0000, v41
    v_mfma_f32_16x16x32_bf16 v[236:239], a[192:195], a[52:55], v[236:239]
pg_16:
    s_cbranch_execz pg_back
    ds_read_b64_tr_b16 a[212:213], v11 offset:16384
    v_lshlrev_b32 v200, 16, v28
    v_mfma_f32_16x16x32_bf16 v[236:239], a[196:199], a[68:71], v[236:239]
    s_waitcnt lgkmcnt(5)
    ds_read_b64_tr_b16 a[214:215], v11 offset:18432
    v_and_b32 v201, 0xffff0000, v28
    v_mfma_f32_16x16x32_bf16 v[228:231], a[196:199], a[64:67], v[228:231]
    s_xor_b32 s81, s53, 4
    ds_read_b64_tr_b16 a[184:185], v10 offset:12288
    v_lshlrev_b32 v202, 16, v29
    v_mfma_f32_16x16x32_bf16 v[228:231], a[192:195], a[48:51], v[228:231]
    buffer_store_dwordx4 v[216:219], v14, s[24:27], s79 offen offset:1024 sc1
    v_and_b32 v203, 0xffff0000, v29
    v_mfma_f32_16x16x32_bf16 v[224:227], a[200:203], a[216:219], v[224:227]
    s_waitcnt lgkmcnt(5)
    ds_read_b64_tr_b16 a[186:187], v10 offset:14336
    v_lshlrev_b32 v216, 16, v44
    v_mfma_f32_16x16x32_bf16 v[224:227], a[204:207], a[232:235], v[224:227]
    s_mul_i32 s81, s81, 2622464
    ds_read_b64_tr_b16 a[188:189], v10 offset:8192
    v_and_b32 v217, 0xffff0000, v44
    v_mfma_f32_16x16x32_bf16 v[232:235], a[204:207], a[236:239], v[232:235]
    s_waitcnt lgkmcnt(5)
    ds_read_b64_tr_b16 a[190:191], v10 offset:10240
    v_lshlrev_b32 v218, 16, v45
    v_mfma_f32_16x16x32_bf16 v[232:235], a[200:203], a[220:223], v[232:235]
    s_add_u32 s81, s81, s48
    ds_read_b64_tr_b16 a[192:193], v11 offset:12288
    v_and_b32 v219, 0xffff0000, v45
    v_mfma_f32_16x16x32_bf16 v[236:239], a[208:211], a[220:223], v[236:239]
    s_waitcnt lgkmcnt(5)
    ds_read_b64_tr_b16 a[194:195], v11 offset:14336
    v_lshlrev_b32 v204, 16, v30
    v_mfma_f32_16x16x32_bf16 v[236:239], a[212:215], a[236:239], v[236:239]
    s_cmp_eq_u32 s32, s7
    s_cselect_b32 s81, s81, 0x70000000
    s_cselect_b32 s57, 16, 0
    ds_read_b64_tr_b16 a[196:197], v11 offset:8192
    v_mfma_f32_16x16x32_bf16 v[228:231], a[212:215], a[232:235], v[228:231]
    s_or_b32 s80, s80, s57
    ds_read_b64_tr_b16 a[198:199], v11 offset:10240
    v_and_b32 v205, 0xffff0000, v30
    v_mfma_f32_16x16x32_bf16 v[228:231], a[208:211], a[216:219], v[228:231]
    s_waitcnt lgkmcnt(6)
    ds_read_b64_tr_b16 a[200:201], v10 offset:4096
    v_lshlrev_b32 v206, 16, v31
    v_mfma_f32_16x16x32_bf16 v[224:227], a[184:187], a[152:155], v[224:227]
    s_waitcnt lgkmcnt(5)
    ds_read_b64_tr_b16 a[202:203], v10 offset:6144
    v_and_b32 v207, 0xffff0000, v31
    v_mfma_f32_16x16x32_bf16 v[224:227], a[188:191], a[168:171], v[224:227]
    ds_read_b64_tr_b16 a[204:205], v10 offset:0
    v_lshlrev_b32 v222, 16, v47
    v_mfma_f32_16x16x32_bf16 v[232:235], a[188:191], a[172:175], v[232:235]
    ds_read_b64_tr_b16 a[206:207], v10 offset:2048
    v_and_b32 v223, 0xffff0000, v47
    v_mfma_f32_16x16x32_bf16 v[232:235], a[184:187], a[156:159], v[232:235]
    s_waitcnt lgkmcnt(6)
    buffer_load_dwordx4 v[144:147], v14, s[24:27], s81 offen offset:0 sc1
    v_mfma_f32_16x16x32_bf16 v[236:239], a[192:195], a[156:159], v[236:239]
    s_waitcnt lgkmcnt(4)
    ds_read_b64_tr_b16 a[208:209], v11 offset:4096
    v_mfma_f32_16x16x32_bf16 v[236:239], a[196:199], a[172:175], v[236:239]
    s_xor_b32 s56, s50, 0
    ds_read_b64_tr_b16 a[210:211], v11 offset:6144
    ds_read_b64_tr_b16 a[212:213], v11 offset:0
    v_mfma_f32_16x16x32_bf16 v[228:231], a[196:199], a[168:171], v[228:231]
    buffer_load_dwordx4 v[148:151], v14, s[24:27], s81 offen offset:1024 sc1
    ds_read_b64_tr_b16 a[214:215], v11 offset:2048
    v_mfma_f32_16x16x32_bf16 v[228:231], a[192:195], a[152:155], v[228:231]
    s_waitcnt lgkmcnt(6)
    ds_read_b64_tr_b16 a[184:185], v10 offset:45056
    s_xor_b32 s81, s53, 5
    v_mfma_f32_16x16x32_bf16 v[224:227], a[200:203], a[80:83], v[224:227]
    s_waitcnt lgkmcnt(5)
    ds_read_b64_tr_b16 a[186:187], v10 offset:47104
    s_mul_i32 s81, s81, 2622464
    v_mfma_f32_16x16x32_bf16 v[224:227], a[204:207], a[96:99], v[224:227]
    s_add_u32 s81, s81, s48
    ds_read_b64_tr_b16 a[188:189], v10 offset:40960
    v_mfma_f32_16x16x32_bf16 v[232:235], a[204:207], a[100:103], v[232:235]
    s_cmp_eq_u32 s33, s7
    s_cselect_b32 s81, s81, 0x70000000
    s_cselect_b32 s57, 32, 0
    ds_read_b64_tr_b16 a[190:191], v10 offset:43008
    v_mfma_f32_16x16x32_bf16 v[232:235], a[200:203], a[84:87], v[232:235]
    s_waitcnt lgkmcnt(6)
    buffer_load_dwordx4 v[152:155], v14, s[24:27], s81 offen offset:0 sc1
    v_mfma_f32_16x16x32_bf16 v[236:239], a[208:211], a[84:87], v[236:239]
    s_waitcnt lgkmcnt(4)
    ds_read_b64_tr_b16 a[192:193], v11 offset:45056
    v_cvt_pk_bf16_f32 v224, v224, v225
    v_mfma_f32_16x16x32_bf16 v[236:239], a[212:215], a[100:103], v[236:239]
    buffer_load_dwordx4 v[156:159], v14, s[24:27], s81 offen offset:1024 sc1
    ds_read_b64_tr_b16 a[194:195], v11 offset:47104
    v_mfma_f32_16x16x32_bf16 v[228:231], a[212:215], a[96:99], v[228:231]
    s_or_b32 s80, s80, s57
    ds_read_b64_tr_b16 a[196:197], v11 offset:40960
    v_cvt_pk_bf16_f32 v225, v226, v227
    ds_read_b64_tr_b16 a[198:199], v11 offset:43008
    v_mfma_f32_16x16x32_bf16 v[228:231], a[208:211], a[80:83], v[228:231]
    s_waitcnt lgkmcnt(6)
    ds_read_b64_tr_b16 a[200:201], v10 offset:36864
    v_cvt_pk_bf16_f32 v232, v232, v233
    v_mfma_f32_16x16x32_bf16 v[240:243], a[184:187], a[136:139], v[240:243]
    s_waitcnt lgkmcnt(5)
    ds_read_b64_tr_b16 a[202:203], v10 offset:38912
    v_cvt_pk_bf16_f32 v233, v234, v235
    v_mfma_f32_16x16x32_bf16 v[240:243], a[188:191], a[8:11], v[240:243]
    s_lshl_b32 s56, s56, 12
    ds_read_b64_tr_b16 a[204:205], v10 offset:32768
    v_cvt_pk_bf16_f32 v226, v228, v229
    v_mfma_f32_16x16x32_bf16 v[248:251], a[188:191], a[12:15], v[248:251]
    s_add_u32 s78, s59, s56
    ds_read_b64_tr_b16 a[206:207], v10 offset:34816
    v_cvt_pk_bf16_f32 v227, v230, v231
    v_mfma_f32_16x16x32_bf16 v[248:251], a[184:187], a[140:143], v[248:251]
    s_waitcnt lgkmcnt(6)
    ds_read_b64_tr_b16 a[208:209], v11 offset:36864
    v_cvt_pk_bf16_f32 v234, v236, v237
    v_mfma_f32_16x16x32_bf16 v[252:255], a[192:195], a[140:143], v[252:255]
    s_waitcnt lgkmcnt(5)
    ds_read_b64_tr_b16 a[210:211], v11 offset:38912
    v_cvt_pk_bf16_f32 v235, v238, v239
    v_mfma_f32_16x16x32_bf16 v[252:255], a[196:199], a[12:15], v[252:255]
    buffer_store_dwordx4 v[224:227], v14, s[24:27], s78 offen offset:0 sc1
    v_mfma_f32_16x16x32_bf16 v[244:247], a[196:199], a[8:11], v[244:247]
    buffer_store_dwordx4 v[232:235], v14, s[24:27], s78 offen offset:1024 sc1
    v_mfma_f32_16x16x32_bf16 v[244:247], a[192:195], a[136:139], v[244:247]
    s_waitcnt lgkmcnt(4)
    ds_read_b64_tr_b16 a[212:213], v11 offset:32768
    s_add_u32 s79, s60, s56
    ds_read_b64_tr_b16 a[214:215], v11 offset:34816
    v_mfma_f32_16x16x32_bf16 v[240:243], a[200:203], a[24:27], v[240:243]
    s_waitcnt lgkmcnt(4)
    ds_read_b64_tr_b16 a[184:185], v10 offset:28672
    v_mfma_f32_16x16x32_bf16 v[240:243], a[204:207], a[40:43], v[240:243]
    ds_read_b64_tr_b16 a[186:187], v10 offset:30720
    ds_read_b64_tr_b16 a[188:189], v10 offset:24576
    v_mfma_f32_16x16x32_bf16 v[248:251], a[204:207], a[44:47], v[248:251]
    ds_read_b64_tr_b16 a[190:191], v10 offset:26624
    v_mfma_f32_16x16x32_bf16 v[248:251], a[200:203], a[28:31], v[248:251]
    s_waitcnt lgkmcnt(6)
    ds_read_b64_tr_b16 a[192:193], v11 offset:28672
    v_mfma_f32_16x16x32_bf16 v[252:255], a[208:211], a[28:31], v[252:255]
    s_waitcnt lgkmcnt(5)
    ds_read_b64_tr_b16 a[194:195], v11 offset:30720
    v_mfma_f32_16x16x32_bf16 v[252:255], a[212:215], a[44:47], v[252:255]
    ds_read_b64_tr_b16 a[196:197], v11 offset:24576
    v_mfma_f32_16x16x32_bf16 v[244:247], a[212:215], a[40:43], v[244:247]
    ds_read_b64_tr_b16 a[198:199], v11 offset:26624
    v_mfma_f32_16x16x32_bf16 v[244:247], a[208:211], a[24:27], v[244:247]
    s_waitcnt lgkmcnt(6)
    ds_read_b64_tr_b16 a[200:201], v10 offset:20480
    v_mfma_f32_16x16x32_bf16 v[240:243], a[184:187], a[56:59], v[240:243]
    s_waitcnt lgkmcnt(5)
    ds_read_b64_tr_b16 a[202:203], v10 offset:22528
    v_mfma_f32_16x16x32_bf16 v[240:243], a[188:191], a[72:75], v[240:243]
    ds_read_b64_tr_b16 a[204:205], v10 offset:16384
    v_mfma_f32_16x16x32_bf16 v[248:251], a[188:191], a[76:79], v[248:251]
    s_xor_b32 s81, s53, 2
    ds_read_b64_tr_b16 a[206:207], v10 offset:18432
    s_mul_i32 s81, s81, 2622464
    v_mfma_f32_16x16x32_bf16 v[248:251], a[184:187], a[60:63], v[248:251]
    s_waitcnt lgkmcnt(6)
    ds_read_b64_tr_b16 a[208:209], v11 offset:20480
    s_add_u32 s81, s81, s48
    v_mfma_f32_16x16x32_bf16 v[252:255], a[192:195], a[60:63], v[252:255]
    s_waitcnt lgkmcnt(5)
    ds_read_b64_tr_b16 a[210:211], v11 offset:22528
    v_mfma_f32_16x16x32_bf16 v[252:255], a[196:199], a[76:79], v[252:255]
    ds_read_b64_tr_b16 a[212:213], v11 offset:16384
    v_mfma_f32_16x16x32_bf16 v[244:247], a[196:199], a[72:75], v[244:247]
    s_cmp_eq_u32 s30, s7
    s_cselect_b32 s81, s81, 0x70000000
    s_cselect_b32 s57, 4, 0
    ds_read_b64_tr_b16 a[214:215], v11 offset:18432
    v_mfma_f32_16x16x32_bf16 v[244:247], a[192:195], a[56:59], v[244:247]
    s_waitcnt lgkmcnt(6)
    ds_read_b64_tr_b16 a[184:185], v10 offset:12288
    s_or_b32 s80, s80, s57
    v_mfma_f32_16x16x32_bf16 v[240:243], a[200:203], a[224:227], v[240:243]
    s_waitcnt lgkmcnt(5)
    ds_read_b64_tr_b16 a[186:187], v10 offset:14336
    v_mfma_f32_16x16x32_bf16 v[240:243], a[204:207], a[240:243], v[240:243]
    ds_read_b64_tr_b16 a[188:189], v10 offset:8192
    v_mfma_f32_16x16x32_bf16 v[248:251], a[204:207], a[244:247], v[248:251]
    ds_read_b64_tr_b16 a[190:191], v10 offset:10240
    v_mfma_f32_16x16x32_bf16 v[248:251], a[200:203], a[228:231], v[248:251]
    s_waitcnt lgkmcnt(6)
    ds_read_b64_tr_b16 a[192:193], v11 offset:12288
    v_mfma_f32_16x16x32_bf16 v[252:255], a[208:211], a[228:231], v[252:255]
    s_waitcnt lgkmcnt(5)
    ds_read_b64_tr_b16 a[194:195], v11 offset:14336
    v_mfma_f32_16x16x32_bf16 v[252:255], a[212:215], a[244:247], v[252:255]
    ds_read_b64_tr_b16 a[196:197], v11 offset:8192
    v_mfma_f32_16x16x32_bf16 v[244:247], a[212:215], a[240:243], v[244:247]
    ds_read_b64_tr_b16 a[198:199], v11 offset:10240
    v_mfma_f32_16x16x32_bf16 v[244:247], a[208:211], a[224:227], v[244:247]
    s_waitcnt lgkmcnt(6)
    ds_read_b64_tr_b16 a[200:201], v10 offset:4096
    v_mfma_f32_16x16x32_bf16 v[240:243], a[184:187], a[160:163], v[240:243]
    s_waitcnt lgkmcnt(5)
    buffer_load_dwordx4 v[160:163], v14, s[24:27], s81 offen offset:0 sc1
    v_mfma_f32_16x16x32_bf16 v[240:243], a[188:191], a[176:179], v[240:243]
    s_waitcnt vmcnt(7)
    ds_read_b64_tr_b16 a[202:203], v10 offset:6144
    ds_read_b64_tr_b16 a[204:205], v10 offset:0
    v_mfma_f32_16x16x32_bf16 v[248:251], a[188:191], a[180:183], v[248:251]
    ds_read_b64_tr_b16 a[206:207], v10 offset:2048
    v_mfma_f32_16x16x32_bf16 v[248:251], a[184:187], a[164:167], v[248:251]
    s_waitcnt lgkmcnt(6)
    ds_read_b64_tr_b16 a[208:209], v11 offset:4096
    v_mfma_f32_16x16x32_bf16 v[252:255], a[192:195], a[164:167], v[252:255]
    s_waitcnt lgkmcnt(5)
    ds_read_b64_tr_b16 a[210:211], v11 offset:6144
    v_mfma_f32_16x16x32_bf16 v[252:255], a[196:199], a[180:183], v[252:255]
    buffer_store_dword v6, v7, s[24:27], s77 offen offset:8 sc1
    ds_read_b64_tr_b16 a[212:213], v11 offset:0
    v_mfma_f32_16x16x32_bf16 v[244:247], a[196:199], a[176:179], v[244:247]
    buffer_load_dwordx4 v[164:167], v14, s[24:27], s81 offen offset:1024 sc1
    ds_read_b64_tr_b16 a[214:215], v11 offset:2048
    v_mfma_f32_16x16x32_bf16 v[244:247], a[192:195], a[160:163], v[244:247]
    s_waitcnt lgkmcnt(6)
    s_xor_b32 s81, s53, 3
    s_mul_i32 s81, s81, 2622464
    v_mfma_f32_16x16x32_bf16 v[240:243], a[200:203], a[88:91], v[240:243]
    s_waitcnt lgkmcnt(4)
    s_add_u32 s81, s81, s48
    v_mfma_f32_16x16x32_bf16 v[240:243], a[204:207], a[104:107], v[240:243]
    s_cmp_eq_u32 s31, s7
    s_cselect_b32 s81, s81, 0x70000000
    s_cselect_b32 s57, 8, 0
    v_mfma_f32_16x16x32_bf16 v[248:251], a[204:207], a[108:111], v[248:251]
    buffer_load_dwordx4 v[168:171], v14, s[24:27], s81 offen offset:0 sc1
    v_mfma_f32_16x16x32_bf16 v[248:251], a[200:203], a[92:95], v[248:251]
    s_waitcnt lgkmcnt(2)
    buffer_load_dwordx4 v[172:175], v14, s[24:27], s81 offen offset:1024 sc1
    v_mfma_f32_16x16x32_bf16 v[252:255], a[208:211], a[92:95], v[252:255]
    s_waitcnt lgkmcnt(0)
    s_or_b32 s80, s80, s57
    s_xor_b32 s81, s53, 1
    v_mfma_f32_16x16x32_bf16 v[252:255], a[212:215], a[108:111], v[252:255]
    s_mul_i32 s81, s81, 2622464
    s_add_u32 s81, s81, s48
    v_mfma_f32_16x16x32_bf16 v[244:247], a[212:215], a[104:107], v[244:247]
    s_cmp_eq_u32 s29, s7
    s_cselect_b32 s81, s81, 0x70000000
    s_cselect_b32 s57, 2, 0
    v_mfma_f32_16x16x32_bf16 v[244:247], a[208:211], a[88:91], v[244:247]
    buffer_load_dwordx4 v[176:179], v14, s[24:27], s81 offen offset:0 sc1
    s_or_b32 s80, s80, s57
    buffer_load_dwordx4 v[180:183], v14, s[24:27], s81 offen offset:1024 sc1
    s_load_dwordx16 s[28:43], s[86:87], s67 glc
post_code:
    s_waitcnt vmcnt(9)
    v_mfma_f32_16x16x32_bf16 v[240:243], v[184:187], v[128:131], v[240:243]
    v_mfma_f32_16x16x32_bf16 v[244:247], v[188:191], v[128:131], v[244:247]
    v_mfma_f32_16x16x32_bf16 v[248:251], v[184:187], v[132:135], v[248:251]
    v_mfma_f32_16x16x32_bf16 v[252:255], v[188:191], v[132:135], v[252:255]
    v_mfma_f32_16x16x32_bf16 v[240:243], v[184:187], v[136:139], v[240:243]
    v_mfma_f32_16x16x32_bf16 v[244:247], v[188:191], v[136:139], v[244:247]
    v_mfma_f32_16x16x32_bf16 v[248:251], v[184:187], v[140:143], v[248:251]
    v_mfma_f32_16x16x32_bf16 v[252:255], v[188:191], v[140:143], v[252:255]
    v_mfma_f32_16x16x32_bf16 v[240:243], v[184:187], v[144:147], v[240:243]
    v_mfma_f32_16x16x32_bf16 v[244:247], v[188:191], v[144:147], v[244:247]
    v_mfma_f32_16x16x32_bf16 v[248:251], v[184:187], v[148:151], v[248:251]
    v_mfma_f32_16x16x32_bf16 v[252:255], v[188:191], v[148:151], v[252:255]
    v_mfma_f32_16x16x32_bf16 v[240:243], v[184:187], v[152:155], v[240:243]
    v_mfma_f32_16x16x32_bf16 v[244:247], v[188:191], v[152:155], v[244:247]
    v_mfma_f32_16x16x32_bf16 v[248:251], v[184:187], v[156:159], v[248:251]
    v_mfma_f32_16x16x32_bf16 v[252:255], v[188:191], v[156:159], v[252:255]
    s_xor_b32 s56, s50, 0
    s_lshl_b32 s56, s56, 10
    s_add_u32 s77, s61, s56
    s_waitcnt vmcnt(7)
    buffer_store_dword v6, v7, s[24:27], s77 offen offset:0 sc1
    s_cmp_lg_u32 s46, 0
    s_cbranch_scc1 routed_a
routed_a_ret:
    s_and_b32 s60, s80, 14
    s_andn2_b32 s79, s80, 14
    s_mov_b32 s47, 2
    s_andn2_b32 s78, 2, s66
    s_cbranch_scc1 ev_loop
    s_load_dwordx16 s[28:43], s[86:87], s67 glc
    v_mfma_f32_16x16x32_bf16 v[112:115], v[184:187], v[56:59], v[112:115]
    v_mfma_f32_16x16x32_bf16 v[116:119], v[188:191], v[56:59], v[116:119]
    v_mfma_f32_16x16x32_bf16 v[120:123], v[184:187], v[60:63], v[120:123]
    v_mfma_f32_16x16x32_bf16 v[124:127], v[188:191], v[60:63], v[124:127]
    v_mfma_f32_16x16x32_bf16 v[112:115], v[184:187], v[64:67], v[112:115]
    v_mfma_f32_16x16x32_bf16 v[116:119], v[188:191], v[64:67], v[116:119]
    v_mfma_f32_16x16x32_bf16 v[120:123], v[184:187], v[68:71], v[120:123]
    v_mfma_f32_16x16x32_bf16 v[124:127], v[188:191], v[68:71], v[124:127]
    v_mfma_f32_16x16x32_bf16 v[112:115], v[184:187], v[72:75], v[112:115]
    v_mfma_f32_16x16x32_bf16 v[116:119], v[188:191], v[72:75], v[116:119]
    v_mfma_f32_16x16x32_bf16 v[120:123], v[184:187], v[76:79], v[120:123]
    v_mfma_f32_16x16x32_bf16 v[124:127], v[188:191], v[76:79], v[124:127]
    v_mfma_f32_16x16x32_bf16 v[112:115], v[184:187], v[80:83], v[112:115]
    v_mfma_f32_16x16x32_bf16 v[116:119], v[188:191], v[80:83], v[116:119]
    v_mfma_f32_16x16x32_bf16 v[120:123], v[184:187], v[84:87], v[120:123]
    v_mfma_f32_16x16x32_bf16 v[124:127], v[188:191], v[84:87], v[124:127]
    v_mfma_f32_16x16x32_bf16 v[112:115], v[184:187], v[88:91], v[112:115]
    v_mfma_f32_16x16x32_bf16 v[116:119], v[188:191], v[88:91], v[116:119]
    v_mfma_f32_16x16x32_bf16 v[120:123], v[184:187], v[92:95], v[120:123]
    v_mfma_f32_16x16x32_bf16 v[124:127], v[188:191], v[92:95], v[124:127]
    v_mfma_f32_16x16x32_bf16 v[112:115], v[184:187], v[96:99], v[112:115]
    v_mfma_f32_16x16x32_bf16 v[116:119], v[188:191], v[96:99], v[116:119]
    v_mfma_f32_16x16x32_bf16 v[120:123], v[184:187], v[100:103], v[120:123]
    v_mfma_f32_16x16x32_bf16 v[124:127], v[188:191], v[100:103], v[124:127]
    v_mfma_f32_16x16x32_bf16 v[112:115], v[184:187], v[104:107], v[112:115]
    v_mfma_f32_16x16x32_bf16 v[116:119], v[188:191], v[104:107], v[116:119]
    v_mfma_f32_16x16x32_bf16 v[120:123], v[184:187], v[108:111], v[120:123]
    v_mfma_f32_16x16x32_bf16 v[124:127], v[188:191], v[108:111], v[124:127]
ev_loop:
    s_mov_b32 s59, 0
    s_cmp_ge_u32 s80, 0xff00
    s_cbranch_scc1 ev_own
    s_cmp_eq_u32 s43, s7
    s_addc_u32 s59, s59, s59
    s_cmp_eq_u32 s42, s7
    s_addc_u32 s59, s59, s59
    s_cmp_eq_u32 s41, s7
    s_addc_u32 s59, s59, s59
    s_cmp_eq_u32 s40, s7
    s_addc_u32 s59, s59, s59
    s_cmp_eq_u32 s39, s7
    s_addc_u32 s59, s59, s59
    s_cmp_eq_u32 s38, s7
    s_addc_u32 s59, s59, s59
    s_cmp_eq_u32 s37, s7
    s_addc_u32 s59, s59, s59
    s_cmp_eq_u32 s36, s7
    s_addc_u32 s59, s59, s59
ev_own:
    s_cmp_eq_u32 s35, s7
    s_addc_u32 s59, s59, s59
    s_cmp_eq_u32 s34, s7
    s_addc_u32 s59, s59, s59
    s_cmp_eq_u32 s33, s7
    s_addc_u32 s59, s59, s59
    s_cmp_eq_u32 s32, s7
    s_addc_u32 s59, s59, s59
    s_cmp_eq_u32 s31, s7
    s_addc_u32 s59, s59, s59
    s_cmp_eq_u32 s30, s7
    s_addc_u32 s59, s59, s59
    s_cmp_eq_u32 s29, s7
    s_addc_u32 s59, s59, s59
    s_cmp_eq_u32 s28, s7
    s_addc_u32 s59, s59, s59
    s_andn2_b32 s59, s59, s80
    s_cbranch_scc0 ev_issued
    s_or_b32 s80, s80, s59
    s_or_b32 s60, s60, s59
    s_mov_b32 s47, 0
    s_bitcmp1_b32 s59, 1
    s_cbranch_scc0 ev_i1
    s_xor_b32 s81, s53, 1
    s_mul_i32 s81, s81, 2622464
    s_add_u32 s81, s81, s48
    buffer_load_dwordx4 v[176:179], v14, s[24:27], s81 offen offset:0 sc1
    buffer_load_dwordx4 v[180:183], v14, s[24:27], s81 offen offset:1024 sc1
ev_i1:
    s_bitcmp1_b32 s59, 2
    s_cbranch_scc0 ev_i2
    s_xor_b32 s81, s53, 2
    s_mul_i32 s81, s81, 2622464
    s_add_u32 s81, s81, s48
    buffer_load_dwordx4 v[160:163], v14, s[24:27], s81 offen offset:0 sc1
    buffer_load_dwordx4 v[164:167], v14, s[24:27], s81 offen offset:1024 sc1
ev_i2:
    s_bitcmp1_b32 s59, 3
    s_cbranch_scc0 ev_i3
    s_xor_b32 s81, s53, 3
    s_mul_i32 s81, s81, 2622464
    s_add_u32 s81, s81, s48
    buffer_load_dwordx4 v[168:171], v14, s[24:27], s81 offen offset:0 sc1
    buffer_load_dwordx4 v[172:175], v14, s[24:27], s81 offen offset:1024 sc1
ev_i3:
    s_lshr_b32 s56, s59, 4
    s_cbranch_scc0 ev_issued
    s_bitcmp1_b32 s59, 4
    s_cbranch_scc0 ev_i4
    s_xor_b32 s81, s53, 4
    s_mul_i32 s81, s81, 2622464
    s_add_u32 s81, s81, s48
    buffer_load_dwordx4 v[144:147], v14, s[24:27], s81 offen offset:0 sc1
    buffer_load_dwordx4 v[148:151], v14, s[24:27], s81 offen offset:1024 sc1
ev_i4:
    s_bitcmp1_b32 s59, 5
    s_cbranch_scc0 ev_i5
    s_xor_b32 s81, s53, 5
    s_mul_i32 s81, s81, 2622464
    s_add_u32 s81, s81, s48
    buffer_load_dwordx4 v[152:155], v14, s[24:27], s81 offen offset:0 sc1
    buffer_load_dwordx4 v[156:159], v14, s[24:27], s81 offen offset:1024 sc1
ev_i5:
    s_bitcmp1_b32 s59, 6
    s_cbranch_scc0 ev_i6
    s_xor_b32 s81, s53, 6
    s_mul_i32 s81, s81, 2622464
    s_add_u32 s81, s81, s48
    buffer_load_dwordx4 v[128:131], v14, s[24:27], s81 offen offset:0 sc1
    buffer_load_dwordx4 v[132:135], v14, s[24:27], s81 offen offset:1024 sc1
ev_i6:
    s_bitcmp1_b32 s59, 7
    s_cbranch_scc0 ev_i7
    s_xor_b32 s81, s53, 7
    s_mul_i32 s81, s81, 2622464
    s_add_u32 s81, s81, s48
    buffer_load_dwordx4 v[136:139], v14, s[24:27], s81 offen offset:0 sc1
    buffer_load_dwordx4 v[140:143], v14, s[24:27], s81 offen offset:1024 sc1
ev_i7:
    s_lshr_b32 s56, s59, 9
    s_cbranch_scc0 ev_issued
    s_bitcmp1_b32 s59, 9
    s_cbranch_scc0 ev_i9
    s_xor_b32 s81, s53, 1
    s_mul_i32 s81, s81, 2622464
    s_add_u32 s81, s81, s63
    buffer_load_dwordx4 v[56:59], v14, s[24:27], s81 offen offset:0 sc1
    buffer_load_dwordx4 v[60:63], v14, s[24:27], s81 offen offset:1024 sc1
ev_i9:
    s_bitcmp1_b32 s59, 10
    s_cbranch_scc0 ev_i10
    s_xor_b32 s81, s53, 2
    s_mul_i32 s81, s81, 2622464
    s_add_u32 s81, s81, s63
    buffer_load_dwordx4 v[64:67], v14, s[24:27], s81 offen offset:0 sc1
    buffer_load_dwordx4 v[68:71], v14, s[24:27], s81 offen offset:1024 sc1
ev_i10:
    s_bitcmp1_b32 s59, 11
    s_cbranch_scc0 ev_i11
    s_xor_b32 s81, s53, 3
    s_mul_i32 s81, s81, 2622464
    s_add_u32 s81, s81, s63
    buffer_load_dwordx4 v[72:75], v14, s[24:27], s81 offen offset:0 sc1
    buffer_load_dwordx4 v[76:79], v14, s[24:27], s81 offen offset:1024 sc1
ev_i11:
    s_bitcmp1_b32 s59, 12
    s_cbranch_scc0 ev_i12
    s_xor_b32 s81, s53, 4
    s_mul_i32 s81, s81, 2622464
    s_add_u32 s81, s81, s63
    buffer_load_dwordx4 v[80:83], v14, s[24:27], s81 offen offset:0 sc1
    buffer_load_dwordx4 v[84:87], v14, s[24:27], s81 offen offset:1024 sc1
ev_i12:
    s_bitcmp1_b32 s59, 13
    s_cbranch_scc0 ev_i13
    s_xor_b32 s81, s53, 5
    s_mul_i32 s81, s81, 2622464
    s_add_u32 s81, s81, s63
    buffer_load_dwordx4 v[88:91], v14, s[24:27], s81 offen offset:0 sc1
    buffer_load_dwordx4 v[92:95], v14, s[24:27], s81 offen offset:1024 sc1
ev_i13:
    s_bitcmp1_b32 s59, 14
    s_cbranch_scc0 ev_i14
    s_xor_b32 s81, s53, 6
    s_mul_i32 s81, s81, 2622464
    s_add_u32 s81, s81, s63
    buffer_load_dwordx4 v[96:99], v14, s[24:27], s81 offen offset:0 sc1
    buffer_load_dwordx4 v[100:103], v14, s[24:27], s81 offen offset:1024 sc1
ev_i14:
    s_bitcmp1_b32 s59, 15
    s_cbranch_scc0 ev_i15
    s_xor_b32 s81, s53, 7
    s_mul_i32 s81, s81, 2622464
    s_add_u32 s81, s81, s63
    buffer_load_dwordx4 v[104:107], v14, s[24:27], s81 offen offset:0 sc1
    buffer_load_dwordx4 v[108:111], v14, s[24:27], s81 offen offset:1024 sc1
ev_i15:
ev_issued:
    s_cmp_eq_u32 s80, 0xffff
    s_cbranch_scc1 ev_acc
    s_load_dwordx16 s[28:43], s[86:87], s67 glc
    s_add_u32 s101, s101, 1
    s_cmp_gt_u32 s101, 0x2000000
    s_cbranch_scc1 ev_done
    s_sleep 4
    s_add_u32 s47, s47, 1
    s_cmp_eq_u32 s47, 3
    s_cbranch_scc0 ev_loop
ev_acc:
    s_waitcnt vmcnt(0)
    s_or_b32 s79, s79, s60
    s_bitcmp1_b32 s60, 1
    s_cbranch_scc0 ev_s1
    v_mfma_f32_16x16x32_bf16 v[240:243], v[184:187], v[176:179], v[240:243]
    v_mfma_f32_16x16x32_bf16 v[244:247], v[188:191], v[176:179], v[244:247]
    v_mfma_f32_16x16x32_bf16 v[248:251], v[184:187], v[180:183], v[248:251]
    v_mfma_f32_16x16x32_bf16 v[252:255], v[188:191], v[180:183], v[252:255]
ev_s1:
    s_bitcmp1_b32 s60, 2
    s_cbranch_scc0 ev_s2
    v_mfma_f32_16x16x32_bf16 v[240:243], v[184:187], v[160:163], v[240:243]
    v_mfma_f32_16x16x32_bf16 v[244:247], v[188:191], v[160:163], v[244:247]
    v_mfma_f32_16x16x32_bf16 v[248:251], v[184:187], v[164:167], v[248:251]
    v_mfma_f32_16x16x32_bf16 v[252:255], v[188:191], v[164:167], v[252:255]
ev_s2:
    s_bitcmp1_b32 s60, 3
    s_cbranch_scc0 ev_s3
    v_mfma_f32_16x16x32_bf16 v[240:243], v[184:187], v[168:171], v[240:243]
    v_mfma_f32_16x16x32_bf16 v[244:247], v[188:191], v[168:171], v[244:247]
    v_mfma_f32_16x16x32_bf16 v[248:251], v[184:187], v[172:175], v[248:251]
    v_mfma_f32_16x16x32_bf16 v[252:255], v[188:191], v[172:175], v[252:255]
ev_s3:
    s_lshr_b32 s56, s60, 4
    s_cbranch_scc0 ev_summed
    s_bitcmp1_b32 s60, 4
    s_cbranch_scc0 ev_s4
    v_mfma_f32_16x16x32_bf16 v[240:243], v[184:187], v[144:147], v[240:243]
    v_mfma_f32_16x16x32_bf16 v[244:247], v[188:191], v[144:147], v[244:247]
    v_mfma_f32_16x16x32_bf16 v[248:251], v[184:187], v[148:151], v[248:251]
    v_mfma_f32_16x16x32_bf16 v[252:255], v[188:191], v[148:151], v[252:255]
ev_s4:
    s_bitcmp1_b32 s60, 5
    s_cbranch_scc0 ev_s5
    v_mfma_f32_16x16x32_bf16 v[240:243], v[184:187], v[152:155], v[240:243]
    v_mfma_f32_16x16x32_bf16 v[244:247], v[188:191], v[152:155], v[244:247]
    v_mfma_f32_16x16x32_bf16 v[248:251], v[184:187], v[156:159], v[248:251]
    v_mfma_f32_16x16x32_bf16 v[252:255], v[188:191], v[156:159], v[252:255]
ev_s5:
    s_bitcmp1_b32 s60, 6
    s_cbranch_scc0 ev_s6
    v_mfma_f32_16x16x32_bf16 v[240:243], v[184:187], v[128:131], v[240:243]
    v_mfma_f32_16x16x32_bf16 v[244:247], v[188:191], v[128:131], v[244:247]
    v_mfma_f32_16x16x32_bf16 v[248:251], v[184:187], v[132:135], v[248:251]
    v_mfma_f32_16x16x32_bf16 v[252:255], v[188:191], v[132:135], v[252:255]
ev_s6:
    s_bitcmp1_b32 s60, 7
    s_cbranch_scc0 ev_s7
    v_mfma_f32_16x16x32_bf16 v[240:243], v[184:187], v[136:139], v[240:243]
    v_mfma_f32_16x16x32_bf16 v[244:247], v[188:191], v[136:139], v[244:247]
    v_mfma_f32_16x16x32_bf16 v[248:251], v[184:187], v[140:143], v[248:251]
    v_mfma_f32_16x16x32_bf16 v[252:255], v[188:191], v[140:143], v[252:255]
ev_s7:
    s_lshr_b32 s56, s60, 9
    s_cbranch_scc0 ev_summed
    s_bitcmp1_b32 s60, 9
    s_cbranch_scc0 ev_s9
    v_mfma_f32_16x16x32_bf16 v[112:115], v[184:187], v[56:59], v[112:115]
    v_mfma_f32_16x16x32_bf16 v[116:119], v[188:191], v[56:59], v[116:119]
    v_mfma_f32_16x16x32_bf16 v[120:123], v[184:187], v[60:63], v[120:123]
    v_mfma_f32_16x16x32_bf16 v[124:127], v[188:191], v[60:63], v[124:127]
ev_s9:
    s_bitcmp1_b32 s60, 10
    s_cbranch_scc0 ev_s10
    v_mfma_f32_16x16x32_bf16 v[112:115], v[184:187], v[64:67], v[112:115]
    v_mfma_f32_16x16x32_bf16 v[116:119], v[188:191], v[64:67], v[116:119]
    v_mfma_f32_16x16x32_bf16 v[120:123], v[184:187], v[68:71], v[120:123]
    v_mfma_f32_16x16x32_bf16 v[124:127], v[188:191], v[68:71], v[124:127]
ev_s10:
    s_bitcmp1_b32 s60, 11
    s_cbranch_scc0 ev_s11
    v_mfma_f32_16x16x32_bf16 v[112:115], v[184:187], v[72:75], v[112:115]
    v_mfma_f32_16x16x32_bf16 v[116:119], v[188:191], v[72:75], v[116:119]
    v_mfma_f32_16x16x32_bf16 v[120:123], v[184:187], v[76:79], v[120:123]
    v_mfma_f32_16x16x32_bf16 v[124:127], v[188:191], v[76:79], v[124:127]
ev_s11:
    s_bitcmp1_b32 s60, 12
    s_cbranch_scc0 ev_s12
    v_mfma_f32_16x16x32_bf16 v[112:115], v[184:187], v[80:83], v[112:115]
    v_mfma_f32_16x16x32_bf16 v[116:119], v[188:191], v[80:83], v[116:119]
    v_mfma_f32_16x16x32_bf16 v[120:123], v[184:187], v[84:87], v[120:123]
    v_mfma_f32_16x16x32_bf16 v[124:127], v[188:191], v[84:87], v[124:127]
ev_s12:
    s_bitcmp1_b32 s60, 13
    s_cbranch_scc0 ev_s13
    v_mfma_f32_16x16x32_bf16 v[112:115], v[184:187], v[88:91], v[112:115]
    v_mfma_f32_16x16x32_bf16 v[116:119], v[188:191], v[88:91], v[116:119]
    v_mfma_f32_16x16x32_bf16 v[120:123], v[184:187], v[92:95], v[120:123]
    v_mfma_f32_16x16x32_bf16 v[124:127], v[188:191], v[92:95], v[124:127]
ev_s13:
    s_bitcmp1_b32 s60, 14
    s_cbranch_scc0 ev_s14
    v_mfma_f32_16x16x32_bf16 v[112:115], v[184:187], v[96:99], v[112:115]
    v_mfma_f32_16x16x32_bf16 v[116:119], v[188:191], v[96:99], v[116:119]
    v_mfma_f32_16x16x32_bf16 v[120:123], v[184:187], v[100:103], v[120:123]
    v_mfma_f32_16x16x32_bf16 v[124:127], v[188:191], v[100:103], v[124:127]
ev_s14:
    s_bitcmp1_b32 s60, 15
    s_cbranch_scc0 ev_s15
    v_mfma_f32_16x16x32_bf16 v[112:115], v[184:187], v[104:107], v[112:115]
    v_mfma_f32_16x16x32_bf16 v[116:119], v[188:191], v[104:107], v[116:119]
    v_mfma_f32_16x16x32_bf16 v[120:123], v[184:187], v[108:111], v[120:123]
    v_mfma_f32_16x16x32_bf16 v[124:127], v[188:191], v[108:111], v[124:127]
ev_s15:
ev_summed:
    s_mov_b32 s60, 0
    s_cmp_lg_u32 s46, 0
    s_cbranch_scc1 routed
routed_ret:
    s_bfe_u32 s56, s79, 524288
    s_cmp_eq_u32 s56, 0xff
    s_cbranch_scc0 ev_f0
    s_bitcmp1_b32 s78, 0
    s_cbranch_scc1 ev_f0
    s_bitset1_b32 s78, 0
    v_pk_fma_f32 v[240:241], v[240:241], v[208:209], v[192:193]
    v_pk_fma_f32 v[242:243], v[242:243], v[210:211], v[194:195]
    v_pk_fma_f32 v[244:245], v[244:245], v[212:213], v[196:197]
    v_pk_fma_f32 v[246:247], v[246:247], v[214:215], v[198:199]
    v_cvt_pk_bf16_f32 v240, v240, v241
    v_cvt_pk_bf16_f32 v241, v242, v243
    v_cvt_pk_bf16_f32 v242, v244, v245
    v_cvt_pk_bf16_f32 v243, v246, v247
    s_nop 1
    v_permlane16_swap_b32 v240, v242
    v_permlane16_swap_b32 v241, v243
    buffer_store_dwordx4 v[240:243], v4, s[16:19], s64 offen sc1
    v_pk_fma_f32 v[248:249], v[248:249], v[216:217], v[200:201]
    v_pk_fma_f32 v[250:251], v[250:251], v[218:219], v[202:203]
    v_pk_fma_f32 v[252:253], v[252:253], v[220:221], v[204:205]
    v_pk_fma_f32 v[254:255], v[254:255], v[222:223], v[206:207]
    v_cvt_pk_bf16_f32 v248, v248, v249
    v_cvt_pk_bf16_f32 v249, v250, v251
    v_cvt_pk_bf16_f32 v250, v252, v253
    v_cvt_pk_bf16_f32 v251, v254, v255
    s_nop 1
    v_permlane16_swap_b32 v248, v250
    v_permlane16_swap_b32 v249, v251
    buffer_store_dwordx4 v[248:251], v4, s[16:19], s65 offen sc1
ev_f0:
    s_bfe_u32 s56, s79, 524296
    s_cmp_eq_u32 s56, 0xff
    s_cbranch_scc0 ev_f1
    s_bitcmp1_b32 s78, 1
    s_cbranch_scc1 ev_f1
    s_bitset1_b32 s78, 1
    v_lshlrev_b32 v56, 16, v32
    v_and_b32 v57, 0xffff0000, v32
    v_lshlrev_b32 v72, 16, v48
    v_and_b32 v73, 0xffff0000, v48
    v_lshlrev_b32 v58, 16, v33
    v_and_b32 v59, 0xffff0000, v33
    v_lshlrev_b32 v74, 16, v49
    v_and_b32 v75, 0xffff0000, v49
    v_lshlrev_b32 v60, 16, v34
    v_and_b32 v61, 0xffff0000, v34
    v_lshlrev_b32 v76, 16, v50
    v_and_b32 v77, 0xffff0000, v50
    v_lshlrev_b32 v62, 16, v35
    v_and_b32 v63, 0xffff0000, v35
    v_lshlrev_b32 v78, 16, v51
    v_and_b32 v79, 0xffff0000, v51
    v_lshlrev_b32 v64, 16, v36
    v_and_b32 v65, 0xffff0000, v36
    v_lshlrev_b32 v80, 16, v52
    v_and_b32 v81, 0xffff0000, v52
    v_lshlrev_b32 v66, 16, v37
    v_and_b32 v67, 0xffff0000, v37
    v_lshlrev_b32 v82, 16, v53
    v_and_b32 v83, 0xffff0000, v53
    v_lshlrev_b32 v68, 16, v38
    v_and_b32 v69, 0xffff0000, v38
    v_lshlrev_b32 v84, 16, v54
    v_and_b32 v85, 0xffff0000, v54
    v_lshlrev_b32 v70, 16, v39
    v_and_b32 v71, 0xffff0000, v39
    v_lshlrev_b32 v86, 16, v55
    v_and_b32 v87, 0xffff0000, v55
    v_pk_fma_f32 v[112:113], v[112:113], v[72:73], v[56:57]
    v_pk_fma_f32 v[114:115], v[114:115], v[74:75], v[58:59]
    v_pk_fma_f32 v[116:117], v[116:117], v[76:77], v[60:61]
    v_pk_fma_f32 v[118:119], v[118:119], v[78:79], v[62:63]
    v_cvt_pk_bf16_f32 v112, v112, v113
    v_cvt_pk_bf16_f32 v113, v114, v115
    v_cvt_pk_bf16_f32 v114, v116, v117
    v_cvt_pk_bf16_f32 v115, v118, v119
    s_nop 1
    v_permlane16_swap_b32 v112, v114
    v_permlane16_swap_b32 v113, v115
    buffer_store_dwordx4 v[112:115], v4, s[16:19], s68 offen sc1
    v_pk_fma_f32 v[120:121], v[120:121], v[80:81], v[64:65]
    v_pk_fma_f32 v[122:123], v[122:123], v[82:83], v[66:67]
    v_pk_fma_f32 v[124:125], v[124:125], v[84:85], v[68:69]
    v_pk_fma_f32 v[126:127], v[126:127], v[86:87], v[70:71]
    v_cvt_pk_bf16_f32 v120, v120, v121
    v_cvt_pk_bf16_f32 v121, v122, v123
    v_cvt_pk_bf16_f32 v122, v124, v125
    v_cvt_pk_bf16_f32 v123, v126, v127
    s_nop 1
    v_permlane16_swap_b32 v120, v122
    v_permlane16_swap_b32 v121, v123
    buffer_store_dwordx4 v[120:123], v4, s[16:19], s69 offen sc1
ev_f1:
    s_cmp_eq_u32 s78, 3
    s_cbranch_scc0 ev_loop
ev_done:
    s_or_b32 s56, s2, s3
    s_cmp_eq_u32 s56, 0
    s_cselect_b32 s56, 0, 0x7ffffff0
    s_add_u32 s56, s56, 3203072
    buffer_store_dword v6, v15, s[24:27], s56 offen
main_fin:
main_end:
    s_endpgm
spin_o0:
    s_load_dwordx4 s[72:75], s[86:87], s5 glc
    s_add_u32 s101, s101, 1
    s_cmp_gt_u32 s101, 0x2000000
    s_waitcnt lgkmcnt(0)
    s_cbranch_scc1 spin_o0_ret
    s_sub_u32 s78, s72, s77
    s_sub_u32 s79, s73, s77
    s_max_u32 s78, s78, s79
    s_sub_u32 s79, s74, s77
    s_max_u32 s78, s78, s79
    s_sub_u32 s79, s75, s77
    s_max_u32 s78, s78, s79
    s_cmp_gt_u32 s78, 5
    s_cbranch_scc1 spin_o0
    s_branch spin_o0_ret
spin_o1:
    s_load_dwordx4 s[72:75], s[86:87], s5 glc
    s_add_u32 s101, s101, 1
    s_cmp_gt_u32 s101, 0x2000000
    s_waitcnt lgkmcnt(0)
    s_cbranch_scc1 spin_o1_ret
    s_sub_u32 s78, s72, s77
    s_sub_u32 s79, s73, s77
    s_max_u32 s78, s78, s79
    s_sub_u32 s79, s74, s77
    s_max_u32 s78, s78, s79
    s_sub_u32 s79, s75, s77
    s_max_u32 s78, s78, s79
    s_cmp_gt_u32 s78, 4
    s_cbranch_scc1 spin_o1
    s_branch spin_o1_ret
spin_o2:
    s_load_dwordx4 s[72:75], s[86:87], s5 glc
    s_add_u32 s101, s101, 1
    s_cmp_gt_u32 s101, 0x2000000
    s_waitcnt lgkmcnt(0)
    s_cbranch_scc1 spin_o2_ret
    s_sub_u32 s78, s72, s77
    s_sub_u32 s79, s73, s77
    s_max_u32 s78, s78, s79
    s_sub_u32 s79, s74, s77
    s_max_u32 s78, s78, s79
    s_sub_u32 s79, s75, s77
    s_max_u32 s78, s78, s79
    s_cmp_gt_u32 s78, 3
    s_cbranch_scc1 spin_o2
    s_branch spin_o2_ret
spin_o3:
    s_load_dwordx4 s[72:75], s[86:87], s5 glc
    s_add_u32 s101, s101, 1
    s_cmp_gt_u32 s101, 0x2000000
    s_waitcnt lgkmcnt(0)
    s_cbranch_scc1 spin_o3_ret
    s_sub_u32 s78, s72, s77
    s_sub_u32 s79, s73, s77
    s_max_u32 s78, s78, s79
    s_sub_u32 s79, s74, s77
    s_max_u32 s78, s78, s79
    s_sub_u32 s79, s75, s77
    s_max_u32 s78, s78, s79
    s_cmp_gt_u32 s78, 2
    s_cbranch_scc1 spin_o3
    s_branch spin_o3_ret
spin_o4:
    s_load_dwordx4 s[72:75], s[86:87], s5 glc
    s_add_u32 s101, s101, 1
    s_cmp_gt_u32 s101, 0x2000000
    s_waitcnt lgkmcnt(0)
    s_cbranch_scc1 spin_o4_ret
    s_sub_u32 s78, s72, s77
    s_sub_u32 s79, s73, s77
    s_max_u32 s78, s78, s79
    s_sub_u32 s79, s74, s77
    s_max_u32 s78, s78, s79
    s_sub_u32 s79, s75, s77
    s_max_u32 s78, s78, s79
    s_cmp_gt_u32 s78, 1
    s_cbranch_scc1 spin_o4
    s_branch spin_o4_ret
spin_o5:
    s_load_dwordx4 s[72:75], s[86:87], s5 glc
    s_add_u32 s101, s101, 1
    s_cmp_gt_u32 s101, 0x2000000
    s_waitcnt lgkmcnt(0)
    s_cbranch_scc1 spin_o5_ret
    s_sub_u32 s78, s72, s77
    s_sub_u32 s79, s73, s77
    s_max_u32 s78, s78, s79
    s_sub_u32 s79, s74, s77
    s_max_u32 s78, s78, s79
    s_sub_u32 s79, s75, s77
    s_max_u32 s78, s78, s79
    s_cmp_gt_u32 s78, 0
    s_cbranch_scc1 spin_o5
    s_branch spin_o5_ret
routed_a:
    v_xor_b32 v22, s7, v22
    v_xor_b32 v23, s7, v23
    v_or_b32 v22, v22, v23
    v_cmp_ne_u32 vcc, 0, v22
    s_cbranch_vccnz spin_y
spin_y_ret:
    v_cmp_lt_u32 vcc, 31, v1
    v_mov_b32 v2, s70
    v_mov_b32 v5, s71
    v_cndmask_b32 v2, v2, v5, vcc
    v_and_b32 v12, 8, v1
    v_mov_b32 v5, s64
    v_mov_b32 v13, s68
    v_cmp_ne_u32 vcc, 0, v12
    s_nop 1
    v_cndmask_b32 v5, v5, v13, vcc
    v_and_b32 v13, 7, v1
    v_lshl_add_u32 v5, v13, 3, v5
    v_lshrrev_b32 v12, 5, v1
    v_bfe_u32 v13, v1, 4, 1
    v_lshl_add_u32 v12, v13, 1, v12
    v_mul_u32_u24 v12, 2560, v12
    v_lshl_add_u32 v21, v5, 1, v12
    s_mov_b32 s56, 3670016
    buffer_load_dwordx4 v[192:195], v21, s[24:27], s56 offen sc1
    s_add_u32 s56, s56, 10240
    buffer_load_dwordx4 v[196:199], v21, s[24:27], s56 offen sc1
    s_add_u32 s56, s56, 10240
    buffer_load_dwordx4 v[200:203], v21, s[24:27], s56 offen sc1
    s_add_u32 s56, s56, 10240
    buffer_load_dwordx4 v[204:207], v21, s[24:27], s56 offen sc1
    s_add_u32 s56, s56, 10240
    buffer_load_dwordx4 v[208:211], v21, s[24:27], s56 offen sc1
    s_add_u32 s56, s56, 10240
    buffer_load_dwordx4 v[212:215], v21, s[24:27], s56 offen sc1
    s_add_u32 s56, s56, 10240
    buffer_load_dwordx4 v[216:219], v21, s[24:27], s56 offen sc1
    s_add_u32 s56, s56, 10240
    buffer_load_dwordx4 v[220:223], v21, s[24:27], s56 offen sc1
    s_add_u32 s56, s56, 10240
    buffer_load_dwordx4 v[224:227], v21, s[24:27], s56 offen sc1
    s_add_u32 s56, s56, 10240
    buffer_load_dwordx4 v[228:231], v21, s[24:27], s56 offen sc1
    s_add_u32 s56, s56, 10240
    buffer_load_dwordx4 v[232:235], v21, s[24:27], s56 offen sc1
    s_add_u32 s56, s56, 10240
    buffer_load_dwordx4 v[236:239], v21, s[24:27], s56 offen sc1
    s_add_u32 s56, s56, 10240
    v_and_b32 v12, 0x7ff, v2
    v_sub_u32 v12, 2047, v12
    v_mul_u32_u24 v13, 1280, v12
    v_add_u32 v13, v13, v5
    v_lshlrev_b32 v12, 3, v12
    s_mov_b32 s57, 3211264
    buffer_load_dwordx2 v[8:9], v13, s[12:15], 0 offen
    buffer_load_dwordx2 v[10:11], v12, s[24:27], s57 offen sc1
    v_and_b32 v2, 0xffff0000, v2
    v_ashrrev_i32 v12, 31, v2
    v_not_b32 v12, v12
    v_or_b32 v12, 0x80000000, v12
    v_xor_b32 v2, v2, v12
    v_and_b32 v2, 0xffff0000, v2
    v_mul_f32 v2, s92, v2
    v_exp_f32 v2, v2
    s_nop 0
    v_add_f32 v2, 1.0, v2
    v_rcp_f32 v2, v2
    s_nop 0
    v_cvt_pk_bf16_f32 v2, v2, v2
    v_and_b32 v2, 0xffff0000, v2
    s_lshl_b32 s56, s3, 9
    s_add_u32 s56, s56, 61440
    v_lshlrev_b32 v12, 3, v1
    v_add_u32 v12, s56, v12
    v_lshrrev_b32 v13, 4, v1
    v_lshlrev_b32 v13, 3, v13
    v_add_u32 v13, s56, v13
    v_add_u32 v21, 256, v13
    v_cndmask_b32 v22, v13, v21, s[20:21]
    v_cndmask_b32 v23, v13, v21, s[22:23]
    s_branch routed_a_ret
routed:
    v_pk_add_f32 v[192:193], v[192:193], v[196:197]
    v_pk_add_f32 v[194:195], v[194:195], v[198:199]
    v_pk_add_f32 v[192:193], v[192:193], v[200:201]
    v_pk_add_f32 v[194:195], v[194:195], v[202:203]
    v_pk_add_f32 v[192:193], v[192:193], v[204:205]
    v_pk_add_f32 v[194:195], v[194:195], v[206:207]
    v_pk_add_f32 v[192:193], v[192:193], v[208:209]
    v_pk_add_f32 v[194:195], v[194:195], v[210:211]
    v_pk_add_f32 v[192:193], v[192:193], v[212:213]
    v_pk_add_f32 v[194:195], v[194:195], v[214:215]
    v_pk_add_f32 v[192:193], v[192:193], v[216:217]
    v_pk_add_f32 v[194:195], v[194:195], v[218:219]
    v_pk_add_f32 v[192:193], v[192:193], v[220:221]
    v_pk_add_f32 v[194:195], v[194:195], v[222:223]
    v_pk_add_f32 v[192:193], v[192:193], v[224:225]
    v_pk_add_f32 v[194:195], v[194:195], v[226:227]
    v_pk_add_f32 v[192:193], v[192:193], v[228:229]
    v_pk_add_f32 v[194:195], v[194:195], v[230:231]
    v_pk_add_f32 v[192:193], v[192:193], v[232:233]
    v_pk_add_f32 v[194:195], v[194:195], v[234:235]
    v_pk_add_f32 v[192:193], v[192:193], v[236:237]
    v_pk_add_f32 v[194:195], v[194:195], v[238:239]
    v_mov_b32 v196, v192
    v_mov_b32 v197, v193
    v_mov_b32 v198, v194
    v_mov_b32 v199, v195
    v_lshlrev_b32 v16, 16, v8
    v_and_b32 v17, 0xffff0000, v8
    v_lshlrev_b32 v18, 16, v9
    v_and_b32 v19, 0xffff0000, v9
    v_permlane16_swap_b32 v192, v196
    v_permlane16_swap_b32 v193, v197
    v_permlane16_swap_b32 v194, v198
    v_permlane16_swap_b32 v195, v199
    v_sub_f32 v16, v16, v10
    v_cvt_pk_bf16_f32 v16, v16, v16
    v_and_b32 v16, 0xffff0000, v16
    v_mul_f32 v16, v16, v11
    v_cvt_pk_bf16_f32 v16, v16, v16
    v_and_b32 v16, 0xffff0000, v16
    v_sub_f32 v17, v17, v10
    v_cvt_pk_bf16_f32 v17, v17, v17
    v_and_b32 v17, 0xffff0000, v17
    v_mul_f32 v17, v17, v11
    v_cvt_pk_bf16_f32 v17, v17, v17
    v_and_b32 v17, 0xffff0000, v17
    v_sub_f32 v18, v18, v10
    v_cvt_pk_bf16_f32 v18, v18, v18
    v_and_b32 v18, 0xffff0000, v18
    v_mul_f32 v18, v18, v11
    v_cvt_pk_bf16_f32 v18, v18, v18
    v_and_b32 v18, 0xffff0000, v18
    v_sub_f32 v19, v19, v10
    v_cvt_pk_bf16_f32 v19, v19, v19
    v_and_b32 v19, 0xffff0000, v19
    v_mul_f32 v19, v19, v11
    v_cvt_pk_bf16_f32 v19, v19, v19
    v_and_b32 v19, 0xffff0000, v19
    v_pk_add_f32 v[192:193], v[192:193], v[196:197]
    v_pk_add_f32 v[194:195], v[194:195], v[198:199]
    v_cvt_pk_bf16_f32 v192, v192, v192
    v_and_b32 v192, 0xffff0000, v192
    v_mul_f32 v192, v192, v2
    v_cvt_pk_bf16_f32 v192, v192, v192
    v_and_b32 v192, 0xffff0000, v192
    v_add_f32 v192, v192, v16
    v_cvt_pk_bf16_f32 v192, v192, v192
    v_and_b32 v192, 0xffff0000, v192
    v_mul_f32 v196, s92, v192
    v_cvt_pk_bf16_f32 v193, v193, v193
    v_and_b32 v193, 0xffff0000, v193
    v_mul_f32 v193, v193, v2
    v_cvt_pk_bf16_f32 v193, v193, v193
    v_and_b32 v193, 0xffff0000, v193
    v_add_f32 v193, v193, v17
    v_cvt_pk_bf16_f32 v193, v193, v193
    v_and_b32 v193, 0xffff0000, v193
    v_mul_f32 v197, s92, v193
    v_cvt_pk_bf16_f32 v194, v194, v194
    v_and_b32 v194, 0xffff0000, v194
    v_mul_f32 v194, v194, v2
    v_cvt_pk_bf16_f32 v194, v194, v194
    v_and_b32 v194, 0xffff0000, v194
    v_add_f32 v194, v194, v18
    v_cvt_pk_bf16_f32 v194, v194, v194
    v_and_b32 v194, 0xffff0000, v194
    v_mul_f32 v198, s92, v194
    v_cvt_pk_bf16_f32 v195, v195, v195
    v_and_b32 v195, 0xffff0000, v195
    v_mul_f32 v195, v195, v2
    v_cvt_pk_bf16_f32 v195, v195, v195
    v_and_b32 v195, 0xffff0000, v195
    v_add_f32 v195, v195, v19
    v_cvt_pk_bf16_f32 v195, v195, v195
    v_and_b32 v195, 0xffff0000, v195
    v_mul_f32 v199, s92, v195
    v_exp_f32 v196, v196
    v_exp_f32 v197, v197
    v_exp_f32 v198, v198
    v_exp_f32 v199, v199
    v_add_f32 v196, 1.0, v196
    v_add_f32 v197, 1.0, v197
    v_add_f32 v198, 1.0, v198
    v_add_f32 v199, 1.0, v199
    v_rcp_f32 v196, v196
    v_rcp_f32 v197, v197
    v_rcp_f32 v198, v198
    v_rcp_f32 v199, v199
    v_mul_f32 v192, v192, v196
    v_mul_f32 v193, v193, v197
    v_mul_f32 v194, v194, v198
    v_mul_f32 v195, v195, v199
    v_cvt_pk_bf16_f32 v192, v192, v193
    v_cvt_pk_bf16_f32 v193, v194, v195
    ds_write_b64 v12, v[192:193]
    s_mov_b64 exec, s[8:9]
    ds_read2_b64 v[40:43], v22 offset0:0 offset1:4
    ds_read2_b64 v[48:51], v22 offset0:8 offset1:12
    s_mov_b64 exec, s[10:11]
    ds_read2_b64 v[44:47], v23 offset0:0 offset1:4
    ds_read2_b64 v[52:55], v23 offset0:8 offset1:12
    s_mov_b64 exec, -1
    s_mov_b32 s46, 0
    s_waitcnt lgkmcnt(0)
    v_lshlrev_b32 v192, 16, v24
    v_and_b32 v193, 0xffff0000, v24
    v_lshlrev_b32 v208, 16, v40
    v_and_b32 v209, 0xffff0000, v40
    v_lshlrev_b32 v194, 16, v25
    v_and_b32 v195, 0xffff0000, v25
    v_lshlrev_b32 v210, 16, v41
    v_and_b32 v211, 0xffff0000, v41
    v_lshlrev_b32 v196, 16, v26
    v_and_b32 v197, 0xffff0000, v26
    v_lshlrev_b32 v212, 16, v42
    v_and_b32 v213, 0xffff0000, v42
    v_lshlrev_b32 v198, 16, v27
    v_and_b32 v199, 0xffff0000, v27
    v_lshlrev_b32 v214, 16, v43
    v_and_b32 v215, 0xffff0000, v43
    v_lshlrev_b32 v200, 16, v28
    v_and_b32 v201, 0xffff0000, v28
    v_lshlrev_b32 v216, 16, v44
    v_and_b32 v217, 0xffff0000, v44
    v_lshlrev_b32 v202, 16, v29
    v_and_b32 v203, 0xffff0000, v29
    v_lshlrev_b32 v218, 16, v45
    v_and_b32 v219, 0xffff0000, v45
    v_lshlrev_b32 v204, 16, v30
    v_and_b32 v205, 0xffff0000, v30
    v_lshlrev_b32 v220, 16, v46
    v_and_b32 v221, 0xffff0000, v46
    v_lshlrev_b32 v206, 16, v31
    v_and_b32 v207, 0xffff0000, v31
    v_lshlrev_b32 v222, 16, v47
    v_and_b32 v223, 0xffff0000, v47
    s_branch routed_ret
spin_y:
    s_add_u32 s101, s101, 1
    s_cmp_gt_u32 s101, 0x2000000
    s_cbranch_scc1 spin_y_x
    buffer_load_dword v22, v3, s[24:27], s44 offen sc1
    buffer_load_dword v23, v3, s[24:27], s45 offen sc1
    s_waitcnt vmcnt(0)
    v_xor_b32 v22, s7, v22
    v_xor_b32 v23, s7, v23
    v_or_b32 v22, v22, v23
    v_cmp_ne_u32 vcc, 0, v22
    s_cbranch_vccnz spin_y
spin_y_x:
    s_branch spin_y_ret
spin_rec:
    s_add_u32 s101, s101, 1
    s_cmp_gt_u32 s101, 0x2000000
    s_cbranch_scc1 spin_rec_x
    buffer_load_dwordx4 v[32:35], v17, s[24:27], s47 offen offset:0 sc1
    buffer_load_dwordx4 v[36:39], v17, s[24:27], s47 offen offset:1024 sc1
    buffer_load_dwordx4 v[40:43], v17, s[24:27], s47 offen offset:2048 sc1
    buffer_load_dwordx4 v[44:47], v17, s[24:27], s47 offen offset:3072 sc1
    s_waitcnt vmcnt(0)
    v_xor_b32 v34, s7, v34
    v_xor_b32 v38, s7, v38
    v_xor_b32 v42, s7, v42
    v_xor_b32 v46, s7, v46
    v_or3_b32 v34, v34, v38, v42
    v_or_b32 v34, v34, v46
    v_cmp_ne_u32 vcc, 0, v34
    s_cbranch_vccnz spin_rec
spin_rec_x:
    s_branch spin_rec_ret
spin_gu:
    s_add_u32 s101, s101, 1
    s_cmp_gt_u32 s101, 0x2000000
    s_cbranch_scc1 spin_gu_x
    buffer_load_dword v23, v22, s[24:27], s42 offen sc1
    s_waitcnt vmcnt(0)
    v_cmp_ne_u32 vcc, s7, v23
    s_cbranch_vccnz spin_gu
spin_gu_x:
    s_branch spin_gu_ret
rare:
    s_nop 7
    s_nop 7
    v_and_b32 v21, 15, v1
    v_mul_u32_u24 v21, 384, v21
    v_bfe_u32 v22, v1, 4, 1
    v_bfe_u32 v23, v1, 5, 1
    v_lshl_add_u32 v22, v22, 1, v23
    v_lshl_add_u32 v21, v22, 4, v21
    v_mov_b32 v24, 0
    v_mov_b32 v25, 0
    v_mov_b32 v26, 0
    v_mov_b32 v27, 0
    v_mov_b32 v28, 0
    v_mov_b32 v29, 0
    v_mov_b32 v30, 0
    v_mov_b32 v31, 0
    v_mov_b32 v32, 0
    v_mov_b32 v33, 0
    v_mov_b32 v34, 0
    v_mov_b32 v35, 0
    v_mov_b32 v36, 0
    v_mov_b32 v37, 0
    v_mov_b32 v38, 0
    v_mov_b32 v39, 0
    v_mov_b32 v16, 0xff800000
    v_mov_b32 v17, 0xff800000
    v_mov_b32 v18, 0xff800000
    v_mov_b32 v19, 0xff800000
    s_mov_b32 s78, 0
rare_pass:
    s_mov_b32 s77, 0
rare_loop:
    buffer_load_dwordx4 a[216:219], v21, s[12:15], s77 offen offset:0
    buffer_load_dwordx4 a[220:223], v21, s[12:15], s77 offen offset:64
    buffer_load_dwordx4 a[224:227], v21, s[12:15], s77 offen offset:128
    buffer_load_dwordx4 a[228:231], v21, s[12:15], s77 offen offset:192
    buffer_load_dwordx4 a[232:235], v21, s[12:15], s77 offen offset:256
    buffer_load_dwordx4 a[236:239], v21, s[12:15], s77 offen offset:320
    s_waitcnt vmcnt(0)
    v_mfma_f32_16x16x32_bf16 v[40:43], a[216:219], a[0:3], v[24:27]
    v_mfma_f32_16x16x32_bf16 v[44:47], a[216:219], a[4:7], v[28:31]
    v_mfma_f32_16x16x32_bf16 v[48:51], a[216:219], a[8:11], v[32:35]
    v_mfma_f32_16x16x32_bf16 v[52:55], a[216:219], a[12:15], v[36:39]
    v_mfma_f32_16x16x32_bf16 v[40:43], a[220:223], a[16:19], v[40:43]
    v_mfma_f32_16x16x32_bf16 v[44:47], a[220:223], a[20:23], v[44:47]
    v_mfma_f32_16x16x32_bf16 v[48:51], a[220:223], a[24:27], v[48:51]
    v_mfma_f32_16x16x32_bf16 v[52:55], a[220:223], a[28:31], v[52:55]
    v_mfma_f32_16x16x32_bf16 v[40:43], a[224:227], a[32:35], v[40:43]
    v_mfma_f32_16x16x32_bf16 v[44:47], a[224:227], a[36:39], v[44:47]
    v_mfma_f32_16x16x32_bf16 v[48:51], a[224:227], a[40:43], v[48:51]
    v_mfma_f32_16x16x32_bf16 v[52:55], a[224:227], a[44:47], v[52:55]
    v_mfma_f32_16x16x32_bf16 v[40:43], a[228:231], a[48:51], v[40:43]
    v_mfma_f32_16x16x32_bf16 v[44:47], a[228:231], a[52:55], v[44:47]
    v_mfma_f32_16x16x32_bf16 v[48:51], a[228:231], a[56:59], v[48:51]
    v_mfma_f32_16x16x32_bf16 v[52:55], a[228:231], a[60:63], v[52:55]
    v_mfma_f32_16x16x32_bf16 v[40:43], a[232:235], a[64:67], v[40:43]
    v_mfma_f32_16x16x32_bf16 v[44:47], a[232:235], a[68:71], v[44:47]
    v_mfma_f32_16x16x32_bf16 v[48:51], a[232:235], a[72:75], v[48:51]
    v_mfma_f32_16x16x32_bf16 v[52:55], a[232:235], a[76:79], v[52:55]
    v_mfma_f32_16x16x32_bf16 v[40:43], a[236:239], a[80:83], v[40:43]
    v_mfma_f32_16x16x32_bf16 v[44:47], a[236:239], a[84:87], v[44:47]
    v_mfma_f32_16x16x32_bf16 v[48:51], a[236:239], a[88:91], v[48:51]
    v_mfma_f32_16x16x32_bf16 v[52:55], a[236:239], a[92:95], v[52:55]
    s_nop 7
    s_cmp_eq_u32 s78, 0
    s_cbranch_scc0 rare_p2
    v_max3_f32 v16, v16, v40, v41
    v_max3_f32 v16, v16, v42, v43
    v_max3_f32 v17, v17, v44, v45
    v_max3_f32 v17, v17, v46, v47
    v_max3_f32 v18, v18, v48, v49
    v_max3_f32 v18, v18, v50, v51
    v_max3_f32 v19, v19, v52, v53
    v_max3_f32 v19, v19, v54, v55
    s_add_u32 s77, s77, 6144
    s_cmp_lt_u32 s77, 196608
    s_cbranch_scc1 rare_loop
    v_mov_b32 v22, v16
    s_nop 1
    v_permlane16_swap_b32 v16, v22
    s_nop 1
    v_max_f32 v16, v16, v22
    v_mov_b32 v22, v16
    s_nop 1
    v_permlane32_swap_b32 v16, v22
    s_nop 1
    v_max_f32 v16, v16, v22
    v_sub_f32 v24, 0, v16
    v_sub_f32 v25, 0, v16
    v_sub_f32 v26, 0, v16
    v_sub_f32 v27, 0, v16
    v_mov_b32 v22, v17
    s_nop 1
    v_permlane16_swap_b32 v17, v22
    s_nop 1
    v_max_f32 v17, v17, v22
    v_mov_b32 v22, v17
    s_nop 1
    v_permlane32_swap_b32 v17, v22
    s_nop 1
    v_max_f32 v17, v17, v22
    v_sub_f32 v28, 0, v17
    v_sub_f32 v29, 0, v17
    v_sub_f32 v30, 0, v17
    v_sub_f32 v31, 0, v17
    v_mov_b32 v22, v18
    s_nop 1
    v_permlane16_swap_b32 v18, v22
    s_nop 1
    v_max_f32 v18, v18, v22
    v_mov_b32 v22, v18
    s_nop 1
    v_permlane32_swap_b32 v18, v22
    s_nop 1
    v_max_f32 v18, v18, v22
    v_sub_f32 v32, 0, v18
    v_sub_f32 v33, 0, v18
    v_sub_f32 v34, 0, v18
    v_sub_f32 v35, 0, v18
    v_mov_b32 v22, v19
    s_nop 1
    v_permlane16_swap_b32 v19, v22
    s_nop 1
    v_max_f32 v19, v19, v22
    v_mov_b32 v22, v19
    s_nop 1
    v_permlane32_swap_b32 v19, v22
    s_nop 1
    v_max_f32 v19, v19, v22
    v_sub_f32 v36, 0, v19
    v_sub_f32 v37, 0, v19
    v_sub_f32 v38, 0, v19
    v_sub_f32 v39, 0, v19
    s_mov_b32 s78, 1
    s_branch rare_pass
rare_p2:
    v_exp_f32 v40, v40
    v_exp_f32 v41, v41
    v_exp_f32 v42, v42
    v_exp_f32 v43, v43
    v_exp_f32 v44, v44
    v_exp_f32 v45, v45
    v_exp_f32 v46, v46
    v_exp_f32 v47, v47
    v_exp_f32 v48, v48
    v_exp_f32 v49, v49
    v_exp_f32 v50, v50
    v_exp_f32 v51, v51
    v_exp_f32 v52, v52
    v_exp_f32 v53, v53
    v_exp_f32 v54, v54
    v_exp_f32 v55, v55
    s_cmp_eq_u32 s77, 0
    s_cbranch_scc0 rare_d0
    v_cvt_pk_bf16_f32 v22, v40, v41
    v_cvt_pk_bf16_f32 v23, v42, v43
    v_accvgpr_write_b32 a96, v22
    v_accvgpr_write_b32 a97, v23
    v_cvt_pk_bf16_f32 v22, v44, v45
    v_cvt_pk_bf16_f32 v23, v46, v47
    v_accvgpr_write_b32 a104, v22
    v_accvgpr_write_b32 a105, v23
    v_cvt_pk_bf16_f32 v22, v48, v49
    v_cvt_pk_bf16_f32 v23, v50, v51
    v_accvgpr_write_b32 a112, v22
    v_accvgpr_write_b32 a113, v23
    v_cvt_pk_bf16_f32 v22, v52, v53
    v_cvt_pk_bf16_f32 v23, v54, v55
    v_accvgpr_write_b32 a120, v22
    v_accvgpr_write_b32 a121, v23
rare_d0:
    s_cmp_eq_u32 s77, 6144
    s_cbranch_scc0 rare_d1
    v_cvt_pk_bf16_f32 v22, v40, v41
    v_cvt_pk_bf16_f32 v23, v42, v43
    v_accvgpr_write_b32 a98, v22
    v_accvgpr_write_b32 a99, v23
    v_cvt_pk_bf16_f32 v22, v44, v45
    v_cvt_pk_bf16_f32 v23, v46, v47
    v_accvgpr_write_b32 a106, v22
    v_accvgpr_write_b32 a107, v23
    v_cvt_pk_bf16_f32 v22, v48, v49
    v_cvt_pk_bf16_f32 v23, v50, v51
    v_accvgpr_write_b32 a114, v22
    v_accvgpr_write_b32 a115, v23
    v_cvt_pk_bf16_f32 v22, v52, v53
    v_cvt_pk_bf16_f32 v23, v54, v55
    v_accvgpr_write_b32 a122, v22
    v_accvgpr_write_b32 a123, v23
rare_d1:
    s_cmp_eq_u32 s77, 12288
    s_cbranch_scc0 rare_d2
    v_cvt_pk_bf16_f32 v22, v40, v41
    v_cvt_pk_bf16_f32 v23, v42, v43
    v_accvgpr_write_b32 a100, v22
    v_accvgpr_write_b32 a101, v23
    v_cvt_pk_bf16_f32 v22, v44, v45
    v_cvt_pk_bf16_f32 v23, v46, v47
    v_accvgpr_write_b32 a108, v22
    v_accvgpr_write_b32 a109, v23
    v_cvt_pk_bf16_f32 v22, v48, v49
    v_cvt_pk_bf16_f32 v23, v50, v51
    v_accvgpr_write_b32 a116, v22
    v_accvgpr_write_b32 a117, v23
    v_cvt_pk_bf16_f32 v22, v52, v53
    v_cvt_pk_bf16_f32 v23, v54, v55
    v_accvgpr_write_b32 a124, v22
    v_accvgpr_write_b32 a125, v23
rare_d2:
    s_cmp_eq_u32 s77, 18432
    s_cbranch_scc0 rare_d3
    v_cvt_pk_bf16_f32 v22, v40, v41
    v_cvt_pk_bf16_f32 v23, v42, v43
    v_accvgpr_write_b32 a102, v22
    v_accvgpr_write_b32 a103, v23
    v_cvt_pk_bf16_f32 v22, v44, v45
    v_cvt_pk_bf16_f32 v23, v46, v47
    v_accvgpr_write_b32 a110, v22
    v_accvgpr_write_b32 a111, v23
    v_cvt_pk_bf16_f32 v22, v48, v49
    v_cvt_pk_bf16_f32 v23, v50, v51
    v_accvgpr_write_b32 a118, v22
    v_accvgpr_write_b32 a119, v23
    v_cvt_pk_bf16_f32 v22, v52, v53
    v_cvt_pk_bf16_f32 v23, v54, v55
    v_accvgpr_write_b32 a126, v22
    v_accvgpr_write_b32 a127, v23
rare_d3:
    s_cmp_eq_u32 s77, 24576
    s_cbranch_scc0 rare_d4
    v_cvt_pk_bf16_f32 v22, v40, v41
    v_cvt_pk_bf16_f32 v23, v42, v43
    v_accvgpr_write_b32 a128, v22
    v_accvgpr_write_b32 a129, v23
    v_cvt_pk_bf16_f32 v22, v44, v45
    v_cvt_pk_bf16_f32 v23, v46, v47
    v_accvgpr_write_b32 a136, v22
    v_accvgpr_write_b32 a137, v23
    v_cvt_pk_bf16_f32 v22, v48, v49
    v_cvt_pk_bf16_f32 v23, v50, v51
    v_accvgpr_write_b32 a144, v22
    v_accvgpr_write_b32 a145, v23
    v_cvt_pk_bf16_f32 v120, v52, v53
    v_cvt_pk_bf16_f32 v121, v54, v55
rare_d4:
    s_cmp_eq_u32 s77, 30720
    s_cbranch_scc0 rare_d5
    v_cvt_pk_bf16_f32 v22, v40, v41
    v_cvt_pk_bf16_f32 v23, v42, v43
    v_accvgpr_write_b32 a130, v22
    v_accvgpr_write_b32 a131, v23
    v_cvt_pk_bf16_f32 v22, v44, v45
    v_cvt_pk_bf16_f32 v23, v46, v47
    v_accvgpr_write_b32 a138, v22
    v_accvgpr_write_b32 a139, v23
    v_cvt_pk_bf16_f32 v22, v48, v49
    v_cvt_pk_bf16_f32 v23, v50, v51
    v_accvgpr_write_b32 a146, v22
    v_accvgpr_write_b32 a147, v23
    v_cvt_pk_bf16_f32 v122, v52, v53
    v_cvt_pk_bf16_f32 v123, v54, v55
rare_d5:
    s_cmp_eq_u32 s77, 36864
    s_cbranch_scc0 rare_d6
    v_cvt_pk_bf16_f32 v22, v40, v41
    v_cvt_pk_bf16_f32 v23, v42, v43
    v_accvgpr_write_b32 a132, v22
    v_accvgpr_write_b32 a133, v23
    v_cvt_pk_bf16_f32 v22, v44, v45
    v_cvt_pk_bf16_f32 v23, v46, v47
    v_accvgpr_write_b32 a140, v22
    v_accvgpr_write_b32 a141, v23
    v_cvt_pk_bf16_f32 v22, v48, v49
    v_cvt_pk_bf16_f32 v23, v50, v51
    v_accvgpr_write_b32 a148, v22
    v_accvgpr_write_b32 a149, v23
    v_cvt_pk_bf16_f32 v124, v52, v53
    v_cvt_pk_bf16_f32 v125, v54, v55
rare_d6:
    s_cmp_eq_u32 s77, 43008
    s_cbranch_scc0 rare_d7
    v_cvt_pk_bf16_f32 v22, v40, v41
    v_cvt_pk_bf16_f32 v23, v42, v43
    v_accvgpr_write_b32 a134, v22
    v_accvgpr_write_b32 a135, v23
    v_cvt_pk_bf16_f32 v22, v44, v45
    v_cvt_pk_bf16_f32 v23, v46, v47
    v_accvgpr_write_b32 a142, v22
    v_accvgpr_write_b32 a143, v23
    v_cvt_pk_bf16_f32 v22, v48, v49
    v_cvt_pk_bf16_f32 v23, v50, v51
    v_accvgpr_write_b32 a150, v22
    v_accvgpr_write_b32 a151, v23
    v_cvt_pk_bf16_f32 v126, v52, v53
    v_cvt_pk_bf16_f32 v127, v54, v55
rare_d7:
    s_cmp_eq_u32 s77, 49152
    s_cbranch_scc0 rare_d8
    v_cvt_pk_bf16_f32 v128, v40, v41
    v_cvt_pk_bf16_f32 v129, v42, v43
    v_cvt_pk_bf16_f32 v136, v44, v45
    v_cvt_pk_bf16_f32 v137, v46, v47
    v_cvt_pk_bf16_f32 v144, v48, v49
    v_cvt_pk_bf16_f32 v145, v50, v51
    v_cvt_pk_bf16_f32 v152, v52, v53
    v_cvt_pk_bf16_f32 v153, v54, v55
rare_d8:
    s_cmp_eq_u32 s77, 55296
    s_cbranch_scc0 rare_d9
    v_cvt_pk_bf16_f32 v130, v40, v41
    v_cvt_pk_bf16_f32 v131, v42, v43
    v_cvt_pk_bf16_f32 v138, v44, v45
    v_cvt_pk_bf16_f32 v139, v46, v47
    v_cvt_pk_bf16_f32 v146, v48, v49
    v_cvt_pk_bf16_f32 v147, v50, v51
    v_cvt_pk_bf16_f32 v154, v52, v53
    v_cvt_pk_bf16_f32 v155, v54, v55
rare_d9:
    s_cmp_eq_u32 s77, 61440
    s_cbranch_scc0 rare_d10
    v_cvt_pk_bf16_f32 v132, v40, v41
    v_cvt_pk_bf16_f32 v133, v42, v43
    v_cvt_pk_bf16_f32 v140, v44, v45
    v_cvt_pk_bf16_f32 v141, v46, v47
    v_cvt_pk_bf16_f32 v148, v48, v49
    v_cvt_pk_bf16_f32 v149, v50, v51
    v_cvt_pk_bf16_f32 v156, v52, v53
    v_cvt_pk_bf16_f32 v157, v54, v55
rare_d10:
    s_cmp_eq_u32 s77, 67584
    s_cbranch_scc0 rare_d11
    v_cvt_pk_bf16_f32 v134, v40, v41
    v_cvt_pk_bf16_f32 v135, v42, v43
    v_cvt_pk_bf16_f32 v142, v44, v45
    v_cvt_pk_bf16_f32 v143, v46, v47
    v_cvt_pk_bf16_f32 v150, v48, v49
    v_cvt_pk_bf16_f32 v151, v50, v51
    v_cvt_pk_bf16_f32 v158, v52, v53
    v_cvt_pk_bf16_f32 v159, v54, v55
rare_d11:
    s_cmp_eq_u32 s77, 73728
    s_cbranch_scc0 rare_d12
    v_cvt_pk_bf16_f32 v160, v40, v41
    v_cvt_pk_bf16_f32 v161, v42, v43
    v_cvt_pk_bf16_f32 v168, v44, v45
    v_cvt_pk_bf16_f32 v169, v46, v47
    v_cvt_pk_bf16_f32 v176, v48, v49
    v_cvt_pk_bf16_f32 v177, v50, v51
    v_cvt_pk_bf16_f32 v184, v52, v53
    v_cvt_pk_bf16_f32 v185, v54, v55
rare_d12:
    s_cmp_eq_u32 s77, 79872
    s_cbranch_scc0 rare_d13
    v_cvt_pk_bf16_f32 v162, v40, v41
    v_cvt_pk_bf16_f32 v163, v42, v43
    v_cvt_pk_bf16_f32 v170, v44, v45
    v_cvt_pk_bf16_f32 v171, v46, v47
    v_cvt_pk_bf16_f32 v178, v48, v49
    v_cvt_pk_bf16_f32 v179, v50, v51
    v_cvt_pk_bf16_f32 v186, v52, v53
    v_cvt_pk_bf16_f32 v187, v54, v55
rare_d13:
    s_cmp_eq_u32 s77, 86016
    s_cbranch_scc0 rare_d14
    v_cvt_pk_bf16_f32 v164, v40, v41
    v_cvt_pk_bf16_f32 v165, v42, v43
    v_cvt_pk_bf16_f32 v172, v44, v45
    v_cvt_pk_bf16_f32 v173, v46, v47
    v_cvt_pk_bf16_f32 v180, v48, v49
    v_cvt_pk_bf16_f32 v181, v50, v51
    v_cvt_pk_bf16_f32 v188, v52, v53
    v_cvt_pk_bf16_f32 v189, v54, v55
rare_d14:
    s_cmp_eq_u32 s77, 92160
    s_cbranch_scc0 rare_d15
    v_cvt_pk_bf16_f32 v166, v40, v41
    v_cvt_pk_bf16_f32 v167, v42, v43
    v_cvt_pk_bf16_f32 v174, v44, v45
    v_cvt_pk_bf16_f32 v175, v46, v47
    v_cvt_pk_bf16_f32 v182, v48, v49
    v_cvt_pk_bf16_f32 v183, v50, v51
    v_cvt_pk_bf16_f32 v190, v52, v53
    v_cvt_pk_bf16_f32 v191, v54, v55
rare_d15:
    s_cmp_eq_u32 s77, 98304
    s_cbranch_scc0 rare_d16
    v_cvt_pk_bf16_f32 v192, v40, v41
    v_cvt_pk_bf16_f32 v193, v42, v43
    v_cvt_pk_bf16_f32 v200, v44, v45
    v_cvt_pk_bf16_f32 v201, v46, v47
    v_cvt_pk_bf16_f32 v208, v48, v49
    v_cvt_pk_bf16_f32 v209, v50, v51
    v_cvt_pk_bf16_f32 v216, v52, v53
    v_cvt_pk_bf16_f32 v217, v54, v55
rare_d16:
    s_cmp_eq_u32 s77, 104448
    s_cbranch_scc0 rare_d17
    v_cvt_pk_bf16_f32 v194, v40, v41
    v_cvt_pk_bf16_f32 v195, v42, v43
    v_cvt_pk_bf16_f32 v202, v44, v45
    v_cvt_pk_bf16_f32 v203, v46, v47
    v_cvt_pk_bf16_f32 v210, v48, v49
    v_cvt_pk_bf16_f32 v211, v50, v51
    v_cvt_pk_bf16_f32 v218, v52, v53
    v_cvt_pk_bf16_f32 v219, v54, v55
rare_d17:
    s_cmp_eq_u32 s77, 110592
    s_cbranch_scc0 rare_d18
    v_cvt_pk_bf16_f32 v196, v40, v41
    v_cvt_pk_bf16_f32 v197, v42, v43
    v_cvt_pk_bf16_f32 v204, v44, v45
    v_cvt_pk_bf16_f32 v205, v46, v47
    v_cvt_pk_bf16_f32 v212, v48, v49
    v_cvt_pk_bf16_f32 v213, v50, v51
    v_cvt_pk_bf16_f32 v220, v52, v53
    v_cvt_pk_bf16_f32 v221, v54, v55
rare_d18:
    s_cmp_eq_u32 s77, 116736
    s_cbranch_scc0 rare_d19
    v_cvt_pk_bf16_f32 v198, v40, v41
    v_cvt_pk_bf16_f32 v199, v42, v43
    v_cvt_pk_bf16_f32 v206, v44, v45
    v_cvt_pk_bf16_f32 v207, v46, v47
    v_cvt_pk_bf16_f32 v214, v48, v49
    v_cvt_pk_bf16_f32 v215, v50, v51
    v_cvt_pk_bf16_f32 v222, v52, v53
    v_cvt_pk_bf16_f32 v223, v54, v55
rare_d19:
    s_cmp_eq_u32 s77, 122880
    s_cbranch_scc0 rare_d20
    v_cvt_pk_bf16_f32 v224, v40, v41
    v_cvt_pk_bf16_f32 v225, v42, v43
    v_cvt_pk_bf16_f32 v232, v44, v45
    v_cvt_pk_bf16_f32 v233, v46, v47
    v_cvt_pk_bf16_f32 v240, v48, v49
    v_cvt_pk_bf16_f32 v241, v50, v51
    v_cvt_pk_bf16_f32 v248, v52, v53
    v_cvt_pk_bf16_f32 v249, v54, v55
rare_d20:
    s_cmp_eq_u32 s77, 129024
    s_cbranch_scc0 rare_d21
    v_cvt_pk_bf16_f32 v226, v40, v41
    v_cvt_pk_bf16_f32 v227, v42, v43
    v_cvt_pk_bf16_f32 v234, v44, v45
    v_cvt_pk_bf16_f32 v235, v46, v47
    v_cvt_pk_bf16_f32 v242, v48, v49
    v_cvt_pk_bf16_f32 v243, v50, v51
    v_cvt_pk_bf16_f32 v250, v52, v53
    v_cvt_pk_bf16_f32 v251, v54, v55
rare_d21:
    s_cmp_eq_u32 s77, 135168
    s_cbranch_scc0 rare_d22
    v_cvt_pk_bf16_f32 v228, v40, v41
    v_cvt_pk_bf16_f32 v229, v42, v43
    v_cvt_pk_bf16_f32 v236, v44, v45
    v_cvt_pk_bf16_f32 v237, v46, v47
    v_cvt_pk_bf16_f32 v244, v48, v49
    v_cvt_pk_bf16_f32 v245, v50, v51
    v_cvt_pk_bf16_f32 v252, v52, v53
    v_cvt_pk_bf16_f32 v253, v54, v55
rare_d22:
    s_cmp_eq_u32 s77, 141312
    s_cbranch_scc0 rare_d23
    v_cvt_pk_bf16_f32 v230, v40, v41
    v_cvt_pk_bf16_f32 v231, v42, v43
    v_cvt_pk_bf16_f32 v238, v44, v45
    v_cvt_pk_bf16_f32 v239, v46, v47
    v_cvt_pk_bf16_f32 v246, v48, v49
    v_cvt_pk_bf16_f32 v247, v50, v51
    v_cvt_pk_bf16_f32 v254, v52, v53
    v_cvt_pk_bf16_f32 v255, v54, v55
rare_d23:
    s_cmp_eq_u32 s77, 147456
    s_cbranch_scc0 rare_d24
    v_cvt_pk_bf16_f32 v56, v40, v41
    v_cvt_pk_bf16_f32 v57, v42, v43
    v_cvt_pk_bf16_f32 v64, v44, v45
    v_cvt_pk_bf16_f32 v65, v46, v47
    v_cvt_pk_bf16_f32 v72, v48, v49
    v_cvt_pk_bf16_f32 v73, v50, v51
    v_cvt_pk_bf16_f32 v80, v52, v53
    v_cvt_pk_bf16_f32 v81, v54, v55
rare_d24:
    s_cmp_eq_u32 s77, 153600
    s_cbranch_scc0 rare_d25
    v_cvt_pk_bf16_f32 v58, v40, v41
    v_cvt_pk_bf16_f32 v59, v42, v43
    v_cvt_pk_bf16_f32 v66, v44, v45
    v_cvt_pk_bf16_f32 v67, v46, v47
    v_cvt_pk_bf16_f32 v74, v48, v49
    v_cvt_pk_bf16_f32 v75, v50, v51
    v_cvt_pk_bf16_f32 v82, v52, v53
    v_cvt_pk_bf16_f32 v83, v54, v55
rare_d25:
    s_cmp_eq_u32 s77, 159744
    s_cbranch_scc0 rare_d26
    v_cvt_pk_bf16_f32 v60, v40, v41
    v_cvt_pk_bf16_f32 v61, v42, v43
    v_cvt_pk_bf16_f32 v68, v44, v45
    v_cvt_pk_bf16_f32 v69, v46, v47
    v_cvt_pk_bf16_f32 v76, v48, v49
    v_cvt_pk_bf16_f32 v77, v50, v51
    v_cvt_pk_bf16_f32 v84, v52, v53
    v_cvt_pk_bf16_f32 v85, v54, v55
rare_d26:
    s_cmp_eq_u32 s77, 165888
    s_cbranch_scc0 rare_d27
    v_cvt_pk_bf16_f32 v62, v40, v41
    v_cvt_pk_bf16_f32 v63, v42, v43
    v_cvt_pk_bf16_f32 v70, v44, v45
    v_cvt_pk_bf16_f32 v71, v46, v47
    v_cvt_pk_bf16_f32 v78, v48, v49
    v_cvt_pk_bf16_f32 v79, v50, v51
    v_cvt_pk_bf16_f32 v86, v52, v53
    v_cvt_pk_bf16_f32 v87, v54, v55
rare_d27:
    s_cmp_eq_u32 s77, 172032
    s_cbranch_scc0 rare_d28
    v_cvt_pk_bf16_f32 v88, v40, v41
    v_cvt_pk_bf16_f32 v89, v42, v43
    v_cvt_pk_bf16_f32 v96, v44, v45
    v_cvt_pk_bf16_f32 v97, v46, v47
    v_cvt_pk_bf16_f32 v104, v48, v49
    v_cvt_pk_bf16_f32 v105, v50, v51
    v_cvt_pk_bf16_f32 v112, v52, v53
    v_cvt_pk_bf16_f32 v113, v54, v55
rare_d28:
    s_cmp_eq_u32 s77, 178176
    s_cbranch_scc0 rare_d29
    v_cvt_pk_bf16_f32 v90, v40, v41
    v_cvt_pk_bf16_f32 v91, v42, v43
    v_cvt_pk_bf16_f32 v98, v44, v45
    v_cvt_pk_bf16_f32 v99, v46, v47
    v_cvt_pk_bf16_f32 v106, v48, v49
    v_cvt_pk_bf16_f32 v107, v50, v51
    v_cvt_pk_bf16_f32 v114, v52, v53
    v_cvt_pk_bf16_f32 v115, v54, v55
rare_d29:
    s_cmp_eq_u32 s77, 184320
    s_cbranch_scc0 rare_d30
    v_cvt_pk_bf16_f32 v92, v40, v41
    v_cvt_pk_bf16_f32 v93, v42, v43
    v_cvt_pk_bf16_f32 v100, v44, v45
    v_cvt_pk_bf16_f32 v101, v46, v47
    v_cvt_pk_bf16_f32 v108, v48, v49
    v_cvt_pk_bf16_f32 v109, v50, v51
    v_cvt_pk_bf16_f32 v116, v52, v53
    v_cvt_pk_bf16_f32 v117, v54, v55
rare_d30:
    s_cmp_eq_u32 s77, 190464
    s_cbranch_scc0 rare_d31
    v_cvt_pk_bf16_f32 v94, v40, v41
    v_cvt_pk_bf16_f32 v95, v42, v43
    v_cvt_pk_bf16_f32 v102, v44, v45
    v_cvt_pk_bf16_f32 v103, v46, v47
    v_cvt_pk_bf16_f32 v110, v48, v49
    v_cvt_pk_bf16_f32 v111, v50, v51
    v_cvt_pk_bf16_f32 v118, v52, v53
    v_cvt_pk_bf16_f32 v119, v54, v55
rare_d31:
    s_add_u32 s77, s77, 6144
    s_cmp_lt_u32 s77, 196608
    s_cbranch_scc1 rare_loop
    ds_read_b64_tr_b16 a[216:217], v8 offset:0
    ds_read_b64_tr_b16 a[218:219], v8 offset:2048
    ds_read_b64_tr_b16 a[220:221], v9 offset:0
    ds_read_b64_tr_b16 a[222:223], v9 offset:2048
    s_waitcnt lgkmcnt(0)
    v_mfma_f32_16x16x32_bf16 a[152:155], a[216:219], a[96:99], 0
    v_mfma_f32_16x16x32_bf16 a[156:159], a[216:219], a[104:107], 0
    v_mfma_f32_16x16x32_bf16 a[160:163], a[216:219], a[112:115], 0
    v_mfma_f32_16x16x32_bf16 a[164:167], a[216:219], a[120:123], 0
    v_mfma_f32_16x16x32_bf16 a[168:171], a[220:223], a[96:99], 0
    v_mfma_f32_16x16x32_bf16 a[172:175], a[220:223], a[104:107], 0
    v_mfma_f32_16x16x32_bf16 a[176:179], a[220:223], a[112:115], 0
    v_mfma_f32_16x16x32_bf16 a[180:183], a[220:223], a[120:123], 0
    ds_read_b64_tr_b16 a[216:217], v8 offset:4096
    ds_read_b64_tr_b16 a[218:219], v8 offset:6144
    ds_read_b64_tr_b16 a[220:221], v9 offset:4096
    ds_read_b64_tr_b16 a[222:223], v9 offset:6144
    s_waitcnt lgkmcnt(0)
    v_mfma_f32_16x16x32_bf16 a[152:155], a[216:219], a[100:103], a[152:155]
    v_mfma_f32_16x16x32_bf16 a[156:159], a[216:219], a[108:111], a[156:159]
    v_mfma_f32_16x16x32_bf16 a[160:163], a[216:219], a[116:119], a[160:163]
    v_mfma_f32_16x16x32_bf16 a[164:167], a[216:219], a[124:127], a[164:167]
    v_mfma_f32_16x16x32_bf16 a[168:171], a[220:223], a[100:103], a[168:171]
    v_mfma_f32_16x16x32_bf16 a[172:175], a[220:223], a[108:111], a[172:175]
    v_mfma_f32_16x16x32_bf16 a[176:179], a[220:223], a[116:119], a[176:179]
    v_mfma_f32_16x16x32_bf16 a[180:183], a[220:223], a[124:127], a[180:183]
    ds_read_b64_tr_b16 a[216:217], v8 offset:8192
    ds_read_b64_tr_b16 a[218:219], v8 offset:10240
    ds_read_b64_tr_b16 a[220:221], v9 offset:8192
    ds_read_b64_tr_b16 a[222:223], v9 offset:10240
    s_waitcnt lgkmcnt(0)
    v_mfma_f32_16x16x32_bf16 a[152:155], a[216:219], a[128:131], a[152:155]
    v_mfma_f32_16x16x32_bf16 a[156:159], a[216:219], a[136:139], a[156:159]
    v_mfma_f32_16x16x32_bf16 a[160:163], a[216:219], a[144:147], a[160:163]
    v_mfma_f32_16x16x32_bf16 a[164:167], a[216:219], v[120:123], a[164:167]
    v_mfma_f32_16x16x32_bf16 a[168:171], a[220:223], a[128:131], a[168:171]
    v_mfma_f32_16x16x32_bf16 a[172:175], a[220:223], a[136:139], a[172:175]
    v_mfma_f32_16x16x32_bf16 a[176:179], a[220:223], a[144:147], a[176:179]
    v_mfma_f32_16x16x32_bf16 a[180:183], a[220:223], v[120:123], a[180:183]
    ds_read_b64_tr_b16 a[216:217], v8 offset:12288
    ds_read_b64_tr_b16 a[218:219], v8 offset:14336
    ds_read_b64_tr_b16 a[220:221], v9 offset:12288
    ds_read_b64_tr_b16 a[222:223], v9 offset:14336
    s_waitcnt lgkmcnt(0)
    v_mfma_f32_16x16x32_bf16 a[152:155], a[216:219], a[132:135], a[152:155]
    v_mfma_f32_16x16x32_bf16 a[156:159], a[216:219], a[140:143], a[156:159]
    v_mfma_f32_16x16x32_bf16 a[160:163], a[216:219], a[148:151], a[160:163]
    v_mfma_f32_16x16x32_bf16 a[164:167], a[216:219], v[124:127], a[164:167]
    v_mfma_f32_16x16x32_bf16 a[168:171], a[220:223], a[132:135], a[168:171]
    v_mfma_f32_16x16x32_bf16 a[172:175], a[220:223], a[140:143], a[172:175]
    v_mfma_f32_16x16x32_bf16 a[176:179], a[220:223], a[148:151], a[176:179]
    v_mfma_f32_16x16x32_bf16 a[180:183], a[220:223], v[124:127], a[180:183]
    ds_read_b64_tr_b16 a[216:217], v8 offset:16384
    ds_read_b64_tr_b16 a[218:219], v8 offset:18432
    ds_read_b64_tr_b16 a[220:221], v9 offset:16384
    ds_read_b64_tr_b16 a[222:223], v9 offset:18432
    s_waitcnt lgkmcnt(0)
    v_mfma_f32_16x16x32_bf16 a[152:155], a[216:219], v[128:131], a[152:155]
    v_mfma_f32_16x16x32_bf16 a[156:159], a[216:219], v[136:139], a[156:159]
    v_mfma_f32_16x16x32_bf16 a[160:163], a[216:219], v[144:147], a[160:163]
    v_mfma_f32_16x16x32_bf16 a[164:167], a[216:219], v[152:155], a[164:167]
    v_mfma_f32_16x16x32_bf16 a[168:171], a[220:223], v[128:131], a[168:171]
    v_mfma_f32_16x16x32_bf16 a[172:175], a[220:223], v[136:139], a[172:175]
    v_mfma_f32_16x16x32_bf16 a[176:179], a[220:223], v[144:147], a[176:179]
    v_mfma_f32_16x16x32_bf16 a[180:183], a[220:223], v[152:155], a[180:183]
    ds_read_b64_tr_b16 a[216:217], v8 offset:20480
    ds_read_b64_tr_b16 a[218:219], v8 offset:22528
    ds_read_b64_tr_b16 a[220:221], v9 offset:20480
    ds_read_b64_tr_b16 a[222:223], v9 offset:22528
    s_waitcnt lgkmcnt(0)
    v_mfma_f32_16x16x32_bf16 a[152:155], a[216:219], v[132:135], a[152:155]
    v_mfma_f32_16x16x32_bf16 a[156:159], a[216:219], v[140:143], a[156:159]
    v_mfma_f32_16x16x32_bf16 a[160:163], a[216:219], v[148:151], a[160:163]
    v_mfma_f32_16x16x32_bf16 a[164:167], a[216:219], v[156:159], a[164:167]
    v_mfma_f32_16x16x32_bf16 a[168:171], a[220:223], v[132:135], a[168:171]
    v_mfma_f32_16x16x32_bf16 a[172:175], a[220:223], v[140:143], a[172:175]
    v_mfma_f32_16x16x32_bf16 a[176:179], a[220:223], v[148:151], a[176:179]
    v_mfma_f32_16x16x32_bf16 a[180:183], a[220:223], v[156:159], a[180:183]
    ds_read_b64_tr_b16 a[216:217], v8 offset:24576
    ds_read_b64_tr_b16 a[218:219], v8 offset:26624
    ds_read_b64_tr_b16 a[220:221], v9 offset:24576
    ds_read_b64_tr_b16 a[222:223], v9 offset:26624
    s_waitcnt lgkmcnt(0)
    v_mfma_f32_16x16x32_bf16 a[152:155], a[216:219], v[160:163], a[152:155]
    v_mfma_f32_16x16x32_bf16 a[156:159], a[216:219], v[168:171], a[156:159]
    v_mfma_f32_16x16x32_bf16 a[160:163], a[216:219], v[176:179], a[160:163]
    v_mfma_f32_16x16x32_bf16 a[164:167], a[216:219], v[184:187], a[164:167]
    v_mfma_f32_16x16x32_bf16 a[168:171], a[220:223], v[160:163], a[168:171]
    v_mfma_f32_16x16x32_bf16 a[172:175], a[220:223], v[168:171], a[172:175]
    v_mfma_f32_16x16x32_bf16 a[176:179], a[220:223], v[176:179], a[176:179]
    v_mfma_f32_16x16x32_bf16 a[180:183], a[220:223], v[184:187], a[180:183]
    ds_read_b64_tr_b16 a[216:217], v8 offset:28672
    ds_read_b64_tr_b16 a[218:219], v8 offset:30720
    ds_read_b64_tr_b16 a[220:221], v9 offset:28672
    ds_read_b64_tr_b16 a[222:223], v9 offset:30720
    s_waitcnt lgkmcnt(0)
    v_mfma_f32_16x16x32_bf16 a[152:155], a[216:219], v[164:167], a[152:155]
    v_mfma_f32_16x16x32_bf16 a[156:159], a[216:219], v[172:175], a[156:159]
    v_mfma_f32_16x16x32_bf16 a[160:163], a[216:219], v[180:183], a[160:163]
    v_mfma_f32_16x16x32_bf16 a[164:167], a[216:219], v[188:191], a[164:167]
    v_mfma_f32_16x16x32_bf16 a[168:171], a[220:223], v[164:167], a[168:171]
    v_mfma_f32_16x16x32_bf16 a[172:175], a[220:223], v[172:175], a[172:175]
    v_mfma_f32_16x16x32_bf16 a[176:179], a[220:223], v[180:183], a[176:179]
    v_mfma_f32_16x16x32_bf16 a[180:183], a[220:223], v[188:191], a[180:183]
    ds_read_b64_tr_b16 a[216:217], v8 offset:32768
    ds_read_b64_tr_b16 a[218:219], v8 offset:34816
    ds_read_b64_tr_b16 a[220:221], v9 offset:32768
    ds_read_b64_tr_b16 a[222:223], v9 offset:34816
    s_waitcnt lgkmcnt(0)
    v_mfma_f32_16x16x32_bf16 a[152:155], a[216:219], v[192:195], a[152:155]
    v_mfma_f32_16x16x32_bf16 a[156:159], a[216:219], v[200:203], a[156:159]
    v_mfma_f32_16x16x32_bf16 a[160:163], a[216:219], v[208:211], a[160:163]
    v_mfma_f32_16x16x32_bf16 a[164:167], a[216:219], v[216:219], a[164:167]
    v_mfma_f32_16x16x32_bf16 a[168:171], a[220:223], v[192:195], a[168:171]
    v_mfma_f32_16x16x32_bf16 a[172:175], a[220:223], v[200:203], a[172:175]
    v_mfma_f32_16x16x32_bf16 a[176:179], a[220:223], v[208:211], a[176:179]
    v_mfma_f32_16x16x32_bf16 a[180:183], a[220:223], v[216:219], a[180:183]
    ds_read_b64_tr_b16 a[216:217], v8 offset:36864
    ds_read_b64_tr_b16 a[218:219], v8 offset:38912
    ds_read_b64_tr_b16 a[220:221], v9 offset:36864
    ds_read_b64_tr_b16 a[222:223], v9 offset:38912
    s_waitcnt lgkmcnt(0)
    v_mfma_f32_16x16x32_bf16 a[152:155], a[216:219], v[196:199], a[152:155]
    v_mfma_f32_16x16x32_bf16 a[156:159], a[216:219], v[204:207], a[156:159]
    v_mfma_f32_16x16x32_bf16 a[160:163], a[216:219], v[212:215], a[160:163]
    v_mfma_f32_16x16x32_bf16 a[164:167], a[216:219], v[220:223], a[164:167]
    v_mfma_f32_16x16x32_bf16 a[168:171], a[220:223], v[196:199], a[168:171]
    v_mfma_f32_16x16x32_bf16 a[172:175], a[220:223], v[204:207], a[172:175]
    v_mfma_f32_16x16x32_bf16 a[176:179], a[220:223], v[212:215], a[176:179]
    v_mfma_f32_16x16x32_bf16 a[180:183], a[220:223], v[220:223], a[180:183]
    ds_read_b64_tr_b16 a[216:217], v8 offset:40960
    ds_read_b64_tr_b16 a[218:219], v8 offset:43008
    ds_read_b64_tr_b16 a[220:221], v9 offset:40960
    ds_read_b64_tr_b16 a[222:223], v9 offset:43008
    s_waitcnt lgkmcnt(0)
    v_mfma_f32_16x16x32_bf16 a[152:155], a[216:219], v[224:227], a[152:155]
    v_mfma_f32_16x16x32_bf16 a[156:159], a[216:219], v[232:235], a[156:159]
    v_mfma_f32_16x16x32_bf16 a[160:163], a[216:219], v[240:243], a[160:163]
    v_mfma_f32_16x16x32_bf16 a[164:167], a[216:219], v[248:251], a[164:167]
    v_mfma_f32_16x16x32_bf16 a[168:171], a[220:223], v[224:227], a[168:171]
    v_mfma_f32_16x16x32_bf16 a[172:175], a[220:223], v[232:235], a[172:175]
    v_mfma_f32_16x16x32_bf16 a[176:179], a[220:223], v[240:243], a[176:179]
    v_mfma_f32_16x16x32_bf16 a[180:183], a[220:223], v[248:251], a[180:183]
    ds_read_b64_tr_b16 a[216:217], v8 offset:45056
    ds_read_b64_tr_b16 a[218:219], v8 offset:47104
    ds_read_b64_tr_b16 a[220:221], v9 offset:45056
    ds_read_b64_tr_b16 a[222:223], v9 offset:47104
    s_waitcnt lgkmcnt(0)
    v_mfma_f32_16x16x32_bf16 a[152:155], a[216:219], v[228:231], a[152:155]
    v_mfma_f32_16x16x32_bf16 a[156:159], a[216:219], v[236:239], a[156:159]
    v_mfma_f32_16x16x32_bf16 a[160:163], a[216:219], v[244:247], a[160:163]
    v_mfma_f32_16x16x32_bf16 a[164:167], a[216:219], v[252:255], a[164:167]
    v_mfma_f32_16x16x32_bf16 a[168:171], a[220:223], v[228:231], a[168:171]
    v_mfma_f32_16x16x32_bf16 a[172:175], a[220:223], v[236:239], a[172:175]
    v_mfma_f32_16x16x32_bf16 a[176:179], a[220:223], v[244:247], a[176:179]
    v_mfma_f32_16x16x32_bf16 a[180:183], a[220:223], v[252:255], a[180:183]
    ds_read_b64_tr_b16 a[216:217], v8 offset:49152
    ds_read_b64_tr_b16 a[218:219], v8 offset:51200
    ds_read_b64_tr_b16 a[220:221], v9 offset:49152
    ds_read_b64_tr_b16 a[222:223], v9 offset:51200
    s_waitcnt lgkmcnt(0)
    v_mfma_f32_16x16x32_bf16 a[152:155], a[216:219], v[56:59], a[152:155]
    v_mfma_f32_16x16x32_bf16 a[156:159], a[216:219], v[64:67], a[156:159]
    v_mfma_f32_16x16x32_bf16 a[160:163], a[216:219], v[72:75], a[160:163]
    v_mfma_f32_16x16x32_bf16 a[164:167], a[216:219], v[80:83], a[164:167]
    v_mfma_f32_16x16x32_bf16 a[168:171], a[220:223], v[56:59], a[168:171]
    v_mfma_f32_16x16x32_bf16 a[172:175], a[220:223], v[64:67], a[172:175]
    v_mfma_f32_16x16x32_bf16 a[176:179], a[220:223], v[72:75], a[176:179]
    v_mfma_f32_16x16x32_bf16 a[180:183], a[220:223], v[80:83], a[180:183]
    ds_read_b64_tr_b16 a[216:217], v8 offset:53248
    ds_read_b64_tr_b16 a[218:219], v8 offset:55296
    ds_read_b64_tr_b16 a[220:221], v9 offset:53248
    ds_read_b64_tr_b16 a[222:223], v9 offset:55296
    s_waitcnt lgkmcnt(0)
    v_mfma_f32_16x16x32_bf16 a[152:155], a[216:219], v[60:63], a[152:155]
    v_mfma_f32_16x16x32_bf16 a[156:159], a[216:219], v[68:71], a[156:159]
    v_mfma_f32_16x16x32_bf16 a[160:163], a[216:219], v[76:79], a[160:163]
    v_mfma_f32_16x16x32_bf16 a[164:167], a[216:219], v[84:87], a[164:167]
    v_mfma_f32_16x16x32_bf16 a[168:171], a[220:223], v[60:63], a[168:171]
    v_mfma_f32_16x16x32_bf16 a[172:175], a[220:223], v[68:71], a[172:175]
    v_mfma_f32_16x16x32_bf16 a[176:179], a[220:223], v[76:79], a[176:179]
    v_mfma_f32_16x16x32_bf16 a[180:183], a[220:223], v[84:87], a[180:183]
    ds_read_b64_tr_b16 a[216:217], v8 offset:57344
    ds_read_b64_tr_b16 a[218:219], v8 offset:59392
    ds_read_b64_tr_b16 a[220:221], v9 offset:57344
    ds_read_b64_tr_b16 a[222:223], v9 offset:59392
    s_waitcnt lgkmcnt(0)
    v_mfma_f32_16x16x32_bf16 a[152:155], a[216:219], v[88:91], a[152:155]
    v_mfma_f32_16x16x32_bf16 a[156:159], a[216:219], v[96:99], a[156:159]
    v_mfma_f32_16x16x32_bf16 a[160:163], a[216:219], v[104:107], a[160:163]
    v_mfma_f32_16x16x32_bf16 a[164:167], a[216:219], v[112:115], a[164:167]
    v_mfma_f32_16x16x32_bf16 a[168:171], a[220:223], v[88:91], a[168:171]
    v_mfma_f32_16x16x32_bf16 a[172:175], a[220:223], v[96:99], a[172:175]
    v_mfma_f32_16x16x32_bf16 a[176:179], a[220:223], v[104:107], a[176:179]
    v_mfma_f32_16x16x32_bf16 a[180:183], a[220:223], v[112:115], a[180:183]
    ds_read_b64_tr_b16 a[216:217], v8 offset:61440
    ds_read_b64_tr_b16 a[218:219], v8 offset:63488
    ds_read_b64_tr_b16 a[220:221], v9 offset:61440
    ds_read_b64_tr_b16 a[222:223], v9 offset:63488
    s_waitcnt lgkmcnt(0)
    v_mfma_f32_16x16x32_bf16 a[152:155], a[216:219], v[92:95], a[152:155]
    v_mfma_f32_16x16x32_bf16 a[156:159], a[216:219], v[100:103], a[156:159]
    v_mfma_f32_16x16x32_bf16 a[160:163], a[216:219], v[108:111], a[160:163]
    v_mfma_f32_16x16x32_bf16 a[164:167], a[216:219], v[116:119], a[164:167]
    v_mfma_f32_16x16x32_bf16 a[168:171], a[220:223], v[92:95], a[168:171]
    v_mfma_f32_16x16x32_bf16 a[172:175], a[220:223], v[100:103], a[172:175]
    v_mfma_f32_16x16x32_bf16 a[176:179], a[220:223], v[108:111], a[176:179]
    v_mfma_f32_16x16x32_bf16 a[180:183], a[220:223], v[116:119], a[180:183]
    v_mov_b32 v24, 0
    v_mov_b32 v25, 0
    v_mov_b32 v26, 0
    v_mov_b32 v27, 0
    v_mov_b32 v28, 0
    v_mov_b32 v29, 0
    v_mov_b32 v30, 0
    v_mov_b32 v31, 0
    v_mov_b32 v32, 0
    v_mov_b32 v33, 0
    v_mov_b32 v34, 0
    v_mov_b32 v35, 0
    v_mov_b32 v36, 0
    v_mov_b32 v37, 0
    v_mov_b32 v38, 0
    v_mov_b32 v39, 0
    s_nop 1
    v_smfmac_f32_16x16x64_bf16 v[24:27], a[248:251], a[96:103], v20
    v_smfmac_f32_16x16x64_bf16 v[28:31], a[248:251], a[104:111], v20
    v_smfmac_f32_16x16x64_bf16 v[32:35], a[248:251], a[112:119], v20
    v_smfmac_f32_16x16x64_bf16 v[36:39], a[248:251], a[120:127], v20
    v_smfmac_f32_16x16x64_bf16 v[24:27], a[248:251], a[128:135], v20
    v_smfmac_f32_16x16x64_bf16 v[28:31], a[248:251], a[136:143], v20
    v_smfmac_f32_16x16x64_bf16 v[32:35], a[248:251], a[144:151], v20
    v_smfmac_f32_16x16x64_bf16 v[36:39], a[248:251], v[120:127], v20
    v_smfmac_f32_16x16x64_bf16 v[24:27], a[248:251], v[128:135], v20
    v_smfmac_f32_16x16x64_bf16 v[28:31], a[248:251], v[136:143], v20
    v_smfmac_f32_16x16x64_bf16 v[32:35], a[248:251], v[144:151], v20
    v_smfmac_f32_16x16x64_bf16 v[36:39], a[248:251], v[152:159], v20
    v_smfmac_f32_16x16x64_bf16 v[24:27], a[248:251], v[160:167], v20
    v_smfmac_f32_16x16x64_bf16 v[28:31], a[248:251], v[168:175], v20
    v_smfmac_f32_16x16x64_bf16 v[32:35], a[248:251], v[176:183], v20
    v_smfmac_f32_16x16x64_bf16 v[36:39], a[248:251], v[184:191], v20
    v_smfmac_f32_16x16x64_bf16 v[24:27], a[248:251], v[192:199], v20
    v_smfmac_f32_16x16x64_bf16 v[28:31], a[248:251], v[200:207], v20
    v_smfmac_f32_16x16x64_bf16 v[32:35], a[248:251], v[208:215], v20
    v_smfmac_f32_16x16x64_bf16 v[36:39], a[248:251], v[216:223], v20
    v_smfmac_f32_16x16x64_bf16 v[24:27], a[248:251], v[224:231], v20
    v_smfmac_f32_16x16x64_bf16 v[28:31], a[248:251], v[232:239], v20
    v_smfmac_f32_16x16x64_bf16 v[32:35], a[248:251], v[240:247], v20
    v_smfmac_f32_16x16x64_bf16 v[36:39], a[248:251], v[248:255], v20
    v_smfmac_f32_16x16x64_bf16 v[24:27], a[248:251], v[56:63], v20
    v_smfmac_f32_16x16x64_bf16 v[28:31], a[248:251], v[64:71], v20
    v_smfmac_f32_16x16x64_bf16 v[32:35], a[248:251], v[72:79], v20
    v_smfmac_f32_16x16x64_bf16 v[36:39], a[248:251], v[80:87], v20
    v_smfmac_f32_16x16x64_bf16 v[24:27], a[248:251], v[88:95], v20
    v_smfmac_f32_16x16x64_bf16 v[28:31], a[248:251], v[96:103], v20
    v_smfmac_f32_16x16x64_bf16 v[32:35], a[248:251], v[104:111], v20
    v_smfmac_f32_16x16x64_bf16 v[36:39], a[248:251], v[112:119], v20
    s_nop 15
    v_add_f32 v24, v24, v25
    v_add_f32 v28, v28, v29
    v_add_f32 v32, v32, v33
    v_add_f32 v36, v36, v37
    v_rcp_f32 v16, v24
    v_rcp_f32 v17, v28
    v_rcp_f32 v18, v32
    v_rcp_f32 v19, v36
    s_nop 1
    s_branch rare_ret
code_end:
    s_endpgm
.section .rodata,"a"
.p2align 6
.amdhsa_kernel recurrent_scan__sliding_block_cached__moe_arch_mod__prompt_kernel
  .amdhsa_next_free_vgpr 512
  .amdhsa_next_free_sgpr 102
  .amdhsa_accum_offset 256
  .amdhsa_group_segment_fixed_size 0
  .amdhsa_kernarg_size 104
  .amdhsa_user_sgpr_count 2
  .amdhsa_user_sgpr_kernarg_segment_ptr 1
  .amdhsa_system_sgpr_workgroup_id_x 1
  .amdhsa_float_denorm_mode_32 3
.end_amdhsa_kernel
```

```asm
; @launch grid=(256,1,1) block=(256,1,1) lds=163840
.amdgcn_target "amdgcn-amd-amdhsa--gfx950"
.text
.globl recurrent_scan__sliding_block_cached__moe_arch_mod__prompt_kernel
.p2align 12
.p2align 8
.type recurrent_scan__sliding_block_cached__moe_arch_mod__prompt_kernel,@function
recurrent_scan__sliding_block_cached__moe_arch_mod__prompt_kernel:
    s_cmp_ge_u32 s2, 256
    s_cbranch_scc1 main_end
    s_load_dwordx16 s[64:79], s[0:1], 0
    s_load_dwordx4 s[80:83], s[0:1], 64
    s_load_dwordx2 s[84:85], s[0:1], 80
    s_load_dwordx2 s[86:87], s[0:1], 96
    s_lshr_b32 s56, s2, 3
    s_lshl_b32 s56, s56, 10
    v_lshrrev_b32 v18, 5, v0
    v_lshlrev_b32 v18, 7, v18
    v_add_u32 v18, s56, v18
    s_getpc_b64 s[88:89]
code0:
    v_and_b32 v19, 3, v0
    v_lshl_add_u32 v19, v19, 15, v18
    v_min_u32 v19, code_end-code0-4, v19
    global_load_dword a252, v19, s[88:89]
    v_lshrrev_b32 v17, 6, v0
    v_lshlrev_b32 v17, 12, v17
    v_and_b32 v1, 63, v0
    v_lshl_add_u32 v17, v1, 4, v17
    v_lshrrev_b32 v29, 6, v0
    v_mov_b32 v16, v0
    v_readfirstlane_b32 s3, v29
    s_and_b32 s53, s2, 7
    s_lshr_b32 s52, s2, 5
    s_bfe_u32 s51, s2, 0x20003
    s_lshl_b32 s50, s53, 2
    s_add_u32 s50, s50, s51
    s_lshl_b32 s60, s2, 3
    s_lshl_b32 s56, s3, 1
    s_add_u32 s60, s60, s56
    v_bfe_u32 v240, v1, 2, 1
    v_add_u32 v240, s60, v240
    v_lshrrev_b32 v241, 3, v1
    v_lshlrev_b32 v241, 6, v241
    v_and_b32 v29, 3, v1
    v_lshl_add_u32 v241, v29, 4, v241
    v_mul_u32_u24 v242, 1280, v240
    v_add_u32 v242, v242, v241
    v_lshrrev_b32 v29, 4, v1
    v_lshlrev_b32 v29, 1, v29
    v_and_b32 v7, 7, v1
    v_xor_b32 v7, v7, v29
    v_lshlrev_b32 v7, 4, v7
    v_lshrrev_b32 v29, 5, v1
    v_lshlrev_b32 v29, 3, v29
    v_bfe_u32 v5, v1, 3, 2
    v_add_u32 v5, v5, v29
    v_mul_u32_u24 v2, 12288, v5
    v_add_u32 v2, v2, v7
    v_add_u32 v3, 196608, v2
    s_lshl_b32 s54, s52, 2
    s_add_u32 s54, s54, s3
    s_mul_i32 s49, s3, 6144
    s_lshr_b32 s59, s3, 1
    s_lshl_b32 s59, s59, 5
    s_and_b32 s56, s3, 1
    s_lshl_b32 s56, s56, 2
    s_add_u32 s59, s59, s56
    s_mul_i32 s36, s59, 12288
    s_mov_b32 s37, 786432
    s_add_u32 s45, s51, s52
    s_and_b32 s45, s45, 3
    s_lshl_b32 s45, s45, 2
    s_lshr_b32 s45, 0x5050, s45
    s_and_b32 s45, s45, 15
    s_mul_i32 s56, s45, 786432
    s_add_u32 s36, s36, s56
    s_lshl_b32 s45, s45, 13
    s_mul_i32 s56, s50, 384
    s_sub_u32 s57, 7864320, s56
    s_waitcnt lgkmcnt(0)
    s_mov_b32 s12, s64
    s_and_b32 s13, s65, 0xffff
    s_mov_b32 s14, 2621440
    s_mov_b32 s15, 0x00020000
    s_mov_b32 s16, s76
    s_and_b32 s17, s77, 0xffff
    s_mov_b32 s18, 1280
    s_mov_b32 s19, 0x00020000
    buffer_load_dwordx4 v[64:67], v242, s[12:15], 0 offen
    buffer_load_dwordx4 v[68:71], v242, s[12:15], 0 offen offset:512
    buffer_load_dwordx4 v[72:75], v242, s[12:15], 0 offen offset:1024
    v_mov_b32 v25, 3203072
    global_load_dword v26, v25, s[86:87] sc1
    s_lshr_b32 s44, s2, 3
    s_lshl_b32 s44, s44, 7
    s_add_u32 s44, s44, 4128768
    s_load_dword s93, s[86:87], s44 glc
    s_add_u32 s8, s70, s56
    s_addc_u32 s9, s71, 0
    s_and_b32 s9, s9, 0xffff
    s_mov_b32 s10, s57
    s_mov_b32 s11, 0x00020000
    s_add_u32 m0, s49, 49152
    s_nop 0
    buffer_load_dwordx4 v2, s[8:11], s36 offen offset:0 lds
    s_add_u32 m0, s49, 50048
    s_nop 0
    buffer_load_dwordx4 v2, s[8:11], s36 offen offset:128 lds
    s_add_u32 m0, s49, 50944
    s_nop 0
    buffer_load_dwordx4 v2, s[8:11], s36 offen offset:256 lds
    s_add_u32 m0, s49, 52224
    s_nop 0
    buffer_load_dwordx4 v3, s[8:11], s36 offen offset:0 lds
    s_add_u32 m0, s49, 53120
    s_nop 0
    buffer_load_dwordx4 v3, s[8:11], s36 offen offset:128 lds
    s_add_u32 m0, s49, 54016
    s_nop 0
    buffer_load_dwordx4 v3, s[8:11], s36 offen offset:256 lds
    s_add_u32 s36, s36, s37
    s_sub_u32 s55, s36, 7864320
    s_min_u32 s36, s36, s55
    buffer_load_dwordx4 v[76:79], v241, s[16:19], 0 offen offset:0
    buffer_load_dwordx4 v[80:83], v241, s[16:19], 0 offen offset:512
    buffer_load_dwordx4 v[84:87], v241, s[16:19], 0 offen offset:1024
    s_mov_b32 s24, s86
    s_and_b32 s25, s87, 0xffff
    s_mov_b32 s26, 268435456
    s_mov_b32 s27, 0x00020000
    v_lshrrev_b32 v243, 6, v240
    v_mul_u32_u24 v243, 81920, v243
    v_bfe_u32 v29, v240, 4, 2
    v_lshl_add_u32 v243, v29, 10, v243
    v_and_b32 v29, 15, v240
    v_lshl_add_u32 v243, v29, 6, v243
    v_lshrrev_b32 v29, 3, v1
    v_lshl_add_u32 v243, v29, 12, v243
    v_and_b32 v29, 3, v1
    v_lshl_add_u32 v243, v29, 4, v243
    s_mov_b32 s38, 0x3acccccd
    s_mov_b32 s39, 0x3727c5ac
    s_mov_b32 s41, 0
    s_mov_b32 s42, 32768
    s_mov_b32 s43, 65536
    v_mul_u32_u24 v22, 21846, v1
    v_lshrrev_b32 v22, 16, v22
    v_mul_u32_u24 v23, 3, v22
    v_sub_u32 v23, v1, v23
    v_min_u32 v22, 7, v22
    v_lshrrev_b32 v24, 2, v22
    v_mul_u32_u24 v24, 6, v24
    v_add_u32 v22, v22, v24
    v_mul_u32_u24 v22, 393216, v22
    v_lshl_add_u32 v28, v23, 7, v22
    s_sub_u32 s48, s54, 64
    s_mul_i32 s48, s48, 12288
    v_bfe_u32 v29, v1, 2, 3
    v_lshlrev_b32 v8, 7, v29
    v_lshrrev_b32 v29, 1, v29
    v_xor_b32 v29, 0, v29
    v_lshl_add_u32 v8, v29, 5, v8
    v_and_b32 v29, 3, v1
    v_lshl_add_u32 v8, v29, 3, v8
    v_lshrrev_b32 v29, 5, v1
    v_mul_u32_u24 v29, 3072, v29
    v_add_u32 v8, v8, v29
    v_add_u32 v8, 49152, v8
    v_xor_b32 v9, 32, v8
    v_xor_b32 v10, 64, v8
    v_xor_b32 v11, 96, v8
    v_and_b32 v15, 15, v1
    v_lshlrev_b32 v15, 6, v15
    v_lshrrev_b32 v29, 4, v1
    v_lshl_add_u32 v15, v29, 4, v15
    s_and_b32 s56, s2, 1
    s_lshl_b32 s56, s56, 11
    v_add_u32 v15, s56, v15
    v_xor_b32 v14, 2048, v15
    s_mul_i32 s56, s54, 81920
    s_add_u32 s56, s56, 0
    s_add_u32 s20, s86, s56
    s_addc_u32 s21, s87, 0
    s_and_b32 s21, s21, 0xffff
    s_mov_b32 s22, 81920
    s_mov_b32 s23, 0x00020000
    s_lshl_b32 s46, s54, 7
    s_add_u32 s46, s46, 4128768
    s_mov_b32 s101, 0
    s_lshl_b32 s56, s53, 12
    s_add_u32 s46, s46, s56
    s_load_dword s92, s[86:87], s46 glc
    s_lshr_b32 s6, s2, 3
    s_lshl_b32 s6, s6, 7
    s_lshl_b32 s56, s53, 2
    s_add_u32 s6, s6, s56
    s_add_u32 s6, s6, 4128768
    s_cmp_eq_u32 s3, 0
    s_cselect_b32 s6, s6, 0x70000000
    v_lshlrev_b32 v20, 12, v1
    s_waitcnt vmcnt(10)
    v_lshlrev_b32 v96, 16, v64
    v_and_b32 v97, 0xffff0000, v64
    v_lshlrev_b32 v98, 16, v65
    v_and_b32 v99, 0xffff0000, v65
    v_lshlrev_b32 v100, 16, v66
    v_and_b32 v101, 0xffff0000, v66
    v_lshlrev_b32 v102, 16, v67
    v_and_b32 v103, 0xffff0000, v67
    v_lshlrev_b32 v104, 16, v68
    v_and_b32 v105, 0xffff0000, v68
    v_lshlrev_b32 v106, 16, v69
    v_and_b32 v107, 0xffff0000, v69
    v_lshlrev_b32 v108, 16, v70
    v_and_b32 v109, 0xffff0000, v70
    v_lshlrev_b32 v110, 16, v71
    v_and_b32 v111, 0xffff0000, v71
    v_lshlrev_b32 v112, 16, v72
    v_and_b32 v113, 0xffff0000, v72
    v_lshlrev_b32 v114, 16, v73
    v_and_b32 v115, 0xffff0000, v73
    v_lshlrev_b32 v116, 16, v74
    v_and_b32 v117, 0xffff0000, v74
    v_lshlrev_b32 v118, 16, v75
    v_and_b32 v119, 0xffff0000, v75
    v_pk_add_f32 v[120:121], v[96:97], v[98:99]
    v_pk_add_f32 v[122:123], v[100:101], v[102:103]
    v_pk_add_f32 v[120:121], v[120:121], v[104:105]
    v_pk_add_f32 v[122:123], v[122:123], v[106:107]
    v_pk_add_f32 v[120:121], v[120:121], v[108:109]
    v_pk_add_f32 v[122:123], v[122:123], v[110:111]
    s_mov_b32 exec_hi, 0
    v_pk_add_f32 v[120:121], v[120:121], v[112:113]
    v_pk_add_f32 v[122:123], v[122:123], v[114:115]
    v_pk_add_f32 v[120:121], v[120:121], v[116:117]
    v_pk_add_f32 v[122:123], v[122:123], v[118:119]
    s_mov_b64 exec, -1
    v_pk_add_f32 v[120:121], v[120:121], v[122:123]
    v_add_f32 v120, v120, v121
    s_nop 1
    v_add_f32_dpp v120, v120, v120 quad_perm:[1,0,3,2] row_mask:0xf bank_mask:0xf
    s_nop 1
    v_add_f32_dpp v120, v120, v120 quad_perm:[2,3,0,1] row_mask:0xf bank_mask:0xf
    s_nop 1
    v_add_f32_dpp v120, v120, v120 row_ror:8 row_mask:0xf bank_mask:0xf
    v_mov_b32 v124, v120
    s_nop 1
    v_permlane16_swap_b32 v120, v124
    s_nop 1
    v_add_f32 v120, v120, v124
    v_mov_b32 v124, v120
    s_nop 1
    v_permlane32_swap_b32 v120, v124
    s_nop 1
    v_add_f32 v120, v120, v124
    v_mul_f32 v126, s38, v120
    v_mul_f32 v128, s38, -v120
    v_mul_f32 v129, s38, -v120
    v_pk_add_f32 v[132:133], v[96:97], v[128:129]
    v_pk_mul_f32 v[120:121], v[132:133], v[132:133]
    v_pk_add_f32 v[134:135], v[98:99], v[128:129]
    v_pk_mul_f32 v[122:123], v[134:135], v[134:135]
    v_pk_add_f32 v[136:137], v[100:101], v[128:129]
    v_pk_fma_f32 v[120:121], v[136:137], v[136:137], v[120:121]
    v_pk_add_f32 v[138:139], v[102:103], v[128:129]
    v_pk_fma_f32 v[122:123], v[138:139], v[138:139], v[122:123]
    v_pk_add_f32 v[132:133], v[104:105], v[128:129]
    v_pk_fma_f32 v[120:121], v[132:133], v[132:133], v[120:121]
    v_pk_add_f32 v[134:135], v[106:107], v[128:129]
    v_pk_fma_f32 v[122:123], v[134:135], v[134:135], v[122:123]
    v_pk_add_f32 v[136:137], v[108:109], v[128:129]
    v_pk_fma_f32 v[120:121], v[136:137], v[136:137], v[120:121]
    v_pk_add_f32 v[138:139], v[110:111], v[128:129]
    v_pk_fma_f32 v[122:123], v[138:139], v[138:139], v[122:123]
    s_mov_b32 exec_hi, 0
    v_pk_add_f32 v[132:133], v[112:113], v[128:129]
    v_pk_fma_f32 v[120:121], v[132:133], v[132:133], v[120:121]
    v_pk_add_f32 v[134:135], v[114:115], v[128:129]
    v_pk_fma_f32 v[122:123], v[134:135], v[134:135], v[122:123]
    v_pk_add_f32 v[136:137], v[116:117], v[128:129]
    v_pk_fma_f32 v[120:121], v[136:137], v[136:137], v[120:121]
    v_pk_add_f32 v[138:139], v[118:119], v[128:129]
    v_pk_fma_f32 v[122:123], v[138:139], v[138:139], v[122:123]
    s_mov_b64 exec, -1
    v_pk_add_f32 v[120:121], v[120:121], v[122:123]
    v_add_f32 v120, v120, v121
    s_nop 1
    v_add_f32_dpp v120, v120, v120 quad_perm:[1,0,3,2] row_mask:0xf bank_mask:0xf
    s_nop 1
    v_add_f32_dpp v120, v120, v120 quad_perm:[2,3,0,1] row_mask:0xf bank_mask:0xf
    s_nop 1
    v_add_f32_dpp v120, v120, v120 row_ror:8 row_mask:0xf bank_mask:0xf
    v_mov_b32 v124, v120
    s_nop 1
    v_permlane16_swap_b32 v120, v124
    s_nop 1
    v_add_f32 v120, v120, v124
    v_mov_b32 v124, v120
    s_nop 1
    v_permlane32_swap_b32 v120, v124
    s_nop 1
    v_add_f32 v120, v120, v124
    v_mul_f32 v130, s38, v120
    v_cvt_pk_bf16_f32 v126, v126, v126
    v_and_b32 v126, 0xffff0000, v126
    v_cvt_pk_bf16_f32 v130, v130, v130
    v_and_b32 v130, 0xffff0000, v130
    v_add_f32 v130, s39, v130
    v_cvt_pk_bf16_f32 v130, v130, v130
    v_and_b32 v130, 0xffff0000, v130
    v_sqrt_f32 v130, v130
    v_sub_f32 v128, 0, v126
    v_cvt_pk_bf16_f32 v130, v130, v130
    v_and_b32 v130, 0xffff0000, v130
    v_rcp_f32 v127, v130
    v_sub_f32 v129, 0, v126
    v_mul_f32 v120, 0x3dd53b95, v127
    v_mul_f32 v121, 0x3dd53b95, v127
    v_mov_b32 v130, v127
    v_mov_b32 v131, v127
    v_pk_add_f32 v[96:97], v[96:97], v[128:129]
    v_pk_mul_f32 v[132:133], v[96:97], v[120:121]
    v_cvt_pk_bf16_f32 v144, v132, v133
    v_pk_add_f32 v[98:99], v[98:99], v[128:129]
    v_pk_mul_f32 v[134:135], v[98:99], v[120:121]
    v_cvt_pk_bf16_f32 v145, v134, v135
    v_pk_add_f32 v[100:101], v[100:101], v[128:129]
    v_pk_mul_f32 v[136:137], v[100:101], v[120:121]
    v_cvt_pk_bf16_f32 v146, v136, v137
    v_pk_add_f32 v[102:103], v[102:103], v[128:129]
    v_pk_mul_f32 v[138:139], v[102:103], v[120:121]
    v_cvt_pk_bf16_f32 v147, v138, v139
    buffer_store_dwordx4 v[144:147], v243, s[24:27], s41 offen sc1
    v_pk_add_f32 v[104:105], v[104:105], v[128:129]
    v_pk_mul_f32 v[132:133], v[104:105], v[120:121]
    v_cvt_pk_bf16_f32 v148, v132, v133
    v_pk_add_f32 v[106:107], v[106:107], v[128:129]
    v_pk_mul_f32 v[134:135], v[106:107], v[120:121]
    v_cvt_pk_bf16_f32 v149, v134, v135
    v_pk_add_f32 v[108:109], v[108:109], v[128:129]
    v_pk_mul_f32 v[136:137], v[108:109], v[120:121]
    v_cvt_pk_bf16_f32 v150, v136, v137
    v_pk_add_f32 v[110:111], v[110:111], v[128:129]
    v_pk_mul_f32 v[138:139], v[110:111], v[120:121]
    v_cvt_pk_bf16_f32 v151, v138, v139
    buffer_store_dwordx4 v[148:151], v243, s[24:27], s42 offen sc1
    v_pk_add_f32 v[112:113], v[112:113], v[128:129]
    v_pk_mul_f32 v[132:133], v[112:113], v[120:121]
    v_cvt_pk_bf16_f32 v152, v132, v133
    v_pk_add_f32 v[114:115], v[114:115], v[128:129]
    v_pk_mul_f32 v[134:135], v[114:115], v[120:121]
    v_cvt_pk_bf16_f32 v153, v134, v135
    v_pk_add_f32 v[116:117], v[116:117], v[128:129]
    v_pk_mul_f32 v[136:137], v[116:117], v[120:121]
    v_cvt_pk_bf16_f32 v154, v136, v137
    v_pk_add_f32 v[118:119], v[118:119], v[128:129]
    v_pk_mul_f32 v[138:139], v[118:119], v[120:121]
    v_cvt_pk_bf16_f32 v155, v138, v139
    s_mov_b32 exec_hi, 0
    buffer_store_dwordx4 v[152:155], v243, s[24:27], s43 offen sc1
    s_mov_b64 exec, -1
    s_waitcnt vmcnt(12)
    v_readfirstlane_b32 s7, v26
    s_lshr_b32 s7, s7, 4
    s_mul_i32 s7, s7, 0x2c9277b5
    s_add_u32 s7, s7, 0x6c564b05
    s_lshl_b32 s7, s7, 4
    s_add_u32 m0, s49, 73728
    s_nop 0
    buffer_load_dwordx4 v2, s[8:11], s36 offen offset:0 lds
    s_add_u32 m0, s49, 74624
    s_nop 0
    buffer_load_dwordx4 v2, s[8:11], s36 offen offset:128 lds
    s_add_u32 m0, s49, 75520
    s_nop 0
    buffer_load_dwordx4 v2, s[8:11], s36 offen offset:256 lds
    s_add_u32 m0, s49, 76800
    s_nop 0
    buffer_load_dwordx4 v3, s[8:11], s36 offen offset:0 lds
    s_add_u32 m0, s49, 77696
    s_nop 0
    buffer_load_dwordx4 v3, s[8:11], s36 offen offset:128 lds
    s_add_u32 m0, s49, 78592
    s_nop 0
    buffer_load_dwordx4 v3, s[8:11], s36 offen offset:256 lds
    s_add_u32 s36, s36, s37
    s_sub_u32 s55, s36, 7864320
    s_min_u32 s36, s36, s55
    s_add_u32 m0, s49, 98304
    s_nop 0
    buffer_load_dwordx4 v2, s[8:11], s36 offen offset:0 lds
    s_add_u32 m0, s49, 99200
    s_nop 0
    buffer_load_dwordx4 v2, s[8:11], s36 offen offset:128 lds
    s_add_u32 m0, s49, 100096
    s_nop 0
    buffer_load_dwordx4 v2, s[8:11], s36 offen offset:256 lds
    s_add_u32 m0, s49, 101376
    s_nop 0
    buffer_load_dwordx4 v3, s[8:11], s36 offen offset:0 lds
    s_add_u32 m0, s49, 102272
    s_nop 0
    buffer_load_dwordx4 v3, s[8:11], s36 offen offset:128 lds
    s_add_u32 m0, s49, 103168
    s_nop 0
    buffer_load_dwordx4 v3, s[8:11], s36 offen offset:256 lds
    s_add_u32 s36, s36, s37
    s_sub_u32 s55, s36, 7864320
    s_min_u32 s36, s36, s55
    s_mov_b64 exec, 0
    s_cmp_eq_u32 s3, 0
    s_cbranch_scc1 pg_0
    s_cmp_eq_u32 s3, 1
    s_cbranch_scc1 pg_1
    s_cmp_eq_u32 s3, 2
    s_cbranch_scc1 pg_2
    s_branch pg_3
pg_back:
    s_mov_b64 exec, -1
    s_waitcnt vmcnt(12) lgkmcnt(0)
    s_barrier
    v_mov_b32 v21, s7
    s_mov_b64 exec, 0xff
    buffer_store_dword v21, v20, s[24:27], s6 offen sc1
    s_mov_b64 exec, 0x11
    v_lshlrev_b32 v29, 3, v240
    s_mov_b32 s56, 3211264
    buffer_store_dwordx2 v[126:127], v29, s[24:27], s56 offen sc1
    s_mov_b64 exec, -1
    s_waitcnt vmcnt(17)
    v_cvt_pk_bf16_f32 v64, v96, v97
    v_lshlrev_b32 v96, 16, v64
    v_and_b32 v97, 0xffff0000, v64
    v_pk_mul_f32 v[96:97], v[96:97], v[130:131]
    v_cvt_pk_bf16_f32 v64, v96, v97
    v_lshlrev_b32 v96, 16, v64
    v_and_b32 v97, 0xffff0000, v64
    v_lshlrev_b32 v132, 16, v76
    v_and_b32 v133, 0xffff0000, v76
    v_pk_mul_f32 v[120:121], v[96:97], v[132:133]
    v_cvt_pk_bf16_f32 v65, v98, v99
    v_lshlrev_b32 v98, 16, v65
    v_and_b32 v99, 0xffff0000, v65
    v_pk_mul_f32 v[98:99], v[98:99], v[130:131]
    v_cvt_pk_bf16_f32 v65, v98, v99
    v_lshlrev_b32 v98, 16, v65
    v_and_b32 v99, 0xffff0000, v65
    v_lshlrev_b32 v134, 16, v77
    v_and_b32 v135, 0xffff0000, v77
    v_pk_mul_f32 v[122:123], v[98:99], v[134:135]
    v_cvt_pk_bf16_f32 v66, v100, v101
    v_lshlrev_b32 v100, 16, v66
    v_and_b32 v101, 0xffff0000, v66
    v_pk_mul_f32 v[100:101], v[100:101], v[130:131]
    v_cvt_pk_bf16_f32 v66, v100, v101
    v_lshlrev_b32 v100, 16, v66
    v_and_b32 v101, 0xffff0000, v66
    v_lshlrev_b32 v136, 16, v78
    v_and_b32 v137, 0xffff0000, v78
    v_pk_fma_f32 v[120:121], v[100:101], v[136:137], v[120:121]
    v_cvt_pk_bf16_f32 v67, v102, v103
    v_lshlrev_b32 v102, 16, v67
    v_and_b32 v103, 0xffff0000, v67
    v_pk_mul_f32 v[102:103], v[102:103], v[130:131]
    v_cvt_pk_bf16_f32 v67, v102, v103
    v_lshlrev_b32 v102, 16, v67
    v_and_b32 v103, 0xffff0000, v67
    v_lshlrev_b32 v138, 16, v79
    v_and_b32 v139, 0xffff0000, v79
    v_pk_fma_f32 v[122:123], v[102:103], v[138:139], v[122:123]
    s_add_u32 m0, s49, 122880
    s_nop 0
    buffer_load_dwordx4 v2, s[8:11], s36 offen offset:0 lds
    s_add_u32 m0, s49, 123776
    s_nop 0
    buffer_load_dwordx4 v2, s[8:11], s36 offen offset:128 lds
    s_add_u32 m0, s49, 124672
    s_nop 0
    buffer_load_dwordx4 v2, s[8:11], s36 offen offset:256 lds
    s_add_u32 m0, s49, 125952
    s_nop 0
    buffer_load_dwordx4 v3, s[8:11], s36 offen offset:0 lds
    s_add_u32 m0, s49, 126848
    s_nop 0
    buffer_load_dwordx4 v3, s[8:11], s36 offen offset:128 lds
    s_add_u32 m0, s49, 127744
    s_nop 0
    buffer_load_dwordx4 v3, s[8:11], s36 offen offset:256 lds
    s_add_u32 s36, s36, s37
    s_sub_u32 s55, s36, 7864320
    s_min_u32 s36, s36, s55
    v_cvt_pk_bf16_f32 v68, v104, v105
    v_lshlrev_b32 v104, 16, v68
    v_and_b32 v105, 0xffff0000, v68
    v_pk_mul_f32 v[104:105], v[104:105], v[130:131]
    v_cvt_pk_bf16_f32 v68, v104, v105
    v_lshlrev_b32 v104, 16, v68
    v_and_b32 v105, 0xffff0000, v68
    v_lshlrev_b32 v132, 16, v80
    v_and_b32 v133, 0xffff0000, v80
    v_pk_fma_f32 v[120:121], v[104:105], v[132:133], v[120:121]
spin_ln:
    s_load_dwordx8 s[28:35], s[86:87], s46 glc
    s_add_u32 s101, s101, 1
    s_cmp_gt_u32 s101, 0x2000000
    s_cselect_b32 s57, 0, -1
    s_waitcnt lgkmcnt(0)
    s_xor_b32 s56, s28, s7
    s_xor_b32 s29, s29, s7
    s_or_b32 s56, s56, s29
    s_xor_b32 s30, s30, s7
    s_or_b32 s56, s56, s30
    s_xor_b32 s31, s31, s7
    s_or_b32 s56, s56, s31
    s_xor_b32 s32, s32, s7
    s_or_b32 s56, s56, s32
    s_xor_b32 s33, s33, s7
    s_or_b32 s56, s56, s33
    s_xor_b32 s34, s34, s7
    s_or_b32 s56, s56, s34
    s_xor_b32 s35, s35, s7
    s_or_b32 s56, s56, s35
    s_and_b32 s56, s56, s57
    s_cbranch_scc1 spin_ln
    s_add_u32 s46, s45, 0
    s_sub_u32 s77, s46, 81920
    s_min_u32 s46, s46, s77
    buffer_load_dwordx4 a[160:163], v14, s[20:23], s46 offen offset:0 sc1
    buffer_load_dwordx4 a[164:167], v14, s[20:23], s46 offen offset:1024 sc1
    buffer_load_dwordx4 a[168:171], v15, s[20:23], s46 offen offset:0 sc1
    buffer_load_dwordx4 a[172:175], v15, s[20:23], s46 offen offset:1024 sc1
    s_add_u32 s46, s45, 4096
    s_sub_u32 s77, s46, 81920
    s_min_u32 s46, s46, s77
    buffer_load_dwordx4 a[176:179], v14, s[20:23], s46 offen offset:0 sc1
    buffer_load_dwordx4 a[180:183], v14, s[20:23], s46 offen offset:1024 sc1
    buffer_load_dwordx4 a[184:187], v15, s[20:23], s46 offen offset:0 sc1
    buffer_load_dwordx4 a[188:191], v15, s[20:23], s46 offen offset:1024 sc1
    v_cvt_pk_bf16_f32 v69, v106, v107
    v_lshlrev_b32 v106, 16, v69
    v_and_b32 v107, 0xffff0000, v69
    v_pk_mul_f32 v[106:107], v[106:107], v[130:131]
    v_cvt_pk_bf16_f32 v69, v106, v107
    v_lshlrev_b32 v106, 16, v69
    v_and_b32 v107, 0xffff0000, v69
    v_lshlrev_b32 v134, 16, v81
    v_and_b32 v135, 0xffff0000, v81
    v_pk_fma_f32 v[122:123], v[106:107], v[134:135], v[122:123]
    s_branch page0
    .p2align 12
page0:
pg_0:
    s_cbranch_execz pg_4
    v_cvt_pk_bf16_f32 v70, v108, v109
    v_lshlrev_b32 v108, 16, v70
    v_and_b32 v109, 0xffff0000, v70
    v_pk_mul_f32 v[108:109], v[108:109], v[130:131]
    v_cvt_pk_bf16_f32 v70, v108, v109
    v_lshlrev_b32 v108, 16, v70
    v_and_b32 v109, 0xffff0000, v70
    v_lshlrev_b32 v136, 16, v82
    v_and_b32 v137, 0xffff0000, v82
    v_pk_fma_f32 v[120:121], v[108:109], v[136:137], v[120:121]
    v_cvt_pk_bf16_f32 v71, v110, v111
    v_lshlrev_b32 v110, 16, v71
    v_and_b32 v111, 0xffff0000, v71
    v_pk_mul_f32 v[110:111], v[110:111], v[130:131]
    v_cvt_pk_bf16_f32 v71, v110, v111
    v_lshlrev_b32 v110, 16, v71
    v_and_b32 v111, 0xffff0000, v71
    v_lshlrev_b32 v138, 16, v83
    v_and_b32 v139, 0xffff0000, v83
    v_pk_fma_f32 v[122:123], v[110:111], v[138:139], v[122:123]
    s_mov_b32 exec_hi, 0
    v_cvt_pk_bf16_f32 v72, v112, v113
    v_lshlrev_b32 v112, 16, v72
    v_and_b32 v113, 0xffff0000, v72
    v_pk_mul_f32 v[112:113], v[112:113], v[130:131]
    v_cvt_pk_bf16_f32 v72, v112, v113
    v_lshlrev_b32 v112, 16, v72
    v_and_b32 v113, 0xffff0000, v72
    v_lshlrev_b32 v132, 16, v84
    v_and_b32 v133, 0xffff0000, v84
    v_pk_fma_f32 v[120:121], v[112:113], v[132:133], v[120:121]
    v_cvt_pk_bf16_f32 v73, v114, v115
    v_lshlrev_b32 v114, 16, v73
    v_and_b32 v115, 0xffff0000, v73
    v_pk_mul_f32 v[114:115], v[114:115], v[130:131]
    v_cvt_pk_bf16_f32 v73, v114, v115
    v_lshlrev_b32 v114, 16, v73
    v_and_b32 v115, 0xffff0000, v73
    v_lshlrev_b32 v134, 16, v85
    v_and_b32 v135, 0xffff0000, v85
    v_pk_fma_f32 v[122:123], v[114:115], v[134:135], v[122:123]
    v_cvt_pk_bf16_f32 v74, v116, v117
    v_lshlrev_b32 v116, 16, v74
    v_and_b32 v117, 0xffff0000, v74
    v_pk_mul_f32 v[116:117], v[116:117], v[130:131]
    v_cvt_pk_bf16_f32 v74, v116, v117
    v_lshlrev_b32 v116, 16, v74
    v_and_b32 v117, 0xffff0000, v74
    v_lshlrev_b32 v136, 16, v86
    v_and_b32 v137, 0xffff0000, v86
    v_pk_fma_f32 v[120:121], v[116:117], v[136:137], v[120:121]
    v_cvt_pk_bf16_f32 v75, v118, v119
    v_lshlrev_b32 v118, 16, v75
    v_and_b32 v119, 0xffff0000, v75
    v_pk_mul_f32 v[118:119], v[118:119], v[130:131]
    v_cvt_pk_bf16_f32 v75, v118, v119
    v_lshlrev_b32 v118, 16, v75
    v_and_b32 v119, 0xffff0000, v75
    v_lshlrev_b32 v138, 16, v87
    v_and_b32 v139, 0xffff0000, v87
    v_pk_fma_f32 v[122:123], v[118:119], v[138:139], v[122:123]
    s_mov_b64 exec, -1
    v_pk_add_f32 v[120:121], v[120:121], v[122:123]
    v_add_f32 v120, v120, v121
    s_nop 1
    v_add_f32_dpp v120, v120, v120 quad_perm:[1,0,3,2] row_mask:0xf bank_mask:0xf
    s_nop 1
    v_add_f32_dpp v120, v120, v120 quad_perm:[2,3,0,1] row_mask:0xf bank_mask:0xf
    s_nop 1
    v_add_f32_dpp v120, v120, v120 row_ror:8 row_mask:0xf bank_mask:0xf
    v_mov_b32 v124, v120
    s_nop 1
    v_permlane16_swap_b32 v120, v124
    s_nop 1
    v_add_f32 v120, v120, v124
    v_mov_b32 v124, v120
    s_nop 1
    v_permlane32_swap_b32 v120, v124
    s_nop 1
    v_add_f32 v120, v120, v124
    v_cvt_pk_bf16_f32 v120, v120, v120
    v_and_b32 v120, 0xffff0000, v120
    v_ashrrev_i32 v122, 31, v120
    v_or_b32 v122, 0x80000000, v122
    v_xor_b32 v120, v120, v122
    v_and_b32 v120, 0xffff0000, v120
    v_sub_u32 v122, 2047, v240
    v_or_b32 v32, v120, v122
    v_mov_b32 v34, s7
    v_mov_b32 v35, s7
    v_mov_b32_dpp v33, v32 row_ror:4 row_mask:0xf bank_mask:0xf
head_code:
    s_waitcnt vmcnt(34)
    s_barrier
    ds_read_b64_tr_b16 a[224:225], v8 offset:0
    ds_read_b64_tr_b16 a[226:227], v8 offset:6144
    ds_read_b64_tr_b16 a[228:229], v9 offset:0
    ds_read_b64_tr_b16 a[230:231], v9 offset:6144
    ds_read_b64_tr_b16 a[232:233], v10 offset:0
    ds_read_b64_tr_b16 a[234:235], v10 offset:6144
    ds_read_b64_tr_b16 a[236:237], v11 offset:0
    ds_read_b64_tr_b16 a[238:239], v11 offset:6144
    ds_read_b64_tr_b16 a[240:241], v8 offset:1024
    ds_read_b64_tr_b16 a[242:243], v8 offset:7168
    ds_read_b64_tr_b16 a[244:245], v9 offset:1024
    ds_read_b64_tr_b16 a[246:247], v9 offset:7168
    s_waitcnt vmcnt(7) lgkmcnt(10)
    v_mfma_f32_16x16x32_bf16 v[64:67], a[224:227], a[160:163], 0
    s_waitcnt vmcnt(6) lgkmcnt(8)
    v_min_u32 v36, 1, v1
    v_lshlrev_b32 v36, 30, v36
    v_mfma_f32_16x16x32_bf16 v[68:71], a[228:231], a[160:163], 0
    s_waitcnt vmcnt(5)
    s_add_u32 s46, s45, 8192
    s_sub_u32 s77, s46, 81920
    v_mfma_f32_16x16x32_bf16 v[76:79], a[228:231], a[164:167], 0
    s_min_u32 s46, s46, s77
    s_lshl_b32 s56, s2, 2
    s_add_u32 s56, s56, s3
    v_mfma_f32_16x16x32_bf16 v[72:75], a[224:227], a[164:167], 0
    buffer_load_dwordx4 a[96:99], v14, s[20:23], s46 offen offset:0 sc1
    v_mfma_f32_16x16x32_bf16 v[80:83], a[224:227], a[168:171], 0
    s_waitcnt vmcnt(5)
    s_lshl_b32 s56, s56, 4
    s_add_u32 s56, s56, 3162112
    v_mfma_f32_16x16x32_bf16 v[84:87], a[228:231], a[168:171], 0
    buffer_store_dwordx4 v[32:35], v36, s[24:27], s56 offen sc1
    v_mfma_f32_16x16x32_bf16 v[92:95], a[228:231], a[172:175], 0
    s_waitcnt lgkmcnt(0)
    ds_read_b64_tr_b16 a[228:229], v11 offset:1024
    v_mfma_f32_16x16x32_bf16 v[88:91], a[224:227], a[172:175], 0
    ds_read_b64_tr_b16 a[230:231], v11 offset:7168
    v_mfma_f32_16x16x32_bf16 v[120:123], a[232:235], a[172:175], 0
    buffer_load_dwordx4 a[100:103], v14, s[20:23], s46 offen offset:1024 sc1
    v_mfma_f32_16x16x32_bf16 v[124:127], a[236:239], a[172:175], 0
    s_mul_i32 s56, s50, 786432
    ds_read_b64_tr_b16 a[224:225], v10 offset:1024
    v_mul_u32_u24 v56, 3072, v5
    v_mfma_f32_16x16x32_bf16 v[116:119], a[236:239], a[168:171], 0
    s_add_u32 s56, s56, 589824
    ds_read_b64_tr_b16 a[226:227], v10 offset:7168
    v_add_u32 v56, v56, v7
    v_mfma_f32_16x16x32_bf16 v[112:115], a[232:235], a[168:171], 0
    s_add_u32 s12, s66, s56
    s_addc_u32 s13, s67, 0
    v_add_u32 v57, 49152, v56
    v_mfma_f32_16x16x32_bf16 v[104:107], a[232:235], a[164:167], 0
    s_and_b32 s13, s13, 0xffff
    v_lshrrev_b32 v29, 3, v1
    v_mul_u32_u24 v31, 384, v29
    v_mfma_f32_16x16x32_bf16 v[108:111], a[236:239], a[164:167], 0
    s_mov_b32 s14, 196608
    v_add_u32 v6, v31, v7
    v_bfe_u32 v29, v1, 4, 1
    v_mfma_f32_16x16x32_bf16 v[100:103], a[236:239], a[160:163], 0
    s_mov_b32 s15, 0x00020000
    ds_read_b64_tr_b16 a[236:237], v9 offset:2048
    v_bfe_u32 v30, v1, 5, 1
    v_mfma_f32_16x16x32_bf16 v[96:99], a[232:235], a[160:163], 0
    buffer_load_dwordx4 a[104:107], v15, s[20:23], s46 offen offset:0 sc1
    v_mfma_f32_16x16x32_bf16 v[128:131], a[240:243], a[160:163], 0
    s_add_u32 s16, s68, s56
    s_addc_u32 s17, s69, 0
    v_lshl_add_u32 v29, v29, 1, v30
    v_mfma_f32_16x16x32_bf16 v[132:135], a[244:247], a[160:163], 0
    s_and_b32 s17, s17, 0xffff
    ds_read_b64_tr_b16 a[238:239], v9 offset:8192
    v_and_b32 v30, 7, v1
    v_mfma_f32_16x16x32_bf16 v[140:143], a[244:247], a[164:167], 0
    s_mov_b32 s18, 196608
    ds_read_b64_tr_b16 a[232:233], v8 offset:2048
    v_xor_b32 v30, v30, v29
    v_mfma_f32_16x16x32_bf16 v[136:139], a[240:243], a[164:167], 0
    s_mov_b32 s19, 0x00020000
    ds_read_b64_tr_b16 a[234:235], v8 offset:8192
    v_lshl_add_u32 v4, v30, 4, v31
    v_mfma_f32_16x16x32_bf16 v[144:147], a[240:243], a[168:171], 0
    s_mov_b32 s28, s78
    v_xor_b32 v30, 4, v30
    v_lshl_add_u32 v5, v30, 4, v31
    v_mfma_f32_16x16x32_bf16 v[148:151], a[244:247], a[168:171], 0
    buffer_load_dwordx4 a[108:111], v15, s[20:23], s46 offen offset:1024 sc1
    v_mfma_f32_16x16x32_bf16 v[156:159], a[244:247], a[172:175], 0
    s_waitcnt lgkmcnt(3)
    ds_read_b64_tr_b16 a[244:245], v11 offset:2048
    v_add_u32 v5, 3072, v5
    v_mfma_f32_16x16x32_bf16 v[152:155], a[240:243], a[172:175], 0
    s_add_u32 s46, s45, 12288
    ds_read_b64_tr_b16 a[246:247], v11 offset:8192
    v_bfe_u32 v30, v1, 1, 1
    v_mfma_f32_16x16x32_bf16 v[184:187], a[224:227], a[172:175], 0
    s_sub_u32 s77, s46, 81920
    ds_read_b64_tr_b16 a[240:241], v10 offset:2048
    v_bfe_u32 v31, v1, 2, 1
    v_mfma_f32_16x16x32_bf16 v[188:191], a[228:231], a[172:175], 0
    s_min_u32 s46, s46, s77
    ds_read_b64_tr_b16 a[242:243], v10 offset:8192
    v_lshl_add_u32 v30, v30, 1, v31
    v_mfma_f32_16x16x32_bf16 v[180:183], a[228:231], a[168:171], 0
    s_and_b32 s29, s79, 0xffff
    v_bfe_u32 v31, v1, 3, 1
    v_lshl_add_u32 v30, v31, 2, v30
    v_mfma_f32_16x16x32_bf16 v[176:179], a[224:227], a[168:171], 0
    s_mov_b32 s30, 1966080
    v_xor_b32 v30, v30, v29
    v_lshlrev_b32 v30, 4, v30
    v_mfma_f32_16x16x32_bf16 v[168:171], a[224:227], a[164:167], 0
    buffer_load_dwordx4 a[112:115], v14, s[20:23], s46 offen offset:0 sc1
    v_mfma_f32_16x16x32_bf16 v[172:175], a[228:231], a[164:167], 0
    s_waitcnt lgkmcnt(3)
    v_mul_u32_u24 v31, 3072, v31
    v_and_b32 v29, 7, v1
    v_mfma_f32_16x16x32_bf16 v[164:167], a[228:231], a[160:163], 0
    s_mov_b32 s31, 0x00020000
    ds_read_b64_tr_b16 a[228:229], v9 offset:12288
    v_lshl_add_u32 v31, v29, 7, v31
    v_mfma_f32_16x16x32_bf16 v[160:163], a[224:227], a[160:163], 0
    s_mov_b32 s32, s80
    ds_read_b64_tr_b16 a[230:231], v9 offset:18432
    v_add_u32 v12, v31, v30
    v_mfma_f32_16x16x32_bf16 v[192:195], a[232:235], a[160:163], 0
    s_and_b32 s33, s81, 0xffff
    ds_read_b64_tr_b16 a[224:225], v8 offset:12288
    v_xor_b32 v30, 64, v30
    v_mfma_f32_16x16x32_bf16 v[196:199], a[236:239], a[160:163], 0
    s_mov_b32 s34, 1966080
    ds_read_b64_tr_b16 a[226:227], v8 offset:18432
    v_add_u32 v13, v31, v30
    v_mfma_f32_16x16x32_bf16 v[204:207], a[236:239], a[164:167], 0
    buffer_load_dwordx4 a[116:119], v14, s[20:23], s46 offen offset:1024 sc1
    v_mfma_f32_16x16x32_bf16 v[200:203], a[232:235], a[164:167], 0
    s_mov_b32 s35, 0x00020000
    v_lshrrev_b32 v19, 5, v1
    v_lshlrev_b32 v19, 11, v19
    v_mfma_f32_16x16x32_bf16 v[208:211], a[232:235], a[168:171], 0
    s_min_u32 s58, s2, 239
    v_sub_u32 v19, 0xffffa000, v19
    s_mul_hi_u32 s56, s58, 178956971
    v_mfma_f32_16x16x32_bf16 v[212:215], a[236:239], a[168:171], 0
    s_waitcnt lgkmcnt(3)
    s_mul_i32 s57, s56, 24
    s_sub_u32 s57, s58, s57
    v_mfma_f32_16x16x32_bf16 v[220:223], a[236:239], a[172:175], 0
    s_lshl_b32 s60, s56, 6
    ds_read_b64_tr_b16 a[236:237], v11 offset:12288
    s_add_u32 s60, s60, s59
    v_mfma_f32_16x16x32_bf16 v[216:219], a[232:235], a[172:175], 0
    s_mul_i32 s60, s60, 3072
    ds_read_b64_tr_b16 a[238:239], v11 offset:18432
    s_lshl_b32 s44, s57, 7
    v_mfma_f32_16x16x32_bf16 v[248:251], a[240:243], a[172:175], 0
    s_add_u32 s60, s60, s44
    ds_read_b64_tr_b16 a[232:233], v10 offset:12288
    s_lshl_b32 s61, s56, 7
    v_mfma_f32_16x16x32_bf16 v[252:255], a[244:247], a[172:175], 0
    buffer_load_dwordx4 a[120:123], v15, s[20:23], s46 offen offset:0 sc1
    v_mfma_f32_16x16x32_bf16 v[244:247], a[244:247], a[168:171], 0
    s_mul_i32 s62, s56, 1536
    ds_read_b64_tr_b16 a[234:235], v10 offset:18432
    s_lshl_b32 s44, s57, 6
    v_mfma_f32_16x16x32_bf16 v[240:243], a[240:243], a[168:171], 0
    s_add_u32 s62, s62, s44
    s_lshl_b32 s44, s3, 4
    s_add_u32 s62, s62, s44
    v_mfma_f32_16x16x32_bf16 v[232:235], a[240:243], a[164:167], 0
    s_lshl_b32 s62, s62, 4
    s_add_u32 s62, s62, 3276800
    s_lshl_b32 s4, s2, 8
    v_mfma_f32_16x16x32_bf16 v[236:239], a[244:247], a[164:167], 0
    s_waitcnt vmcnt(11) lgkmcnt(3)
    s_lshl_b32 s44, s3, 2
    s_add_u32 s4, s4, s44
    v_mfma_f32_16x16x32_bf16 v[228:231], a[244:247], a[160:163], 0
    s_add_u32 s4, s4, 3932160
    ds_read_b64_tr_b16 a[244:245], v9 offset:13312
    s_lshl_b32 s5, s52, 3
    v_mfma_f32_16x16x32_bf16 v[224:227], a[240:243], a[160:163], 0
    buffer_load_dwordx4 a[124:127], v15, s[20:23], s46 offen offset:1024 sc1
    v_mfma_f32_16x16x32_bf16 v[64:67], a[224:227], a[176:179], v[64:67]
    s_waitcnt vmcnt(11)
    ds_read_b64_tr_b16 a[246:247], v9 offset:19456
    s_add_u32 s46, s45, 16384
    v_mfma_f32_16x16x32_bf16 v[68:71], a[228:231], a[176:179], v[68:71]
    s_waitcnt vmcnt(10)
    ds_read_b64_tr_b16 a[240:241], v8 offset:13312
    s_sub_u32 s77, s46, 81920
    v_mfma_f32_16x16x32_bf16 v[76:79], a[228:231], a[180:183], v[76:79]
    s_min_u32 s46, s46, s77
    ds_read_b64_tr_b16 a[242:243], v8 offset:19456
    s_add_u32 s5, s5, s53
    v_mfma_f32_16x16x32_bf16 v[72:75], a[224:227], a[180:183], v[72:75]
    s_waitcnt vmcnt(9)
    s_lshl_b32 s5, s5, 2
    s_add_u32 s5, s5, s3
    v_mfma_f32_16x16x32_bf16 v[80:83], a[224:227], a[184:187], v[80:83]
    s_lshl_b32 s5, s5, 7
    s_add_u32 s5, s5, 4096000
    s_lshl_b32 s76, s51, 2
    v_mfma_f32_16x16x32_bf16 v[84:87], a[228:231], a[184:187], v[84:87]
    s_waitcnt lgkmcnt(3)
    s_add_u32 s76, s76, s5
    s_mov_b32 s92, 0xbfb8aa3b
    v_mfma_f32_16x16x32_bf16 v[92:95], a[228:231], a[188:191], v[92:95]
    buffer_load_dwordx4 a[128:131], v14, s[20:23], s46 offen offset:0 sc1
    v_mfma_f32_16x16x32_bf16 v[88:91], a[224:227], a[188:191], v[88:91]
    s_lshl_b32 s44, s3, 12
    ds_read_b64_tr_b16 a[228:229], v11 offset:13312
    s_mov_b32 s38, s49
    v_mfma_f32_16x16x32_bf16 v[120:123], a[232:235], a[188:191], v[120:123]
    s_mul_i32 s40, s3, 3072
    ds_read_b64_tr_b16 a[230:231], v11 offset:19456
    s_mov_b32 s47, 3162112
    v_mfma_f32_16x16x32_bf16 v[124:127], a[236:239], a[188:191], v[124:127]
    s_lshl_b32 s63, s3, 10
    ds_read_b64_tr_b16 a[224:225], v10 offset:13312
    s_lshl_b32 s67, s2, 2
    v_mfma_f32_16x16x32_bf16 v[116:119], a[236:239], a[184:187], v[116:119]
    s_add_u32 s67, s67, s3
    ds_read_b64_tr_b16 a[226:227], v10 offset:19456
    s_lshl_b32 s67, s67, 7
    v_mfma_f32_16x16x32_bf16 v[112:115], a[232:235], a[184:187], v[112:115]
    s_add_u32 s67, s67, 4194304
    v_mfma_f32_16x16x32_bf16 v[104:107], a[232:235], a[180:183], v[104:107]
    buffer_load_dwordx4 a[132:135], v14, s[20:23], s46 offen offset:1024 sc1
    v_mfma_f32_16x16x32_bf16 v[108:111], a[236:239], a[180:183], v[108:111]
    s_waitcnt lgkmcnt(4)
    v_mfma_f32_16x16x32_bf16 v[100:103], a[236:239], a[176:179], v[100:103]
    ds_read_b64_tr_b16 a[236:237], v9 offset:14336
    v_mfma_f32_16x16x32_bf16 v[96:99], a[232:235], a[176:179], v[96:99]
    ds_read_b64_tr_b16 a[238:239], v9 offset:20480
    v_mfma_f32_16x16x32_bf16 v[128:131], a[240:243], a[176:179], v[128:131]
    ds_read_b64_tr_b16 a[232:233], v8 offset:14336
    v_mfma_f32_16x16x32_bf16 v[132:135], a[244:247], a[176:179], v[132:135]
    ds_read_b64_tr_b16 a[234:235], v8 offset:20480
    v_mfma_f32_16x16x32_bf16 v[140:143], a[244:247], a[180:183], v[140:143]
    v_mfma_f32_16x16x32_bf16 v[136:139], a[240:243], a[180:183], v[136:139]
    buffer_load_dwordx4 a[136:139], v15, s[20:23], s46 offen offset:0 sc1
    v_mfma_f32_16x16x32_bf16 v[144:147], a[240:243], a[184:187], v[144:147]
    v_mfma_f32_16x16x32_bf16 v[148:151], a[244:247], a[184:187], v[148:151]
    s_waitcnt lgkmcnt(3)
    v_mfma_f32_16x16x32_bf16 v[156:159], a[244:247], a[188:191], v[156:159]
    ds_read_b64_tr_b16 a[244:245], v11 offset:14336
    ds_read_b64_tr_b16 a[246:247], v11 offset:20480
    v_mfma_f32_16x16x32_bf16 v[152:155], a[240:243], a[188:191], v[152:155]
    ds_read_b64_tr_b16 a[240:241], v10 offset:14336
    ds_read_b64_tr_b16 a[242:243], v10 offset:20480
    v_mfma_f32_16x16x32_bf16 v[184:187], a[224:227], a[188:191], v[184:187]
    v_mfma_f32_16x16x32_bf16 v[188:191], a[228:231], a[188:191], v[188:191]
    buffer_load_dwordx4 a[140:143], v15, s[20:23], s46 offen offset:1024 sc1
    v_mfma_f32_16x16x32_bf16 v[180:183], a[228:231], a[184:187], v[180:183]
    s_add_u32 s46, s45, 20480
    s_sub_u32 s77, s46, 81920
    s_min_u32 s46, s46, s77
    v_mfma_f32_16x16x32_bf16 v[176:179], a[224:227], a[184:187], v[176:179]
    v_mfma_f32_16x16x32_bf16 v[168:171], a[224:227], a[180:183], v[168:171]
    v_mfma_f32_16x16x32_bf16 v[172:175], a[228:231], a[180:183], v[172:175]
    s_waitcnt lgkmcnt(2)
    v_mfma_f32_16x16x32_bf16 v[164:167], a[228:231], a[176:179], v[164:167]
    s_waitcnt lgkmcnt(0)
    s_barrier
    v_mfma_f32_16x16x32_bf16 v[160:163], a[224:227], a[176:179], v[160:163]
    ds_read_b64_tr_b16 a[224:225], v8 offset:24576
    v_mfma_f32_16x16x32_bf16 v[192:195], a[232:235], a[176:179], v[192:195]
    buffer_load_dwordx4 a[144:147], v14, s[20:23], s46 offen offset:0 sc1
    v_mfma_f32_16x16x32_bf16 v[196:199], a[236:239], a[176:179], v[196:199]
    ds_read_b64_tr_b16 a[226:227], v8 offset:30720
    v_mfma_f32_16x16x32_bf16 v[204:207], a[236:239], a[180:183], v[204:207]
    ds_read_b64_tr_b16 a[228:229], v8 offset:36864
    v_mfma_f32_16x16x32_bf16 v[200:203], a[232:235], a[180:183], v[200:203]
    ds_read_b64_tr_b16 a[230:231], v8 offset:43008
    v_mfma_f32_16x16x32_bf16 v[208:211], a[232:235], a[184:187], v[208:211]
    v_mfma_f32_16x16x32_bf16 v[212:215], a[236:239], a[184:187], v[212:215]
    v_mfma_f32_16x16x32_bf16 v[220:223], a[236:239], a[188:191], v[220:223]
    buffer_load_dwordx4 a[148:151], v14, s[20:23], s46 offen offset:1024 sc1
    v_mfma_f32_16x16x32_bf16 v[216:219], a[232:235], a[188:191], v[216:219]
    ds_read_b64_tr_b16 a[232:233], v9 offset:24576
    v_mfma_f32_16x16x32_bf16 v[248:251], a[240:243], a[188:191], v[248:251]
    ds_read_b64_tr_b16 a[234:235], v9 offset:30720
    v_mfma_f32_16x16x32_bf16 v[252:255], a[244:247], a[188:191], v[252:255]
    ds_read_b64_tr_b16 a[236:237], v9 offset:36864
    v_mfma_f32_16x16x32_bf16 v[244:247], a[244:247], a[184:187], v[244:247]
    ds_read_b64_tr_b16 a[238:239], v9 offset:43008
    v_mfma_f32_16x16x32_bf16 v[240:243], a[240:243], a[184:187], v[240:243]
    v_mfma_f32_16x16x32_bf16 v[232:235], a[240:243], a[180:183], v[232:235]
    v_mfma_f32_16x16x32_bf16 v[236:239], a[244:247], a[180:183], v[236:239]
    buffer_load_dwordx4 a[152:155], v15, s[20:23], s46 offen offset:0 sc1
    v_mfma_f32_16x16x32_bf16 v[228:231], a[244:247], a[176:179], v[228:231]
    s_waitcnt vmcnt(10) lgkmcnt(3)
    v_mfma_f32_16x16x32_bf16 v[224:227], a[240:243], a[176:179], v[224:227]
    s_waitcnt vmcnt(9)
    ds_read_b64_tr_b16 a[240:241], v10 offset:24576
    v_mfma_f32_16x16x32_bf16 v[64:67], a[224:227], a[96:99], v[64:67]
    ds_read_b64_tr_b16 a[242:243], v10 offset:30720
    v_mfma_f32_16x16x32_bf16 v[64:67], a[228:231], a[112:115], v[64:67]
    ds_read_b64_tr_b16 a[244:245], v10 offset:36864
    v_mfma_f32_16x16x32_bf16 v[72:75], a[228:231], a[116:119], v[72:75]
    s_waitcnt vmcnt(8)
    ds_read_b64_tr_b16 a[246:247], v10 offset:43008
    v_mfma_f32_16x16x32_bf16 v[72:75], a[224:227], a[100:103], v[72:75]
    buffer_load_dwordx4 a[156:159], v15, s[20:23], s46 offen offset:1024 sc1
    v_mfma_f32_16x16x32_bf16 v[80:83], a[224:227], a[104:107], v[80:83]
    s_waitcnt vmcnt(8)
    s_add_u32 s46, s45, 24576
    s_sub_u32 s77, s46, 81920
    v_mfma_f32_16x16x32_bf16 v[80:83], a[228:231], a[120:123], v[80:83]
    s_waitcnt lgkmcnt(4)
    s_min_u32 s46, s46, s77
    v_mfma_f32_16x16x32_bf16 v[88:91], a[228:231], a[124:127], v[88:91]
    v_mfma_f32_16x16x32_bf16 v[88:91], a[224:227], a[108:111], v[88:91]
    ds_read_b64_tr_b16 a[224:225], v11 offset:24576
    v_mfma_f32_16x16x32_bf16 v[92:95], a[232:235], a[108:111], v[92:95]
    ds_read_b64_tr_b16 a[226:227], v11 offset:30720
    v_mfma_f32_16x16x32_bf16 v[92:95], a[236:239], a[124:127], v[92:95]
    ds_read_b64_tr_b16 a[228:229], v11 offset:36864
    v_mfma_f32_16x16x32_bf16 v[84:87], a[236:239], a[120:123], v[84:87]
    buffer_load_dwordx4 a[192:195], v14, s[20:23], s46 offen offset:0 sc1
    v_mfma_f32_16x16x32_bf16 v[84:87], a[232:235], a[104:107], v[84:87]
    ds_read_b64_tr_b16 a[230:231], v11 offset:43008
    v_mfma_f32_16x16x32_bf16 v[76:79], a[232:235], a[100:103], v[76:79]
    v_mfma_f32_16x16x32_bf16 v[76:79], a[236:239], a[116:119], v[76:79]
    s_waitcnt lgkmcnt(4)
    v_mfma_f32_16x16x32_bf16 v[68:71], a[236:239], a[112:115], v[68:71]
    v_mfma_f32_16x16x32_bf16 v[68:71], a[232:235], a[96:99], v[68:71]
    ds_read_b64_tr_b16 a[232:233], v8 offset:25600
    v_mfma_f32_16x16x32_bf16 v[96:99], a[240:243], a[96:99], v[96:99]
    buffer_load_dwordx4 a[196:199], v14, s[20:23], s46 offen offset:1024 sc1
    v_mfma_f32_16x16x32_bf16 v[96:99], a[244:247], a[112:115], v[96:99]
    ds_read_b64_tr_b16 a[234:235], v8 offset:31744
    v_mfma_f32_16x16x32_bf16 v[104:107], a[244:247], a[116:119], v[104:107]
    ds_read_b64_tr_b16 a[236:237], v8 offset:37888
    v_mfma_f32_16x16x32_bf16 v[104:107], a[240:243], a[100:103], v[104:107]
    ds_read_b64_tr_b16 a[238:239], v8 offset:44032
    v_mfma_f32_16x16x32_bf16 v[112:115], a[240:243], a[104:107], v[112:115]
    v_mfma_f32_16x16x32_bf16 v[112:115], a[244:247], a[120:123], v[112:115]
    s_waitcnt lgkmcnt(4)
    v_mfma_f32_16x16x32_bf16 v[120:123], a[244:247], a[124:127], v[120:123]
    v_mfma_f32_16x16x32_bf16 v[120:123], a[240:243], a[108:111], v[120:123]
    buffer_load_dwordx4 a[200:203], v15, s[20:23], s46 offen offset:0 sc1
    v_mfma_f32_16x16x32_bf16 v[124:127], a[224:227], a[108:111], v[124:127]
    ds_read_b64_tr_b16 a[240:241], v9 offset:25600
    v_mfma_f32_16x16x32_bf16 v[124:127], a[228:231], a[124:127], v[124:127]
    ds_read_b64_tr_b16 a[242:243], v9 offset:31744
    v_mfma_f32_16x16x32_bf16 v[116:119], a[228:231], a[120:123], v[116:119]
    ds_read_b64_tr_b16 a[244:245], v9 offset:37888
    v_mfma_f32_16x16x32_bf16 v[116:119], a[224:227], a[104:107], v[116:119]
    ds_read_b64_tr_b16 a[246:247], v9 offset:44032
    v_mfma_f32_16x16x32_bf16 v[108:111], a[224:227], a[100:103], v[108:111]
    v_mfma_f32_16x16x32_bf16 v[108:111], a[228:231], a[116:119], v[108:111]
    buffer_load_dwordx4 a[204:207], v15, s[20:23], s46 offen offset:1024 sc1
    v_mfma_f32_16x16x32_bf16 v[100:103], a[228:231], a[112:115], v[100:103]
    s_waitcnt lgkmcnt(4)
    s_add_u32 m0, s49, 0
    v_mfma_f32_16x16x32_bf16 v[100:103], a[224:227], a[96:99], v[100:103]
    ds_read_b64_tr_b16 a[224:225], v10 offset:25600
    v_mfma_f32_16x16x32_bf16 v[128:131], a[232:235], a[96:99], v[128:131]
    ds_read_b64_tr_b16 a[226:227], v10 offset:31744
    v_mfma_f32_16x16x32_bf16 v[128:131], a[236:239], a[112:115], v[128:131]
    ds_read_b64_tr_b16 a[228:229], v10 offset:37888
    v_mfma_f32_16x16x32_bf16 v[136:139], a[236:239], a[116:119], v[136:139]
    ds_read_b64_tr_b16 a[230:231], v10 offset:44032
    v_mfma_f32_16x16x32_bf16 v[136:139], a[232:235], a[100:103], v[136:139]
    v_mfma_f32_16x16x32_bf16 v[144:147], a[232:235], a[104:107], v[144:147]
    buffer_load_dwordx4 v2, s[8:11], s36 offen offset:0 lds
    v_mfma_f32_16x16x32_bf16 v[144:147], a[236:239], a[120:123], v[144:147]
    s_waitcnt lgkmcnt(4)
    s_add_u32 m0, s49, 896
    v_mfma_f32_16x16x32_bf16 v[152:155], a[236:239], a[124:127], v[152:155]
    v_mfma_f32_16x16x32_bf16 v[152:155], a[232:235], a[108:111], v[152:155]
    ds_read_b64_tr_b16 a[232:233], v11 offset:25600
    v_mfma_f32_16x16x32_bf16 v[156:159], a[240:243], a[108:111], v[156:159]
    ds_read_b64_tr_b16 a[234:235], v11 offset:31744
    v_mfma_f32_16x16x32_bf16 v[156:159], a[244:247], a[124:127], v[156:159]
    ds_read_b64_tr_b16 a[236:237], v11 offset:37888
    v_mfma_f32_16x16x32_bf16 v[148:151], a[244:247], a[120:123], v[148:151]
    buffer_load_dwordx4 v2, s[8:11], s36 offen offset:128 lds
    v_mfma_f32_16x16x32_bf16 v[148:151], a[240:243], a[104:107], v[148:151]
    s_add_u32 m0, s49, 1792
    ds_read_b64_tr_b16 a[238:239], v11 offset:44032
    v_mfma_f32_16x16x32_bf16 v[140:143], a[240:243], a[100:103], v[140:143]
    v_mfma_f32_16x16x32_bf16 v[140:143], a[244:247], a[116:119], v[140:143]
    s_waitcnt lgkmcnt(4)
    v_mfma_f32_16x16x32_bf16 v[132:135], a[244:247], a[112:115], v[132:135]
    v_mfma_f32_16x16x32_bf16 v[132:135], a[240:243], a[96:99], v[132:135]
    ds_read_b64_tr_b16 a[240:241], v8 offset:26624
    v_mfma_f32_16x16x32_bf16 v[160:163], a[224:227], a[96:99], v[160:163]
    ds_read_b64_tr_b16 a[242:243], v8 offset:32768
    v_mfma_f32_16x16x32_bf16 v[160:163], a[228:231], a[112:115], v[160:163]
    buffer_load_dwordx4 v2, s[8:11], s36 offen offset:256 lds
    v_mfma_f32_16x16x32_bf16 v[168:171], a[228:231], a[116:119], v[168:171]
    s_add_u32 m0, s49, 3072
    ds_read_b64_tr_b16 a[244:245], v8 offset:38912
    v_mfma_f32_16x16x32_bf16 v[168:171], a[224:227], a[100:103], v[168:171]
    ds_read_b64_tr_b16 a[246:247], v8 offset:45056
    v_mfma_f32_16x16x32_bf16 v[176:179], a[224:227], a[104:107], v[176:179]
    v_add_u32 v8, 49152, v8
    v_mfma_f32_16x16x32_bf16 v[176:179], a[228:231], a[120:123], v[176:179]
    s_waitcnt lgkmcnt(4)
    v_mfma_f32_16x16x32_bf16 v[184:187], a[228:231], a[124:127], v[184:187]
    v_mfma_f32_16x16x32_bf16 v[184:187], a[224:227], a[108:111], v[184:187]
    buffer_load_dwordx4 v3, s[8:11], s36 offen offset:0 lds
    v_mfma_f32_16x16x32_bf16 v[188:191], a[232:235], a[108:111], v[188:191]
    s_add_u32 m0, s49, 3968
    ds_read_b64_tr_b16 a[224:225], v9 offset:26624
    v_mfma_f32_16x16x32_bf16 v[188:191], a[236:239], a[124:127], v[188:191]
    ds_read_b64_tr_b16 a[226:227], v9 offset:32768
    v_mfma_f32_16x16x32_bf16 v[180:183], a[236:239], a[120:123], v[180:183]
    ds_read_b64_tr_b16 a[228:229], v9 offset:38912
    v_mfma_f32_16x16x32_bf16 v[180:183], a[232:235], a[104:107], v[180:183]
    ds_read_b64_tr_b16 a[230:231], v9 offset:45056
    v_mfma_f32_16x16x32_bf16 v[172:175], a[232:235], a[100:103], v[172:175]
    v_add_u32 v9, 49152, v9
    v_mfma_f32_16x16x32_bf16 v[172:175], a[236:239], a[116:119], v[172:175]
    s_waitcnt lgkmcnt(4)
    v_mfma_f32_16x16x32_bf16 v[164:167], a[236:239], a[112:115], v[164:167]
    buffer_load_dwordx4 v3, s[8:11], s36 offen offset:128 lds
    v_mfma_f32_16x16x32_bf16 v[164:167], a[232:235], a[96:99], v[164:167]
    s_add_u32 m0, s49, 4864
    ds_read_b64_tr_b16 a[232:233], v10 offset:26624
    v_mfma_f32_16x16x32_bf16 v[192:195], a[240:243], a[96:99], v[192:195]
    ds_read_b64_tr_b16 a[234:235], v10 offset:32768
    v_mfma_f32_16x16x32_bf16 v[192:195], a[244:247], a[112:115], v[192:195]
    ds_read_b64_tr_b16 a[236:237], v10 offset:38912
    v_mfma_f32_16x16x32_bf16 v[200:203], a[244:247], a[116:119], v[200:203]
    ds_read_b64_tr_b16 a[238:239], v10 offset:45056
    v_mfma_f32_16x16x32_bf16 v[200:203], a[240:243], a[100:103], v[200:203]
    v_add_u32 v10, 49152, v10
    v_mfma_f32_16x16x32_bf16 v[208:211], a[240:243], a[104:107], v[208:211]
    buffer_load_dwordx4 v3, s[8:11], s36 offen offset:256 lds
    v_mfma_f32_16x16x32_bf16 v[208:211], a[244:247], a[120:123], v[208:211]
    s_waitcnt lgkmcnt(4)
    s_add_u32 s36, s36, s37
    s_sub_u32 s55, s36, 7864320
    v_mfma_f32_16x16x32_bf16 v[216:219], a[244:247], a[124:127], v[216:219]
    s_min_u32 s36, s36, s55
    s_add_u32 s46, s45, 28672
    s_sub_u32 s77, s46, 81920
    v_mfma_f32_16x16x32_bf16 v[216:219], a[240:243], a[108:111], v[216:219]
    s_min_u32 s46, s46, s77
    ds_read_b64_tr_b16 a[240:241], v11 offset:26624
    ds_read_b64_tr_b16 a[242:243], v11 offset:32768
    ds_read_b64_tr_b16 a[244:245], v11 offset:38912
    v_mfma_f32_16x16x32_bf16 v[220:223], a[224:227], a[108:111], v[220:223]
    ds_read_b64_tr_b16 a[246:247], v11 offset:45056
    v_mfma_f32_16x16x32_bf16 v[220:223], a[228:231], a[124:127], v[220:223]
    v_add_u32 v11, 49152, v11
    v_mfma_f32_16x16x32_bf16 v[212:215], a[228:231], a[120:123], v[212:215]
    v_mfma_f32_16x16x32_bf16 v[212:215], a[224:227], a[104:107], v[212:215]
    buffer_load_dwordx4 a[208:211], v14, s[20:23], s46 offen offset:0 sc1
    v_mfma_f32_16x16x32_bf16 v[204:207], a[224:227], a[100:103], v[204:207]
    v_mfma_f32_16x16x32_bf16 v[204:207], a[228:231], a[116:119], v[204:207]
    s_waitcnt lgkmcnt(4)
    v_mfma_f32_16x16x32_bf16 v[196:199], a[228:231], a[112:115], v[196:199]
    s_waitcnt lgkmcnt(0)
    s_barrier
    v_mfma_f32_16x16x32_bf16 v[196:199], a[224:227], a[96:99], v[196:199]
    ds_read_b64_tr_b16 a[224:225], v8 offset:0
    v_mfma_f32_16x16x32_bf16 v[224:227], a[232:235], a[96:99], v[224:227]
    ds_read_b64_tr_b16 a[226:227], v8 offset:6144
    v_mfma_f32_16x16x32_bf16 v[224:227], a[236:239], a[112:115], v[224:227]
    buffer_load_dwordx4 a[212:215], v14, s[20:23], s46 offen offset:1024 sc1
    v_mfma_f32_16x16x32_bf16 v[232:235], a[236:239], a[116:119], v[232:235]
    ds_read_b64_tr_b16 a[228:229], v8 offset:12288
    v_mfma_f32_16x16x32_bf16 v[232:235], a[232:235], a[100:103], v[232:235]
    ds_read_b64_tr_b16 a[230:231], v8 offset:18432
    v_mfma_f32_16x16x32_bf16 v[240:243], a[232:235], a[104:107], v[240:243]
    v_mov_b32 v23, 0
    v_mfma_f32_16x16x32_bf16 v[240:243], a[236:239], a[120:123], v[240:243]
    buffer_load_dword a252, v23, s[24:27], s67 offen sc1
    v_mfma_f32_16x16x32_bf16 v[248:251], a[236:239], a[124:127], v[248:251]
    v_mfma_f32_16x16x32_bf16 v[248:251], a[232:235], a[108:111], v[248:251]
    ds_read_b64_tr_b16 a[232:233], v9 offset:0
    v_mfma_f32_16x16x32_bf16 v[252:255], a[240:243], a[108:111], v[252:255]
    buffer_load_dwordx4 a[216:219], v15, s[20:23], s46 offen offset:0 sc1
    v_mfma_f32_16x16x32_bf16 v[252:255], a[244:247], a[124:127], v[252:255]
    ds_read_b64_tr_b16 a[234:235], v9 offset:6144
    v_mfma_f32_16x16x32_bf16 v[244:247], a[244:247], a[120:123], v[244:247]
    ds_read_b64_tr_b16 a[236:237], v9 offset:12288
    v_mfma_f32_16x16x32_bf16 v[244:247], a[240:243], a[104:107], v[244:247]
    ds_read_b64_tr_b16 a[238:239], v9 offset:18432
    v_mfma_f32_16x16x32_bf16 v[236:239], a[240:243], a[100:103], v[236:239]
    v_mfma_f32_16x16x32_bf16 v[236:239], a[244:247], a[116:119], v[236:239]
    s_waitcnt vmcnt(21) lgkmcnt(4)
    v_mfma_f32_16x16x32_bf16 v[228:231], a[244:247], a[112:115], v[228:231]
pg_1:
    s_cbranch_execz pg_5
    buffer_load_dwordx4 a[220:223], v15, s[20:23], s46 offen offset:1024 sc1
    v_mfma_f32_16x16x32_bf16 v[228:231], a[240:243], a[96:99], v[228:231]
    s_waitcnt vmcnt(17)
    ds_read_b64_tr_b16 a[240:241], v10 offset:0
    v_and_b32 v22, 1, v1
    v_mfma_f32_16x16x32_bf16 v[64:67], a[224:227], a[128:131], v[64:67]
    s_add_u32 s46, s45, 32768
    ds_read_b64_tr_b16 a[242:243], v10 offset:6144
    s_sub_u32 s77, s46, 81920
    v_mfma_f32_16x16x32_bf16 v[64:67], a[228:231], a[144:147], v[64:67]
    s_min_u32 s46, s46, s77
    ds_read_b64_tr_b16 a[244:245], v10 offset:12288
    s_sub_u32 s56, s5, s4
    v_mfma_f32_16x16x32_bf16 v[72:75], a[228:231], a[148:151], v[72:75]
    s_waitcnt vmcnt(16)
    ds_read_b64_tr_b16 a[246:247], v10 offset:18432
    s_sub_u32 s56, s56, 128
    v_mfma_f32_16x16x32_bf16 v[72:75], a[224:227], a[132:135], v[72:75]
    s_waitcnt vmcnt(15)
    v_mul_lo_u32 v22, v22, s56
    v_mfma_f32_16x16x32_bf16 v[80:83], a[224:227], a[136:139], v[80:83]
    buffer_load_dword a252, v22, s[24:27], s4 offen offset:128 sc1
    v_mfma_f32_16x16x32_bf16 v[80:83], a[228:231], a[152:155], v[80:83]
    buffer_load_dwordx4 a[0:3], v14, s[20:23], s46 offen offset:0 sc1
    v_mfma_f32_16x16x32_bf16 v[88:91], a[228:231], a[156:159], v[88:91]
    s_waitcnt lgkmcnt(3)
    v_mfma_f32_16x16x32_bf16 v[88:91], a[224:227], a[140:143], v[88:91]
    ds_read_b64_tr_b16 a[224:225], v11 offset:0
    v_mfma_f32_16x16x32_bf16 v[92:95], a[232:235], a[140:143], v[92:95]
    ds_read_b64_tr_b16 a[226:227], v11 offset:6144
    v_mfma_f32_16x16x32_bf16 v[92:95], a[236:239], a[156:159], v[92:95]
    ds_read_b64_tr_b16 a[228:229], v11 offset:12288
    v_mfma_f32_16x16x32_bf16 v[84:87], a[236:239], a[152:155], v[84:87]
    ds_read_b64_tr_b16 a[230:231], v11 offset:18432
    v_mfma_f32_16x16x32_bf16 v[84:87], a[232:235], a[136:139], v[84:87]
    buffer_load_dwordx4 a[4:7], v14, s[20:23], s46 offen offset:1024 sc1
    v_mfma_f32_16x16x32_bf16 v[76:79], a[232:235], a[132:135], v[76:79]
    v_mfma_f32_16x16x32_bf16 v[76:79], a[236:239], a[148:151], v[76:79]
    s_waitcnt lgkmcnt(4)
    v_mfma_f32_16x16x32_bf16 v[68:71], a[236:239], a[144:147], v[68:71]
    v_mfma_f32_16x16x32_bf16 v[68:71], a[232:235], a[128:131], v[68:71]
    ds_read_b64_tr_b16 a[232:233], v8 offset:1024
    v_mfma_f32_16x16x32_bf16 v[96:99], a[240:243], a[128:131], v[96:99]
    ds_read_b64_tr_b16 a[234:235], v8 offset:7168
    v_mfma_f32_16x16x32_bf16 v[96:99], a[244:247], a[144:147], v[96:99]
    ds_read_b64_tr_b16 a[236:237], v8 offset:13312
    v_mfma_f32_16x16x32_bf16 v[104:107], a[244:247], a[148:151], v[104:107]
    buffer_load_dwordx4 a[8:11], v15, s[20:23], s46 offen offset:0 sc1
    v_mfma_f32_16x16x32_bf16 v[104:107], a[240:243], a[132:135], v[104:107]
    ds_read_b64_tr_b16 a[238:239], v8 offset:19456
    v_mfma_f32_16x16x32_bf16 v[112:115], a[240:243], a[136:139], v[112:115]
    v_mfma_f32_16x16x32_bf16 v[112:115], a[244:247], a[152:155], v[112:115]
    s_waitcnt lgkmcnt(4)
    v_mfma_f32_16x16x32_bf16 v[120:123], a[244:247], a[156:159], v[120:123]
    v_mfma_f32_16x16x32_bf16 v[120:123], a[240:243], a[140:143], v[120:123]
    ds_read_b64_tr_b16 a[240:241], v9 offset:1024
    v_mfma_f32_16x16x32_bf16 v[124:127], a[224:227], a[140:143], v[124:127]
    buffer_load_dwordx4 a[12:15], v15, s[20:23], s46 offen offset:1024 sc1
    v_mfma_f32_16x16x32_bf16 v[124:127], a[228:231], a[156:159], v[124:127]
    s_add_u32 m0, s49, 24576
    ds_read_b64_tr_b16 a[242:243], v9 offset:7168
    v_mfma_f32_16x16x32_bf16 v[116:119], a[228:231], a[152:155], v[116:119]
    ds_read_b64_tr_b16 a[244:245], v9 offset:13312
    v_mfma_f32_16x16x32_bf16 v[116:119], a[224:227], a[136:139], v[116:119]
    ds_read_b64_tr_b16 a[246:247], v9 offset:19456
    v_mfma_f32_16x16x32_bf16 v[108:111], a[224:227], a[132:135], v[108:111]
    v_mfma_f32_16x16x32_bf16 v[108:111], a[228:231], a[148:151], v[108:111]
    s_waitcnt lgkmcnt(4)
    v_mfma_f32_16x16x32_bf16 v[100:103], a[228:231], a[144:147], v[100:103]
    v_mfma_f32_16x16x32_bf16 v[100:103], a[224:227], a[128:131], v[100:103]
    buffer_load_dwordx4 v2, s[8:11], s36 offen offset:0 lds
    v_mfma_f32_16x16x32_bf16 v[128:131], a[232:235], a[128:131], v[128:131]
    s_add_u32 m0, s49, 25472
    ds_read_b64_tr_b16 a[224:225], v10 offset:1024
    v_mfma_f32_16x16x32_bf16 v[128:131], a[236:239], a[144:147], v[128:131]
    ds_read_b64_tr_b16 a[226:227], v10 offset:7168
    v_mfma_f32_16x16x32_bf16 v[136:139], a[236:239], a[148:151], v[136:139]
    ds_read_b64_tr_b16 a[228:229], v10 offset:13312
    v_mfma_f32_16x16x32_bf16 v[136:139], a[232:235], a[132:135], v[136:139]
    ds_read_b64_tr_b16 a[230:231], v10 offset:19456
    v_mfma_f32_16x16x32_bf16 v[144:147], a[232:235], a[136:139], v[144:147]
    v_mfma_f32_16x16x32_bf16 v[144:147], a[236:239], a[152:155], v[144:147]
    buffer_load_dwordx4 v2, s[8:11], s36 offen offset:128 lds
    v_mfma_f32_16x16x32_bf16 v[152:155], a[236:239], a[156:159], v[152:155]
    buffer_load_dwordx4 v[32:35], v17, s[24:27], s47 offen offset:0 sc1
    v_mfma_f32_16x16x32_bf16 v[152:155], a[232:235], a[140:143], v[152:155]
    s_waitcnt lgkmcnt(3)
    ds_read_b64_tr_b16 a[232:233], v11 offset:1024
    s_add_u32 m0, s49, 26368
    v_mfma_f32_16x16x32_bf16 v[156:159], a[240:243], a[140:143], v[156:159]
    ds_read_b64_tr_b16 a[234:235], v11 offset:7168
    v_mfma_f32_16x16x32_bf16 v[156:159], a[244:247], a[156:159], v[156:159]
    ds_read_b64_tr_b16 a[236:237], v11 offset:13312
    v_mfma_f32_16x16x32_bf16 v[148:151], a[244:247], a[152:155], v[148:151]
    ds_read_b64_tr_b16 a[238:239], v11 offset:19456
    v_mfma_f32_16x16x32_bf16 v[148:151], a[240:243], a[136:139], v[148:151]
    v_mfma_f32_16x16x32_bf16 v[140:143], a[240:243], a[132:135], v[140:143]
    buffer_load_dwordx4 v2, s[8:11], s36 offen offset:256 lds
    v_mfma_f32_16x16x32_bf16 v[140:143], a[244:247], a[148:151], v[140:143]
    s_waitcnt lgkmcnt(4)
    s_add_u32 m0, s49, 27648
    v_mfma_f32_16x16x32_bf16 v[132:135], a[244:247], a[144:147], v[132:135]
    v_mfma_f32_16x16x32_bf16 v[132:135], a[240:243], a[128:131], v[132:135]
    ds_read_b64_tr_b16 a[240:241], v8 offset:2048
    v_mfma_f32_16x16x32_bf16 v[160:163], a[224:227], a[128:131], v[160:163]
    ds_read_b64_tr_b16 a[242:243], v8 offset:8192
    v_mfma_f32_16x16x32_bf16 v[160:163], a[228:231], a[144:147], v[160:163]
    ds_read_b64_tr_b16 a[244:245], v8 offset:14336
    v_mfma_f32_16x16x32_bf16 v[168:171], a[228:231], a[148:151], v[168:171]
    buffer_load_dwordx4 v3, s[8:11], s36 offen offset:0 lds
    v_mfma_f32_16x16x32_bf16 v[168:171], a[224:227], a[132:135], v[168:171]
    s_add_u32 m0, s49, 28544
    ds_read_b64_tr_b16 a[246:247], v8 offset:20480
    v_mfma_f32_16x16x32_bf16 v[176:179], a[224:227], a[136:139], v[176:179]
    buffer_load_dwordx4 v[36:39], v17, s[24:27], s47 offen offset:1024 sc1
    v_mfma_f32_16x16x32_bf16 v[176:179], a[228:231], a[152:155], v[176:179]
    s_waitcnt lgkmcnt(4)
    v_mfma_f32_16x16x32_bf16 v[184:187], a[228:231], a[156:159], v[184:187]
    v_mfma_f32_16x16x32_bf16 v[184:187], a[224:227], a[140:143], v[184:187]
    ds_read_b64_tr_b16 a[224:225], v9 offset:2048
    v_mfma_f32_16x16x32_bf16 v[188:191], a[232:235], a[140:143], v[188:191]
    ds_read_b64_tr_b16 a[226:227], v9 offset:8192
    v_mfma_f32_16x16x32_bf16 v[188:191], a[236:239], a[156:159], v[188:191]
    buffer_load_dwordx4 v3, s[8:11], s36 offen offset:128 lds
    v_mfma_f32_16x16x32_bf16 v[180:183], a[236:239], a[152:155], v[180:183]
    s_add_u32 m0, s49, 29440
    ds_read_b64_tr_b16 a[228:229], v9 offset:14336
    v_mfma_f32_16x16x32_bf16 v[180:183], a[232:235], a[136:139], v[180:183]
    ds_read_b64_tr_b16 a[230:231], v9 offset:20480
    v_mfma_f32_16x16x32_bf16 v[172:175], a[232:235], a[132:135], v[172:175]
    v_mfma_f32_16x16x32_bf16 v[172:175], a[236:239], a[148:151], v[172:175]
    s_waitcnt lgkmcnt(4)
    v_mfma_f32_16x16x32_bf16 v[164:167], a[236:239], a[144:147], v[164:167]
    v_mfma_f32_16x16x32_bf16 v[164:167], a[232:235], a[128:131], v[164:167]
    buffer_load_dwordx4 v3, s[8:11], s36 offen offset:256 lds
    v_mfma_f32_16x16x32_bf16 v[192:195], a[240:243], a[128:131], v[192:195]
    s_add_u32 s36, s36, s37
    ds_read_b64_tr_b16 a[232:233], v10 offset:2048
    s_sub_u32 s55, s36, 7864320
    v_mfma_f32_16x16x32_bf16 v[192:195], a[244:247], a[144:147], v[192:195]
    s_min_u32 s36, s36, s55
    ds_read_b64_tr_b16 a[234:235], v10 offset:8192
    s_add_u32 s46, s45, 36864
    v_mfma_f32_16x16x32_bf16 v[200:203], a[244:247], a[148:151], v[200:203]
    s_sub_u32 s77, s46, 81920
    ds_read_b64_tr_b16 a[236:237], v10 offset:14336
    s_min_u32 s46, s46, s77
    v_mfma_f32_16x16x32_bf16 v[200:203], a[240:243], a[132:135], v[200:203]
    ds_read_b64_tr_b16 a[238:239], v10 offset:20480
    v_mfma_f32_16x16x32_bf16 v[208:211], a[240:243], a[136:139], v[208:211]
    buffer_load_dwordx4 v[40:43], v17, s[24:27], s47 offen offset:2048 sc1
    v_mfma_f32_16x16x32_bf16 v[208:211], a[244:247], a[152:155], v[208:211]
    s_waitcnt lgkmcnt(4)
    v_mfma_f32_16x16x32_bf16 v[216:219], a[244:247], a[156:159], v[216:219]
    buffer_load_dwordx4 a[16:19], v14, s[20:23], s46 offen offset:0 sc1
    v_mfma_f32_16x16x32_bf16 v[216:219], a[240:243], a[140:143], v[216:219]
    ds_read_b64_tr_b16 a[240:241], v11 offset:2048
    ds_read_b64_tr_b16 a[242:243], v11 offset:8192
    ds_read_b64_tr_b16 a[244:245], v11 offset:14336
    v_mfma_f32_16x16x32_bf16 v[220:223], a[224:227], a[140:143], v[220:223]
    ds_read_b64_tr_b16 a[246:247], v11 offset:20480
    v_mfma_f32_16x16x32_bf16 v[220:223], a[228:231], a[156:159], v[220:223]
    v_mfma_f32_16x16x32_bf16 v[212:215], a[228:231], a[152:155], v[212:215]
    v_mfma_f32_16x16x32_bf16 v[212:215], a[224:227], a[136:139], v[212:215]
    v_mfma_f32_16x16x32_bf16 v[204:207], a[224:227], a[132:135], v[204:207]
    buffer_load_dwordx4 a[20:23], v14, s[20:23], s46 offen offset:1024 sc1
    v_mfma_f32_16x16x32_bf16 v[204:207], a[228:231], a[148:151], v[204:207]
    s_waitcnt lgkmcnt(4)
    v_mfma_f32_16x16x32_bf16 v[196:199], a[228:231], a[144:147], v[196:199]
    s_waitcnt lgkmcnt(0)
    s_barrier
    v_mfma_f32_16x16x32_bf16 v[196:199], a[224:227], a[128:131], v[196:199]
    ds_read_b64_tr_b16 a[224:225], v8 offset:24576
    v_mfma_f32_16x16x32_bf16 v[224:227], a[232:235], a[128:131], v[224:227]
    buffer_load_dwordx4 v[44:47], v17, s[24:27], s47 offen offset:3072 sc1
    v_mfma_f32_16x16x32_bf16 v[224:227], a[236:239], a[144:147], v[224:227]
    ds_read_b64_tr_b16 a[226:227], v8 offset:30720
    v_mfma_f32_16x16x32_bf16 v[232:235], a[236:239], a[148:151], v[232:235]
    ds_read_b64_tr_b16 a[228:229], v8 offset:36864
    v_mfma_f32_16x16x32_bf16 v[232:235], a[232:235], a[132:135], v[232:235]
    buffer_load_dwordx4 a[24:27], v15, s[20:23], s46 offen offset:0 sc1
    v_mfma_f32_16x16x32_bf16 v[240:243], a[232:235], a[136:139], v[240:243]
    ds_read_b64_tr_b16 a[230:231], v8 offset:43008
    v_mfma_f32_16x16x32_bf16 v[240:243], a[236:239], a[152:155], v[240:243]
    v_mfma_f32_16x16x32_bf16 v[248:251], a[236:239], a[156:159], v[248:251]
    v_mfma_f32_16x16x32_bf16 v[248:251], a[232:235], a[140:143], v[248:251]
    ds_read_b64_tr_b16 a[232:233], v9 offset:24576
    v_mfma_f32_16x16x32_bf16 v[252:255], a[240:243], a[140:143], v[252:255]
    ds_read_b64_tr_b16 a[234:235], v9 offset:30720
    v_mfma_f32_16x16x32_bf16 v[252:255], a[244:247], a[156:159], v[252:255]
    buffer_load_dwordx4 a[28:31], v15, s[20:23], s46 offen offset:1024 sc1
    v_mfma_f32_16x16x32_bf16 v[244:247], a[244:247], a[152:155], v[244:247]
    s_add_u32 s46, s45, 40960
    ds_read_b64_tr_b16 a[236:237], v9 offset:36864
    s_sub_u32 s77, s46, 81920
    v_mfma_f32_16x16x32_bf16 v[244:247], a[240:243], a[136:139], v[244:247]
    s_min_u32 s46, s46, s77
    ds_read_b64_tr_b16 a[238:239], v9 offset:43008
    v_mfma_f32_16x16x32_bf16 v[236:239], a[240:243], a[132:135], v[236:239]
    v_mfma_f32_16x16x32_bf16 v[236:239], a[244:247], a[148:151], v[236:239]
    s_waitcnt vmcnt(33) lgkmcnt(4)
    v_mfma_f32_16x16x32_bf16 v[228:231], a[244:247], a[144:147], v[228:231]
    s_waitcnt vmcnt(23)
    v_mfma_f32_16x16x32_bf16 v[228:231], a[240:243], a[128:131], v[228:231]
    s_waitcnt vmcnt(22)
    ds_read_b64_tr_b16 a[240:241], v10 offset:24576
    v_mfma_f32_16x16x32_bf16 v[64:67], a[224:227], a[192:195], v[64:67]
    buffer_load_dwordx4 a[32:35], v14, s[20:23], s46 offen offset:0 sc1
    v_mfma_f32_16x16x32_bf16 v[64:67], a[228:231], a[208:211], v[64:67]
    ds_read_b64_tr_b16 a[242:243], v10 offset:30720
    v_mfma_f32_16x16x32_bf16 v[72:75], a[228:231], a[212:215], v[72:75]
    s_waitcnt vmcnt(21)
    ds_read_b64_tr_b16 a[244:245], v10 offset:36864
    v_mfma_f32_16x16x32_bf16 v[72:75], a[224:227], a[196:199], v[72:75]
    s_waitcnt vmcnt(20)
    ds_read_b64_tr_b16 a[246:247], v10 offset:43008
    v_mfma_f32_16x16x32_bf16 v[80:83], a[224:227], a[200:203], v[80:83]
    v_mfma_f32_16x16x32_bf16 v[80:83], a[228:231], a[216:219], v[80:83]
    s_waitcnt lgkmcnt(4)
    v_mfma_f32_16x16x32_bf16 v[88:91], a[228:231], a[220:223], v[88:91]
    buffer_load_dwordx4 a[36:39], v14, s[20:23], s46 offen offset:1024 sc1
    v_mfma_f32_16x16x32_bf16 v[88:91], a[224:227], a[204:207], v[88:91]
    ds_read_b64_tr_b16 a[224:225], v11 offset:24576
    v_mfma_f32_16x16x32_bf16 v[92:95], a[232:235], a[204:207], v[92:95]
    ds_read_b64_tr_b16 a[226:227], v11 offset:30720
    v_mfma_f32_16x16x32_bf16 v[92:95], a[236:239], a[220:223], v[92:95]
    ds_read_b64_tr_b16 a[228:229], v11 offset:36864
    v_mfma_f32_16x16x32_bf16 v[84:87], a[236:239], a[216:219], v[84:87]
    ds_read_b64_tr_b16 a[230:231], v11 offset:43008
    v_mfma_f32_16x16x32_bf16 v[84:87], a[232:235], a[200:203], v[84:87]
    v_mfma_f32_16x16x32_bf16 v[76:79], a[232:235], a[196:199], v[76:79]
    v_mfma_f32_16x16x32_bf16 v[76:79], a[236:239], a[212:215], v[76:79]
    buffer_load_dwordx4 a[40:43], v15, s[20:23], s46 offen offset:0 sc1
    v_mfma_f32_16x16x32_bf16 v[68:71], a[236:239], a[208:211], v[68:71]
    s_waitcnt lgkmcnt(3)
    v_mfma_f32_16x16x32_bf16 v[68:71], a[232:235], a[192:195], v[68:71]
    ds_read_b64_tr_b16 a[232:233], v8 offset:25600
    v_mfma_f32_16x16x32_bf16 v[96:99], a[240:243], a[192:195], v[96:99]
    ds_read_b64_tr_b16 a[234:235], v8 offset:31744
    v_mfma_f32_16x16x32_bf16 v[96:99], a[244:247], a[208:211], v[96:99]
    ds_read_b64_tr_b16 a[236:237], v8 offset:37888
    v_mfma_f32_16x16x32_bf16 v[104:107], a[244:247], a[212:215], v[104:107]
    ds_read_b64_tr_b16 a[238:239], v8 offset:44032
    v_mfma_f32_16x16x32_bf16 v[104:107], a[240:243], a[196:199], v[104:107]
    buffer_load_dwordx4 a[44:47], v15, s[20:23], s46 offen offset:1024 sc1
    v_mfma_f32_16x16x32_bf16 v[112:115], a[240:243], a[200:203], v[112:115]
    s_add_u32 m0, s49, 49152
    v_mfma_f32_16x16x32_bf16 v[112:115], a[244:247], a[216:219], v[112:115]
    s_waitcnt lgkmcnt(4)
    v_mfma_f32_16x16x32_bf16 v[120:123], a[244:247], a[220:223], v[120:123]
    v_mfma_f32_16x16x32_bf16 v[120:123], a[240:243], a[204:207], v[120:123]
    ds_read_b64_tr_b16 a[240:241], v9 offset:25600
    v_mfma_f32_16x16x32_bf16 v[124:127], a[224:227], a[204:207], v[124:127]
    ds_read_b64_tr_b16 a[242:243], v9 offset:31744
    v_mfma_f32_16x16x32_bf16 v[124:127], a[228:231], a[220:223], v[124:127]
    ds_read_b64_tr_b16 a[244:245], v9 offset:37888
    v_mfma_f32_16x16x32_bf16 v[116:119], a[228:231], a[216:219], v[116:119]
    buffer_load_dwordx4 v2, s[8:11], s36 offen offset:0 lds
    v_mfma_f32_16x16x32_bf16 v[116:119], a[224:227], a[200:203], v[116:119]
    s_add_u32 m0, s49, 50048
    ds_read_b64_tr_b16 a[246:247], v9 offset:44032
    v_mfma_f32_16x16x32_bf16 v[108:111], a[224:227], a[196:199], v[108:111]
    v_mfma_f32_16x16x32_bf16 v[108:111], a[228:231], a[212:215], v[108:111]
    s_waitcnt lgkmcnt(4)
    v_mfma_f32_16x16x32_bf16 v[100:103], a[228:231], a[208:211], v[100:103]
    v_mfma_f32_16x16x32_bf16 v[100:103], a[224:227], a[192:195], v[100:103]
    ds_read_b64_tr_b16 a[224:225], v10 offset:25600
    v_mfma_f32_16x16x32_bf16 v[128:131], a[232:235], a[192:195], v[128:131]
    buffer_load_dwordx4 v2, s[8:11], s36 offen offset:128 lds
    v_mfma_f32_16x16x32_bf16 v[128:131], a[236:239], a[208:211], v[128:131]
    s_add_u32 m0, s49, 50944
    ds_read_b64_tr_b16 a[226:227], v10 offset:31744
    v_mfma_f32_16x16x32_bf16 v[136:139], a[236:239], a[212:215], v[136:139]
    ds_read_b64_tr_b16 a[228:229], v10 offset:37888
    v_mfma_f32_16x16x32_bf16 v[136:139], a[232:235], a[196:199], v[136:139]
    ds_read_b64_tr_b16 a[230:231], v10 offset:44032
    v_mfma_f32_16x16x32_bf16 v[144:147], a[232:235], a[200:203], v[144:147]
    v_mfma_f32_16x16x32_bf16 v[144:147], a[236:239], a[216:219], v[144:147]
    s_waitcnt lgkmcnt(4)
    v_mfma_f32_16x16x32_bf16 v[152:155], a[236:239], a[220:223], v[152:155]
    v_mfma_f32_16x16x32_bf16 v[152:155], a[232:235], a[204:207], v[152:155]
    buffer_load_dwordx4 v2, s[8:11], s36 offen offset:256 lds
    v_mfma_f32_16x16x32_bf16 v[156:159], a[240:243], a[204:207], v[156:159]
    s_add_u32 m0, s49, 52224
    ds_read_b64_tr_b16 a[232:233], v11 offset:25600
    v_mfma_f32_16x16x32_bf16 v[156:159], a[244:247], a[220:223], v[156:159]
    ds_read_b64_tr_b16 a[234:235], v11 offset:31744
    v_mfma_f32_16x16x32_bf16 v[148:151], a[244:247], a[216:219], v[148:151]
    ds_read_b64_tr_b16 a[236:237], v11 offset:37888
    v_mfma_f32_16x16x32_bf16 v[148:151], a[240:243], a[200:203], v[148:151]
    ds_read_b64_tr_b16 a[238:239], v11 offset:44032
    v_mfma_f32_16x16x32_bf16 v[140:143], a[240:243], a[196:199], v[140:143]
    v_mfma_f32_16x16x32_bf16 v[140:143], a[244:247], a[212:215], v[140:143]
    buffer_load_dwordx4 v3, s[8:11], s36 offen offset:0 lds
    v_mfma_f32_16x16x32_bf16 v[132:135], a[244:247], a[208:211], v[132:135]
    s_waitcnt lgkmcnt(4)
    s_add_u32 m0, s49, 53120
    v_mfma_f32_16x16x32_bf16 v[132:135], a[240:243], a[192:195], v[132:135]
    ds_read_b64_tr_b16 a[240:241], v8 offset:26624
    v_mfma_f32_16x16x32_bf16 v[160:163], a[224:227], a[192:195], v[160:163]
    ds_read_b64_tr_b16 a[242:243], v8 offset:32768
    v_mfma_f32_16x16x32_bf16 v[160:163], a[228:231], a[208:211], v[160:163]
    ds_read_b64_tr_b16 a[244:245], v8 offset:38912
    v_mfma_f32_16x16x32_bf16 v[168:171], a[228:231], a[212:215], v[168:171]
    ds_read_b64_tr_b16 a[246:247], v8 offset:45056
    v_mfma_f32_16x16x32_bf16 v[168:171], a[224:227], a[196:199], v[168:171]
    v_subrev_u32 v8, 98304, v8
    v_mfma_f32_16x16x32_bf16 v[176:179], a[224:227], a[200:203], v[176:179]
    buffer_load_dwordx4 v3, s[8:11], s36 offen offset:128 lds
    v_mfma_f32_16x16x32_bf16 v[176:179], a[228:231], a[216:219], v[176:179]
    s_waitcnt lgkmcnt(4)
    s_add_u32 m0, s49, 54016
    v_mfma_f32_16x16x32_bf16 v[184:187], a[228:231], a[220:223], v[184:187]
    v_mfma_f32_16x16x32_bf16 v[184:187], a[224:227], a[204:207], v[184:187]
    ds_read_b64_tr_b16 a[224:225], v9 offset:26624
    v_mfma_f32_16x16x32_bf16 v[188:191], a[232:235], a[204:207], v[188:191]
    ds_read_b64_tr_b16 a[226:227], v9 offset:32768
    v_mfma_f32_16x16x32_bf16 v[188:191], a[236:239], a[220:223], v[188:191]
    ds_read_b64_tr_b16 a[228:229], v9 offset:38912
    v_mfma_f32_16x16x32_bf16 v[180:183], a[236:239], a[216:219], v[180:183]
    buffer_load_dwordx4 v3, s[8:11], s36 offen offset:256 lds
    v_mfma_f32_16x16x32_bf16 v[180:183], a[232:235], a[200:203], v[180:183]
    s_add_u32 s36, s36, s37
    ds_read_b64_tr_b16 a[230:231], v9 offset:45056
    s_sub_u32 s55, s36, 7864320
    v_mfma_f32_16x16x32_bf16 v[172:175], a[232:235], a[196:199], v[172:175]
    s_min_u32 s36, s36, s55
    v_subrev_u32 v9, 98304, v9
    s_add_u32 s46, s45, 45056
    v_mfma_f32_16x16x32_bf16 v[172:175], a[236:239], a[212:215], v[172:175]
    s_waitcnt lgkmcnt(4)
    s_sub_u32 s77, s46, 81920
    s_min_u32 s46, s46, s77
    v_mfma_f32_16x16x32_bf16 v[164:167], a[236:239], a[208:211], v[164:167]
    s_waitcnt vmcnt(21)
    v_xor_b32 v34, s7, v34
    v_mfma_f32_16x16x32_bf16 v[164:167], a[232:235], a[192:195], v[164:167]
    s_waitcnt vmcnt(18)
    ds_read_b64_tr_b16 a[232:233], v10 offset:26624
    v_xor_b32 v38, s7, v38
    v_mfma_f32_16x16x32_bf16 v[192:195], a[240:243], a[192:195], v[192:195]
    s_waitcnt vmcnt(15)
    ds_read_b64_tr_b16 a[234:235], v10 offset:32768
    v_xor_b32 v42, s7, v42
    v_mfma_f32_16x16x32_bf16 v[192:195], a[244:247], a[208:211], v[192:195]
    buffer_load_dwordx4 a[48:51], v14, s[20:23], s46 offen offset:0 sc1
    v_mfma_f32_16x16x32_bf16 v[200:203], a[244:247], a[212:215], v[200:203]
    s_waitcnt vmcnt(13)
    ds_read_b64_tr_b16 a[236:237], v10 offset:38912
    v_xor_b32 v46, s7, v46
    v_mfma_f32_16x16x32_bf16 v[200:203], a[240:243], a[196:199], v[200:203]
    s_lshl_b32 s56, s3, 3
    ds_read_b64_tr_b16 a[238:239], v10 offset:45056
    v_or3_b32 v34, v34, v38, v42
    v_mfma_f32_16x16x32_bf16 v[208:211], a[240:243], a[200:203], v[208:211]
    s_add_u32 s56, s56, 147456
    v_or_b32 v34, v34, v46
    v_cmp_ne_u32 vcc, 0, v34
    v_mfma_f32_16x16x32_bf16 v[208:211], a[244:247], a[216:219], v[208:211]
    s_waitcnt lgkmcnt(4)
    v_subrev_u32 v10, 98304, v10
    v_mfma_f32_16x16x32_bf16 v[216:219], a[244:247], a[220:223], v[216:219]
    s_cbranch_vccnz spin_rec
spin_rec_ret:
    v_max_u32 v20, v32, v33
    v_mfma_f32_16x16x32_bf16 v[216:219], a[240:243], a[204:207], v[216:219]
    ds_read_b64_tr_b16 a[240:241], v11 offset:26624
    v_min_u32 v21, v32, v33
    ds_read_b64_tr_b16 a[242:243], v11 offset:32768
    v_mfma_f32_16x16x32_bf16 v[220:223], a[224:227], a[204:207], v[220:223]
    ds_read_b64_tr_b16 a[244:245], v11 offset:38912
    v_med3_u32 v21, v20, v21, v36
    ds_read_b64_tr_b16 a[246:247], v11 offset:45056
    v_mfma_f32_16x16x32_bf16 v[220:223], a[228:231], a[220:223], v[220:223]
    buffer_load_dwordx4 a[52:55], v14, s[20:23], s46 offen offset:1024 sc1
    v_mfma_f32_16x16x32_bf16 v[212:215], a[228:231], a[216:219], v[212:215]
    v_max_u32 v20, v20, v36
    v_med3_u32 v21, v20, v21, v37
    v_mfma_f32_16x16x32_bf16 v[212:215], a[224:227], a[200:203], v[212:215]
    v_max_u32 v20, v20, v37
    v_med3_u32 v21, v20, v21, v40
    v_mfma_f32_16x16x32_bf16 v[204:207], a[224:227], a[196:199], v[204:207]
    v_max_u32 v20, v20, v40
    v_med3_u32 v21, v20, v21, v41
    v_mfma_f32_16x16x32_bf16 v[204:207], a[228:231], a[212:215], v[204:207]
    s_waitcnt lgkmcnt(4)
    v_max_u32 v20, v20, v41
    v_med3_u32 v21, v20, v21, v44
    v_mfma_f32_16x16x32_bf16 v[196:199], a[228:231], a[208:211], v[196:199]
    s_waitcnt lgkmcnt(0)
    s_barrier
    v_mfma_f32_16x16x32_bf16 v[196:199], a[224:227], a[192:195], v[196:199]
    buffer_load_dwordx4 a[56:59], v15, s[20:23], s46 offen offset:0 sc1
    v_mfma_f32_16x16x32_bf16 v[224:227], a[232:235], a[192:195], v[224:227]
    ds_read_b64_tr_b16 a[224:225], v8 offset:0
    v_max_u32 v20, v20, v44
    v_mfma_f32_16x16x32_bf16 v[224:227], a[236:239], a[208:211], v[224:227]
    ds_read_b64_tr_b16 a[226:227], v8 offset:6144
    v_med3_u32 v21, v20, v21, v45
    v_mfma_f32_16x16x32_bf16 v[232:235], a[236:239], a[212:215], v[232:235]
    ds_read_b64_tr_b16 a[228:229], v8 offset:12288
    v_max_u32 v20, v20, v45
    v_mfma_f32_16x16x32_bf16 v[232:235], a[232:235], a[196:199], v[232:235]
    ds_read_b64_tr_b16 a[230:231], v8 offset:18432
    v_mov_b32_dpp v22, v20 row_ror:8 row_mask:0xf bank_mask:0xf
    v_mfma_f32_16x16x32_bf16 v[240:243], a[232:235], a[200:203], v[240:243]
    buffer_load_dwordx4 a[60:63], v15, s[20:23], s46 offen offset:1024 sc1
    v_mfma_f32_16x16x32_bf16 v[240:243], a[236:239], a[216:219], v[240:243]
    s_add_u32 s46, s45, 49152
    v_mov_b32_dpp v23, v21 row_ror:8 row_mask:0xf bank_mask:0xf
    v_min_u32 v24, v20, v22
    v_mfma_f32_16x16x32_bf16 v[248:251], a[236:239], a[220:223], v[248:251]
    s_sub_u32 s77, s46, 81920
    v_max_u32 v20, v20, v22
    v_max3_u32 v21, v24, v21, v23
    v_mfma_f32_16x16x32_bf16 v[248:251], a[232:235], a[204:207], v[248:251]
    s_min_u32 s46, s46, s77
    ds_read_b64_tr_b16 a[232:233], v9 offset:0
    v_mov_b32_dpp v22, v20 row_ror:4 row_mask:0xf bank_mask:0xf
    v_mfma_f32_16x16x32_bf16 v[252:255], a[240:243], a[204:207], v[252:255]
    ds_read_b64_tr_b16 a[234:235], v9 offset:6144
    v_mov_b32_dpp v23, v21 row_ror:4 row_mask:0xf bank_mask:0xf
    v_mfma_f32_16x16x32_bf16 v[252:255], a[244:247], a[220:223], v[252:255]
    ds_read_b64_tr_b16 a[236:237], v9 offset:12288
    v_min_u32 v24, v20, v22
    v_mfma_f32_16x16x32_bf16 v[244:247], a[244:247], a[216:219], v[244:247]
    ds_read_b64_tr_b16 a[238:239], v9 offset:18432
    v_max_u32 v20, v20, v22
    v_mfma_f32_16x16x32_bf16 v[244:247], a[240:243], a[200:203], v[244:247]
    buffer_load_dwordx4 a[64:67], v14, s[20:23], s46 offen offset:0 sc1
    v_mfma_f32_16x16x32_bf16 v[236:239], a[240:243], a[196:199], v[236:239]
    v_max3_u32 v21, v24, v21, v23
    v_mov_b32_dpp v22, v20 row_ror:2 row_mask:0xf bank_mask:0xf
    v_mfma_f32_16x16x32_bf16 v[236:239], a[244:247], a[212:215], v[236:239]
    s_waitcnt lgkmcnt(4)
    v_mov_b32_dpp v23, v21 row_ror:2 row_mask:0xf bank_mask:0xf
    v_min_u32 v24, v20, v22
    v_mfma_f32_16x16x32_bf16 v[228:231], a[244:247], a[208:211], v[228:231]
    v_max_u32 v20, v20, v22
    v_max3_u32 v21, v24, v21, v23
    v_mfma_f32_16x16x32_bf16 v[228:231], a[240:243], a[192:195], v[228:231]
    ds_read_b64_tr_b16 a[240:241], v10 offset:0
    v_mov_b32_dpp v22, v20 row_ror:1 row_mask:0xf bank_mask:0xf
    v_mfma_f32_16x16x32_bf16 v[64:67], a[224:227], a[0:3], v[64:67]
    ds_read_b64_tr_b16 a[242:243], v10 offset:6144
    v_mov_b32_dpp v23, v21 row_ror:1 row_mask:0xf bank_mask:0xf
    v_mfma_f32_16x16x32_bf16 v[64:67], a[228:231], a[16:19], v[64:67]
    buffer_load_dwordx4 a[68:71], v14, s[20:23], s46 offen offset:1024 sc1
    v_mfma_f32_16x16x32_bf16 v[72:75], a[228:231], a[20:23], v[72:75]
    s_waitcnt vmcnt(17)
    ds_read_b64_tr_b16 a[244:245], v10 offset:12288
    v_min_u32 v24, v20, v22
    v_mfma_f32_16x16x32_bf16 v[72:75], a[224:227], a[4:7], v[72:75]
    s_waitcnt vmcnt(16)
    ds_read_b64_tr_b16 a[246:247], v10 offset:18432
    v_max_u32 v20, v20, v22
    v_mfma_f32_16x16x32_bf16 v[80:83], a[224:227], a[8:11], v[80:83]
    v_max3_u32 v21, v24, v21, v23
    v_mov_b32 v22, v20
    v_mfma_f32_16x16x32_bf16 v[80:83], a[228:231], a[24:27], v[80:83]
    s_waitcnt lgkmcnt(4)
    v_permlane16_swap_b32 v20, v22
    v_mfma_f32_16x16x32_bf16 v[88:91], a[228:231], a[28:31], v[88:91]
    v_mov_b32 v23, v21
    v_min_u32 v24, v20, v22
    v_mfma_f32_16x16x32_bf16 v[88:91], a[224:227], a[12:15], v[88:91]
    v_permlane16_swap_b32 v21, v23
    v_mfma_f32_16x16x32_bf16 v[92:95], a[232:235], a[12:15], v[92:95]
    buffer_load_dwordx4 a[72:75], v15, s[20:23], s46 offen offset:0 sc1
    v_mfma_f32_16x16x32_bf16 v[92:95], a[236:239], a[28:31], v[92:95]
    v_max_u32 v20, v20, v22
    v_max3_u32 v21, v24, v21, v23
    v_mfma_f32_16x16x32_bf16 v[84:87], a[236:239], a[24:27], v[84:87]
    v_mov_b32 v22, v20
    v_mov_b32 v23, v21
    v_mfma_f32_16x16x32_bf16 v[84:87], a[232:235], a[8:11], v[84:87]
    v_permlane32_swap_b32 v20, v22
    v_mfma_f32_16x16x32_bf16 v[76:79], a[232:235], a[4:7], v[76:79]
    v_permlane32_swap_b32 v21, v23
    v_mfma_f32_16x16x32_bf16 v[76:79], a[236:239], a[20:23], v[76:79]
    s_waitcnt lgkmcnt(0)
    v_min_u32 v24, v20, v22
    v_max_u32 v20, v20, v22
    v_mfma_f32_16x16x32_bf16 v[68:71], a[236:239], a[16:19], v[68:71]
    buffer_load_dwordx4 a[76:79], v15, s[20:23], s46 offen offset:1024 sc1
    v_subrev_u32 v11, 98304, v11
    v_mfma_f32_16x16x32_bf16 v[68:71], a[232:235], a[0:3], v[68:71]
    s_add_u32 m0, s49, 73728
    ds_read_b64_tr_b16 a[224:225], v11 offset:0
    v_max3_u32 v21, v24, v21, v23
    v_mfma_f32_16x16x32_bf16 v[96:99], a[240:243], a[0:3], v[96:99]
    ds_read_b64_tr_b16 a[226:227], v11 offset:6144
    v_mov_b32 v22, s56
    v_mfma_f32_16x16x32_bf16 v[96:99], a[244:247], a[16:19], v[96:99]
    ds_write_b64 v22, v[20:21]
    ds_read_b64_tr_b16 a[228:229], v11 offset:12288
    v_mfma_f32_16x16x32_bf16 v[104:107], a[244:247], a[20:23], v[104:107]
    ds_read_b64_tr_b16 a[230:231], v11 offset:18432
    v_mov_b32 v23, 147456
    v_mfma_f32_16x16x32_bf16 v[104:107], a[240:243], a[4:7], v[104:107]
    ds_read_b64_tr_b16 a[232:233], v8 offset:1024
    v_mfma_f32_16x16x32_bf16 v[112:115], a[240:243], a[8:11], v[112:115]
    ds_read_b64_tr_b16 a[234:235], v8 offset:7168
    v_mfma_f32_16x16x32_bf16 v[112:115], a[244:247], a[24:27], v[112:115]
    buffer_load_dwordx4 v2, s[8:11], s36 offen offset:0 lds
    v_mfma_f32_16x16x32_bf16 v[120:123], a[244:247], a[28:31], v[120:123]
    s_add_u32 m0, s49, 74624
    ds_read_b64_tr_b16 a[236:237], v8 offset:13312
    v_mfma_f32_16x16x32_bf16 v[120:123], a[240:243], a[12:15], v[120:123]
    s_waitcnt lgkmcnt(6)
    ds_read_b64_tr_b16 a[238:239], v8 offset:19456
    v_mfma_f32_16x16x32_bf16 v[124:127], a[224:227], a[12:15], v[124:127]
    s_waitcnt lgkmcnt(4)
    ds_read_b64_tr_b16 a[240:241], v9 offset:1024
    v_mfma_f32_16x16x32_bf16 v[124:127], a[228:231], a[28:31], v[124:127]
    ds_read_b64_tr_b16 a[242:243], v9 offset:7168
    v_mfma_f32_16x16x32_bf16 v[116:119], a[228:231], a[24:27], v[116:119]
    ds_read_b64_tr_b16 a[244:245], v9 offset:13312
    v_mfma_f32_16x16x32_bf16 v[116:119], a[224:227], a[8:11], v[116:119]
    buffer_load_dwordx4 v2, s[8:11], s36 offen offset:128 lds
    v_mfma_f32_16x16x32_bf16 v[108:111], a[224:227], a[4:7], v[108:111]
    s_add_u32 m0, s49, 75520
    ds_read_b64_tr_b16 a[246:247], v9 offset:19456
    v_mfma_f32_16x16x32_bf16 v[108:111], a[228:231], a[20:23], v[108:111]
    s_waitcnt lgkmcnt(5)
    v_mfma_f32_16x16x32_bf16 v[100:103], a[228:231], a[16:19], v[100:103]
    s_waitcnt lgkmcnt(4)
    v_mfma_f32_16x16x32_bf16 v[100:103], a[224:227], a[0:3], v[100:103]
    ds_read_b64_tr_b16 a[224:225], v10 offset:1024
    v_mfma_f32_16x16x32_bf16 v[128:131], a[232:235], a[0:3], v[128:131]
    ds_read_b64_tr_b16 a[226:227], v10 offset:7168
    v_mfma_f32_16x16x32_bf16 v[128:131], a[236:239], a[16:19], v[128:131]
    ds_read_b64_tr_b16 a[228:229], v10 offset:13312
    v_mfma_f32_16x16x32_bf16 v[136:139], a[236:239], a[20:23], v[136:139]
    buffer_load_dwordx4 v2, s[8:11], s36 offen offset:256 lds
    v_mfma_f32_16x16x32_bf16 v[136:139], a[232:235], a[4:7], v[136:139]
    s_add_u32 m0, s49, 76800
    ds_read_b64_tr_b16 a[230:231], v10 offset:19456
    v_mfma_f32_16x16x32_bf16 v[144:147], a[232:235], a[8:11], v[144:147]
    v_mfma_f32_16x16x32_bf16 v[144:147], a[236:239], a[24:27], v[144:147]
    s_waitcnt lgkmcnt(4)
    v_mfma_f32_16x16x32_bf16 v[152:155], a[236:239], a[28:31], v[152:155]
    v_mfma_f32_16x16x32_bf16 v[152:155], a[232:235], a[12:15], v[152:155]
    ds_read_b64_tr_b16 a[232:233], v11 offset:1024
    v_mfma_f32_16x16x32_bf16 v[156:159], a[240:243], a[12:15], v[156:159]
    buffer_load_dwordx4 v3, s[8:11], s36 offen offset:0 lds
    v_mfma_f32_16x16x32_bf16 v[156:159], a[244:247], a[28:31], v[156:159]
    s_add_u32 m0, s49, 77696
    ds_read_b64_tr_b16 a[234:235], v11 offset:7168
    v_mfma_f32_16x16x32_bf16 v[148:151], a[244:247], a[24:27], v[148:151]
    ds_read_b64_tr_b16 a[236:237], v11 offset:13312
    v_mfma_f32_16x16x32_bf16 v[148:151], a[240:243], a[8:11], v[148:151]
    ds_read_b64_tr_b16 a[238:239], v11 offset:19456
    v_mfma_f32_16x16x32_bf16 v[140:143], a[240:243], a[4:7], v[140:143]
    v_mfma_f32_16x16x32_bf16 v[140:143], a[244:247], a[20:23], v[140:143]
    s_waitcnt lgkmcnt(4)
    v_mfma_f32_16x16x32_bf16 v[132:135], a[244:247], a[16:19], v[132:135]
    v_mfma_f32_16x16x32_bf16 v[132:135], a[240:243], a[0:3], v[132:135]
    buffer_load_dwordx4 v3, s[8:11], s36 offen offset:128 lds
    v_mfma_f32_16x16x32_bf16 v[160:163], a[224:227], a[0:3], v[160:163]
pg_2:
    s_cbranch_execz pg_6
    s_add_u32 m0, s49, 78592
    ds_read_b64_tr_b16 a[240:241], v8 offset:2048
    v_mfma_f32_16x16x32_bf16 v[160:163], a[228:231], a[16:19], v[160:163]
    ds_read_b64_tr_b16 a[242:243], v8 offset:8192
    v_mfma_f32_16x16x32_bf16 v[168:171], a[228:231], a[20:23], v[168:171]
    ds_read_b64_tr_b16 a[244:245], v8 offset:14336
    v_mfma_f32_16x16x32_bf16 v[168:171], a[224:227], a[4:7], v[168:171]
    ds_read_b64_tr_b16 a[246:247], v8 offset:20480
    v_mfma_f32_16x16x32_bf16 v[176:179], a[224:227], a[8:11], v[176:179]
    v_mfma_f32_16x16x32_bf16 v[176:179], a[228:231], a[24:27], v[176:179]
    buffer_load_dwordx4 v3, s[8:11], s36 offen offset:256 lds
    v_mfma_f32_16x16x32_bf16 v[184:187], a[228:231], a[28:31], v[184:187]
    s_waitcnt lgkmcnt(4)
    s_add_u32 s36, s36, s37
    s_sub_u32 s55, s36, 7864320
    v_mfma_f32_16x16x32_bf16 v[184:187], a[224:227], a[12:15], v[184:187]
    s_min_u32 s36, s36, s55
    ds_read_b64_tr_b16 a[224:225], v9 offset:2048
    s_add_u32 s46, s45, 53248
    v_mfma_f32_16x16x32_bf16 v[188:191], a[232:235], a[12:15], v[188:191]
    s_sub_u32 s77, s46, 81920
    ds_read_b64_tr_b16 a[226:227], v9 offset:8192
    s_min_u32 s46, s46, s77
    v_mfma_f32_16x16x32_bf16 v[188:191], a[236:239], a[28:31], v[188:191]
    ds_read_b64_tr_b16 a[228:229], v9 offset:14336
    v_mfma_f32_16x16x32_bf16 v[180:183], a[236:239], a[24:27], v[180:183]
    ds_read_b64_tr_b16 a[230:231], v9 offset:20480
    v_mfma_f32_16x16x32_bf16 v[180:183], a[232:235], a[8:11], v[180:183]
    v_mfma_f32_16x16x32_bf16 v[172:175], a[232:235], a[4:7], v[172:175]
    buffer_load_dwordx4 a[80:83], v14, s[20:23], s46 offen offset:0 sc1
    v_mfma_f32_16x16x32_bf16 v[172:175], a[236:239], a[20:23], v[172:175]
    s_waitcnt lgkmcnt(4)
    v_mfma_f32_16x16x32_bf16 v[164:167], a[236:239], a[16:19], v[164:167]
    v_mfma_f32_16x16x32_bf16 v[164:167], a[232:235], a[0:3], v[164:167]
    ds_read_b64_tr_b16 a[232:233], v10 offset:2048
    v_mfma_f32_16x16x32_bf16 v[192:195], a[240:243], a[0:3], v[192:195]
    ds_read_b64_tr_b16 a[234:235], v10 offset:8192
    v_mfma_f32_16x16x32_bf16 v[192:195], a[244:247], a[16:19], v[192:195]
    ds_read_b64_tr_b16 a[236:237], v10 offset:14336
    v_mfma_f32_16x16x32_bf16 v[200:203], a[244:247], a[20:23], v[200:203]
    buffer_load_dwordx4 a[84:87], v14, s[20:23], s46 offen offset:1024 sc1
    v_mfma_f32_16x16x32_bf16 v[200:203], a[240:243], a[4:7], v[200:203]
    ds_read_b64_tr_b16 a[238:239], v10 offset:20480
    v_mfma_f32_16x16x32_bf16 v[208:211], a[240:243], a[8:11], v[208:211]
    v_mfma_f32_16x16x32_bf16 v[208:211], a[244:247], a[24:27], v[208:211]
    s_waitcnt lgkmcnt(4)
    v_mfma_f32_16x16x32_bf16 v[216:219], a[244:247], a[28:31], v[216:219]
    v_mfma_f32_16x16x32_bf16 v[216:219], a[240:243], a[12:15], v[216:219]
    ds_read_b64_tr_b16 a[240:241], v11 offset:2048
    ds_read_b64_tr_b16 a[242:243], v11 offset:8192
    ds_read_b64_tr_b16 a[244:245], v11 offset:14336
    v_mfma_f32_16x16x32_bf16 v[220:223], a[224:227], a[12:15], v[220:223]
    ds_read_b64_tr_b16 a[246:247], v11 offset:20480
    v_mfma_f32_16x16x32_bf16 v[220:223], a[228:231], a[28:31], v[220:223]
    buffer_load_dwordx4 a[88:91], v15, s[20:23], s46 offen offset:0 sc1
    v_mfma_f32_16x16x32_bf16 v[212:215], a[228:231], a[24:27], v[212:215]
    v_mfma_f32_16x16x32_bf16 v[212:215], a[224:227], a[8:11], v[212:215]
    v_mfma_f32_16x16x32_bf16 v[204:207], a[224:227], a[4:7], v[204:207]
    v_mfma_f32_16x16x32_bf16 v[204:207], a[228:231], a[20:23], v[204:207]
    s_waitcnt lgkmcnt(4)
    v_mfma_f32_16x16x32_bf16 v[196:199], a[228:231], a[16:19], v[196:199]
    s_waitcnt lgkmcnt(0)
    s_barrier
    v_mfma_f32_16x16x32_bf16 v[196:199], a[224:227], a[0:3], v[196:199]
    buffer_load_dwordx4 a[92:95], v15, s[20:23], s46 offen offset:1024 sc1
    v_mfma_f32_16x16x32_bf16 v[224:227], a[232:235], a[0:3], v[224:227]
    s_add_u32 s46, s45, 57344
    ds_read_b128 v[32:35], v23 offset:0
    v_and_b32 v22, 1, v1
    v_mfma_f32_16x16x32_bf16 v[224:227], a[236:239], a[16:19], v[224:227]
    s_sub_u32 s77, s46, 81920
    ds_read_b128 v[36:39], v23 offset:16
    v_cmp_eq_u32 vcc, 1, v22
    v_mfma_f32_16x16x32_bf16 v[232:235], a[236:239], a[20:23], v[232:235]
    s_min_u32 s46, s46, s77
    ds_read_b64_tr_b16 a[224:225], v8 offset:24576
    v_lshrrev_b32 v24, 4, v1
    v_mfma_f32_16x16x32_bf16 v[232:235], a[232:235], a[4:7], v[232:235]
    ds_read_b64_tr_b16 a[226:227], v8 offset:30720
    v_bfe_u32 v26, v1, 2, 3
    v_mfma_f32_16x16x32_bf16 v[240:243], a[232:235], a[8:11], v[240:243]
    ds_read_b64_tr_b16 a[228:229], v8 offset:36864
    v_lshlrev_b32 v25, 7, v26
    v_mfma_f32_16x16x32_bf16 v[240:243], a[236:239], a[24:27], v[240:243]
    ds_read_b64_tr_b16 a[230:231], v8 offset:43008
    v_lshrrev_b32 v26, 1, v26
    v_mfma_f32_16x16x32_bf16 v[248:251], a[236:239], a[28:31], v[248:251]
    buffer_load_dwordx4 a[160:163], v14, s[20:23], s46 offen offset:0 sc1
    v_mfma_f32_16x16x32_bf16 v[248:251], a[232:235], a[12:15], v[248:251]
    s_waitcnt lgkmcnt(5)
    ds_read_b64_tr_b16 a[232:233], v9 offset:24576
    v_max_u32 v20, v32, v33
    v_mfma_f32_16x16x32_bf16 v[252:255], a[240:243], a[12:15], v[252:255]
    ds_read_b64_tr_b16 a[234:235], v9 offset:30720
    v_min_u32 v21, v32, v33
    v_mfma_f32_16x16x32_bf16 v[252:255], a[244:247], a[28:31], v[252:255]
    ds_read_b64_tr_b16 a[236:237], v9 offset:36864
    v_med3_u32 v21, v20, v21, v34
    v_mfma_f32_16x16x32_bf16 v[244:247], a[244:247], a[24:27], v[244:247]
    ds_read_b64_tr_b16 a[238:239], v9 offset:43008
    v_max_u32 v20, v20, v34
    v_mfma_f32_16x16x32_bf16 v[244:247], a[240:243], a[8:11], v[244:247]
    v_med3_u32 v21, v20, v21, v35
    v_max_u32 v20, v20, v35
    v_mfma_f32_16x16x32_bf16 v[236:239], a[240:243], a[4:7], v[236:239]
    buffer_load_dwordx4 a[164:167], v14, s[20:23], s46 offen offset:1024 sc1
    v_mfma_f32_16x16x32_bf16 v[236:239], a[244:247], a[20:23], v[236:239]
    s_waitcnt vmcnt(29) lgkmcnt(4)
    v_med3_u32 v21, v20, v21, v36
    v_max_u32 v20, v20, v36
    v_mfma_f32_16x16x32_bf16 v[228:231], a[244:247], a[16:19], v[228:231]
    s_waitcnt vmcnt(19)
    v_med3_u32 v21, v20, v21, v37
    v_max_u32 v20, v20, v37
    v_mfma_f32_16x16x32_bf16 v[228:231], a[240:243], a[0:3], v[228:231]
    s_waitcnt vmcnt(18)
    ds_read_b64_tr_b16 a[240:241], v10 offset:24576
    v_med3_u32 v21, v20, v21, v38
    v_mfma_f32_16x16x32_bf16 v[64:67], a[224:227], a[32:35], v[64:67]
    ds_read_b64_tr_b16 a[242:243], v10 offset:30720
    v_max_u32 v20, v20, v38
    v_mfma_f32_16x16x32_bf16 v[64:67], a[228:231], a[48:51], v[64:67]
    ds_read_b64_tr_b16 a[244:245], v10 offset:36864
    v_med3_u32 v21, v20, v21, v39
    v_mfma_f32_16x16x32_bf16 v[72:75], a[228:231], a[52:55], v[72:75]
    s_waitcnt vmcnt(17)
    ds_read_b64_tr_b16 a[246:247], v10 offset:43008
    v_max_u32 v20, v20, v39
    v_mfma_f32_16x16x32_bf16 v[72:75], a[224:227], a[36:39], v[72:75]
    buffer_load_dwordx4 a[168:171], v15, s[20:23], s46 offen offset:0 sc1
    v_mfma_f32_16x16x32_bf16 v[80:83], a[224:227], a[40:43], v[80:83]
    s_waitcnt vmcnt(17)
    v_readfirstlane_b32 s70, v20
    v_readfirstlane_b32 s71, v21
    v_mfma_f32_16x16x32_bf16 v[80:83], a[228:231], a[56:59], v[80:83]
    s_waitcnt lgkmcnt(4)
    v_cndmask_b32 v22, v20, v21, vcc
    v_and_b32 v22, 0x7ff, v22
    v_mfma_f32_16x16x32_bf16 v[88:91], a[228:231], a[60:63], v[88:91]
    v_sub_u32 v22, 2047, v22
    v_mul_u32_u24 v23, 1280, v22
    v_mfma_f32_16x16x32_bf16 v[88:91], a[224:227], a[44:47], v[88:91]
    ds_read_b64_tr_b16 a[224:225], v11 offset:24576
    v_lshl_add_u32 v23, v24, 4, v23
    v_mfma_f32_16x16x32_bf16 v[92:95], a[232:235], a[44:47], v[92:95]
    ds_read_b64_tr_b16 a[226:227], v11 offset:30720
    v_add_u32 v23, s61, v23
    v_mfma_f32_16x16x32_bf16 v[92:95], a[236:239], a[60:63], v[92:95]
    buffer_load_dwordx4 a[172:175], v15, s[20:23], s46 offen offset:1024 sc1
    v_mfma_f32_16x16x32_bf16 v[84:87], a[236:239], a[56:59], v[84:87]
    s_add_u32 m0, s49, 98304
    ds_read_b64_tr_b16 a[228:229], v11 offset:36864
    v_lshlrev_b32 v24, 3, v22
    v_mfma_f32_16x16x32_bf16 v[84:87], a[232:235], a[40:43], v[84:87]
    ds_read_b64_tr_b16 a[230:231], v11 offset:43008
    v_add_u32 v24, 3211264, v24
    v_mfma_f32_16x16x32_bf16 v[76:79], a[232:235], a[36:39], v[76:79]
    v_xor_b32 v26, s3, v26
    v_lshl_add_u32 v25, v26, 5, v25
    v_mfma_f32_16x16x32_bf16 v[76:79], a[236:239], a[52:55], v[76:79]
    s_waitcnt lgkmcnt(4)
    v_and_b32 v26, 3, v1
    v_lshl_add_u32 v25, v26, 3, v25
    v_mfma_f32_16x16x32_bf16 v[68:71], a[236:239], a[48:51], v[68:71]
    v_lshrrev_b32 v26, 5, v1
    v_mul_u32_u24 v26, 2048, v26
    v_mfma_f32_16x16x32_bf16 v[68:71], a[232:235], a[32:35], v[68:71]
    ds_read_b64_tr_b16 a[232:233], v8 offset:25600
    v_add_u32 v25, v25, v26
    v_mfma_f32_16x16x32_bf16 v[96:99], a[240:243], a[32:35], v[96:99]
    buffer_load_dwordx4 v2, s[8:11], s36 offen offset:0 lds
    v_mfma_f32_16x16x32_bf16 v[96:99], a[244:247], a[48:51], v[96:99]
    s_add_u32 m0, s49, 99200
    ds_read_b64_tr_b16 a[234:235], v8 offset:31744
    v_add_u32 v25, 147456, v25
    v_mfma_f32_16x16x32_bf16 v[104:107], a[244:247], a[52:55], v[104:107]
    ds_read_b64_tr_b16 a[236:237], v8 offset:37888
    v_lshlrev_b32 v26, 4, v1
    v_mfma_f32_16x16x32_bf16 v[104:107], a[240:243], a[36:39], v[104:107]
    ds_read_b64_tr_b16 a[238:239], v8 offset:44032
    v_cmp_gt_u32 vcc, 16, v1
    v_mfma_f32_16x16x32_bf16 v[112:115], a[240:243], a[40:43], v[112:115]
    v_mov_b32 v27, 0x7ffffff0
    v_cndmask_b32 v26, v27, v26, vcc
    v_mfma_f32_16x16x32_bf16 v[112:115], a[244:247], a[56:59], v[112:115]
    s_waitcnt lgkmcnt(4)
    v_min_u32 v27, 1, v1
    v_mfma_f32_16x16x32_bf16 v[120:123], a[244:247], a[60:63], v[120:123]
    buffer_load_dwordx4 v2, s[8:11], s36 offen offset:128 lds
    v_mfma_f32_16x16x32_bf16 v[120:123], a[240:243], a[44:47], v[120:123]
    s_add_u32 m0, s49, 100096
    ds_read_b64_tr_b16 a[240:241], v9 offset:25600
    v_mfma_f32_16x16x32_bf16 v[124:127], a[224:227], a[44:47], v[124:127]
    ds_read_b64_tr_b16 a[242:243], v9 offset:31744
    v_mfma_f32_16x16x32_bf16 v[124:127], a[228:231], a[60:63], v[124:127]
    ds_read_b64_tr_b16 a[244:245], v9 offset:37888
    v_mfma_f32_16x16x32_bf16 v[116:119], a[228:231], a[56:59], v[116:119]
    ds_read_b64_tr_b16 a[246:247], v9 offset:44032
    v_mfma_f32_16x16x32_bf16 v[116:119], a[224:227], a[40:43], v[116:119]
    v_lshlrev_b32 v27, 30, v27
    v_mfma_f32_16x16x32_bf16 v[108:111], a[224:227], a[36:39], v[108:111]
    v_mfma_f32_16x16x32_bf16 v[108:111], a[228:231], a[52:55], v[108:111]
    buffer_load_dwordx4 v2, s[8:11], s36 offen offset:256 lds
    v_mfma_f32_16x16x32_bf16 v[100:103], a[228:231], a[48:51], v[100:103]
    s_waitcnt lgkmcnt(3)
    s_add_u32 m0, s49, 101376
    v_mfma_f32_16x16x32_bf16 v[100:103], a[224:227], a[32:35], v[100:103]
    ds_read_b64_tr_b16 a[224:225], v10 offset:25600
    v_mfma_f32_16x16x32_bf16 v[128:131], a[232:235], a[32:35], v[128:131]
    ds_read_b64_tr_b16 a[226:227], v10 offset:31744
    v_mfma_f32_16x16x32_bf16 v[128:131], a[236:239], a[48:51], v[128:131]
    ds_read_b64_tr_b16 a[228:229], v10 offset:37888
    v_mfma_f32_16x16x32_bf16 v[136:139], a[236:239], a[52:55], v[136:139]
    ds_read_b64_tr_b16 a[230:231], v10 offset:44032
    v_mfma_f32_16x16x32_bf16 v[136:139], a[232:235], a[36:39], v[136:139]
    buffer_load_dwordx4 v3, s[8:11], s36 offen offset:0 lds
    v_mfma_f32_16x16x32_bf16 v[144:147], a[232:235], a[40:43], v[144:147]
    s_add_u32 m0, s49, 102272
    v_mfma_f32_16x16x32_bf16 v[144:147], a[236:239], a[56:59], v[144:147]
    s_waitcnt lgkmcnt(4)
    v_mfma_f32_16x16x32_bf16 v[152:155], a[236:239], a[60:63], v[152:155]
    v_mfma_f32_16x16x32_bf16 v[152:155], a[232:235], a[44:47], v[152:155]
    ds_read_b64_tr_b16 a[232:233], v11 offset:25600
    v_mfma_f32_16x16x32_bf16 v[156:159], a[240:243], a[44:47], v[156:159]
    ds_read_b64_tr_b16 a[234:235], v11 offset:31744
    v_mfma_f32_16x16x32_bf16 v[156:159], a[244:247], a[60:63], v[156:159]
    ds_read_b64_tr_b16 a[236:237], v11 offset:37888
    v_mfma_f32_16x16x32_bf16 v[148:151], a[244:247], a[56:59], v[148:151]
    buffer_load_dwordx4 v3, s[8:11], s36 offen offset:128 lds
    v_mfma_f32_16x16x32_bf16 v[148:151], a[240:243], a[40:43], v[148:151]
    s_add_u32 m0, s49, 103168
    ds_read_b64_tr_b16 a[238:239], v11 offset:44032
    v_mfma_f32_16x16x32_bf16 v[140:143], a[240:243], a[36:39], v[140:143]
    v_mfma_f32_16x16x32_bf16 v[140:143], a[244:247], a[52:55], v[140:143]
    s_waitcnt lgkmcnt(4)
    v_mfma_f32_16x16x32_bf16 v[132:135], a[244:247], a[48:51], v[132:135]
    v_mfma_f32_16x16x32_bf16 v[132:135], a[240:243], a[32:35], v[132:135]
    ds_read_b64_tr_b16 a[240:241], v8 offset:26624
    v_mfma_f32_16x16x32_bf16 v[160:163], a[224:227], a[32:35], v[160:163]
    buffer_load_dwordx4 v3, s[8:11], s36 offen offset:256 lds
    v_mfma_f32_16x16x32_bf16 v[160:163], a[228:231], a[48:51], v[160:163]
    s_add_u32 s36, s36, s37
    ds_read_b64_tr_b16 a[242:243], v8 offset:32768
    s_sub_u32 s55, s36, 7864320
    v_mfma_f32_16x16x32_bf16 v[168:171], a[228:231], a[52:55], v[168:171]
    global_load_dwordx4 v[48:51], v23, s[64:65]
    v_mfma_f32_16x16x32_bf16 v[168:171], a[224:227], a[36:39], v[168:171]
    global_load_dwordx4 v[52:55], v23, s[64:65] offset:64
    v_mfma_f32_16x16x32_bf16 v[176:179], a[224:227], a[40:43], v[176:179]
    buffer_load_dwordx2 v[40:41], v24, s[24:27], 0 offen sc1
    v_mfma_f32_16x16x32_bf16 v[176:179], a[228:231], a[56:59], v[176:179]
    s_waitcnt lgkmcnt(2)
    ds_read_b64_tr_b16 a[244:245], v8 offset:38912
    s_min_u32 s36, s36, s55
    v_mfma_f32_16x16x32_bf16 v[184:187], a[228:231], a[60:63], v[184:187]
    s_add_u32 s46, s45, 61440
    ds_read_b64_tr_b16 a[246:247], v8 offset:45056
    s_sub_u32 s77, s46, 81920
    v_mfma_f32_16x16x32_bf16 v[184:187], a[224:227], a[44:47], v[184:187]
    s_min_u32 s46, s46, s77
    ds_read_b64_tr_b16 a[224:225], v9 offset:26624
    v_mfma_f32_16x16x32_bf16 v[188:191], a[232:235], a[44:47], v[188:191]
    buffer_load_dwordx4 a[176:179], v14, s[20:23], s46 offen offset:0 sc1
    v_mfma_f32_16x16x32_bf16 v[188:191], a[236:239], a[60:63], v[188:191]
    ds_read_b64_tr_b16 a[226:227], v9 offset:32768
    v_mfma_f32_16x16x32_bf16 v[180:183], a[236:239], a[56:59], v[180:183]
    ds_read_b64_tr_b16 a[228:229], v9 offset:38912
    v_mfma_f32_16x16x32_bf16 v[180:183], a[232:235], a[40:43], v[180:183]
    ds_read_b64_tr_b16 a[230:231], v9 offset:45056
    v_mfma_f32_16x16x32_bf16 v[172:175], a[232:235], a[36:39], v[172:175]
    v_add_u32 v8, 49152, v8
    v_mfma_f32_16x16x32_bf16 v[172:175], a[236:239], a[52:55], v[172:175]
    buffer_load_dwordx4 a[180:183], v14, s[20:23], s46 offen offset:1024 sc1
    v_mfma_f32_16x16x32_bf16 v[164:167], a[236:239], a[48:51], v[164:167]
    s_waitcnt lgkmcnt(3)
    v_add_u32 v9, 49152, v9
    v_mfma_f32_16x16x32_bf16 v[164:167], a[232:235], a[32:35], v[164:167]
    ds_read_b64_tr_b16 a[232:233], v10 offset:26624
    v_mfma_f32_16x16x32_bf16 v[192:195], a[240:243], a[32:35], v[192:195]
    ds_read_b64_tr_b16 a[234:235], v10 offset:32768
    v_mfma_f32_16x16x32_bf16 v[192:195], a[244:247], a[48:51], v[192:195]
    ds_read_b64_tr_b16 a[236:237], v10 offset:38912
    v_mfma_f32_16x16x32_bf16 v[200:203], a[244:247], a[52:55], v[200:203]
    ds_read_b64_tr_b16 a[238:239], v10 offset:45056
    v_mfma_f32_16x16x32_bf16 v[200:203], a[240:243], a[36:39], v[200:203]
    v_add_u32 v10, 49152, v10
    v_mfma_f32_16x16x32_bf16 v[208:211], a[240:243], a[40:43], v[208:211]
    buffer_load_dwordx4 a[184:187], v15, s[20:23], s46 offen offset:0 sc1
    v_mfma_f32_16x16x32_bf16 v[208:211], a[244:247], a[56:59], v[208:211]
    s_waitcnt lgkmcnt(4)
    v_mfma_f32_16x16x32_bf16 v[216:219], a[244:247], a[60:63], v[216:219]
    v_mfma_f32_16x16x32_bf16 v[216:219], a[240:243], a[44:47], v[216:219]
    ds_read_b64_tr_b16 a[240:241], v11 offset:26624
    ds_read_b64_tr_b16 a[242:243], v11 offset:32768
    ds_read_b64_tr_b16 a[244:245], v11 offset:38912
    v_mfma_f32_16x16x32_bf16 v[220:223], a[224:227], a[44:47], v[220:223]
    ds_read_b64_tr_b16 a[246:247], v11 offset:45056
    v_mfma_f32_16x16x32_bf16 v[220:223], a[228:231], a[60:63], v[220:223]
    v_add_u32 v11, 49152, v11
    v_mfma_f32_16x16x32_bf16 v[212:215], a[228:231], a[56:59], v[212:215]
    buffer_load_dwordx4 a[188:191], v15, s[20:23], s46 offen offset:1024 sc1
    v_mfma_f32_16x16x32_bf16 v[212:215], a[224:227], a[40:43], v[212:215]
    s_add_u32 m0, s44, 147456
    v_mfma_f32_16x16x32_bf16 v[204:207], a[224:227], a[36:39], v[204:207]
    v_mfma_f32_16x16x32_bf16 v[204:207], a[228:231], a[52:55], v[204:207]
    s_waitcnt lgkmcnt(4)
    v_mfma_f32_16x16x32_bf16 v[196:199], a[228:231], a[48:51], v[196:199]
    s_waitcnt lgkmcnt(0)
    s_barrier
    v_mfma_f32_16x16x32_bf16 v[196:199], a[224:227], a[32:35], v[196:199]
    ds_read_b64_tr_b16 a[224:225], v8 offset:0
    v_mfma_f32_16x16x32_bf16 v[224:227], a[232:235], a[32:35], v[224:227]
    ds_read_b64_tr_b16 a[226:227], v8 offset:6144
    v_mfma_f32_16x16x32_bf16 v[224:227], a[236:239], a[48:51], v[224:227]
    buffer_load_dwordx4 v56, s[28:31], s60 offen lds
    v_mfma_f32_16x16x32_bf16 v[232:235], a[236:239], a[52:55], v[232:235]
    s_add_u32 m0, s44, 148480
    ds_read_b64_tr_b16 a[228:229], v8 offset:12288
    v_mfma_f32_16x16x32_bf16 v[232:235], a[232:235], a[36:39], v[232:235]
    ds_read_b64_tr_b16 a[230:231], v8 offset:18432
    v_mfma_f32_16x16x32_bf16 v[240:243], a[232:235], a[40:43], v[240:243]
    v_mfma_f32_16x16x32_bf16 v[240:243], a[236:239], a[56:59], v[240:243]
    v_mfma_f32_16x16x32_bf16 v[248:251], a[236:239], a[60:63], v[248:251]
    v_mfma_f32_16x16x32_bf16 v[248:251], a[232:235], a[44:47], v[248:251]
    buffer_load_dwordx4 v56, s[32:35], s60 offen lds
    v_mfma_f32_16x16x32_bf16 v[252:255], a[240:243], a[44:47], v[252:255]
    s_add_u32 m0, s44, 149504
    ds_read_b64_tr_b16 a[232:233], v9 offset:0
    v_mfma_f32_16x16x32_bf16 v[252:255], a[244:247], a[60:63], v[252:255]
    ds_read_b64_tr_b16 a[234:235], v9 offset:6144
    v_mfma_f32_16x16x32_bf16 v[244:247], a[244:247], a[56:59], v[244:247]
    ds_read_b64_tr_b16 a[236:237], v9 offset:12288
    v_mfma_f32_16x16x32_bf16 v[244:247], a[240:243], a[40:43], v[244:247]
    ds_read_b64_tr_b16 a[238:239], v9 offset:18432
    v_mfma_f32_16x16x32_bf16 v[236:239], a[240:243], a[36:39], v[236:239]
    v_mfma_f32_16x16x32_bf16 v[236:239], a[244:247], a[52:55], v[236:239]
    s_waitcnt vmcnt(32) lgkmcnt(4)
    v_mfma_f32_16x16x32_bf16 v[228:231], a[244:247], a[48:51], v[228:231]
    buffer_load_dwordx4 v57, s[28:31], s60 offen lds
    v_mfma_f32_16x16x32_bf16 v[228:231], a[240:243], a[32:35], v[228:231]
    s_waitcnt vmcnt(22)
    ds_read_b64_tr_b16 a[240:241], v10 offset:0
    s_add_u32 m0, s44, 150528
    v_mfma_f32_16x16x32_bf16 v[64:67], a[224:227], a[64:67], v[64:67]
    ds_read_b64_tr_b16 a[242:243], v10 offset:6144
    v_mfma_f32_16x16x32_bf16 v[64:67], a[228:231], a[80:83], v[64:67]
    ds_read_b64_tr_b16 a[244:245], v10 offset:12288
    v_mfma_f32_16x16x32_bf16 v[72:75], a[228:231], a[84:87], v[72:75]
    s_waitcnt vmcnt(21)
    ds_read_b64_tr_b16 a[246:247], v10 offset:18432
    v_mfma_f32_16x16x32_bf16 v[72:75], a[224:227], a[68:71], v[72:75]
    s_waitcnt vmcnt(20)
    v_mfma_f32_16x16x32_bf16 v[80:83], a[224:227], a[72:75], v[80:83]
    buffer_load_dwordx4 v57, s[32:35], s60 offen lds
    v_mfma_f32_16x16x32_bf16 v[80:83], a[228:231], a[88:91], v[80:83]
    s_waitcnt lgkmcnt(4)
    s_add_u32 s46, s45, 65536
    s_sub_u32 s77, s46, 81920
    v_mfma_f32_16x16x32_bf16 v[88:91], a[228:231], a[92:95], v[88:91]
    s_min_u32 s46, s46, s77
    v_mfma_f32_16x16x32_bf16 v[88:91], a[224:227], a[76:79], v[88:91]
    ds_read_b64_tr_b16 a[224:225], v11 offset:0
    v_mfma_f32_16x16x32_bf16 v[92:95], a[232:235], a[76:79], v[92:95]
    ds_read_b64_tr_b16 a[226:227], v11 offset:6144
    v_mfma_f32_16x16x32_bf16 v[92:95], a[236:239], a[92:95], v[92:95]
    ds_read_b64_tr_b16 a[228:229], v11 offset:12288
    v_mfma_f32_16x16x32_bf16 v[84:87], a[236:239], a[88:91], v[84:87]
    ds_read_b64_tr_b16 a[230:231], v11 offset:18432
    v_mfma_f32_16x16x32_bf16 v[84:87], a[232:235], a[72:75], v[84:87]
    buffer_load_dwordx4 a[96:99], v14, s[20:23], s46 offen offset:0 sc1
    v_mfma_f32_16x16x32_bf16 v[76:79], a[232:235], a[68:71], v[76:79]
    v_mfma_f32_16x16x32_bf16 v[76:79], a[236:239], a[84:87], v[76:79]
    s_waitcnt lgkmcnt(4)
    v_mfma_f32_16x16x32_bf16 v[68:71], a[236:239], a[80:83], v[68:71]
    v_mfma_f32_16x16x32_bf16 v[68:71], a[232:235], a[64:67], v[68:71]
    ds_read_b64_tr_b16 a[232:233], v8 offset:1024
    v_mfma_f32_16x16x32_bf16 v[96:99], a[240:243], a[64:67], v[96:99]
    ds_read_b64_tr_b16 a[234:235], v8 offset:7168
    v_mfma_f32_16x16x32_bf16 v[96:99], a[244:247], a[80:83], v[96:99]
    buffer_load_dwordx4 a[100:103], v14, s[20:23], s46 offen offset:1024 sc1
    v_mfma_f32_16x16x32_bf16 v[104:107], a[244:247], a[84:87], v[104:107]
    ds_read_b64_tr_b16 a[236:237], v8 offset:13312
    v_mfma_f32_16x16x32_bf16 v[104:107], a[240:243], a[68:71], v[104:107]
    ds_read_b64_tr_b16 a[238:239], v8 offset:19456
    v_mfma_f32_16x16x32_bf16 v[112:115], a[240:243], a[72:75], v[112:115]
    s_add_u32 s88, s88, 32768
    s_addc_u32 s89, s89, 0
    v_mfma_f32_16x16x32_bf16 v[112:115], a[244:247], a[88:91], v[112:115]
    s_waitcnt lgkmcnt(4)
    v_mfma_f32_16x16x32_bf16 v[120:123], a[244:247], a[92:95], v[120:123]
    v_mfma_f32_16x16x32_bf16 v[120:123], a[240:243], a[76:79], v[120:123]
    ds_read_b64_tr_b16 a[240:241], v9 offset:1024
    v_mfma_f32_16x16x32_bf16 v[124:127], a[224:227], a[76:79], v[124:127]
    global_load_dword a252, v18, s[88:89]
    v_mfma_f32_16x16x32_bf16 v[124:127], a[228:231], a[92:95], v[124:127]
    buffer_load_dwordx4 a[104:107], v15, s[20:23], s46 offen offset:0 sc1
    v_mfma_f32_16x16x32_bf16 v[116:119], a[228:231], a[88:91], v[116:119]
    ds_read_b64_tr_b16 a[242:243], v9 offset:7168
    v_mfma_f32_16x16x32_bf16 v[116:119], a[224:227], a[72:75], v[116:119]
    ds_read_b64_tr_b16 a[244:245], v9 offset:13312
    v_mfma_f32_16x16x32_bf16 v[108:111], a[224:227], a[68:71], v[108:111]
    ds_read_b64_tr_b16 a[246:247], v9 offset:19456
    v_mfma_f32_16x16x32_bf16 v[108:111], a[228:231], a[84:87], v[108:111]
    s_waitcnt lgkmcnt(4)
    v_mfma_f32_16x16x32_bf16 v[100:103], a[228:231], a[80:83], v[100:103]
    buffer_load_dwordx4 a[108:111], v15, s[20:23], s46 offen offset:1024 sc1
    v_mfma_f32_16x16x32_bf16 v[100:103], a[224:227], a[64:67], v[100:103]
    s_add_u32 m0, s49, 122880
    ds_read_b64_tr_b16 a[224:225], v10 offset:1024
    v_mfma_f32_16x16x32_bf16 v[128:131], a[232:235], a[64:67], v[128:131]
    ds_read_b64_tr_b16 a[226:227], v10 offset:7168
    v_mfma_f32_16x16x32_bf16 v[128:131], a[236:239], a[80:83], v[128:131]
    ds_read_b64_tr_b16 a[228:229], v10 offset:13312
    v_mfma_f32_16x16x32_bf16 v[136:139], a[236:239], a[84:87], v[136:139]
    ds_read_b64_tr_b16 a[230:231], v10 offset:19456
    v_mfma_f32_16x16x32_bf16 v[136:139], a[232:235], a[68:71], v[136:139]
    v_mfma_f32_16x16x32_bf16 v[144:147], a[232:235], a[72:75], v[144:147]
    v_mfma_f32_16x16x32_bf16 v[144:147], a[236:239], a[88:91], v[144:147]
    buffer_load_dwordx4 v2, s[8:11], s36 offen offset:0 lds
    v_mfma_f32_16x16x32_bf16 v[152:155], a[236:239], a[92:95], v[152:155]
    s_waitcnt lgkmcnt(3)
    s_add_u32 m0, s49, 123776
    v_mfma_f32_16x16x32_bf16 v[152:155], a[232:235], a[76:79], v[152:155]
    ds_read_b64_tr_b16 a[232:233], v11 offset:1024
    v_mfma_f32_16x16x32_bf16 v[156:159], a[240:243], a[76:79], v[156:159]
    ds_read_b64_tr_b16 a[234:235], v11 offset:7168
    v_mfma_f32_16x16x32_bf16 v[156:159], a[244:247], a[92:95], v[156:159]
    ds_read_b64_tr_b16 a[236:237], v11 offset:13312
    v_mfma_f32_16x16x32_bf16 v[148:151], a[244:247], a[88:91], v[148:151]
    ds_read_b64_tr_b16 a[238:239], v11 offset:19456
    v_mfma_f32_16x16x32_bf16 v[148:151], a[240:243], a[72:75], v[148:151]
    buffer_load_dwordx4 v2, s[8:11], s36 offen offset:128 lds
    v_mfma_f32_16x16x32_bf16 v[140:143], a[240:243], a[68:71], v[140:143]
    s_add_u32 m0, s49, 124672
    v_mfma_f32_16x16x32_bf16 v[140:143], a[244:247], a[84:87], v[140:143]
    s_waitcnt lgkmcnt(4)
    v_mfma_f32_16x16x32_bf16 v[132:135], a[244:247], a[80:83], v[132:135]
    v_mfma_f32_16x16x32_bf16 v[132:135], a[240:243], a[64:67], v[132:135]
    ds_read_b64_tr_b16 a[240:241], v8 offset:2048
    v_mfma_f32_16x16x32_bf16 v[160:163], a[224:227], a[64:67], v[160:163]
    ds_read_b64_tr_b16 a[242:243], v8 offset:8192
    v_mfma_f32_16x16x32_bf16 v[160:163], a[228:231], a[80:83], v[160:163]
    ds_read_b64_tr_b16 a[244:245], v8 offset:14336
    v_mfma_f32_16x16x32_bf16 v[168:171], a[228:231], a[84:87], v[168:171]
    buffer_load_dwordx4 v2, s[8:11], s36 offen offset:256 lds
    v_mfma_f32_16x16x32_bf16 v[168:171], a[224:227], a[68:71], v[168:171]
    s_add_u32 m0, s49, 125952
    ds_read_b64_tr_b16 a[246:247], v8 offset:20480
    v_mfma_f32_16x16x32_bf16 v[176:179], a[224:227], a[72:75], v[176:179]
    v_mfma_f32_16x16x32_bf16 v[176:179], a[228:231], a[88:91], v[176:179]
    s_waitcnt lgkmcnt(4)
    v_mfma_f32_16x16x32_bf16 v[184:187], a[228:231], a[92:95], v[184:187]
    s_waitcnt vmcnt(18)
    v_lshlrev_b32 v42, 16, v48
    v_and_b32 v43, 0xffff0000, v48
    v_mfma_f32_16x16x32_bf16 v[184:187], a[224:227], a[76:79], v[184:187]
    ds_read_b64_tr_b16 a[224:225], v9 offset:2048
    v_mfma_f32_16x16x32_bf16 v[188:191], a[232:235], a[76:79], v[188:191]
    buffer_load_dwordx4 v3, s[8:11], s36 offen offset:0 lds
    v_mfma_f32_16x16x32_bf16 v[188:191], a[236:239], a[92:95], v[188:191]
    s_add_u32 m0, s49, 126848
    ds_read_b64_tr_b16 a[226:227], v9 offset:8192
    v_mfma_f32_16x16x32_bf16 v[180:183], a[236:239], a[88:91], v[180:183]
    s_waitcnt vmcnt(17)
    ds_read_b64_tr_b16 a[228:229], v9 offset:14336
    v_sub_f32 v42, v42, v40
    v_mfma_f32_16x16x32_bf16 v[180:183], a[232:235], a[72:75], v[180:183]
    ds_read_b64_tr_b16 a[230:231], v9 offset:20480
    v_sub_f32 v43, v43, v40
    v_mfma_f32_16x16x32_bf16 v[172:175], a[232:235], a[68:71], v[172:175]
    v_cvt_pk_bf16_f32 v44, v42, v43
    v_lshlrev_b32 v42, 16, v44
    v_mfma_f32_16x16x32_bf16 v[172:175], a[236:239], a[84:87], v[172:175]
    s_waitcnt lgkmcnt(4)
    v_and_b32 v43, 0xffff0000, v44
    v_mul_f32 v42, v42, v41
    v_mfma_f32_16x16x32_bf16 v[164:167], a[236:239], a[80:83], v[164:167]
    v_mul_f32 v43, v43, v41
    v_cvt_pk_bf16_f32 v48, v42, v43
    v_mfma_f32_16x16x32_bf16 v[164:167], a[232:235], a[64:67], v[164:167]
    buffer_load_dwordx4 v3, s[8:11], s36 offen offset:128 lds
    v_mfma_f32_16x16x32_bf16 v[192:195], a[240:243], a[64:67], v[192:195]
    s_add_u32 m0, s49, 127744
    ds_read_b64_tr_b16 a[232:233], v10 offset:2048
    v_lshlrev_b32 v42, 16, v49
    v_mfma_f32_16x16x32_bf16 v[192:195], a[244:247], a[80:83], v[192:195]
    ds_read_b64_tr_b16 a[234:235], v10 offset:8192
    v_and_b32 v43, 0xffff0000, v49
    v_mfma_f32_16x16x32_bf16 v[200:203], a[244:247], a[84:87], v[200:203]
    ds_read_b64_tr_b16 a[236:237], v10 offset:14336
    v_sub_f32 v42, v42, v40
    v_mfma_f32_16x16x32_bf16 v[200:203], a[240:243], a[68:71], v[200:203]
    ds_read_b64_tr_b16 a[238:239], v10 offset:20480
    v_sub_f32 v43, v43, v40
    v_mfma_f32_16x16x32_bf16 v[208:211], a[240:243], a[72:75], v[208:211]
    v_cvt_pk_bf16_f32 v44, v42, v43
    v_lshlrev_b32 v42, 16, v44
    v_mfma_f32_16x16x32_bf16 v[208:211], a[244:247], a[88:91], v[208:211]
    buffer_load_dwordx4 v3, s[8:11], s36 offen offset:256 lds
    v_mfma_f32_16x16x32_bf16 v[216:219], a[244:247], a[92:95], v[216:219]
    s_waitcnt lgkmcnt(4)
    v_and_b32 v43, 0xffff0000, v44
    v_mul_f32 v42, v42, v41
    v_mfma_f32_16x16x32_bf16 v[216:219], a[240:243], a[76:79], v[216:219]
    s_add_u32 s36, s36, s37
    ds_read_b64_tr_b16 a[240:241], v11 offset:2048
    v_mul_f32 v43, v43, v41
    ds_read_b64_tr_b16 a[242:243], v11 offset:8192
    v_mfma_f32_16x16x32_bf16 v[220:223], a[224:227], a[76:79], v[220:223]
    s_sub_u32 s55, s36, 7864320
    ds_read_b64_tr_b16 a[244:245], v11 offset:14336
    v_cvt_pk_bf16_f32 v49, v42, v43
    ds_read_b64_tr_b16 a[246:247], v11 offset:20480
    v_mfma_f32_16x16x32_bf16 v[220:223], a[228:231], a[92:95], v[220:223]
    s_min_u32 s36, s36, s55
    v_lshlrev_b32 v42, 16, v50
    v_and_b32 v43, 0xffff0000, v50
    v_mfma_f32_16x16x32_bf16 v[212:215], a[228:231], a[88:91], v[212:215]
    s_add_u32 s46, s45, 69632
    v_sub_f32 v42, v42, v40
    v_sub_f32 v43, v43, v40
    v_mfma_f32_16x16x32_bf16 v[212:215], a[224:227], a[72:75], v[212:215]
    s_sub_u32 s77, s46, 81920
    v_cvt_pk_bf16_f32 v44, v42, v43
    v_lshlrev_b32 v42, 16, v44
    v_mfma_f32_16x16x32_bf16 v[204:207], a[224:227], a[68:71], v[204:207]
    s_min_u32 s46, s46, s77
    v_and_b32 v43, 0xffff0000, v44
    v_mul_f32 v42, v42, v41
    v_mfma_f32_16x16x32_bf16 v[204:207], a[228:231], a[84:87], v[204:207]
    buffer_load_dwordx4 a[112:115], v14, s[20:23], s46 offen offset:0 sc1
    v_mfma_f32_16x16x32_bf16 v[196:199], a[228:231], a[80:83], v[196:199]
    s_waitcnt vmcnt(12) lgkmcnt(0)
    s_barrier
    v_mfma_f32_16x16x32_bf16 v[196:199], a[224:227], a[64:67], v[196:199]
    ds_read_b64_tr_b16 a[224:225], v8 offset:24576
    v_mul_f32 v43, v43, v41
    v_mfma_f32_16x16x32_bf16 v[224:227], a[232:235], a[64:67], v[224:227]
    ds_read_b64_tr_b16 a[226:227], v8 offset:30720
    v_cvt_pk_bf16_f32 v50, v42, v43
    v_mfma_f32_16x16x32_bf16 v[224:227], a[236:239], a[80:83], v[224:227]
    ds_read_b64_tr_b16 a[228:229], v8 offset:36864
    v_lshlrev_b32 v42, 16, v51
    v_mfma_f32_16x16x32_bf16 v[232:235], a[236:239], a[84:87], v[232:235]
    buffer_load_dwordx4 a[116:119], v14, s[20:23], s46 offen offset:1024 sc1
    v_mfma_f32_16x16x32_bf16 v[232:235], a[232:235], a[68:71], v[232:235]
    ds_read_b64_tr_b16 a[230:231], v8 offset:43008
    v_and_b32 v43, 0xffff0000, v51
    v_mfma_f32_16x16x32_bf16 v[240:243], a[232:235], a[72:75], v[240:243]
    v_sub_f32 v42, v42, v40
    v_sub_f32 v43, v43, v40
    v_mfma_f32_16x16x32_bf16 v[240:243], a[236:239], a[88:91], v[240:243]
    v_cvt_pk_bf16_f32 v44, v42, v43
    v_lshlrev_b32 v42, 16, v44
    v_mfma_f32_16x16x32_bf16 v[248:251], a[236:239], a[92:95], v[248:251]
    v_and_b32 v43, 0xffff0000, v44
    v_mul_f32 v42, v42, v41
    v_mfma_f32_16x16x32_bf16 v[248:251], a[232:235], a[76:79], v[248:251]
    ds_read_b64_tr_b16 a[232:233], v9 offset:24576
    v_mul_f32 v43, v43, v41
    v_mfma_f32_16x16x32_bf16 v[252:255], a[240:243], a[76:79], v[252:255]
    ds_read_b64_tr_b16 a[234:235], v9 offset:30720
    v_cvt_pk_bf16_f32 v51, v42, v43
    v_mfma_f32_16x16x32_bf16 v[252:255], a[244:247], a[92:95], v[252:255]
pg_3:
    s_cbranch_execz pg_7
    buffer_load_dwordx4 a[120:123], v15, s[20:23], s46 offen offset:0 sc1
    v_mfma_f32_16x16x32_bf16 v[244:247], a[244:247], a[88:91], v[244:247]
    ds_read_b64_tr_b16 a[236:237], v9 offset:36864
    v_lshlrev_b32 v42, 16, v52
    v_mfma_f32_16x16x32_bf16 v[244:247], a[240:243], a[72:75], v[244:247]
    ds_read_b64_tr_b16 a[238:239], v9 offset:43008
    v_and_b32 v43, 0xffff0000, v52
    v_mfma_f32_16x16x32_bf16 v[236:239], a[240:243], a[68:71], v[236:239]
    v_sub_f32 v42, v42, v40
    v_sub_f32 v43, v43, v40
    v_mfma_f32_16x16x32_bf16 v[236:239], a[244:247], a[84:87], v[236:239]
    s_waitcnt lgkmcnt(4)
    v_cvt_pk_bf16_f32 v44, v42, v43
    v_lshlrev_b32 v42, 16, v44
    v_mfma_f32_16x16x32_bf16 v[228:231], a[244:247], a[80:83], v[228:231]
    v_and_b32 v43, 0xffff0000, v44
    v_mul_f32 v42, v42, v41
    v_mfma_f32_16x16x32_bf16 v[228:231], a[240:243], a[64:67], v[228:231]
    buffer_load_dwordx4 a[124:127], v15, s[20:23], s46 offen offset:1024 sc1
    v_mfma_f32_16x16x32_bf16 v[64:67], a[224:227], a[160:163], v[64:67]
    s_add_u32 s46, s45, 73728
    ds_read_b64_tr_b16 a[240:241], v10 offset:24576
    v_mul_f32 v43, v43, v41
    v_mfma_f32_16x16x32_bf16 v[64:67], a[228:231], a[176:179], v[64:67]
    s_sub_u32 s77, s46, 81920
    ds_read_b64_tr_b16 a[242:243], v10 offset:30720
    v_cvt_pk_bf16_f32 v52, v42, v43
    v_mfma_f32_16x16x32_bf16 v[72:75], a[228:231], a[180:183], v[72:75]
    s_min_u32 s46, s46, s77
    ds_read_b64_tr_b16 a[244:245], v10 offset:36864
    v_lshlrev_b32 v42, 16, v53
    v_mfma_f32_16x16x32_bf16 v[72:75], a[224:227], a[164:167], v[72:75]
    ds_read_b64_tr_b16 a[246:247], v10 offset:43008
    v_and_b32 v43, 0xffff0000, v53
    v_mfma_f32_16x16x32_bf16 v[80:83], a[224:227], a[168:171], v[80:83]
    v_sub_f32 v42, v42, v40
    v_sub_f32 v43, v43, v40
    v_mfma_f32_16x16x32_bf16 v[80:83], a[228:231], a[184:187], v[80:83]
    s_waitcnt lgkmcnt(4)
    v_cvt_pk_bf16_f32 v44, v42, v43
    v_lshlrev_b32 v42, 16, v44
    v_mfma_f32_16x16x32_bf16 v[88:91], a[228:231], a[188:191], v[88:91]
    buffer_load_dwordx4 a[128:131], v14, s[20:23], s46 offen offset:0 sc1
    v_mfma_f32_16x16x32_bf16 v[88:91], a[224:227], a[172:175], v[88:91]
    ds_read_b64_tr_b16 a[224:225], v11 offset:24576
    v_and_b32 v43, 0xffff0000, v44
    v_mfma_f32_16x16x32_bf16 v[92:95], a[232:235], a[172:175], v[92:95]
    ds_read_b64_tr_b16 a[226:227], v11 offset:30720
    v_mul_f32 v42, v42, v41
    v_mfma_f32_16x16x32_bf16 v[92:95], a[236:239], a[188:191], v[92:95]
    ds_read_b64_tr_b16 a[228:229], v11 offset:36864
    v_mul_f32 v43, v43, v41
    v_mfma_f32_16x16x32_bf16 v[84:87], a[236:239], a[184:187], v[84:87]
    ds_read_b64_tr_b16 a[230:231], v11 offset:43008
    v_cvt_pk_bf16_f32 v53, v42, v43
    v_mfma_f32_16x16x32_bf16 v[84:87], a[232:235], a[168:171], v[84:87]
    v_lshlrev_b32 v42, 16, v54
    v_and_b32 v43, 0xffff0000, v54
    v_mfma_f32_16x16x32_bf16 v[76:79], a[232:235], a[164:167], v[76:79]
    buffer_load_dwordx4 a[132:135], v14, s[20:23], s46 offen offset:1024 sc1
    v_mfma_f32_16x16x32_bf16 v[76:79], a[236:239], a[180:183], v[76:79]
    s_waitcnt lgkmcnt(4)
    v_sub_f32 v42, v42, v40
    v_sub_f32 v43, v43, v40
    v_mfma_f32_16x16x32_bf16 v[68:71], a[236:239], a[176:179], v[68:71]
    v_cvt_pk_bf16_f32 v44, v42, v43
    v_lshlrev_b32 v42, 16, v44
    v_mfma_f32_16x16x32_bf16 v[68:71], a[232:235], a[160:163], v[68:71]
    ds_read_b64_tr_b16 a[232:233], v8 offset:25600
    v_and_b32 v43, 0xffff0000, v44
    v_mfma_f32_16x16x32_bf16 v[96:99], a[240:243], a[160:163], v[96:99]
    ds_read_b64_tr_b16 a[234:235], v8 offset:31744
    v_mul_f32 v42, v42, v41
    v_mfma_f32_16x16x32_bf16 v[96:99], a[244:247], a[176:179], v[96:99]
    ds_read_b64_tr_b16 a[236:237], v8 offset:37888
    v_mul_f32 v43, v43, v41
    v_mfma_f32_16x16x32_bf16 v[104:107], a[244:247], a[180:183], v[104:107]
    ds_read_b64_tr_b16 a[238:239], v8 offset:44032
    v_cvt_pk_bf16_f32 v54, v42, v43
    v_mfma_f32_16x16x32_bf16 v[104:107], a[240:243], a[164:167], v[104:107]
    buffer_load_dwordx4 a[136:139], v15, s[20:23], s46 offen offset:0 sc1
    v_mfma_f32_16x16x32_bf16 v[112:115], a[240:243], a[168:171], v[112:115]
    v_lshlrev_b32 v42, 16, v55
    v_and_b32 v43, 0xffff0000, v55
    v_mfma_f32_16x16x32_bf16 v[112:115], a[244:247], a[184:187], v[112:115]
    s_waitcnt lgkmcnt(4)
    v_sub_f32 v42, v42, v40
    v_sub_f32 v43, v43, v40
    v_mfma_f32_16x16x32_bf16 v[120:123], a[244:247], a[188:191], v[120:123]
    v_cvt_pk_bf16_f32 v44, v42, v43
    v_lshlrev_b32 v42, 16, v44
    v_mfma_f32_16x16x32_bf16 v[120:123], a[240:243], a[172:175], v[120:123]
    ds_read_b64_tr_b16 a[240:241], v9 offset:25600
    v_and_b32 v43, 0xffff0000, v44
    v_mfma_f32_16x16x32_bf16 v[124:127], a[224:227], a[172:175], v[124:127]
    ds_read_b64_tr_b16 a[242:243], v9 offset:31744
    v_mul_f32 v42, v42, v41
    v_mfma_f32_16x16x32_bf16 v[124:127], a[228:231], a[188:191], v[124:127]
    buffer_load_dwordx4 a[140:143], v15, s[20:23], s46 offen offset:1024 sc1
    v_mfma_f32_16x16x32_bf16 v[116:119], a[228:231], a[184:187], v[116:119]
    s_add_u32 s46, s45, 77824
    ds_read_b64_tr_b16 a[244:245], v9 offset:37888
    v_mul_f32 v43, v43, v41
    v_mfma_f32_16x16x32_bf16 v[116:119], a[224:227], a[168:171], v[116:119]
    s_sub_u32 s77, s46, 81920
    ds_read_b64_tr_b16 a[246:247], v9 offset:44032
    v_cvt_pk_bf16_f32 v55, v42, v43
    v_mfma_f32_16x16x32_bf16 v[108:111], a[224:227], a[164:167], v[108:111]
    s_min_u32 s46, s46, s77
    v_mfma_f32_16x16x32_bf16 v[108:111], a[228:231], a[180:183], v[108:111]
    s_waitcnt lgkmcnt(4)
    v_mfma_f32_16x16x32_bf16 v[100:103], a[228:231], a[176:179], v[100:103]
    v_mfma_f32_16x16x32_bf16 v[100:103], a[224:227], a[160:163], v[100:103]
    ds_read_b64_tr_b16 a[224:225], v10 offset:25600
    v_mfma_f32_16x16x32_bf16 v[128:131], a[232:235], a[160:163], v[128:131]
    buffer_load_dwordx4 a[144:147], v14, s[20:23], s46 offen offset:0 sc1
    v_mfma_f32_16x16x32_bf16 v[128:131], a[236:239], a[176:179], v[128:131]
    ds_read_b64_tr_b16 a[226:227], v10 offset:31744
    v_mfma_f32_16x16x32_bf16 v[136:139], a[236:239], a[180:183], v[136:139]
    ds_read_b64_tr_b16 a[228:229], v10 offset:37888
    v_mfma_f32_16x16x32_bf16 v[136:139], a[232:235], a[164:167], v[136:139]
    ds_read_b64_tr_b16 a[230:231], v10 offset:44032
    v_mfma_f32_16x16x32_bf16 v[144:147], a[232:235], a[168:171], v[144:147]
    v_mfma_f32_16x16x32_bf16 v[144:147], a[236:239], a[184:187], v[144:147]
    s_waitcnt lgkmcnt(4)
    v_mfma_f32_16x16x32_bf16 v[152:155], a[236:239], a[188:191], v[152:155]
    buffer_load_dwordx4 a[148:151], v14, s[20:23], s46 offen offset:1024 sc1
    v_mfma_f32_16x16x32_bf16 v[152:155], a[232:235], a[172:175], v[152:155]
    ds_read_b64_tr_b16 a[232:233], v11 offset:25600
    v_mfma_f32_16x16x32_bf16 v[156:159], a[240:243], a[172:175], v[156:159]
    ds_read_b64_tr_b16 a[234:235], v11 offset:31744
    v_mfma_f32_16x16x32_bf16 v[156:159], a[244:247], a[188:191], v[156:159]
    ds_read_b64_tr_b16 a[236:237], v11 offset:37888
    v_mfma_f32_16x16x32_bf16 v[148:151], a[244:247], a[184:187], v[148:151]
    ds_read_b64_tr_b16 a[238:239], v11 offset:44032
    v_mfma_f32_16x16x32_bf16 v[148:151], a[240:243], a[168:171], v[148:151]
    v_mfma_f32_16x16x32_bf16 v[140:143], a[240:243], a[164:167], v[140:143]
    v_mfma_f32_16x16x32_bf16 v[140:143], a[244:247], a[180:183], v[140:143]
    buffer_load_dwordx4 a[152:155], v15, s[20:23], s46 offen offset:0 sc1
    v_mfma_f32_16x16x32_bf16 v[132:135], a[244:247], a[176:179], v[132:135]
    s_waitcnt lgkmcnt(3)
    v_mfma_f32_16x16x32_bf16 v[132:135], a[240:243], a[160:163], v[132:135]
    ds_read_b64_tr_b16 a[240:241], v8 offset:26624
    v_mfma_f32_16x16x32_bf16 v[160:163], a[224:227], a[160:163], v[160:163]
    ds_read_b64_tr_b16 a[242:243], v8 offset:32768
    v_mfma_f32_16x16x32_bf16 v[160:163], a[228:231], a[176:179], v[160:163]
    ds_read_b64_tr_b16 a[244:245], v8 offset:38912
    v_mfma_f32_16x16x32_bf16 v[168:171], a[228:231], a[180:183], v[168:171]
    ds_read_b64_tr_b16 a[246:247], v8 offset:45056
    v_mfma_f32_16x16x32_bf16 v[168:171], a[224:227], a[164:167], v[168:171]
    buffer_load_dwordx4 a[156:159], v15, s[20:23], s46 offen offset:1024 sc1
    v_mfma_f32_16x16x32_bf16 v[176:179], a[224:227], a[168:171], v[176:179]
    s_add_u32 m0, s49, 0
    ds_read_b64_tr_b16 v[32:33], v25 offset:0
    v_mfma_f32_16x16x32_bf16 v[176:179], a[228:231], a[184:187], v[176:179]
    s_waitcnt lgkmcnt(5)
    ds_read_b64_tr_b16 v[34:35], v25 offset:4096
    v_mfma_f32_16x16x32_bf16 v[184:187], a[228:231], a[188:191], v[184:187]
    ds_read_b64_tr_b16 v[36:37], v25 offset:1024
    v_mfma_f32_16x16x32_bf16 v[184:187], a[224:227], a[172:175], v[184:187]
    ds_read_b64_tr_b16 v[38:39], v25 offset:5120
    v_mfma_f32_16x16x32_bf16 v[188:191], a[232:235], a[172:175], v[188:191]
    ds_read_b64_tr_b16 v[40:41], v25 offset:8192
    v_mfma_f32_16x16x32_bf16 v[188:191], a[236:239], a[188:191], v[188:191]
    ds_read_b64_tr_b16 v[42:43], v25 offset:12288
    v_mfma_f32_16x16x32_bf16 v[180:183], a[236:239], a[184:187], v[180:183]
    buffer_load_dwordx4 v4, s[12:15], s38 offen offset:0 lds
    v_mfma_f32_16x16x32_bf16 v[180:183], a[232:235], a[168:171], v[180:183]
    s_add_u32 m0, s49, 896
    ds_read_b64_tr_b16 v[44:45], v25 offset:9216
    v_mfma_f32_16x16x32_bf16 v[172:175], a[232:235], a[164:167], v[172:175]
    s_waitcnt lgkmcnt(5)
    ds_read_b64_tr_b16 v[46:47], v25 offset:13312
    ds_read_b64_tr_b16 a[224:225], v9 offset:26624
    v_mfma_f32_16x16x32_bf16 v[172:175], a[236:239], a[180:183], v[172:175]
    ds_read_b64_tr_b16 a[226:227], v9 offset:32768
    v_mfma_f32_16x16x32_bf16 v[164:167], a[236:239], a[176:179], v[164:167]
    ds_read_b64_tr_b16 a[228:229], v9 offset:38912
    v_mfma_f32_16x16x32_bf16 v[164:167], a[232:235], a[160:163], v[164:167]
    ds_read_b64_tr_b16 a[230:231], v9 offset:45056
    v_mfma_f32_16x16x32_bf16 v[192:195], a[240:243], a[160:163], v[192:195]
    ds_read_b64_tr_b16 a[232:233], v10 offset:26624
    v_mfma_f32_16x16x32_bf16 v[192:195], a[244:247], a[176:179], v[192:195]
    s_waitcnt lgkmcnt(7)
    ds_read_b64_tr_b16 a[234:235], v10 offset:32768
    v_mfma_f32_16x16x32_bf16 v[200:203], a[244:247], a[180:183], v[200:203]
    ds_read_b64_tr_b16 a[236:237], v10 offset:38912
    v_mfma_f32_16x16x32_bf16 v[200:203], a[240:243], a[164:167], v[200:203]
    ds_read_b64_tr_b16 a[238:239], v10 offset:45056
    v_mfma_f32_16x16x32_bf16 v[208:211], a[240:243], a[168:171], v[208:211]
    buffer_load_dwordx4 v4, s[12:15], s38 offen offset:128 lds
    v_mfma_f32_16x16x32_bf16 v[208:211], a[244:247], a[184:187], v[208:211]
    s_waitcnt lgkmcnt(5)
    v_add_u32 v8, 49152, v8
    s_add_u32 m0, s49, 1792
    v_mfma_f32_16x16x32_bf16 v[216:219], a[244:247], a[188:191], v[216:219]
    s_waitcnt lgkmcnt(4)
    v_add_u32 v9, 49152, v9
    v_mfma_f32_16x16x32_bf16 v[216:219], a[240:243], a[172:175], v[216:219]
    ds_read_b64_tr_b16 a[240:241], v11 offset:26624
    ds_read_b64_tr_b16 a[242:243], v11 offset:32768
    ds_read_b64_tr_b16 a[244:245], v11 offset:38912
    v_mfma_f32_16x16x32_bf16 v[220:223], a[224:227], a[172:175], v[220:223]
    ds_read_b64_tr_b16 a[246:247], v11 offset:45056
    v_mfma_f32_16x16x32_bf16 v[220:223], a[228:231], a[188:191], v[220:223]
    buffer_load_dwordx4 v4, s[12:15], s38 offen offset:256 lds
    v_mfma_f32_16x16x32_bf16 v[212:215], a[228:231], a[184:187], v[212:215]
    s_add_u32 m0, s49, 3072
    v_add_u32 v10, 49152, v10
    v_mfma_f32_16x16x32_bf16 v[212:215], a[224:227], a[168:171], v[212:215]
    v_add_u32 v11, 49152, v11
    v_mfma_f32_16x16x32_bf16 v[204:207], a[224:227], a[164:167], v[204:207]
    v_mfma_f32_16x16x32_bf16 v[204:207], a[228:231], a[180:183], v[204:207]
    buffer_load_dwordx4 v5, s[12:15], s38 offen offset:0 lds
    v_mfma_f32_16x16x32_bf16 v[196:199], a[228:231], a[176:179], v[196:199]
    s_waitcnt vmcnt(16) lgkmcnt(0)
    s_barrier
    v_mfma_f32_16x16x32_bf16 v[196:199], a[224:227], a[160:163], v[196:199]
    s_add_u32 m0, s49, 3968
    ds_read_b64_tr_b16 a[224:225], v8 offset:0
    v_mfma_f32_16x16x32_bf16 v[224:227], a[232:235], a[160:163], v[224:227]
    ds_read_b64_tr_b16 a[226:227], v8 offset:6144
    v_mfma_f32_16x16x32_bf16 v[224:227], a[236:239], a[176:179], v[224:227]
    ds_read_b64_tr_b16 a[228:229], v8 offset:12288
    v_mfma_f32_16x16x32_bf16 v[232:235], a[236:239], a[180:183], v[232:235]
    ds_read_b64_tr_b16 a[230:231], v8 offset:18432
    v_mfma_f32_16x16x32_bf16 v[232:235], a[232:235], a[164:167], v[232:235]
    v_mfma_f32_16x16x32_bf16 v[240:243], a[232:235], a[168:171], v[240:243]
    buffer_load_dwordx4 v5, s[12:15], s38 offen offset:128 lds
    v_mfma_f32_16x16x32_bf16 v[240:243], a[236:239], a[184:187], v[240:243]
    s_add_u32 m0, s49, 4864
    v_mfma_f32_16x16x32_bf16 v[248:251], a[236:239], a[188:191], v[248:251]
    v_mfma_f32_16x16x32_bf16 v[248:251], a[232:235], a[172:175], v[248:251]
    ds_read_b64_tr_b16 a[232:233], v8 offset:24576
    v_mfma_f32_16x16x32_bf16 v[20:23], v[48:51], v[32:35], 0
    ds_read_b64_tr_b16 a[234:235], v8 offset:30720
    v_mfma_f32_16x16x32_bf16 v[58:61], v[48:51], v[36:39], 0
    ds_read_b64_tr_b16 a[236:237], v8 offset:36864
    v_mfma_f32_16x16x32_bf16 v[20:23], v[52:55], v[40:43], v[20:23]
    buffer_load_dwordx4 v5, s[12:15], s38 offen offset:256 lds
    v_mfma_f32_16x16x32_bf16 v[58:61], v[52:55], v[44:47], v[58:61]
    s_add_u32 s38, s38, 24576
    ds_read_b64_tr_b16 a[238:239], v8 offset:43008
    s_add_u32 m0, s49, 24576
    v_mfma_f32_16x16x32_bf16 v[252:255], a[240:243], a[172:175], v[252:255]
    s_mul_i32 s56, s53, 983040
    v_lshlrev_b32 v14, 4, v1
    v_min_u32 v15, 1, v1
    v_mfma_f32_16x16x32_bf16 v[252:255], a[244:247], a[188:191], v[252:255]
    s_mul_i32 s57, s51, 320
    v_mov_b32 v22, v58
    v_mov_b32 v23, v59
    v_mfma_f32_16x16x32_bf16 v[244:247], a[244:247], a[184:187], v[244:247]
    buffer_store_dwordx4 v[20:23], v26, s[24:27], s62 offen sc1
    v_mov_b32 v26, s7
    v_mfma_f32_16x16x32_bf16 v[244:247], a[240:243], a[168:171], v[244:247]
    s_add_u32 s56, s56, s57
    v_lshrrev_b32 v21, 3, v1
    v_mul_u32_u24 v21, 1280, v21
    v_mfma_f32_16x16x32_bf16 v[236:239], a[240:243], a[164:167], v[236:239]
    s_sub_u32 s57, 7864320, s56
    v_and_b32 v22, 16, v1
    v_lshlrev_b32 v22, 1, v22
    v_mfma_f32_16x16x32_bf16 v[236:239], a[244:247], a[180:183], v[236:239]
    buffer_load_dwordx4 v4, s[12:15], s38 offen offset:0 lds
    v_mfma_f32_16x16x32_bf16 v[228:231], a[244:247], a[176:179], v[228:231]
    s_waitcnt vmcnt(19) lgkmcnt(0)
    v_lshlrev_b32 v15, 30, v15
    v_and_b32 v20, 1, v1
    v_mfma_f32_16x16x32_bf16 v[228:231], a[240:243], a[160:163], v[228:231]
    s_waitcnt vmcnt(18)
    ds_read_b64_tr_b16 a[240:241], v9 offset:0
    v_mul_u32_u24 v20, 0xaaaa, v20
    v_mfma_f32_16x16x32_bf16 v[64:67], a[224:227], a[96:99], v[64:67]
    s_add_u32 m0, s49, 25472
    ds_read_b64_tr_b16 a[242:243], v9 offset:6144
    v_add_u32 v20, 0x4444, v20
    v_mfma_f32_16x16x32_bf16 v[64:67], a[228:231], a[112:115], v[64:67]
    s_add_u32 s8, s72, s56
    s_addc_u32 s9, s73, 0
    s_and_b32 s9, s9, 0xffff
    v_mfma_f32_16x16x32_bf16 v[72:75], a[228:231], a[116:119], v[72:75]
    s_waitcnt vmcnt(17)
    ds_read_b64_tr_b16 a[244:245], v9 offset:12288
    s_mov_b32 s10, s57
    v_mfma_f32_16x16x32_bf16 v[72:75], a[224:227], a[100:103], v[72:75]
    buffer_load_dwordx4 v4, s[12:15], s38 offen offset:128 lds
    v_mfma_f32_16x16x32_bf16 v[80:83], a[224:227], a[104:107], v[80:83]
    s_waitcnt vmcnt(17)
    ds_read_b64_tr_b16 a[246:247], v9 offset:18432
    s_add_u32 m0, s49, 26368
    v_mfma_f32_16x16x32_bf16 v[80:83], a[228:231], a[120:123], v[80:83]
    s_waitcnt vmcnt(13)
    s_mov_b32 s11, 0x00020000
    s_mul_i32 s56, s53, 983040
    v_mfma_f32_16x16x32_bf16 v[88:91], a[228:231], a[124:127], v[88:91]
    s_waitcnt vmcnt(9)
    s_mov_b32 s34, 983040
    s_mov_b32 s35, 0x00020000
    v_mfma_f32_16x16x32_bf16 v[88:91], a[224:227], a[108:111], v[88:91]
    s_add_u32 s32, s72, s56
    s_addc_u32 s33, s73, 0
    s_and_b32 s33, s33, 0xffff
    v_mfma_f32_16x16x32_bf16 v[88:91], a[232:235], a[140:143], v[88:91]
    s_mul_i32 s56, s53, 3145728
    ds_read_b64_tr_b16 a[224:225], v9 offset:24576
    s_add_u32 s56, s56, 16777216
    v_mfma_f32_16x16x32_bf16 v[88:91], a[236:239], a[156:159], v[88:91]
    s_add_u32 s20, s86, s56
    s_addc_u32 s21, s87, 0
    s_and_b32 s21, s21, 0xffff
    v_mfma_f32_16x16x32_bf16 v[80:83], a[236:239], a[152:155], v[80:83]
    buffer_load_dwordx4 v4, s[12:15], s38 offen offset:256 lds
    v_mfma_f32_16x16x32_bf16 v[80:83], a[232:235], a[136:139], v[80:83]
    s_add_u32 m0, s49, 27648
    ds_read_b64_tr_b16 a[226:227], v9 offset:30720
    v_cvt_pk_bf16_f32 v88, v88, v89
    v_mfma_f32_16x16x32_bf16 v[72:75], a[232:235], a[132:135], v[72:75]
    s_mov_b32 s22, 3145728
    ds_read_b64_tr_b16 a[228:229], v9 offset:36864
    v_cvt_pk_bf16_f32 v89, v90, v91
    v_mfma_f32_16x16x32_bf16 v[72:75], a[236:239], a[148:151], v[72:75]
    s_waitcnt lgkmcnt(3)
    ds_read_b64_tr_b16 a[230:231], v9 offset:43008
    v_cvt_pk_bf16_f32 v80, v80, v81
    v_mfma_f32_16x16x32_bf16 v[64:67], a[236:239], a[144:147], v[64:67]
    s_mov_b32 s23, 0x00020000
    v_cvt_pk_bf16_f32 v81, v82, v83
    s_lshl_b32 s55, s51, 5
    v_mfma_f32_16x16x32_bf16 v[64:67], a[232:235], a[128:131], v[64:67]
    s_add_u32 s55, s55, s54
    ds_read_b64_tr_b16 a[232:233], v10 offset:0
    v_cvt_pk_bf16_f32 v72, v72, v73
    v_mfma_f32_16x16x32_bf16 v[68:71], a[240:243], a[96:99], v[68:71]
    buffer_load_dwordx4 v5, s[12:15], s38 offen offset:0 lds
    v_mfma_f32_16x16x32_bf16 v[68:71], a[244:247], a[112:115], v[68:71]
    s_add_u32 m0, s49, 28544
    ds_read_b64_tr_b16 a[234:235], v10 offset:6144
    v_cvt_pk_bf16_f32 v64, v64, v65
    v_mfma_f32_16x16x32_bf16 v[76:79], a[244:247], a[116:119], v[76:79]
    s_mul_i32 s55, s55, 24576
    ds_read_b64_tr_b16 a[236:237], v10 offset:12288
    v_cvt_pk_bf16_f32 v65, v66, v67
    v_mfma_f32_16x16x32_bf16 v[76:79], a[240:243], a[100:103], v[76:79]
    s_lshr_b32 s50, s53, 1
    ds_read_b64_tr_b16 a[238:239], v10 offset:18432
    v_cvt_pk_bf16_f32 v73, v74, v75
    v_mfma_f32_16x16x32_bf16 v[84:87], a[240:243], a[104:107], v[84:87]
    s_add_u32 s56, s51, 0
    s_and_b32 s56, s56, 3
    s_mul_i32 s44, s56, 245760
    v_mfma_f32_16x16x32_bf16 v[84:87], a[244:247], a[120:123], v[84:87]
    s_waitcnt lgkmcnt(4)
    s_add_u32 s56, s51, 1
    s_and_b32 s56, s56, 3
    v_mfma_f32_16x16x32_bf16 v[92:95], a[244:247], a[124:127], v[92:95]
    s_mul_i32 s45, s56, 245760
    s_lshl_b32 s56, s56, 5
    s_add_u32 s56, s56, s54
    v_mfma_f32_16x16x32_bf16 v[92:95], a[240:243], a[108:111], v[92:95]
    buffer_load_dwordx4 v5, s[12:15], s38 offen offset:128 lds
    v_mfma_f32_16x16x32_bf16 v[92:95], a[224:227], a[140:143], v[92:95]
    s_add_u32 m0, s49, 29440
    ds_read_b64_tr_b16 a[240:241], v10 offset:24576
    s_mul_i32 s59, s56, 24576
    v_mfma_f32_16x16x32_bf16 v[92:95], a[228:231], a[156:159], v[92:95]
    s_add_u32 s56, s51, 2
    ds_read_b64_tr_b16 a[242:243], v10 offset:30720
    s_and_b32 s56, s56, 3
    v_mfma_f32_16x16x32_bf16 v[84:87], a[228:231], a[152:155], v[84:87]
    s_mul_i32 s46, s56, 245760
    ds_read_b64_tr_b16 a[244:245], v10 offset:36864
    s_lshl_b32 s56, s56, 5
    v_mfma_f32_16x16x32_bf16 v[84:87], a[224:227], a[136:139], v[84:87]
    s_add_u32 s56, s56, s54
    ds_read_b64_tr_b16 a[246:247], v10 offset:43008
    v_cvt_pk_bf16_f32 v90, v92, v93
    v_mfma_f32_16x16x32_bf16 v[76:79], a[224:227], a[132:135], v[76:79]
    s_add_u32 s39, s40, 0
    v_permlane16_swap_b32 v88, v90
    v_mfma_f32_16x16x32_bf16 v[76:79], a[228:231], a[148:151], v[76:79]
    buffer_load_dwordx4 v5, s[12:15], s38 offen offset:256 lds
    v_mfma_f32_16x16x32_bf16 v[68:71], a[228:231], a[144:147], v[68:71]
    s_waitcnt lgkmcnt(4)
    v_cvt_pk_bf16_f32 v82, v84, v85
    v_cvt_pk_bf16_f32 v83, v86, v87
    v_mfma_f32_16x16x32_bf16 v[68:71], a[224:227], a[128:131], v[68:71]
    s_add_u32 s38, s38, 24576
    ds_read_b64_tr_b16 a[224:225], v11 offset:0
    v_cvt_pk_bf16_f32 v74, v76, v77
    v_mfma_f32_16x16x32_bf16 v[96:99], a[232:235], a[96:99], v[96:99]
    s_add_u32 m0, s63, 73728
    ds_read_b64_tr_b16 a[226:227], v11 offset:6144
    v_cvt_pk_bf16_f32 v75, v78, v79
    v_mfma_f32_16x16x32_bf16 v[96:99], a[236:239], a[112:115], v[96:99]
    s_mul_i32 s60, s56, 24576
    ds_read_b64_tr_b16 a[228:229], v11 offset:12288
    v_cvt_pk_bf16_f32 v66, v68, v69
    v_mfma_f32_16x16x32_bf16 v[104:107], a[236:239], a[116:119], v[104:107]
    s_add_u32 s56, s51, 3
    ds_read_b64_tr_b16 a[230:231], v11 offset:18432
    v_cvt_pk_bf16_f32 v67, v70, v71
    v_mfma_f32_16x16x32_bf16 v[104:107], a[232:235], a[100:103], v[104:107]
    s_and_b32 s56, s56, 3
    v_permlane16_swap_b32 v64, v66
    v_mfma_f32_16x16x32_bf16 v[112:115], a[232:235], a[104:107], v[112:115]
    buffer_load_dwordx4 v6, s[16:19], s39 offen lds
    v_mfma_f32_16x16x32_bf16 v[112:115], a[236:239], a[120:123], v[112:115]
    s_waitcnt lgkmcnt(4)
    v_permlane16_swap_b32 v65, v67
    v_mfma_f32_16x16x32_bf16 v[120:123], a[236:239], a[124:127], v[120:123]
    s_add_u32 s39, s40, 12288
    v_permlane16_swap_b32 v72, v74
    v_mfma_f32_16x16x32_bf16 v[120:123], a[232:235], a[108:111], v[120:123]
    s_add_u32 m0, s63, 77824
    ds_read_b64_tr_b16 a[232:233], v11 offset:24576
    v_accvgpr_write_b32 a0, v64
    v_mfma_f32_16x16x32_bf16 v[120:123], a[240:243], a[140:143], v[120:123]
    s_mul_i32 s47, s56, 245760
    ds_read_b64_tr_b16 a[234:235], v11 offset:30720
    v_accvgpr_write_b32 a1, v65
    v_mfma_f32_16x16x32_bf16 v[120:123], a[244:247], a[156:159], v[120:123]
    s_lshl_b32 s56, s56, 5
    ds_read_b64_tr_b16 a[236:237], v11 offset:36864
    v_accvgpr_write_b32 a2, v66
    v_mfma_f32_16x16x32_bf16 v[112:115], a[244:247], a[152:155], v[112:115]
    buffer_load_dwordx4 v6, s[16:19], s39 offen lds
    v_mfma_f32_16x16x32_bf16 v[112:115], a[240:243], a[136:139], v[112:115]
    s_add_u32 s39, s40, 24576
    ds_read_b64_tr_b16 a[238:239], v11 offset:43008
    v_accvgpr_write_b32 a3, v67
    v_mfma_f32_16x16x32_bf16 v[104:107], a[240:243], a[132:135], v[104:107]
    s_add_u32 m0, s63, 81920
    v_permlane16_swap_b32 v73, v75
    v_mfma_f32_16x16x32_bf16 v[104:107], a[244:247], a[148:151], v[104:107]
    s_waitcnt lgkmcnt(4)
    v_permlane16_swap_b32 v80, v82
    v_mfma_f32_16x16x32_bf16 v[96:99], a[244:247], a[144:147], v[96:99]
    s_add_u32 s56, s56, s54
    v_permlane16_swap_b32 v81, v83
    v_mfma_f32_16x16x32_bf16 v[96:99], a[240:243], a[128:131], v[96:99]
    s_mul_i32 s61, s56, 24576
    ds_read_b64_tr_b16 a[240:241], v8 offset:1024
    v_cvt_pk_bf16_f32 v91, v94, v95
    v_mfma_f32_16x16x32_bf16 v[100:103], a[224:227], a[96:99], v[100:103]
    s_mov_b32 s72, s7
    ds_read_b64_tr_b16 a[242:243], v8 offset:7168
    v_accvgpr_write_b32 a4, v72
    v_mfma_f32_16x16x32_bf16 v[100:103], a[228:231], a[112:115], v[100:103]
    buffer_load_dwordx4 v6, s[16:19], s39 offen lds
    v_mfma_f32_16x16x32_bf16 v[108:111], a[228:231], a[116:119], v[108:111]
    s_add_u32 s39, s40, 36864
    ds_read_b64_tr_b16 a[244:245], v8 offset:13312
    v_accvgpr_write_b32 a5, v73
    v_mfma_f32_16x16x32_bf16 v[108:111], a[224:227], a[100:103], v[108:111]
    s_add_u32 m0, s63, 86016
    ds_read_b64_tr_b16 a[246:247], v8 offset:19456
    v_accvgpr_write_b32 a6, v74
    v_mfma_f32_16x16x32_bf16 v[116:119], a[224:227], a[104:107], v[116:119]
    s_mov_b32 s73, s7
    v_permlane16_swap_b32 v89, v91
    v_mfma_f32_16x16x32_bf16 v[116:119], a[228:231], a[120:123], v[116:119]
    s_waitcnt lgkmcnt(4)
    v_accvgpr_write_b32 a7, v75
    v_accvgpr_write_b32 a8, v80
    v_mfma_f32_16x16x32_bf16 v[124:127], a[228:231], a[124:127], v[124:127]
    s_mov_b32 s74, s7
    v_accvgpr_write_b32 a9, v81
    v_accvgpr_write_b32 a10, v82
    v_mfma_f32_16x16x32_bf16 v[124:127], a[224:227], a[108:111], v[124:127]
    buffer_load_dwordx4 v6, s[16:19], s39 offen lds
    v_mfma_f32_16x16x32_bf16 v[124:127], a[232:235], a[140:143], v[124:127]
    s_mov_b32 s75, s7
    ds_read_b64_tr_b16 a[224:225], v8 offset:25600
    v_accvgpr_write_b32 a11, v83
    v_mfma_f32_16x16x32_bf16 v[124:127], a[236:239], a[156:159], v[124:127]
    s_lshl_b32 s56, s50, 6
    ds_read_b64_tr_b16 a[226:227], v8 offset:31744
    v_accvgpr_write_b32 a12, v88
    v_mfma_f32_16x16x32_bf16 v[116:119], a[236:239], a[152:155], v[116:119]
    s_xor_b32 s56, s56, 192
    ds_read_b64_tr_b16 a[228:229], v8 offset:37888
    v_xor_b32 v2, s56, v7
    v_mfma_f32_16x16x32_bf16 v[116:119], a[232:235], a[136:139], v[116:119]
    s_and_b32 s56, s51, 1
    ds_read_b64_tr_b16 a[230:231], v8 offset:44032
    v_xor_b32 v3, 128, v2
    v_mfma_f32_16x16x32_bf16 v[108:111], a[232:235], a[132:135], v[108:111]
    s_lshl_b32 s56, s56, 6
    v_accvgpr_write_b32 a13, v89
    v_accvgpr_write_b32 a14, v90
    v_mfma_f32_16x16x32_bf16 v[108:111], a[236:239], a[148:151], v[108:111]
    s_waitcnt lgkmcnt(4)
    v_accvgpr_write_b32 a15, v91
    v_cvt_pk_bf16_f32 v96, v96, v97
    v_mfma_f32_16x16x32_bf16 v[100:103], a[236:239], a[144:147], v[100:103]
    s_mul_i32 s57, s3, 10240
    v_cvt_pk_bf16_f32 v97, v98, v99
    v_cvt_pk_bf16_f32 v104, v104, v105
    v_mfma_f32_16x16x32_bf16 v[100:103], a[232:235], a[128:131], v[100:103]
    s_add_u32 s56, s56, s57
    ds_read_b64_tr_b16 a[232:233], v9 offset:1024
    v_add_u32 v21, s56, v21
    v_mfma_f32_16x16x32_bf16 v[128:131], a[240:243], a[96:99], v[128:131]
    s_and_b32 s56, s51, 1
    ds_read_b64_tr_b16 a[234:235], v9 offset:7168
    v_add_u32 v2, v2, v21
    v_mfma_f32_16x16x32_bf16 v[128:131], a[244:247], a[112:115], v[128:131]
    s_xor_b32 s56, s56, 1
    ds_read_b64_tr_b16 a[236:237], v9 offset:13312
    v_add_u32 v3, v3, v21
    v_mfma_f32_16x16x32_bf16 v[136:139], a[244:247], a[116:119], v[136:139]
    s_lshl_b32 s56, s56, 8
    ds_read_b64_tr_b16 a[238:239], v9 offset:19456
    v_and_b32 v21, 3, v1
    v_mfma_f32_16x16x32_bf16 v[136:139], a[240:243], a[100:103], v[136:139]
    s_and_b32 s57, s3, 1
    v_lshlrev_b32 v21, 4, v21
    v_xor_b32 v21, v21, v22
    v_mfma_f32_16x16x32_bf16 v[144:147], a[240:243], a[104:107], v[144:147]
    s_mul_i32 s57, s57, 20480
    v_lshrrev_b32 v22, 2, v1
    v_mul_u32_u24 v22, 1280, v22
    v_mfma_f32_16x16x32_bf16 v[144:147], a[244:247], a[120:123], v[144:147]
    s_waitcnt lgkmcnt(4)
    v_add_u32 v21, v21, v22
    v_min_u32 v22, 11, v1
    v_mfma_f32_16x16x32_bf16 v[152:155], a[244:247], a[124:127], v[152:155]
    s_add_u32 s56, s56, s57
    v_add_u32 v7, s56, v21
    v_mov_b32 v21, 0x3f803f80
    v_mfma_f32_16x16x32_bf16 v[152:155], a[240:243], a[108:111], v[152:155]
    s_lshr_b32 s42, s2, 3
    ds_read_b64_tr_b16 a[240:241], v9 offset:25600
    v_accvgpr_write_b32 a248, v21
    v_mfma_f32_16x16x32_bf16 v[152:155], a[224:227], a[140:143], v[152:155]
    s_lshl_b32 s42, s42, 2
    ds_read_b64_tr_b16 a[242:243], v9 offset:31744
    v_accvgpr_write_b32 a249, v21
    v_mfma_f32_16x16x32_bf16 v[152:155], a[228:231], a[156:159], v[152:155]
    s_add_u32 s42, s42, s3
    ds_read_b64_tr_b16 a[244:245], v9 offset:37888
    v_accvgpr_write_b32 a250, v21
    v_mfma_f32_16x16x32_bf16 v[144:147], a[228:231], a[152:155], v[144:147]
    s_mul_i32 s42, s42, 7680
    ds_read_b64_tr_b16 a[246:247], v9 offset:44032
    v_accvgpr_write_b32 a251, v21
    v_mfma_f32_16x16x32_bf16 v[144:147], a[224:227], a[136:139], v[144:147]
    v_lshlrev_b32 v22, 7, v22
    v_cvt_pk_bf16_f32 v98, v100, v101
    v_mfma_f32_16x16x32_bf16 v[136:139], a[224:227], a[132:135], v[136:139]
    v_cvt_pk_bf16_f32 v99, v102, v103
    v_cvt_pk_bf16_f32 v105, v106, v107
    v_mfma_f32_16x16x32_bf16 v[136:139], a[228:231], a[148:151], v[136:139]
    s_waitcnt lgkmcnt(4)
    v_permlane16_swap_b32 v96, v98
    v_mfma_f32_16x16x32_bf16 v[128:131], a[228:231], a[144:147], v[128:131]
    v_permlane16_swap_b32 v97, v99
    v_mfma_f32_16x16x32_bf16 v[128:131], a[224:227], a[128:131], v[128:131]
    ds_read_b64_tr_b16 a[224:225], v10 offset:1024
    v_cvt_pk_bf16_f32 v106, v108, v109
    v_mfma_f32_16x16x32_bf16 v[132:135], a[232:235], a[96:99], v[132:135]
    ds_read_b64_tr_b16 a[226:227], v10 offset:7168
    v_cvt_pk_bf16_f32 v107, v110, v111
    v_mfma_f32_16x16x32_bf16 v[132:135], a[236:239], a[112:115], v[132:135]
    ds_read_b64_tr_b16 a[228:229], v10 offset:13312
    v_cvt_pk_bf16_f32 v112, v112, v113
    v_mfma_f32_16x16x32_bf16 v[140:143], a[236:239], a[116:119], v[140:143]
    ds_read_b64_tr_b16 a[230:231], v10 offset:19456
    v_cvt_pk_bf16_f32 v113, v114, v115
    v_mfma_f32_16x16x32_bf16 v[140:143], a[232:235], a[100:103], v[140:143]
    v_permlane16_swap_b32 v104, v106
    v_mfma_f32_16x16x32_bf16 v[148:151], a[232:235], a[104:107], v[148:151]
    s_waitcnt vmcnt(10)
    v_permlane16_swap_b32 v105, v107
    v_mfma_f32_16x16x32_bf16 v[148:151], a[236:239], a[120:123], v[148:151]
    buffer_store_dword v26, v27, s[24:27], s4 offen offset:144 sc1
    v_mfma_f32_16x16x32_bf16 v[156:159], a[236:239], a[124:127], v[156:159]
pg_4:
    s_cbranch_execz pg_8
    s_waitcnt lgkmcnt(3)
    v_cvt_pk_bf16_f32 v114, v116, v117
    v_cvt_pk_bf16_f32 v115, v118, v119
    v_mfma_f32_16x16x32_bf16 v[156:159], a[232:235], a[108:111], v[156:159]
    ds_read_b64_tr_b16 a[232:233], v10 offset:25600
    v_accvgpr_write_b32 a16, v96
    v_mfma_f32_16x16x32_bf16 v[156:159], a[240:243], a[140:143], v[156:159]
    ds_read_b64_tr_b16 a[234:235], v10 offset:31744
    v_accvgpr_write_b32 a17, v97
    v_mfma_f32_16x16x32_bf16 v[156:159], a[244:247], a[156:159], v[156:159]
    ds_read_b64_tr_b16 a[236:237], v10 offset:37888
    v_accvgpr_write_b32 a18, v98
    v_mfma_f32_16x16x32_bf16 v[148:151], a[244:247], a[152:155], v[148:151]
    ds_read_b64_tr_b16 a[238:239], v10 offset:44032
    v_accvgpr_write_b32 a19, v99
    v_mfma_f32_16x16x32_bf16 v[148:151], a[240:243], a[136:139], v[148:151]
    v_permlane16_swap_b32 v112, v114
    v_mfma_f32_16x16x32_bf16 v[140:143], a[240:243], a[132:135], v[140:143]
    v_permlane16_swap_b32 v113, v115
    v_mfma_f32_16x16x32_bf16 v[140:143], a[244:247], a[148:151], v[140:143]
    s_waitcnt lgkmcnt(4)
    v_cvt_pk_bf16_f32 v120, v120, v121
    v_cvt_pk_bf16_f32 v121, v122, v123
    v_mfma_f32_16x16x32_bf16 v[132:135], a[244:247], a[144:147], v[132:135]
    v_cvt_pk_bf16_f32 v122, v124, v125
    v_cvt_pk_bf16_f32 v123, v126, v127
    v_mfma_f32_16x16x32_bf16 v[132:135], a[240:243], a[128:131], v[132:135]
    ds_read_b64_tr_b16 a[240:241], v11 offset:1024
    v_accvgpr_write_b32 a20, v104
    v_mfma_f32_16x16x32_bf16 v[160:163], a[224:227], a[96:99], v[160:163]
    ds_read_b64_tr_b16 a[242:243], v11 offset:7168
    v_accvgpr_write_b32 a21, v105
    v_mfma_f32_16x16x32_bf16 v[160:163], a[228:231], a[112:115], v[160:163]
    ds_read_b64_tr_b16 a[244:245], v11 offset:13312
    v_accvgpr_write_b32 a22, v106
    v_mfma_f32_16x16x32_bf16 v[168:171], a[228:231], a[116:119], v[168:171]
    ds_read_b64_tr_b16 a[246:247], v11 offset:19456
    v_accvgpr_write_b32 a23, v107
    v_mfma_f32_16x16x32_bf16 v[168:171], a[224:227], a[100:103], v[168:171]
    v_permlane16_swap_b32 v120, v122
    v_mfma_f32_16x16x32_bf16 v[176:179], a[224:227], a[104:107], v[176:179]
    v_permlane16_swap_b32 v121, v123
    v_mfma_f32_16x16x32_bf16 v[176:179], a[228:231], a[120:123], v[176:179]
    s_waitcnt lgkmcnt(4)
    v_accvgpr_write_b32 a24, v112
    v_accvgpr_write_b32 a25, v113
    v_mfma_f32_16x16x32_bf16 v[184:187], a[228:231], a[124:127], v[184:187]
    v_accvgpr_write_b32 a26, v114
    v_accvgpr_write_b32 a27, v115
    v_mfma_f32_16x16x32_bf16 v[184:187], a[224:227], a[108:111], v[184:187]
    ds_read_b64_tr_b16 a[224:225], v11 offset:25600
    v_accvgpr_write_b32 a28, v120
    v_mfma_f32_16x16x32_bf16 v[184:187], a[232:235], a[140:143], v[184:187]
    ds_read_b64_tr_b16 a[226:227], v11 offset:31744
    v_accvgpr_write_b32 a29, v121
    v_mfma_f32_16x16x32_bf16 v[184:187], a[236:239], a[156:159], v[184:187]
    ds_read_b64_tr_b16 a[228:229], v11 offset:37888
    v_accvgpr_write_b32 a30, v122
    v_mfma_f32_16x16x32_bf16 v[176:179], a[236:239], a[152:155], v[176:179]
    ds_read_b64_tr_b16 a[230:231], v11 offset:44032
    v_accvgpr_write_b32 a31, v123
    v_mfma_f32_16x16x32_bf16 v[176:179], a[232:235], a[136:139], v[176:179]
    v_cvt_pk_bf16_f32 v128, v128, v129
    v_cvt_pk_bf16_f32 v129, v130, v131
    v_mfma_f32_16x16x32_bf16 v[168:171], a[232:235], a[132:135], v[168:171]
    v_cvt_pk_bf16_f32 v130, v132, v133
    v_cvt_pk_bf16_f32 v131, v134, v135
    v_mfma_f32_16x16x32_bf16 v[168:171], a[236:239], a[148:151], v[168:171]
    s_waitcnt lgkmcnt(4)
    v_permlane16_swap_b32 v128, v130
    v_mfma_f32_16x16x32_bf16 v[160:163], a[236:239], a[144:147], v[160:163]
    v_permlane16_swap_b32 v129, v131
    v_mfma_f32_16x16x32_bf16 v[160:163], a[232:235], a[128:131], v[160:163]
    ds_read_b64_tr_b16 a[232:233], v8 offset:2048
    v_cvt_pk_bf16_f32 v136, v136, v137
    v_mfma_f32_16x16x32_bf16 v[164:167], a[240:243], a[96:99], v[164:167]
    ds_read_b64_tr_b16 a[234:235], v8 offset:8192
    v_cvt_pk_bf16_f32 v137, v138, v139
    v_mfma_f32_16x16x32_bf16 v[164:167], a[244:247], a[112:115], v[164:167]
    ds_read_b64_tr_b16 a[236:237], v8 offset:14336
    v_cvt_pk_bf16_f32 v138, v140, v141
    v_mfma_f32_16x16x32_bf16 v[172:175], a[244:247], a[116:119], v[172:175]
    ds_read_b64_tr_b16 a[238:239], v8 offset:20480
    v_cvt_pk_bf16_f32 v139, v142, v143
    v_mfma_f32_16x16x32_bf16 v[172:175], a[240:243], a[100:103], v[172:175]
    v_permlane16_swap_b32 v136, v138
    v_mfma_f32_16x16x32_bf16 v[180:183], a[240:243], a[104:107], v[180:183]
    v_permlane16_swap_b32 v137, v139
    v_mfma_f32_16x16x32_bf16 v[180:183], a[244:247], a[120:123], v[180:183]
    s_waitcnt lgkmcnt(4)
    v_cvt_pk_bf16_f32 v144, v144, v145
    v_cvt_pk_bf16_f32 v145, v146, v147
    v_mfma_f32_16x16x32_bf16 v[188:191], a[244:247], a[124:127], v[188:191]
    v_cvt_pk_bf16_f32 v146, v148, v149
    v_cvt_pk_bf16_f32 v147, v150, v151
    v_mfma_f32_16x16x32_bf16 v[188:191], a[240:243], a[108:111], v[188:191]
    ds_read_b64_tr_b16 a[240:241], v8 offset:26624
    v_accvgpr_write_b32 a32, v128
    v_mfma_f32_16x16x32_bf16 v[188:191], a[224:227], a[140:143], v[188:191]
    ds_read_b64_tr_b16 a[242:243], v8 offset:32768
    v_accvgpr_write_b32 a33, v129
    v_mfma_f32_16x16x32_bf16 v[188:191], a[228:231], a[156:159], v[188:191]
    ds_read_b64_tr_b16 a[244:245], v8 offset:38912
    v_accvgpr_write_b32 a34, v130
    v_mfma_f32_16x16x32_bf16 v[180:183], a[228:231], a[152:155], v[180:183]
    ds_read_b64_tr_b16 a[246:247], v8 offset:45056
    v_accvgpr_write_b32 a35, v131
    v_mfma_f32_16x16x32_bf16 v[180:183], a[224:227], a[136:139], v[180:183]
    v_permlane16_swap_b32 v144, v146
    v_mfma_f32_16x16x32_bf16 v[172:175], a[224:227], a[132:135], v[172:175]
    s_add_u32 s88, s88, code_end-code0-65536
    s_addc_u32 s89, s89, 0
    v_cvt_pk_bf16_f32 v152, v152, v153
    v_mfma_f32_16x16x32_bf16 v[172:175], a[228:231], a[148:151], v[172:175]
    s_waitcnt lgkmcnt(4)
    v_permlane16_swap_b32 v145, v147
    v_mfma_f32_16x16x32_bf16 v[164:167], a[228:231], a[144:147], v[164:167]
    v_cvt_pk_bf16_f32 v153, v154, v155
    v_cvt_pk_bf16_f32 v154, v156, v157
    v_mfma_f32_16x16x32_bf16 v[164:167], a[224:227], a[128:131], v[164:167]
    ds_read_b64_tr_b16 a[224:225], v9 offset:2048
    v_cvt_pk_bf16_f32 v155, v158, v159
    v_mfma_f32_16x16x32_bf16 v[192:195], a[232:235], a[96:99], v[192:195]
    global_load_dword a252, v18, s[88:89]
    v_mfma_f32_16x16x32_bf16 v[192:195], a[236:239], a[112:115], v[192:195]
    ds_read_b64_tr_b16 a[226:227], v9 offset:8192
    v_accvgpr_write_b32 a36, v136
    v_mfma_f32_16x16x32_bf16 v[200:203], a[236:239], a[116:119], v[200:203]
    ds_read_b64_tr_b16 a[228:229], v9 offset:14336
    v_accvgpr_write_b32 a37, v137
    v_mfma_f32_16x16x32_bf16 v[200:203], a[232:235], a[100:103], v[200:203]
    ds_read_b64_tr_b16 a[230:231], v9 offset:20480
    v_accvgpr_write_b32 a38, v138
    v_mfma_f32_16x16x32_bf16 v[208:211], a[232:235], a[104:107], v[208:211]
    v_permlane16_swap_b32 v152, v154
    v_mfma_f32_16x16x32_bf16 v[208:211], a[236:239], a[120:123], v[208:211]
    s_waitcnt lgkmcnt(4)
    v_permlane16_swap_b32 v153, v155
    v_mfma_f32_16x16x32_bf16 v[216:219], a[236:239], a[124:127], v[216:219]
    v_accvgpr_write_b32 a39, v139
    v_accvgpr_write_b32 a40, v144
    v_mfma_f32_16x16x32_bf16 v[216:219], a[232:235], a[108:111], v[216:219]
    ds_read_b64_tr_b16 a[232:233], v9 offset:26624
    v_accvgpr_write_b32 a41, v145
    v_mfma_f32_16x16x32_bf16 v[216:219], a[240:243], a[140:143], v[216:219]
    ds_read_b64_tr_b16 a[234:235], v9 offset:32768
    v_accvgpr_write_b32 a42, v146
    v_mfma_f32_16x16x32_bf16 v[216:219], a[244:247], a[156:159], v[216:219]
    ds_read_b64_tr_b16 a[236:237], v9 offset:38912
    v_accvgpr_write_b32 a43, v147
    v_mfma_f32_16x16x32_bf16 v[208:211], a[244:247], a[152:155], v[208:211]
    ds_read_b64_tr_b16 a[238:239], v9 offset:45056
    v_accvgpr_write_b32 a44, v152
    v_mfma_f32_16x16x32_bf16 v[208:211], a[240:243], a[136:139], v[208:211]
    v_accvgpr_write_b32 a45, v153
    v_accvgpr_write_b32 a46, v154
    v_mfma_f32_16x16x32_bf16 v[200:203], a[240:243], a[132:135], v[200:203]
    v_accvgpr_write_b32 a47, v155
    v_cvt_pk_bf16_f32 v160, v160, v161
    v_mfma_f32_16x16x32_bf16 v[200:203], a[244:247], a[148:151], v[200:203]
    s_waitcnt lgkmcnt(4)
    v_cvt_pk_bf16_f32 v161, v162, v163
    v_cvt_pk_bf16_f32 v162, v164, v165
    v_mfma_f32_16x16x32_bf16 v[192:195], a[244:247], a[144:147], v[192:195]
    v_cvt_pk_bf16_f32 v163, v166, v167
    v_cvt_pk_bf16_f32 v168, v168, v169
    v_mfma_f32_16x16x32_bf16 v[192:195], a[240:243], a[128:131], v[192:195]
    ds_read_b64_tr_b16 a[240:241], v10 offset:2048
    v_cvt_pk_bf16_f32 v169, v170, v171
    v_mfma_f32_16x16x32_bf16 v[196:199], a[224:227], a[96:99], v[196:199]
    ds_read_b64_tr_b16 a[242:243], v10 offset:8192
    v_cvt_pk_bf16_f32 v170, v172, v173
    v_mfma_f32_16x16x32_bf16 v[196:199], a[228:231], a[112:115], v[196:199]
    ds_read_b64_tr_b16 a[244:245], v10 offset:14336
    v_cvt_pk_bf16_f32 v171, v174, v175
    v_mfma_f32_16x16x32_bf16 v[204:207], a[228:231], a[116:119], v[204:207]
    ds_read_b64_tr_b16 a[246:247], v10 offset:20480
    v_cvt_pk_bf16_f32 v176, v176, v177
    v_mfma_f32_16x16x32_bf16 v[204:207], a[224:227], a[100:103], v[204:207]
    v_permlane16_swap_b32 v160, v162
    v_mfma_f32_16x16x32_bf16 v[212:215], a[224:227], a[104:107], v[212:215]
    v_permlane16_swap_b32 v161, v163
    v_mfma_f32_16x16x32_bf16 v[212:215], a[228:231], a[120:123], v[212:215]
    s_waitcnt lgkmcnt(4)
    v_permlane16_swap_b32 v168, v170
    v_mfma_f32_16x16x32_bf16 v[220:223], a[228:231], a[124:127], v[220:223]
    v_permlane16_swap_b32 v169, v171
    v_mfma_f32_16x16x32_bf16 v[220:223], a[224:227], a[108:111], v[220:223]
    ds_read_b64_tr_b16 a[224:225], v10 offset:26624
    v_cvt_pk_bf16_f32 v177, v178, v179
    v_mfma_f32_16x16x32_bf16 v[220:223], a[232:235], a[140:143], v[220:223]
    ds_read_b64_tr_b16 a[226:227], v10 offset:32768
    v_cvt_pk_bf16_f32 v178, v180, v181
    v_mfma_f32_16x16x32_bf16 v[220:223], a[236:239], a[156:159], v[220:223]
    ds_read_b64_tr_b16 a[228:229], v10 offset:38912
    v_cvt_pk_bf16_f32 v179, v182, v183
    v_mfma_f32_16x16x32_bf16 v[212:215], a[236:239], a[152:155], v[212:215]
    ds_read_b64_tr_b16 a[230:231], v10 offset:45056
    v_accvgpr_write_b32 a48, v160
    v_mfma_f32_16x16x32_bf16 v[212:215], a[232:235], a[136:139], v[212:215]
    v_permlane16_swap_b32 v176, v178
    v_mfma_f32_16x16x32_bf16 v[204:207], a[232:235], a[132:135], v[204:207]
    v_permlane16_swap_b32 v177, v179
    v_mfma_f32_16x16x32_bf16 v[204:207], a[236:239], a[148:151], v[204:207]
    s_waitcnt lgkmcnt(4)
    v_accvgpr_write_b32 a49, v161
    v_accvgpr_write_b32 a50, v162
    v_mfma_f32_16x16x32_bf16 v[196:199], a[236:239], a[144:147], v[196:199]
    v_accvgpr_write_b32 a51, v163
    v_cvt_pk_bf16_f32 v184, v184, v185
    v_mfma_f32_16x16x32_bf16 v[196:199], a[232:235], a[128:131], v[196:199]
    ds_read_b64_tr_b16 a[232:233], v11 offset:2048
    v_cvt_pk_bf16_f32 v185, v186, v187
    ds_read_b64_tr_b16 a[234:235], v11 offset:8192
    v_mfma_f32_16x16x32_bf16 v[224:227], a[240:243], a[96:99], v[224:227]
    ds_read_b64_tr_b16 a[236:237], v11 offset:14336
    v_cvt_pk_bf16_f32 v186, v188, v189
    ds_read_b64_tr_b16 a[238:239], v11 offset:20480
    v_mfma_f32_16x16x32_bf16 v[224:227], a[244:247], a[112:115], v[224:227]
    v_permlane16_swap_b32 v184, v186
    v_mfma_f32_16x16x32_bf16 v[232:235], a[244:247], a[116:119], v[232:235]
    v_cvt_pk_bf16_f32 v187, v190, v191
    v_accvgpr_write_b32 a52, v168
    v_mfma_f32_16x16x32_bf16 v[232:235], a[240:243], a[100:103], v[232:235]
    v_permlane16_swap_b32 v185, v187
    v_mfma_f32_16x16x32_bf16 v[240:243], a[240:243], a[104:107], v[240:243]
    v_accvgpr_write_b32 a53, v169
    v_accvgpr_write_b32 a54, v170
    v_mfma_f32_16x16x32_bf16 v[240:243], a[244:247], a[120:123], v[240:243]
    s_waitcnt lgkmcnt(4)
    v_accvgpr_write_b32 a55, v171
    v_accvgpr_write_b32 a56, v176
    v_mfma_f32_16x16x32_bf16 v[248:251], a[244:247], a[124:127], v[248:251]
    s_waitcnt lgkmcnt(0)
    s_barrier
    v_mfma_f32_16x16x32_bf16 v[248:251], a[240:243], a[108:111], v[248:251]
    s_add_u32 m0, s49, 49152
    ds_read_b128 a[184:187], v12 offset:0
    v_accvgpr_write_b32 a57, v177
    v_mfma_f32_16x16x32_bf16 v[248:251], a[224:227], a[140:143], v[248:251]
    ds_read_b128 a[188:191], v13 offset:0
    v_accvgpr_write_b32 a58, v178
    v_mfma_f32_16x16x32_bf16 v[248:251], a[228:231], a[156:159], v[248:251]
    ds_read_b128 a[192:195], v12 offset:1024
    v_accvgpr_write_b32 a59, v179
    v_mfma_f32_16x16x32_bf16 v[240:243], a[228:231], a[152:155], v[240:243]
    ds_read_b128 a[196:199], v13 offset:1024
    v_accvgpr_write_b32 a60, v184
    v_mfma_f32_16x16x32_bf16 v[240:243], a[224:227], a[136:139], v[240:243]
    ds_read_b128 a[200:203], v12 offset:2048
    v_accvgpr_write_b32 a61, v185
    v_mfma_f32_16x16x32_bf16 v[232:235], a[224:227], a[132:135], v[232:235]
    buffer_load_dwordx4 v4, s[12:15], s38 offen offset:0 lds
    v_mfma_f32_16x16x32_bf16 v[232:235], a[228:231], a[148:151], v[232:235]
    ds_read_b64_tr_b16 a[240:241], v11 offset:26624
    v_accvgpr_write_b32 a62, v186
    v_mfma_f32_16x16x32_bf16 v[224:227], a[228:231], a[144:147], v[224:227]
    ds_read_b64_tr_b16 a[242:243], v11 offset:32768
    v_accvgpr_write_b32 a63, v187
    v_mfma_f32_16x16x32_bf16 v[224:227], a[224:227], a[128:131], v[224:227]
    ds_read_b64_tr_b16 a[244:245], v11 offset:38912
    v_cvt_pk_bf16_f32 v192, v192, v193
    v_mfma_f32_16x16x32_bf16 v[228:231], a[232:235], a[96:99], v[228:231]
    ds_read_b64_tr_b16 a[246:247], v11 offset:45056
    v_cvt_pk_bf16_f32 v193, v194, v195
    v_mfma_f32_16x16x32_bf16 v[228:231], a[236:239], a[112:115], v[228:231]
    v_cvt_pk_bf16_f32 v194, v196, v197
    v_cvt_pk_bf16_f32 v195, v198, v199
    v_mfma_f32_16x16x32_bf16 v[236:239], a[236:239], a[116:119], v[236:239]
    s_add_u32 m0, s49, 50048
    v_permlane16_swap_b32 v192, v194
    v_mfma_f32_16x16x32_bf16 v[236:239], a[232:235], a[100:103], v[236:239]
    v_permlane16_swap_b32 v193, v195
    v_mfma_f32_16x16x32_bf16 v[244:247], a[232:235], a[104:107], v[244:247]
    v_cvt_pk_bf16_f32 v200, v200, v201
    v_cvt_pk_bf16_f32 v201, v202, v203
    v_mfma_f32_16x16x32_bf16 v[244:247], a[236:239], a[120:123], v[244:247]
    s_waitcnt lgkmcnt(2)
    v_cvt_pk_bf16_f32 v202, v204, v205
    v_cvt_pk_bf16_f32 v203, v206, v207
    v_mfma_f32_16x16x32_bf16 v[252:255], a[236:239], a[124:127], v[252:255]
    ds_read_b128 a[204:207], v13 offset:2048
    v_cvt_pk_bf16_f32 v208, v208, v209
    v_mfma_f32_16x16x32_bf16 v[252:255], a[232:235], a[108:111], v[252:255]
    s_waitcnt lgkmcnt(1)
    v_permlane16_swap_b32 v200, v202
    v_mfma_f32_16x16x32_bf16 v[252:255], a[240:243], a[140:143], v[252:255]
    buffer_load_dwordx4 v4, s[12:15], s38 offen offset:128 lds
    v_mfma_f32_16x16x32_bf16 v[252:255], a[244:247], a[156:159], v[252:255]
    v_permlane16_swap_b32 v201, v203
    v_mfma_f32_16x16x32_bf16 v[244:247], a[244:247], a[152:155], v[244:247]
    ds_read_b128 a[208:211], v12 offset:6144
    v_cvt_pk_bf16_f32 v209, v210, v211
    v_mfma_f32_16x16x32_bf16 v[244:247], a[240:243], a[136:139], v[244:247]
    ds_read_b128 a[212:215], v13 offset:6144
    v_cvt_pk_bf16_f32 v210, v212, v213
    v_mfma_f32_16x16x32_bf16 v[236:239], a[240:243], a[132:135], v[236:239]
    ds_read_b128 a[216:219], v12 offset:7168
    v_cvt_pk_bf16_f32 v211, v214, v215
    v_mfma_f32_16x16x32_bf16 v[236:239], a[244:247], a[148:151], v[236:239]
    ds_read_b128 a[220:223], v13 offset:7168
    v_accvgpr_write_b32 a64, v192
    v_mfma_f32_16x16x32_bf16 v[228:231], a[244:247], a[144:147], v[228:231]
    s_add_u32 m0, s49, 50944
    ds_read_b128 a[224:227], v12 offset:8192
    v_accvgpr_write_b32 a65, v193
    v_mfma_f32_16x16x32_bf16 v[228:231], a[240:243], a[128:131], v[228:231]
    ds_read_b128 a[228:231], v13 offset:8192
    v_accvgpr_write_b32 a66, v194
    v_mfma_f32_16x16x32_bf16 v[64:67], a[184:187], a[0:3], 0
    v_permlane16_swap_b32 v208, v210
    v_mfma_f32_16x16x32_bf16 v[64:67], a[188:191], a[16:19], v[64:67]
    v_permlane16_swap_b32 v209, v211
    v_mfma_f32_16x16x32_bf16 v[64:67], a[192:195], a[32:35], v[64:67]
    v_accvgpr_write_b32 a67, v195
    v_cvt_pk_bf16_f32 v216, v216, v217
    v_mfma_f32_16x16x32_bf16 v[64:67], a[196:199], a[48:51], v[64:67]
    v_cvt_pk_bf16_f32 v217, v218, v219
    v_cvt_pk_bf16_f32 v218, v220, v221
    v_mfma_f32_16x16x32_bf16 v[64:67], a[200:203], a[64:67], v[64:67]
    buffer_load_dwordx4 v4, s[12:15], s38 offen offset:256 lds
    v_accvgpr_write_b32 a68, v200
    v_accvgpr_write_b32 a69, v201
    v_accvgpr_write_b32 a70, v202
    v_accvgpr_write_b32 a71, v203
    s_nop 1
    v_mfma_f32_16x16x32_bf16 v[72:75], a[200:203], a[68:71], 0
    v_permlane16_swap_b32 v216, v218
    v_mfma_f32_16x16x32_bf16 v[72:75], a[196:199], a[52:55], v[72:75]
    v_cvt_pk_bf16_f32 v219, v222, v223
    v_accvgpr_write_b32 a72, v208
    v_mfma_f32_16x16x32_bf16 v[72:75], a[192:195], a[36:39], v[72:75]
    v_permlane16_swap_b32 v217, v219
    v_mfma_f32_16x16x32_bf16 v[72:75], a[188:191], a[20:23], v[72:75]
    v_accvgpr_write_b32 a73, v209
    v_accvgpr_write_b32 a74, v210
    v_mfma_f32_16x16x32_bf16 v[72:75], a[184:187], a[4:7], v[72:75]
    v_accvgpr_write_b32 a75, v211
    v_accvgpr_write_b32 a76, v216
    v_mfma_f32_16x16x32_bf16 v[80:83], a[184:187], a[8:11], 0
    s_add_u32 m0, s49, 52224
    v_accvgpr_write_b32 a77, v217
    v_accvgpr_write_b32 a78, v218
    v_mfma_f32_16x16x32_bf16 v[80:83], a[188:191], a[24:27], v[80:83]
    v_accvgpr_write_b32 a79, v219
    v_cvt_pk_bf16_f32 v224, v224, v225
    v_mfma_f32_16x16x32_bf16 v[80:83], a[192:195], a[40:43], v[80:83]
    v_cvt_pk_bf16_f32 v225, v226, v227
    v_cvt_pk_bf16_f32 v226, v228, v229
    v_mfma_f32_16x16x32_bf16 v[80:83], a[196:199], a[56:59], v[80:83]
    v_cvt_pk_bf16_f32 v227, v230, v231
    v_cvt_pk_bf16_f32 v232, v232, v233
    v_mfma_f32_16x16x32_bf16 v[80:83], a[200:203], a[72:75], v[80:83]
    v_permlane16_swap_b32 v224, v226
    v_mfma_f32_16x16x32_bf16 v[88:91], a[200:203], a[76:79], 0
    v_permlane16_swap_b32 v225, v227
    v_mfma_f32_16x16x32_bf16 v[88:91], a[196:199], a[60:63], v[88:91]
    buffer_load_dwordx4 v5, s[12:15], s38 offen offset:0 lds
    v_mfma_f32_16x16x32_bf16 v[88:91], a[192:195], a[44:47], v[88:91]
    s_waitcnt lgkmcnt(0)
    v_cvt_pk_bf16_f32 v233, v234, v235
    v_cvt_pk_bf16_f32 v234, v236, v237
    v_mfma_f32_16x16x32_bf16 v[88:91], a[188:191], a[28:31], v[88:91]
    v_cvt_pk_bf16_f32 v235, v238, v239
    v_cvt_pk_bf16_f32 v240, v240, v241
    v_mfma_f32_16x16x32_bf16 v[88:91], a[184:187], a[12:15], v[88:91]
    ds_read_b128 a[184:187], v12 offset:12288
    v_cvt_pk_bf16_f32 v241, v242, v243
    v_mfma_f32_16x16x32_bf16 v[64:67], a[204:207], v[224:227], v[64:67]
    ds_read_b128 a[188:191], v13 offset:12288
    v_cvt_pk_bf16_f32 v242, v244, v245
    v_permlane16_swap_b32 v232, v234
    v_permlane16_swap_b32 v233, v235
    s_nop 1
    v_mfma_f32_16x16x32_bf16 v[72:75], a[204:207], v[232:235], v[72:75]
    ds_read_b128 a[192:195], v12 offset:13312
    v_cvt_pk_bf16_f32 v243, v246, v247
    v_permlane16_swap_b32 v240, v242
    v_cvt_pk_bf16_f32 v248, v248, v249
    v_permlane16_swap_b32 v241, v243
    s_nop 1
    v_mfma_f32_16x16x32_bf16 v[80:83], a[204:207], v[240:243], v[80:83]
    s_add_u32 m0, s49, 53120
    ds_read_b128 a[196:199], v13 offset:13312
    v_cvt_pk_bf16_f32 v249, v250, v251
    v_cvt_pk_bf16_f32 v250, v252, v253
    v_cvt_pk_bf16_f32 v251, v254, v255
    v_accvgpr_write_b32 a80, v224
    v_permlane16_swap_b32 v248, v250
    v_permlane16_swap_b32 v249, v251
    s_nop 1
    v_mfma_f32_16x16x32_bf16 v[88:91], a[204:207], v[248:251], v[88:91]
    ds_read_b128 a[200:203], v12 offset:14336
    v_accvgpr_write_b32 a81, v225
    v_mfma_f32_16x16x32_bf16 v[24:27], a[208:211], a[0:3], 0
    ds_read_b128 a[204:207], v13 offset:14336
    v_accvgpr_write_b32 a82, v226
    v_mfma_f32_16x16x32_bf16 v[24:27], a[212:215], a[16:19], v[24:27]
    v_exp_f32 v64, v64
    v_mfma_f32_16x16x32_bf16 v[24:27], a[216:219], a[32:35], v[24:27]
    v_exp_f32 v65, v65
    v_mfma_f32_16x16x32_bf16 v[24:27], a[220:223], a[48:51], v[24:27]
    v_exp_f32 v66, v66
    v_mfma_f32_16x16x32_bf16 v[24:27], a[224:227], a[64:67], v[24:27]
    buffer_load_dwordx4 v5, s[12:15], s38 offen offset:128 lds
    v_accvgpr_write_b32 a83, v227
    s_nop 1
    v_mfma_f32_16x16x32_bf16 v[24:27], a[228:231], a[80:83], v[24:27]
    v_exp_f32 v67, v67
    v_accvgpr_write_b32 a84, v232
    v_accvgpr_write_b32 a85, v233
    v_accvgpr_write_b32 a86, v234
    v_accvgpr_write_b32 a87, v235
    s_nop 1
    v_mfma_f32_16x16x32_bf16 v[28:31], a[228:231], a[84:87], 0
    v_exp_f32 v72, v72
    v_mfma_f32_16x16x32_bf16 v[28:31], a[224:227], a[68:71], v[28:31]
    v_exp_f32 v73, v73
    v_mfma_f32_16x16x32_bf16 v[28:31], a[220:223], a[52:55], v[28:31]
    v_exp_f32 v74, v74
    v_mfma_f32_16x16x32_bf16 v[28:31], a[216:219], a[36:39], v[28:31]
    v_exp_f32 v75, v75
    v_mfma_f32_16x16x32_bf16 v[28:31], a[212:215], a[20:23], v[28:31]
    s_add_u32 m0, s49, 54016
    v_exp_f32 v80, v80
    v_mfma_f32_16x16x32_bf16 v[28:31], a[208:211], a[4:7], v[28:31]
    v_exp_f32 v81, v81
    v_mfma_f32_16x16x32_bf16 v[32:35], a[208:211], a[8:11], 0
    v_exp_f32 v82, v82
    v_mfma_f32_16x16x32_bf16 v[32:35], a[212:215], a[24:27], v[32:35]
    v_exp_f32 v83, v83
    v_mfma_f32_16x16x32_bf16 v[32:35], a[216:219], a[40:43], v[32:35]
    v_exp_f32 v88, v88
    v_mfma_f32_16x16x32_bf16 v[32:35], a[220:223], a[56:59], v[32:35]
    v_exp_f32 v89, v89
    v_mfma_f32_16x16x32_bf16 v[32:35], a[224:227], a[72:75], v[32:35]
    buffer_load_dwordx4 v5, s[12:15], s38 offen offset:256 lds
    v_accvgpr_write_b32 a88, v240
    v_accvgpr_write_b32 a89, v241
    v_accvgpr_write_b32 a90, v242
    v_accvgpr_write_b32 a91, v243
    s_nop 1
    v_mfma_f32_16x16x32_bf16 v[32:35], a[228:231], a[88:91], v[32:35]
    s_add_u32 s38, s38, 24576
    v_exp_f32 v90, v90
    v_accvgpr_write_b32 a92, v248
    v_accvgpr_write_b32 a93, v249
    v_accvgpr_write_b32 a94, v250
    v_accvgpr_write_b32 a95, v251
    s_nop 1
    v_mfma_f32_16x16x32_bf16 v[36:39], a[228:231], a[92:95], 0
    v_exp_f32 v91, v91
    v_mfma_f32_16x16x32_bf16 v[36:39], a[224:227], a[76:79], v[36:39]
    v_cvt_pk_bf16_f32 v64, v64, v65
    v_cvt_pk_bf16_f32 v65, v66, v67
    v_mfma_f32_16x16x32_bf16 v[36:39], a[220:223], a[60:63], v[36:39]
    s_add_u32 s39, s40, 49152
    v_exp_f32 v24, v24
    v_mfma_f32_16x16x32_bf16 v[36:39], a[216:219], a[44:47], v[36:39]
    s_waitcnt lgkmcnt(0)
    v_exp_f32 v25, v25
    v_mfma_f32_16x16x32_bf16 v[36:39], a[212:215], a[28:31], v[36:39]
    s_add_u32 m0, s63, 90112
    ds_read_b128 a[212:215], v13 offset:18432
    v_cvt_pk_bf16_f32 v72, v72, v73
    v_mfma_f32_16x16x32_bf16 v[36:39], a[208:211], a[12:15], v[36:39]
    ds_read_b128 a[220:223], v13 offset:19456
    v_cvt_pk_bf16_f32 v73, v74, v75
    v_mfma_f32_16x16x32_bf16 v[68:71], a[184:187], a[0:3], 0
    ds_read_b128 a[208:211], v12 offset:18432
    v_cvt_pk_bf16_f32 v80, v80, v81
    v_mfma_f32_16x16x32_bf16 v[68:71], a[188:191], a[16:19], v[68:71]
    ds_read_b128 a[216:219], v12 offset:19456
    v_cvt_pk_bf16_f32 v81, v82, v83
    v_mfma_f32_16x16x32_bf16 v[68:71], a[192:195], a[32:35], v[68:71]
    ds_read_b128 a[224:227], v12 offset:20480
    v_cvt_pk_bf16_f32 v88, v88, v89
    v_mfma_f32_16x16x32_bf16 v[68:71], a[196:199], a[48:51], v[68:71]
    ds_read_b128 a[228:231], v13 offset:20480
    v_cvt_pk_bf16_f32 v89, v90, v91
    v_mfma_f32_16x16x32_bf16 v[68:71], a[200:203], a[64:67], v[68:71]
    buffer_load_dwordx4 v6, s[16:19], s39 offen lds
    v_mfma_f32_16x16x32_bf16 v[68:71], a[204:207], a[80:83], v[68:71]
    v_exp_f32 v26, v26
    v_mfma_f32_16x16x32_bf16 v[76:79], a[204:207], a[84:87], 0
    v_exp_f32 v27, v27
    v_mfma_f32_16x16x32_bf16 v[76:79], a[200:203], a[68:71], v[76:79]
    v_exp_f32 v28, v28
    v_mfma_f32_16x16x32_bf16 v[76:79], a[196:199], a[52:55], v[76:79]
    s_add_u32 s39, s40, 61440
    v_exp_f32 v29, v29
    v_mfma_f32_16x16x32_bf16 v[76:79], a[192:195], a[36:39], v[76:79]
    v_exp_f32 v30, v30
    v_mfma_f32_16x16x32_bf16 v[76:79], a[188:191], a[20:23], v[76:79]
    s_add_u32 m0, s63, 94208
    v_exp_f32 v31, v31
    v_mfma_f32_16x16x32_bf16 v[76:79], a[184:187], a[4:7], v[76:79]
    v_cvt_pk_bf16_f32 v66, v24, v25
    v_cvt_pk_bf16_f32 v67, v26, v27
    v_mfma_f32_16x16x32_bf16 v[84:87], a[184:187], a[8:11], 0
    v_exp_f32 v32, v32
    v_mfma_f32_16x16x32_bf16 v[84:87], a[188:191], a[24:27], v[84:87]
    v_exp_f32 v33, v33
    v_mfma_f32_16x16x32_bf16 v[84:87], a[192:195], a[40:43], v[84:87]
    v_exp_f32 v34, v34
    v_mfma_f32_16x16x32_bf16 v[84:87], a[196:199], a[56:59], v[84:87]
    v_exp_f32 v35, v35
    v_mfma_f32_16x16x32_bf16 v[84:87], a[200:203], a[72:75], v[84:87]
    buffer_load_dwordx4 v6, s[16:19], s39 offen lds
    v_mfma_f32_16x16x32_bf16 v[84:87], a[204:207], a[88:91], v[84:87]
    v_cvt_pk_bf16_f32 v74, v28, v29
    v_cvt_pk_bf16_f32 v75, v30, v31
    v_mfma_f32_16x16x32_bf16 v[92:95], a[204:207], a[92:95], 0
    v_exp_f32 v36, v36
    v_mfma_f32_16x16x32_bf16 v[92:95], a[200:203], a[76:79], v[92:95]
    v_exp_f32 v37, v37
    v_mfma_f32_16x16x32_bf16 v[92:95], a[196:199], a[60:63], v[92:95]
    v_exp_f32 v38, v38
    v_mfma_f32_16x16x32_bf16 v[92:95], a[192:195], a[44:47], v[92:95]
    s_waitcnt lgkmcnt(0)
    v_exp_f32 v39, v39
    v_mfma_f32_16x16x32_bf16 v[92:95], a[188:191], a[28:31], v[92:95]
    s_add_u32 m0, s49, 0
    v_add_u32 v8, v19, v8
    v_add_u32 v9, v19, v9
    v_mfma_f32_16x16x32_bf16 v[92:95], a[184:187], a[12:15], v[92:95]
    v_add_u32 v10, v19, v10
    v_add_u32 v11, v19, v11
    v_mfma_f32_16x16x32_bf16 v[40:43], a[208:211], a[0:3], 0
    s_waitcnt vmcnt(13)
    v_cvt_pk_bf16_f32 v82, v32, v33
    v_cvt_pk_bf16_f32 v83, v34, v35
    v_mfma_f32_16x16x32_bf16 v[40:43], a[212:215], a[16:19], v[40:43]
    s_barrier
    v_mfma_f32_16x16x32_bf16 v[40:43], a[216:219], a[32:35], v[40:43]
    ds_read_b128 a[184:187], v12 offset:24576
    v_cvt_pk_bf16_f32 v90, v36, v37
    v_mfma_f32_16x16x32_bf16 v[40:43], a[220:223], a[48:51], v[40:43]
    ds_read_b128 a[188:191], v13 offset:24576
    v_cvt_pk_bf16_f32 v91, v38, v39
    v_mfma_f32_16x16x32_bf16 v[40:43], a[224:227], a[64:67], v[40:43]
    buffer_load_dwordx4 v4, s[12:15], s38 offen offset:0 lds
    v_mfma_f32_16x16x32_bf16 v[40:43], a[228:231], a[80:83], v[40:43]
    v_exp_f32 v68, v68
    v_mfma_f32_16x16x32_bf16 v[44:47], a[228:231], a[84:87], 0
    v_exp_f32 v69, v69
    v_mfma_f32_16x16x32_bf16 v[44:47], a[224:227], a[68:71], v[44:47]
    ds_read_b128 a[192:195], v12 offset:25600
    v_cvt_pk_bf16_f32 v68, v68, v69
    v_mfma_f32_16x16x32_bf16 v[44:47], a[220:223], a[52:55], v[44:47]
    v_exp_f32 v70, v70
    v_mfma_f32_16x16x32_bf16 v[44:47], a[216:219], a[36:39], v[44:47]
    v_exp_f32 v71, v71
    v_mfma_f32_16x16x32_bf16 v[44:47], a[212:215], a[20:23], v[44:47]
    s_add_u32 m0, s49, 896
    ds_read_b128 a[196:199], v13 offset:25600
    v_cvt_pk_bf16_f32 v69, v70, v71
    v_mfma_f32_16x16x32_bf16 v[44:47], a[208:211], a[4:7], v[44:47]
    v_exp_f32 v76, v76
    v_mfma_f32_16x16x32_bf16 v[48:51], a[208:211], a[8:11], 0
    buffer_load_dword a252, v22, s[32:35], s42 offen offset:0
    v_mfma_f32_16x16x32_bf16 v[48:51], a[212:215], a[24:27], v[48:51]
    v_exp_f32 v77, v77
    v_mfma_f32_16x16x32_bf16 v[48:51], a[216:219], a[40:43], v[48:51]
pg_5:
    s_cbranch_execz pg_9
    ds_read_b128 a[200:203], v12 offset:26624
    v_cvt_pk_bf16_f32 v76, v76, v77
    v_mfma_f32_16x16x32_bf16 v[48:51], a[220:223], a[56:59], v[48:51]
    v_exp_f32 v78, v78
    v_mfma_f32_16x16x32_bf16 v[48:51], a[224:227], a[72:75], v[48:51]
    buffer_load_dwordx4 v4, s[12:15], s38 offen offset:128 lds
    v_mfma_f32_16x16x32_bf16 v[48:51], a[228:231], a[88:91], v[48:51]
    v_exp_f32 v79, v79
    v_mfma_f32_16x16x32_bf16 v[52:55], a[228:231], a[92:95], 0
    ds_read_b128 a[204:207], v13 offset:26624
    v_cvt_pk_bf16_f32 v77, v78, v79
    v_mfma_f32_16x16x32_bf16 v[52:55], a[224:227], a[76:79], v[52:55]
    v_exp_f32 v84, v84
    v_mfma_f32_16x16x32_bf16 v[52:55], a[220:223], a[60:63], v[52:55]
    v_exp_f32 v85, v85
    v_mfma_f32_16x16x32_bf16 v[52:55], a[216:219], a[44:47], v[52:55]
    s_waitcnt lgkmcnt(1)
    v_exp_f32 v86, v86
    v_mfma_f32_16x16x32_bf16 v[52:55], a[212:215], a[28:31], v[52:55]
    s_add_u32 m0, s49, 1792
    ds_read_b128 a[212:215], v13 offset:30720
    v_cvt_pk_bf16_f32 v84, v84, v85
    v_mfma_f32_16x16x32_bf16 v[52:55], a[208:211], a[12:15], v[52:55]
    v_exp_f32 v87, v87
    v_mfma_f32_16x16x32_bf16 v[96:99], a[184:187], a[0:3], 0
    ds_read_b128 a[220:223], v13 offset:31744
    v_cvt_pk_bf16_f32 v85, v86, v87
    v_mfma_f32_16x16x32_bf16 v[96:99], a[188:191], a[16:19], v[96:99]
    v_exp_f32 v92, v92
    v_mfma_f32_16x16x32_bf16 v[96:99], a[192:195], a[32:35], v[96:99]
    s_waitcnt lgkmcnt(2)
    v_exp_f32 v93, v93
    v_mfma_f32_16x16x32_bf16 v[96:99], a[196:199], a[48:51], v[96:99]
    ds_read_b128 a[208:211], v12 offset:30720
    v_cvt_pk_bf16_f32 v92, v92, v93
    v_mfma_f32_16x16x32_bf16 v[96:99], a[200:203], a[64:67], v[96:99]
    buffer_load_dwordx4 v4, s[12:15], s38 offen offset:256 lds
    v_mfma_f32_16x16x32_bf16 v[96:99], a[204:207], a[80:83], v[96:99]
    v_exp_f32 v94, v94
    v_mfma_f32_16x16x32_bf16 v[104:107], a[204:207], a[84:87], 0
    v_exp_f32 v95, v95
    v_mfma_f32_16x16x32_bf16 v[104:107], a[200:203], a[68:71], v[104:107]
    ds_read_b128 a[216:219], v12 offset:31744
    v_cvt_pk_bf16_f32 v93, v94, v95
    v_mfma_f32_16x16x32_bf16 v[104:107], a[196:199], a[52:55], v[104:107]
    v_exp_f32 v40, v40
    v_mfma_f32_16x16x32_bf16 v[104:107], a[192:195], a[36:39], v[104:107]
    v_exp_f32 v41, v41
    v_mfma_f32_16x16x32_bf16 v[104:107], a[188:191], a[20:23], v[104:107]
    s_add_u32 m0, s49, 3072
    ds_read_b128 a[224:227], v12 offset:32768
    v_cvt_pk_bf16_f32 v70, v40, v41
    v_mfma_f32_16x16x32_bf16 v[104:107], a[184:187], a[4:7], v[104:107]
    v_exp_f32 v42, v42
    v_mfma_f32_16x16x32_bf16 v[112:115], a[184:187], a[8:11], 0
    v_exp_f32 v43, v43
    v_mfma_f32_16x16x32_bf16 v[112:115], a[188:191], a[24:27], v[112:115]
    ds_read_b128 a[228:231], v13 offset:32768
    v_cvt_pk_bf16_f32 v71, v42, v43
    v_mfma_f32_16x16x32_bf16 v[112:115], a[192:195], a[40:43], v[112:115]
    v_exp_f32 v44, v44
    v_mfma_f32_16x16x32_bf16 v[112:115], a[196:199], a[56:59], v[112:115]
    v_exp_f32 v45, v45
    v_mfma_f32_16x16x32_bf16 v[112:115], a[200:203], a[72:75], v[112:115]
    buffer_load_dwordx4 v5, s[12:15], s38 offen offset:0 lds
    v_mfma_f32_16x16x32_bf16 v[112:115], a[204:207], a[88:91], v[112:115]
    v_exp_f32 v46, v46
    v_mfma_f32_16x16x32_bf16 v[120:123], a[204:207], a[92:95], 0
    ds_read_b64_tr_b16 a[232:233], v8 offset:0
    v_cvt_pk_bf16_f32 v78, v44, v45
    v_mfma_f32_16x16x32_bf16 v[120:123], a[200:203], a[76:79], v[120:123]
    v_exp_f32 v47, v47
    v_mfma_f32_16x16x32_bf16 v[120:123], a[196:199], a[60:63], v[120:123]
    ds_read_b64_tr_b16 a[234:235], v8 offset:2048
    v_cvt_pk_bf16_f32 v79, v46, v47
    v_mfma_f32_16x16x32_bf16 v[120:123], a[192:195], a[44:47], v[120:123]
    s_waitcnt lgkmcnt(2)
    v_exp_f32 v48, v48
    v_mfma_f32_16x16x32_bf16 v[120:123], a[188:191], a[28:31], v[120:123]
    s_add_u32 m0, s49, 3968
    v_exp_f32 v49, v49
    v_mfma_f32_16x16x32_bf16 v[120:123], a[184:187], a[12:15], v[120:123]
    ds_read_b64_tr_b16 a[236:237], v9 offset:0
    v_cvt_pk_bf16_f32 v86, v48, v49
    v_mfma_f32_16x16x32_bf16 v[24:27], a[208:211], a[0:3], 0
    v_exp_f32 v50, v50
    v_mfma_f32_16x16x32_bf16 v[24:27], a[212:215], a[16:19], v[24:27]
    v_exp_f32 v51, v51
    v_mfma_f32_16x16x32_bf16 v[24:27], a[216:219], a[32:35], v[24:27]
    ds_read_b64_tr_b16 a[238:239], v9 offset:2048
    v_cvt_pk_bf16_f32 v87, v50, v51
    v_mfma_f32_16x16x32_bf16 v[24:27], a[220:223], a[48:51], v[24:27]
    v_exp_f32 v52, v52
    v_mfma_f32_16x16x32_bf16 v[24:27], a[224:227], a[64:67], v[24:27]
    buffer_load_dwordx4 v5, s[12:15], s38 offen offset:128 lds
    v_mfma_f32_16x16x32_bf16 v[24:27], a[228:231], a[80:83], v[24:27]
    v_exp_f32 v53, v53
    v_mfma_f32_16x16x32_bf16 v[28:31], a[228:231], a[84:87], 0
    ds_read_b128 a[184:187], v12 offset:36864
    v_cvt_pk_bf16_f32 v94, v52, v53
    v_mfma_f32_16x16x32_bf16 v[28:31], a[224:227], a[68:71], v[28:31]
    v_exp_f32 v54, v54
    v_mfma_f32_16x16x32_bf16 v[28:31], a[220:223], a[52:55], v[28:31]
    v_exp_f32 v55, v55
    v_mfma_f32_16x16x32_bf16 v[28:31], a[216:219], a[36:39], v[28:31]
    ds_read_b128 a[188:191], v13 offset:36864
    v_cvt_pk_bf16_f32 v95, v54, v55
    v_mfma_f32_16x16x32_bf16 v[28:31], a[212:215], a[20:23], v[28:31]
    s_add_u32 m0, s49, 4864
    v_exp_f32 v96, v96
    v_mfma_f32_16x16x32_bf16 v[28:31], a[208:211], a[4:7], v[28:31]
    v_exp_f32 v97, v97
    v_mfma_f32_16x16x32_bf16 v[32:35], a[208:211], a[8:11], 0
    ds_read_b128 a[192:195], v12 offset:37888
    v_cvt_pk_bf16_f32 v96, v96, v97
    v_mfma_f32_16x16x32_bf16 v[32:35], a[212:215], a[24:27], v[32:35]
    v_exp_f32 v98, v98
    v_mfma_f32_16x16x32_bf16 v[32:35], a[216:219], a[40:43], v[32:35]
    v_exp_f32 v99, v99
    v_mfma_f32_16x16x32_bf16 v[32:35], a[220:223], a[56:59], v[32:35]
    ds_read_b128 a[196:199], v13 offset:37888
    v_cvt_pk_bf16_f32 v97, v98, v99
    v_mfma_f32_16x16x32_bf16 v[32:35], a[224:227], a[72:75], v[32:35]
    buffer_load_dwordx4 v5, s[12:15], s38 offen offset:256 lds
    v_mfma_f32_16x16x32_bf16 v[32:35], a[228:231], a[88:91], v[32:35]
    s_add_u32 s38, s38, 24576
    v_exp_f32 v104, v104
    v_mfma_f32_16x16x32_bf16 v[36:39], a[228:231], a[92:95], 0
    v_exp_f32 v105, v105
    v_mfma_f32_16x16x32_bf16 v[36:39], a[224:227], a[76:79], v[36:39]
    ds_read_b128 a[200:203], v12 offset:38912
    v_cvt_pk_bf16_f32 v104, v104, v105
    v_mfma_f32_16x16x32_bf16 v[36:39], a[220:223], a[60:63], v[36:39]
    s_add_u32 s39, s40, 73728
    v_exp_f32 v106, v106
    v_mfma_f32_16x16x32_bf16 v[36:39], a[216:219], a[44:47], v[36:39]
    s_waitcnt lgkmcnt(2)
    v_exp_f32 v107, v107
    v_mfma_f32_16x16x32_bf16 v[36:39], a[212:215], a[28:31], v[36:39]
    s_add_u32 m0, s63, 98304
    ds_read_b128 a[204:207], v13 offset:38912
    v_cvt_pk_bf16_f32 v105, v106, v107
    v_mfma_f32_16x16x32_bf16 v[36:39], a[208:211], a[12:15], v[36:39]
    v_exp_f32 v112, v112
    v_mfma_f32_16x16x32_bf16 a[152:155], a[232:235], v[64:67], 0
    v_exp_f32 v113, v113
    v_mfma_f32_16x16x32_bf16 a[168:171], a[236:239], v[64:67], 0
    v_exp_f32 v114, v114
    v_mfma_f32_16x16x32_bf16 a[172:175], a[236:239], v[72:75], 0
    ds_read_b128 a[208:211], v12 offset:43008
    v_cvt_pk_bf16_f32 v112, v112, v113
    v_mfma_f32_16x16x32_bf16 a[156:159], a[232:235], v[72:75], 0
    v_exp_f32 v115, v115
    v_mfma_f32_16x16x32_bf16 a[160:163], a[232:235], v[80:83], 0
    buffer_load_dwordx4 v6, s[16:19], s39 offen lds
    v_mfma_f32_16x16x32_bf16 a[176:179], a[236:239], v[80:83], 0
    ds_read_b128 a[212:215], v13 offset:43008
    v_cvt_pk_bf16_f32 v113, v114, v115
    v_mfma_f32_16x16x32_bf16 a[180:183], a[236:239], v[88:91], 0
    v_exp_f32 v120, v120
    v_mfma_f32_16x16x32_bf16 a[164:167], a[232:235], v[88:91], 0
    v_exp_f32 v121, v121
    v_mfma_f32_16x16x32_bf16 v[100:103], a[184:187], a[0:3], 0
    s_waitcnt lgkmcnt(2)
    ds_read_b128 a[216:219], v12 offset:44032
    v_cvt_pk_bf16_f32 v120, v120, v121
    v_mfma_f32_16x16x32_bf16 v[100:103], a[188:191], a[16:19], v[100:103]
    s_add_u32 s39, s40, 86016
    v_exp_f32 v122, v122
    v_mfma_f32_16x16x32_bf16 v[100:103], a[192:195], a[32:35], v[100:103]
    s_add_u32 m0, s63, 102400
    v_exp_f32 v123, v123
    v_mfma_f32_16x16x32_bf16 v[100:103], a[196:199], a[48:51], v[100:103]
    ds_read_b128 a[220:223], v13 offset:44032
    v_cvt_pk_bf16_f32 v121, v122, v123
    v_mfma_f32_16x16x32_bf16 v[100:103], a[200:203], a[64:67], v[100:103]
    v_exp_f32 v24, v24
    v_mfma_f32_16x16x32_bf16 v[100:103], a[204:207], a[80:83], v[100:103]
    v_exp_f32 v25, v25
    v_mfma_f32_16x16x32_bf16 v[108:111], a[204:207], a[84:87], 0
    ds_read_b128 a[224:227], v12 offset:45056
    v_cvt_pk_bf16_f32 v98, v24, v25
    v_mfma_f32_16x16x32_bf16 v[108:111], a[200:203], a[68:71], v[108:111]
    v_exp_f32 v26, v26
    v_mfma_f32_16x16x32_bf16 v[108:111], a[196:199], a[52:55], v[108:111]
    buffer_load_dwordx4 v6, s[16:19], s39 offen lds
    v_mfma_f32_16x16x32_bf16 v[108:111], a[192:195], a[36:39], v[108:111]
    v_exp_f32 v27, v27
    v_mfma_f32_16x16x32_bf16 v[108:111], a[188:191], a[20:23], v[108:111]
    ds_read_b128 a[228:231], v13 offset:45056
    v_cvt_pk_bf16_f32 v99, v26, v27
    v_mfma_f32_16x16x32_bf16 v[108:111], a[184:187], a[4:7], v[108:111]
    v_exp_f32 v28, v28
    v_mfma_f32_16x16x32_bf16 v[116:119], a[184:187], a[8:11], 0
    v_exp_f32 v29, v29
    v_mfma_f32_16x16x32_bf16 v[116:119], a[188:191], a[24:27], v[116:119]
    v_exp_f32 v30, v30
    v_mfma_f32_16x16x32_bf16 v[116:119], a[192:195], a[40:43], v[116:119]
    v_exp_f32 v31, v31
    v_mfma_f32_16x16x32_bf16 v[116:119], a[196:199], a[56:59], v[116:119]
    v_exp_f32 v32, v32
    v_mfma_f32_16x16x32_bf16 v[116:119], a[200:203], a[72:75], v[116:119]
    v_exp_f32 v33, v33
    v_mfma_f32_16x16x32_bf16 v[116:119], a[204:207], a[88:91], v[116:119]
    v_exp_f32 v34, v34
    v_mfma_f32_16x16x32_bf16 v[124:127], a[204:207], a[92:95], 0
    v_exp_f32 v35, v35
    v_mfma_f32_16x16x32_bf16 v[124:127], a[200:203], a[76:79], v[124:127]
    v_cvt_pk_bf16_f32 v106, v28, v29
    v_cvt_pk_bf16_f32 v107, v30, v31
    v_mfma_f32_16x16x32_bf16 v[124:127], a[196:199], a[60:63], v[124:127]
    s_add_u32 m0, s49, 24576
    v_exp_f32 v36, v36
    v_mfma_f32_16x16x32_bf16 v[124:127], a[192:195], a[44:47], v[124:127]
    s_waitcnt lgkmcnt(0)
    v_exp_f32 v37, v37
    v_mfma_f32_16x16x32_bf16 v[124:127], a[188:191], a[28:31], v[124:127]
    v_exp_f32 v38, v38
    v_mfma_f32_16x16x32_bf16 v[124:127], a[184:187], a[12:15], v[124:127]
    v_exp_f32 v39, v39
    v_mfma_f32_16x16x32_bf16 v[40:43], a[208:211], a[0:3], 0
    s_waitcnt vmcnt(11)
    v_cvt_pk_bf16_f32 v114, v32, v33
    v_cvt_pk_bf16_f32 v115, v34, v35
    v_mfma_f32_16x16x32_bf16 v[40:43], a[212:215], a[16:19], v[40:43]
    s_barrier
    v_mfma_f32_16x16x32_bf16 v[40:43], a[216:219], a[32:35], v[40:43]
    buffer_load_dwordx4 v4, s[12:15], s38 offen offset:0 lds
    v_mfma_f32_16x16x32_bf16 v[40:43], a[220:223], a[48:51], v[40:43]
    ds_read_b64_tr_b16 a[240:241], v8 offset:4096
    v_cvt_pk_bf16_f32 v122, v36, v37
    v_mfma_f32_16x16x32_bf16 v[40:43], a[224:227], a[64:67], v[40:43]
    ds_read_b64_tr_b16 a[242:243], v8 offset:6144
    v_cvt_pk_bf16_f32 v123, v38, v39
    v_mfma_f32_16x16x32_bf16 v[40:43], a[228:231], a[80:83], v[40:43]
    v_exp_f32 v100, v100
    v_mfma_f32_16x16x32_bf16 v[44:47], a[228:231], a[84:87], 0
    v_exp_f32 v101, v101
    v_mfma_f32_16x16x32_bf16 v[44:47], a[224:227], a[68:71], v[44:47]
    ds_read_b64_tr_b16 a[244:245], v9 offset:4096
    v_cvt_pk_bf16_f32 v100, v100, v101
    v_mfma_f32_16x16x32_bf16 v[44:47], a[220:223], a[52:55], v[44:47]
    s_add_u32 m0, s49, 25472
    v_exp_f32 v102, v102
    v_mfma_f32_16x16x32_bf16 v[44:47], a[216:219], a[36:39], v[44:47]
    v_exp_f32 v103, v103
    v_mfma_f32_16x16x32_bf16 v[44:47], a[212:215], a[20:23], v[44:47]
    ds_read_b64_tr_b16 a[246:247], v9 offset:6144
    v_cvt_pk_bf16_f32 v101, v102, v103
    v_mfma_f32_16x16x32_bf16 v[44:47], a[208:211], a[4:7], v[44:47]
    v_exp_f32 v108, v108
    v_mfma_f32_16x16x32_bf16 v[48:51], a[208:211], a[8:11], 0
    buffer_load_dword a252, v22, s[32:35], s42 offen offset:1536
    s_add_u32 s42, s42, 3072
    v_mfma_f32_16x16x32_bf16 v[48:51], a[212:215], a[24:27], v[48:51]
    v_exp_f32 v109, v109
    v_mfma_f32_16x16x32_bf16 v[48:51], a[216:219], a[40:43], v[48:51]
    buffer_load_dwordx4 v4, s[12:15], s38 offen offset:128 lds
    v_mfma_f32_16x16x32_bf16 v[48:51], a[220:223], a[56:59], v[48:51]
    ds_read_b128 a[184:187], v12 offset:49152
    v_cvt_pk_bf16_f32 v108, v108, v109
    v_mfma_f32_16x16x32_bf16 v[48:51], a[224:227], a[72:75], v[48:51]
    v_exp_f32 v110, v110
    v_mfma_f32_16x16x32_bf16 v[48:51], a[228:231], a[88:91], v[48:51]
    v_exp_f32 v111, v111
    v_mfma_f32_16x16x32_bf16 v[52:55], a[228:231], a[92:95], 0
    ds_read_b128 a[188:191], v13 offset:49152
    v_cvt_pk_bf16_f32 v109, v110, v111
    v_mfma_f32_16x16x32_bf16 v[52:55], a[224:227], a[76:79], v[52:55]
    v_exp_f32 v116, v116
    v_mfma_f32_16x16x32_bf16 v[52:55], a[220:223], a[60:63], v[52:55]
    s_add_u32 m0, s49, 26368
    ds_read_b128 a[192:195], v12 offset:50176
    v_accvgpr_write_b32 a96, v64
    v_mfma_f32_16x16x32_bf16 v[52:55], a[216:219], a[44:47], v[52:55]
    s_waitcnt lgkmcnt(3)
    v_exp_f32 v117, v117
    v_mfma_f32_16x16x32_bf16 v[52:55], a[212:215], a[28:31], v[52:55]
    ds_read_b128 a[196:199], v13 offset:50176
    v_cvt_pk_bf16_f32 v116, v116, v117
    v_mfma_f32_16x16x32_bf16 v[52:55], a[208:211], a[12:15], v[52:55]
    v_exp_f32 v118, v118
    v_mfma_f32_16x16x32_bf16 a[164:167], a[240:243], v[92:95], a[164:167]
    v_exp_f32 v119, v119
    v_mfma_f32_16x16x32_bf16 a[180:183], a[244:247], v[92:95], a[180:183]
    ds_read_b128 a[200:203], v12 offset:51200
    v_cvt_pk_bf16_f32 v117, v118, v119
    v_mfma_f32_16x16x32_bf16 a[176:179], a[244:247], v[84:87], a[176:179]
    buffer_load_dwordx4 v4, s[12:15], s38 offen offset:256 lds
    v_mfma_f32_16x16x32_bf16 a[160:163], a[240:243], v[84:87], a[160:163]
    ds_read_b128 a[204:207], v13 offset:51200
    v_accvgpr_write_b32 a97, v65
    v_mfma_f32_16x16x32_bf16 a[156:159], a[240:243], v[76:79], a[156:159]
    v_exp_f32 v124, v124
    v_mfma_f32_16x16x32_bf16 a[172:175], a[244:247], v[76:79], a[172:175]
    s_waitcnt lgkmcnt(2)
    v_exp_f32 v125, v125
    v_mfma_f32_16x16x32_bf16 a[168:171], a[244:247], v[68:71], a[168:171]
    ds_read_b128 a[208:211], v12 offset:55296
    v_cvt_pk_bf16_f32 v124, v124, v125
    v_mfma_f32_16x16x32_bf16 a[152:155], a[240:243], v[68:71], a[152:155]
    v_exp_f32 v126, v126
    v_mfma_f32_16x16x32_bf16 v[128:131], a[184:187], a[0:3], 0
    s_add_u32 m0, s49, 27648
    v_exp_f32 v127, v127
    v_mfma_f32_16x16x32_bf16 v[128:131], a[188:191], a[16:19], v[128:131]
    s_waitcnt lgkmcnt(2)
    ds_read_b128 a[212:215], v13 offset:55296
    v_cvt_pk_bf16_f32 v125, v126, v127
    v_mfma_f32_16x16x32_bf16 v[128:131], a[192:195], a[32:35], v[128:131]
    s_waitcnt lgkmcnt(2)
    v_exp_f32 v40, v40
    v_mfma_f32_16x16x32_bf16 v[128:131], a[196:199], a[48:51], v[128:131]
    ds_read_b128 a[216:219], v12 offset:56320
    v_accvgpr_write_b32 a98, v66
    v_mfma_f32_16x16x32_bf16 v[128:131], a[200:203], a[64:67], v[128:131]
    v_exp_f32 v41, v41
    v_mfma_f32_16x16x32_bf16 v[128:131], a[204:207], a[80:83], v[128:131]
    ds_read_b128 a[220:223], v13 offset:56320
    v_cvt_pk_bf16_f32 v102, v40, v41
    v_mfma_f32_16x16x32_bf16 v[136:139], a[204:207], a[84:87], 0
    buffer_load_dwordx4 v5, s[12:15], s38 offen offset:0 lds
    v_mfma_f32_16x16x32_bf16 v[136:139], a[200:203], a[68:71], v[136:139]
    v_exp_f32 v42, v42
    v_mfma_f32_16x16x32_bf16 v[136:139], a[196:199], a[52:55], v[136:139]
    v_exp_f32 v43, v43
    v_mfma_f32_16x16x32_bf16 v[136:139], a[192:195], a[36:39], v[136:139]
    ds_read_b128 a[224:227], v12 offset:57344
    v_cvt_pk_bf16_f32 v103, v42, v43
    v_mfma_f32_16x16x32_bf16 v[136:139], a[188:191], a[20:23], v[136:139]
    v_exp_f32 v44, v44
    v_mfma_f32_16x16x32_bf16 v[136:139], a[184:187], a[4:7], v[136:139]
    ds_read_b128 a[228:231], v13 offset:57344
    v_accvgpr_write_b32 a99, v67
    v_mfma_f32_16x16x32_bf16 v[144:147], a[184:187], a[8:11], 0
    s_add_u32 m0, s49, 28544
    v_exp_f32 v45, v45
    v_mfma_f32_16x16x32_bf16 v[144:147], a[188:191], a[24:27], v[144:147]
    v_exp_f32 v46, v46
    v_mfma_f32_16x16x32_bf16 v[144:147], a[192:195], a[40:43], v[144:147]
    v_exp_f32 v47, v47
    v_mfma_f32_16x16x32_bf16 v[144:147], a[196:199], a[56:59], v[144:147]
    v_exp_f32 v48, v48
    v_mfma_f32_16x16x32_bf16 v[144:147], a[200:203], a[72:75], v[144:147]
    v_exp_f32 v49, v49
    v_mfma_f32_16x16x32_bf16 v[144:147], a[204:207], a[88:91], v[144:147]
    v_exp_f32 v50, v50
    v_mfma_f32_16x16x32_bf16 v[152:155], a[204:207], a[92:95], 0
    buffer_load_dwordx4 v5, s[12:15], s38 offen offset:128 lds
    v_mfma_f32_16x16x32_bf16 v[152:155], a[200:203], a[76:79], v[152:155]
    ds_read_b64_tr_b16 a[232:233], v8 offset:8192
    v_cvt_pk_bf16_f32 v110, v44, v45
    v_mfma_f32_16x16x32_bf16 v[152:155], a[196:199], a[60:63], v[152:155]
    ds_read_b64_tr_b16 a[234:235], v8 offset:10240
    v_cvt_pk_bf16_f32 v111, v46, v47
    v_mfma_f32_16x16x32_bf16 v[152:155], a[192:195], a[44:47], v[152:155]
    s_waitcnt lgkmcnt(2)
    ds_read_b64_tr_b16 a[236:237], v9 offset:8192
    v_cvt_pk_bf16_f32 v118, v48, v49
    v_mfma_f32_16x16x32_bf16 v[152:155], a[188:191], a[28:31], v[152:155]
    ds_read_b64_tr_b16 a[238:239], v9 offset:10240
    v_accvgpr_write_b32 a100, v68
    v_mfma_f32_16x16x32_bf16 v[152:155], a[184:187], a[12:15], v[152:155]
    v_exp_f32 v51, v51
    v_mfma_f32_16x16x32_bf16 v[24:27], a[208:211], a[0:3], 0
    s_add_u32 m0, s49, 29440
    v_exp_f32 v52, v52
    v_mfma_f32_16x16x32_bf16 v[24:27], a[212:215], a[16:19], v[24:27]
    v_exp_f32 v53, v53
    v_mfma_f32_16x16x32_bf16 v[24:27], a[216:219], a[32:35], v[24:27]
    ds_read_b128 a[184:187], v12 offset:61440
    v_cvt_pk_bf16_f32 v119, v50, v51
    v_mfma_f32_16x16x32_bf16 v[24:27], a[220:223], a[48:51], v[24:27]
    ds_read_b128 a[188:191], v13 offset:61440
    v_cvt_pk_bf16_f32 v126, v52, v53
    v_mfma_f32_16x16x32_bf16 v[24:27], a[224:227], a[64:67], v[24:27]
    ds_read_b128 a[192:195], v12 offset:62464
    v_accvgpr_write_b32 a101, v69
    v_mfma_f32_16x16x32_bf16 v[24:27], a[228:231], a[80:83], v[24:27]
    v_exp_f32 v54, v54
    v_mfma_f32_16x16x32_bf16 v[28:31], a[228:231], a[84:87], 0
    buffer_load_dwordx4 v5, s[12:15], s38 offen offset:256 lds
    v_mfma_f32_16x16x32_bf16 v[28:31], a[224:227], a[68:71], v[28:31]
    s_add_u32 s38, s38, 24576
    v_exp_f32 v55, v55
    v_mfma_f32_16x16x32_bf16 v[28:31], a[220:223], a[52:55], v[28:31]
    ds_read_b128 a[196:199], v13 offset:62464
    v_cvt_pk_bf16_f32 v127, v54, v55
    v_mfma_f32_16x16x32_bf16 v[28:31], a[216:219], a[36:39], v[28:31]
    v_exp_f32 v128, v128
    v_mfma_f32_16x16x32_bf16 v[28:31], a[212:215], a[20:23], v[28:31]
    s_add_u32 s39, s40, 98304
    ds_read_b128 a[200:203], v12 offset:63488
    v_add_u32 v12, 67584, v12
    v_mfma_f32_16x16x32_bf16 v[28:31], a[208:211], a[4:7], v[28:31]
    ds_read_b128 a[204:207], v13 offset:63488
    v_add_u32 v13, 67584, v13
    v_mfma_f32_16x16x32_bf16 v[32:35], a[208:211], a[8:11], 0
    s_add_u32 m0, s63, 106496
    v_exp_f32 v129, v129
    v_mfma_f32_16x16x32_bf16 v[32:35], a[212:215], a[24:27], v[32:35]
    v_exp_f32 v130, v130
    v_mfma_f32_16x16x32_bf16 v[32:35], a[216:219], a[40:43], v[32:35]
    v_exp_f32 v131, v131
    v_mfma_f32_16x16x32_bf16 v[32:35], a[220:223], a[56:59], v[32:35]
    v_exp_f32 v136, v136
    v_mfma_f32_16x16x32_bf16 v[32:35], a[224:227], a[72:75], v[32:35]
    v_exp_f32 v137, v137
    v_mfma_f32_16x16x32_bf16 v[32:35], a[228:231], a[88:91], v[32:35]
    v_exp_f32 v138, v138
    v_mfma_f32_16x16x32_bf16 v[36:39], a[228:231], a[92:95], 0
    buffer_load_dwordx4 v6, s[16:19], s39 offen lds
    v_mfma_f32_16x16x32_bf16 v[36:39], a[224:227], a[76:79], v[36:39]
    v_exp_f32 v139, v139
    v_mfma_f32_16x16x32_bf16 v[36:39], a[220:223], a[60:63], v[36:39]
    v_cvt_pk_bf16_f32 v128, v128, v129
    v_cvt_pk_bf16_f32 v129, v130, v131
    v_mfma_f32_16x16x32_bf16 v[36:39], a[216:219], a[44:47], v[36:39]
    s_waitcnt lgkmcnt(0)
    v_exp_f32 v144, v144
    v_mfma_f32_16x16x32_bf16 v[36:39], a[212:215], a[28:31], v[36:39]
    s_add_u32 s39, s40, 110592
    v_exp_f32 v145, v145
    v_mfma_f32_16x16x32_bf16 v[36:39], a[208:211], a[12:15], v[36:39]
    v_exp_f32 v146, v146
    v_mfma_f32_16x16x32_bf16 a[152:155], a[232:235], v[96:99], a[152:155]
    s_add_u32 m0, s63, 110592
    v_exp_f32 v147, v147
    v_mfma_f32_16x16x32_bf16 a[168:171], a[236:239], v[96:99], a[168:171]
    v_cvt_pk_bf16_f32 v136, v136, v137
    v_cvt_pk_bf16_f32 v137, v138, v139
    v_mfma_f32_16x16x32_bf16 a[172:175], a[236:239], v[104:107], a[172:175]
    ds_read_b128 a[208:211], v12 offset:0
    v_cvt_pk_bf16_f32 v144, v144, v145
    v_mfma_f32_16x16x32_bf16 a[156:159], a[232:235], v[104:107], a[156:159]
    ds_read_b128 a[212:215], v13 offset:0
    v_cvt_pk_bf16_f32 v145, v146, v147
    v_mfma_f32_16x16x32_bf16 a[160:163], a[232:235], v[112:115], a[160:163]
    ds_read_b128 a[216:219], v12 offset:1024
    v_accvgpr_write_b32 a102, v70
    v_mfma_f32_16x16x32_bf16 a[176:179], a[236:239], v[112:115], a[176:179]
    ds_read_b128 a[220:223], v13 offset:1024
    v_accvgpr_write_b32 a103, v71
    v_mfma_f32_16x16x32_bf16 a[180:183], a[236:239], v[120:123], a[180:183]
    buffer_load_dwordx4 v6, s[16:19], s39 offen lds
    v_mfma_f32_16x16x32_bf16 a[164:167], a[232:235], v[120:123], a[164:167]
    ds_read_b128 a[224:227], v12 offset:2048
    v_accvgpr_write_b32 a104, v72
    v_mfma_f32_16x16x32_bf16 v[132:135], a[184:187], a[0:3], 0
    ds_read_b128 a[228:231], v13 offset:2048
    v_subrev_u32 v12, 67584, v12
    v_mfma_f32_16x16x32_bf16 v[132:135], a[188:191], a[16:19], v[132:135]
    v_exp_f32 v152, v152
    v_mfma_f32_16x16x32_bf16 v[132:135], a[192:195], a[32:35], v[132:135]
    v_exp_f32 v153, v153
    v_mfma_f32_16x16x32_bf16 v[132:135], a[196:199], a[48:51], v[132:135]
    v_exp_f32 v154, v154
    v_mfma_f32_16x16x32_bf16 v[132:135], a[200:203], a[64:67], v[132:135]
    v_exp_f32 v155, v155
    v_mfma_f32_16x16x32_bf16 v[132:135], a[204:207], a[80:83], v[132:135]
    v_exp_f32 v24, v24
    v_mfma_f32_16x16x32_bf16 v[140:143], a[204:207], a[84:87], 0
    v_exp_f32 v25, v25
    v_mfma_f32_16x16x32_bf16 v[140:143], a[200:203], a[68:71], v[140:143]
    v_exp_f32 v26, v26
    v_mfma_f32_16x16x32_bf16 v[140:143], a[196:199], a[52:55], v[140:143]
    v_exp_f32 v27, v27
    v_mfma_f32_16x16x32_bf16 v[140:143], a[192:195], a[36:39], v[140:143]
    v_cvt_pk_bf16_f32 v152, v152, v153
    v_cvt_pk_bf16_f32 v153, v154, v155
    v_mfma_f32_16x16x32_bf16 v[140:143], a[188:191], a[20:23], v[140:143]
    v_exp_f32 v28, v28
    v_mfma_f32_16x16x32_bf16 v[140:143], a[184:187], a[4:7], v[140:143]
    v_exp_f32 v29, v29
    v_mfma_f32_16x16x32_bf16 v[148:151], a[184:187], a[8:11], 0
    v_exp_f32 v30, v30
    v_mfma_f32_16x16x32_bf16 v[148:151], a[188:191], a[24:27], v[148:151]
    v_exp_f32 v31, v31
    v_mfma_f32_16x16x32_bf16 v[148:151], a[192:195], a[40:43], v[148:151]
    v_cvt_pk_bf16_f32 v130, v24, v25
    v_cvt_pk_bf16_f32 v131, v26, v27
    v_mfma_f32_16x16x32_bf16 v[148:151], a[196:199], a[56:59], v[148:151]
    v_exp_f32 v32, v32
    v_mfma_f32_16x16x32_bf16 v[148:151], a[200:203], a[72:75], v[148:151]
    v_exp_f32 v33, v33
    v_mfma_f32_16x16x32_bf16 v[148:151], a[204:207], a[88:91], v[148:151]
    v_exp_f32 v34, v34
    v_mfma_f32_16x16x32_bf16 v[156:159], a[204:207], a[92:95], 0
    v_exp_f32 v35, v35
    v_mfma_f32_16x16x32_bf16 v[156:159], a[200:203], a[76:79], v[156:159]
    v_cvt_pk_bf16_f32 v138, v28, v29
    v_cvt_pk_bf16_f32 v139, v30, v31
    v_mfma_f32_16x16x32_bf16 v[156:159], a[196:199], a[60:63], v[156:159]
    s_add_u32 m0, s49, 49152
    v_exp_f32 v36, v36
    v_mfma_f32_16x16x32_bf16 v[156:159], a[192:195], a[44:47], v[156:159]
    s_waitcnt lgkmcnt(0)
    v_exp_f32 v37, v37
    v_mfma_f32_16x16x32_bf16 v[156:159], a[188:191], a[28:31], v[156:159]
    v_exp_f32 v38, v38
    v_mfma_f32_16x16x32_bf16 v[156:159], a[184:187], a[12:15], v[156:159]
    v_exp_f32 v39, v39
    v_mfma_f32_16x16x32_bf16 v[40:43], a[208:211], a[0:3], 0
    s_waitcnt vmcnt(11)
    v_cvt_pk_bf16_f32 v146, v32, v33
    v_cvt_pk_bf16_f32 v147, v34, v35
    v_mfma_f32_16x16x32_bf16 v[40:43], a[212:215], a[16:19], v[40:43]
    s_barrier
    v_mfma_f32_16x16x32_bf16 v[40:43], a[216:219], a[32:35], v[40:43]
    buffer_load_dwordx4 v4, s[12:15], s38 offen offset:0 lds
    v_mfma_f32_16x16x32_bf16 v[40:43], a[220:223], a[48:51], v[40:43]
    ds_read_b64_tr_b16 a[240:241], v8 offset:12288
    v_cvt_pk_bf16_f32 v154, v36, v37
    v_mfma_f32_16x16x32_bf16 v[40:43], a[224:227], a[64:67], v[40:43]
    ds_read_b64_tr_b16 a[242:243], v8 offset:14336
    v_cvt_pk_bf16_f32 v155, v38, v39
    v_mfma_f32_16x16x32_bf16 v[40:43], a[228:231], a[80:83], v[40:43]
    ds_read_b64_tr_b16 a[244:245], v9 offset:12288
    v_accvgpr_write_b32 a105, v73
    v_mfma_f32_16x16x32_bf16 v[44:47], a[228:231], a[84:87], 0
    ds_read_b64_tr_b16 a[246:247], v9 offset:14336
    v_subrev_u32 v13, 67584, v13
    v_mfma_f32_16x16x32_bf16 v[44:47], a[224:227], a[68:71], v[44:47]
    ds_read_b128 a[184:187], v12 offset:0
    v_accvgpr_write_b32 a106, v74
    v_mfma_f32_16x16x32_bf16 v[44:47], a[220:223], a[52:55], v[44:47]
    s_add_u32 m0, s49, 50048
    ds_read_b128 a[188:191], v13 offset:0
    v_accvgpr_write_b32 a107, v75
    v_mfma_f32_16x16x32_bf16 v[44:47], a[216:219], a[36:39], v[44:47]
    ds_read_b128 a[192:195], v12 offset:1024
    v_accvgpr_write_b32 a108, v76
    v_mfma_f32_16x16x32_bf16 v[44:47], a[212:215], a[20:23], v[44:47]
    ds_read_b128 a[196:199], v13 offset:1024
    v_accvgpr_write_b32 a109, v77
    v_mfma_f32_16x16x32_bf16 v[44:47], a[208:211], a[4:7], v[44:47]
    v_exp_f32 v132, v132
    v_mfma_f32_16x16x32_bf16 v[48:51], a[208:211], a[8:11], 0
    buffer_load_dword a252, v22, s[32:35], s42 offen offset:0
    v_mfma_f32_16x16x32_bf16 v[48:51], a[212:215], a[24:27], v[48:51]
    v_exp_f32 v133, v133
    v_mfma_f32_16x16x32_bf16 v[48:51], a[216:219], a[40:43], v[48:51]
    buffer_load_dwordx4 v4, s[12:15], s38 offen offset:128 lds
    v_mfma_f32_16x16x32_bf16 v[48:51], a[220:223], a[56:59], v[48:51]
    ds_read_b128 a[200:203], v12 offset:2048
    v_cvt_pk_bf16_f32 v132, v132, v133
    v_mfma_f32_16x16x32_bf16 v[48:51], a[224:227], a[72:75], v[48:51]
    v_exp_f32 v134, v134
    v_mfma_f32_16x16x32_bf16 v[48:51], a[228:231], a[88:91], v[48:51]
    ds_read_b128 a[204:207], v13 offset:2048
    v_accvgpr_write_b32 a110, v78
    v_mfma_f32_16x16x32_bf16 v[52:55], a[228:231], a[92:95], 0
    v_exp_f32 v135, v135
    v_mfma_f32_16x16x32_bf16 v[52:55], a[224:227], a[76:79], v[52:55]
    v_exp_f32 v140, v140
    v_mfma_f32_16x16x32_bf16 v[52:55], a[220:223], a[60:63], v[52:55]
    s_add_u32 m0, s49, 50944
    v_exp_f32 v141, v141
    v_mfma_f32_16x16x32_bf16 v[52:55], a[216:219], a[44:47], v[52:55]
    s_waitcnt lgkmcnt(2)
    v_exp_f32 v142, v142
    v_mfma_f32_16x16x32_bf16 v[52:55], a[212:215], a[28:31], v[52:55]
    v_exp_f32 v143, v143
    v_mfma_f32_16x16x32_bf16 v[52:55], a[208:211], a[12:15], v[52:55]
    v_exp_f32 v148, v148
    v_mfma_f32_16x16x32_bf16 a[164:167], a[240:243], v[124:127], a[164:167]
    v_exp_f32 v149, v149
    v_mfma_f32_16x16x32_bf16 a[180:183], a[244:247], v[124:127], a[180:183]
    v_cvt_pk_bf16_f32 v133, v134, v135
    v_cvt_pk_bf16_f32 v140, v140, v141
    v_mfma_f32_16x16x32_bf16 a[176:179], a[244:247], v[116:119], a[176:179]
    buffer_load_dwordx4 v4, s[12:15], s38 offen offset:256 lds
    v_mfma_f32_16x16x32_bf16 a[160:163], a[240:243], v[116:119], a[160:163]
    ds_read_b128 a[208:211], v12 offset:6144
    v_cvt_pk_bf16_f32 v141, v142, v143
    v_mfma_f32_16x16x32_bf16 a[156:159], a[240:243], v[108:111], a[156:159]
    ds_read_b128 a[212:215], v13 offset:6144
    v_cvt_pk_bf16_f32 v148, v148, v149
    v_mfma_f32_16x16x32_bf16 a[172:175], a[244:247], v[108:111], a[172:175]
    ds_read_b128 a[216:219], v12 offset:7168
    v_accvgpr_write_b32 a111, v79
    v_mfma_f32_16x16x32_bf16 a[168:171], a[244:247], v[100:103], a[168:171]
    v_exp_f32 v150, v150
    v_mfma_f32_16x16x32_bf16 a[152:155], a[240:243], v[100:103], a[152:155]
    v_exp_f32 v151, v151
    v_mfma_f32_16x16x32_bf16 v[160:163], a[184:187], a[0:3], 0
    s_add_u32 m0, s49, 52224
    ds_read_b128 a[220:223], v13 offset:7168
    v_cvt_pk_bf16_f32 v149, v150, v151
    v_mfma_f32_16x16x32_bf16 v[160:163], a[188:191], a[16:19], v[160:163]
pg_6:
    s_cbranch_execz pg_10
    s_waitcnt lgkmcnt(4)
    ds_read_b128 a[224:227], v12 offset:8192
    v_accvgpr_write_b32 a112, v80
    v_mfma_f32_16x16x32_bf16 v[160:163], a[192:195], a[32:35], v[160:163]
    v_exp_f32 v156, v156
    v_mfma_f32_16x16x32_bf16 v[160:163], a[196:199], a[48:51], v[160:163]
    v_exp_f32 v157, v157
    v_mfma_f32_16x16x32_bf16 v[160:163], a[200:203], a[64:67], v[160:163]
    ds_read_b128 a[228:231], v13 offset:8192
    v_cvt_pk_bf16_f32 v156, v156, v157
    v_mfma_f32_16x16x32_bf16 v[160:163], a[204:207], a[80:83], v[160:163]
    v_exp_f32 v158, v158
    v_mfma_f32_16x16x32_bf16 v[168:171], a[204:207], a[84:87], 0
    buffer_load_dwordx4 v5, s[12:15], s38 offen offset:0 lds
    v_mfma_f32_16x16x32_bf16 v[168:171], a[200:203], a[68:71], v[168:171]
    v_exp_f32 v159, v159
    v_mfma_f32_16x16x32_bf16 v[168:171], a[196:199], a[52:55], v[168:171]
    v_exp_f32 v40, v40
    v_mfma_f32_16x16x32_bf16 v[168:171], a[192:195], a[36:39], v[168:171]
    v_exp_f32 v41, v41
    v_mfma_f32_16x16x32_bf16 v[168:171], a[188:191], a[20:23], v[168:171]
    v_exp_f32 v42, v42
    v_mfma_f32_16x16x32_bf16 v[168:171], a[184:187], a[4:7], v[168:171]
    v_exp_f32 v43, v43
    v_mfma_f32_16x16x32_bf16 v[176:179], a[184:187], a[8:11], 0
    s_add_u32 m0, s49, 53120
    v_cvt_pk_bf16_f32 v157, v158, v159
    v_cvt_pk_bf16_f32 v134, v40, v41
    v_mfma_f32_16x16x32_bf16 v[176:179], a[188:191], a[24:27], v[176:179]
    v_exp_f32 v44, v44
    v_mfma_f32_16x16x32_bf16 v[176:179], a[192:195], a[40:43], v[176:179]
    v_exp_f32 v45, v45
    v_mfma_f32_16x16x32_bf16 v[176:179], a[196:199], a[56:59], v[176:179]
    v_exp_f32 v46, v46
    v_mfma_f32_16x16x32_bf16 v[176:179], a[200:203], a[72:75], v[176:179]
    v_exp_f32 v47, v47
    v_mfma_f32_16x16x32_bf16 v[176:179], a[204:207], a[88:91], v[176:179]
    v_cvt_pk_bf16_f32 v135, v42, v43
    v_cvt_pk_bf16_f32 v142, v44, v45
    v_mfma_f32_16x16x32_bf16 v[184:187], a[204:207], a[92:95], 0
    buffer_load_dwordx4 v5, s[12:15], s38 offen offset:128 lds
    v_mfma_f32_16x16x32_bf16 v[184:187], a[200:203], a[76:79], v[184:187]
    ds_read_b64_tr_b16 a[232:233], v8 offset:16384
    v_cvt_pk_bf16_f32 v143, v46, v47
    v_mfma_f32_16x16x32_bf16 v[184:187], a[196:199], a[60:63], v[184:187]
    ds_read_b64_tr_b16 a[234:235], v8 offset:18432
    v_accvgpr_write_b32 a113, v81
    v_mfma_f32_16x16x32_bf16 v[184:187], a[192:195], a[44:47], v[184:187]
    s_waitcnt lgkmcnt(2)
    ds_read_b64_tr_b16 a[236:237], v9 offset:16384
    v_accvgpr_write_b32 a114, v82
    v_mfma_f32_16x16x32_bf16 v[184:187], a[188:191], a[28:31], v[184:187]
    v_exp_f32 v48, v48
    v_mfma_f32_16x16x32_bf16 v[184:187], a[184:187], a[12:15], v[184:187]
    v_exp_f32 v49, v49
    v_mfma_f32_16x16x32_bf16 v[24:27], a[208:211], a[0:3], 0
    s_add_u32 m0, s49, 54016
    ds_read_b64_tr_b16 a[238:239], v9 offset:18432
    v_cvt_pk_bf16_f32 v150, v48, v49
    v_mfma_f32_16x16x32_bf16 v[24:27], a[212:215], a[16:19], v[24:27]
    v_exp_f32 v50, v50
    v_mfma_f32_16x16x32_bf16 v[24:27], a[216:219], a[32:35], v[24:27]
    ds_read_b128 a[184:187], v12 offset:12288
    v_accvgpr_write_b32 a115, v83
    v_mfma_f32_16x16x32_bf16 v[24:27], a[220:223], a[48:51], v[24:27]
    v_exp_f32 v51, v51
    v_mfma_f32_16x16x32_bf16 v[24:27], a[224:227], a[64:67], v[24:27]
    ds_read_b128 a[188:191], v13 offset:12288
    v_cvt_pk_bf16_f32 v151, v50, v51
    v_mfma_f32_16x16x32_bf16 v[24:27], a[228:231], a[80:83], v[24:27]
    v_exp_f32 v52, v52
    v_mfma_f32_16x16x32_bf16 v[28:31], a[228:231], a[84:87], 0
    buffer_load_dwordx4 v5, s[12:15], s38 offen offset:256 lds
    v_mfma_f32_16x16x32_bf16 v[28:31], a[224:227], a[68:71], v[28:31]
    s_add_u32 s38, s38, 24576
    v_exp_f32 v53, v53
    v_mfma_f32_16x16x32_bf16 v[28:31], a[220:223], a[52:55], v[28:31]
    ds_read_b128 a[192:195], v12 offset:13312
    v_cvt_pk_bf16_f32 v158, v52, v53
    v_mfma_f32_16x16x32_bf16 v[28:31], a[216:219], a[36:39], v[28:31]
    ds_read_b128 a[196:199], v13 offset:13312
    v_accvgpr_write_b32 a116, v84
    v_mfma_f32_16x16x32_bf16 v[28:31], a[212:215], a[20:23], v[28:31]
    s_add_u32 s39, s40, 122880
    v_exp_f32 v54, v54
    v_mfma_f32_16x16x32_bf16 v[28:31], a[208:211], a[4:7], v[28:31]
    v_exp_f32 v55, v55
    v_mfma_f32_16x16x32_bf16 v[32:35], a[208:211], a[8:11], 0
    s_add_u32 m0, s63, 114688
    ds_read_b128 a[200:203], v12 offset:14336
    v_cvt_pk_bf16_f32 v159, v54, v55
    v_mfma_f32_16x16x32_bf16 v[32:35], a[212:215], a[24:27], v[32:35]
    v_exp_f32 v160, v160
    v_mfma_f32_16x16x32_bf16 v[32:35], a[216:219], a[40:43], v[32:35]
    v_exp_f32 v161, v161
    v_mfma_f32_16x16x32_bf16 v[32:35], a[220:223], a[56:59], v[32:35]
    ds_read_b128 a[204:207], v13 offset:14336
    v_cvt_pk_bf16_f32 v160, v160, v161
    v_mfma_f32_16x16x32_bf16 v[32:35], a[224:227], a[72:75], v[32:35]
    v_exp_f32 v162, v162
    v_mfma_f32_16x16x32_bf16 v[32:35], a[228:231], a[88:91], v[32:35]
    v_exp_f32 v163, v163
    v_mfma_f32_16x16x32_bf16 v[36:39], a[228:231], a[92:95], 0
    buffer_load_dwordx4 v6, s[16:19], s39 offen lds
    v_mfma_f32_16x16x32_bf16 v[36:39], a[224:227], a[76:79], v[36:39]
    v_exp_f32 v168, v168
    v_mfma_f32_16x16x32_bf16 v[36:39], a[220:223], a[60:63], v[36:39]
    v_exp_f32 v169, v169
    v_mfma_f32_16x16x32_bf16 v[36:39], a[216:219], a[44:47], v[36:39]
    s_waitcnt lgkmcnt(1)
    v_exp_f32 v170, v170
    v_mfma_f32_16x16x32_bf16 v[36:39], a[212:215], a[28:31], v[36:39]
    s_add_u32 s39, s40, 135168
    v_exp_f32 v171, v171
    v_mfma_f32_16x16x32_bf16 v[36:39], a[208:211], a[12:15], v[36:39]
    v_exp_f32 v176, v176
    v_mfma_f32_16x16x32_bf16 a[152:155], a[232:235], v[128:131], a[152:155]
    s_add_u32 m0, s63, 118784
    v_cvt_pk_bf16_f32 v161, v162, v163
    v_cvt_pk_bf16_f32 v168, v168, v169
    v_mfma_f32_16x16x32_bf16 a[168:171], a[236:239], v[128:131], a[168:171]
    v_exp_f32 v177, v177
    v_mfma_f32_16x16x32_bf16 a[172:175], a[236:239], v[136:139], a[172:175]
    ds_read_b128 a[208:211], v12 offset:18432
    v_cvt_pk_bf16_f32 v169, v170, v171
    v_mfma_f32_16x16x32_bf16 a[156:159], a[232:235], v[136:139], a[156:159]
    ds_read_b128 a[212:215], v13 offset:18432
    v_cvt_pk_bf16_f32 v176, v176, v177
    v_mfma_f32_16x16x32_bf16 a[160:163], a[232:235], v[144:147], a[160:163]
    ds_read_b128 a[216:219], v12 offset:19456
    v_accvgpr_write_b32 a117, v85
    v_mfma_f32_16x16x32_bf16 a[176:179], a[236:239], v[144:147], a[176:179]
    ds_read_b128 a[220:223], v13 offset:19456
    v_accvgpr_write_b32 a118, v86
    v_mfma_f32_16x16x32_bf16 a[180:183], a[236:239], v[152:155], a[180:183]
    buffer_load_dwordx4 v6, s[16:19], s39 offen lds
    v_mfma_f32_16x16x32_bf16 a[164:167], a[232:235], v[152:155], a[164:167]
    ds_read_b128 a[224:227], v12 offset:20480
    v_accvgpr_write_b32 a119, v87
    v_mfma_f32_16x16x32_bf16 v[164:167], a[184:187], a[0:3], 0
    v_exp_f32 v178, v178
    v_mfma_f32_16x16x32_bf16 v[164:167], a[188:191], a[16:19], v[164:167]
    v_exp_f32 v179, v179
    v_mfma_f32_16x16x32_bf16 v[164:167], a[192:195], a[32:35], v[164:167]
    s_waitcnt lgkmcnt(3)
    ds_read_b128 a[228:231], v13 offset:20480
    v_cvt_pk_bf16_f32 v177, v178, v179
    v_mfma_f32_16x16x32_bf16 v[164:167], a[196:199], a[48:51], v[164:167]
    v_exp_f32 v184, v184
    v_mfma_f32_16x16x32_bf16 v[164:167], a[200:203], a[64:67], v[164:167]
    v_exp_f32 v185, v185
    v_mfma_f32_16x16x32_bf16 v[164:167], a[204:207], a[80:83], v[164:167]
    v_exp_f32 v186, v186
    v_mfma_f32_16x16x32_bf16 v[172:175], a[204:207], a[84:87], 0
    v_exp_f32 v187, v187
    v_mfma_f32_16x16x32_bf16 v[172:175], a[200:203], a[68:71], v[172:175]
    v_exp_f32 v24, v24
    v_mfma_f32_16x16x32_bf16 v[172:175], a[196:199], a[52:55], v[172:175]
    v_exp_f32 v25, v25
    v_mfma_f32_16x16x32_bf16 v[172:175], a[192:195], a[36:39], v[172:175]
    v_exp_f32 v26, v26
    v_mfma_f32_16x16x32_bf16 v[172:175], a[188:191], a[20:23], v[172:175]
    v_exp_f32 v27, v27
    v_mfma_f32_16x16x32_bf16 v[172:175], a[184:187], a[4:7], v[172:175]
    v_cvt_pk_bf16_f32 v184, v184, v185
    v_cvt_pk_bf16_f32 v185, v186, v187
    v_mfma_f32_16x16x32_bf16 v[180:183], a[184:187], a[8:11], 0
    v_exp_f32 v28, v28
    v_mfma_f32_16x16x32_bf16 v[180:183], a[188:191], a[24:27], v[180:183]
    v_exp_f32 v29, v29
    v_mfma_f32_16x16x32_bf16 v[180:183], a[192:195], a[40:43], v[180:183]
    v_exp_f32 v30, v30
    v_mfma_f32_16x16x32_bf16 v[180:183], a[196:199], a[56:59], v[180:183]
    v_exp_f32 v31, v31
    v_mfma_f32_16x16x32_bf16 v[180:183], a[200:203], a[72:75], v[180:183]
    v_cvt_pk_bf16_f32 v162, v24, v25
    v_cvt_pk_bf16_f32 v163, v26, v27
    v_mfma_f32_16x16x32_bf16 v[180:183], a[204:207], a[88:91], v[180:183]
    v_exp_f32 v32, v32
    v_mfma_f32_16x16x32_bf16 v[188:191], a[204:207], a[92:95], 0
    v_exp_f32 v33, v33
    v_mfma_f32_16x16x32_bf16 v[188:191], a[200:203], a[76:79], v[188:191]
    v_exp_f32 v34, v34
    v_mfma_f32_16x16x32_bf16 v[188:191], a[196:199], a[60:63], v[188:191]
    s_add_u32 m0, s49, 0
    v_exp_f32 v35, v35
    v_mfma_f32_16x16x32_bf16 v[188:191], a[192:195], a[44:47], v[188:191]
    v_cvt_pk_bf16_f32 v170, v28, v29
    v_cvt_pk_bf16_f32 v171, v30, v31
    v_mfma_f32_16x16x32_bf16 v[188:191], a[188:191], a[28:31], v[188:191]
    v_exp_f32 v36, v36
    v_mfma_f32_16x16x32_bf16 v[188:191], a[184:187], a[12:15], v[188:191]
    s_waitcnt lgkmcnt(0)
    v_exp_f32 v37, v37
    v_mfma_f32_16x16x32_bf16 v[40:43], a[208:211], a[0:3], 0
    s_waitcnt vmcnt(11)
    v_exp_f32 v38, v38
    v_mfma_f32_16x16x32_bf16 v[40:43], a[212:215], a[16:19], v[40:43]
    s_barrier
    v_mfma_f32_16x16x32_bf16 v[40:43], a[216:219], a[32:35], v[40:43]
    buffer_load_dwordx4 v4, s[12:15], s38 offen offset:0 lds
    v_mfma_f32_16x16x32_bf16 v[40:43], a[220:223], a[48:51], v[40:43]
    ds_read_b64_tr_b16 a[240:241], v8 offset:20480
    v_cvt_pk_bf16_f32 v178, v32, v33
    v_mfma_f32_16x16x32_bf16 v[40:43], a[224:227], a[64:67], v[40:43]
    ds_read_b64_tr_b16 a[242:243], v8 offset:22528
    v_cvt_pk_bf16_f32 v179, v34, v35
    v_mfma_f32_16x16x32_bf16 v[40:43], a[228:231], a[80:83], v[40:43]
    ds_read_b64_tr_b16 a[244:245], v9 offset:20480
    v_cvt_pk_bf16_f32 v186, v36, v37
    v_mfma_f32_16x16x32_bf16 v[44:47], a[228:231], a[84:87], 0
    ds_read_b64_tr_b16 a[246:247], v9 offset:22528
    v_accvgpr_write_b32 a120, v88
    v_mfma_f32_16x16x32_bf16 v[44:47], a[224:227], a[68:71], v[44:47]
    ds_read_b128 a[184:187], v12 offset:24576
    v_accvgpr_write_b32 a121, v89
    v_mfma_f32_16x16x32_bf16 v[44:47], a[220:223], a[52:55], v[44:47]
    s_add_u32 m0, s49, 896
    ds_read_b128 a[188:191], v13 offset:24576
    v_accvgpr_write_b32 a122, v90
    v_mfma_f32_16x16x32_bf16 v[44:47], a[216:219], a[36:39], v[44:47]
    ds_read_b128 a[192:195], v12 offset:25600
    v_accvgpr_write_b32 a123, v91
    v_mfma_f32_16x16x32_bf16 v[44:47], a[212:215], a[20:23], v[44:47]
    v_exp_f32 v39, v39
    v_mfma_f32_16x16x32_bf16 v[44:47], a[208:211], a[4:7], v[44:47]
    ds_read_b128 a[196:199], v13 offset:25600
    v_cvt_pk_bf16_f32 v187, v38, v39
    v_mfma_f32_16x16x32_bf16 v[48:51], a[208:211], a[8:11], 0
    buffer_load_dword a252, v22, s[32:35], s42 offen offset:1536
    s_add_u32 s42, s42, 3072
    v_mfma_f32_16x16x32_bf16 v[48:51], a[212:215], a[24:27], v[48:51]
    v_exp_f32 v164, v164
    v_mfma_f32_16x16x32_bf16 v[48:51], a[216:219], a[40:43], v[48:51]
    buffer_load_dwordx4 v4, s[12:15], s38 offen offset:128 lds
    v_mfma_f32_16x16x32_bf16 v[48:51], a[220:223], a[56:59], v[48:51]
    ds_read_b128 a[200:203], v12 offset:26624
    v_accvgpr_write_b32 a124, v92
    v_mfma_f32_16x16x32_bf16 v[48:51], a[224:227], a[72:75], v[48:51]
    v_exp_f32 v165, v165
    v_mfma_f32_16x16x32_bf16 v[48:51], a[228:231], a[88:91], v[48:51]
    ds_read_b128 a[204:207], v13 offset:26624
    v_cvt_pk_bf16_f32 v164, v164, v165
    v_mfma_f32_16x16x32_bf16 v[52:55], a[228:231], a[92:95], 0
    v_exp_f32 v166, v166
    v_mfma_f32_16x16x32_bf16 v[52:55], a[224:227], a[76:79], v[52:55]
    v_exp_f32 v167, v167
    v_mfma_f32_16x16x32_bf16 v[52:55], a[220:223], a[60:63], v[52:55]
    s_add_u32 m0, s49, 1792
    v_exp_f32 v172, v172
    v_mfma_f32_16x16x32_bf16 v[52:55], a[216:219], a[44:47], v[52:55]
    s_waitcnt lgkmcnt(2)
    v_exp_f32 v173, v173
    v_mfma_f32_16x16x32_bf16 v[52:55], a[212:215], a[28:31], v[52:55]
    v_exp_f32 v174, v174
    v_mfma_f32_16x16x32_bf16 v[52:55], a[208:211], a[12:15], v[52:55]
    v_exp_f32 v175, v175
    v_mfma_f32_16x16x32_bf16 a[164:167], a[240:243], v[156:159], a[164:167]
    v_exp_f32 v180, v180
    v_mfma_f32_16x16x32_bf16 a[180:183], a[244:247], v[156:159], a[180:183]
    v_exp_f32 v181, v181
    v_mfma_f32_16x16x32_bf16 a[176:179], a[244:247], v[148:151], a[176:179]
    buffer_load_dwordx4 v4, s[12:15], s38 offen offset:256 lds
    v_mfma_f32_16x16x32_bf16 a[160:163], a[240:243], v[148:151], a[160:163]
    ds_read_b128 a[208:211], v12 offset:30720
    v_cvt_pk_bf16_f32 v165, v166, v167
    v_mfma_f32_16x16x32_bf16 a[156:159], a[240:243], v[140:143], a[156:159]
    ds_read_b128 a[212:215], v13 offset:30720
    v_cvt_pk_bf16_f32 v172, v172, v173
    v_mfma_f32_16x16x32_bf16 a[172:175], a[244:247], v[140:143], a[172:175]
    ds_read_b128 a[216:219], v12 offset:31744
    v_cvt_pk_bf16_f32 v173, v174, v175
    v_mfma_f32_16x16x32_bf16 a[168:171], a[244:247], v[132:135], a[168:171]
    ds_read_b128 a[220:223], v13 offset:31744
    v_cvt_pk_bf16_f32 v180, v180, v181
    v_mfma_f32_16x16x32_bf16 a[152:155], a[240:243], v[132:135], a[152:155]
    ds_read_b128 a[224:227], v12 offset:32768
    v_accvgpr_write_b32 a125, v93
    v_mfma_f32_16x16x32_bf16 v[192:195], a[184:187], a[0:3], 0
    s_add_u32 m0, s49, 3072
    ds_read_b128 a[228:231], v13 offset:32768
    v_accvgpr_write_b32 a126, v94
    v_mfma_f32_16x16x32_bf16 v[192:195], a[188:191], a[16:19], v[192:195]
    s_waitcnt lgkmcnt(6)
    v_exp_f32 v182, v182
    v_mfma_f32_16x16x32_bf16 v[192:195], a[192:195], a[32:35], v[192:195]
    v_exp_f32 v183, v183
    v_mfma_f32_16x16x32_bf16 v[192:195], a[196:199], a[48:51], v[192:195]
    v_exp_f32 v188, v188
    v_mfma_f32_16x16x32_bf16 v[192:195], a[200:203], a[64:67], v[192:195]
    v_exp_f32 v189, v189
    v_mfma_f32_16x16x32_bf16 v[192:195], a[204:207], a[80:83], v[192:195]
    v_exp_f32 v190, v190
    v_mfma_f32_16x16x32_bf16 v[200:203], a[204:207], a[84:87], 0
    buffer_load_dwordx4 v5, s[12:15], s38 offen offset:0 lds
    v_mfma_f32_16x16x32_bf16 v[200:203], a[200:203], a[68:71], v[200:203]
    v_exp_f32 v191, v191
    v_mfma_f32_16x16x32_bf16 v[200:203], a[196:199], a[52:55], v[200:203]
    v_exp_f32 v40, v40
    v_mfma_f32_16x16x32_bf16 v[200:203], a[192:195], a[36:39], v[200:203]
    v_exp_f32 v41, v41
    v_mfma_f32_16x16x32_bf16 v[200:203], a[188:191], a[20:23], v[200:203]
    v_cvt_pk_bf16_f32 v181, v182, v183
    v_cvt_pk_bf16_f32 v188, v188, v189
    v_mfma_f32_16x16x32_bf16 v[200:203], a[184:187], a[4:7], v[200:203]
    v_exp_f32 v42, v42
    v_mfma_f32_16x16x32_bf16 v[208:211], a[184:187], a[8:11], 0
    s_add_u32 m0, s49, 3968
    v_exp_f32 v43, v43
    v_mfma_f32_16x16x32_bf16 v[208:211], a[188:191], a[24:27], v[208:211]
    v_cvt_pk_bf16_f32 v189, v190, v191
    v_cvt_pk_bf16_f32 v166, v40, v41
    v_mfma_f32_16x16x32_bf16 v[208:211], a[192:195], a[40:43], v[208:211]
    v_exp_f32 v44, v44
    v_mfma_f32_16x16x32_bf16 v[208:211], a[196:199], a[56:59], v[208:211]
    v_exp_f32 v45, v45
    v_mfma_f32_16x16x32_bf16 v[208:211], a[200:203], a[72:75], v[208:211]
    v_exp_f32 v46, v46
    v_mfma_f32_16x16x32_bf16 v[208:211], a[204:207], a[88:91], v[208:211]
    v_exp_f32 v47, v47
    v_mfma_f32_16x16x32_bf16 v[216:219], a[204:207], a[92:95], 0
    buffer_load_dwordx4 v5, s[12:15], s38 offen offset:128 lds
    v_mfma_f32_16x16x32_bf16 v[216:219], a[200:203], a[76:79], v[216:219]
    ds_read_b64_tr_b16 a[232:233], v8 offset:24576
    v_cvt_pk_bf16_f32 v167, v42, v43
    v_mfma_f32_16x16x32_bf16 v[216:219], a[196:199], a[60:63], v[216:219]
    ds_read_b64_tr_b16 a[234:235], v8 offset:26624
    v_cvt_pk_bf16_f32 v174, v44, v45
    v_mfma_f32_16x16x32_bf16 v[216:219], a[192:195], a[44:47], v[216:219]
    s_waitcnt lgkmcnt(2)
    ds_read_b64_tr_b16 a[236:237], v9 offset:24576
    v_cvt_pk_bf16_f32 v175, v46, v47
    v_mfma_f32_16x16x32_bf16 v[216:219], a[188:191], a[28:31], v[216:219]
    ds_read_b64_tr_b16 a[238:239], v9 offset:26624
    v_accvgpr_write_b32 a127, v95
    v_mfma_f32_16x16x32_bf16 v[216:219], a[184:187], a[12:15], v[216:219]
    v_exp_f32 v48, v48
    v_mfma_f32_16x16x32_bf16 v[24:27], a[208:211], a[0:3], 0
    s_add_u32 m0, s49, 4864
    v_exp_f32 v49, v49
    v_mfma_f32_16x16x32_bf16 v[24:27], a[212:215], a[16:19], v[24:27]
    v_exp_f32 v50, v50
    v_mfma_f32_16x16x32_bf16 v[24:27], a[216:219], a[32:35], v[24:27]
    ds_read_b128 a[184:187], v12 offset:36864
    v_cvt_pk_bf16_f32 v182, v48, v49
    v_mfma_f32_16x16x32_bf16 v[24:27], a[220:223], a[48:51], v[24:27]
    ds_read_b128 a[188:191], v13 offset:36864
    v_accvgpr_write_b32 a128, v96
    v_mfma_f32_16x16x32_bf16 v[24:27], a[224:227], a[64:67], v[24:27]
    ds_read_b128 a[192:195], v12 offset:37888
    v_accvgpr_write_b32 a129, v97
    v_mfma_f32_16x16x32_bf16 v[24:27], a[228:231], a[80:83], v[24:27]
    ds_read_b128 a[196:199], v13 offset:37888
    v_accvgpr_write_b32 a130, v98
    v_mfma_f32_16x16x32_bf16 v[28:31], a[228:231], a[84:87], 0
    buffer_load_dwordx4 v5, s[12:15], s38 offen offset:256 lds
    v_mfma_f32_16x16x32_bf16 v[28:31], a[224:227], a[68:71], v[28:31]
    s_add_u32 s38, s38, 24576
    v_exp_f32 v51, v51
    v_mfma_f32_16x16x32_bf16 v[28:31], a[220:223], a[52:55], v[28:31]
    ds_read_b128 a[200:203], v12 offset:38912
    v_cvt_pk_bf16_f32 v183, v50, v51
    v_mfma_f32_16x16x32_bf16 v[28:31], a[216:219], a[36:39], v[28:31]
    v_exp_f32 v52, v52
    v_mfma_f32_16x16x32_bf16 v[28:31], a[212:215], a[20:23], v[28:31]
    s_add_u32 s39, s40, 147456
    v_exp_f32 v53, v53
    v_mfma_f32_16x16x32_bf16 v[28:31], a[208:211], a[4:7], v[28:31]
    ds_read_b128 a[204:207], v13 offset:38912
    v_cvt_pk_bf16_f32 v190, v52, v53
    v_mfma_f32_16x16x32_bf16 v[32:35], a[208:211], a[8:11], 0
    s_add_u32 m0, s63, 122880
    v_exp_f32 v54, v54
    v_mfma_f32_16x16x32_bf16 v[32:35], a[212:215], a[24:27], v[32:35]
    v_exp_f32 v55, v55
    v_mfma_f32_16x16x32_bf16 v[32:35], a[216:219], a[40:43], v[32:35]
    v_exp_f32 v192, v192
    v_mfma_f32_16x16x32_bf16 v[32:35], a[220:223], a[56:59], v[32:35]
    v_exp_f32 v193, v193
    v_mfma_f32_16x16x32_bf16 v[32:35], a[224:227], a[72:75], v[32:35]
    v_exp_f32 v194, v194
    v_mfma_f32_16x16x32_bf16 v[32:35], a[228:231], a[88:91], v[32:35]
    v_exp_f32 v195, v195
    v_mfma_f32_16x16x32_bf16 v[36:39], a[228:231], a[92:95], 0
    buffer_load_dwordx4 v6, s[16:19], s39 offen lds
    v_mfma_f32_16x16x32_bf16 v[36:39], a[224:227], a[76:79], v[36:39]
    v_exp_f32 v200, v200
    v_mfma_f32_16x16x32_bf16 v[36:39], a[220:223], a[60:63], v[36:39]
    v_exp_f32 v201, v201
    v_mfma_f32_16x16x32_bf16 v[36:39], a[216:219], a[44:47], v[36:39]
    s_waitcnt lgkmcnt(0)
    v_cvt_pk_bf16_f32 v191, v54, v55
    v_cvt_pk_bf16_f32 v192, v192, v193
    v_mfma_f32_16x16x32_bf16 v[36:39], a[212:215], a[28:31], v[36:39]
    s_add_u32 s39, s40, 159744
    v_exp_f32 v202, v202
    v_mfma_f32_16x16x32_bf16 v[36:39], a[208:211], a[12:15], v[36:39]
    v_exp_f32 v203, v203
    v_mfma_f32_16x16x32_bf16 a[152:155], a[232:235], v[160:163], a[152:155]
    s_add_u32 m0, s63, 126976
    v_cvt_pk_bf16_f32 v193, v194, v195
    v_cvt_pk_bf16_f32 v200, v200, v201
    v_mfma_f32_16x16x32_bf16 a[168:171], a[236:239], v[160:163], a[168:171]
    v_exp_f32 v208, v208
    v_mfma_f32_16x16x32_bf16 a[172:175], a[236:239], v[168:171], a[172:175]
    ds_read_b128 a[208:211], v12 offset:43008
    v_cvt_pk_bf16_f32 v201, v202, v203
    v_mfma_f32_16x16x32_bf16 a[156:159], a[232:235], v[168:171], a[156:159]
    ds_read_b128 a[212:215], v13 offset:43008
    v_accvgpr_write_b32 a131, v99
    v_mfma_f32_16x16x32_bf16 a[160:163], a[232:235], v[176:179], a[160:163]
    ds_read_b128 a[216:219], v12 offset:44032
    v_accvgpr_write_b32 a132, v100
    v_mfma_f32_16x16x32_bf16 a[176:179], a[236:239], v[176:179], a[176:179]
    ds_read_b128 a[220:223], v13 offset:44032
    v_accvgpr_write_b32 a133, v101
    v_mfma_f32_16x16x32_bf16 a[180:183], a[236:239], v[184:187], a[180:183]
    buffer_load_dwordx4 v6, s[16:19], s39 offen lds
    v_mfma_f32_16x16x32_bf16 a[164:167], a[232:235], v[184:187], a[164:167]
    v_exp_f32 v209, v209
    v_mfma_f32_16x16x32_bf16 v[196:199], a[184:187], a[0:3], 0
    ds_read_b128 a[224:227], v12 offset:45056
    v_cvt_pk_bf16_f32 v208, v208, v209
    v_mfma_f32_16x16x32_bf16 v[196:199], a[188:191], a[16:19], v[196:199]
    v_exp_f32 v210, v210
    v_mfma_f32_16x16x32_bf16 v[196:199], a[192:195], a[32:35], v[196:199]
    v_exp_f32 v211, v211
    v_mfma_f32_16x16x32_bf16 v[196:199], a[196:199], a[48:51], v[196:199]
    ds_read_b128 a[228:231], v13 offset:45056
    v_cvt_pk_bf16_f32 v209, v210, v211
    v_mfma_f32_16x16x32_bf16 v[196:199], a[200:203], a[64:67], v[196:199]
    v_exp_f32 v216, v216
    v_mfma_f32_16x16x32_bf16 v[196:199], a[204:207], a[80:83], v[196:199]
    v_exp_f32 v217, v217
    v_mfma_f32_16x16x32_bf16 v[204:207], a[204:207], a[84:87], 0
    v_exp_f32 v218, v218
    v_mfma_f32_16x16x32_bf16 v[204:207], a[200:203], a[68:71], v[204:207]
    v_exp_f32 v219, v219
    v_mfma_f32_16x16x32_bf16 v[204:207], a[196:199], a[52:55], v[204:207]
    v_exp_f32 v24, v24
    v_mfma_f32_16x16x32_bf16 v[204:207], a[192:195], a[36:39], v[204:207]
    v_exp_f32 v25, v25
    v_mfma_f32_16x16x32_bf16 v[204:207], a[188:191], a[20:23], v[204:207]
    v_exp_f32 v26, v26
    v_mfma_f32_16x16x32_bf16 v[204:207], a[184:187], a[4:7], v[204:207]
    v_exp_f32 v27, v27
    v_mfma_f32_16x16x32_bf16 v[212:215], a[184:187], a[8:11], 0
    v_cvt_pk_bf16_f32 v216, v216, v217
    v_cvt_pk_bf16_f32 v217, v218, v219
    v_mfma_f32_16x16x32_bf16 v[212:215], a[188:191], a[24:27], v[212:215]
    v_exp_f32 v28, v28
    v_mfma_f32_16x16x32_bf16 v[212:215], a[192:195], a[40:43], v[212:215]
    v_exp_f32 v29, v29
    v_mfma_f32_16x16x32_bf16 v[212:215], a[196:199], a[56:59], v[212:215]
    v_exp_f32 v30, v30
    v_mfma_f32_16x16x32_bf16 v[212:215], a[200:203], a[72:75], v[212:215]
    v_exp_f32 v31, v31
    v_mfma_f32_16x16x32_bf16 v[212:215], a[204:207], a[88:91], v[212:215]
    v_cvt_pk_bf16_f32 v194, v24, v25
    v_cvt_pk_bf16_f32 v195, v26, v27
    v_mfma_f32_16x16x32_bf16 v[220:223], a[204:207], a[92:95], 0
    v_exp_f32 v32, v32
    v_mfma_f32_16x16x32_bf16 v[220:223], a[200:203], a[76:79], v[220:223]
    v_exp_f32 v33, v33
    v_mfma_f32_16x16x32_bf16 v[220:223], a[196:199], a[60:63], v[220:223]
    s_add_u32 m0, s49, 24576
    v_exp_f32 v34, v34
    v_mfma_f32_16x16x32_bf16 v[220:223], a[192:195], a[44:47], v[220:223]
    s_waitcnt lgkmcnt(0)
    v_exp_f32 v35, v35
    v_mfma_f32_16x16x32_bf16 v[220:223], a[188:191], a[28:31], v[220:223]
    v_cvt_pk_bf16_f32 v202, v28, v29
    v_cvt_pk_bf16_f32 v203, v30, v31
    v_mfma_f32_16x16x32_bf16 v[220:223], a[184:187], a[12:15], v[220:223]
    v_exp_f32 v36, v36
    v_mfma_f32_16x16x32_bf16 v[40:43], a[208:211], a[0:3], 0
    s_waitcnt vmcnt(11)
    v_exp_f32 v37, v37
    v_mfma_f32_16x16x32_bf16 v[40:43], a[212:215], a[16:19], v[40:43]
    s_barrier
    v_mfma_f32_16x16x32_bf16 v[40:43], a[216:219], a[32:35], v[40:43]
    buffer_load_dwordx4 v4, s[12:15], s38 offen offset:0 lds
    v_mfma_f32_16x16x32_bf16 v[40:43], a[220:223], a[48:51], v[40:43]
    ds_read_b64_tr_b16 a[240:241], v8 offset:28672
    v_cvt_pk_bf16_f32 v210, v32, v33
    v_mfma_f32_16x16x32_bf16 v[40:43], a[224:227], a[64:67], v[40:43]
    ds_read_b64_tr_b16 a[242:243], v8 offset:30720
    v_cvt_pk_bf16_f32 v211, v34, v35
    v_mfma_f32_16x16x32_bf16 v[40:43], a[228:231], a[80:83], v[40:43]
    ds_read_b64_tr_b16 a[244:245], v9 offset:28672
    v_cvt_pk_bf16_f32 v218, v36, v37
    v_mfma_f32_16x16x32_bf16 v[44:47], a[228:231], a[84:87], 0
    ds_read_b64_tr_b16 a[246:247], v9 offset:30720
    v_accvgpr_write_b32 a134, v102
    v_mfma_f32_16x16x32_bf16 v[44:47], a[224:227], a[68:71], v[44:47]
    ds_read_b128 a[184:187], v12 offset:49152
    v_accvgpr_write_b32 a135, v103
    v_mfma_f32_16x16x32_bf16 v[44:47], a[220:223], a[52:55], v[44:47]
    s_add_u32 m0, s49, 25472
    ds_read_b128 a[188:191], v13 offset:49152
    v_accvgpr_write_b32 a136, v104
    v_mfma_f32_16x16x32_bf16 v[44:47], a[216:219], a[36:39], v[44:47]
    ds_read_b128 a[192:195], v12 offset:50176
    v_accvgpr_write_b32 a137, v105
    v_mfma_f32_16x16x32_bf16 v[44:47], a[212:215], a[20:23], v[44:47]
    v_exp_f32 v38, v38
    v_mfma_f32_16x16x32_bf16 v[44:47], a[208:211], a[4:7], v[44:47]
    v_exp_f32 v39, v39
    v_mfma_f32_16x16x32_bf16 v[48:51], a[208:211], a[8:11], 0
    buffer_load_dword a252, v22, s[32:35], s42 offen offset:0
    v_mfma_f32_16x16x32_bf16 v[48:51], a[212:215], a[24:27], v[48:51]
    s_add_u32 s32, s7, 1
    ds_read_b128 a[196:199], v13 offset:50176
    v_cvt_pk_bf16_f32 v219, v38, v39
    v_mfma_f32_16x16x32_bf16 v[48:51], a[216:219], a[40:43], v[48:51]
    buffer_load_dwordx4 v4, s[12:15], s38 offen offset:128 lds
    v_mfma_f32_16x16x32_bf16 v[48:51], a[220:223], a[56:59], v[48:51]
    s_add_u32 s33, s7, 1
    ds_read_b128 a[200:203], v12 offset:51200
    v_accvgpr_write_b32 a138, v106
    v_mfma_f32_16x16x32_bf16 v[48:51], a[224:227], a[72:75], v[48:51]
    s_add_u32 s34, s7, 1
    v_exp_f32 v196, v196
    v_mfma_f32_16x16x32_bf16 v[48:51], a[228:231], a[88:91], v[48:51]
    s_add_u32 s35, s7, 1
    v_exp_f32 v197, v197
    v_mfma_f32_16x16x32_bf16 v[52:55], a[228:231], a[92:95], 0
    ds_read_b128 a[204:207], v13 offset:51200
    v_cvt_pk_bf16_f32 v196, v196, v197
    v_mfma_f32_16x16x32_bf16 v[52:55], a[224:227], a[76:79], v[52:55]
    v_exp_f32 v198, v198
    v_mfma_f32_16x16x32_bf16 v[52:55], a[220:223], a[60:63], v[52:55]
    s_add_u32 m0, s49, 26368
    v_exp_f32 v199, v199
    v_mfma_f32_16x16x32_bf16 v[52:55], a[216:219], a[44:47], v[52:55]
    s_waitcnt lgkmcnt(2)
    v_exp_f32 v204, v204
    v_mfma_f32_16x16x32_bf16 v[52:55], a[212:215], a[28:31], v[52:55]
    v_exp_f32 v205, v205
    v_mfma_f32_16x16x32_bf16 v[52:55], a[208:211], a[12:15], v[52:55]
    v_exp_f32 v206, v206
    v_mfma_f32_16x16x32_bf16 a[164:167], a[240:243], v[188:191], a[164:167]
    v_exp_f32 v207, v207
    v_mfma_f32_16x16x32_bf16 a[180:183], a[244:247], v[188:191], a[180:183]
    v_exp_f32 v212, v212
    v_mfma_f32_16x16x32_bf16 a[176:179], a[244:247], v[180:183], a[176:179]
    buffer_load_dwordx4 v4, s[12:15], s38 offen offset:256 lds
    v_mfma_f32_16x16x32_bf16 a[160:163], a[240:243], v[180:183], a[160:163]
    ds_read_b128 a[208:211], v12 offset:55296
    v_cvt_pk_bf16_f32 v197, v198, v199
    v_mfma_f32_16x16x32_bf16 a[156:159], a[240:243], v[172:175], a[156:159]
    ds_read_b128 a[212:215], v13 offset:55296
    v_cvt_pk_bf16_f32 v204, v204, v205
    v_mfma_f32_16x16x32_bf16 a[172:175], a[244:247], v[172:175], a[172:175]
    ds_read_b128 a[216:219], v12 offset:56320
    v_cvt_pk_bf16_f32 v205, v206, v207
    v_mfma_f32_16x16x32_bf16 a[168:171], a[244:247], v[164:167], a[168:171]
    ds_read_b128 a[220:223], v13 offset:56320
    v_accvgpr_write_b32 a139, v107
    v_mfma_f32_16x16x32_bf16 a[152:155], a[240:243], v[164:167], a[152:155]
    ds_read_b128 a[224:227], v12 offset:57344
    v_accvgpr_write_b32 a140, v108
    v_mfma_f32_16x16x32_bf16 v[224:227], a[184:187], a[0:3], 0
    s_add_u32 m0, s49, 27648
    v_exp_f32 v213, v213
    v_mfma_f32_16x16x32_bf16 v[224:227], a[188:191], a[16:19], v[224:227]
    s_waitcnt lgkmcnt(5)
    ds_read_b128 a[228:231], v13 offset:57344
    v_cvt_pk_bf16_f32 v212, v212, v213
    v_mfma_f32_16x16x32_bf16 v[224:227], a[192:195], a[32:35], v[224:227]
    v_exp_f32 v214, v214
    v_mfma_f32_16x16x32_bf16 v[224:227], a[196:199], a[48:51], v[224:227]
    v_exp_f32 v215, v215
    v_mfma_f32_16x16x32_bf16 v[224:227], a[200:203], a[64:67], v[224:227]
    v_exp_f32 v220, v220
    v_mfma_f32_16x16x32_bf16 v[224:227], a[204:207], a[80:83], v[224:227]
    v_exp_f32 v221, v221
    v_mfma_f32_16x16x32_bf16 v[232:235], a[204:207], a[84:87], 0
    buffer_load_dwordx4 v5, s[12:15], s38 offen offset:0 lds
    v_mfma_f32_16x16x32_bf16 v[232:235], a[200:203], a[68:71], v[232:235]
    v_exp_f32 v222, v222
    v_mfma_f32_16x16x32_bf16 v[232:235], a[196:199], a[52:55], v[232:235]
    v_exp_f32 v223, v223
    v_mfma_f32_16x16x32_bf16 v[232:235], a[192:195], a[36:39], v[232:235]
    v_exp_f32 v40, v40
    v_mfma_f32_16x16x32_bf16 v[232:235], a[188:191], a[20:23], v[232:235]
pg_7:
    s_cbranch_execz pg_11
    v_exp_f32 v41, v41
    v_mfma_f32_16x16x32_bf16 v[232:235], a[184:187], a[4:7], v[232:235]
    v_cvt_pk_bf16_f32 v213, v214, v215
    v_cvt_pk_bf16_f32 v220, v220, v221
    v_mfma_f32_16x16x32_bf16 v[240:243], a[184:187], a[8:11], 0
    s_add_u32 m0, s49, 28544
    v_exp_f32 v42, v42
    v_mfma_f32_16x16x32_bf16 v[240:243], a[188:191], a[24:27], v[240:243]
    v_exp_f32 v43, v43
    v_mfma_f32_16x16x32_bf16 v[240:243], a[192:195], a[40:43], v[240:243]
    v_cvt_pk_bf16_f32 v221, v222, v223
    v_cvt_pk_bf16_f32 v198, v40, v41
    v_mfma_f32_16x16x32_bf16 v[240:243], a[196:199], a[56:59], v[240:243]
    v_exp_f32 v44, v44
    v_mfma_f32_16x16x32_bf16 v[240:243], a[200:203], a[72:75], v[240:243]
    v_exp_f32 v45, v45
    v_mfma_f32_16x16x32_bf16 v[240:243], a[204:207], a[88:91], v[240:243]
    v_exp_f32 v46, v46
    v_mfma_f32_16x16x32_bf16 v[248:251], a[204:207], a[92:95], 0
    buffer_load_dwordx4 v5, s[12:15], s38 offen offset:128 lds
    v_mfma_f32_16x16x32_bf16 v[248:251], a[200:203], a[76:79], v[248:251]
    ds_read_b64_tr_b16 a[232:233], v8 offset:32768
    v_cvt_pk_bf16_f32 v199, v42, v43
    v_mfma_f32_16x16x32_bf16 v[248:251], a[196:199], a[60:63], v[248:251]
    ds_read_b64_tr_b16 a[234:235], v8 offset:34816
    v_cvt_pk_bf16_f32 v206, v44, v45
    v_mfma_f32_16x16x32_bf16 v[248:251], a[192:195], a[44:47], v[248:251]
    s_waitcnt lgkmcnt(2)
    ds_read_b64_tr_b16 a[236:237], v9 offset:32768
    v_accvgpr_write_b32 a141, v109
    v_mfma_f32_16x16x32_bf16 v[248:251], a[188:191], a[28:31], v[248:251]
    ds_read_b64_tr_b16 a[238:239], v9 offset:34816
    v_accvgpr_write_b32 a142, v110
    v_mfma_f32_16x16x32_bf16 v[248:251], a[184:187], a[12:15], v[248:251]
    v_exp_f32 v47, v47
    v_mfma_f32_16x16x32_bf16 v[24:27], a[208:211], a[0:3], 0
    s_add_u32 m0, s49, 29440
    v_exp_f32 v48, v48
    v_mfma_f32_16x16x32_bf16 v[24:27], a[212:215], a[16:19], v[24:27]
    v_exp_f32 v49, v49
    v_mfma_f32_16x16x32_bf16 v[24:27], a[216:219], a[32:35], v[24:27]
    ds_read_b128 a[184:187], v12 offset:61440
    v_cvt_pk_bf16_f32 v207, v46, v47
    v_mfma_f32_16x16x32_bf16 v[24:27], a[220:223], a[48:51], v[24:27]
    ds_read_b128 a[188:191], v13 offset:61440
    v_cvt_pk_bf16_f32 v214, v48, v49
    v_mfma_f32_16x16x32_bf16 v[24:27], a[224:227], a[64:67], v[24:27]
    ds_read_b128 a[192:195], v12 offset:62464
    v_accvgpr_write_b32 a143, v111
    v_mfma_f32_16x16x32_bf16 v[24:27], a[228:231], a[80:83], v[24:27]
    ds_read_b128 a[196:199], v13 offset:62464
    v_accvgpr_write_b32 a144, v112
    v_mfma_f32_16x16x32_bf16 v[28:31], a[228:231], a[84:87], 0
    buffer_load_dwordx4 v5, s[12:15], s38 offen offset:256 lds
    v_mfma_f32_16x16x32_bf16 v[28:31], a[224:227], a[68:71], v[28:31]
    s_add_u32 s38, s38, 24576
    v_exp_f32 v50, v50
    v_mfma_f32_16x16x32_bf16 v[28:31], a[220:223], a[52:55], v[28:31]
    v_exp_f32 v51, v51
    v_mfma_f32_16x16x32_bf16 v[28:31], a[216:219], a[36:39], v[28:31]
    ds_read_b128 a[200:203], v12 offset:63488
    v_cvt_pk_bf16_f32 v215, v50, v51
    v_mfma_f32_16x16x32_bf16 v[28:31], a[212:215], a[20:23], v[28:31]
    s_add_u32 s39, s40, 172032
    ds_read_b128 a[204:207], v13 offset:63488
    v_add_u32 v12, 67584, v12
    v_mfma_f32_16x16x32_bf16 v[28:31], a[208:211], a[4:7], v[28:31]
    v_exp_f32 v52, v52
    v_mfma_f32_16x16x32_bf16 v[32:35], a[208:211], a[8:11], 0
    s_add_u32 m0, s63, 131072
    v_exp_f32 v53, v53
    v_mfma_f32_16x16x32_bf16 v[32:35], a[212:215], a[24:27], v[32:35]
    v_exp_f32 v54, v54
    v_mfma_f32_16x16x32_bf16 v[32:35], a[216:219], a[40:43], v[32:35]
    v_exp_f32 v55, v55
    v_mfma_f32_16x16x32_bf16 v[32:35], a[220:223], a[56:59], v[32:35]
    v_cvt_pk_bf16_f32 v222, v52, v53
    v_cvt_pk_bf16_f32 v223, v54, v55
    v_mfma_f32_16x16x32_bf16 v[32:35], a[224:227], a[72:75], v[32:35]
    v_exp_f32 v224, v224
    v_mfma_f32_16x16x32_bf16 v[32:35], a[228:231], a[88:91], v[32:35]
    v_exp_f32 v225, v225
    v_mfma_f32_16x16x32_bf16 v[36:39], a[228:231], a[92:95], 0
    buffer_load_dwordx4 v6, s[16:19], s39 offen lds
    v_mfma_f32_16x16x32_bf16 v[36:39], a[224:227], a[76:79], v[36:39]
    v_exp_f32 v226, v226
    v_mfma_f32_16x16x32_bf16 v[36:39], a[220:223], a[60:63], v[36:39]
    v_exp_f32 v227, v227
    v_mfma_f32_16x16x32_bf16 v[36:39], a[216:219], a[44:47], v[36:39]
    s_waitcnt lgkmcnt(0)
    v_exp_f32 v232, v232
    v_mfma_f32_16x16x32_bf16 v[36:39], a[212:215], a[28:31], v[36:39]
    s_add_u32 s39, s40, 184320
    v_exp_f32 v233, v233
    v_mfma_f32_16x16x32_bf16 v[36:39], a[208:211], a[12:15], v[36:39]
    v_exp_f32 v234, v234
    v_mfma_f32_16x16x32_bf16 a[152:155], a[232:235], v[192:195], a[152:155]
    s_add_u32 m0, s63, 135168
    v_exp_f32 v235, v235
    v_mfma_f32_16x16x32_bf16 a[168:171], a[236:239], v[192:195], a[168:171]
    v_cvt_pk_bf16_f32 v224, v224, v225
    v_cvt_pk_bf16_f32 v225, v226, v227
    v_mfma_f32_16x16x32_bf16 a[172:175], a[236:239], v[200:203], a[172:175]
    ds_read_b128 a[208:211], v12 offset:0
    v_cvt_pk_bf16_f32 v232, v232, v233
    v_mfma_f32_16x16x32_bf16 a[156:159], a[232:235], v[200:203], a[156:159]
    v_exp_f32 v240, v240
    v_mfma_f32_16x16x32_bf16 a[160:163], a[232:235], v[208:211], a[160:163]
    v_exp_f32 v241, v241
    v_mfma_f32_16x16x32_bf16 a[176:179], a[236:239], v[208:211], a[176:179]
    v_exp_f32 v242, v242
    v_mfma_f32_16x16x32_bf16 a[180:183], a[236:239], v[216:219], a[180:183]
    buffer_load_dwordx4 v6, s[16:19], s39 offen lds
    v_mfma_f32_16x16x32_bf16 a[164:167], a[232:235], v[216:219], a[164:167]
    v_exp_f32 v243, v243
    v_mfma_f32_16x16x32_bf16 v[228:231], a[184:187], a[0:3], 0
    v_cvt_pk_bf16_f32 v233, v234, v235
    v_cvt_pk_bf16_f32 v240, v240, v241
    v_mfma_f32_16x16x32_bf16 v[228:231], a[188:191], a[16:19], v[228:231]
    v_exp_f32 v248, v248
    v_mfma_f32_16x16x32_bf16 v[228:231], a[192:195], a[32:35], v[228:231]
    v_exp_f32 v249, v249
    v_mfma_f32_16x16x32_bf16 v[228:231], a[196:199], a[48:51], v[228:231]
    v_exp_f32 v250, v250
    v_mfma_f32_16x16x32_bf16 v[228:231], a[200:203], a[64:67], v[228:231]
    v_exp_f32 v251, v251
    v_mfma_f32_16x16x32_bf16 v[228:231], a[204:207], a[80:83], v[228:231]
    v_cvt_pk_bf16_f32 v241, v242, v243
    v_cvt_pk_bf16_f32 v248, v248, v249
    v_mfma_f32_16x16x32_bf16 v[236:239], a[204:207], a[84:87], 0
    v_exp_f32 v24, v24
    v_mfma_f32_16x16x32_bf16 v[236:239], a[200:203], a[68:71], v[236:239]
    v_exp_f32 v25, v25
    v_mfma_f32_16x16x32_bf16 v[236:239], a[196:199], a[52:55], v[236:239]
    v_exp_f32 v26, v26
    v_mfma_f32_16x16x32_bf16 v[236:239], a[192:195], a[36:39], v[236:239]
    v_exp_f32 v27, v27
    v_mfma_f32_16x16x32_bf16 v[236:239], a[188:191], a[20:23], v[236:239]
    v_cvt_pk_bf16_f32 v249, v250, v251
    v_cvt_pk_bf16_f32 v226, v24, v25
    v_mfma_f32_16x16x32_bf16 v[236:239], a[184:187], a[4:7], v[236:239]
    v_exp_f32 v28, v28
    v_mfma_f32_16x16x32_bf16 v[244:247], a[184:187], a[8:11], 0
    v_exp_f32 v29, v29
    v_mfma_f32_16x16x32_bf16 v[244:247], a[188:191], a[24:27], v[244:247]
    v_exp_f32 v30, v30
    v_add_u32 v13, 67584, v13
    v_mfma_f32_16x16x32_bf16 v[244:247], a[192:195], a[40:43], v[244:247]
    ds_read_b128 a[212:215], v13 offset:0
    v_cvt_pk_bf16_f32 v227, v26, v27
    v_mfma_f32_16x16x32_bf16 v[244:247], a[196:199], a[56:59], v[244:247]
    ds_read_b128 a[216:219], v12 offset:1024
    v_cvt_pk_bf16_f32 v234, v28, v29
    v_mfma_f32_16x16x32_bf16 v[244:247], a[200:203], a[72:75], v[244:247]
    ds_read_b128 a[220:223], v13 offset:1024
    v_accvgpr_write_b32 a145, v113
    v_mfma_f32_16x16x32_bf16 v[244:247], a[204:207], a[88:91], v[244:247]
    ds_read_b128 a[224:227], v12 offset:2048
    v_accvgpr_write_b32 a146, v114
    v_mfma_f32_16x16x32_bf16 v[252:255], a[204:207], a[92:95], 0
    s_add_u32 s39, s40, 128
    ds_read_b128 a[228:231], v13 offset:2048
    v_accvgpr_write_b32 a147, v115
    v_mfma_f32_16x16x32_bf16 v[252:255], a[200:203], a[76:79], v[252:255]
    v_exp_f32 v31, v31
    v_mfma_f32_16x16x32_bf16 v[252:255], a[196:199], a[60:63], v[252:255]
    s_add_u32 m0, s63, 49152
    v_exp_f32 v32, v32
    v_mfma_f32_16x16x32_bf16 v[252:255], a[192:195], a[44:47], v[252:255]
    s_waitcnt lgkmcnt(4)
    v_exp_f32 v33, v33
    v_mfma_f32_16x16x32_bf16 v[252:255], a[188:191], a[28:31], v[252:255]
    v_exp_f32 v34, v34
    v_mfma_f32_16x16x32_bf16 v[252:255], a[184:187], a[12:15], v[252:255]
    s_waitcnt lgkmcnt(2)
    v_exp_f32 v35, v35
    v_mfma_f32_16x16x32_bf16 v[40:43], a[208:211], a[0:3], 0
    s_waitcnt vmcnt(11) lgkmcnt(0)
    v_cvt_pk_bf16_f32 v235, v30, v31
    v_cvt_pk_bf16_f32 v242, v32, v33
    v_mfma_f32_16x16x32_bf16 v[40:43], a[212:215], a[16:19], v[40:43]
    s_barrier
    v_mfma_f32_16x16x32_bf16 v[40:43], a[216:219], a[32:35], v[40:43]
    buffer_load_dwordx4 v6, s[16:19], s39 offen lds
    v_mfma_f32_16x16x32_bf16 v[40:43], a[220:223], a[48:51], v[40:43]
    ds_read_b64_tr_b16 a[240:241], v8 offset:36864
    v_cvt_pk_bf16_f32 v243, v34, v35
    v_mfma_f32_16x16x32_bf16 v[40:43], a[224:227], a[64:67], v[40:43]
    ds_read_b64_tr_b16 a[242:243], v8 offset:38912
    v_subrev_u32 v12, 67584, v12
    v_mfma_f32_16x16x32_bf16 v[40:43], a[228:231], a[80:83], v[40:43]
    ds_read_b64_tr_b16 a[244:245], v9 offset:36864
    v_accvgpr_write_b32 a148, v116
    v_mfma_f32_16x16x32_bf16 v[44:47], a[228:231], a[84:87], 0
    s_add_u32 s39, s40, 12416
    ds_read_b64_tr_b16 a[246:247], v9 offset:38912
    v_subrev_u32 v13, 67584, v13
    v_mfma_f32_16x16x32_bf16 v[44:47], a[224:227], a[68:71], v[44:47]
    ds_read_b128 a[184:187], v12 offset:0
    v_accvgpr_write_b32 a149, v117
    v_mfma_f32_16x16x32_bf16 v[44:47], a[220:223], a[52:55], v[44:47]
    s_add_u32 m0, s63, 53248
    ds_read_b128 a[188:191], v13 offset:0
    v_accvgpr_write_b32 a150, v118
    v_mfma_f32_16x16x32_bf16 v[44:47], a[216:219], a[36:39], v[44:47]
    ds_read_b128 a[192:195], v12 offset:1024
    v_accvgpr_write_b32 a151, v119
    v_mfma_f32_16x16x32_bf16 v[44:47], a[212:215], a[20:23], v[44:47]
    v_exp_f32 v36, v36
    v_mfma_f32_16x16x32_bf16 v[44:47], a[208:211], a[4:7], v[44:47]
    v_exp_f32 v37, v37
    v_mfma_f32_16x16x32_bf16 v[48:51], a[208:211], a[8:11], 0
    s_lshl_b32 s42, s54, 4
    ds_read_b128 a[196:199], v13 offset:1024
    v_cvt_pk_bf16_f32 v250, v36, v37
    v_mfma_f32_16x16x32_bf16 v[48:51], a[212:215], a[24:27], v[48:51]
    s_mul_i32 s42, s42, 384
    ds_read_b128 a[200:203], v12 offset:2048
    v_and_b32 v22, 15, v1
    v_mfma_f32_16x16x32_bf16 v[48:51], a[216:219], a[40:43], v[48:51]
    buffer_load_dwordx4 v6, s[16:19], s39 offen lds
    v_mfma_f32_16x16x32_bf16 v[48:51], a[220:223], a[56:59], v[48:51]
    ds_read_b128 a[204:207], v13 offset:2048
    v_mul_u32_u24 v22, 384, v22
    v_mfma_f32_16x16x32_bf16 v[48:51], a[224:227], a[72:75], v[48:51]
    buffer_load_dword a252, v22, s[16:19], s42 offen offset:256
    v_mfma_f32_16x16x32_bf16 v[48:51], a[228:231], a[88:91], v[48:51]
    v_exp_f32 v38, v38
    v_mfma_f32_16x16x32_bf16 v[52:55], a[228:231], a[92:95], 0
    s_add_u32 s39, s40, 24704
    v_exp_f32 v39, v39
    v_mfma_f32_16x16x32_bf16 v[52:55], a[224:227], a[76:79], v[52:55]
    v_exp_f32 v228, v228
    v_mfma_f32_16x16x32_bf16 v[52:55], a[220:223], a[60:63], v[52:55]
    s_add_u32 m0, s63, 57344
    v_exp_f32 v229, v229
    v_mfma_f32_16x16x32_bf16 v[52:55], a[216:219], a[44:47], v[52:55]
    s_waitcnt lgkmcnt(1)
    v_exp_f32 v230, v230
    v_mfma_f32_16x16x32_bf16 v[52:55], a[212:215], a[28:31], v[52:55]
    v_exp_f32 v231, v231
    v_mfma_f32_16x16x32_bf16 v[52:55], a[208:211], a[12:15], v[52:55]
    v_exp_f32 v236, v236
    v_mfma_f32_16x16x32_bf16 a[164:167], a[240:243], v[220:223], a[164:167]
    v_exp_f32 v237, v237
    v_mfma_f32_16x16x32_bf16 a[180:183], a[244:247], v[220:223], a[180:183]
    v_exp_f32 v238, v238
    v_mfma_f32_16x16x32_bf16 a[176:179], a[244:247], v[212:215], a[176:179]
    buffer_load_dwordx4 v6, s[16:19], s39 offen lds
    v_mfma_f32_16x16x32_bf16 a[160:163], a[240:243], v[212:215], a[160:163]
    ds_read_b128 a[208:211], v12 offset:6144
    v_cvt_pk_bf16_f32 v251, v38, v39
    v_mfma_f32_16x16x32_bf16 a[156:159], a[240:243], v[204:207], a[156:159]
    ds_read_b128 a[212:215], v13 offset:6144
    v_cvt_pk_bf16_f32 v228, v228, v229
    v_mfma_f32_16x16x32_bf16 a[172:175], a[244:247], v[204:207], a[172:175]
    ds_read_b128 a[216:219], v12 offset:7168
    v_cvt_pk_bf16_f32 v229, v230, v231
    v_mfma_f32_16x16x32_bf16 a[168:171], a[244:247], v[196:199], a[168:171]
    s_add_u32 s39, s40, 36992
    ds_read_b128 a[220:223], v13 offset:7168
    v_cvt_pk_bf16_f32 v236, v236, v237
    v_mfma_f32_16x16x32_bf16 a[152:155], a[240:243], v[196:199], a[152:155]
    v_exp_f32 v239, v239
    v_mfma_f32_16x16x32_bf16 v[56:59], a[184:187], a[0:3], 0
    s_add_u32 m0, s63, 61440
    ds_read_b128 a[224:227], v12 offset:8192
    v_cvt_pk_bf16_f32 v237, v238, v239
    v_mfma_f32_16x16x32_bf16 v[56:59], a[188:191], a[16:19], v[56:59]
    v_exp_f32 v244, v244
    v_mfma_f32_16x16x32_bf16 v[56:59], a[192:195], a[32:35], v[56:59]
    s_waitcnt lgkmcnt(4)
    v_exp_f32 v245, v245
    v_mfma_f32_16x16x32_bf16 v[56:59], a[196:199], a[48:51], v[56:59]
    ds_read_b128 a[228:231], v13 offset:8192
    v_cvt_pk_bf16_f32 v244, v244, v245
    v_mfma_f32_16x16x32_bf16 v[56:59], a[200:203], a[64:67], v[56:59]
    v_exp_f32 v246, v246
    v_mfma_f32_16x16x32_bf16 v[56:59], a[204:207], a[80:83], v[56:59]
    v_exp_f32 v247, v247
    v_mfma_f32_16x16x32_bf16 v[64:67], a[204:207], a[84:87], 0
    buffer_load_dwordx4 v6, s[16:19], s39 offen lds
    v_mfma_f32_16x16x32_bf16 v[64:67], a[200:203], a[68:71], v[64:67]
    v_exp_f32 v252, v252
    v_mfma_f32_16x16x32_bf16 v[64:67], a[196:199], a[52:55], v[64:67]
    v_exp_f32 v253, v253
    v_mfma_f32_16x16x32_bf16 v[64:67], a[192:195], a[36:39], v[64:67]
    v_exp_f32 v254, v254
    v_mfma_f32_16x16x32_bf16 v[64:67], a[188:191], a[20:23], v[64:67]
    v_exp_f32 v255, v255
    v_mfma_f32_16x16x32_bf16 v[64:67], a[184:187], a[4:7], v[64:67]
    v_exp_f32 v40, v40
    v_mfma_f32_16x16x32_bf16 v[72:75], a[184:187], a[8:11], 0
    v_exp_f32 v41, v41
    v_mfma_f32_16x16x32_bf16 v[72:75], a[188:191], a[24:27], v[72:75]
    v_exp_f32 v42, v42
    v_mfma_f32_16x16x32_bf16 v[72:75], a[192:195], a[40:43], v[72:75]
    v_exp_f32 v43, v43
    v_mfma_f32_16x16x32_bf16 v[72:75], a[196:199], a[56:59], v[72:75]
    v_cvt_pk_bf16_f32 v245, v246, v247
    v_cvt_pk_bf16_f32 v252, v252, v253
    v_mfma_f32_16x16x32_bf16 v[72:75], a[200:203], a[72:75], v[72:75]
    v_exp_f32 v44, v44
    v_mfma_f32_16x16x32_bf16 v[72:75], a[204:207], a[88:91], v[72:75]
    v_exp_f32 v45, v45
    v_mfma_f32_16x16x32_bf16 v[80:83], a[204:207], a[92:95], 0
    ds_read_b64_tr_b16 a[232:233], v8 offset:40960
    v_cvt_pk_bf16_f32 v253, v254, v255
    v_mfma_f32_16x16x32_bf16 v[80:83], a[200:203], a[76:79], v[80:83]
    ds_read_b64_tr_b16 a[234:235], v8 offset:43008
    v_cvt_pk_bf16_f32 v230, v40, v41
    v_mfma_f32_16x16x32_bf16 v[80:83], a[196:199], a[60:63], v[80:83]
    ds_read_b64_tr_b16 a[236:237], v9 offset:40960
    v_cvt_pk_bf16_f32 v231, v42, v43
    v_mfma_f32_16x16x32_bf16 v[80:83], a[192:195], a[44:47], v[80:83]
    ds_read_b64_tr_b16 a[238:239], v9 offset:43008
    v_cvt_pk_bf16_f32 v238, v44, v45
    v_mfma_f32_16x16x32_bf16 v[80:83], a[188:191], a[28:31], v[80:83]
    s_waitcnt lgkmcnt(4)
    v_exp_f32 v46, v46
    v_mfma_f32_16x16x32_bf16 v[80:83], a[184:187], a[12:15], v[80:83]
    v_exp_f32 v47, v47
    v_mfma_f32_16x16x32_bf16 v[24:27], a[208:211], a[0:3], 0
    v_exp_f32 v48, v48
    v_mfma_f32_16x16x32_bf16 v[24:27], a[212:215], a[16:19], v[24:27]
    v_exp_f32 v49, v49
    v_mfma_f32_16x16x32_bf16 v[24:27], a[216:219], a[32:35], v[24:27]
    ds_read_b128 a[184:187], v12 offset:12288
    v_cvt_pk_bf16_f32 v239, v46, v47
    v_mfma_f32_16x16x32_bf16 v[24:27], a[220:223], a[48:51], v[24:27]
    ds_read_b128 a[188:191], v13 offset:12288
    v_cvt_pk_bf16_f32 v246, v48, v49
    v_mfma_f32_16x16x32_bf16 v[24:27], a[224:227], a[64:67], v[24:27]
    v_exp_f32 v50, v50
    v_mfma_f32_16x16x32_bf16 v[24:27], a[228:231], a[80:83], v[24:27]
    v_exp_f32 v51, v51
    v_mfma_f32_16x16x32_bf16 v[28:31], a[228:231], a[84:87], 0
    ds_read_b128 a[192:195], v12 offset:13312
    v_cvt_pk_bf16_f32 v247, v50, v51
    v_mfma_f32_16x16x32_bf16 v[28:31], a[224:227], a[68:71], v[28:31]
    v_exp_f32 v52, v52
    v_mfma_f32_16x16x32_bf16 v[28:31], a[220:223], a[52:55], v[28:31]
    v_exp_f32 v53, v53
    v_mfma_f32_16x16x32_bf16 v[28:31], a[216:219], a[36:39], v[28:31]
    ds_read_b128 a[196:199], v13 offset:13312
    v_cvt_pk_bf16_f32 v254, v52, v53
    v_mfma_f32_16x16x32_bf16 v[28:31], a[212:215], a[20:23], v[28:31]
    v_exp_f32 v54, v54
    v_mfma_f32_16x16x32_bf16 v[28:31], a[208:211], a[4:7], v[28:31]
    v_exp_f32 v55, v55
    v_mfma_f32_16x16x32_bf16 v[32:35], a[208:211], a[8:11], 0
    ds_read_b128 a[200:203], v12 offset:14336
    v_cvt_pk_bf16_f32 v255, v54, v55
    v_mfma_f32_16x16x32_bf16 v[32:35], a[212:215], a[24:27], v[32:35]
    v_exp_f32 v56, v56
    v_mfma_f32_16x16x32_bf16 v[32:35], a[216:219], a[40:43], v[32:35]
    v_exp_f32 v57, v57
    v_mfma_f32_16x16x32_bf16 v[32:35], a[220:223], a[56:59], v[32:35]
    ds_read_b128 a[204:207], v13 offset:14336
    v_cvt_pk_bf16_f32 v56, v56, v57
    v_mfma_f32_16x16x32_bf16 v[32:35], a[224:227], a[72:75], v[32:35]
    v_exp_f32 v58, v58
    v_mfma_f32_16x16x32_bf16 v[32:35], a[228:231], a[88:91], v[32:35]
    v_exp_f32 v59, v59
    v_mfma_f32_16x16x32_bf16 v[36:39], a[228:231], a[92:95], 0
    v_exp_f32 v64, v64
    v_mfma_f32_16x16x32_bf16 v[36:39], a[224:227], a[76:79], v[36:39]
    v_exp_f32 v65, v65
    v_mfma_f32_16x16x32_bf16 v[36:39], a[220:223], a[60:63], v[36:39]
    v_exp_f32 v66, v66
    v_mfma_f32_16x16x32_bf16 v[36:39], a[216:219], a[44:47], v[36:39]
    s_waitcnt lgkmcnt(1)
    v_exp_f32 v67, v67
    v_mfma_f32_16x16x32_bf16 v[36:39], a[212:215], a[28:31], v[36:39]
    v_exp_f32 v72, v72
    v_mfma_f32_16x16x32_bf16 v[36:39], a[208:211], a[12:15], v[36:39]
    v_exp_f32 v73, v73
    v_mfma_f32_16x16x32_bf16 a[152:155], a[232:235], v[224:227], a[152:155]
    v_exp_f32 v74, v74
    v_mfma_f32_16x16x32_bf16 a[168:171], a[236:239], v[224:227], a[168:171]
    v_exp_f32 v75, v75
    v_mfma_f32_16x16x32_bf16 a[172:175], a[236:239], v[232:235], a[172:175]
    ds_read_b128 a[208:211], v12 offset:18432
    v_cvt_pk_bf16_f32 v57, v58, v59
    v_mfma_f32_16x16x32_bf16 a[156:159], a[232:235], v[232:235], a[156:159]
    ds_read_b128 a[212:215], v13 offset:18432
    v_cvt_pk_bf16_f32 v64, v64, v65
    v_mfma_f32_16x16x32_bf16 a[160:163], a[232:235], v[240:243], a[160:163]
    ds_read_b128 a[216:219], v12 offset:19456
    v_cvt_pk_bf16_f32 v65, v66, v67
    v_mfma_f32_16x16x32_bf16 a[176:179], a[236:239], v[240:243], a[176:179]
    ds_read_b128 a[220:223], v13 offset:19456
    v_cvt_pk_bf16_f32 v72, v72, v73
    v_mfma_f32_16x16x32_bf16 a[180:183], a[236:239], v[248:251], a[180:183]
    ds_read_b128 a[224:227], v12 offset:20480
    v_cvt_pk_bf16_f32 v73, v74, v75
    v_mfma_f32_16x16x32_bf16 a[164:167], a[232:235], v[248:251], a[164:167]
    v_exp_f32 v80, v80
    v_mfma_f32_16x16x32_bf16 v[60:63], a[184:187], a[0:3], 0
    v_exp_f32 v81, v81
    v_mfma_f32_16x16x32_bf16 v[60:63], a[188:191], a[16:19], v[60:63]
    ds_read_b128 a[228:231], v13 offset:20480
    v_cvt_pk_bf16_f32 v80, v80, v81
    v_mfma_f32_16x16x32_bf16 v[60:63], a[192:195], a[32:35], v[60:63]
    s_waitcnt lgkmcnt(4)
    v_exp_f32 v82, v82
    v_mfma_f32_16x16x32_bf16 v[60:63], a[196:199], a[48:51], v[60:63]
    v_exp_f32 v83, v83
    v_mfma_f32_16x16x32_bf16 v[60:63], a[200:203], a[64:67], v[60:63]
    v_exp_f32 v24, v24
    v_mfma_f32_16x16x32_bf16 v[60:63], a[204:207], a[80:83], v[60:63]
    v_exp_f32 v25, v25
    v_mfma_f32_16x16x32_bf16 v[68:71], a[204:207], a[84:87], 0
    v_exp_f32 v26, v26
    v_mfma_f32_16x16x32_bf16 v[68:71], a[200:203], a[68:71], v[68:71]
    v_exp_f32 v27, v27
    v_mfma_f32_16x16x32_bf16 v[68:71], a[196:199], a[52:55], v[68:71]
    v_exp_f32 v28, v28
    v_mfma_f32_16x16x32_bf16 v[68:71], a[192:195], a[36:39], v[68:71]
    v_exp_f32 v29, v29
    v_mfma_f32_16x16x32_bf16 v[68:71], a[188:191], a[20:23], v[68:71]
    v_cvt_pk_bf16_f32 v81, v82, v83
    v_cvt_pk_bf16_f32 v58, v24, v25
    v_mfma_f32_16x16x32_bf16 v[68:71], a[184:187], a[4:7], v[68:71]
    v_exp_f32 v30, v30
    v_mfma_f32_16x16x32_bf16 v[76:79], a[184:187], a[8:11], 0
    v_exp_f32 v31, v31
    v_mfma_f32_16x16x32_bf16 v[76:79], a[188:191], a[24:27], v[76:79]
    v_exp_f32 v32, v32
    v_mfma_f32_16x16x32_bf16 v[76:79], a[192:195], a[40:43], v[76:79]
    v_exp_f32 v33, v33
    v_mfma_f32_16x16x32_bf16 v[76:79], a[196:199], a[56:59], v[76:79]
    v_cvt_pk_bf16_f32 v59, v26, v27
    v_cvt_pk_bf16_f32 v66, v28, v29
    v_mfma_f32_16x16x32_bf16 v[76:79], a[200:203], a[72:75], v[76:79]
    v_exp_f32 v34, v34
    v_mfma_f32_16x16x32_bf16 v[76:79], a[204:207], a[88:91], v[76:79]
    v_exp_f32 v35, v35
    v_mfma_f32_16x16x32_bf16 v[84:87], a[204:207], a[92:95], 0
    s_add_u32 s39, s40, 49280
    v_exp_f32 v36, v36
    v_mfma_f32_16x16x32_bf16 v[84:87], a[200:203], a[76:79], v[84:87]
    v_exp_f32 v37, v37
    v_mfma_f32_16x16x32_bf16 v[84:87], a[196:199], a[60:63], v[84:87]
    s_add_u32 m0, s63, 0
    v_cvt_pk_bf16_f32 v67, v30, v31
    v_cvt_pk_bf16_f32 v74, v32, v33
    v_mfma_f32_16x16x32_bf16 v[84:87], a[192:195], a[44:47], v[84:87]
    v_exp_f32 v38, v38
    v_mfma_f32_16x16x32_bf16 v[84:87], a[188:191], a[28:31], v[84:87]
    v_exp_f32 v39, v39
    v_mfma_f32_16x16x32_bf16 v[84:87], a[184:187], a[12:15], v[84:87]
    s_waitcnt lgkmcnt(0)
    v_exp_f32 v60, v60
    v_mfma_f32_16x16x32_bf16 v[40:43], a[208:211], a[0:3], 0
    s_waitcnt vmcnt(7)
    v_exp_f32 v61, v61
    v_mfma_f32_16x16x32_bf16 v[40:43], a[212:215], a[16:19], v[40:43]
    s_barrier
    v_mfma_f32_16x16x32_bf16 v[40:43], a[216:219], a[32:35], v[40:43]
    buffer_load_dwordx4 v6, s[16:19], s39 offen lds
    v_mfma_f32_16x16x32_bf16 v[40:43], a[220:223], a[48:51], v[40:43]
    ds_read_b64_tr_b16 a[240:241], v8 offset:45056
    v_cvt_pk_bf16_f32 v75, v34, v35
    v_mfma_f32_16x16x32_bf16 v[40:43], a[224:227], a[64:67], v[40:43]
    ds_read_b64_tr_b16 a[242:243], v8 offset:47104
    v_cvt_pk_bf16_f32 v82, v36, v37
    v_mfma_f32_16x16x32_bf16 v[40:43], a[228:231], a[80:83], v[40:43]
    ds_read_b64_tr_b16 a[244:245], v9 offset:45056
    v_cvt_pk_bf16_f32 v83, v38, v39
    v_mfma_f32_16x16x32_bf16 v[44:47], a[228:231], a[84:87], 0
    s_add_u32 s39, s40, 61568
    ds_read_b64_tr_b16 a[246:247], v9 offset:47104
    v_cvt_pk_bf16_f32 v60, v60, v61
    v_mfma_f32_16x16x32_bf16 v[44:47], a[224:227], a[68:71], v[44:47]
    v_exp_f32 v62, v62
    v_mfma_f32_16x16x32_bf16 v[44:47], a[220:223], a[52:55], v[44:47]
    s_add_u32 m0, s63, 4096
    v_exp_f32 v63, v63
    v_mfma_f32_16x16x32_bf16 v[44:47], a[216:219], a[36:39], v[44:47]
    ds_read_b128 a[184:187], v12 offset:24576
    v_cvt_pk_bf16_f32 v61, v62, v63
    v_mfma_f32_16x16x32_bf16 v[44:47], a[212:215], a[20:23], v[44:47]
    v_exp_f32 v68, v68
    v_mfma_f32_16x16x32_bf16 v[44:47], a[208:211], a[4:7], v[44:47]
    v_exp_f32 v69, v69
    v_mfma_f32_16x16x32_bf16 v[48:51], a[208:211], a[8:11], 0
    s_mov_b32 s28, s82
    ds_read_b128 a[188:191], v13 offset:24576
    v_cvt_pk_bf16_f32 v68, v68, v69
    v_mfma_f32_16x16x32_bf16 v[48:51], a[212:215], a[24:27], v[48:51]
    s_and_b32 s29, s83, 0xffff
    ds_read_b128 a[192:195], v12 offset:25600
    v_and_b32 v22, 15, v1
    v_mfma_f32_16x16x32_bf16 v[48:51], a[216:219], a[40:43], v[48:51]
    buffer_load_dwordx4 v6, s[16:19], s39 offen lds
    v_mfma_f32_16x16x32_bf16 v[48:51], a[220:223], a[56:59], v[48:51]
    s_mov_b32 s30, 1966080
    ds_read_b128 a[196:199], v13 offset:25600
    v_mul_u32_u24 v22, 1280, v22
    v_mfma_f32_16x16x32_bf16 v[48:51], a[224:227], a[72:75], v[48:51]
    s_mov_b32 s31, 0x00020000
    v_exp_f32 v70, v70
    v_mfma_f32_16x16x32_bf16 v[48:51], a[228:231], a[88:91], v[48:51]
    s_mul_hi_u32 s48, s58, 429496730
    v_exp_f32 v71, v71
    v_mfma_f32_16x16x32_bf16 v[52:55], a[228:231], a[92:95], 0
    s_add_u32 s39, s40, 73856
    ds_read_b128 a[200:203], v12 offset:26624
    v_cvt_pk_bf16_f32 v69, v70, v71
    v_mfma_f32_16x16x32_bf16 v[52:55], a[224:227], a[76:79], v[52:55]
    s_mul_i32 s42, s48, 80640
    v_exp_f32 v76, v76
    v_mfma_f32_16x16x32_bf16 v[52:55], a[220:223], a[60:63], v[52:55]
    s_add_u32 m0, s63, 8192
    v_exp_f32 v77, v77
    v_mfma_f32_16x16x32_bf16 v[52:55], a[216:219], a[44:47], v[52:55]
    s_waitcnt lgkmcnt(2)
    ds_read_b128 a[204:207], v13 offset:26624
    v_cvt_pk_bf16_f32 v76, v76, v77
    v_mfma_f32_16x16x32_bf16 v[52:55], a[212:215], a[28:31], v[52:55]
    s_lshl_b32 s56, s58, 7
    v_exp_f32 v78, v78
    v_mfma_f32_16x16x32_bf16 v[52:55], a[208:211], a[12:15], v[52:55]
    s_add_u32 s42, s42, s56
    v_exp_f32 v79, v79
    v_mfma_f32_16x16x32_bf16 a[164:167], a[240:243], v[252:255], a[164:167]
    s_mul_i32 s56, s3, 20480
    v_exp_f32 v84, v84
    v_mfma_f32_16x16x32_bf16 a[180:183], a[244:247], v[252:255], a[180:183]
    s_add_u32 s42, s42, s56
    v_exp_f32 v85, v85
    v_mfma_f32_16x16x32_bf16 a[176:179], a[244:247], v[244:247], a[176:179]
    buffer_load_dword a252, v22, s[28:31], s42 offen
    v_mfma_f32_16x16x32_bf16 a[160:163], a[240:243], v[244:247], a[160:163]
    buffer_load_dwordx4 v6, s[16:19], s39 offen lds
    v_mfma_f32_16x16x32_bf16 a[156:159], a[240:243], v[236:239], a[156:159]
    s_add_u32 s56, s7, 1
    ds_read_b128 a[208:211], v12 offset:30720
    v_cvt_pk_bf16_f32 v77, v78, v79
    v_mfma_f32_16x16x32_bf16 a[172:175], a[244:247], v[236:239], a[172:175]
    ds_read_b128 a[212:215], v13 offset:30720
    v_cvt_pk_bf16_f32 v84, v84, v85
    v_mfma_f32_16x16x32_bf16 a[168:171], a[244:247], v[228:231], a[168:171]
    s_add_u32 s39, s40, 86144
    ds_read_b128 a[216:219], v12 offset:31744
    v_mov_b32 v4, s56
    v_mfma_f32_16x16x32_bf16 a[152:155], a[240:243], v[228:231], a[152:155]
    s_add_u32 s56, s7, 2
    v_exp_f32 v86, v86
    v_mfma_f32_16x16x32_bf16 v[88:91], a[184:187], a[0:3], 0
    s_waitcnt lgkmcnt(3)
    v_exp_f32 v87, v87
    v_mfma_f32_16x16x32_bf16 v[88:91], a[188:191], a[16:19], v[88:91]
    s_add_u32 m0, s63, 12288
    ds_read_b128 a[220:223], v13 offset:31744
    v_cvt_pk_bf16_f32 v85, v86, v87
    v_mfma_f32_16x16x32_bf16 v[88:91], a[192:195], a[32:35], v[88:91]
    v_exp_f32 v40, v40
    v_mfma_f32_16x16x32_bf16 v[88:91], a[196:199], a[48:51], v[88:91]
    v_exp_f32 v41, v41
    v_mfma_f32_16x16x32_bf16 v[88:91], a[200:203], a[64:67], v[88:91]
    ds_read_b128 a[224:227], v12 offset:32768
    v_cvt_pk_bf16_f32 v62, v40, v41
    v_mfma_f32_16x16x32_bf16 v[88:91], a[204:207], a[80:83], v[88:91]
    v_exp_f32 v42, v42
    v_mfma_f32_16x16x32_bf16 v[96:99], a[204:207], a[84:87], 0
    buffer_load_dwordx4 v6, s[16:19], s39 offen lds
    v_mfma_f32_16x16x32_bf16 v[96:99], a[200:203], a[68:71], v[96:99]
    v_exp_f32 v43, v43
    v_mfma_f32_16x16x32_bf16 v[96:99], a[196:199], a[52:55], v[96:99]
    ds_read_b128 a[228:231], v13 offset:32768
    v_cvt_pk_bf16_f32 v63, v42, v43
    v_mfma_f32_16x16x32_bf16 v[96:99], a[192:195], a[36:39], v[96:99]
    v_exp_f32 v44, v44
    v_mfma_f32_16x16x32_bf16 v[96:99], a[188:191], a[20:23], v[96:99]
    s_add_u32 s39, s40, 98432
    v_exp_f32 v45, v45
    v_mfma_f32_16x16x32_bf16 v[96:99], a[184:187], a[4:7], v[96:99]
    v_exp_f32 v46, v46
    v_mfma_f32_16x16x32_bf16 v[104:107], a[184:187], a[8:11], 0
    s_add_u32 m0, s63, 16384
    v_exp_f32 v47, v47
    v_mfma_f32_16x16x32_bf16 v[104:107], a[188:191], a[24:27], v[104:107]
    v_exp_f32 v48, v48
    v_mfma_f32_16x16x32_bf16 v[104:107], a[192:195], a[40:43], v[104:107]
    v_exp_f32 v49, v49
    v_mfma_f32_16x16x32_bf16 v[104:107], a[196:199], a[56:59], v[104:107]
    v_exp_f32 v50, v50
    v_mfma_f32_16x16x32_bf16 v[104:107], a[200:203], a[72:75], v[104:107]
    v_exp_f32 v51, v51
    v_mfma_f32_16x16x32_bf16 v[104:107], a[204:207], a[88:91], v[104:107]
    v_cvt_pk_bf16_f32 v70, v44, v45
    v_cvt_pk_bf16_f32 v71, v46, v47
    v_mfma_f32_16x16x32_bf16 v[112:115], a[204:207], a[92:95], 0
pg_8:
    s_cbranch_execz pg_12
    buffer_load_dwordx4 v6, s[16:19], s39 offen lds
    v_mfma_f32_16x16x32_bf16 v[112:115], a[200:203], a[76:79], v[112:115]
    ds_read_b64_tr_b16 a[232:233], v8 offset:49152
    v_cvt_pk_bf16_f32 v78, v48, v49
    v_mfma_f32_16x16x32_bf16 v[112:115], a[196:199], a[60:63], v[112:115]
    ds_read_b64_tr_b16 a[234:235], v8 offset:51200
    v_cvt_pk_bf16_f32 v79, v50, v51
    v_mfma_f32_16x16x32_bf16 v[112:115], a[192:195], a[44:47], v[112:115]
    s_waitcnt lgkmcnt(2)
    v_exp_f32 v52, v52
    v_mfma_f32_16x16x32_bf16 v[112:115], a[188:191], a[28:31], v[112:115]
    s_add_u32 s39, s40, 110720
    v_exp_f32 v53, v53
    v_mfma_f32_16x16x32_bf16 v[112:115], a[184:187], a[12:15], v[112:115]
    ds_read_b64_tr_b16 a[236:237], v9 offset:49152
    v_cvt_pk_bf16_f32 v86, v52, v53
    v_mfma_f32_16x16x32_bf16 v[24:27], a[208:211], a[0:3], 0
    s_add_u32 m0, s63, 20480
    v_exp_f32 v54, v54
    v_mfma_f32_16x16x32_bf16 v[24:27], a[212:215], a[16:19], v[24:27]
    v_exp_f32 v55, v55
    v_mfma_f32_16x16x32_bf16 v[24:27], a[216:219], a[32:35], v[24:27]
    ds_read_b64_tr_b16 a[238:239], v9 offset:51200
    v_cvt_pk_bf16_f32 v87, v54, v55
    v_mfma_f32_16x16x32_bf16 v[24:27], a[220:223], a[48:51], v[24:27]
    v_exp_f32 v88, v88
    v_mfma_f32_16x16x32_bf16 v[24:27], a[224:227], a[64:67], v[24:27]
    v_exp_f32 v89, v89
    v_mfma_f32_16x16x32_bf16 v[24:27], a[228:231], a[80:83], v[24:27]
    ds_read_b128 a[184:187], v12 offset:36864
    v_cvt_pk_bf16_f32 v88, v88, v89
    v_mfma_f32_16x16x32_bf16 v[28:31], a[228:231], a[84:87], 0
    buffer_load_dwordx4 v6, s[16:19], s39 offen lds
    v_mfma_f32_16x16x32_bf16 v[28:31], a[224:227], a[68:71], v[28:31]
    v_exp_f32 v90, v90
    v_mfma_f32_16x16x32_bf16 v[28:31], a[220:223], a[52:55], v[28:31]
    v_exp_f32 v91, v91
    v_mfma_f32_16x16x32_bf16 v[28:31], a[216:219], a[36:39], v[28:31]
    ds_read_b128 a[188:191], v13 offset:36864
    v_cvt_pk_bf16_f32 v89, v90, v91
    v_mfma_f32_16x16x32_bf16 v[28:31], a[212:215], a[20:23], v[28:31]
    v_exp_f32 v96, v96
    v_mfma_f32_16x16x32_bf16 v[28:31], a[208:211], a[4:7], v[28:31]
    v_exp_f32 v97, v97
    v_mfma_f32_16x16x32_bf16 v[32:35], a[208:211], a[8:11], 0
    ds_read_b128 a[192:195], v12 offset:37888
    v_cvt_pk_bf16_f32 v96, v96, v97
    v_mfma_f32_16x16x32_bf16 v[32:35], a[212:215], a[24:27], v[32:35]
    v_exp_f32 v98, v98
    v_mfma_f32_16x16x32_bf16 v[32:35], a[216:219], a[40:43], v[32:35]
    v_exp_f32 v99, v99
    v_mfma_f32_16x16x32_bf16 v[32:35], a[220:223], a[56:59], v[32:35]
    ds_read_b128 a[196:199], v13 offset:37888
    v_cvt_pk_bf16_f32 v97, v98, v99
    v_mfma_f32_16x16x32_bf16 v[32:35], a[224:227], a[72:75], v[32:35]
    v_exp_f32 v104, v104
    v_mfma_f32_16x16x32_bf16 v[32:35], a[228:231], a[88:91], v[32:35]
    v_exp_f32 v105, v105
    v_mfma_f32_16x16x32_bf16 v[36:39], a[228:231], a[92:95], 0
    ds_read_b128 a[200:203], v12 offset:38912
    v_cvt_pk_bf16_f32 v104, v104, v105
    v_mfma_f32_16x16x32_bf16 v[36:39], a[224:227], a[76:79], v[36:39]
    v_exp_f32 v106, v106
    v_mfma_f32_16x16x32_bf16 v[36:39], a[220:223], a[60:63], v[36:39]
    v_exp_f32 v107, v107
    v_mfma_f32_16x16x32_bf16 v[36:39], a[216:219], a[44:47], v[36:39]
    s_waitcnt lgkmcnt(2)
    ds_read_b128 a[204:207], v13 offset:38912
    v_cvt_pk_bf16_f32 v105, v106, v107
    v_mfma_f32_16x16x32_bf16 v[36:39], a[212:215], a[28:31], v[36:39]
    v_exp_f32 v112, v112
    v_mfma_f32_16x16x32_bf16 v[36:39], a[208:211], a[12:15], v[36:39]
    v_exp_f32 v113, v113
    v_mfma_f32_16x16x32_bf16 a[152:155], a[232:235], v[56:59], a[152:155]
    v_exp_f32 v114, v114
    v_mfma_f32_16x16x32_bf16 a[168:171], a[236:239], v[56:59], a[168:171]
    v_exp_f32 v115, v115
    v_mfma_f32_16x16x32_bf16 a[172:175], a[236:239], v[64:67], a[172:175]
    ds_read_b128 a[208:211], v12 offset:43008
    v_cvt_pk_bf16_f32 v112, v112, v113
    v_mfma_f32_16x16x32_bf16 a[156:159], a[232:235], v[64:67], a[156:159]
    ds_read_b128 a[212:215], v13 offset:43008
    v_cvt_pk_bf16_f32 v113, v114, v115
    v_mfma_f32_16x16x32_bf16 a[160:163], a[232:235], v[72:75], a[160:163]
    v_exp_f32 v24, v24
    v_mfma_f32_16x16x32_bf16 a[176:179], a[236:239], v[72:75], a[176:179]
    v_exp_f32 v25, v25
    v_mfma_f32_16x16x32_bf16 a[180:183], a[236:239], v[80:83], a[180:183]
    ds_read_b128 a[216:219], v12 offset:44032
    v_cvt_pk_bf16_f32 v90, v24, v25
    v_mfma_f32_16x16x32_bf16 a[164:167], a[232:235], v[80:83], a[164:167]
    ds_read_b128 a[220:223], v13 offset:44032
    v_mov_b32 v24, 0
    v_mfma_f32_16x16x32_bf16 v[92:95], a[184:187], a[0:3], 0
    s_waitcnt lgkmcnt(4)
    ds_read_b128 a[224:227], v12 offset:45056
    v_mov_b32 v25, 0
    v_mfma_f32_16x16x32_bf16 v[92:95], a[188:191], a[16:19], v[92:95]
    v_exp_f32 v26, v26
    v_mfma_f32_16x16x32_bf16 v[92:95], a[192:195], a[32:35], v[92:95]
    v_exp_f32 v27, v27
    v_mfma_f32_16x16x32_bf16 v[92:95], a[196:199], a[48:51], v[92:95]
    ds_read_b128 a[228:231], v13 offset:45056
    v_cvt_pk_bf16_f32 v91, v26, v27
    v_mfma_f32_16x16x32_bf16 v[92:95], a[200:203], a[64:67], v[92:95]
    v_exp_f32 v28, v28
    v_mfma_f32_16x16x32_bf16 v[92:95], a[204:207], a[80:83], v[92:95]
    v_exp_f32 v29, v29
    v_mfma_f32_16x16x32_bf16 v[100:103], a[204:207], a[84:87], 0
    v_exp_f32 v30, v30
    v_mfma_f32_16x16x32_bf16 v[100:103], a[200:203], a[68:71], v[100:103]
    v_exp_f32 v31, v31
    v_mfma_f32_16x16x32_bf16 v[100:103], a[196:199], a[52:55], v[100:103]
    v_exp_f32 v32, v32
    v_mfma_f32_16x16x32_bf16 v[100:103], a[192:195], a[36:39], v[100:103]
    v_exp_f32 v33, v33
    v_mfma_f32_16x16x32_bf16 v[100:103], a[188:191], a[20:23], v[100:103]
    v_exp_f32 v34, v34
    v_mfma_f32_16x16x32_bf16 v[100:103], a[184:187], a[4:7], v[100:103]
    v_exp_f32 v35, v35
    v_mfma_f32_16x16x32_bf16 v[108:111], a[184:187], a[8:11], 0
    v_cvt_pk_bf16_f32 v98, v28, v29
    v_cvt_pk_bf16_f32 v99, v30, v31
    v_mfma_f32_16x16x32_bf16 v[108:111], a[188:191], a[24:27], v[108:111]
    v_exp_f32 v36, v36
    v_mfma_f32_16x16x32_bf16 v[108:111], a[192:195], a[40:43], v[108:111]
    v_exp_f32 v37, v37
    v_mfma_f32_16x16x32_bf16 v[108:111], a[196:199], a[56:59], v[108:111]
    v_exp_f32 v38, v38
    v_mfma_f32_16x16x32_bf16 v[108:111], a[200:203], a[72:75], v[108:111]
    v_exp_f32 v39, v39
    v_mfma_f32_16x16x32_bf16 v[108:111], a[204:207], a[88:91], v[108:111]
    v_cvt_pk_bf16_f32 v106, v32, v33
    v_cvt_pk_bf16_f32 v107, v34, v35
    v_mfma_f32_16x16x32_bf16 v[116:119], a[204:207], a[92:95], 0
    s_add_u32 s39, s40, 123008
    v_cvt_pk_bf16_f32 v114, v36, v37
    v_cvt_pk_bf16_f32 v115, v38, v39
    v_mfma_f32_16x16x32_bf16 v[116:119], a[200:203], a[76:79], v[116:119]
    v_exp_f32 v92, v92
    v_mfma_f32_16x16x32_bf16 v[116:119], a[196:199], a[60:63], v[116:119]
    s_add_u32 m0, s63, 24576
    v_exp_f32 v93, v93
    v_mfma_f32_16x16x32_bf16 v[116:119], a[192:195], a[44:47], v[116:119]
    s_waitcnt lgkmcnt(0)
    v_exp_f32 v94, v94
    v_mfma_f32_16x16x32_bf16 v[116:119], a[188:191], a[28:31], v[116:119]
    v_exp_f32 v95, v95
    v_mfma_f32_16x16x32_bf16 v[116:119], a[184:187], a[12:15], v[116:119]
    v_exp_f32 v100, v100
    v_mfma_f32_16x16x32_bf16 v[40:43], a[208:211], a[0:3], 0
    s_waitcnt vmcnt(12)
    v_exp_f32 v101, v101
    v_mfma_f32_16x16x32_bf16 v[40:43], a[212:215], a[16:19], v[40:43]
    s_barrier
    v_mfma_f32_16x16x32_bf16 v[40:43], a[216:219], a[32:35], v[40:43]
    buffer_load_dwordx4 v6, s[16:19], s39 offen lds
    v_mfma_f32_16x16x32_bf16 v[40:43], a[220:223], a[48:51], v[40:43]
    s_add_u32 s39, s40, 135296
    ds_read_b64_tr_b16 a[240:241], v8 offset:53248
    v_cvt_pk_bf16_f32 v92, v92, v93
    v_mfma_f32_16x16x32_bf16 v[40:43], a[224:227], a[64:67], v[40:43]
    s_add_u32 m0, s63, 28672
    ds_read_b64_tr_b16 a[242:243], v8 offset:55296
    v_cvt_pk_bf16_f32 v93, v94, v95
    v_mfma_f32_16x16x32_bf16 v[40:43], a[228:231], a[80:83], v[40:43]
    ds_read_b64_tr_b16 a[244:245], v9 offset:53248
    v_cvt_pk_bf16_f32 v100, v100, v101
    v_mfma_f32_16x16x32_bf16 v[44:47], a[228:231], a[84:87], 0
    ds_read_b64_tr_b16 a[246:247], v9 offset:55296
    v_mov_b32 v28, 0
    v_mfma_f32_16x16x32_bf16 v[44:47], a[224:227], a[68:71], v[44:47]
    v_exp_f32 v102, v102
    v_mfma_f32_16x16x32_bf16 v[44:47], a[220:223], a[52:55], v[44:47]
    v_exp_f32 v103, v103
    v_mfma_f32_16x16x32_bf16 v[44:47], a[216:219], a[36:39], v[44:47]
    v_exp_f32 v108, v108
    v_mfma_f32_16x16x32_bf16 v[44:47], a[212:215], a[20:23], v[44:47]
    buffer_load_dwordx4 v6, s[16:19], s39 offen lds
    v_mfma_f32_16x16x32_bf16 v[44:47], a[208:211], a[4:7], v[44:47]
    s_add_u32 s39, s40, 147584
    v_exp_f32 v109, v109
    v_mfma_f32_16x16x32_bf16 v[48:51], a[208:211], a[8:11], 0
    s_add_u32 m0, s63, 32768
    v_exp_f32 v110, v110
    v_mfma_f32_16x16x32_bf16 v[48:51], a[212:215], a[24:27], v[48:51]
    v_exp_f32 v111, v111
    v_mfma_f32_16x16x32_bf16 v[48:51], a[216:219], a[40:43], v[48:51]
    v_cvt_pk_bf16_f32 v101, v102, v103
    v_cvt_pk_bf16_f32 v108, v108, v109
    v_mfma_f32_16x16x32_bf16 v[48:51], a[220:223], a[56:59], v[48:51]
    v_exp_f32 v116, v116
    v_mfma_f32_16x16x32_bf16 v[48:51], a[224:227], a[72:75], v[48:51]
    v_exp_f32 v117, v117
    v_mfma_f32_16x16x32_bf16 v[48:51], a[228:231], a[88:91], v[48:51]
    v_exp_f32 v118, v118
    v_mfma_f32_16x16x32_bf16 v[52:55], a[228:231], a[92:95], 0
    buffer_load_dwordx4 v6, s[16:19], s39 offen lds
    v_mfma_f32_16x16x32_bf16 v[52:55], a[224:227], a[76:79], v[52:55]
    s_add_u32 s39, s40, 159872
    v_exp_f32 v119, v119
    v_mfma_f32_16x16x32_bf16 v[52:55], a[220:223], a[60:63], v[52:55]
    s_add_u32 m0, s63, 36864
    v_cvt_pk_bf16_f32 v109, v110, v111
    v_cvt_pk_bf16_f32 v116, v116, v117
    v_mfma_f32_16x16x32_bf16 v[52:55], a[216:219], a[44:47], v[52:55]
    s_waitcnt lgkmcnt(0)
    v_exp_f32 v40, v40
    v_mfma_f32_16x16x32_bf16 v[52:55], a[212:215], a[28:31], v[52:55]
    v_exp_f32 v41, v41
    v_mfma_f32_16x16x32_bf16 v[52:55], a[208:211], a[12:15], v[52:55]
    v_exp_f32 v42, v42
    v_mfma_f32_16x16x32_bf16 a[164:167], a[240:243], v[84:87], a[164:167]
    v_exp_f32 v43, v43
    v_mfma_f32_16x16x32_bf16 a[180:183], a[244:247], v[84:87], a[180:183]
    v_cvt_pk_bf16_f32 v117, v118, v119
    v_cvt_pk_bf16_f32 v94, v40, v41
    v_mfma_f32_16x16x32_bf16 a[176:179], a[244:247], v[76:79], a[176:179]
    buffer_load_dwordx4 v6, s[16:19], s39 offen lds
    v_mfma_f32_16x16x32_bf16 a[160:163], a[240:243], v[76:79], a[160:163]
    s_add_u32 s39, s40, 172160
    v_exp_f32 v44, v44
    v_mfma_f32_16x16x32_bf16 a[156:159], a[240:243], v[68:71], a[156:159]
    s_add_u32 m0, s63, 40960
    v_exp_f32 v45, v45
    v_mfma_f32_16x16x32_bf16 a[172:175], a[244:247], v[68:71], a[172:175]
    v_exp_f32 v46, v46
    v_mfma_f32_16x16x32_bf16 a[168:171], a[244:247], v[60:63], a[168:171]
    v_exp_f32 v47, v47
    v_mfma_f32_16x16x32_bf16 a[152:155], a[240:243], v[60:63], a[152:155]
    v_cvt_pk_bf16_f32 v95, v42, v43
    v_cvt_pk_bf16_f32 v102, v44, v45
    v_smfmac_f32_16x16x64_bf16 v[24:27], a[248:251], a[96:103], v20
    v_cvt_pk_bf16_f32 v103, v46, v47
    v_mov_b32 v29, 0
    s_nop 1
    v_smfmac_f32_16x16x64_bf16 v[28:31], a[248:251], a[104:111], v20
    v_mov_b32 v32, 0
    v_mov_b32 v33, 0
    s_nop 1
    v_smfmac_f32_16x16x64_bf16 v[32:35], a[248:251], a[112:119], v20
    buffer_load_dwordx4 v6, s[16:19], s39 offen lds
    v_mov_b32 v36, 0
    v_mov_b32 v37, 0
    s_nop 1
    v_smfmac_f32_16x16x64_bf16 v[36:39], a[248:251], a[120:127], v20
    s_add_u32 s39, s40, 184448
    ds_read_b64_tr_b16 a[232:233], v8 offset:57344
    v_smfmac_f32_16x16x64_bf16 v[24:27], a[248:251], a[128:135], v20
    s_add_u32 m0, s63, 45056
    ds_read_b64_tr_b16 a[234:235], v8 offset:59392
    v_smfmac_f32_16x16x64_bf16 v[28:31], a[248:251], a[136:143], v20
    ds_read_b64_tr_b16 a[236:237], v9 offset:57344
    v_smfmac_f32_16x16x64_bf16 v[32:35], a[248:251], a[144:151], v20
    ds_read_b64_tr_b16 a[238:239], v9 offset:59392
    v_smfmac_f32_16x16x64_bf16 v[36:39], a[248:251], v[120:127], v20
    v_smfmac_f32_16x16x64_bf16 v[24:27], a[248:251], v[128:135], v20
    v_smfmac_f32_16x16x64_bf16 v[28:31], a[248:251], v[136:143], v20
    v_smfmac_f32_16x16x64_bf16 v[32:35], a[248:251], v[144:151], v20
    buffer_load_dwordx4 v6, s[16:19], s39 offen lds
    v_smfmac_f32_16x16x64_bf16 v[36:39], a[248:251], v[152:159], v20
    s_add_u32 s38, s44, 0
    ds_read_b64_tr_b16 a[240:241], v8 offset:61440
    s_add_u32 s36, s44, 40960
    v_smfmac_f32_16x16x64_bf16 v[24:27], a[248:251], v[160:167], v20
    s_cmp_lt_u32 s3, 2
    s_cselect_b32 s38, s38, s36
    s_add_u32 m0, s63, 155648
    v_smfmac_f32_16x16x64_bf16 v[28:31], a[248:251], v[168:175], v20
    ds_read_b64_tr_b16 a[242:243], v8 offset:63488
    v_smfmac_f32_16x16x64_bf16 v[32:35], a[248:251], v[176:183], v20
    ds_read_b64_tr_b16 a[244:245], v9 offset:61440
    v_smfmac_f32_16x16x64_bf16 v[36:39], a[248:251], v[184:191], v20
    ds_read_b64_tr_b16 a[246:247], v9 offset:63488
    v_smfmac_f32_16x16x64_bf16 v[24:27], a[248:251], v[192:199], v20
    v_smfmac_f32_16x16x64_bf16 v[28:31], a[248:251], v[200:207], v20
    v_smfmac_f32_16x16x64_bf16 v[32:35], a[248:251], v[208:215], v20
    buffer_load_dwordx4 v7, s[8:11], s38 offen lds
    v_smfmac_f32_16x16x64_bf16 v[36:39], a[248:251], v[216:223], v20
    s_add_u32 s38, s44, 0
    ds_read_b64_tr_b16 a[184:185], v10 offset:0
    v_smfmac_f32_16x16x64_bf16 v[24:27], a[248:251], v[224:231], v20
    s_add_u32 m0, s63, 139264
    ds_read_b64_tr_b16 a[186:187], v10 offset:2048
    v_smfmac_f32_16x16x64_bf16 v[28:31], a[248:251], v[232:239], v20
    ds_read_b64_tr_b16 a[188:189], v10 offset:4096
    v_smfmac_f32_16x16x64_bf16 v[32:35], a[248:251], v[240:247], v20
    s_waitcnt lgkmcnt(3)
    ds_read_b64_tr_b16 a[190:191], v10 offset:6144
    v_smfmac_f32_16x16x64_bf16 v[36:39], a[248:251], v[248:255], v20
    v_smfmac_f32_16x16x64_bf16 v[24:27], a[248:251], v[56:63], v20
    v_smfmac_f32_16x16x64_bf16 v[28:31], a[248:251], v[64:71], v20
    v_smfmac_f32_16x16x64_bf16 v[32:35], a[248:251], v[72:79], v20
    buffer_load_dwordx4 v2, s[8:11], s38 offen lds
    v_smfmac_f32_16x16x64_bf16 v[36:39], a[248:251], v[80:87], v20
    s_add_u32 s38, s44, 0
    ds_read_b64_tr_b16 a[192:193], v10 offset:8192
    v_smfmac_f32_16x16x64_bf16 v[24:27], a[248:251], v[88:95], v20
    s_add_u32 m0, s63, 143360
    ds_read_b64_tr_b16 a[194:195], v10 offset:10240
    v_smfmac_f32_16x16x64_bf16 v[28:31], a[248:251], v[96:103], v20
    ds_read_b64_tr_b16 a[196:197], v10 offset:12288
    v_exp_f32 v48, v48
    v_exp_f32 v49, v49
    v_exp_f32 v50, v50
    v_exp_f32 v51, v51
    v_cvt_pk_bf16_f32 v110, v48, v49
    v_cvt_pk_bf16_f32 v111, v50, v51
    s_nop 1
    v_smfmac_f32_16x16x64_bf16 v[32:35], a[248:251], v[104:111], v20
    ds_read_b64_tr_b16 a[198:199], v10 offset:14336
    v_add_f32 v24, v24, v25
    v_exp_f32 v52, v52
    v_exp_f32 v53, v53
    v_exp_f32 v54, v54
    v_exp_f32 v55, v55
    v_cvt_pk_bf16_f32 v118, v52, v53
    v_cvt_pk_bf16_f32 v119, v54, v55
    s_nop 1
    v_smfmac_f32_16x16x64_bf16 v[36:39], a[248:251], v[112:119], v20
    v_add_f32 v28, v28, v29
    v_mfma_f32_16x16x32_bf16 a[152:155], a[232:235], v[88:91], a[152:155]
    v_rcp_f32 v16, v24
    v_mfma_f32_16x16x32_bf16 a[168:171], a[236:239], v[88:91], a[168:171]
    v_rcp_f32 v17, v28
    v_mfma_f32_16x16x32_bf16 a[172:175], a[236:239], v[96:99], a[172:175]
    buffer_load_dwordx4 v3, s[8:11], s38 offen lds
    v_mfma_f32_16x16x32_bf16 a[156:159], a[232:235], v[96:99], a[156:159]
    s_add_u32 s38, s44, 40960
    ds_read_b64_tr_b16 a[200:201], v10 offset:16384
    v_add_f32 v32, v32, v33
    v_mfma_f32_16x16x32_bf16 a[160:163], a[232:235], v[104:107], a[160:163]
    s_add_u32 m0, s63, 147456
    ds_read_b64_tr_b16 a[202:203], v10 offset:18432
    v_add_f32 v36, v36, v37
    v_mfma_f32_16x16x32_bf16 a[176:179], a[236:239], v[104:107], a[176:179]
    ds_read_b64_tr_b16 a[204:205], v10 offset:20480
    v_max3_f32 v21, v24, v28, v32
    v_mfma_f32_16x16x32_bf16 a[180:183], a[236:239], v[112:115], a[180:183]
    s_waitcnt lgkmcnt(3)
    ds_read_b64_tr_b16 a[206:207], v10 offset:22528
    v_max3_f32 v21, v21, v36, v16
    v_mfma_f32_16x16x32_bf16 a[164:167], a[232:235], v[112:115], a[164:167]
    v_rcp_f32 v18, v32
    v_mfma_f32_16x16x32_bf16 a[164:167], a[240:243], v[116:119], a[164:167]
    v_rcp_f32 v19, v36
    v_mfma_f32_16x16x32_bf16 a[180:183], a[244:247], v[116:119], a[180:183]
    v_max3_f32 v21, v21, v17, v18
    v_max_f32 v21, v21, v19
    v_mfma_f32_16x16x32_bf16 a[176:179], a[244:247], v[108:111], a[176:179]
    buffer_load_dwordx4 v2, s[8:11], s38 offen lds
    v_mfma_f32_16x16x32_bf16 a[160:163], a[240:243], v[108:111], a[160:163]
    s_add_u32 s38, s44, 40960
    ds_read_b64_tr_b16 a[208:209], v10 offset:24576
    v_cmp_nge_f32 vcc, 0x5f800000, v21
    v_mfma_f32_16x16x32_bf16 a[156:159], a[240:243], v[100:103], a[156:159]
    s_add_u32 m0, s63, 151552
    ds_read_b64_tr_b16 a[210:211], v10 offset:26624
    v_mfma_f32_16x16x32_bf16 a[172:175], a[244:247], v[100:103], a[172:175]
    ds_read_b64_tr_b16 a[212:213], v10 offset:28672
    v_mfma_f32_16x16x32_bf16 a[168:171], a[244:247], v[92:95], a[168:171]
    ds_read_b64_tr_b16 a[214:215], v10 offset:30720
    v_mfma_f32_16x16x32_bf16 a[152:155], a[240:243], v[92:95], a[152:155]
    s_cbranch_vccnz rare
rare_ret:
    v_mfma_f32_16x16x32_bf16 v[40:43], a[184:187], a[96:99], 0
    v_subrev_u32 v8, 73728, v8
    v_subrev_u32 v9, 73728, v9
    v_mfma_f32_16x16x32_bf16 v[40:43], a[188:191], a[100:103], v[40:43]
    v_mfma_f32_16x16x32_bf16 v[44:47], a[188:191], a[108:111], 0
    s_barrier
    v_mfma_f32_16x16x32_bf16 v[44:47], a[184:187], a[104:107], v[44:47]
    buffer_load_dwordx4 v3, s[8:11], s38 offen lds
    v_mfma_f32_16x16x32_bf16 v[48:51], a[184:187], a[112:115], 0
    v_accvgpr_read_b32 v21, a152
    v_accvgpr_read_b32 v22, a153
    v_mfma_f32_16x16x32_bf16 v[48:51], a[188:191], a[116:119], v[48:51]
    v_accvgpr_read_b32 v23, a154
    v_accvgpr_read_b32 v5, a155
    v_mfma_f32_16x16x32_bf16 v[52:55], a[188:191], a[124:127], 0
    v_mul_f32 v21, v16, v21
    v_mul_f32 v22, v16, v22
    v_mfma_f32_16x16x32_bf16 v[52:55], a[184:187], a[120:123], v[52:55]
    ds_read_b64_tr_b16 a[184:185], v10 offset:32768
    v_mul_f32 v23, v16, v23
    v_mfma_f32_16x16x32_bf16 v[52:55], a[192:195], v[120:123], v[52:55]
    ds_read_b64_tr_b16 a[186:187], v10 offset:34816
    v_mul_f32 v5, v16, v5
    v_mfma_f32_16x16x32_bf16 v[52:55], a[196:199], v[124:127], v[52:55]
    ds_read_b64_tr_b16 a[188:189], v10 offset:36864
    v_cvt_pk_bf16_f32 v21, v21, v22
    v_mfma_f32_16x16x32_bf16 v[48:51], a[196:199], a[148:151], v[48:51]
    s_waitcnt lgkmcnt(3)
    ds_read_b64_tr_b16 a[190:191], v10 offset:38912
    v_cvt_pk_bf16_f32 v22, v23, v5
    v_mfma_f32_16x16x32_bf16 v[48:51], a[192:195], a[144:147], v[48:51]
    v_accvgpr_write_b32 a0, v21
    v_accvgpr_write_b32 a1, v22
    v_mfma_f32_16x16x32_bf16 v[44:47], a[192:195], a[136:139], v[44:47]
    v_accvgpr_read_b32 v21, a168
    v_accvgpr_read_b32 v22, a169
    v_mfma_f32_16x16x32_bf16 v[44:47], a[196:199], a[140:143], v[44:47]
    v_accvgpr_read_b32 v23, a170
    v_accvgpr_read_b32 v5, a171
    v_mfma_f32_16x16x32_bf16 v[40:43], a[196:199], a[132:135], v[40:43]
    v_mul_f32 v21, v16, v21
    v_mul_f32 v22, v16, v22
    v_mfma_f32_16x16x32_bf16 v[40:43], a[192:195], a[128:131], v[40:43]
    ds_read_b64_tr_b16 a[192:193], v10 offset:40960
    v_mul_f32 v23, v16, v23
    v_mfma_f32_16x16x32_bf16 v[40:43], a[200:203], v[128:131], v[40:43]
    ds_read_b64_tr_b16 a[194:195], v10 offset:43008
    v_mul_f32 v5, v16, v5
    v_mfma_f32_16x16x32_bf16 v[40:43], a[204:207], v[132:135], v[40:43]
    ds_read_b64_tr_b16 a[196:197], v10 offset:45056
    v_cvt_pk_bf16_f32 v21, v21, v22
    v_mfma_f32_16x16x32_bf16 v[44:47], a[204:207], v[140:143], v[44:47]
    ds_read_b64_tr_b16 a[198:199], v10 offset:47104
    v_cvt_pk_bf16_f32 v22, v23, v5
    v_mfma_f32_16x16x32_bf16 v[44:47], a[200:203], v[136:139], v[44:47]
    v_accvgpr_write_b32 a2, v21
    v_accvgpr_write_b32 a3, v22
    v_mfma_f32_16x16x32_bf16 v[48:51], a[200:203], v[144:147], v[48:51]
    buffer_store_dwordx4 a[0:3], v14, s[20:23], s55 offen offset:0 sc1
    v_accvgpr_read_b32 v21, a156
    v_mfma_f32_16x16x32_bf16 v[48:51], a[204:207], v[148:151], v[48:51]
    v_accvgpr_read_b32 v22, a157
    v_accvgpr_read_b32 v23, a158
    v_mfma_f32_16x16x32_bf16 v[52:55], a[204:207], v[156:159], v[52:55]
    v_accvgpr_read_b32 v5, a159
    v_mul_f32 v21, v17, v21
    v_mfma_f32_16x16x32_bf16 v[52:55], a[200:203], v[152:155], v[52:55]
    ds_read_b64_tr_b16 a[200:201], v10 offset:49152
    v_mul_f32 v22, v17, v22
    v_mfma_f32_16x16x32_bf16 v[52:55], a[208:211], v[184:187], v[52:55]
    ds_read_b64_tr_b16 a[202:203], v10 offset:51200
    v_mul_f32 v23, v17, v23
    v_mfma_f32_16x16x32_bf16 v[52:55], a[212:215], v[188:191], v[52:55]
    ds_read_b64_tr_b16 a[204:205], v10 offset:53248
    v_mul_f32 v5, v17, v5
    v_mfma_f32_16x16x32_bf16 v[48:51], a[212:215], v[180:183], v[48:51]
    s_waitcnt lgkmcnt(3)
    ds_read_b64_tr_b16 a[206:207], v10 offset:55296
    v_cvt_pk_bf16_f32 v21, v21, v22
    v_mfma_f32_16x16x32_bf16 v[48:51], a[208:211], v[176:179], v[48:51]
    v_cvt_pk_bf16_f32 v22, v23, v5
    v_accvgpr_write_b32 a4, v21
    v_mfma_f32_16x16x32_bf16 v[44:47], a[208:211], v[168:171], v[44:47]
    v_accvgpr_write_b32 a5, v22
    v_accvgpr_read_b32 v21, a172
    v_mfma_f32_16x16x32_bf16 v[44:47], a[212:215], v[172:175], v[44:47]
    v_accvgpr_read_b32 v22, a173
    v_accvgpr_read_b32 v23, a174
    v_mfma_f32_16x16x32_bf16 v[40:43], a[212:215], v[164:167], v[40:43]
    v_accvgpr_read_b32 v5, a175
    v_mul_f32 v21, v17, v21
    v_mfma_f32_16x16x32_bf16 v[40:43], a[208:211], v[160:163], v[40:43]
    ds_read_b64_tr_b16 a[208:209], v10 offset:57344
    v_mul_f32 v22, v17, v22
    v_mfma_f32_16x16x32_bf16 v[40:43], a[184:187], v[192:195], v[40:43]
    ds_read_b64_tr_b16 a[210:211], v10 offset:59392
    v_mul_f32 v23, v17, v23
    v_mfma_f32_16x16x32_bf16 v[40:43], a[188:191], v[196:199], v[40:43]
    ds_read_b64_tr_b16 a[212:213], v10 offset:61440
    v_mul_f32 v5, v17, v5
    v_mfma_f32_16x16x32_bf16 v[44:47], a[188:191], v[204:207], v[44:47]
    ds_read_b64_tr_b16 a[214:215], v10 offset:63488
    v_cvt_pk_bf16_f32 v21, v21, v22
    v_mfma_f32_16x16x32_bf16 v[44:47], a[184:187], v[200:203], v[44:47]
    v_cvt_pk_bf16_f32 v22, v23, v5
    v_accvgpr_write_b32 a6, v21
    v_mfma_f32_16x16x32_bf16 v[48:51], a[184:187], v[208:211], v[48:51]
    v_accvgpr_write_b32 a7, v22
    v_accvgpr_read_b32 v21, a160
    v_mfma_f32_16x16x32_bf16 v[48:51], a[188:191], v[212:215], v[48:51]
    buffer_store_dwordx4 a[4:7], v14, s[20:23], s55 offen offset:1024 sc1
    v_accvgpr_read_b32 v22, a161
    v_mfma_f32_16x16x32_bf16 v[52:55], a[188:191], v[220:223], v[52:55]
    v_accvgpr_read_b32 v23, a162
    v_accvgpr_read_b32 v5, a163
    v_mfma_f32_16x16x32_bf16 v[52:55], a[184:187], v[216:219], v[52:55]
    ds_read_b64_tr_b16 a[184:185], v11 offset:0
    v_mul_f32 v21, v18, v21
    v_mfma_f32_16x16x32_bf16 v[52:55], a[192:195], v[248:251], v[52:55]
    ds_read_b64_tr_b16 a[186:187], v11 offset:2048
    v_mul_f32 v22, v18, v22
    v_mfma_f32_16x16x32_bf16 v[52:55], a[196:199], v[252:255], v[52:55]
    ds_read_b64_tr_b16 a[188:189], v11 offset:4096
    v_mul_f32 v23, v18, v23
    v_mfma_f32_16x16x32_bf16 v[48:51], a[196:199], v[244:247], v[48:51]
    s_waitcnt lgkmcnt(3)
    ds_read_b64_tr_b16 a[190:191], v11 offset:6144
    v_mul_f32 v5, v18, v5
    v_mfma_f32_16x16x32_bf16 v[48:51], a[192:195], v[240:243], v[48:51]
    v_cvt_pk_bf16_f32 v21, v21, v22
    v_cvt_pk_bf16_f32 v22, v23, v5
    v_mfma_f32_16x16x32_bf16 v[44:47], a[192:195], v[232:235], v[44:47]
    v_accvgpr_write_b32 a8, v21
    v_accvgpr_write_b32 a9, v22
    v_mfma_f32_16x16x32_bf16 v[44:47], a[196:199], v[236:239], v[44:47]
    v_accvgpr_read_b32 v21, a176
    v_accvgpr_read_b32 v22, a177
    v_mfma_f32_16x16x32_bf16 v[40:43], a[196:199], v[228:231], v[40:43]
    v_accvgpr_read_b32 v23, a178
    v_accvgpr_read_b32 v5, a179
    v_mfma_f32_16x16x32_bf16 v[40:43], a[192:195], v[224:227], v[40:43]
    ds_read_b64_tr_b16 a[192:193], v11 offset:8192
    v_mul_f32 v21, v18, v21
    v_mfma_f32_16x16x32_bf16 v[40:43], a[200:203], v[56:59], v[40:43]
    ds_read_b64_tr_b16 a[194:195], v11 offset:10240
    v_mul_f32 v22, v18, v22
    v_mfma_f32_16x16x32_bf16 v[40:43], a[204:207], v[60:63], v[40:43]
    ds_read_b64_tr_b16 a[196:197], v11 offset:12288
    v_mul_f32 v23, v18, v23
    v_mfma_f32_16x16x32_bf16 v[44:47], a[204:207], v[68:71], v[44:47]
    ds_read_b64_tr_b16 a[198:199], v11 offset:14336
    v_mul_f32 v5, v18, v5
    v_mfma_f32_16x16x32_bf16 v[44:47], a[200:203], v[64:67], v[44:47]
    v_cvt_pk_bf16_f32 v21, v21, v22
    v_cvt_pk_bf16_f32 v22, v23, v5
    v_mfma_f32_16x16x32_bf16 v[48:51], a[200:203], v[72:75], v[48:51]
    v_accvgpr_write_b32 a10, v21
    v_accvgpr_write_b32 a11, v22
    v_mfma_f32_16x16x32_bf16 v[48:51], a[204:207], v[76:79], v[48:51]
    buffer_store_dwordx4 a[8:11], v14, s[20:23], s55 offen offset:2048 sc1
    v_accvgpr_read_b32 v21, a164
    v_mfma_f32_16x16x32_bf16 v[52:55], a[204:207], v[84:87], v[52:55]
    v_accvgpr_read_b32 v22, a165
    v_accvgpr_read_b32 v23, a166
    v_mfma_f32_16x16x32_bf16 v[52:55], a[200:203], v[80:83], v[52:55]
    ds_read_b64_tr_b16 a[200:201], v11 offset:16384
    v_accvgpr_read_b32 v5, a167
    v_mfma_f32_16x16x32_bf16 v[52:55], a[208:211], v[112:115], v[52:55]
    ds_read_b64_tr_b16 a[202:203], v11 offset:18432
    v_mul_f32 v21, v19, v21
    v_mfma_f32_16x16x32_bf16 v[52:55], a[212:215], v[116:119], v[52:55]
    ds_read_b64_tr_b16 a[204:205], v11 offset:20480
    v_mul_f32 v22, v19, v22
    v_mfma_f32_16x16x32_bf16 v[48:51], a[212:215], v[108:111], v[48:51]
    s_waitcnt lgkmcnt(3)
    ds_read_b64_tr_b16 a[206:207], v11 offset:22528
    v_mul_f32 v23, v19, v23
    v_mfma_f32_16x16x32_bf16 v[48:51], a[208:211], v[104:107], v[48:51]
    v_mul_f32 v5, v19, v5
    v_cvt_pk_bf16_f32 v21, v21, v22
    v_mfma_f32_16x16x32_bf16 v[44:47], a[208:211], v[96:99], v[44:47]
    v_cvt_pk_bf16_f32 v22, v23, v5
    v_accvgpr_write_b32 a12, v21
    v_mfma_f32_16x16x32_bf16 v[44:47], a[212:215], v[100:103], v[44:47]
    v_accvgpr_write_b32 a13, v22
    v_accvgpr_read_b32 v21, a180
    v_mfma_f32_16x16x32_bf16 v[40:43], a[212:215], v[92:95], v[40:43]
    v_accvgpr_read_b32 v22, a181
    v_accvgpr_read_b32 v23, a182
    v_mfma_f32_16x16x32_bf16 v[40:43], a[208:211], v[88:91], v[40:43]
    ds_read_b64_tr_b16 a[208:209], v11 offset:24576
    v_accvgpr_read_b32 v5, a183
    v_mfma_f32_16x16x32_bf16 v[24:27], a[184:187], a[96:99], 0
    ds_read_b64_tr_b16 a[210:211], v11 offset:26624
    v_mul_f32 v21, v19, v21
    v_mfma_f32_16x16x32_bf16 v[24:27], a[188:191], a[100:103], v[24:27]
    ds_read_b64_tr_b16 a[212:213], v11 offset:28672
    v_mul_f32 v22, v19, v22
    v_mfma_f32_16x16x32_bf16 v[28:31], a[188:191], a[108:111], 0
    ds_read_b64_tr_b16 a[214:215], v11 offset:30720
    v_mul_f32 v23, v19, v23
    v_mfma_f32_16x16x32_bf16 v[28:31], a[184:187], a[104:107], v[28:31]
    v_mul_f32 v5, v19, v5
    v_cvt_pk_bf16_f32 v21, v21, v22
    v_mfma_f32_16x16x32_bf16 v[32:35], a[184:187], a[112:115], 0
    v_cvt_pk_bf16_f32 v22, v23, v5
    v_accvgpr_write_b32 a14, v21
    v_mfma_f32_16x16x32_bf16 v[32:35], a[188:191], a[116:119], v[32:35]
    v_accvgpr_write_b32 a15, v22
    v_mul_f32 v40, v16, v40
    v_mfma_f32_16x16x32_bf16 v[36:39], a[188:191], a[124:127], 0
    buffer_store_dwordx4 a[12:15], v14, s[20:23], s55 offen offset:3072 sc1
    v_mul_f32 v41, v16, v41
    v_mfma_f32_16x16x32_bf16 v[36:39], a[184:187], a[120:123], v[36:39]
    s_add_u32 s55, s55, 4096
    ds_read_b64_tr_b16 a[184:185], v11 offset:32768
    v_mul_f32 v42, v16, v42
    v_mfma_f32_16x16x32_bf16 v[36:39], a[192:195], v[120:123], v[36:39]
    ds_read_b64_tr_b16 a[186:187], v11 offset:34816
    v_mul_f32 v43, v16, v43
    v_mfma_f32_16x16x32_bf16 v[36:39], a[196:199], v[124:127], v[36:39]
pg_9:
    s_cbranch_execz pg_13
    ds_read_b64_tr_b16 a[188:189], v11 offset:36864
    v_cvt_pk_bf16_f32 v40, v40, v41
    v_mfma_f32_16x16x32_bf16 v[32:35], a[196:199], a[148:151], v[32:35]
    s_waitcnt lgkmcnt(3)
    ds_read_b64_tr_b16 a[190:191], v11 offset:38912
    v_cvt_pk_bf16_f32 v41, v42, v43
    v_mfma_f32_16x16x32_bf16 v[32:35], a[192:195], a[144:147], v[32:35]
    v_accvgpr_write_b32 a16, v40
    v_accvgpr_write_b32 a17, v41
    v_mfma_f32_16x16x32_bf16 v[28:31], a[192:195], a[136:139], v[28:31]
    v_mul_f32 v44, v17, v44
    v_mul_f32 v45, v17, v45
    v_mfma_f32_16x16x32_bf16 v[28:31], a[196:199], a[140:143], v[28:31]
    v_mul_f32 v46, v17, v46
    v_mul_f32 v47, v17, v47
    v_mfma_f32_16x16x32_bf16 v[24:27], a[196:199], a[132:135], v[24:27]
    v_cvt_pk_bf16_f32 v44, v44, v45
    v_cvt_pk_bf16_f32 v45, v46, v47
    v_mfma_f32_16x16x32_bf16 v[24:27], a[192:195], a[128:131], v[24:27]
    ds_read_b64_tr_b16 a[192:193], v11 offset:40960
    v_accvgpr_write_b32 a20, v44
    v_mfma_f32_16x16x32_bf16 v[24:27], a[200:203], v[128:131], v[24:27]
    ds_read_b64_tr_b16 a[194:195], v11 offset:43008
    v_accvgpr_write_b32 a21, v45
    v_mfma_f32_16x16x32_bf16 v[24:27], a[204:207], v[132:135], v[24:27]
    ds_read_b64_tr_b16 a[196:197], v11 offset:45056
    v_mul_f32 v48, v18, v48
    v_mfma_f32_16x16x32_bf16 v[28:31], a[204:207], v[140:143], v[28:31]
    ds_read_b64_tr_b16 a[198:199], v11 offset:47104
    v_mul_f32 v49, v18, v49
    v_mfma_f32_16x16x32_bf16 v[28:31], a[200:203], v[136:139], v[28:31]
    v_mul_f32 v50, v18, v50
    v_mul_f32 v51, v18, v51
    v_mfma_f32_16x16x32_bf16 v[32:35], a[200:203], v[144:147], v[32:35]
    v_cvt_pk_bf16_f32 v48, v48, v49
    v_cvt_pk_bf16_f32 v49, v50, v51
    v_mfma_f32_16x16x32_bf16 v[32:35], a[204:207], v[148:151], v[32:35]
    v_accvgpr_write_b32 a24, v48
    v_accvgpr_write_b32 a25, v49
    v_mfma_f32_16x16x32_bf16 v[36:39], a[204:207], v[156:159], v[36:39]
    v_mul_f32 v52, v19, v52
    v_mul_f32 v53, v19, v53
    v_mfma_f32_16x16x32_bf16 v[36:39], a[200:203], v[152:155], v[36:39]
    ds_read_b64_tr_b16 a[200:201], v11 offset:49152
    v_mul_f32 v54, v19, v54
    v_mfma_f32_16x16x32_bf16 v[36:39], a[208:211], v[184:187], v[36:39]
    ds_read_b64_tr_b16 a[202:203], v11 offset:51200
    v_mul_f32 v55, v19, v55
    v_mfma_f32_16x16x32_bf16 v[36:39], a[212:215], v[188:191], v[36:39]
    ds_read_b64_tr_b16 a[204:205], v11 offset:53248
    v_cvt_pk_bf16_f32 v52, v52, v53
    v_mfma_f32_16x16x32_bf16 v[32:35], a[212:215], v[180:183], v[32:35]
    s_waitcnt lgkmcnt(3)
    ds_read_b64_tr_b16 a[206:207], v11 offset:55296
    v_cvt_pk_bf16_f32 v53, v54, v55
    v_mfma_f32_16x16x32_bf16 v[32:35], a[208:211], v[176:179], v[32:35]
    v_accvgpr_write_b32 a28, v52
    v_accvgpr_write_b32 a29, v53
    v_mfma_f32_16x16x32_bf16 v[28:31], a[208:211], v[168:171], v[28:31]
    v_subrev_u32 v10, 73728, v10
    v_mfma_f32_16x16x32_bf16 v[28:31], a[212:215], v[172:175], v[28:31]
    v_mfma_f32_16x16x32_bf16 v[24:27], a[212:215], v[164:167], v[24:27]
    v_mfma_f32_16x16x32_bf16 v[24:27], a[208:211], v[160:163], v[24:27]
    ds_read_b64_tr_b16 a[208:209], v11 offset:57344
    v_mfma_f32_16x16x32_bf16 v[24:27], a[184:187], v[192:195], v[24:27]
    ds_read_b64_tr_b16 a[210:211], v11 offset:59392
    v_mfma_f32_16x16x32_bf16 v[24:27], a[188:191], v[196:199], v[24:27]
    ds_read_b64_tr_b16 a[212:213], v11 offset:61440
    v_mfma_f32_16x16x32_bf16 v[28:31], a[188:191], v[204:207], v[28:31]
    ds_read_b64_tr_b16 a[214:215], v11 offset:63488
    v_mfma_f32_16x16x32_bf16 v[28:31], a[184:187], v[200:203], v[28:31]
    s_add_u32 s39, s40, 256
    v_subrev_u32 v11, 73728, v11
    v_mfma_f32_16x16x32_bf16 v[32:35], a[184:187], v[208:211], v[32:35]
    v_mfma_f32_16x16x32_bf16 v[32:35], a[188:191], v[212:215], v[32:35]
    s_add_u32 m0, s63, 73728
    v_mfma_f32_16x16x32_bf16 v[36:39], a[188:191], v[220:223], v[36:39]
    v_mfma_f32_16x16x32_bf16 v[36:39], a[184:187], v[216:219], v[36:39]
    v_mfma_f32_16x16x32_bf16 v[36:39], a[192:195], v[248:251], v[36:39]
    v_mfma_f32_16x16x32_bf16 v[36:39], a[196:199], v[252:255], v[36:39]
    s_waitcnt vmcnt(17) lgkmcnt(0)
    v_mfma_f32_16x16x32_bf16 v[32:35], a[196:199], v[244:247], v[32:35]
    s_barrier
    v_mfma_f32_16x16x32_bf16 v[32:35], a[192:195], v[240:243], v[32:35]
    buffer_load_dwordx4 v6, s[16:19], s39 offen lds
    v_mfma_f32_16x16x32_bf16 v[28:31], a[192:195], v[232:235], v[28:31]
    ds_read_b64_tr_b16 a[184:185], v8 offset:49152
    v_mfma_f32_16x16x32_bf16 v[28:31], a[196:199], v[236:239], v[28:31]
    ds_read_b64_tr_b16 a[186:187], v8 offset:51200
    v_mfma_f32_16x16x32_bf16 v[24:27], a[196:199], v[228:231], v[24:27]
    ds_read_b64_tr_b16 a[188:189], v8 offset:53248
    v_mfma_f32_16x16x32_bf16 v[24:27], a[192:195], v[224:227], v[24:27]
    s_add_u32 s39, s40, 12544
    ds_read_b64_tr_b16 a[190:191], v8 offset:55296
    v_mfma_f32_16x16x32_bf16 v[24:27], a[200:203], v[56:59], v[24:27]
    ds_read_b64_tr_b16 a[192:193], v8 offset:57344
    v_mfma_f32_16x16x32_bf16 v[24:27], a[204:207], v[60:63], v[24:27]
    s_add_u32 m0, s63, 77824
    ds_read_b64_tr_b16 a[194:195], v8 offset:59392
    v_mfma_f32_16x16x32_bf16 v[28:31], a[204:207], v[68:71], v[28:31]
    ds_read_b64_tr_b16 a[196:197], v8 offset:61440
    v_mfma_f32_16x16x32_bf16 v[28:31], a[200:203], v[64:67], v[28:31]
    ds_read_b64_tr_b16 a[198:199], v8 offset:63488
    v_mfma_f32_16x16x32_bf16 v[32:35], a[200:203], v[72:75], v[32:35]
    v_mfma_f32_16x16x32_bf16 v[32:35], a[204:207], v[76:79], v[32:35]
    v_mfma_f32_16x16x32_bf16 v[36:39], a[204:207], v[84:87], v[36:39]
    v_mfma_f32_16x16x32_bf16 v[36:39], a[200:203], v[80:83], v[36:39]
    buffer_load_dwordx4 v6, s[16:19], s39 offen lds
    v_mfma_f32_16x16x32_bf16 v[36:39], a[208:211], v[112:115], v[36:39]
    ds_read_b64_tr_b16 a[200:201], v8 offset:0
    v_mfma_f32_16x16x32_bf16 v[36:39], a[212:215], v[116:119], v[36:39]
    ds_read_b64_tr_b16 a[202:203], v8 offset:2048
    v_mfma_f32_16x16x32_bf16 v[32:35], a[212:215], v[108:111], v[32:35]
    ds_read_b64_tr_b16 a[204:205], v8 offset:4096
    v_mfma_f32_16x16x32_bf16 v[32:35], a[208:211], v[104:107], v[32:35]
    s_waitcnt lgkmcnt(3)
    ds_read_b64_tr_b16 a[206:207], v8 offset:6144
    s_add_u32 s39, s40, 24832
    v_mfma_f32_16x16x32_bf16 v[28:31], a[208:211], v[96:99], v[28:31]
    v_mul_f32 v36, v19, v36
    v_mfma_f32_16x16x32_bf16 v[28:31], a[212:215], v[100:103], v[28:31]
    s_add_u32 m0, s63, 81920
    v_mul_f32 v37, v19, v37
    v_mul_f32 v32, v18, v32
    v_mfma_f32_16x16x32_bf16 v[24:27], a[212:215], v[92:95], v[24:27]
    v_mul_f32 v33, v18, v33
    v_mfma_f32_16x16x32_bf16 v[24:27], a[208:211], v[88:91], v[24:27]
    ds_read_b64_tr_b16 a[208:209], v8 offset:8192
    v_mfma_f32_16x16x32_bf16 v[40:43], a[184:187], a[96:99], 0
    ds_read_b64_tr_b16 a[210:211], v8 offset:10240
    v_mul_f32 v28, v17, v28
    v_mfma_f32_16x16x32_bf16 v[40:43], a[188:191], a[100:103], v[40:43]
    ds_read_b64_tr_b16 a[212:213], v8 offset:12288
    v_mul_f32 v29, v17, v29
    v_mfma_f32_16x16x32_bf16 v[44:47], a[188:191], a[108:111], 0
    ds_read_b64_tr_b16 a[214:215], v8 offset:14336
    v_mul_f32 v24, v16, v24
    v_mfma_f32_16x16x32_bf16 v[44:47], a[184:187], a[104:107], v[44:47]
    buffer_load_dwordx4 v6, s[16:19], s39 offen lds
    v_mfma_f32_16x16x32_bf16 v[48:51], a[184:187], a[112:115], 0
    v_mul_f32 v25, v16, v25
    v_mul_f32 v26, v16, v26
    v_mfma_f32_16x16x32_bf16 v[48:51], a[188:191], a[116:119], v[48:51]
    v_mul_f32 v27, v16, v27
    v_cvt_pk_bf16_f32 v24, v24, v25
    v_mfma_f32_16x16x32_bf16 v[52:55], a[188:191], a[124:127], 0
    v_cvt_pk_bf16_f32 v25, v26, v27
    v_accvgpr_write_b32 a18, v24
    v_mfma_f32_16x16x32_bf16 v[52:55], a[184:187], a[120:123], v[52:55]
    s_add_u32 s39, s40, 37120
    v_accvgpr_write_b32 a19, v25
    v_mul_f32 v30, v17, v30
    v_mfma_f32_16x16x32_bf16 v[52:55], a[192:195], v[120:123], v[52:55]
    buffer_store_dwordx4 a[16:19], v14, s[20:23], s55 offen offset:0 sc1
    v_mul_f32 v31, v17, v31
    v_mfma_f32_16x16x32_bf16 v[52:55], a[196:199], v[124:127], v[52:55]
    s_add_u32 m0, s63, 86016
    v_cvt_pk_bf16_f32 v28, v28, v29
    v_cvt_pk_bf16_f32 v29, v30, v31
    v_mfma_f32_16x16x32_bf16 v[48:51], a[196:199], a[148:151], v[48:51]
    v_accvgpr_write_b32 a22, v28
    v_accvgpr_write_b32 a23, v29
    v_mfma_f32_16x16x32_bf16 v[48:51], a[192:195], a[144:147], v[48:51]
    buffer_store_dwordx4 a[20:23], v14, s[20:23], s55 offen offset:1024 sc1
    v_mul_f32 v34, v18, v34
    v_mfma_f32_16x16x32_bf16 v[44:47], a[192:195], a[136:139], v[44:47]
    v_mul_f32 v35, v18, v35
    v_mfma_f32_16x16x32_bf16 v[44:47], a[196:199], a[140:143], v[44:47]
    s_waitcnt lgkmcnt(0)
    v_cvt_pk_bf16_f32 v32, v32, v33
    v_mfma_f32_16x16x32_bf16 v[40:43], a[196:199], a[132:135], v[40:43]
    v_cvt_pk_bf16_f32 v33, v34, v35
    v_accvgpr_write_b32 a26, v32
    v_mfma_f32_16x16x32_bf16 v[40:43], a[192:195], a[128:131], v[40:43]
    buffer_load_dwordx4 v6, s[16:19], s39 offen lds
    v_mfma_f32_16x16x32_bf16 v[40:43], a[200:203], v[128:131], v[40:43]
    v_accvgpr_write_b32 a27, v33
    v_mfma_f32_16x16x32_bf16 v[40:43], a[204:207], v[132:135], v[40:43]
    buffer_store_dwordx4 a[24:27], v14, s[20:23], s55 offen offset:2048 sc1
    v_mul_f32 v38, v19, v38
    v_mfma_f32_16x16x32_bf16 v[44:47], a[204:207], v[140:143], v[44:47]
    v_mul_f32 v39, v19, v39
    v_mfma_f32_16x16x32_bf16 v[44:47], a[200:203], v[136:139], v[44:47]
    s_waitcnt vmcnt(16)
    v_cvt_pk_bf16_f32 v36, v36, v37
    s_add_u32 s39, s40, 49408
    v_mfma_f32_16x16x32_bf16 v[48:51], a[200:203], v[144:147], v[48:51]
    s_barrier
    v_mfma_f32_16x16x32_bf16 v[48:51], a[204:207], v[148:151], v[48:51]
    s_add_u32 m0, s63, 90112
    ds_read_b64_tr_b16 a[184:185], v8 offset:16384
    v_cvt_pk_bf16_f32 v37, v38, v39
    v_mfma_f32_16x16x32_bf16 v[52:55], a[204:207], v[156:159], v[52:55]
    s_waitcnt vmcnt(7)
    ds_read_b64_tr_b16 a[186:187], v8 offset:18432
    v_accvgpr_write_b32 a30, v36
    v_mfma_f32_16x16x32_bf16 v[52:55], a[200:203], v[152:155], v[52:55]
    buffer_store_dword v4, v15, s[24:27], s76 offen sc1
    v_mfma_f32_16x16x32_bf16 v[52:55], a[208:211], v[184:187], v[52:55]
    ds_read_b64_tr_b16 a[188:189], v8 offset:20480
    v_mov_b32 v4, s56
    v_mfma_f32_16x16x32_bf16 v[52:55], a[212:215], v[188:191], v[52:55]
    s_add_u32 s56, s7, 3
    ds_read_b64_tr_b16 a[190:191], v8 offset:22528
    v_accvgpr_write_b32 a31, v37
    v_mfma_f32_16x16x32_bf16 v[48:51], a[212:215], v[180:183], v[48:51]
    buffer_store_dwordx4 a[28:31], v14, s[20:23], s55 offen offset:3072 sc1
    v_mfma_f32_16x16x32_bf16 v[48:51], a[208:211], v[176:179], v[48:51]
    buffer_load_dwordx4 v6, s[16:19], s39 offen lds
    v_mfma_f32_16x16x32_bf16 v[44:47], a[208:211], v[168:171], v[44:47]
    s_add_u32 s55, s55, 4096
    ds_read_b64_tr_b16 a[192:193], v8 offset:24576
    v_mfma_f32_16x16x32_bf16 v[44:47], a[212:215], v[172:175], v[44:47]
    s_waitcnt lgkmcnt(3)
    ds_read_b64_tr_b16 a[194:195], v8 offset:26624
    v_mfma_f32_16x16x32_bf16 v[40:43], a[212:215], v[164:167], v[40:43]
    ds_read_b64_tr_b16 a[196:197], v8 offset:28672
    v_mfma_f32_16x16x32_bf16 v[40:43], a[208:211], v[160:163], v[40:43]
    s_add_u32 s39, s40, 61696
    ds_read_b64_tr_b16 a[198:199], v8 offset:30720
    v_mfma_f32_16x16x32_bf16 v[40:43], a[184:187], v[192:195], v[40:43]
    s_waitcnt lgkmcnt(4)
    ds_read_b64_tr_b16 a[200:201], v8 offset:32768
    v_mfma_f32_16x16x32_bf16 v[40:43], a[188:191], v[196:199], v[40:43]
    s_add_u32 m0, s63, 94208
    ds_read_b64_tr_b16 a[202:203], v8 offset:34816
    v_mfma_f32_16x16x32_bf16 v[44:47], a[188:191], v[204:207], v[44:47]
    ds_read_b64_tr_b16 a[204:205], v8 offset:36864
    v_mfma_f32_16x16x32_bf16 v[44:47], a[184:187], v[200:203], v[44:47]
    ds_read_b64_tr_b16 a[206:207], v8 offset:38912
    v_mfma_f32_16x16x32_bf16 v[48:51], a[184:187], v[208:211], v[48:51]
    ds_read_b64_tr_b16 a[208:209], v8 offset:40960
    v_mfma_f32_16x16x32_bf16 v[48:51], a[188:191], v[212:215], v[48:51]
    s_waitcnt lgkmcnt(6)
    ds_read_b64_tr_b16 a[210:211], v8 offset:43008
    v_mfma_f32_16x16x32_bf16 v[52:55], a[188:191], v[220:223], v[52:55]
    s_waitcnt lgkmcnt(6)
    ds_read_b64_tr_b16 a[212:213], v8 offset:45056
    v_mfma_f32_16x16x32_bf16 v[52:55], a[184:187], v[216:219], v[52:55]
    buffer_load_dwordx4 v6, s[16:19], s39 offen lds
    v_mfma_f32_16x16x32_bf16 v[52:55], a[192:195], v[248:251], v[52:55]
    ds_read_b64_tr_b16 a[214:215], v8 offset:47104
    v_mfma_f32_16x16x32_bf16 v[52:55], a[196:199], v[252:255], v[52:55]
    ds_read_b64_tr_b16 a[184:185], v9 offset:49152
    v_mfma_f32_16x16x32_bf16 v[48:51], a[196:199], v[244:247], v[48:51]
    ds_read_b64_tr_b16 a[186:187], v9 offset:51200
    v_mfma_f32_16x16x32_bf16 v[48:51], a[192:195], v[240:243], v[48:51]
    s_add_u32 s39, s40, 73984
    ds_read_b64_tr_b16 a[188:189], v9 offset:53248
    v_mfma_f32_16x16x32_bf16 v[44:47], a[192:195], v[232:235], v[44:47]
    s_waitcnt lgkmcnt(5)
    ds_read_b64_tr_b16 a[190:191], v9 offset:55296
    v_mfma_f32_16x16x32_bf16 v[44:47], a[196:199], v[236:239], v[44:47]
    s_add_u32 m0, s63, 98304
    v_add_u32 v8, 73728, v8
    v_mfma_f32_16x16x32_bf16 v[40:43], a[196:199], v[228:231], v[40:43]
    v_mfma_f32_16x16x32_bf16 v[40:43], a[192:195], v[224:227], v[40:43]
    ds_read_b64_tr_b16 a[192:193], v9 offset:57344
    v_mfma_f32_16x16x32_bf16 v[40:43], a[200:203], v[56:59], v[40:43]
    ds_read_b64_tr_b16 a[194:195], v9 offset:59392
    v_mfma_f32_16x16x32_bf16 v[40:43], a[204:207], v[60:63], v[40:43]
    ds_read_b64_tr_b16 a[196:197], v9 offset:61440
    v_mfma_f32_16x16x32_bf16 v[44:47], a[204:207], v[68:71], v[44:47]
    ds_read_b64_tr_b16 a[198:199], v9 offset:63488
    v_mfma_f32_16x16x32_bf16 v[44:47], a[200:203], v[64:67], v[44:47]
    buffer_load_dwordx4 v6, s[16:19], s39 offen lds
    v_mfma_f32_16x16x32_bf16 v[48:51], a[200:203], v[72:75], v[48:51]
    v_mfma_f32_16x16x32_bf16 v[48:51], a[204:207], v[76:79], v[48:51]
    v_mfma_f32_16x16x32_bf16 v[52:55], a[204:207], v[84:87], v[52:55]
    s_waitcnt lgkmcnt(3)
    v_mfma_f32_16x16x32_bf16 v[52:55], a[200:203], v[80:83], v[52:55]
    s_add_u32 s39, s40, 86272
    ds_read_b64_tr_b16 a[200:201], v9 offset:0
    v_mfma_f32_16x16x32_bf16 v[52:55], a[208:211], v[112:115], v[52:55]
    ds_read_b64_tr_b16 a[202:203], v9 offset:2048
    v_mfma_f32_16x16x32_bf16 v[52:55], a[212:215], v[116:119], v[52:55]
    s_add_u32 m0, s63, 102400
    ds_read_b64_tr_b16 a[204:205], v9 offset:4096
    v_mfma_f32_16x16x32_bf16 v[48:51], a[212:215], v[108:111], v[48:51]
    ds_read_b64_tr_b16 a[206:207], v9 offset:6144
    v_mfma_f32_16x16x32_bf16 v[48:51], a[208:211], v[104:107], v[48:51]
    v_mfma_f32_16x16x32_bf16 v[44:47], a[208:211], v[96:99], v[44:47]
    v_mfma_f32_16x16x32_bf16 v[44:47], a[212:215], v[100:103], v[44:47]
    v_mfma_f32_16x16x32_bf16 v[40:43], a[212:215], v[92:95], v[40:43]
    v_mul_f32 v52, v19, v52
    v_mfma_f32_16x16x32_bf16 v[40:43], a[208:211], v[88:91], v[40:43]
    buffer_load_dwordx4 v6, s[16:19], s39 offen lds
    v_mfma_f32_16x16x32_bf16 v[24:27], a[184:187], a[96:99], 0
    ds_read_b64_tr_b16 a[208:209], v9 offset:8192
    v_mul_f32 v48, v18, v48
    v_mfma_f32_16x16x32_bf16 v[24:27], a[188:191], a[100:103], v[24:27]
    ds_read_b64_tr_b16 a[210:211], v9 offset:10240
    v_mul_f32 v44, v17, v44
    v_mfma_f32_16x16x32_bf16 v[28:31], a[188:191], a[108:111], 0
    ds_read_b64_tr_b16 a[212:213], v9 offset:12288
    v_mul_f32 v40, v16, v40
    v_mfma_f32_16x16x32_bf16 v[28:31], a[184:187], a[104:107], v[28:31]
    s_add_u32 s39, s40, 98560
    ds_read_b64_tr_b16 a[214:215], v9 offset:14336
    v_mul_f32 v41, v16, v41
    v_mfma_f32_16x16x32_bf16 v[32:35], a[184:187], a[112:115], 0
    s_waitcnt lgkmcnt(4)
    v_mul_f32 v42, v16, v42
    v_mul_f32 v43, v16, v43
    v_mfma_f32_16x16x32_bf16 v[32:35], a[188:191], a[116:119], v[32:35]
    s_add_u32 m0, s63, 106496
    v_cvt_pk_bf16_f32 v40, v40, v41
    v_cvt_pk_bf16_f32 v41, v42, v43
    v_mfma_f32_16x16x32_bf16 v[36:39], a[188:191], a[124:127], 0
    v_accvgpr_write_b32 a32, v40
    v_accvgpr_write_b32 a33, v41
    v_mfma_f32_16x16x32_bf16 v[36:39], a[184:187], a[120:123], v[36:39]
    ds_read_b64_tr_b16 a[184:185], v9 offset:16384
    v_mul_f32 v45, v17, v45
    v_mfma_f32_16x16x32_bf16 v[36:39], a[192:195], v[120:123], v[36:39]
    ds_read_b64_tr_b16 a[186:187], v9 offset:18432
    v_mul_f32 v46, v17, v46
    v_mfma_f32_16x16x32_bf16 v[36:39], a[196:199], v[124:127], v[36:39]
    ds_read_b64_tr_b16 a[188:189], v9 offset:20480
    v_mul_f32 v47, v17, v47
    v_mfma_f32_16x16x32_bf16 v[32:35], a[196:199], a[148:151], v[32:35]
    ds_read_b64_tr_b16 a[190:191], v9 offset:22528
    v_cvt_pk_bf16_f32 v44, v44, v45
    v_mfma_f32_16x16x32_bf16 v[32:35], a[192:195], a[144:147], v[32:35]
    buffer_load_dwordx4 v6, s[16:19], s39 offen lds
    v_mfma_f32_16x16x32_bf16 v[28:31], a[192:195], a[136:139], v[28:31]
    v_cvt_pk_bf16_f32 v45, v46, v47
    v_accvgpr_write_b32 a36, v44
    v_mfma_f32_16x16x32_bf16 v[28:31], a[196:199], a[140:143], v[28:31]
    v_accvgpr_write_b32 a37, v45
    v_mfma_f32_16x16x32_bf16 v[24:27], a[196:199], a[132:135], v[24:27]
    v_mul_f32 v49, v18, v49
    v_mul_f32 v50, v18, v50
    v_mfma_f32_16x16x32_bf16 v[24:27], a[192:195], a[128:131], v[24:27]
    s_add_u32 s39, s40, 110848
    ds_read_b64_tr_b16 a[192:193], v9 offset:24576
    v_mul_f32 v51, v18, v51
    v_mfma_f32_16x16x32_bf16 v[24:27], a[200:203], v[128:131], v[24:27]
    ds_read_b64_tr_b16 a[194:195], v9 offset:26624
    v_cvt_pk_bf16_f32 v48, v48, v49
    v_mfma_f32_16x16x32_bf16 v[24:27], a[204:207], v[132:135], v[24:27]
    s_add_u32 m0, s63, 110592
    ds_read_b64_tr_b16 a[196:197], v9 offset:28672
    v_cvt_pk_bf16_f32 v49, v50, v51
    v_mfma_f32_16x16x32_bf16 v[28:31], a[204:207], v[140:143], v[28:31]
    s_waitcnt lgkmcnt(3)
    ds_read_b64_tr_b16 a[198:199], v9 offset:30720
    v_accvgpr_write_b32 a40, v48
    v_mfma_f32_16x16x32_bf16 v[28:31], a[200:203], v[136:139], v[28:31]
    v_accvgpr_write_b32 a41, v49
    v_mfma_f32_16x16x32_bf16 v[32:35], a[200:203], v[144:147], v[32:35]
    v_mul_f32 v53, v19, v53
    v_mul_f32 v54, v19, v54
    v_mfma_f32_16x16x32_bf16 v[32:35], a[204:207], v[148:151], v[32:35]
    v_mul_f32 v55, v19, v55
    v_cvt_pk_bf16_f32 v52, v52, v53
    v_mfma_f32_16x16x32_bf16 v[36:39], a[204:207], v[156:159], v[36:39]
    v_cvt_pk_bf16_f32 v53, v54, v55
    v_accvgpr_write_b32 a44, v52
    v_mfma_f32_16x16x32_bf16 v[36:39], a[200:203], v[152:155], v[36:39]
    buffer_load_dwordx4 v6, s[16:19], s39 offen lds
    v_mfma_f32_16x16x32_bf16 v[36:39], a[208:211], v[184:187], v[36:39]
    ds_read_b64_tr_b16 a[200:201], v9 offset:32768
    v_accvgpr_write_b32 a45, v53
    v_mfma_f32_16x16x32_bf16 v[36:39], a[212:215], v[188:191], v[36:39]
    ds_read_b64_tr_b16 a[202:203], v9 offset:34816
    v_mfma_f32_16x16x32_bf16 v[32:35], a[212:215], v[180:183], v[32:35]
    ds_read_b64_tr_b16 a[204:205], v9 offset:36864
    v_mfma_f32_16x16x32_bf16 v[32:35], a[208:211], v[176:179], v[32:35]
    s_add_u32 s39, s40, 123136
    ds_read_b64_tr_b16 a[206:207], v9 offset:38912
    v_mfma_f32_16x16x32_bf16 v[28:31], a[208:211], v[168:171], v[28:31]
    v_mfma_f32_16x16x32_bf16 v[28:31], a[212:215], v[172:175], v[28:31]
    s_add_u32 m0, s63, 114688
    v_mfma_f32_16x16x32_bf16 v[24:27], a[212:215], v[164:167], v[24:27]
    v_mfma_f32_16x16x32_bf16 v[24:27], a[208:211], v[160:163], v[24:27]
    ds_read_b64_tr_b16 a[208:209], v9 offset:40960
    v_mfma_f32_16x16x32_bf16 v[24:27], a[184:187], v[192:195], v[24:27]
    ds_read_b64_tr_b16 a[210:211], v9 offset:43008
    v_mfma_f32_16x16x32_bf16 v[24:27], a[188:191], v[196:199], v[24:27]
    ds_read_b64_tr_b16 a[212:213], v9 offset:45056
    v_mfma_f32_16x16x32_bf16 v[28:31], a[188:191], v[204:207], v[28:31]
    s_waitcnt lgkmcnt(3)
    ds_read_b64_tr_b16 a[214:215], v9 offset:47104
    v_mfma_f32_16x16x32_bf16 v[28:31], a[184:187], v[200:203], v[28:31]
    buffer_load_dwordx4 v6, s[16:19], s39 offen lds
    v_mfma_f32_16x16x32_bf16 v[32:35], a[184:187], v[208:211], v[32:35]
    v_add_u32 v9, 73728, v9
    v_mfma_f32_16x16x32_bf16 v[32:35], a[188:191], v[212:215], v[32:35]
    v_mfma_f32_16x16x32_bf16 v[36:39], a[188:191], v[220:223], v[36:39]
    v_mfma_f32_16x16x32_bf16 v[36:39], a[184:187], v[216:219], v[36:39]
    s_add_u32 s39, s40, 135424
    ds_read_b64_tr_b16 a[184:185], v10 offset:49152
    v_mfma_f32_16x16x32_bf16 v[36:39], a[192:195], v[248:251], v[36:39]
    ds_read_b64_tr_b16 a[186:187], v10 offset:51200
    v_mfma_f32_16x16x32_bf16 v[36:39], a[196:199], v[252:255], v[36:39]
    s_add_u32 m0, s63, 118784
    ds_read_b64_tr_b16 a[188:189], v10 offset:53248
    v_mfma_f32_16x16x32_bf16 v[32:35], a[196:199], v[244:247], v[32:35]
    s_barrier
    v_mfma_f32_16x16x32_bf16 v[32:35], a[192:195], v[240:243], v[32:35]
    s_waitcnt vmcnt(7)
    ds_read_b64_tr_b16 a[190:191], v10 offset:55296
    v_mfma_f32_16x16x32_bf16 v[28:31], a[192:195], v[232:235], v[28:31]
    buffer_store_dword v4, v15, s[24:27], s76 offen sc1
    v_mfma_f32_16x16x32_bf16 v[28:31], a[196:199], v[236:239], v[28:31]
    v_mov_b32 v4, s56
    v_mfma_f32_16x16x32_bf16 v[24:27], a[196:199], v[228:231], v[24:27]
    s_add_u32 s56, s7, 4
    v_mfma_f32_16x16x32_bf16 v[24:27], a[192:195], v[224:227], v[24:27]
    buffer_load_dwordx4 v6, s[16:19], s39 offen lds
    v_mfma_f32_16x16x32_bf16 v[24:27], a[200:203], v[56:59], v[24:27]
    ds_read_b64_tr_b16 a[192:193], v10 offset:57344
    v_mfma_f32_16x16x32_bf16 v[24:27], a[204:207], v[60:63], v[24:27]
    ds_read_b64_tr_b16 a[194:195], v10 offset:59392
    v_mfma_f32_16x16x32_bf16 v[28:31], a[204:207], v[68:71], v[28:31]
    ds_read_b64_tr_b16 a[196:197], v10 offset:61440
    v_mfma_f32_16x16x32_bf16 v[28:31], a[200:203], v[64:67], v[28:31]
    s_waitcnt lgkmcnt(3)
    ds_read_b64_tr_b16 a[198:199], v10 offset:63488
    s_add_u32 s39, s40, 147712
    v_mfma_f32_16x16x32_bf16 v[32:35], a[200:203], v[72:75], v[32:35]
    v_mfma_f32_16x16x32_bf16 v[32:35], a[204:207], v[76:79], v[32:35]
    s_add_u32 m0, s63, 122880
    v_mfma_f32_16x16x32_bf16 v[36:39], a[204:207], v[84:87], v[36:39]
    v_mfma_f32_16x16x32_bf16 v[36:39], a[200:203], v[80:83], v[36:39]
    ds_read_b64_tr_b16 a[200:201], v10 offset:0
    v_mfma_f32_16x16x32_bf16 v[36:39], a[208:211], v[112:115], v[36:39]
    ds_read_b64_tr_b16 a[202:203], v10 offset:2048
    v_mfma_f32_16x16x32_bf16 v[36:39], a[212:215], v[116:119], v[36:39]
    ds_read_b64_tr_b16 a[204:205], v10 offset:4096
    v_mfma_f32_16x16x32_bf16 v[32:35], a[212:215], v[108:111], v[32:35]
    s_add_u32 s77, s7, 1
    ds_read_b64_tr_b16 a[206:207], v10 offset:6144
    v_mfma_f32_16x16x32_bf16 v[32:35], a[208:211], v[104:107], v[32:35]
    buffer_load_dwordx4 v6, s[16:19], s39 offen lds
    v_mfma_f32_16x16x32_bf16 v[28:31], a[208:211], v[96:99], v[28:31]
    v_mfma_f32_16x16x32_bf16 v[28:31], a[212:215], v[100:103], v[28:31]
    v_mul_f32 v36, v19, v36
    v_mfma_f32_16x16x32_bf16 v[24:27], a[212:215], v[92:95], v[24:27]
    s_load_dwordx4 s[72:75], s[86:87], s5 glc
    v_mul_f32 v37, v19, v37
    v_mfma_f32_16x16x32_bf16 v[24:27], a[208:211], v[88:91], v[24:27]
    s_add_u32 s39, s40, 160000
    ds_read_b64_tr_b16 a[208:209], v10 offset:8192
    v_mul_f32 v32, v18, v32
    v_mfma_f32_16x16x32_bf16 v[40:43], a[184:187], a[96:99], 0
    s_lshl_b32 s42, s48, 8
    ds_read_b64_tr_b16 a[210:211], v10 offset:10240
    v_lshrrev_b32 v22, 2, v1
    v_mfma_f32_16x16x32_bf16 v[40:43], a[188:191], a[100:103], v[40:43]
    s_add_u32 m0, s63, 126976
    ds_read_b64_tr_b16 a[212:213], v10 offset:12288
    v_min_u32 v22, 9, v22
    v_mfma_f32_16x16x32_bf16 v[44:47], a[188:191], a[108:111], 0
    s_waitcnt lgkmcnt(3)
    ds_read_b64_tr_b16 a[214:215], v10 offset:14336
    v_mul_u32_u24 v22, 6144, v22
    v_mfma_f32_16x16x32_bf16 v[44:47], a[184:187], a[104:107], v[44:47]
    s_add_u32 s42, s42, 3932304
    v_and_b32 v23, 3, v1
    v_lshl_add_u32 v22, v23, 2, v22
    v_mfma_f32_16x16x32_bf16 v[48:51], a[184:187], a[112:115], 0
    buffer_load_dword v23, v22, s[24:27], s42 offen sc1
    v_mfma_f32_16x16x32_bf16 v[48:51], a[188:191], a[116:119], v[48:51]
    v_mul_f32 v24, v16, v24
    v_mul_f32 v25, v16, v25
    v_mfma_f32_16x16x32_bf16 v[52:55], a[188:191], a[124:127], 0
    v_mul_f32 v26, v16, v26
    v_mul_f32 v27, v16, v27
    v_mfma_f32_16x16x32_bf16 v[52:55], a[184:187], a[120:123], v[52:55]
    buffer_load_dwordx4 v6, s[16:19], s39 offen lds
    v_mfma_f32_16x16x32_bf16 v[52:55], a[192:195], v[120:123], v[52:55]
    ds_read_b64_tr_b16 a[184:185], v10 offset:16384
    v_cvt_pk_bf16_f32 v24, v24, v25
    v_mfma_f32_16x16x32_bf16 v[52:55], a[196:199], v[124:127], v[52:55]
    ds_read_b64_tr_b16 a[186:187], v10 offset:18432
    v_cvt_pk_bf16_f32 v25, v26, v27
    v_mfma_f32_16x16x32_bf16 v[48:51], a[196:199], a[148:151], v[48:51]
    ds_read_b64_tr_b16 a[188:189], v10 offset:20480
    v_accvgpr_write_b32 a34, v24
    v_mfma_f32_16x16x32_bf16 v[48:51], a[192:195], a[144:147], v[48:51]
    s_add_u32 s39, s40, 172288
    ds_read_b64_tr_b16 a[190:191], v10 offset:22528
    v_accvgpr_write_b32 a35, v25
    v_mfma_f32_16x16x32_bf16 v[44:47], a[192:195], a[136:139], v[44:47]
    buffer_store_dwordx4 a[32:35], v14, s[20:23], s55 offen offset:0 sc1
    v_mul_f32 v28, v17, v28
    v_mfma_f32_16x16x32_bf16 v[44:47], a[196:199], a[140:143], v[44:47]
    s_add_u32 m0, s63, 131072
    v_mul_f32 v29, v17, v29
    v_mul_f32 v30, v17, v30
    v_mfma_f32_16x16x32_bf16 v[40:43], a[196:199], a[132:135], v[40:43]
    v_mul_f32 v31, v17, v31
    v_cvt_pk_bf16_f32 v28, v28, v29
    v_mfma_f32_16x16x32_bf16 v[40:43], a[192:195], a[128:131], v[40:43]
    ds_read_b64_tr_b16 a[192:193], v10 offset:24576
    v_cvt_pk_bf16_f32 v29, v30, v31
    v_mfma_f32_16x16x32_bf16 v[40:43], a[200:203], v[128:131], v[40:43]
    ds_read_b64_tr_b16 a[194:195], v10 offset:26624
    v_accvgpr_write_b32 a38, v28
    v_mfma_f32_16x16x32_bf16 v[40:43], a[204:207], v[132:135], v[40:43]
    ds_read_b64_tr_b16 a[196:197], v10 offset:28672
    v_accvgpr_write_b32 a39, v29
    v_mfma_f32_16x16x32_bf16 v[44:47], a[204:207], v[140:143], v[44:47]
    s_waitcnt lgkmcnt(3)
    buffer_store_dwordx4 a[36:39], v14, s[20:23], s55 offen offset:1024 sc1
    v_mul_f32 v33, v18, v33
    v_mfma_f32_16x16x32_bf16 v[44:47], a[200:203], v[136:139], v[44:47]
    buffer_load_dwordx4 v6, s[16:19], s39 offen lds
    v_mfma_f32_16x16x32_bf16 v[48:51], a[200:203], v[144:147], v[48:51]
    ds_read_b64_tr_b16 a[198:199], v10 offset:30720
    v_mul_f32 v34, v18, v34
    v_mfma_f32_16x16x32_bf16 v[48:51], a[204:207], v[148:151], v[48:51]
    v_mul_f32 v35, v18, v35
    v_cvt_pk_bf16_f32 v32, v32, v33
    v_mfma_f32_16x16x32_bf16 v[52:55], a[204:207], v[156:159], v[52:55]
    v_cvt_pk_bf16_f32 v33, v34, v35
    v_accvgpr_write_b32 a42, v32
    v_mfma_f32_16x16x32_bf16 v[52:55], a[200:203], v[152:155], v[52:55]
    s_add_u32 s39, s40, 184576
    ds_read_b64_tr_b16 a[200:201], v10 offset:32768
    v_accvgpr_write_b32 a43, v33
    v_mfma_f32_16x16x32_bf16 v[52:55], a[208:211], v[184:187], v[52:55]
    buffer_store_dwordx4 a[40:43], v14, s[20:23], s55 offen offset:2048 sc1
    v_mul_f32 v38, v19, v38
    v_mfma_f32_16x16x32_bf16 v[52:55], a[212:215], v[188:191], v[52:55]
    s_add_u32 m0, s63, 135168
    ds_read_b64_tr_b16 a[202:203], v10 offset:34816
    v_mul_f32 v39, v19, v39
    v_mfma_f32_16x16x32_bf16 v[48:51], a[212:215], v[180:183], v[48:51]
    s_add_u32 s40, s7, 1
    ds_read_b64_tr_b16 a[204:205], v10 offset:36864
    v_cvt_pk_bf16_f32 v36, v36, v37
    v_mfma_f32_16x16x32_bf16 v[48:51], a[208:211], v[176:179], v[48:51]
    ds_read_b64_tr_b16 a[206:207], v10 offset:38912
    v_cvt_pk_bf16_f32 v37, v38, v39
    v_mfma_f32_16x16x32_bf16 v[44:47], a[208:211], v[168:171], v[44:47]
    v_accvgpr_write_b32 a46, v36
    v_accvgpr_write_b32 a47, v37
    v_mfma_f32_16x16x32_bf16 v[44:47], a[212:215], v[172:175], v[44:47]
    buffer_store_dwordx4 a[44:47], v14, s[20:23], s55 offen offset:3072 sc1
    v_mfma_f32_16x16x32_bf16 v[40:43], a[212:215], v[164:167], v[40:43]
    s_add_u32 s55, s55, 4096
    v_mfma_f32_16x16x32_bf16 v[40:43], a[208:211], v[160:163], v[40:43]
    buffer_load_dwordx4 v6, s[16:19], s39 offen lds
    v_mfma_f32_16x16x32_bf16 v[40:43], a[184:187], v[192:195], v[40:43]
    s_add_u32 s39, s7, 1
    ds_read_b64_tr_b16 a[208:209], v10 offset:40960
    v_mfma_f32_16x16x32_bf16 v[40:43], a[188:191], v[196:199], v[40:43]
    ds_read_b64_tr_b16 a[210:211], v10 offset:43008
    v_mfma_f32_16x16x32_bf16 v[44:47], a[188:191], v[204:207], v[44:47]
    ds_read_b64_tr_b16 a[212:213], v10 offset:45056
    v_mfma_f32_16x16x32_bf16 v[44:47], a[184:187], v[200:203], v[44:47]
    s_waitcnt lgkmcnt(3)
    ds_read_b64_tr_b16 a[214:215], v10 offset:47104
    v_mfma_f32_16x16x32_bf16 v[48:51], a[184:187], v[208:211], v[48:51]
    v_add_u32 v10, 73728, v10
    v_mfma_f32_16x16x32_bf16 v[48:51], a[188:191], v[212:215], v[48:51]
pg_10:
    s_cbranch_execz pg_14
    v_mov_b32 v6, s7
    v_mfma_f32_16x16x32_bf16 v[52:55], a[188:191], v[220:223], v[52:55]
    v_mfma_f32_16x16x32_bf16 v[52:55], a[184:187], v[216:219], v[52:55]
    ds_read_b64_tr_b16 a[184:185], v11 offset:49152
    v_mfma_f32_16x16x32_bf16 v[52:55], a[192:195], v[248:251], v[52:55]
    ds_read_b64_tr_b16 a[186:187], v11 offset:51200
    v_mfma_f32_16x16x32_bf16 v[52:55], a[196:199], v[252:255], v[52:55]
    ds_read_b64_tr_b16 a[188:189], v11 offset:53248
    v_mfma_f32_16x16x32_bf16 v[48:51], a[196:199], v[244:247], v[48:51]
    ds_read_b64_tr_b16 a[190:191], v11 offset:55296
    v_mfma_f32_16x16x32_bf16 v[48:51], a[192:195], v[240:243], v[48:51]
    v_mfma_f32_16x16x32_bf16 v[44:47], a[192:195], v[232:235], v[44:47]
    s_sub_u32 s78, s72, s77
    s_sub_u32 s79, s73, s77
    s_max_u32 s78, s78, s79
    v_mfma_f32_16x16x32_bf16 v[44:47], a[196:199], v[236:239], v[44:47]
    s_sub_u32 s79, s74, s77
    s_max_u32 s78, s78, s79
    s_sub_u32 s79, s75, s77
    v_mfma_f32_16x16x32_bf16 v[40:43], a[196:199], v[228:231], v[40:43]
    s_max_u32 s78, s78, s79
    v_mfma_f32_16x16x32_bf16 v[40:43], a[192:195], v[224:227], v[40:43]
    s_cmp_gt_u32 s78, 5
    s_cbranch_scc1 spin_o0
spin_o0_ret:
    v_mfma_f32_16x16x32_bf16 v[40:43], a[200:203], v[56:59], v[40:43]
    s_add_u32 s37, s59, 0
    ds_read_b64_tr_b16 a[192:193], v11 offset:57344
    v_mfma_f32_16x16x32_bf16 v[40:43], a[204:207], v[60:63], v[40:43]
    ds_read_b64_tr_b16 a[194:195], v11 offset:59392
    v_mfma_f32_16x16x32_bf16 v[44:47], a[204:207], v[68:71], v[44:47]
    ds_read_b64_tr_b16 a[196:197], v11 offset:61440
    v_mfma_f32_16x16x32_bf16 v[44:47], a[200:203], v[64:67], v[44:47]
    s_waitcnt lgkmcnt(3)
    ds_read_b64_tr_b16 a[198:199], v11 offset:63488
    v_mfma_f32_16x16x32_bf16 v[48:51], a[200:203], v[72:75], v[48:51]
    v_mfma_f32_16x16x32_bf16 v[48:51], a[204:207], v[76:79], v[48:51]
    v_mfma_f32_16x16x32_bf16 v[52:55], a[204:207], v[84:87], v[52:55]
    buffer_load_dwordx4 a[216:219], v14, s[20:23], s37 offen offset:0 sc1
    v_mfma_f32_16x16x32_bf16 v[52:55], a[200:203], v[80:83], v[52:55]
    ds_read_b64_tr_b16 a[200:201], v11 offset:0
    v_mfma_f32_16x16x32_bf16 v[52:55], a[208:211], v[112:115], v[52:55]
    ds_read_b64_tr_b16 a[202:203], v11 offset:2048
    v_mfma_f32_16x16x32_bf16 v[52:55], a[212:215], v[116:119], v[52:55]
    ds_read_b64_tr_b16 a[204:205], v11 offset:4096
    v_mfma_f32_16x16x32_bf16 v[48:51], a[212:215], v[108:111], v[48:51]
    ds_read_b64_tr_b16 a[206:207], v11 offset:6144
    v_mfma_f32_16x16x32_bf16 v[48:51], a[208:211], v[104:107], v[48:51]
    buffer_load_dwordx4 a[220:223], v14, s[20:23], s37 offen offset:1024 sc1
    v_mfma_f32_16x16x32_bf16 v[44:47], a[208:211], v[96:99], v[44:47]
    v_mfma_f32_16x16x32_bf16 v[44:47], a[212:215], v[100:103], v[44:47]
    v_mfma_f32_16x16x32_bf16 v[40:43], a[212:215], v[92:95], v[40:43]
    v_mul_f32 v52, v19, v52
    v_mfma_f32_16x16x32_bf16 v[40:43], a[208:211], v[88:91], v[40:43]
    ds_read_b64_tr_b16 a[208:209], v11 offset:8192
    v_mfma_f32_16x16x32_bf16 v[24:27], a[184:187], a[96:99], 0
    buffer_load_dwordx4 a[224:227], v14, s[20:23], s37 offen offset:2048 sc1
    v_mfma_f32_16x16x32_bf16 v[24:27], a[188:191], a[100:103], v[24:27]
    s_waitcnt vmcnt(10)
    ds_read_b64_tr_b16 a[210:211], v11 offset:10240
    v_cmp_ne_u32 vcc, s7, v23
    v_mfma_f32_16x16x32_bf16 v[28:31], a[188:191], a[108:111], 0
    s_cbranch_vccnz spin_gu
spin_gu_ret:
    v_mul_f32 v40, v16, v40
    v_mfma_f32_16x16x32_bf16 v[28:31], a[184:187], a[104:107], v[28:31]
    s_add_u32 s42, s7, 1
    ds_read_b64_tr_b16 a[212:213], v11 offset:12288
    v_mul_f32 v41, v16, v41
    v_mfma_f32_16x16x32_bf16 v[32:35], a[184:187], a[112:115], 0
    s_waitcnt lgkmcnt(3)
    ds_read_b64_tr_b16 a[214:215], v11 offset:14336
    v_mul_f32 v42, v16, v42
    v_mfma_f32_16x16x32_bf16 v[32:35], a[188:191], a[116:119], v[32:35]
    buffer_load_dwordx4 a[228:231], v14, s[20:23], s37 offen offset:3072 sc1
    v_mfma_f32_16x16x32_bf16 v[36:39], a[188:191], a[124:127], 0
    v_mul_f32 v43, v16, v43
    v_cvt_pk_bf16_f32 v40, v40, v41
    v_mfma_f32_16x16x32_bf16 v[36:39], a[184:187], a[120:123], v[36:39]
    ds_read_b64_tr_b16 a[184:185], v11 offset:16384
    v_cvt_pk_bf16_f32 v41, v42, v43
    v_mfma_f32_16x16x32_bf16 v[36:39], a[192:195], v[120:123], v[36:39]
    ds_read_b64_tr_b16 a[186:187], v11 offset:18432
    v_accvgpr_write_b32 a48, v40
    v_mfma_f32_16x16x32_bf16 v[36:39], a[196:199], v[124:127], v[36:39]
    ds_read_b64_tr_b16 a[188:189], v11 offset:20480
    v_accvgpr_write_b32 a49, v41
    v_mfma_f32_16x16x32_bf16 v[32:35], a[196:199], a[148:151], v[32:35]
    ds_read_b64_tr_b16 a[190:191], v11 offset:22528
    v_mul_f32 v44, v17, v44
    v_mfma_f32_16x16x32_bf16 v[32:35], a[192:195], a[144:147], v[32:35]
    v_mul_f32 v45, v17, v45
    v_mul_f32 v46, v17, v46
    v_mfma_f32_16x16x32_bf16 v[28:31], a[192:195], a[136:139], v[28:31]
    v_mul_f32 v47, v17, v47
    v_cvt_pk_bf16_f32 v44, v44, v45
    v_mfma_f32_16x16x32_bf16 v[28:31], a[196:199], a[140:143], v[28:31]
    v_cvt_pk_bf16_f32 v45, v46, v47
    v_accvgpr_write_b32 a52, v44
    v_mfma_f32_16x16x32_bf16 v[24:27], a[196:199], a[132:135], v[24:27]
    s_add_u32 s77, s7, 2
    v_accvgpr_write_b32 a53, v45
    v_mul_f32 v48, v18, v48
    v_mfma_f32_16x16x32_bf16 v[24:27], a[192:195], a[128:131], v[24:27]
    ds_read_b64_tr_b16 a[192:193], v11 offset:24576
    v_mul_f32 v49, v18, v49
    v_mfma_f32_16x16x32_bf16 v[24:27], a[200:203], v[128:131], v[24:27]
    ds_read_b64_tr_b16 a[194:195], v11 offset:26624
    v_mul_f32 v50, v18, v50
    v_mfma_f32_16x16x32_bf16 v[24:27], a[204:207], v[132:135], v[24:27]
    ds_read_b64_tr_b16 a[196:197], v11 offset:28672
    v_mul_f32 v51, v18, v51
    v_mfma_f32_16x16x32_bf16 v[28:31], a[204:207], v[140:143], v[28:31]
    s_waitcnt lgkmcnt(3)
    ds_read_b64_tr_b16 a[198:199], v11 offset:30720
    v_cvt_pk_bf16_f32 v48, v48, v49
    v_mfma_f32_16x16x32_bf16 v[28:31], a[200:203], v[136:139], v[28:31]
    s_load_dwordx4 s[72:75], s[86:87], s5 glc
    v_cvt_pk_bf16_f32 v49, v50, v51
    v_accvgpr_write_b32 a56, v48
    v_mfma_f32_16x16x32_bf16 v[32:35], a[200:203], v[144:147], v[32:35]
    v_accvgpr_write_b32 a57, v49
    v_mul_f32 v53, v19, v53
    v_mfma_f32_16x16x32_bf16 v[32:35], a[204:207], v[148:151], v[32:35]
    v_mul_f32 v54, v19, v54
    v_mul_f32 v55, v19, v55
    v_mfma_f32_16x16x32_bf16 v[36:39], a[204:207], v[156:159], v[36:39]
    v_cvt_pk_bf16_f32 v52, v52, v53
    v_cvt_pk_bf16_f32 v53, v54, v55
    v_mfma_f32_16x16x32_bf16 v[36:39], a[200:203], v[152:155], v[36:39]
    ds_read_b64_tr_b16 a[200:201], v11 offset:32768
    v_accvgpr_write_b32 a60, v52
    v_mfma_f32_16x16x32_bf16 v[36:39], a[208:211], v[184:187], v[36:39]
    ds_read_b64_tr_b16 a[202:203], v11 offset:34816
    v_accvgpr_write_b32 a61, v53
    v_mfma_f32_16x16x32_bf16 v[36:39], a[212:215], v[188:191], v[36:39]
    ds_read_b64_tr_b16 a[204:205], v11 offset:36864
    v_mfma_f32_16x16x32_bf16 v[32:35], a[212:215], v[180:183], v[32:35]
    ds_read_b64_tr_b16 a[206:207], v11 offset:38912
    v_mfma_f32_16x16x32_bf16 v[32:35], a[208:211], v[176:179], v[32:35]
    v_cmp_gt_u32 vcc, 16, v1
    v_mfma_f32_16x16x32_bf16 v[28:31], a[208:211], v[168:171], v[28:31]
    s_add_u32 s37, s60, 0
    v_mfma_f32_16x16x32_bf16 v[28:31], a[212:215], v[172:175], v[28:31]
    v_mfma_f32_16x16x32_bf16 v[24:27], a[212:215], v[164:167], v[24:27]
    v_mfma_f32_16x16x32_bf16 v[24:27], a[208:211], v[160:163], v[24:27]
    ds_read_b64_tr_b16 a[208:209], v11 offset:40960
    v_mfma_f32_16x16x32_bf16 v[24:27], a[184:187], v[192:195], v[24:27]
    ds_read_b64_tr_b16 a[210:211], v11 offset:43008
    v_mfma_f32_16x16x32_bf16 v[24:27], a[188:191], v[196:199], v[24:27]
    ds_read_b64_tr_b16 a[212:213], v11 offset:45056
    v_mfma_f32_16x16x32_bf16 v[28:31], a[188:191], v[204:207], v[28:31]
    s_waitcnt lgkmcnt(3)
    ds_read_b64_tr_b16 a[214:215], v11 offset:47104
    v_mfma_f32_16x16x32_bf16 v[28:31], a[184:187], v[200:203], v[28:31]
    buffer_load_dwordx4 a[232:235], v14, s[20:23], s37 offen offset:0 sc1
    v_mfma_f32_16x16x32_bf16 v[32:35], a[184:187], v[208:211], v[32:35]
    s_add_u32 s38, s44, 81920
    v_add_u32 v11, 73728, v11
    s_add_u32 s36, s44, 122880
    v_mfma_f32_16x16x32_bf16 v[32:35], a[188:191], v[212:215], v[32:35]
    s_cmp_lt_u32 s3, 2
    s_cselect_b32 s38, s38, s36
    s_add_u32 m0, s63, 16384
    v_mfma_f32_16x16x32_bf16 v[36:39], a[188:191], v[220:223], v[36:39]
    v_mfma_f32_16x16x32_bf16 v[36:39], a[184:187], v[216:219], v[36:39]
    buffer_load_dwordx4 a[236:239], v14, s[20:23], s37 offen offset:1024 sc1
    v_mfma_f32_16x16x32_bf16 v[36:39], a[192:195], v[248:251], v[36:39]
    v_mfma_f32_16x16x32_bf16 v[36:39], a[196:199], v[252:255], v[36:39]
    s_waitcnt vmcnt(6) lgkmcnt(0)
    v_mfma_f32_16x16x32_bf16 v[32:35], a[196:199], v[244:247], v[32:35]
    s_barrier
    v_mfma_f32_16x16x32_bf16 v[32:35], a[192:195], v[240:243], v[32:35]
    buffer_load_dwordx4 v7, s[8:11], s38 offen lds
    v_mfma_f32_16x16x32_bf16 v[28:31], a[192:195], v[232:235], v[28:31]
    buffer_load_dwordx4 a[240:243], v14, s[20:23], s37 offen offset:2048 sc1
    v_mfma_f32_16x16x32_bf16 v[28:31], a[196:199], v[236:239], v[28:31]
    buffer_store_dword v4, v15, s[24:27], s76 offen sc1
    v_mfma_f32_16x16x32_bf16 v[24:27], a[196:199], v[228:231], v[24:27]
    ds_read_b64_tr_b16 a[184:185], v8 offset:0
    v_mfma_f32_16x16x32_bf16 v[24:27], a[192:195], v[224:227], v[24:27]
    s_add_u32 s38, s44, 81920
    ds_read_b64_tr_b16 a[186:187], v8 offset:2048
    v_mfma_f32_16x16x32_bf16 v[24:27], a[200:203], v[56:59], v[24:27]
    ds_read_b64_tr_b16 a[188:189], v8 offset:4096
    v_mfma_f32_16x16x32_bf16 v[24:27], a[204:207], v[60:63], v[24:27]
    buffer_load_dwordx4 a[244:247], v14, s[20:23], s37 offen offset:3072 sc1
    v_mfma_f32_16x16x32_bf16 v[28:31], a[204:207], v[68:71], v[28:31]
    s_add_u32 s37, s61, 0
    ds_read_b64_tr_b16 a[190:191], v8 offset:6144
    s_add_u32 m0, s63, 0
    v_mfma_f32_16x16x32_bf16 v[28:31], a[200:203], v[64:67], v[28:31]
    ds_read_b64_tr_b16 a[192:193], v8 offset:8192
    v_mfma_f32_16x16x32_bf16 v[32:35], a[200:203], v[72:75], v[32:35]
    ds_read_b64_tr_b16 a[194:195], v8 offset:10240
    v_mfma_f32_16x16x32_bf16 v[32:35], a[204:207], v[76:79], v[32:35]
    ds_read_b64_tr_b16 a[196:197], v8 offset:12288
    v_mfma_f32_16x16x32_bf16 v[36:39], a[204:207], v[84:87], v[36:39]
    buffer_load_dwordx4 a[152:155], v14, s[20:23], s37 offen offset:0 sc1
    v_mfma_f32_16x16x32_bf16 v[36:39], a[200:203], v[80:83], v[36:39]
    buffer_load_dwordx4 v2, s[8:11], s38 offen lds
    v_mfma_f32_16x16x32_bf16 v[36:39], a[208:211], v[112:115], v[36:39]
    ds_read_b64_tr_b16 a[198:199], v8 offset:14336
    v_mfma_f32_16x16x32_bf16 v[36:39], a[212:215], v[116:119], v[36:39]
    ds_read_b64_tr_b16 a[200:201], v8 offset:16384
    v_mfma_f32_16x16x32_bf16 v[32:35], a[212:215], v[108:111], v[32:35]
    ds_read_b64_tr_b16 a[202:203], v8 offset:18432
    v_mfma_f32_16x16x32_bf16 v[32:35], a[208:211], v[104:107], v[32:35]
    buffer_load_dwordx4 a[156:159], v14, s[20:23], s37 offen offset:1024 sc1
    v_mfma_f32_16x16x32_bf16 v[28:31], a[208:211], v[96:99], v[28:31]
    s_add_u32 s38, s44, 81920
    ds_read_b64_tr_b16 a[204:205], v8 offset:20480
    v_mfma_f32_16x16x32_bf16 v[28:31], a[212:215], v[100:103], v[28:31]
    s_waitcnt lgkmcnt(4)
    ds_read_b64_tr_b16 a[206:207], v8 offset:22528
    s_add_u32 m0, s63, 4096
    v_mfma_f32_16x16x32_bf16 v[24:27], a[212:215], v[92:95], v[24:27]
    v_mov_b32 v4, s56
    v_mul_f32 v32, v18, v32
    v_mfma_f32_16x16x32_bf16 v[24:27], a[208:211], v[88:91], v[24:27]
    ds_read_b64_tr_b16 a[208:209], v8 offset:24576
    v_mul_f32 v28, v17, v28
    v_mfma_f32_16x16x32_bf16 v[40:43], a[184:187], a[96:99], 0
    buffer_load_dwordx4 a[160:163], v14, s[20:23], s37 offen offset:2048 sc1
    v_mfma_f32_16x16x32_bf16 v[40:43], a[188:191], a[100:103], v[40:43]
    s_sub_u32 s78, s72, s77
    ds_read_b64_tr_b16 a[210:211], v8 offset:26624
    v_mul_f32 v29, v17, v29
    v_mfma_f32_16x16x32_bf16 v[44:47], a[188:191], a[108:111], 0
    s_sub_u32 s79, s73, s77
    ds_read_b64_tr_b16 a[212:213], v8 offset:28672
    v_mul_f32 v24, v16, v24
    v_mfma_f32_16x16x32_bf16 v[44:47], a[184:187], a[104:107], v[44:47]
    buffer_load_dwordx4 v3, s[8:11], s38 offen lds
    v_mfma_f32_16x16x32_bf16 v[48:51], a[184:187], a[112:115], 0
    s_max_u32 s78, s78, s79
    ds_read_b64_tr_b16 a[214:215], v8 offset:30720
    v_mul_f32 v25, v16, v25
    v_mfma_f32_16x16x32_bf16 v[48:51], a[188:191], a[116:119], v[48:51]
    buffer_load_dwordx4 a[164:167], v14, s[20:23], s37 offen offset:3072 sc1
    v_mfma_f32_16x16x32_bf16 v[52:55], a[188:191], a[124:127], 0
    s_waitcnt lgkmcnt(3)
    v_mul_f32 v26, v16, v26
    v_mul_f32 v27, v16, v27
    v_mfma_f32_16x16x32_bf16 v[52:55], a[184:187], a[120:123], v[52:55]
    s_sub_u32 s79, s74, s77
    ds_read_b64_tr_b16 a[184:185], v8 offset:32768
    v_cvt_pk_bf16_f32 v24, v24, v25
    v_mfma_f32_16x16x32_bf16 v[52:55], a[192:195], v[120:123], v[52:55]
    s_max_u32 s78, s78, s79
    ds_read_b64_tr_b16 a[186:187], v8 offset:34816
    v_cvt_pk_bf16_f32 v25, v26, v27
    v_mfma_f32_16x16x32_bf16 v[52:55], a[196:199], v[124:127], v[52:55]
    s_sub_u32 s79, s75, s77
    ds_read_b64_tr_b16 a[188:189], v8 offset:36864
    v_accvgpr_write_b32 a50, v24
    v_mfma_f32_16x16x32_bf16 v[48:51], a[196:199], a[148:151], v[48:51]
    s_max_u32 s78, s78, s79
    ds_read_b64_tr_b16 a[190:191], v8 offset:38912
    v_accvgpr_write_b32 a51, v25
    v_mfma_f32_16x16x32_bf16 v[48:51], a[192:195], a[144:147], v[48:51]
    buffer_store_dwordx4 a[48:51], v14, s[20:23], s55 offen offset:0 sc1
    v_mul_f32 v30, v17, v30
    v_mfma_f32_16x16x32_bf16 v[44:47], a[192:195], a[136:139], v[44:47]
    s_cmp_gt_u32 s78, 4
    s_cbranch_scc1 spin_o1
spin_o1_ret:
    v_mul_f32 v31, v17, v31
    v_mfma_f32_16x16x32_bf16 v[44:47], a[196:199], a[140:143], v[44:47]
    s_add_u32 s37, s59, 4096
    v_cvt_pk_bf16_f32 v28, v28, v29
    v_cvt_pk_bf16_f32 v29, v30, v31
    v_mfma_f32_16x16x32_bf16 v[40:43], a[196:199], a[132:135], v[40:43]
    buffer_load_dwordx4 a[168:171], v14, s[20:23], s37 offen offset:0 sc1
    v_mfma_f32_16x16x32_bf16 v[40:43], a[192:195], a[128:131], v[40:43]
    buffer_load_dwordx4 a[172:175], v14, s[20:23], s37 offen offset:1024 sc1
    v_mfma_f32_16x16x32_bf16 v[40:43], a[200:203], v[128:131], v[40:43]
    s_add_u32 s38, s44, 122880
    ds_read_b64_tr_b16 a[192:193], v8 offset:40960
    v_accvgpr_write_b32 a54, v28
    v_mfma_f32_16x16x32_bf16 v[40:43], a[204:207], v[132:135], v[40:43]
    s_add_u32 m0, s63, 8192
    ds_read_b64_tr_b16 a[194:195], v8 offset:43008
    v_accvgpr_write_b32 a55, v29
    v_mfma_f32_16x16x32_bf16 v[44:47], a[204:207], v[140:143], v[44:47]
    buffer_store_dwordx4 a[52:55], v14, s[20:23], s55 offen offset:1024 sc1
    v_mul_f32 v33, v18, v33
    v_mfma_f32_16x16x32_bf16 v[44:47], a[200:203], v[136:139], v[44:47]
    buffer_load_dwordx4 v2, s[8:11], s38 offen lds
    v_mfma_f32_16x16x32_bf16 v[48:51], a[200:203], v[144:147], v[48:51]
    buffer_load_dwordx4 a[176:179], v14, s[20:23], s37 offen offset:2048 sc1
    v_mfma_f32_16x16x32_bf16 v[48:51], a[204:207], v[148:151], v[48:51]
    s_waitcnt lgkmcnt(2)
    ds_read_b64_tr_b16 a[196:197], v8 offset:45056
    v_mul_f32 v34, v18, v34
    v_mfma_f32_16x16x32_bf16 v[52:55], a[204:207], v[156:159], v[52:55]
    s_add_u32 s38, s44, 122880
    ds_read_b64_tr_b16 a[198:199], v8 offset:47104
    v_mul_f32 v35, v18, v35
    v_mfma_f32_16x16x32_bf16 v[52:55], a[200:203], v[152:155], v[52:55]
    s_add_u32 m0, s63, 12288
    ds_read_b64_tr_b16 a[200:201], v8 offset:49152
    v_cvt_pk_bf16_f32 v32, v32, v33
    v_mfma_f32_16x16x32_bf16 v[52:55], a[208:211], v[184:187], v[52:55]
    ds_read_b64_tr_b16 a[202:203], v8 offset:51200
    v_cvt_pk_bf16_f32 v33, v34, v35
    v_mfma_f32_16x16x32_bf16 v[52:55], a[212:215], v[188:191], v[52:55]
    buffer_load_dwordx4 a[180:183], v14, s[20:23], s37 offen offset:3072 sc1
    v_mfma_f32_16x16x32_bf16 v[48:51], a[212:215], v[180:183], v[48:51]
    ds_read_b64_tr_b16 a[204:205], v8 offset:53248
    v_accvgpr_write_b32 a58, v32
    v_mfma_f32_16x16x32_bf16 v[48:51], a[208:211], v[176:179], v[48:51]
    buffer_load_dwordx4 v3, s[8:11], s38 offen lds
    v_mfma_f32_16x16x32_bf16 v[44:47], a[208:211], v[168:171], v[44:47]
    ds_read_b64_tr_b16 a[206:207], v8 offset:55296
    v_accvgpr_write_b32 a59, v33
    v_mfma_f32_16x16x32_bf16 v[44:47], a[212:215], v[172:175], v[44:47]
    buffer_store_dwordx4 a[56:59], v14, s[20:23], s55 offen offset:2048 sc1
    v_mul_f32 v36, v19, v36
    v_mfma_f32_16x16x32_bf16 v[40:43], a[212:215], v[164:167], v[40:43]
    v_mul_f32 v37, v19, v37
    v_mul_f32 v38, v19, v38
    v_mfma_f32_16x16x32_bf16 v[40:43], a[208:211], v[160:163], v[40:43]
    s_add_u32 s38, s44, 163840
    ds_read_b64_tr_b16 a[208:209], v8 offset:57344
    v_mul_f32 v39, v19, v39
    v_mfma_f32_16x16x32_bf16 v[40:43], a[184:187], v[192:195], v[40:43]
    s_add_u32 s36, s45, 0
    ds_read_b64_tr_b16 a[210:211], v8 offset:59392
    v_cvt_pk_bf16_f32 v36, v36, v37
    v_mfma_f32_16x16x32_bf16 v[40:43], a[188:191], v[196:199], v[40:43]
    s_cmp_lt_u32 s3, 2
    s_cselect_b32 s38, s38, s36
    v_cvt_pk_bf16_f32 v37, v38, v39
    v_mfma_f32_16x16x32_bf16 v[44:47], a[188:191], v[204:207], v[44:47]
    s_add_u32 m0, s63, 36864
    ds_read_b64_tr_b16 a[212:213], v8 offset:61440
    v_accvgpr_write_b32 a62, v36
    v_mfma_f32_16x16x32_bf16 v[44:47], a[184:187], v[200:203], v[44:47]
    s_waitcnt lgkmcnt(3)
    ds_read_b64_tr_b16 a[214:215], v8 offset:63488
    v_accvgpr_write_b32 a63, v37
    v_mfma_f32_16x16x32_bf16 v[48:51], a[184:187], v[208:211], v[48:51]
    buffer_store_dwordx4 a[60:63], v14, s[20:23], s55 offen offset:3072 sc1
    v_add_u32 v8, 65536, v8
    v_mfma_f32_16x16x32_bf16 v[48:51], a[188:191], v[212:215], v[48:51]
    s_add_u32 s55, s55, 4096
    v_mfma_f32_16x16x32_bf16 v[52:55], a[188:191], v[220:223], v[52:55]
    v_mfma_f32_16x16x32_bf16 v[52:55], a[184:187], v[216:219], v[52:55]
    buffer_load_dwordx4 v7, s[8:11], s38 offen lds
    v_mfma_f32_16x16x32_bf16 v[52:55], a[192:195], v[248:251], v[52:55]
    ds_read_b64_tr_b16 a[184:185], v9 offset:0
    v_mfma_f32_16x16x32_bf16 v[52:55], a[196:199], v[252:255], v[52:55]
    ds_read_b64_tr_b16 a[186:187], v9 offset:2048
    v_mfma_f32_16x16x32_bf16 v[48:51], a[196:199], v[244:247], v[48:51]
    ds_read_b64_tr_b16 a[188:189], v9 offset:4096
    v_mfma_f32_16x16x32_bf16 v[48:51], a[192:195], v[240:243], v[48:51]
    s_add_u32 s38, s44, 163840
    ds_read_b64_tr_b16 a[190:191], v9 offset:6144
    v_mfma_f32_16x16x32_bf16 v[44:47], a[192:195], v[232:235], v[44:47]
    v_mfma_f32_16x16x32_bf16 v[44:47], a[196:199], v[236:239], v[44:47]
    s_add_u32 m0, s63, 20480
    v_mfma_f32_16x16x32_bf16 v[40:43], a[196:199], v[228:231], v[40:43]
    v_mfma_f32_16x16x32_bf16 v[40:43], a[192:195], v[224:227], v[40:43]
    ds_read_b64_tr_b16 a[192:193], v9 offset:8192
    v_mfma_f32_16x16x32_bf16 v[40:43], a[200:203], v[56:59], v[40:43]
    ds_read_b64_tr_b16 a[194:195], v9 offset:10240
    v_mfma_f32_16x16x32_bf16 v[40:43], a[204:207], v[60:63], v[40:43]
    ds_read_b64_tr_b16 a[196:197], v9 offset:12288
    v_mfma_f32_16x16x32_bf16 v[44:47], a[204:207], v[68:71], v[44:47]
    s_waitcnt lgkmcnt(3)
    ds_read_b64_tr_b16 a[198:199], v9 offset:14336
    v_mfma_f32_16x16x32_bf16 v[44:47], a[200:203], v[64:67], v[44:47]
    buffer_load_dwordx4 v2, s[8:11], s38 offen lds
    v_mfma_f32_16x16x32_bf16 v[48:51], a[200:203], v[72:75], v[48:51]
    v_mfma_f32_16x16x32_bf16 v[48:51], a[204:207], v[76:79], v[48:51]
    v_mfma_f32_16x16x32_bf16 v[52:55], a[204:207], v[84:87], v[52:55]
    v_mfma_f32_16x16x32_bf16 v[52:55], a[200:203], v[80:83], v[52:55]
    s_add_u32 s38, s44, 163840
    ds_read_b64_tr_b16 a[200:201], v9 offset:16384
    v_mfma_f32_16x16x32_bf16 v[52:55], a[208:211], v[112:115], v[52:55]
    ds_read_b64_tr_b16 a[202:203], v9 offset:18432
    v_mfma_f32_16x16x32_bf16 v[52:55], a[212:215], v[116:119], v[52:55]
    s_add_u32 m0, s63, 24576
    ds_read_b64_tr_b16 a[204:205], v9 offset:20480
    v_mfma_f32_16x16x32_bf16 v[48:51], a[212:215], v[108:111], v[48:51]
    ds_read_b64_tr_b16 a[206:207], v9 offset:22528
    v_mfma_f32_16x16x32_bf16 v[48:51], a[208:211], v[104:107], v[48:51]
    v_mfma_f32_16x16x32_bf16 v[44:47], a[208:211], v[96:99], v[44:47]
    v_mfma_f32_16x16x32_bf16 v[44:47], a[212:215], v[100:103], v[44:47]
    v_mfma_f32_16x16x32_bf16 v[40:43], a[212:215], v[92:95], v[40:43]
    v_mul_f32 v52, v19, v52
    v_mfma_f32_16x16x32_bf16 v[40:43], a[208:211], v[88:91], v[40:43]
    buffer_load_dwordx4 v3, s[8:11], s38 offen lds
    v_mfma_f32_16x16x32_bf16 v[24:27], a[184:187], a[96:99], 0
    ds_read_b64_tr_b16 a[208:209], v9 offset:24576
    v_mul_f32 v48, v18, v48
    v_mfma_f32_16x16x32_bf16 v[24:27], a[188:191], a[100:103], v[24:27]
    ds_read_b64_tr_b16 a[210:211], v9 offset:26624
    v_mul_f32 v44, v17, v44
    v_mfma_f32_16x16x32_bf16 v[28:31], a[188:191], a[108:111], 0
    ds_read_b64_tr_b16 a[212:213], v9 offset:28672
    v_mul_f32 v40, v16, v40
    v_mfma_f32_16x16x32_bf16 v[28:31], a[184:187], a[104:107], v[28:31]
    s_waitcnt lgkmcnt(3)
    ds_read_b64_tr_b16 a[214:215], v9 offset:30720
    v_mul_f32 v41, v16, v41
    v_mfma_f32_16x16x32_bf16 v[32:35], a[184:187], a[112:115], 0
    s_add_u32 s38, s45, 0
    v_mul_f32 v42, v16, v42
    v_mul_f32 v43, v16, v43
    v_mfma_f32_16x16x32_bf16 v[32:35], a[188:191], a[116:119], v[32:35]
    s_add_u32 m0, s63, 28672
    v_cvt_pk_bf16_f32 v40, v40, v41
    v_cvt_pk_bf16_f32 v41, v42, v43
    v_mfma_f32_16x16x32_bf16 v[36:39], a[188:191], a[124:127], 0
    v_accvgpr_write_b32 a64, v40
    v_accvgpr_write_b32 a65, v41
    v_mfma_f32_16x16x32_bf16 v[36:39], a[184:187], a[120:123], v[36:39]
    ds_read_b64_tr_b16 a[184:185], v9 offset:32768
    v_mul_f32 v45, v17, v45
    v_mfma_f32_16x16x32_bf16 v[36:39], a[192:195], v[120:123], v[36:39]
    ds_read_b64_tr_b16 a[186:187], v9 offset:34816
    v_mul_f32 v46, v17, v46
    v_mfma_f32_16x16x32_bf16 v[36:39], a[196:199], v[124:127], v[36:39]
    ds_read_b64_tr_b16 a[188:189], v9 offset:36864
    v_mul_f32 v47, v17, v47
    v_mfma_f32_16x16x32_bf16 v[32:35], a[196:199], a[148:151], v[32:35]
    s_mov_b32 s12, s64
    ds_read_b64_tr_b16 a[190:191], v9 offset:38912
    v_cvt_pk_bf16_f32 v44, v44, v45
    v_mfma_f32_16x16x32_bf16 v[32:35], a[192:195], a[144:147], v[32:35]
    buffer_load_dwordx4 v2, s[8:11], s38 offen lds
    v_mfma_f32_16x16x32_bf16 v[28:31], a[192:195], a[136:139], v[28:31]
    s_and_b32 s13, s65, 0xffff
    v_cvt_pk_bf16_f32 v45, v46, v47
    v_accvgpr_write_b32 a68, v44
    v_mfma_f32_16x16x32_bf16 v[28:31], a[196:199], a[140:143], v[28:31]
    s_mov_b32 s14, 2621440
    v_accvgpr_write_b32 a69, v45
    s_mov_b32 s15, 0x00020000
    v_mfma_f32_16x16x32_bf16 v[24:27], a[196:199], a[132:135], v[24:27]
    s_lshl_b32 s56, s54, 1
    v_mul_f32 v49, v18, v49
    v_mul_f32 v50, v18, v50
    v_mfma_f32_16x16x32_bf16 v[24:27], a[192:195], a[128:131], v[24:27]
    s_add_u32 s38, s45, 0
    ds_read_b64_tr_b16 a[192:193], v9 offset:40960
    v_mul_f32 v51, v18, v51
    v_mfma_f32_16x16x32_bf16 v[24:27], a[200:203], v[128:131], v[24:27]
    s_and_b32 s57, s53, 1
    ds_read_b64_tr_b16 a[194:195], v9 offset:43008
    v_cvt_pk_bf16_f32 v48, v48, v49
    v_mfma_f32_16x16x32_bf16 v[24:27], a[204:207], v[132:135], v[24:27]
    s_add_u32 m0, s63, 32768
    ds_read_b64_tr_b16 a[196:197], v9 offset:45056
    v_cvt_pk_bf16_f32 v49, v50, v51
    v_mfma_f32_16x16x32_bf16 v[28:31], a[204:207], v[140:143], v[28:31]
    s_waitcnt lgkmcnt(3)
    ds_read_b64_tr_b16 a[198:199], v9 offset:47104
    v_accvgpr_write_b32 a72, v48
    v_mfma_f32_16x16x32_bf16 v[28:31], a[200:203], v[136:139], v[28:31]
    s_add_u32 s56, s56, s57
    v_accvgpr_write_b32 a73, v49
    s_lshl_b32 s6, s56, 5
    v_mfma_f32_16x16x32_bf16 v[32:35], a[200:203], v[144:147], v[32:35]
    s_mul_i32 s56, s51, 320
    v_mul_f32 v53, v19, v53
    v_mul_f32 v54, v19, v54
    v_mfma_f32_16x16x32_bf16 v[32:35], a[204:207], v[148:151], v[32:35]
    s_and_b32 s57, s51, 1
    v_mul_f32 v55, v19, v55
    v_cvt_pk_bf16_f32 v52, v52, v53
    v_mfma_f32_16x16x32_bf16 v[36:39], a[204:207], v[156:159], v[36:39]
    s_add_u32 s64, s57, s50
    v_cvt_pk_bf16_f32 v53, v54, v55
    v_accvgpr_write_b32 a76, v52
    v_mfma_f32_16x16x32_bf16 v[36:39], a[200:203], v[152:155], v[36:39]
    buffer_load_dwordx4 v3, s[8:11], s38 offen lds
    v_mfma_f32_16x16x32_bf16 v[36:39], a[208:211], v[184:187], v[36:39]
    s_lshl_b32 s64, s64, 6
    ds_read_b64_tr_b16 a[200:201], v9 offset:49152
    v_accvgpr_write_b32 a77, v53
    v_mfma_f32_16x16x32_bf16 v[36:39], a[212:215], v[188:191], v[36:39]
    s_add_u32 s64, s64, s56
    ds_read_b64_tr_b16 a[202:203], v9 offset:51200
    s_add_u32 s65, s64, 20480
    v_mfma_f32_16x16x32_bf16 v[32:35], a[212:215], v[180:183], v[32:35]
    s_xor_b32 s57, s57, 1
    ds_read_b64_tr_b16 a[204:205], v9 offset:53248
    s_lshl_b32 s57, s57, 8
    v_mfma_f32_16x16x32_bf16 v[32:35], a[208:211], v[176:179], v[32:35]
    s_add_u32 s38, s46, 0
    ds_read_b64_tr_b16 a[206:207], v9 offset:55296
    s_add_u32 s36, s47, 0
    v_mfma_f32_16x16x32_bf16 v[28:31], a[208:211], v[168:171], v[28:31]
    s_cmp_lt_u32 s3, 2
    s_cselect_b32 s38, s38, s36
    s_add_u32 s68, s56, s57
    v_mfma_f32_16x16x32_bf16 v[28:31], a[212:215], v[172:175], v[28:31]
    s_add_u32 m0, s63, 57344
    s_add_u32 s69, s68, 20480
    v_mfma_f32_16x16x32_bf16 v[24:27], a[212:215], v[164:167], v[24:27]
    s_cmp_eq_u32 s50, s3
    s_cselect_b32 s66, -1, 0
    s_cselect_b32 s56, s68, s64
    v_mfma_f32_16x16x32_bf16 v[24:27], a[208:211], v[160:163], v[24:27]
    s_add_u32 s56, s7, 5
    ds_read_b64_tr_b16 a[208:209], v9 offset:57344
    v_mfma_f32_16x16x32_bf16 v[24:27], a[184:187], v[192:195], v[24:27]
    s_andn2_b32 s80, 0xff00, s66
    ds_read_b64_tr_b16 a[210:211], v9 offset:59392
    v_mfma_f32_16x16x32_bf16 v[24:27], a[188:191], v[196:199], v[24:27]
    s_or_b32 s80, s80, 0x101
    ds_read_b64_tr_b16 a[212:213], v9 offset:61440
    v_mfma_f32_16x16x32_bf16 v[28:31], a[188:191], v[204:207], v[28:31]
    s_waitcnt lgkmcnt(3)
    ds_read_b64_tr_b16 a[214:215], v9 offset:63488
    v_mfma_f32_16x16x32_bf16 v[28:31], a[184:187], v[200:203], v[28:31]
    buffer_load_dwordx4 v7, s[8:11], s38 offen lds
    v_mfma_f32_16x16x32_bf16 v[32:35], a[184:187], v[208:211], v[32:35]
    v_add_u32 v9, 65536, v9
    v_mfma_f32_16x16x32_bf16 v[32:35], a[188:191], v[212:215], v[32:35]
    v_mfma_f32_16x16x32_bf16 v[36:39], a[188:191], v[220:223], v[36:39]
    v_mfma_f32_16x16x32_bf16 v[36:39], a[184:187], v[216:219], v[36:39]
    s_add_u32 s38, s46, 0
    ds_read_b64_tr_b16 a[184:185], v10 offset:0
    v_mfma_f32_16x16x32_bf16 v[36:39], a[192:195], v[248:251], v[36:39]
    ds_read_b64_tr_b16 a[186:187], v10 offset:2048
    v_mfma_f32_16x16x32_bf16 v[36:39], a[196:199], v[252:255], v[36:39]
    s_add_u32 m0, s63, 40960
    ds_read_b64_tr_b16 a[188:189], v10 offset:4096
    v_mfma_f32_16x16x32_bf16 v[32:35], a[196:199], v[244:247], v[32:35]
    s_barrier
    v_mfma_f32_16x16x32_bf16 v[32:35], a[192:195], v[240:243], v[32:35]
    ds_read_b64_tr_b16 a[190:191], v10 offset:6144
    v_mfma_f32_16x16x32_bf16 v[28:31], a[192:195], v[232:235], v[28:31]
    v_mfma_f32_16x16x32_bf16 v[28:31], a[196:199], v[236:239], v[28:31]
    v_mfma_f32_16x16x32_bf16 v[24:27], a[196:199], v[228:231], v[24:27]
    v_mfma_f32_16x16x32_bf16 v[24:27], a[192:195], v[224:227], v[24:27]
    buffer_load_dwordx4 v2, s[8:11], s38 offen lds
    v_mfma_f32_16x16x32_bf16 v[24:27], a[200:203], v[56:59], v[24:27]
    ds_read_b64_tr_b16 a[192:193], v10 offset:8192
    v_mfma_f32_16x16x32_bf16 v[24:27], a[204:207], v[60:63], v[24:27]
    ds_read_b64_tr_b16 a[194:195], v10 offset:10240
    v_mfma_f32_16x16x32_bf16 v[28:31], a[204:207], v[68:71], v[28:31]
    ds_read_b64_tr_b16 a[196:197], v10 offset:12288
    v_mfma_f32_16x16x32_bf16 v[28:31], a[200:203], v[64:67], v[28:31]
    s_waitcnt lgkmcnt(3)
    ds_read_b64_tr_b16 a[198:199], v10 offset:14336
    s_add_u32 s38, s46, 0
    v_mfma_f32_16x16x32_bf16 v[32:35], a[200:203], v[72:75], v[32:35]
    s_waitcnt vmcnt(7)
    v_mfma_f32_16x16x32_bf16 v[32:35], a[204:207], v[76:79], v[32:35]
    buffer_store_dword v4, v15, s[24:27], s76 offen sc1
    v_mfma_f32_16x16x32_bf16 v[36:39], a[204:207], v[84:87], v[36:39]
    s_add_u32 m0, s63, 45056
    v_mov_b32 v4, s56
    v_mfma_f32_16x16x32_bf16 v[36:39], a[200:203], v[80:83], v[36:39]
    ds_read_b64_tr_b16 a[200:201], v10 offset:16384
    v_mfma_f32_16x16x32_bf16 v[36:39], a[208:211], v[112:115], v[36:39]
    ds_read_b64_tr_b16 a[202:203], v10 offset:18432
    v_mfma_f32_16x16x32_bf16 v[36:39], a[212:215], v[116:119], v[36:39]
    ds_read_b64_tr_b16 a[204:205], v10 offset:20480
    v_mfma_f32_16x16x32_bf16 v[32:35], a[212:215], v[108:111], v[32:35]
    ds_read_b64_tr_b16 a[206:207], v10 offset:22528
    v_mfma_f32_16x16x32_bf16 v[32:35], a[208:211], v[104:107], v[32:35]
    buffer_load_dwordx4 v3, s[8:11], s38 offen lds
    v_mfma_f32_16x16x32_bf16 v[28:31], a[208:211], v[96:99], v[28:31]
    v_mfma_f32_16x16x32_bf16 v[28:31], a[212:215], v[100:103], v[28:31]
    v_mfma_f32_16x16x32_bf16 v[24:27], a[212:215], v[92:95], v[24:27]
    v_mul_f32 v36, v19, v36
    v_mfma_f32_16x16x32_bf16 v[24:27], a[208:211], v[88:91], v[24:27]
    s_add_u32 s38, s47, 0
    ds_read_b64_tr_b16 a[208:209], v10 offset:24576
    v_mul_f32 v32, v18, v32
    v_mfma_f32_16x16x32_bf16 v[40:43], a[184:187], a[96:99], 0
    s_mul_i32 s57, s48, 10
    ds_read_b64_tr_b16 a[210:211], v10 offset:26624
    v_lshrrev_b32 v5, 5, v1
    v_mfma_f32_16x16x32_bf16 v[40:43], a[188:191], a[100:103], v[40:43]
pg_11:
    s_cbranch_execz pg_15
    s_add_u32 m0, s63, 49152
    ds_read_b64_tr_b16 a[212:213], v10 offset:28672
    v_lshlrev_b32 v5, 3, v5
    v_mfma_f32_16x16x32_bf16 v[44:47], a[188:191], a[108:111], 0
    s_waitcnt lgkmcnt(3)
    ds_read_b64_tr_b16 a[214:215], v10 offset:30720
    v_bfe_u32 v22, v1, 3, 2
    v_mfma_f32_16x16x32_bf16 v[44:47], a[184:187], a[104:107], v[44:47]
    s_sub_u32 s57, s58, s57
    v_add_u32 v22, v22, v5
    v_mul_u32_u24 v22, 1280, v22
    v_mfma_f32_16x16x32_bf16 v[48:51], a[184:187], a[112:115], 0
    s_mul_i32 s62, s48, 1280
    v_lshrrev_b32 v5, 4, v1
    v_lshlrev_b32 v5, 1, v5
    v_mfma_f32_16x16x32_bf16 v[48:51], a[188:191], a[116:119], v[48:51]
    s_lshl_b32 s56, s57, 6
    v_and_b32 v23, 7, v1
    v_xor_b32 v23, v23, v5
    v_mfma_f32_16x16x32_bf16 v[52:55], a[188:191], a[124:127], 0
    s_add_u32 s62, s62, s56
    v_lshlrev_b32 v23, 4, v23
    v_add_u32 v22, v22, v23
    v_mfma_f32_16x16x32_bf16 v[52:55], a[184:187], a[120:123], v[52:55]
    buffer_load_dwordx4 v2, s[8:11], s38 offen lds
    v_mfma_f32_16x16x32_bf16 v[52:55], a[192:195], v[120:123], v[52:55]
    s_lshl_b32 s56, s3, 4
    ds_read_b64_tr_b16 a[184:185], v10 offset:32768
    v_add_u32 v23, 20480, v22
    v_mfma_f32_16x16x32_bf16 v[52:55], a[196:199], v[124:127], v[52:55]
    s_add_u32 s62, s62, s56
    ds_read_b64_tr_b16 a[186:187], v10 offset:34816
    v_mul_f32 v24, v16, v24
    v_mfma_f32_16x16x32_bf16 v[48:51], a[196:199], a[148:151], v[48:51]
    s_lshl_b32 s62, s62, 2
    ds_read_b64_tr_b16 a[188:189], v10 offset:36864
    v_mul_f32 v25, v16, v25
    v_mfma_f32_16x16x32_bf16 v[48:51], a[192:195], a[144:147], v[48:51]
    s_add_u32 s38, s47, 0
    ds_read_b64_tr_b16 a[190:191], v10 offset:38912
    v_mul_f32 v26, v16, v26
    v_mfma_f32_16x16x32_bf16 v[44:47], a[192:195], a[136:139], v[44:47]
    s_add_u32 s62, s62, 3670016
    v_mul_f32 v27, v16, v27
    v_cvt_pk_bf16_f32 v24, v24, v25
    v_mfma_f32_16x16x32_bf16 v[44:47], a[196:199], a[140:143], v[44:47]
    s_add_u32 m0, s63, 53248
    v_cvt_pk_bf16_f32 v25, v26, v27
    v_accvgpr_write_b32 a66, v24
    v_mfma_f32_16x16x32_bf16 v[40:43], a[196:199], a[132:135], v[40:43]
    s_lshl_b32 s41, s48, 6
    v_accvgpr_write_b32 a67, v25
    v_mul_f32 v28, v17, v28
    v_mfma_f32_16x16x32_bf16 v[40:43], a[192:195], a[128:131], v[40:43]
    buffer_store_dwordx4 a[64:67], v14, s[20:23], s55 offen offset:0 sc1
    v_mul_f32 v29, v17, v29
    v_mfma_f32_16x16x32_bf16 v[40:43], a[200:203], v[128:131], v[40:43]
    s_lshr_b32 s56, s3, 1
    ds_read_b64_tr_b16 a[192:193], v10 offset:40960
    v_mul_f32 v30, v17, v30
    v_mfma_f32_16x16x32_bf16 v[40:43], a[204:207], v[132:135], v[40:43]
    s_lshl_b32 s56, s56, 5
    ds_read_b64_tr_b16 a[194:195], v10 offset:43008
    v_mul_f32 v31, v17, v31
    v_mfma_f32_16x16x32_bf16 v[44:47], a[204:207], v[140:143], v[44:47]
    s_add_u32 s41, s41, s56
    ds_read_b64_tr_b16 a[196:197], v10 offset:45056
    v_cvt_pk_bf16_f32 v28, v28, v29
    v_mfma_f32_16x16x32_bf16 v[44:47], a[200:203], v[136:139], v[44:47]
    s_waitcnt lgkmcnt(3)
    ds_read_b64_tr_b16 a[198:199], v10 offset:47104
    v_cvt_pk_bf16_f32 v29, v30, v31
    v_mfma_f32_16x16x32_bf16 v[48:51], a[200:203], v[144:147], v[48:51]
    buffer_load_dwordx4 v3, s[8:11], s38 offen lds
    v_mfma_f32_16x16x32_bf16 v[48:51], a[204:207], v[148:151], v[48:51]
    s_and_b32 s56, s3, 1
    v_accvgpr_write_b32 a70, v28
    v_accvgpr_write_b32 a71, v29
    v_mfma_f32_16x16x32_bf16 v[52:55], a[204:207], v[156:159], v[52:55]
    buffer_store_dwordx4 a[68:71], v14, s[20:23], s55 offen offset:1024 sc1
    v_mul_f32 v33, v18, v33
    v_mfma_f32_16x16x32_bf16 v[52:55], a[200:203], v[152:155], v[52:55]
    s_lshl_b32 s56, s56, 2
    ds_read_b64_tr_b16 a[200:201], v10 offset:49152
    v_mul_f32 v34, v18, v34
    v_mfma_f32_16x16x32_bf16 v[52:55], a[208:211], v[184:187], v[52:55]
    s_add_u32 s41, s41, s56
    ds_read_b64_tr_b16 a[202:203], v10 offset:51200
    v_mul_f32 v35, v18, v35
    v_mfma_f32_16x16x32_bf16 v[52:55], a[212:215], v[188:191], v[52:55]
    s_add_u32 s56, s3, 0
    ds_read_b64_tr_b16 a[204:205], v10 offset:53248
    v_cvt_pk_bf16_f32 v32, v32, v33
    v_mfma_f32_16x16x32_bf16 v[48:51], a[212:215], v[180:183], v[48:51]
    s_min_u32 s56, s56, 9
    ds_read_b64_tr_b16 a[206:207], v10 offset:55296
    v_cvt_pk_bf16_f32 v33, v34, v35
    v_mfma_f32_16x16x32_bf16 v[48:51], a[208:211], v[176:179], v[48:51]
    s_mul_i32 s38, s56, 24576
    v_accvgpr_write_b32 a74, v32
    v_accvgpr_write_b32 a75, v33
    v_mfma_f32_16x16x32_bf16 v[44:47], a[208:211], v[168:171], v[44:47]
    buffer_store_dwordx4 a[72:75], v14, s[20:23], s55 offen offset:2048 sc1
    v_mul_f32 v37, v19, v37
    v_mfma_f32_16x16x32_bf16 v[44:47], a[212:215], v[172:175], v[44:47]
    s_lshl_b32 s56, s56, 10
    v_mul_f32 v38, v19, v38
    v_mul_f32 v39, v19, v39
    v_mfma_f32_16x16x32_bf16 v[40:43], a[212:215], v[164:167], v[40:43]
    s_add_u32 m0, s56, 61440
    v_cvt_pk_bf16_f32 v36, v36, v37
    v_cvt_pk_bf16_f32 v37, v38, v39
    v_mfma_f32_16x16x32_bf16 v[40:43], a[208:211], v[160:163], v[40:43]
    s_mul_i32 s41, s41, 1280
    ds_read_b64_tr_b16 a[208:209], v10 offset:57344
    v_accvgpr_write_b32 a78, v36
    v_mfma_f32_16x16x32_bf16 v[40:43], a[184:187], v[192:195], v[40:43]
    s_lshl_b32 s57, s57, 7
    ds_read_b64_tr_b16 a[210:211], v10 offset:59392
    v_accvgpr_write_b32 a79, v37
    v_mfma_f32_16x16x32_bf16 v[40:43], a[188:191], v[196:199], v[40:43]
    buffer_store_dwordx4 a[76:79], v14, s[20:23], s55 offen offset:3072 sc1
    v_mfma_f32_16x16x32_bf16 v[44:47], a[188:191], v[204:207], v[44:47]
    s_add_u32 s56, s3, 4
    ds_read_b64_tr_b16 a[212:213], v10 offset:61440
    s_min_u32 s56, s56, 9
    v_mfma_f32_16x16x32_bf16 v[44:47], a[184:187], v[200:203], v[44:47]
    s_waitcnt lgkmcnt(3)
    ds_read_b64_tr_b16 a[214:215], v10 offset:63488
    s_add_u32 s55, s55, 4096
    v_mfma_f32_16x16x32_bf16 v[48:51], a[184:187], v[208:211], v[48:51]
    s_add_u32 s41, s41, s57
    v_add_u32 v10, 65536, v10
    s_lshl_b32 s57, s48, 10
    v_mfma_f32_16x16x32_bf16 v[48:51], a[188:191], v[212:215], v[48:51]
    s_add_u32 s38, s38, s57
    s_add_u32 s38, s38, 3276800
    s_lshl_b32 s57, s48, 10
    v_mfma_f32_16x16x32_bf16 v[52:55], a[188:191], v[220:223], v[52:55]
    buffer_load_dwordx4 v14, s[24:27], s38 offen sc1 lds
    v_mfma_f32_16x16x32_bf16 v[52:55], a[184:187], v[216:219], v[52:55]
    s_mul_i32 s38, s56, 24576
    ds_read_b64_tr_b16 a[184:185], v11 offset:0
    s_add_u32 s38, s38, s57
    v_mfma_f32_16x16x32_bf16 v[52:55], a[192:195], v[248:251], v[52:55]
    s_add_u32 s38, s38, 3276800
    ds_read_b64_tr_b16 a[186:187], v11 offset:2048
    s_lshl_b32 s56, s56, 10
    v_mfma_f32_16x16x32_bf16 v[52:55], a[196:199], v[252:255], v[52:55]
    s_add_u32 m0, s56, 61440
    ds_read_b64_tr_b16 a[188:189], v11 offset:4096
    s_lshl_b32 s43, s3, 11
    v_mfma_f32_16x16x32_bf16 v[48:51], a[196:199], v[244:247], v[48:51]
    buffer_load_dwordx4 v14, s[24:27], s38 offen sc1 lds
    v_mfma_f32_16x16x32_bf16 v[48:51], a[192:195], v[240:243], v[48:51]
    s_add_u32 s56, s3, 8
    ds_read_b64_tr_b16 a[190:191], v11 offset:6144
    s_min_u32 s56, s56, 9
    v_mfma_f32_16x16x32_bf16 v[44:47], a[192:195], v[232:235], v[44:47]
    s_mul_i32 s38, s56, 24576
    s_lshl_b32 s57, s48, 10
    s_add_u32 s38, s38, s57
    v_mfma_f32_16x16x32_bf16 v[44:47], a[196:199], v[236:239], v[44:47]
    s_add_u32 s38, s38, 3276800
    s_lshl_b32 s56, s56, 10
    s_add_u32 m0, s56, 61440
    v_mfma_f32_16x16x32_bf16 v[40:43], a[196:199], v[228:231], v[40:43]
    s_add_u32 s56, s7, 6
    v_lshrrev_b32 v12, 2, v1
    v_mfma_f32_16x16x32_bf16 v[40:43], a[192:195], v[224:227], v[40:43]
    ds_read_b64_tr_b16 a[192:193], v11 offset:8192
    v_mfma_f32_16x16x32_bf16 v[40:43], a[200:203], v[56:59], v[40:43]
    s_add_u32 s77, s7, 3
    ds_read_b64_tr_b16 a[194:195], v11 offset:10240
    v_mfma_f32_16x16x32_bf16 v[40:43], a[204:207], v[60:63], v[40:43]
    ds_read_b64_tr_b16 a[196:197], v11 offset:12288
    v_mfma_f32_16x16x32_bf16 v[44:47], a[204:207], v[68:71], v[44:47]
    s_waitcnt lgkmcnt(3)
    ds_read_b64_tr_b16 a[198:199], v11 offset:14336
    v_mfma_f32_16x16x32_bf16 v[44:47], a[200:203], v[64:67], v[44:47]
    buffer_load_dwordx4 v14, s[24:27], s38 offen sc1 lds
    v_mfma_f32_16x16x32_bf16 v[48:51], a[200:203], v[72:75], v[48:51]
    s_load_dwordx4 s[72:75], s[86:87], s5 glc
    v_lshlrev_b32 v12, 6, v12
    v_mfma_f32_16x16x32_bf16 v[48:51], a[204:207], v[76:79], v[48:51]
    v_and_b32 v21, 3, v1
    v_mfma_f32_16x16x32_bf16 v[52:55], a[204:207], v[84:87], v[52:55]
    v_lshl_add_u32 v12, v21, 3, v12
    v_mfma_f32_16x16x32_bf16 v[52:55], a[200:203], v[80:83], v[52:55]
    ds_read_b64_tr_b16 a[200:201], v11 offset:16384
    v_mfma_f32_16x16x32_bf16 v[52:55], a[208:211], v[112:115], v[52:55]
    ds_read_b64_tr_b16 a[202:203], v11 offset:18432
    v_mfma_f32_16x16x32_bf16 v[52:55], a[212:215], v[116:119], v[52:55]
    ds_read_b64_tr_b16 a[204:205], v11 offset:20480
    v_mfma_f32_16x16x32_bf16 v[48:51], a[212:215], v[108:111], v[48:51]
    ds_read_b64_tr_b16 a[206:207], v11 offset:22528
    v_mfma_f32_16x16x32_bf16 v[48:51], a[208:211], v[104:107], v[48:51]
    v_and_b32 v21, 16, v1
    v_mfma_f32_16x16x32_bf16 v[44:47], a[208:211], v[96:99], v[44:47]
    v_lshl_add_u32 v12, v21, 1, v12
    v_mfma_f32_16x16x32_bf16 v[44:47], a[212:215], v[100:103], v[44:47]
    v_mul_f32 v52, v19, v52
    v_mfma_f32_16x16x32_bf16 v[40:43], a[212:215], v[92:95], v[40:43]
    s_add_u32 s37, s60, 4096
    v_mul_f32 v53, v19, v53
    v_mul_f32 v48, v18, v48
    v_mfma_f32_16x16x32_bf16 v[40:43], a[208:211], v[88:91], v[40:43]
    ds_read_b64_tr_b16 a[208:209], v11 offset:24576
    v_mul_f32 v49, v18, v49
    v_mfma_f32_16x16x32_bf16 v[24:27], a[184:187], a[96:99], 0
    ds_read_b64_tr_b16 a[210:211], v11 offset:26624
    v_mul_f32 v44, v17, v44
    v_mfma_f32_16x16x32_bf16 v[24:27], a[188:191], a[100:103], v[24:27]
    ds_read_b64_tr_b16 a[212:213], v11 offset:28672
    v_mul_f32 v45, v17, v45
    v_mfma_f32_16x16x32_bf16 v[28:31], a[188:191], a[108:111], 0
    s_waitcnt lgkmcnt(3)
    ds_read_b64_tr_b16 a[214:215], v11 offset:30720
    v_mul_f32 v40, v16, v40
    v_mfma_f32_16x16x32_bf16 v[28:31], a[184:187], a[104:107], v[28:31]
    v_mul_f32 v41, v16, v41
    v_mul_f32 v42, v16, v42
    v_mfma_f32_16x16x32_bf16 v[32:35], a[184:187], a[112:115], 0
    buffer_load_dwordx4 a[96:99], v14, s[20:23], s37 offen offset:0 sc1
    v_mfma_f32_16x16x32_bf16 v[32:35], a[188:191], a[116:119], v[32:35]
    v_mul_f32 v43, v16, v43
    v_cvt_pk_bf16_f32 v40, v40, v41
    v_mfma_f32_16x16x32_bf16 v[36:39], a[188:191], a[124:127], 0
    v_cvt_pk_bf16_f32 v41, v42, v43
    v_accvgpr_write_b32 a80, v40
    v_mfma_f32_16x16x32_bf16 v[36:39], a[184:187], a[120:123], v[36:39]
    ds_read_b64_tr_b16 a[184:185], v11 offset:32768
    v_accvgpr_write_b32 a81, v41
    v_mfma_f32_16x16x32_bf16 v[36:39], a[192:195], v[120:123], v[36:39]
    ds_read_b64_tr_b16 a[186:187], v11 offset:34816
    v_mul_f32 v46, v17, v46
    v_mfma_f32_16x16x32_bf16 v[36:39], a[196:199], v[124:127], v[36:39]
    buffer_load_dwordx4 a[100:103], v14, s[20:23], s37 offen offset:1024 sc1
    v_mfma_f32_16x16x32_bf16 v[32:35], a[196:199], a[148:151], v[32:35]
    ds_read_b64_tr_b16 a[188:189], v11 offset:36864
    v_mul_f32 v47, v17, v47
    v_mfma_f32_16x16x32_bf16 v[32:35], a[192:195], a[144:147], v[32:35]
    ds_read_b64_tr_b16 a[190:191], v11 offset:38912
    v_cvt_pk_bf16_f32 v44, v44, v45
    v_mfma_f32_16x16x32_bf16 v[28:31], a[192:195], a[136:139], v[28:31]
    v_cvt_pk_bf16_f32 v45, v46, v47
    v_accvgpr_write_b32 a84, v44
    v_mfma_f32_16x16x32_bf16 v[28:31], a[196:199], a[140:143], v[28:31]
    v_accvgpr_write_b32 a85, v45
    v_mul_f32 v50, v18, v50
    v_mfma_f32_16x16x32_bf16 v[24:27], a[196:199], a[132:135], v[24:27]
    buffer_load_dwordx4 a[104:107], v14, s[20:23], s37 offen offset:2048 sc1
    v_mfma_f32_16x16x32_bf16 v[24:27], a[192:195], a[128:131], v[24:27]
    ds_read_b64_tr_b16 a[192:193], v11 offset:40960
    v_mul_f32 v51, v18, v51
    v_mfma_f32_16x16x32_bf16 v[24:27], a[200:203], v[128:131], v[24:27]
    ds_read_b64_tr_b16 a[194:195], v11 offset:43008
    v_cvt_pk_bf16_f32 v48, v48, v49
    v_mfma_f32_16x16x32_bf16 v[24:27], a[204:207], v[132:135], v[24:27]
    ds_read_b64_tr_b16 a[196:197], v11 offset:45056
    v_cvt_pk_bf16_f32 v49, v50, v51
    v_mfma_f32_16x16x32_bf16 v[28:31], a[204:207], v[140:143], v[28:31]
    s_waitcnt lgkmcnt(3)
    ds_read_b64_tr_b16 a[198:199], v11 offset:47104
    v_accvgpr_write_b32 a88, v48
    v_mfma_f32_16x16x32_bf16 v[28:31], a[200:203], v[136:139], v[28:31]
    buffer_load_dwordx4 a[108:111], v14, s[20:23], s37 offen offset:3072 sc1
    v_mfma_f32_16x16x32_bf16 v[32:35], a[200:203], v[144:147], v[32:35]
    s_add_u32 s37, s61, 4096
    v_accvgpr_write_b32 a89, v49
    v_mul_f32 v54, v19, v54
    v_mfma_f32_16x16x32_bf16 v[32:35], a[204:207], v[148:151], v[32:35]
    v_mul_f32 v55, v19, v55
    v_cvt_pk_bf16_f32 v52, v52, v53
    v_mfma_f32_16x16x32_bf16 v[36:39], a[204:207], v[156:159], v[36:39]
    v_cvt_pk_bf16_f32 v53, v54, v55
    v_accvgpr_write_b32 a92, v52
    v_mfma_f32_16x16x32_bf16 v[36:39], a[200:203], v[152:155], v[36:39]
    ds_read_b64_tr_b16 a[200:201], v11 offset:49152
    v_accvgpr_write_b32 a93, v53
    v_mfma_f32_16x16x32_bf16 v[36:39], a[208:211], v[184:187], v[36:39]
    buffer_load_dwordx4 a[112:115], v14, s[20:23], s37 offen offset:0 sc1
    v_mfma_f32_16x16x32_bf16 v[36:39], a[212:215], v[188:191], v[36:39]
    ds_read_b64_tr_b16 a[202:203], v11 offset:51200
    v_mfma_f32_16x16x32_bf16 v[32:35], a[212:215], v[180:183], v[32:35]
    ds_read_b64_tr_b16 a[204:205], v11 offset:53248
    v_mfma_f32_16x16x32_bf16 v[32:35], a[208:211], v[176:179], v[32:35]
    ds_read_b64_tr_b16 a[206:207], v11 offset:55296
    v_mfma_f32_16x16x32_bf16 v[28:31], a[208:211], v[168:171], v[28:31]
    v_add_u32 v12, 98304, v12
    v_mfma_f32_16x16x32_bf16 v[28:31], a[212:215], v[172:175], v[28:31]
    buffer_load_dwordx4 a[116:119], v14, s[20:23], s37 offen offset:1024 sc1
    v_mfma_f32_16x16x32_bf16 v[24:27], a[212:215], v[164:167], v[24:27]
    v_lshrrev_b32 v13, 2, v1
    v_mfma_f32_16x16x32_bf16 v[24:27], a[208:211], v[160:163], v[24:27]
    ds_read_b64_tr_b16 a[208:209], v11 offset:57344
    v_mfma_f32_16x16x32_bf16 v[24:27], a[184:187], v[192:195], v[24:27]
    ds_read_b64_tr_b16 a[210:211], v11 offset:59392
    v_mfma_f32_16x16x32_bf16 v[24:27], a[188:191], v[196:199], v[24:27]
    ds_read_b64_tr_b16 a[212:213], v11 offset:61440
    v_mfma_f32_16x16x32_bf16 v[28:31], a[188:191], v[204:207], v[28:31]
    s_waitcnt lgkmcnt(3)
    ds_read_b64_tr_b16 a[214:215], v11 offset:63488
    s_sub_u32 s78, s72, s77
    v_mfma_f32_16x16x32_bf16 v[28:31], a[184:187], v[200:203], v[28:31]
    buffer_load_dwordx4 a[120:123], v14, s[20:23], s37 offen offset:2048 sc1
    v_mfma_f32_16x16x32_bf16 v[32:35], a[184:187], v[208:211], v[32:35]
    s_sub_u32 s79, s73, s77
    v_lshlrev_b32 v13, 6, v13
    s_max_u32 s78, s78, s79
    v_mfma_f32_16x16x32_bf16 v[32:35], a[188:191], v[212:215], v[32:35]
    s_sub_u32 s79, s74, s77
    v_and_b32 v21, 3, v1
    s_max_u32 s78, s78, s79
    v_mfma_f32_16x16x32_bf16 v[36:39], a[188:191], v[220:223], v[36:39]
    s_sub_u32 s79, s75, s77
    v_lshl_add_u32 v13, v21, 3, v13
    s_max_u32 s78, s78, s79
    v_mfma_f32_16x16x32_bf16 v[36:39], a[184:187], v[216:219], v[36:39]
    buffer_load_dwordx4 a[124:127], v14, s[20:23], s37 offen offset:3072 sc1
    v_mfma_f32_16x16x32_bf16 v[36:39], a[192:195], v[248:251], v[36:39]
    s_cmp_gt_u32 s78, 3
    s_cbranch_scc1 spin_o2
spin_o2_ret:
    s_add_u32 s37, s59, 8192
    v_mfma_f32_16x16x32_bf16 v[36:39], a[196:199], v[252:255], v[36:39]
    s_waitcnt lgkmcnt(0)
    v_and_b32 v21, 16, v1
    v_mfma_f32_16x16x32_bf16 v[32:35], a[196:199], v[244:247], v[32:35]
    s_barrier
    v_mfma_f32_16x16x32_bf16 v[32:35], a[192:195], v[240:243], v[32:35]
    ds_read_b64_tr_b16 a[184:185], v12 offset:57344
    v_mfma_f32_16x16x32_bf16 v[28:31], a[192:195], v[232:235], v[28:31]
    buffer_load_dwordx4 a[128:131], v14, s[20:23], s37 offen offset:0 sc1
    v_mfma_f32_16x16x32_bf16 v[28:31], a[196:199], v[236:239], v[28:31]
    ds_read_b64_tr_b16 a[186:187], v12 offset:58368
    v_mfma_f32_16x16x32_bf16 v[24:27], a[196:199], v[228:231], v[24:27]
    ds_read_b64_tr_b16 a[188:189], v12 offset:59392
    v_lshl_add_u32 v13, v21, 1, v13
    v_mfma_f32_16x16x32_bf16 v[24:27], a[192:195], v[224:227], v[24:27]
    ds_read_b64_tr_b16 a[190:191], v12 offset:60416
    v_xor_b32 v13, 32, v13
    v_mfma_f32_16x16x32_bf16 v[24:27], a[200:203], v[56:59], v[24:27]
    v_add_u32 v13, 98304, v13
    v_mfma_f32_16x16x32_bf16 v[24:27], a[204:207], v[60:63], v[24:27]
    buffer_load_dwordx4 a[132:135], v14, s[20:23], s37 offen offset:1024 sc1
    v_mfma_f32_16x16x32_bf16 v[28:31], a[204:207], v[68:71], v[28:31]
    s_waitcnt vmcnt(13)
    ds_read_b64_tr_b16 a[192:193], v13 offset:57344
    v_mfma_f32_16x16x32_bf16 v[28:31], a[200:203], v[64:67], v[28:31]
    buffer_store_dword v4, v15, s[24:27], s76 offen sc1
    v_mfma_f32_16x16x32_bf16 v[32:35], a[200:203], v[72:75], v[32:35]
    ds_read_b64_tr_b16 a[194:195], v13 offset:58368
    v_mfma_f32_16x16x32_bf16 v[32:35], a[204:207], v[76:79], v[32:35]
    ds_read_b64_tr_b16 a[196:197], v13 offset:59392
    v_mfma_f32_16x16x32_bf16 v[36:39], a[204:207], v[84:87], v[36:39]
    buffer_load_dwordx4 a[136:139], v14, s[20:23], s37 offen offset:2048 sc1
    v_mfma_f32_16x16x32_bf16 v[36:39], a[200:203], v[80:83], v[36:39]
    ds_read_b64_tr_b16 a[198:199], v13 offset:60416
    v_mfma_f32_16x16x32_bf16 v[36:39], a[208:211], v[112:115], v[36:39]
    ds_read_b64_tr_b16 a[200:201], v8 offset:0
    v_mfma_f32_16x16x32_bf16 v[36:39], a[212:215], v[116:119], v[36:39]
    ds_read_b64_tr_b16 a[202:203], v8 offset:2048
    v_mfma_f32_16x16x32_bf16 v[32:35], a[212:215], v[108:111], v[32:35]
    ds_read_b64_tr_b16 a[204:205], v8 offset:8192
    v_mfma_f32_16x16x32_bf16 v[32:35], a[208:211], v[104:107], v[32:35]
    s_waitcnt lgkmcnt(5)
    ds_read_b64_tr_b16 a[206:207], v8 offset:10240
    v_mfma_f32_16x16x32_bf16 v[28:31], a[208:211], v[96:99], v[28:31]
    buffer_load_dwordx4 a[140:143], v14, s[20:23], s37 offen offset:3072 sc1
    v_mfma_f32_16x16x32_bf16 v[28:31], a[212:215], v[100:103], v[28:31]
    v_mov_b32 v4, s56
    v_add_u32 v11, 65536, v11
    v_mfma_f32_16x16x32_bf16 v[24:27], a[212:215], v[92:95], v[24:27]
    s_lshl_b32 s56, s3, 8
    v_mul_f32 v32, v18, v32
    v_mul_f32 v33, v18, v33
    v_mfma_f32_16x16x32_bf16 v[24:27], a[208:211], v[88:91], v[24:27]
    s_add_u32 s56, s56, 71680
    ds_read_b64_tr_b16 a[208:209], v9 offset:0
    v_mul_f32 v28, v17, v28
    v_mfma_f32_16x16x32_bf16 v[96:99], a[184:187], a[0:3], 0
    ds_read_b64_tr_b16 a[210:211], v9 offset:2048
    v_mul_f32 v29, v17, v29
    v_mfma_f32_16x16x32_bf16 v[96:99], a[188:191], a[16:19], v[96:99]
    ds_read_b64_tr_b16 a[212:213], v9 offset:8192
    v_mul_f32 v24, v16, v24
    v_mfma_f32_16x16x32_bf16 v[104:107], a[188:191], a[20:23], 0
    ds_read_b64_tr_b16 a[214:215], v9 offset:10240
    v_mul_f32 v25, v16, v25
    v_mfma_f32_16x16x32_bf16 v[104:107], a[184:187], a[4:7], v[104:107]
    v_mul_f32 v26, v16, v26
    v_mul_f32 v27, v16, v27
    v_mfma_f32_16x16x32_bf16 v[112:115], a[184:187], a[8:11], 0
    v_cvt_pk_bf16_f32 v24, v24, v25
    v_cvt_pk_bf16_f32 v25, v26, v27
    v_mfma_f32_16x16x32_bf16 v[112:115], a[188:191], a[24:27], v[112:115]
    v_accvgpr_write_b32 a82, v24
    v_accvgpr_write_b32 a83, v25
    v_mfma_f32_16x16x32_bf16 v[120:123], a[188:191], a[28:31], 0
    buffer_store_dwordx4 a[80:83], v14, s[20:23], s55 offen offset:0 sc1
    v_mul_f32 v30, v17, v30
    v_mfma_f32_16x16x32_bf16 v[120:123], a[184:187], a[12:15], v[120:123]
    s_waitcnt lgkmcnt(2)
    ds_read_b64_tr_b16 a[184:185], v10 offset:0
    v_mul_f32 v31, v17, v31
    v_mfma_f32_16x16x32_bf16 v[124:127], a[192:195], a[12:15], 0
    ds_read_b64_tr_b16 a[186:187], v10 offset:2048
    v_cvt_pk_bf16_f32 v28, v28, v29
    v_mfma_f32_16x16x32_bf16 v[124:127], a[196:199], a[28:31], v[124:127]
    ds_read_b64_tr_b16 a[188:189], v10 offset:8192
    v_cvt_pk_bf16_f32 v29, v30, v31
    v_mfma_f32_16x16x32_bf16 v[116:119], a[196:199], a[24:27], 0
    ds_read_b64_tr_b16 a[190:191], v10 offset:10240
    v_accvgpr_write_b32 a86, v28
    v_mfma_f32_16x16x32_bf16 v[116:119], a[192:195], a[8:11], v[116:119]
    v_accvgpr_write_b32 a87, v29
    v_mul_f32 v34, v18, v34
    v_mfma_f32_16x16x32_bf16 v[108:111], a[192:195], a[4:7], 0
    buffer_store_dwordx4 a[84:87], v14, s[20:23], s55 offen offset:1024 sc1
    v_mul_f32 v35, v18, v35
    v_mfma_f32_16x16x32_bf16 v[108:111], a[196:199], a[20:23], v[108:111]
    v_cvt_pk_bf16_f32 v32, v32, v33
    v_cvt_pk_bf16_f32 v33, v34, v35
    v_mfma_f32_16x16x32_bf16 v[100:103], a[196:199], a[16:19], 0
    v_accvgpr_write_b32 a90, v32
    v_accvgpr_write_b32 a91, v33
    v_mfma_f32_16x16x32_bf16 v[100:103], a[192:195], a[0:3], v[100:103]
    buffer_store_dwordx4 a[88:91], v14, s[20:23], s55 offen offset:2048 sc1
    v_mul_f32 v36, v19, v36
    v_mfma_f32_16x16x32_bf16 v[128:131], a[200:203], a[0:3], 0
    ds_read_b64_tr_b16 a[192:193], v11 offset:0
    v_mfma_f32_16x16x32_bf16 v[128:131], a[204:207], a[16:19], v[128:131]
    ds_read_b64_tr_b16 a[194:195], v11 offset:2048
    v_mfma_f32_16x16x32_bf16 v[136:139], a[204:207], a[20:23], 0
    ds_read_b64_tr_b16 a[196:197], v11 offset:8192
    v_mfma_f32_16x16x32_bf16 v[136:139], a[200:203], a[4:7], v[136:139]
    ds_read_b64_tr_b16 a[198:199], v11 offset:10240
    v_mfma_f32_16x16x32_bf16 v[144:147], a[200:203], a[8:11], 0
    v_mul_f32 v37, v19, v37
    v_mul_f32 v38, v19, v38
    v_mfma_f32_16x16x32_bf16 v[144:147], a[204:207], a[24:27], v[144:147]
    v_mul_f32 v39, v19, v39
    v_cvt_pk_bf16_f32 v36, v36, v37
    v_mfma_f32_16x16x32_bf16 v[152:155], a[204:207], a[28:31], 0
    s_waitcnt lgkmcnt(4)
    v_cvt_pk_bf16_f32 v37, v38, v39
    v_accvgpr_write_b32 a94, v36
    v_mfma_f32_16x16x32_bf16 v[152:155], a[200:203], a[12:15], v[152:155]
    ds_read_b64_tr_b16 a[200:201], v8 offset:4096
    v_accvgpr_write_b32 a95, v37
    v_mfma_f32_16x16x32_bf16 v[156:159], a[208:211], a[12:15], 0
    buffer_store_dwordx4 a[92:95], v14, s[20:23], s55 offen offset:3072 sc1
    v_subrev_u32 v12, 81920, v12
    v_mfma_f32_16x16x32_bf16 v[156:159], a[212:215], a[28:31], v[156:159]
    s_add_u32 s55, s55, 4096
    ds_read_b64_tr_b16 a[202:203], v8 offset:6144
    v_mfma_f32_16x16x32_bf16 v[148:151], a[212:215], a[24:27], 0
    ds_read_b64_tr_b16 a[204:205], v8 offset:12288
    v_mfma_f32_16x16x32_bf16 v[148:151], a[208:211], a[8:11], v[148:151]
    ds_read_b64_tr_b16 a[206:207], v8 offset:14336
    v_mfma_f32_16x16x32_bf16 v[140:143], a[208:211], a[4:7], 0
    v_subrev_u32 v13, 81920, v13
    v_mfma_f32_16x16x32_bf16 v[140:143], a[212:215], a[20:23], v[140:143]
    v_subrev_u32 v8, 139264, v8
    v_mfma_f32_16x16x32_bf16 v[132:135], a[212:215], a[16:19], 0
    v_mfma_f32_16x16x32_bf16 v[132:135], a[208:211], a[0:3], v[132:135]
    ds_read_b64_tr_b16 a[208:209], v9 offset:4096
    v_mfma_f32_16x16x32_bf16 v[160:163], a[184:187], a[0:3], 0
    ds_read_b64_tr_b16 a[210:211], v9 offset:6144
    v_mfma_f32_16x16x32_bf16 v[160:163], a[188:191], a[16:19], v[160:163]
    ds_read_b64_tr_b16 a[212:213], v9 offset:12288
    v_mfma_f32_16x16x32_bf16 v[168:171], a[188:191], a[20:23], 0
    s_waitcnt lgkmcnt(3)
    ds_read_b64_tr_b16 a[214:215], v9 offset:14336
    v_mfma_f32_16x16x32_bf16 v[168:171], a[184:187], a[4:7], v[168:171]
    v_subrev_u32 v9, 139264, v9
    v_mfma_f32_16x16x32_bf16 v[176:179], a[184:187], a[8:11], 0
    v_mfma_f32_16x16x32_bf16 v[176:179], a[188:191], a[24:27], v[176:179]
    v_mfma_f32_16x16x32_bf16 v[184:187], a[188:191], a[28:31], 0
    v_mfma_f32_16x16x32_bf16 v[184:187], a[184:187], a[12:15], v[184:187]
    ds_read_b64_tr_b16 a[184:185], v10 offset:4096
    v_mfma_f32_16x16x32_bf16 v[188:191], a[192:195], a[12:15], 0
    ds_read_b64_tr_b16 a[186:187], v10 offset:6144
    v_mfma_f32_16x16x32_bf16 v[188:191], a[196:199], a[28:31], v[188:191]
    ds_read_b64_tr_b16 a[188:189], v10 offset:12288
    v_mfma_f32_16x16x32_bf16 v[180:183], a[196:199], a[24:27], 0
    ds_read_b64_tr_b16 a[190:191], v10 offset:14336
    v_mfma_f32_16x16x32_bf16 v[180:183], a[192:195], a[8:11], v[180:183]
    v_subrev_u32 v10, 139264, v10
    v_mfma_f32_16x16x32_bf16 v[172:175], a[192:195], a[4:7], 0
    s_add_u32 m0, s43, 114688
    v_mfma_f32_16x16x32_bf16 v[172:175], a[196:199], a[20:23], v[172:175]
    v_mfma_f32_16x16x32_bf16 v[164:167], a[196:199], a[16:19], 0
    v_mfma_f32_16x16x32_bf16 v[164:167], a[192:195], a[0:3], v[164:167]
    ds_read_b64_tr_b16 a[192:193], v11 offset:4096
    v_mfma_f32_16x16x32_bf16 v[192:195], a[200:203], a[0:3], 0
    ds_read_b64_tr_b16 a[194:195], v11 offset:6144
    v_mfma_f32_16x16x32_bf16 v[192:195], a[204:207], a[16:19], v[192:195]
    ds_read_b64_tr_b16 a[196:197], v11 offset:12288
    v_mfma_f32_16x16x32_bf16 v[200:203], a[204:207], a[20:23], 0
    s_waitcnt lgkmcnt(3)
    ds_read_b64_tr_b16 a[198:199], v11 offset:14336
    v_mfma_f32_16x16x32_bf16 v[200:203], a[200:203], a[4:7], v[200:203]
    buffer_load_dwordx4 v22, s[28:31], s41 offen lds
    v_mfma_f32_16x16x32_bf16 v[208:211], a[200:203], a[8:11], 0
    v_subrev_u32 v11, 139264, v11
    v_mfma_f32_16x16x32_bf16 v[208:211], a[204:207], a[24:27], v[208:211]
    v_mfma_f32_16x16x32_bf16 v[216:219], a[204:207], a[28:31], 0
    v_add_u32 v21, 61440, v14
    v_mfma_f32_16x16x32_bf16 v[216:219], a[200:203], a[12:15], v[216:219]
    v_mfma_f32_16x16x32_bf16 v[220:223], a[208:211], a[12:15], 0
    s_add_u32 m0, s43, 115712
    v_mfma_f32_16x16x32_bf16 v[220:223], a[212:215], a[28:31], v[220:223]
    s_waitcnt vmcnt(18) lgkmcnt(0)
    v_mfma_f32_16x16x32_bf16 v[212:215], a[212:215], a[24:27], 0
    s_barrier
    v_mfma_f32_16x16x32_bf16 v[212:215], a[208:211], a[8:11], v[212:215]
    s_add_u32 s43, s7, 1
    ds_read_b64_tr_b16 a[200:201], v12 offset:0
    v_mfma_f32_16x16x32_bf16 v[204:207], a[208:211], a[4:7], 0
    ds_read_b64_tr_b16 a[202:203], v12 offset:1024
    v_mfma_f32_16x16x32_bf16 v[204:207], a[212:215], a[20:23], v[204:207]
    ds_read_b64_tr_b16 a[204:205], v12 offset:2048
    v_mfma_f32_16x16x32_bf16 v[196:199], a[212:215], a[16:19], 0
    buffer_load_dwordx4 v23, s[28:31], s41 offen lds
    v_mfma_f32_16x16x32_bf16 v[196:199], a[208:211], a[0:3], v[196:199]
    s_add_u32 s28, s7, 1
    ds_read_b64_tr_b16 a[206:207], v12 offset:3072
    v_mfma_f32_16x16x32_bf16 v[224:227], a[184:187], a[0:3], 0
    s_add_u32 s29, s7, 1
    ds_read_b64_tr_b16 a[208:209], v13 offset:0
    v_mfma_f32_16x16x32_bf16 v[224:227], a[188:191], a[16:19], v[224:227]
    s_add_u32 s30, s7, 1
    ds_read_b64_tr_b16 a[210:211], v13 offset:1024
    v_mfma_f32_16x16x32_bf16 v[232:235], a[188:191], a[20:23], 0
    s_add_u32 s38, s45, 40960
    ds_read_b64_tr_b16 a[212:213], v13 offset:2048
    s_add_u32 s36, s44, 204800
    v_mfma_f32_16x16x32_bf16 v[232:235], a[184:187], a[4:7], v[232:235]
    s_cmp_lt_u32 s3, 2
    s_cselect_b32 s38, s38, s36
    v_mfma_f32_16x16x32_bf16 v[240:243], a[184:187], a[8:11], 0
    s_add_u32 m0, s63, 90112
    ds_read_b64_tr_b16 a[214:215], v13 offset:3072
    v_mfma_f32_16x16x32_bf16 v[240:243], a[188:191], a[24:27], v[240:243]
    s_add_u32 s31, s7, 1
    ds_read_b128 v[56:59], v21 offset:0
    v_mfma_f32_16x16x32_bf16 v[248:251], a[188:191], a[28:31], 0
    s_add_u32 s41, s7, 1
    ds_read_b128 v[60:63], v21 offset:1024
    v_mfma_f32_16x16x32_bf16 v[248:251], a[184:187], a[12:15], v[248:251]
    ds_read_b128 v[64:67], v21 offset:2048
    v_mfma_f32_16x16x32_bf16 v[252:255], a[192:195], a[12:15], 0
    s_waitcnt lgkmcnt(5)
    ds_read_b64_tr_b16 a[184:185], v8 offset:0
    v_mfma_f32_16x16x32_bf16 v[252:255], a[196:199], a[28:31], v[252:255]
    ds_read_b64_tr_b16 a[186:187], v8 offset:2048
    v_mfma_f32_16x16x32_bf16 v[244:247], a[196:199], a[24:27], 0
    buffer_load_dwordx4 v7, s[8:11], s38 offen lds
    v_mfma_f32_16x16x32_bf16 v[244:247], a[192:195], a[8:11], v[244:247]
    s_add_u32 s37, s60, 8192
    ds_read_b64_tr_b16 a[188:189], v8 offset:8192
    v_mfma_f32_16x16x32_bf16 v[236:239], a[192:195], a[4:7], 0
    ds_read_b64_tr_b16 a[190:191], v8 offset:10240
    v_mfma_f32_16x16x32_bf16 v[236:239], a[196:199], a[20:23], v[236:239]
    s_waitcnt lgkmcnt(5)
    ds_read_b128 v[68:71], v21 offset:3072
    v_add_f32 v56, v56, v60
    v_mfma_f32_16x16x32_bf16 v[228:231], a[196:199], a[16:19], 0
    s_add_u32 s38, s45, 40960
    ds_read_b128 v[72:75], v21 offset:4096
    v_add_f32 v57, v57, v61
    v_mfma_f32_16x16x32_bf16 v[228:231], a[192:195], a[0:3], v[228:231]
    s_waitcnt lgkmcnt(5)
    ds_read_b128 v[76:79], v21 offset:5120
    v_add_f32 v58, v58, v62
    v_mfma_f32_16x16x32_bf16 v[96:99], a[200:203], a[32:35], v[96:99]
    buffer_load_dwordx4 a[0:3], v14, s[20:23], s37 offen offset:0 sc1
    v_mfma_f32_16x16x32_bf16 v[96:99], a[204:207], a[48:51], v[96:99]
pg_12:
    s_cbranch_execz pg_16
    s_add_u32 m0, s63, 73728
    ds_read_b64_tr_b16 a[192:193], v9 offset:0
    v_add_f32 v59, v59, v63
    v_mfma_f32_16x16x32_bf16 v[104:107], a[204:207], a[52:55], v[104:107]
    ds_read_b64_tr_b16 a[194:195], v9 offset:2048
    v_add_f32 v56, v56, v64
    v_mfma_f32_16x16x32_bf16 v[104:107], a[200:203], a[36:39], v[104:107]
    ds_read_b64_tr_b16 a[196:197], v9 offset:8192
    v_add_f32 v57, v57, v65
    v_mfma_f32_16x16x32_bf16 v[112:115], a[200:203], a[40:43], v[112:115]
    s_waitcnt lgkmcnt(5)
    ds_read_b64_tr_b16 a[198:199], v9 offset:10240
    v_add_f32 v58, v58, v66
    v_mfma_f32_16x16x32_bf16 v[112:115], a[204:207], a[56:59], v[112:115]
    buffer_load_dwordx4 a[4:7], v14, s[20:23], s37 offen offset:1024 sc1
    v_mfma_f32_16x16x32_bf16 v[120:123], a[204:207], a[60:63], v[120:123]
    buffer_load_dwordx4 v2, s[8:11], s38 offen lds
    v_mfma_f32_16x16x32_bf16 v[120:123], a[200:203], a[44:47], v[120:123]
    ds_read_b128 v[80:83], v21 offset:6144
    v_add_f32 v59, v59, v67
    v_mfma_f32_16x16x32_bf16 v[124:127], a[208:211], a[44:47], v[124:127]
    ds_read_b128 v[84:87], v21 offset:7168
    v_add_f32 v56, v56, v68
    v_mfma_f32_16x16x32_bf16 v[124:127], a[212:215], a[60:63], v[124:127]
    s_waitcnt lgkmcnt(4)
    ds_read_b64_tr_b16 a[200:201], v10 offset:0
    v_add_f32 v57, v57, v69
    v_mfma_f32_16x16x32_bf16 v[116:119], a[212:215], a[56:59], v[116:119]
    buffer_load_dwordx4 a[8:11], v14, s[20:23], s37 offen offset:2048 sc1
    v_mfma_f32_16x16x32_bf16 v[116:119], a[208:211], a[40:43], v[116:119]
    s_add_u32 s38, s45, 40960
    ds_read_b64_tr_b16 a[202:203], v10 offset:2048
    v_add_f32 v58, v58, v70
    v_mfma_f32_16x16x32_bf16 v[108:111], a[208:211], a[36:39], v[108:111]
    s_add_u32 m0, s63, 77824
    ds_read_b64_tr_b16 a[204:205], v10 offset:8192
    v_add_f32 v59, v59, v71
    v_mfma_f32_16x16x32_bf16 v[108:111], a[212:215], a[52:55], v[108:111]
    ds_read_b64_tr_b16 a[206:207], v10 offset:10240
    v_add_f32 v56, v56, v72
    v_mfma_f32_16x16x32_bf16 v[100:103], a[212:215], a[48:51], v[100:103]
    ds_read_b128 v[88:91], v21 offset:8192
    v_add_f32 v57, v57, v73
    v_mfma_f32_16x16x32_bf16 v[100:103], a[208:211], a[32:35], v[100:103]
    buffer_load_dwordx4 a[12:15], v14, s[20:23], s37 offen offset:3072 sc1
    v_mfma_f32_16x16x32_bf16 v[128:131], a[184:187], a[32:35], v[128:131]
    s_add_u32 s37, s61, 8192
    ds_read_b128 v[92:95], v21 offset:9216
    v_add_f32 v58, v58, v74
    v_mfma_f32_16x16x32_bf16 v[128:131], a[188:191], a[48:51], v[128:131]
    ds_read_b64_tr_b16 a[208:209], v11 offset:0
    v_add_f32 v59, v59, v75
    v_mfma_f32_16x16x32_bf16 v[136:139], a[188:191], a[52:55], v[136:139]
    s_waitcnt lgkmcnt(5)
    ds_read_b64_tr_b16 a[210:211], v11 offset:2048
    v_add_f32 v56, v56, v76
    v_mfma_f32_16x16x32_bf16 v[136:139], a[184:187], a[36:39], v[136:139]
    buffer_load_dwordx4 v3, s[8:11], s38 offen lds
    v_mfma_f32_16x16x32_bf16 v[144:147], a[184:187], a[40:43], v[144:147]
    buffer_load_dwordx4 a[16:19], v14, s[20:23], s37 offen offset:0 sc1
    v_mfma_f32_16x16x32_bf16 v[144:147], a[188:191], a[56:59], v[144:147]
    s_add_u32 s77, s7, 4
    ds_read_b64_tr_b16 a[212:213], v11 offset:8192
    v_add_f32 v57, v57, v77
    v_mfma_f32_16x16x32_bf16 v[152:155], a[188:191], a[60:63], v[152:155]
    s_add_u32 s38, s44, 204800
    ds_read_b64_tr_b16 a[214:215], v11 offset:10240
    v_add_f32 v58, v58, v78
    v_mfma_f32_16x16x32_bf16 v[152:155], a[184:187], a[44:47], v[152:155]
    ds_read_b64_tr_b16 a[184:185], v8 offset:4096
    v_add_f32 v59, v59, v79
    v_mfma_f32_16x16x32_bf16 v[156:159], a[192:195], a[44:47], v[156:159]
    s_add_u32 m0, s63, 81920
    ds_read_b64_tr_b16 a[186:187], v8 offset:6144
    v_add_f32 v56, v56, v80
    v_mfma_f32_16x16x32_bf16 v[156:159], a[196:199], a[60:63], v[156:159]
    buffer_load_dwordx4 a[20:23], v14, s[20:23], s37 offen offset:1024 sc1
    v_mfma_f32_16x16x32_bf16 v[148:151], a[196:199], a[56:59], v[148:151]
    s_load_dwordx4 s[72:75], s[86:87], s5 glc
    ds_read_b64_tr_b16 a[188:189], v8 offset:12288
    v_add_f32 v57, v57, v81
    v_mfma_f32_16x16x32_bf16 v[148:151], a[192:195], a[40:43], v[148:151]
    s_waitcnt lgkmcnt(5)
    ds_read_b64_tr_b16 a[190:191], v8 offset:14336
    v_add_f32 v58, v58, v82
    v_mfma_f32_16x16x32_bf16 v[140:143], a[192:195], a[36:39], v[140:143]
    s_waitcnt vmcnt(11)
    v_add_f32 v59, v59, v83
    v_add_f32 v56, v56, v84
    v_mfma_f32_16x16x32_bf16 v[140:143], a[196:199], a[52:55], v[140:143]
    buffer_store_dword v4, v15, s[24:27], s76 offen sc1
    v_mfma_f32_16x16x32_bf16 v[132:135], a[196:199], a[48:51], v[132:135]
    buffer_load_dwordx4 a[24:27], v14, s[20:23], s37 offen offset:2048 sc1
    v_mfma_f32_16x16x32_bf16 v[132:135], a[192:195], a[32:35], v[132:135]
    buffer_load_dwordx4 v2, s[8:11], s38 offen lds
    v_mfma_f32_16x16x32_bf16 v[160:163], a[200:203], a[32:35], v[160:163]
    ds_read_b64_tr_b16 a[192:193], v9 offset:4096
    v_add_f32 v57, v57, v85
    v_mfma_f32_16x16x32_bf16 v[160:163], a[204:207], a[48:51], v[160:163]
    ds_read_b64_tr_b16 a[194:195], v9 offset:6144
    v_add_f32 v58, v58, v86
    v_mfma_f32_16x16x32_bf16 v[168:171], a[204:207], a[52:55], v[168:171]
    s_add_u32 s38, s44, 204800
    ds_read_b64_tr_b16 a[196:197], v9 offset:12288
    v_add_f32 v59, v59, v87
    v_mfma_f32_16x16x32_bf16 v[168:171], a[200:203], a[36:39], v[168:171]
    buffer_load_dwordx4 a[28:31], v14, s[20:23], s37 offen offset:3072 sc1
    v_mfma_f32_16x16x32_bf16 v[176:179], a[200:203], a[40:43], v[176:179]
    s_add_u32 m0, s63, 86016
    ds_read_b64_tr_b16 a[198:199], v9 offset:14336
    v_add_f32 v56, v56, v88
    v_mfma_f32_16x16x32_bf16 v[176:179], a[204:207], a[56:59], v[176:179]
    v_add_f32 v57, v57, v89
    v_add_f32 v58, v58, v90
    v_mfma_f32_16x16x32_bf16 v[184:187], a[204:207], a[60:63], v[184:187]
    s_waitcnt lgkmcnt(4)
    v_add_f32 v59, v59, v91
    v_add_f32 v56, v56, v92
    v_mfma_f32_16x16x32_bf16 v[184:187], a[200:203], a[44:47], v[184:187]
    ds_read_b64_tr_b16 a[200:201], v10 offset:4096
    v_add_f32 v57, v57, v93
    v_mfma_f32_16x16x32_bf16 v[188:191], a[208:211], a[44:47], v[188:191]
    ds_read_b64_tr_b16 a[202:203], v10 offset:6144
    v_add_f32 v58, v58, v94
    v_mfma_f32_16x16x32_bf16 v[188:191], a[212:215], a[60:63], v[188:191]
    ds_read_b64_tr_b16 a[204:205], v10 offset:12288
    v_add_f32 v59, v59, v95
    v_mfma_f32_16x16x32_bf16 v[180:183], a[212:215], a[56:59], v[180:183]
    buffer_load_dwordx4 v3, s[8:11], s38 offen lds
    v_mfma_f32_16x16x32_bf16 v[180:183], a[208:211], a[40:43], v[180:183]
    ds_read_b64_tr_b16 a[206:207], v10 offset:14336
    v_cvt_pk_bf16_f32 v56, v56, v56
    v_mfma_f32_16x16x32_bf16 v[172:175], a[208:211], a[36:39], v[172:175]
    v_and_b32 v56, 0xffff0000, v56
    v_cvt_pk_bf16_f32 v57, v57, v57
    v_mfma_f32_16x16x32_bf16 v[172:175], a[212:215], a[52:55], v[172:175]
    v_and_b32 v57, 0xffff0000, v57
    v_cvt_pk_bf16_f32 v58, v58, v58
    v_mfma_f32_16x16x32_bf16 v[164:167], a[212:215], a[48:51], v[164:167]
    s_add_u32 s38, s46, 40960
    v_and_b32 v58, 0xffff0000, v58
    v_cvt_pk_bf16_f32 v59, v59, v59
    v_mfma_f32_16x16x32_bf16 v[164:167], a[208:211], a[32:35], v[164:167]
    s_add_u32 s36, s47, 40960
    ds_read_b64_tr_b16 a[208:209], v11 offset:4096
    v_and_b32 v59, 0xffff0000, v59
    v_mfma_f32_16x16x32_bf16 v[192:195], a[184:187], a[32:35], v[192:195]
    s_cmp_lt_u32 s3, 2
    s_cselect_b32 s38, s38, s36
    v_mul_f32 v60, s92, v56
    v_mfma_f32_16x16x32_bf16 v[192:195], a[188:191], a[48:51], v[192:195]
    s_add_u32 m0, s63, 110592
    ds_read_b64_tr_b16 a[210:211], v11 offset:6144
    v_mul_f32 v61, s92, v57
    v_mfma_f32_16x16x32_bf16 v[200:203], a[188:191], a[52:55], v[200:203]
    ds_read_b64_tr_b16 a[212:213], v11 offset:12288
    v_lshlrev_b32 v64, 1, v1
    v_mfma_f32_16x16x32_bf16 v[200:203], a[184:187], a[36:39], v[200:203]
    s_waitcnt lgkmcnt(3)
    ds_read_b64_tr_b16 a[214:215], v11 offset:14336
    v_add_u32 v64, s56, v64
    v_mfma_f32_16x16x32_bf16 v[208:211], a[184:187], a[40:43], v[208:211]
    v_exp_f32 v60, v60
    v_mfma_f32_16x16x32_bf16 v[208:211], a[188:191], a[56:59], v[208:211]
    v_exp_f32 v61, v61
    v_mfma_f32_16x16x32_bf16 v[216:219], a[188:191], a[60:63], v[216:219]
    buffer_load_dwordx4 v7, s[8:11], s38 offen lds
    v_mfma_f32_16x16x32_bf16 v[216:219], a[184:187], a[44:47], v[216:219]
    v_add_f32 v60, 1.0, v60
    v_add_f32 v61, 1.0, v61
    v_mfma_f32_16x16x32_bf16 v[220:223], a[192:195], a[44:47], v[220:223]
    v_rcp_f32 v60, v60
    v_mfma_f32_16x16x32_bf16 v[220:223], a[196:199], a[60:63], v[220:223]
    s_waitcnt lgkmcnt(0)
    v_rcp_f32 v61, v61
    v_mfma_f32_16x16x32_bf16 v[212:215], a[196:199], a[56:59], v[212:215]
    s_barrier
    v_mfma_f32_16x16x32_bf16 v[212:215], a[192:195], a[40:43], v[212:215]
    s_add_u32 s38, s46, 40960
    ds_read_b64_tr_b16 a[184:185], v12 offset:20480
    v_mul_f32 v56, v56, v60
    v_mfma_f32_16x16x32_bf16 v[204:207], a[192:195], a[36:39], v[204:207]
    s_add_u32 m0, s63, 94208
    ds_read_b64_tr_b16 a[186:187], v12 offset:21504
    v_cvt_pk_bf16_f32 v56, v56, v56
    v_mfma_f32_16x16x32_bf16 v[204:207], a[196:199], a[52:55], v[204:207]
    s_mov_b32 s16, s84
    ds_read_b64_tr_b16 a[188:189], v12 offset:22528
    v_and_b32 v56, 0xffff0000, v56
    v_mfma_f32_16x16x32_bf16 v[196:199], a[196:199], a[48:51], v[196:199]
    s_and_b32 s17, s85, 0xffff
    ds_read_b64_tr_b16 a[190:191], v12 offset:23552
    v_mul_f32 v56, v56, v58
    v_mfma_f32_16x16x32_bf16 v[196:199], a[192:195], a[32:35], v[196:199]
    s_mov_b32 s18, 2621440
    ds_read_b64_tr_b16 a[192:193], v13 offset:20480
    v_mul_f32 v57, v57, v61
    v_mfma_f32_16x16x32_bf16 v[224:227], a[200:203], a[32:35], v[224:227]
    s_mov_b32 s19, 0x00020000
    ds_read_b64_tr_b16 a[194:195], v13 offset:21504
    v_cvt_pk_bf16_f32 v57, v57, v57
    v_mfma_f32_16x16x32_bf16 v[224:227], a[204:207], a[48:51], v[224:227]
    ds_read_b64_tr_b16 a[196:197], v13 offset:22528
    v_and_b32 v57, 0xffff0000, v57
    v_mfma_f32_16x16x32_bf16 v[232:235], a[204:207], a[52:55], v[232:235]
    buffer_load_dwordx4 v2, s[8:11], s38 offen lds
    v_mfma_f32_16x16x32_bf16 v[232:235], a[200:203], a[36:39], v[232:235]
    ds_read_b64_tr_b16 a[198:199], v13 offset:23552
    v_mul_f32 v57, v57, v59
    v_mfma_f32_16x16x32_bf16 v[240:243], a[200:203], a[40:43], v[240:243]
    v_cvt_pk_bf16_f32 v56, v56, v57
    v_and_b32 v65, 1, v1
    v_mfma_f32_16x16x32_bf16 v[240:243], a[204:207], a[56:59], v[240:243]
    ds_write_b16 v64, v56
    v_mfma_f32_16x16x32_bf16 v[248:251], a[204:207], a[60:63], v[248:251]
    ds_write_b16_d16_hi v64, v56 offset:128
    v_mfma_f32_16x16x32_bf16 v[248:251], a[200:203], a[44:47], v[248:251]
    s_add_u32 s38, s46, 40960
    ds_read_b64_tr_b16 a[200:201], v8 offset:20480
    v_lshlrev_b32 v65, 7, v65
    v_mfma_f32_16x16x32_bf16 v[252:255], a[208:211], a[44:47], v[252:255]
    s_waitcnt lgkmcnt(4)
    ds_read_b64_tr_b16 a[202:203], v8 offset:22528
    v_lshrrev_b32 v67, 4, v1
    v_mfma_f32_16x16x32_bf16 v[252:255], a[212:215], a[60:63], v[252:255]
    s_add_u32 m0, s63, 98304
    ds_read_b64_tr_b16 a[204:205], v8 offset:28672
    v_lshl_add_u32 v65, v67, 4, v65
    v_mfma_f32_16x16x32_bf16 v[244:247], a[212:215], a[56:59], v[244:247]
    s_sub_u32 s78, s72, s77
    ds_read_b64_tr_b16 a[206:207], v8 offset:30720
    v_add_u32 v65, s56, v65
    v_mfma_f32_16x16x32_bf16 v[244:247], a[208:211], a[40:43], v[244:247]
    s_sub_u32 s79, s73, s77
    ds_read_b128 v[68:71], v65
    v_bfe_u32 v67, v1, 2, 3
    v_mfma_f32_16x16x32_bf16 v[236:239], a[208:211], a[36:39], v[236:239]
    s_max_u32 s78, s78, s79
    ds_read_b128 v[72:75], v65 offset:64
    v_lshlrev_b32 v66, 7, v67
    v_mfma_f32_16x16x32_bf16 v[236:239], a[212:215], a[52:55], v[236:239]
    s_sub_u32 s79, s74, s77
    v_lshrrev_b32 v67, 1, v67
    v_xor_b32 v67, s3, v67
    v_mfma_f32_16x16x32_bf16 v[228:231], a[212:215], a[48:51], v[228:231]
    buffer_load_dwordx4 v3, s[8:11], s38 offen lds
    v_mfma_f32_16x16x32_bf16 v[228:231], a[208:211], a[32:35], v[228:231]
    s_max_u32 s78, s78, s79
    ds_read_b64_tr_b16 a[208:209], v9 offset:20480
    v_lshl_add_u32 v66, v67, 5, v66
    v_mfma_f32_16x16x32_bf16 v[96:99], a[184:187], a[64:67], v[96:99]
    s_sub_u32 s79, s75, s77
    ds_read_b64_tr_b16 a[210:211], v9 offset:22528
    v_and_b32 v67, 3, v1
    v_mfma_f32_16x16x32_bf16 v[96:99], a[188:191], a[216:219], v[96:99]
    s_waitcnt lgkmcnt(4)
    ds_read_b64_tr_b16 a[212:213], v9 offset:28672
    v_lshl_add_u32 v66, v67, 3, v66
    v_mfma_f32_16x16x32_bf16 v[104:107], a[188:191], a[220:223], v[104:107]
    s_max_u32 s78, s78, s79
    ds_read_b64_tr_b16 a[214:215], v9 offset:30720
    v_lshrrev_b32 v67, 5, v1
    v_mfma_f32_16x16x32_bf16 v[104:107], a[184:187], a[68:71], v[104:107]
    s_cmp_gt_u32 s78, 2
    s_cbranch_scc1 spin_o3
spin_o3_ret:
    v_mul_u32_u24 v67, 1024, v67
    v_mfma_f32_16x16x32_bf16 v[112:115], a[184:187], a[72:75], v[112:115]
    s_add_u32 s37, s59, 12288
    v_add_u32 v66, v66, v67
    v_add_u32 v66, 114688, v66
    v_mfma_f32_16x16x32_bf16 v[112:115], a[188:191], a[224:227], v[112:115]
    buffer_load_dwordx4 a[32:35], v14, s[20:23], s37 offen offset:0 sc1
    v_mfma_f32_16x16x32_bf16 v[120:123], a[188:191], a[228:231], v[120:123]
    buffer_load_dwordx4 a[36:39], v14, s[20:23], s37 offen offset:1024 sc1
    v_mfma_f32_16x16x32_bf16 v[120:123], a[184:187], a[76:79], v[120:123]
    s_add_u32 s38, s47, 40960
    ds_read_b64_tr_b16 a[184:185], v10 offset:20480
    v_lshlrev_b32 v62, 2, v1
    v_mfma_f32_16x16x32_bf16 v[124:127], a[192:195], a[76:79], v[124:127]
    s_add_u32 m0, s63, 102400
    ds_read_b64_tr_b16 a[186:187], v10 offset:22528
    v_mov_b32 v67, 0x7ffffff0
    v_mfma_f32_16x16x32_bf16 v[124:127], a[196:199], a[228:231], v[124:127]
    s_andn2_b32 s56, 0x70000000, s66
    ds_read_b64_tr_b16 a[188:189], v10 offset:28672
    v_cndmask_b32 v62, v67, v62, vcc
    v_mfma_f32_16x16x32_bf16 v[116:119], a[196:199], a[224:227], v[116:119]
    buffer_load_dwordx4 a[40:43], v14, s[20:23], s37 offen offset:2048 sc1
    v_mfma_f32_16x16x32_bf16 v[116:119], a[192:195], a[72:75], v[116:119]
    buffer_load_dwordx4 v2, s[8:11], s38 offen lds
    v_mfma_f32_16x16x32_bf16 v[108:111], a[192:195], a[68:71], v[108:111]
    ds_read_b64_tr_b16 a[190:191], v10 offset:30720
    v_and_b32 v5, 15, v1
    v_mfma_f32_16x16x32_bf16 v[108:111], a[196:199], a[220:223], v[108:111]
    v_add_u32 v5, s6, v5
    v_bfe_u32 v20, v1, 4, 1
    v_mfma_f32_16x16x32_bf16 v[100:103], a[196:199], a[216:219], v[100:103]
    s_add_u32 s38, s47, 40960
    v_bfe_u32 v21, v1, 5, 1
    v_lshl_add_u32 v20, v20, 1, v21
    v_mfma_f32_16x16x32_bf16 v[100:103], a[192:195], a[64:67], v[100:103]
    buffer_load_dwordx4 a[44:47], v14, s[20:23], s37 offen offset:3072 sc1
    v_mfma_f32_16x16x32_bf16 v[128:131], a[200:203], a[64:67], v[128:131]
    s_add_u32 s37, s60, 12288
    ds_read_b64_tr_b16 a[192:193], v11 offset:20480
    v_mul_u32_u24 v4, 1280, v5
    v_mfma_f32_16x16x32_bf16 v[128:131], a[204:207], a[216:219], v[128:131]
    s_waitcnt lgkmcnt(2)
    ds_read_b64_tr_b16 a[194:195], v11 offset:22528
    v_lshl_add_u32 v4, v20, 4, v4
    v_mfma_f32_16x16x32_bf16 v[136:139], a[204:207], a[220:223], v[136:139]
    s_add_u32 m0, s63, 106496
    ds_read_b64_tr_b16 a[196:197], v11 offset:28672
    v_lshlrev_b32 v20, 3, v5
    v_mfma_f32_16x16x32_bf16 v[136:139], a[200:203], a[68:71], v[136:139]
    ds_read_b64_tr_b16 a[198:199], v11 offset:30720
    v_add_u32 v20, 3211264, v20
    v_mfma_f32_16x16x32_bf16 v[144:147], a[200:203], a[72:75], v[144:147]
    buffer_load_dwordx4 a[48:51], v14, s[20:23], s37 offen offset:0 sc1
    v_mfma_f32_16x16x32_bf16 v[144:147], a[204:207], a[224:227], v[144:147]
    buffer_load_dwordx2 v[16:17], v20, s[24:27], 0 offen offset:0 sc1
    v_mfma_f32_16x16x32_bf16 v[152:155], a[204:207], a[228:231], v[152:155]
    buffer_load_dwordx4 v3, s[8:11], s38 offen lds
    v_mfma_f32_16x16x32_bf16 v[152:155], a[200:203], a[76:79], v[152:155]
    ds_read_b64_tr_b16 a[200:201], v8 offset:24576
    v_or_b32 v21, s56, v4
    v_mfma_f32_16x16x32_bf16 v[156:159], a[208:211], a[76:79], v[156:159]
    ds_read_b64_tr_b16 a[202:203], v8 offset:26624
    v_mfma_f32_16x16x32_bf16 v[156:159], a[212:215], a[228:231], v[156:159]
    buffer_load_dwordx4 a[52:55], v14, s[20:23], s37 offen offset:1024 sc1
    v_mfma_f32_16x16x32_bf16 v[148:151], a[212:215], a[224:227], v[148:151]
    s_add_u32 s38, s45, 81920
    ds_read_b64_tr_b16 a[204:205], v8 offset:32768
    s_add_u32 s36, s46, 81920
    v_mfma_f32_16x16x32_bf16 v[148:151], a[208:211], a[72:75], v[148:151]
    buffer_load_dwordx2 v[18:19], v20, s[24:27], 0 offen offset:128 sc1
    v_mfma_f32_16x16x32_bf16 v[140:143], a[208:211], a[68:71], v[140:143]
    s_cmp_lt_u32 s3, 2
    s_cselect_b32 s38, s38, s36
    s_add_u32 m0, s63, 139264
    v_mfma_f32_16x16x32_bf16 v[140:143], a[212:215], a[220:223], v[140:143]
    ds_read_b64_tr_b16 a[206:207], v8 offset:34816
    v_mfma_f32_16x16x32_bf16 v[132:135], a[212:215], a[216:219], v[132:135]
    buffer_load_dwordx4 a[56:59], v14, s[20:23], s37 offen offset:2048 sc1
    v_mfma_f32_16x16x32_bf16 v[132:135], a[208:211], a[64:67], v[132:135]
    s_waitcnt lgkmcnt(2)
    ds_read_b64_tr_b16 a[208:209], v9 offset:24576
    v_mfma_f32_16x16x32_bf16 v[160:163], a[184:187], a[64:67], v[160:163]
    ds_read_b64_tr_b16 a[210:211], v9 offset:26624
    v_mfma_f32_16x16x32_bf16 v[160:163], a[188:191], a[216:219], v[160:163]
    ds_read_b64_tr_b16 a[212:213], v9 offset:32768
    v_mfma_f32_16x16x32_bf16 v[168:171], a[188:191], a[220:223], v[168:171]
    buffer_load_dwordx4 v7, s[8:11], s38 offen lds
    v_mfma_f32_16x16x32_bf16 v[168:171], a[184:187], a[68:71], v[168:171]
    buffer_load_dwordx4 v[24:27], v4, s[12:15], s64 offen
    v_mfma_f32_16x16x32_bf16 v[176:179], a[184:187], a[72:75], v[176:179]
    buffer_load_dwordx4 a[60:63], v14, s[20:23], s37 offen offset:3072 sc1
    v_mfma_f32_16x16x32_bf16 v[176:179], a[188:191], a[224:227], v[176:179]
    ds_read_b64_tr_b16 a[214:215], v9 offset:34816
    v_mfma_f32_16x16x32_bf16 v[184:187], a[188:191], a[228:231], v[184:187]
    v_mfma_f32_16x16x32_bf16 v[184:187], a[184:187], a[76:79], v[184:187]
    ds_read_b64_tr_b16 a[184:185], v10 offset:24576
    v_mfma_f32_16x16x32_bf16 v[188:191], a[192:195], a[76:79], v[188:191]
    s_add_u32 s77, s7, 5
    ds_read_b64_tr_b16 a[186:187], v10 offset:26624
    v_mfma_f32_16x16x32_bf16 v[188:191], a[196:199], a[228:231], v[188:191]
    buffer_load_dwordx4 v[28:31], v4, s[12:15], s65 offen
    v_mfma_f32_16x16x32_bf16 v[180:183], a[196:199], a[224:227], v[180:183]
    ds_read_b64_tr_b16 a[188:189], v10 offset:32768
    v_mfma_f32_16x16x32_bf16 v[180:183], a[192:195], a[72:75], v[180:183]
    ds_read_b64_tr_b16 a[190:191], v10 offset:34816
    v_mfma_f32_16x16x32_bf16 v[172:175], a[192:195], a[68:71], v[172:175]
    s_load_dwordx4 s[72:75], s[86:87], s5 glc
    v_mfma_f32_16x16x32_bf16 v[172:175], a[196:199], a[220:223], v[172:175]
    v_mfma_f32_16x16x32_bf16 v[164:167], a[196:199], a[216:219], v[164:167]
    s_waitcnt lgkmcnt(3)
    s_add_u32 s38, s47, 81920
    s_add_u32 s36, s45, 122880
    v_mfma_f32_16x16x32_bf16 v[164:167], a[192:195], a[64:67], v[164:167]
    s_cmp_lt_u32 s3, 2
    s_cselect_b32 s38, s38, s36
    v_mfma_f32_16x16x32_bf16 v[192:195], a[200:203], a[64:67], v[192:195]
    buffer_load_dwordx4 v[32:35], v21, s[12:15], s68 offen
    v_mfma_f32_16x16x32_bf16 v[192:195], a[204:207], a[216:219], v[192:195]
    s_add_u32 m0, s63, 143360
    ds_read_b64_tr_b16 a[192:193], v11 offset:24576
    v_mfma_f32_16x16x32_bf16 v[200:203], a[204:207], a[220:223], v[200:203]
    ds_read_b64_tr_b16 a[194:195], v11 offset:26624
    ds_read_b64_tr_b16 a[196:197], v11 offset:32768
    v_mfma_f32_16x16x32_bf16 v[200:203], a[200:203], a[68:71], v[200:203]
    ds_read_b64_tr_b16 a[198:199], v11 offset:34816
    v_mfma_f32_16x16x32_bf16 v[208:211], a[200:203], a[72:75], v[208:211]
    v_mfma_f32_16x16x32_bf16 v[208:211], a[204:207], a[224:227], v[208:211]
    v_mfma_f32_16x16x32_bf16 v[216:219], a[204:207], a[228:231], v[216:219]
    buffer_load_dwordx4 v7, s[8:11], s38 offen lds
    v_mfma_f32_16x16x32_bf16 v[216:219], a[200:203], a[76:79], v[216:219]
    buffer_load_dwordx4 v[36:39], v21, s[12:15], s69 offen
    v_mfma_f32_16x16x32_bf16 v[220:223], a[208:211], a[76:79], v[220:223]
    v_mfma_f32_16x16x32_bf16 v[220:223], a[212:215], a[228:231], v[220:223]
    s_waitcnt vmcnt(35) lgkmcnt(0)
    v_mfma_f32_16x16x32_bf16 v[212:215], a[212:215], a[224:227], v[212:215]
    s_barrier
    v_mfma_f32_16x16x32_bf16 v[212:215], a[208:211], a[72:75], v[212:215]
    ds_read_b64_tr_b16 a[200:201], v12 offset:40960
    v_mfma_f32_16x16x32_bf16 v[204:207], a[208:211], a[68:71], v[204:207]
    ds_read_b64_tr_b16 a[202:203], v12 offset:41984
    v_mfma_f32_16x16x32_bf16 v[204:207], a[212:215], a[220:223], v[204:207]
    ds_read_b64_tr_b16 a[204:205], v12 offset:43008
    v_mfma_f32_16x16x32_bf16 v[196:199], a[212:215], a[216:219], v[196:199]
    ds_read_b64_tr_b16 a[206:207], v12 offset:44032
    v_mfma_f32_16x16x32_bf16 v[196:199], a[208:211], a[64:67], v[196:199]
    ds_read_b64_tr_b16 a[208:209], v13 offset:40960
    v_mfma_f32_16x16x32_bf16 v[224:227], a[184:187], a[64:67], v[224:227]
    ds_read_b64_tr_b16 a[210:211], v13 offset:41984
    v_mfma_f32_16x16x32_bf16 v[224:227], a[188:191], a[216:219], v[224:227]
    ds_read_b64_tr_b16 a[212:213], v13 offset:43008
    v_mfma_f32_16x16x32_bf16 v[232:235], a[188:191], a[220:223], v[232:235]
    s_add_u32 s38, s46, 122880
    ds_read_b64_tr_b16 a[214:215], v13 offset:44032
    s_add_u32 s36, s47, 122880
    v_mfma_f32_16x16x32_bf16 v[232:235], a[184:187], a[68:71], v[232:235]
    s_cmp_lt_u32 s3, 2
    s_cselect_b32 s38, s38, s36
    v_mfma_f32_16x16x32_bf16 v[240:243], a[184:187], a[72:75], v[240:243]
    s_add_u32 m0, s63, 147456
    v_add_u32 v12, 73728, v12
    v_mfma_f32_16x16x32_bf16 v[240:243], a[188:191], a[224:227], v[240:243]
    v_add_u32 v13, 73728, v13
    v_mfma_f32_16x16x32_bf16 v[248:251], a[188:191], a[228:231], v[248:251]
    v_mfma_f32_16x16x32_bf16 v[248:251], a[184:187], a[76:79], v[248:251]
    ds_read_b64_tr_b16 a[184:185], v8 offset:40960
    v_mfma_f32_16x16x32_bf16 v[252:255], a[192:195], a[76:79], v[252:255]
    ds_read_b64_tr_b16 a[186:187], v8 offset:43008
    v_mfma_f32_16x16x32_bf16 v[252:255], a[196:199], a[228:231], v[252:255]
    ds_read_b64_tr_b16 a[188:189], v8 offset:49152
    v_mfma_f32_16x16x32_bf16 v[244:247], a[196:199], a[224:227], v[244:247]
    s_waitcnt lgkmcnt(3)
    ds_read_b64_tr_b16 a[190:191], v8 offset:51200
    s_add_u32 s37, s61, 12288
    v_mfma_f32_16x16x32_bf16 v[244:247], a[192:195], a[72:75], v[244:247]
    buffer_load_dwordx4 v7, s[8:11], s38 offen lds
    v_mfma_f32_16x16x32_bf16 v[236:239], a[192:195], a[68:71], v[236:239]
    v_mfma_f32_16x16x32_bf16 v[236:239], a[196:199], a[220:223], v[236:239]
    v_mfma_f32_16x16x32_bf16 v[228:231], a[196:199], a[216:219], v[228:231]
    v_mfma_f32_16x16x32_bf16 v[228:231], a[192:195], a[64:67], v[228:231]
    ds_read_b64_tr_b16 a[192:193], v9 offset:40960
    v_mfma_f32_16x16x32_bf16 v[96:99], a[200:203], a[232:235], v[96:99]
    buffer_load_dwordx4 a[64:67], v14, s[20:23], s37 offen offset:0 sc1
    v_mfma_f32_16x16x32_bf16 v[96:99], a[204:207], a[152:155], v[96:99]
    ds_read_b64_tr_b16 a[194:195], v9 offset:43008
    v_mfma_f32_16x16x32_bf16 v[104:107], a[204:207], a[156:159], v[104:107]
    ds_read_b64_tr_b16 a[196:197], v9 offset:49152
    v_mfma_f32_16x16x32_bf16 v[104:107], a[200:203], a[236:239], v[104:107]
    ds_read_b64_tr_b16 a[198:199], v9 offset:51200
    v_mfma_f32_16x16x32_bf16 v[112:115], a[200:203], a[240:243], v[112:115]
    ds_read_b64_tr_b16 v[76:77], v66 offset:0
    v_mfma_f32_16x16x32_bf16 v[112:115], a[204:207], a[160:163], v[112:115]
    buffer_load_dwordx4 a[68:71], v14, s[20:23], s37 offen offset:1024 sc1
    v_mfma_f32_16x16x32_bf16 v[120:123], a[204:207], a[164:167], v[120:123]
    s_add_u32 s38, s45, 163840
    ds_read_b64_tr_b16 v[78:79], v66 offset:2048
    s_add_u32 s36, s46, 163840
    v_mfma_f32_16x16x32_bf16 v[120:123], a[200:203], a[244:247], v[120:123]
    s_cmp_lt_u32 s3, 2
    s_cselect_b32 s38, s38, s36
    v_mfma_f32_16x16x32_bf16 v[124:127], a[208:211], a[244:247], v[124:127]
    s_add_u32 m0, s63, 151552
    ds_read_b64_tr_b16 v[80:81], v66 offset:4096
    v_mfma_f32_16x16x32_bf16 v[124:127], a[212:215], a[164:167], v[124:127]
    s_waitcnt lgkmcnt(4)
    ds_read_b64_tr_b16 v[82:83], v66 offset:6144
    v_mfma_f32_16x16x32_bf16 v[116:119], a[212:215], a[160:163], v[116:119]
    buffer_load_dwordx4 a[72:75], v14, s[20:23], s37 offen offset:2048 sc1
    v_mfma_f32_16x16x32_bf16 v[116:119], a[208:211], a[240:243], v[116:119]
    s_sub_u32 s78, s72, s77
    ds_read_b64_tr_b16 a[200:201], v10 offset:40960
    s_sub_u32 s79, s73, s77
    v_mfma_f32_16x16x32_bf16 v[108:111], a[208:211], a[236:239], v[108:111]
    s_max_u32 s78, s78, s79
    ds_read_b64_tr_b16 a[202:203], v10 offset:43008
    s_sub_u32 s79, s74, s77
    v_mfma_f32_16x16x32_bf16 v[108:111], a[212:215], a[156:159], v[108:111]
    s_max_u32 s78, s78, s79
    ds_read_b64_tr_b16 a[204:205], v10 offset:49152
    s_sub_u32 s79, s75, s77
    v_mfma_f32_16x16x32_bf16 v[100:103], a[212:215], a[152:155], v[100:103]
    buffer_load_dwordx4 v7, s[8:11], s38 offen lds
    v_mfma_f32_16x16x32_bf16 v[100:103], a[208:211], a[232:235], v[100:103]
    buffer_load_dwordx4 a[76:79], v14, s[20:23], s37 offen offset:3072 sc1
    v_mfma_f32_16x16x32_bf16 v[128:131], a[184:187], a[232:235], v[128:131]
    s_max_u32 s78, s78, s79
    ds_read_b64_tr_b16 a[206:207], v10 offset:51200
    s_add_u32 s37, s59, 16384
    v_mfma_f32_16x16x32_bf16 v[128:131], a[188:191], a[152:155], v[128:131]
    s_cmp_gt_u32 s78, 1
    s_cbranch_scc1 spin_o4
spin_o4_ret:
    v_mfma_f32_16x16x32_bf16 v[136:139], a[188:191], a[156:159], v[136:139]
    ds_read_b64_tr_b16 a[208:209], v11 offset:40960
    v_mfma_f32_16x16x32_bf16 v[136:139], a[184:187], a[236:239], v[136:139]
    ds_read_b64_tr_b16 a[210:211], v11 offset:43008
    v_mfma_f32_16x16x32_bf16 v[144:147], a[184:187], a[240:243], v[144:147]
    s_waitcnt lgkmcnt(3)
    ds_read_b64_tr_b16 a[212:213], v11 offset:49152
    v_mfma_f32_16x16x32_bf16 v[144:147], a[188:191], a[160:163], v[144:147]
    buffer_load_dwordx4 a[216:219], v14, s[20:23], s37 offen offset:0 sc1
    v_mfma_f32_16x16x32_bf16 v[152:155], a[188:191], a[164:167], v[152:155]
    ds_read_b64_tr_b16 a[214:215], v11 offset:51200
    v_mfma_f32_16x16x32_bf16 v[152:155], a[184:187], a[244:247], v[152:155]
    ds_read_b64_tr_b16 a[184:185], v8 offset:45056
    v_mfma_f32_16x16x32_bf16 v[156:159], a[192:195], a[244:247], v[156:159]
    ds_read_b64_tr_b16 a[186:187], v8 offset:47104
    v_mfma_f32_16x16x32_bf16 v[156:159], a[196:199], a[164:167], v[156:159]
    buffer_load_dwordx4 a[220:223], v14, s[20:23], s37 offen offset:1024 sc1
    v_mfma_f32_16x16x32_bf16 v[148:151], a[196:199], a[160:163], v[148:151]
    s_add_u32 s38, s47, 163840
    ds_read_b64_tr_b16 a[188:189], v8 offset:53248
    s_add_u32 s36, s45, 204800
    v_mfma_f32_16x16x32_bf16 v[148:151], a[192:195], a[240:243], v[148:151]
    s_cmp_lt_u32 s3, 2
    s_cselect_b32 s38, s38, s36
    v_mfma_f32_16x16x32_bf16 v[140:143], a[192:195], a[236:239], v[140:143]
    s_add_u32 m0, s63, 155648
    ds_read_b64_tr_b16 a[190:191], v8 offset:55296
    v_mfma_f32_16x16x32_bf16 v[140:143], a[196:199], a[156:159], v[140:143]
    v_add_u32 v8, 73728, v8
    v_mfma_f32_16x16x32_bf16 v[132:135], a[196:199], a[152:155], v[132:135]
    buffer_load_dwordx4 a[224:227], v14, s[20:23], s37 offen offset:2048 sc1
    v_mfma_f32_16x16x32_bf16 v[132:135], a[192:195], a[232:235], v[132:135]
    ds_read_b64_tr_b16 a[192:193], v9 offset:45056
    v_mfma_f32_16x16x32_bf16 v[84:87], v[68:71], v[76:79], 0
    s_waitcnt lgkmcnt(3)
    ds_read_b64_tr_b16 a[194:195], v9 offset:47104
    v_mfma_f32_16x16x32_bf16 v[84:87], v[72:75], v[80:83], v[84:87]
    ds_read_b64_tr_b16 a[196:197], v9 offset:53248
    v_mfma_f32_16x16x32_bf16 v[160:163], a[200:203], a[232:235], v[160:163]
    buffer_load_dwordx4 v7, s[8:11], s38 offen lds
    v_mfma_f32_16x16x32_bf16 v[160:163], a[204:207], a[152:155], v[160:163]
    buffer_load_dwordx4 a[228:231], v14, s[20:23], s37 offen offset:3072 sc1
    v_mfma_f32_16x16x32_bf16 v[168:171], a[204:207], a[156:159], v[168:171]
    ds_read_b64_tr_b16 a[198:199], v9 offset:55296
    v_mfma_f32_16x16x32_bf16 v[168:171], a[200:203], a[236:239], v[168:171]
    buffer_store_dword v84, v62, s[24:27], s62 offen sc1
    v_mfma_f32_16x16x32_bf16 v[176:179], a[200:203], a[240:243], v[176:179]
    buffer_store_dword v85, v62, s[24:27], s62 offen offset:2560 sc1
    v_mfma_f32_16x16x32_bf16 v[176:179], a[204:207], a[160:163], v[176:179]
    v_add_u32 v9, 73728, v9
    v_mfma_f32_16x16x32_bf16 v[184:187], a[204:207], a[164:167], v[184:187]
    v_mfma_f32_16x16x32_bf16 v[184:187], a[200:203], a[244:247], v[184:187]
    ds_read_b64_tr_b16 a[200:201], v10 offset:45056
    v_mfma_f32_16x16x32_bf16 v[188:191], a[208:211], a[244:247], v[188:191]
    ds_read_b64_tr_b16 a[202:203], v10 offset:47104
    v_mfma_f32_16x16x32_bf16 v[188:191], a[212:215], a[164:167], v[188:191]
    ds_read_b64_tr_b16 a[204:205], v10 offset:53248
    v_mfma_f32_16x16x32_bf16 v[180:183], a[212:215], a[160:163], v[180:183]
    ds_read_b64_tr_b16 a[206:207], v10 offset:55296
    v_mfma_f32_16x16x32_bf16 v[180:183], a[208:211], a[240:243], v[180:183]
    v_add_u32 v10, 73728, v10
    v_mfma_f32_16x16x32_bf16 v[172:175], a[208:211], a[236:239], v[172:175]
    s_add_u32 s38, s46, 204800
    s_add_u32 s36, s47, 204800
    v_mfma_f32_16x16x32_bf16 v[172:175], a[212:215], a[156:159], v[172:175]
    s_cmp_lt_u32 s3, 2
    s_cselect_b32 s38, s38, s36
    v_mfma_f32_16x16x32_bf16 v[164:167], a[212:215], a[152:155], v[164:167]
    s_waitcnt lgkmcnt(3)
    s_add_u32 m0, s63, 159744
    v_mfma_f32_16x16x32_bf16 v[164:167], a[208:211], a[232:235], v[164:167]
    s_add_u32 s36, s7, 1
    ds_read_b64_tr_b16 a[208:209], v11 offset:45056
    v_mfma_f32_16x16x32_bf16 v[192:195], a[184:187], a[232:235], v[192:195]
    ds_read_b64_tr_b16 a[210:211], v11 offset:47104
    v_mfma_f32_16x16x32_bf16 v[192:195], a[188:191], a[152:155], v[192:195]
pg_13:
    s_cbranch_execz pg_back
    ds_read_b64_tr_b16 a[212:213], v11 offset:53248
    v_mfma_f32_16x16x32_bf16 v[200:203], a[188:191], a[156:159], v[200:203]
    ds_read_b64_tr_b16 a[214:215], v11 offset:55296
    v_mfma_f32_16x16x32_bf16 v[200:203], a[184:187], a[236:239], v[200:203]
    v_add_u32 v11, 73728, v11
    v_mfma_f32_16x16x32_bf16 v[208:211], a[184:187], a[240:243], v[208:211]
    buffer_load_dwordx4 v7, s[8:11], s38 offen lds
    v_mfma_f32_16x16x32_bf16 v[208:211], a[188:191], a[160:163], v[208:211]
    v_mfma_f32_16x16x32_bf16 v[216:219], a[188:191], a[164:167], v[216:219]
    v_mfma_f32_16x16x32_bf16 v[216:219], a[184:187], a[244:247], v[216:219]
    v_mfma_f32_16x16x32_bf16 v[220:223], a[192:195], a[244:247], v[220:223]
    v_mfma_f32_16x16x32_bf16 v[220:223], a[196:199], a[164:167], v[220:223]
    s_waitcnt vmcnt(35) lgkmcnt(0)
    v_mfma_f32_16x16x32_bf16 v[212:215], a[196:199], a[160:163], v[212:215]
    s_barrier
    v_mfma_f32_16x16x32_bf16 v[212:215], a[192:195], a[240:243], v[212:215]
    ds_read_b64_tr_b16 a[184:185], v12 offset:0
    v_mfma_f32_16x16x32_bf16 v[204:207], a[192:195], a[236:239], v[204:207]
    ds_read_b64_tr_b16 a[186:187], v12 offset:1024
    v_mfma_f32_16x16x32_bf16 v[204:207], a[196:199], a[156:159], v[204:207]
    ds_read_b64_tr_b16 a[188:189], v12 offset:2048
    v_mfma_f32_16x16x32_bf16 v[196:199], a[196:199], a[152:155], v[196:199]
    ds_read_b64_tr_b16 a[190:191], v12 offset:3072
    v_mfma_f32_16x16x32_bf16 v[196:199], a[192:195], a[232:235], v[196:199]
    s_waitcnt vmcnt(19)
    ds_read_b64_tr_b16 a[192:193], v13 offset:0
    v_mfma_f32_16x16x32_bf16 v[224:227], a[200:203], a[232:235], v[224:227]
    s_add_u32 s38, s45, 81920
    ds_read_b64_tr_b16 a[194:195], v13 offset:1024
    v_mfma_f32_16x16x32_bf16 v[224:227], a[204:207], a[152:155], v[224:227]
    ds_read_b64_tr_b16 a[196:197], v13 offset:2048
    v_mfma_f32_16x16x32_bf16 v[232:235], a[204:207], a[156:159], v[232:235]
    s_add_u32 m0, s63, 0
    ds_read_b64_tr_b16 a[198:199], v13 offset:3072
    v_mfma_f32_16x16x32_bf16 v[232:235], a[200:203], a[236:239], v[232:235]
    v_permlane16_swap_b32 v24, v26
    v_mfma_f32_16x16x32_bf16 v[240:243], a[200:203], a[240:243], v[240:243]
    v_permlane16_swap_b32 v25, v27
    v_mfma_f32_16x16x32_bf16 v[240:243], a[204:207], a[160:163], v[240:243]
    s_waitcnt vmcnt(17)
    v_lshlrev_b32 v20, 16, v24
    v_and_b32 v21, 0xffff0000, v24
    v_mfma_f32_16x16x32_bf16 v[248:251], a[204:207], a[164:167], v[248:251]
    v_sub_f32 v20, v20, v16
    v_sub_f32 v21, v21, v16
    v_mfma_f32_16x16x32_bf16 v[248:251], a[200:203], a[244:247], v[248:251]
    ds_read_b64_tr_b16 a[200:201], v8 offset:0
    v_cvt_pk_bf16_f32 v22, v20, v21
    v_mfma_f32_16x16x32_bf16 v[252:255], a[208:211], a[244:247], v[252:255]
    buffer_load_dwordx4 v2, s[8:11], s38 offen lds
    v_mfma_f32_16x16x32_bf16 v[252:255], a[212:215], a[164:167], v[252:255]
    ds_read_b64_tr_b16 a[202:203], v8 offset:2048
    v_lshlrev_b32 v20, 16, v22
    v_mfma_f32_16x16x32_bf16 v[244:247], a[212:215], a[160:163], v[244:247]
    s_add_u32 s37, s60, 16384
    ds_read_b64_tr_b16 a[204:205], v8 offset:8192
    v_and_b32 v21, 0xffff0000, v22
    v_mfma_f32_16x16x32_bf16 v[244:247], a[208:211], a[240:243], v[244:247]
    s_waitcnt lgkmcnt(3)
    ds_read_b64_tr_b16 a[206:207], v8 offset:10240
    v_mul_f32 v20, v20, v17
    v_mfma_f32_16x16x32_bf16 v[236:239], a[208:211], a[236:239], v[236:239]
    s_waitcnt vmcnt(17)
    v_mul_f32 v21, v21, v17
    v_cvt_pk_bf16_f32 v22, v20, v21
    v_mfma_f32_16x16x32_bf16 v[236:239], a[212:215], a[156:159], v[236:239]
    v_lshlrev_b32 v20, 16, v22
    v_and_b32 v21, 0xffff0000, v22
    v_mfma_f32_16x16x32_bf16 v[228:231], a[212:215], a[152:155], v[228:231]
    s_add_u32 s38, s46, 81920
    v_mul_f32 v23, s92, v20
    v_mul_f32 v92, s92, v21
    v_mfma_f32_16x16x32_bf16 v[228:231], a[208:211], a[232:235], v[228:231]
    ds_read_b64_tr_b16 a[208:209], v9 offset:0
    v_mfma_f32_16x16x32_bf16 v[96:99], a[184:187], a[168:171], v[96:99]
    buffer_load_dwordx4 a[232:235], v14, s[20:23], s37 offen offset:0 sc1
    v_mfma_f32_16x16x32_bf16 v[96:99], a[188:191], a[80:83], v[96:99]
    s_add_u32 m0, s63, 4096
    ds_read_b64_tr_b16 a[210:211], v9 offset:2048
    v_mfma_f32_16x16x32_bf16 v[104:107], a[188:191], a[84:87], v[104:107]
    ds_read_b64_tr_b16 a[212:213], v9 offset:8192
    v_mfma_f32_16x16x32_bf16 v[104:107], a[184:187], a[172:175], v[104:107]
    s_waitcnt vmcnt(16)
    ds_read_b64_tr_b16 a[214:215], v9 offset:10240
    v_mfma_f32_16x16x32_bf16 v[112:115], a[184:187], a[176:179], v[112:115]
    v_exp_f32 v23, v23
    v_mfma_f32_16x16x32_bf16 v[112:115], a[188:191], a[88:91], v[112:115]
    buffer_load_dwordx4 a[236:239], v14, s[20:23], s37 offen offset:1024 sc1
    v_mfma_f32_16x16x32_bf16 v[120:123], a[188:191], a[92:95], v[120:123]
    buffer_load_dwordx4 v2, s[8:11], s38 offen lds
    v_mfma_f32_16x16x32_bf16 v[120:123], a[184:187], a[180:183], v[120:123]
    ds_read_b64_tr_b16 a[184:185], v10 offset:0
    v_add_f32 v23, 1.0, v23
    v_mfma_f32_16x16x32_bf16 v[124:127], a[192:195], a[180:183], v[124:127]
    ds_read_b64_tr_b16 a[186:187], v10 offset:2048
    v_mfma_f32_16x16x32_bf16 v[124:127], a[196:199], a[92:95], v[124:127]
    ds_read_b64_tr_b16 a[188:189], v10 offset:8192
    v_mfma_f32_16x16x32_bf16 v[116:119], a[196:199], a[88:91], v[116:119]
    s_waitcnt lgkmcnt(3)
    ds_read_b64_tr_b16 a[190:191], v10 offset:10240
    v_mfma_f32_16x16x32_bf16 v[116:119], a[192:195], a[176:179], v[116:119]
    buffer_load_dwordx4 a[240:243], v14, s[20:23], s37 offen offset:2048 sc1
    v_mfma_f32_16x16x32_bf16 v[108:111], a[192:195], a[172:175], v[108:111]
    s_add_u32 s38, s47, 81920
    v_exp_f32 v92, v92
    v_mfma_f32_16x16x32_bf16 v[108:111], a[196:199], a[84:87], v[108:111]
    v_rcp_f32 v23, v23
    v_mfma_f32_16x16x32_bf16 v[100:103], a[196:199], a[80:83], v[100:103]
    s_add_u32 m0, s63, 8192
    v_add_f32 v92, 1.0, v92
    v_mul_f32 v20, v20, v23
    v_mfma_f32_16x16x32_bf16 v[100:103], a[192:195], a[168:171], v[100:103]
    buffer_load_dwordx4 a[244:247], v14, s[20:23], s37 offen offset:3072 sc1
    v_mfma_f32_16x16x32_bf16 v[128:131], a[200:203], a[168:171], v[128:131]
    s_add_u32 s37, s61, 16384
    ds_read_b64_tr_b16 a[192:193], v11 offset:0
    v_mfma_f32_16x16x32_bf16 v[128:131], a[204:207], a[80:83], v[128:131]
    ds_read_b64_tr_b16 a[194:195], v11 offset:2048
    v_mfma_f32_16x16x32_bf16 v[136:139], a[204:207], a[84:87], v[136:139]
    ds_read_b64_tr_b16 a[196:197], v11 offset:8192
    v_mfma_f32_16x16x32_bf16 v[136:139], a[200:203], a[172:175], v[136:139]
    ds_read_b64_tr_b16 a[198:199], v11 offset:10240
    v_mfma_f32_16x16x32_bf16 v[144:147], a[200:203], a[176:179], v[144:147]
    buffer_load_dwordx4 a[152:155], v14, s[20:23], s37 offen offset:0 sc1
    v_mfma_f32_16x16x32_bf16 v[144:147], a[204:207], a[88:91], v[144:147]
    buffer_load_dwordx4 v2, s[8:11], s38 offen lds
    v_mfma_f32_16x16x32_bf16 v[152:155], a[204:207], a[92:95], v[152:155]
    s_add_u32 s77, s7, 6
    v_rcp_f32 v92, v92
    v_mfma_f32_16x16x32_bf16 v[152:155], a[200:203], a[180:183], v[152:155]
    ds_read_b64_tr_b16 a[200:201], v8 offset:4096
    v_mul_f32 v21, v21, v92
    v_mfma_f32_16x16x32_bf16 v[156:159], a[208:211], a[180:183], v[156:159]
    s_load_dwordx4 s[72:75], s[86:87], s5 glc
    ds_read_b64_tr_b16 a[202:203], v8 offset:6144
    v_cvt_pk_bf16_f32 v40, v20, v21
    v_mfma_f32_16x16x32_bf16 v[156:159], a[212:215], a[92:95], v[156:159]
    buffer_load_dwordx4 a[156:159], v14, s[20:23], s37 offen offset:1024 sc1
    v_mfma_f32_16x16x32_bf16 v[148:151], a[212:215], a[88:91], v[148:151]
    s_add_u32 s38, s45, 122880
    ds_read_b64_tr_b16 a[204:205], v8 offset:12288
    v_lshlrev_b32 v20, 16, v25
    v_mfma_f32_16x16x32_bf16 v[148:151], a[208:211], a[176:179], v[148:151]
    s_waitcnt lgkmcnt(3)
    ds_read_b64_tr_b16 a[206:207], v8 offset:14336
    v_and_b32 v21, 0xffff0000, v25
    v_mfma_f32_16x16x32_bf16 v[140:143], a[208:211], a[172:175], v[140:143]
    s_add_u32 m0, s63, 12288
    v_sub_f32 v20, v20, v16
    v_sub_f32 v21, v21, v16
    v_mfma_f32_16x16x32_bf16 v[140:143], a[212:215], a[84:87], v[140:143]
    v_cvt_pk_bf16_f32 v22, v20, v21
    v_lshlrev_b32 v20, 16, v22
    v_mfma_f32_16x16x32_bf16 v[132:135], a[212:215], a[80:83], v[132:135]
    buffer_load_dwordx4 a[160:163], v14, s[20:23], s37 offen offset:2048 sc1
    v_mfma_f32_16x16x32_bf16 v[132:135], a[208:211], a[168:171], v[132:135]
    ds_read_b64_tr_b16 a[208:209], v9 offset:4096
    v_and_b32 v21, 0xffff0000, v22
    v_mfma_f32_16x16x32_bf16 v[160:163], a[184:187], a[168:171], v[160:163]
    ds_read_b64_tr_b16 a[210:211], v9 offset:6144
    v_mul_f32 v20, v20, v17
    v_mfma_f32_16x16x32_bf16 v[160:163], a[188:191], a[80:83], v[160:163]
    ds_read_b64_tr_b16 a[212:213], v9 offset:12288
    v_mul_f32 v21, v21, v17
    v_mfma_f32_16x16x32_bf16 v[168:171], a[188:191], a[84:87], v[168:171]
    buffer_load_dwordx4 v2, s[8:11], s38 offen lds
    v_mfma_f32_16x16x32_bf16 v[168:171], a[184:187], a[172:175], v[168:171]
    buffer_load_dwordx4 a[164:167], v14, s[20:23], s37 offen offset:3072 sc1
    v_mfma_f32_16x16x32_bf16 v[176:179], a[184:187], a[176:179], v[176:179]
    s_waitcnt vmcnt(13)
    ds_read_b64_tr_b16 a[214:215], v9 offset:14336
    v_cvt_pk_bf16_f32 v22, v20, v21
    v_mfma_f32_16x16x32_bf16 v[176:179], a[188:191], a[88:91], v[176:179]
    buffer_store_dword v6, v15, s[24:27], s4 offen offset:160 sc1
    v_mfma_f32_16x16x32_bf16 v[184:187], a[188:191], a[92:95], v[184:187]
    v_lshlrev_b32 v20, 16, v22
    v_and_b32 v21, 0xffff0000, v22
    v_mfma_f32_16x16x32_bf16 v[184:187], a[184:187], a[180:183], v[184:187]
    ds_read_b64_tr_b16 a[184:185], v10 offset:4096
    v_mul_f32 v23, s92, v20
    v_mfma_f32_16x16x32_bf16 v[188:191], a[192:195], a[180:183], v[188:191]
    s_add_u32 s38, s46, 122880
    ds_read_b64_tr_b16 a[186:187], v10 offset:6144
    v_mul_f32 v92, s92, v21
    v_mfma_f32_16x16x32_bf16 v[188:191], a[196:199], a[92:95], v[188:191]
    ds_read_b64_tr_b16 a[188:189], v10 offset:12288
    v_mfma_f32_16x16x32_bf16 v[180:183], a[196:199], a[88:91], v[180:183]
    s_waitcnt lgkmcnt(4)
    ds_read_b64_tr_b16 a[190:191], v10 offset:14336
    s_add_u32 m0, s63, 16384
    v_mfma_f32_16x16x32_bf16 v[180:183], a[192:195], a[176:179], v[180:183]
    v_exp_f32 v23, v23
    v_mfma_f32_16x16x32_bf16 v[172:175], a[192:195], a[172:175], v[172:175]
    v_exp_f32 v92, v92
    v_mfma_f32_16x16x32_bf16 v[172:175], a[196:199], a[84:87], v[172:175]
    v_add_f32 v23, 1.0, v23
    v_add_f32 v92, 1.0, v92
    v_mfma_f32_16x16x32_bf16 v[164:167], a[196:199], a[80:83], v[164:167]
    v_rcp_f32 v23, v23
    v_mfma_f32_16x16x32_bf16 v[164:167], a[192:195], a[168:171], v[164:167]
    ds_read_b64_tr_b16 a[192:193], v11 offset:4096
    v_mul_f32 v20, v20, v23
    v_mfma_f32_16x16x32_bf16 v[192:195], a[200:203], a[168:171], v[192:195]
    buffer_load_dwordx4 v2, s[8:11], s38 offen lds
    v_mfma_f32_16x16x32_bf16 v[192:195], a[204:207], a[80:83], v[192:195]
    ds_read_b64_tr_b16 a[194:195], v11 offset:6144
    v_mfma_f32_16x16x32_bf16 v[200:203], a[204:207], a[84:87], v[200:203]
    ds_read_b64_tr_b16 a[196:197], v11 offset:12288
    v_mfma_f32_16x16x32_bf16 v[200:203], a[200:203], a[172:175], v[200:203]
    ds_read_b64_tr_b16 a[198:199], v11 offset:14336
    v_mfma_f32_16x16x32_bf16 v[208:211], a[200:203], a[176:179], v[208:211]
    v_rcp_f32 v92, v92
    v_mfma_f32_16x16x32_bf16 v[208:211], a[204:207], a[88:91], v[208:211]
    v_mul_f32 v21, v21, v92
    v_cvt_pk_bf16_f32 v41, v20, v21
    v_mfma_f32_16x16x32_bf16 v[216:219], a[204:207], a[92:95], v[216:219]
    s_waitcnt lgkmcnt(3)
    v_lshlrev_b32 v20, 16, v26
    v_and_b32 v21, 0xffff0000, v26
    v_mfma_f32_16x16x32_bf16 v[216:219], a[200:203], a[180:183], v[216:219]
    s_add_u32 s38, s47, 122880
    v_sub_f32 v20, v20, v16
    v_sub_f32 v21, v21, v16
    v_mfma_f32_16x16x32_bf16 v[220:223], a[208:211], a[180:183], v[220:223]
    s_add_u32 m0, s63, 20480
    v_cvt_pk_bf16_f32 v22, v20, v21
    v_lshlrev_b32 v20, 16, v22
    v_mfma_f32_16x16x32_bf16 v[220:223], a[212:215], a[92:95], v[220:223]
    v_and_b32 v21, 0xffff0000, v22
    v_mul_f32 v20, v20, v17
    v_mfma_f32_16x16x32_bf16 v[212:215], a[212:215], a[88:91], v[212:215]
    s_barrier
    v_mfma_f32_16x16x32_bf16 v[212:215], a[208:211], a[176:179], v[212:215]
    ds_read_b64_tr_b16 a[200:201], v12 offset:20480
    v_mul_f32 v21, v21, v17
    v_mfma_f32_16x16x32_bf16 v[204:207], a[208:211], a[172:175], v[204:207]
    ds_read_b64_tr_b16 a[202:203], v12 offset:21504
    v_cvt_pk_bf16_f32 v22, v20, v21
    v_mfma_f32_16x16x32_bf16 v[204:207], a[212:215], a[84:87], v[204:207]
    ds_read_b64_tr_b16 a[204:205], v13 offset:20480
    v_lshlrev_b32 v20, 16, v22
    v_mfma_f32_16x16x32_bf16 v[196:199], a[212:215], a[80:83], v[196:199]
    buffer_load_dwordx4 v2, s[8:11], s38 offen lds
    v_mfma_f32_16x16x32_bf16 v[196:199], a[208:211], a[168:171], v[196:199]
    ds_read_b64_tr_b16 a[206:207], v13 offset:21504
    v_and_b32 v21, 0xffff0000, v22
    v_mfma_f32_16x16x32_bf16 v[224:227], a[184:187], a[168:171], v[224:227]
    ds_read_b64_tr_b16 a[208:209], v8 offset:20480
    v_mul_f32 v23, s92, v20
    v_mfma_f32_16x16x32_bf16 v[224:227], a[188:191], a[80:83], v[224:227]
    ds_read_b64_tr_b16 a[210:211], v8 offset:22528
    v_mul_f32 v92, s92, v21
    v_mfma_f32_16x16x32_bf16 v[232:235], a[188:191], a[84:87], v[232:235]
    ds_read_b64_tr_b16 a[212:213], v9 offset:20480
    v_mfma_f32_16x16x32_bf16 v[232:235], a[184:187], a[172:175], v[232:235]
    ds_read_b64_tr_b16 a[214:215], v9 offset:22528
    v_mfma_f32_16x16x32_bf16 v[240:243], a[184:187], a[176:179], v[240:243]
    s_waitcnt lgkmcnt(5)
    v_exp_f32 v23, v23
    v_mfma_f32_16x16x32_bf16 v[240:243], a[188:191], a[88:91], v[240:243]
    s_add_u32 s38, s45, 163840
    v_exp_f32 v92, v92
    v_mfma_f32_16x16x32_bf16 v[248:251], a[188:191], a[92:95], v[248:251]
    s_add_u32 m0, s63, 24576
    ds_read_b64_tr_b16 a[188:189], v11 offset:20480
    v_add_f32 v23, 1.0, v23
    v_mfma_f32_16x16x32_bf16 v[248:251], a[184:187], a[180:183], v[248:251]
    s_sub_u32 s78, s72, s77
    ds_read_b64_tr_b16 a[190:191], v11 offset:22528
    v_add_f32 v92, 1.0, v92
    v_mfma_f32_16x16x32_bf16 v[252:255], a[192:195], a[180:183], v[252:255]
    s_sub_u32 s79, s73, s77
    ds_read_b64_tr_b16 a[184:185], v10 offset:20480
    s_max_u32 s78, s78, s79
    v_mfma_f32_16x16x32_bf16 v[252:255], a[196:199], a[92:95], v[252:255]
    s_sub_u32 s79, s74, s77
    ds_read_b64_tr_b16 a[186:187], v10 offset:22528
    s_max_u32 s78, s78, s79
    v_mfma_f32_16x16x32_bf16 v[244:247], a[196:199], a[88:91], v[244:247]
    s_sub_u32 s79, s75, s77
    v_rcp_f32 v23, v23
    v_mfma_f32_16x16x32_bf16 v[244:247], a[192:195], a[176:179], v[244:247]
    s_max_u32 s78, s78, s79
    v_rcp_f32 v92, v92
    v_mfma_f32_16x16x32_bf16 v[236:239], a[192:195], a[172:175], v[236:239]
    buffer_load_dwordx4 v2, s[8:11], s38 offen lds
    v_mfma_f32_16x16x32_bf16 v[236:239], a[196:199], a[84:87], v[236:239]
    s_cmp_gt_u32 s78, 0
    s_cbranch_scc1 spin_o5
spin_o5_ret:
    v_mul_f32 v20, v20, v23
    v_mfma_f32_16x16x32_bf16 v[228:231], a[196:199], a[80:83], v[228:231]
    s_waitcnt lgkmcnt(2)
    v_mul_f32 v21, v21, v92
    v_cvt_pk_bf16_f32 v42, v20, v21
    v_mfma_f32_16x16x32_bf16 v[228:231], a[192:195], a[168:171], v[228:231]
    s_add_u32 s37, s59, 20480
    ds_read_b64_tr_b16 a[192:193], v8 offset:24576
    v_lshlrev_b32 v20, 16, v27
    v_mfma_f32_16x16x32_bf16 v[96:99], a[200:203], a[96:99], v[96:99]
    buffer_load_dwordx4 a[168:171], v14, s[20:23], s37 offen offset:0 sc1
    v_mfma_f32_16x16x32_bf16 v[100:103], a[204:207], a[96:99], v[100:103]
    ds_read_b64_tr_b16 a[194:195], v8 offset:26624
    v_and_b32 v21, 0xffff0000, v27
    v_mfma_f32_16x16x32_bf16 v[108:111], a[204:207], a[100:103], v[108:111]
    s_add_u32 s38, s46, 163840
    ds_read_b64_tr_b16 a[196:197], v9 offset:24576
    v_sub_f32 v20, v20, v16
    v_mfma_f32_16x16x32_bf16 v[104:107], a[200:203], a[100:103], v[104:107]
    ds_read_b64_tr_b16 a[198:199], v9 offset:26624
    v_sub_f32 v21, v21, v16
    v_mfma_f32_16x16x32_bf16 v[112:115], a[200:203], a[104:107], v[112:115]
    s_add_u32 m0, s63, 28672
    v_cvt_pk_bf16_f32 v22, v20, v21
    v_lshlrev_b32 v20, 16, v22
    v_mfma_f32_16x16x32_bf16 v[116:119], a[204:207], a[104:107], v[116:119]
    buffer_load_dwordx4 a[172:175], v14, s[20:23], s37 offen offset:1024 sc1
    v_mfma_f32_16x16x32_bf16 v[124:127], a[204:207], a[108:111], v[124:127]
    ds_read_b64_tr_b16 a[204:205], v11 offset:24576
    v_and_b32 v21, 0xffff0000, v22
    v_mfma_f32_16x16x32_bf16 v[120:123], a[200:203], a[108:111], v[120:123]
    ds_read_b64_tr_b16 a[206:207], v11 offset:26624
    v_mul_f32 v20, v20, v17
    v_mfma_f32_16x16x32_bf16 v[152:155], a[208:211], a[108:111], v[152:155]
    ds_read_b64_tr_b16 a[200:201], v10 offset:24576
    v_mul_f32 v21, v21, v17
    v_mfma_f32_16x16x32_bf16 v[156:159], a[212:215], a[108:111], v[156:159]
    ds_read_b64_tr_b16 a[202:203], v10 offset:26624
    v_cvt_pk_bf16_f32 v22, v20, v21
    v_mfma_f32_16x16x32_bf16 v[148:151], a[212:215], a[104:107], v[148:151]
    buffer_load_dwordx4 a[176:179], v14, s[20:23], s37 offen offset:2048 sc1
    v_mfma_f32_16x16x32_bf16 v[144:147], a[208:211], a[104:107], v[144:147]
    buffer_load_dwordx4 v2, s[8:11], s38 offen lds
    v_mfma_f32_16x16x32_bf16 v[136:139], a[208:211], a[100:103], v[136:139]
    v_lshlrev_b32 v20, 16, v22
    v_and_b32 v21, 0xffff0000, v22
    v_mfma_f32_16x16x32_bf16 v[140:143], a[212:215], a[100:103], v[140:143]
    s_waitcnt lgkmcnt(3)
    v_mul_f32 v23, s92, v20
    v_mul_f32 v92, s92, v21
    v_mfma_f32_16x16x32_bf16 v[132:135], a[212:215], a[96:99], v[132:135]
    ds_read_b64_tr_b16 a[212:213], v13 offset:22528
    v_mfma_f32_16x16x32_bf16 v[128:131], a[208:211], a[96:99], v[128:131]
    buffer_load_dwordx4 a[180:183], v14, s[20:23], s37 offen offset:3072 sc1
    v_mfma_f32_16x16x32_bf16 v[160:163], a[184:187], a[96:99], v[160:163]
    s_add_u32 s37, s60, 20480
    ds_read_b64_tr_b16 a[214:215], v13 offset:23552
    s_add_u32 s38, s47, 163840
    v_mfma_f32_16x16x32_bf16 v[164:167], a[188:191], a[96:99], v[164:167]
    ds_read_b64_tr_b16 a[208:209], v12 offset:22528
    v_mfma_f32_16x16x32_bf16 v[172:175], a[188:191], a[100:103], v[172:175]
    s_add_u32 m0, s63, 32768
    ds_read_b64_tr_b16 a[210:211], v12 offset:23552
    v_mfma_f32_16x16x32_bf16 v[168:171], a[184:187], a[100:103], v[168:171]
    v_exp_f32 v23, v23
    v_mfma_f32_16x16x32_bf16 v[176:179], a[184:187], a[104:107], v[176:179]
    buffer_load_dwordx4 a[80:83], v14, s[20:23], s37 offen offset:0 sc1
    v_mfma_f32_16x16x32_bf16 v[180:183], a[188:191], a[104:107], v[180:183]
    v_exp_f32 v92, v92
    v_mfma_f32_16x16x32_bf16 v[188:191], a[188:191], a[108:111], v[188:191]
    v_permlane16_swap_b32 v28, v30
    v_mfma_f32_16x16x32_bf16 v[184:187], a[184:187], a[108:111], v[184:187]
    ds_read_b64_tr_b16 a[184:185], v8 offset:28672
    v_add_f32 v23, 1.0, v23
    v_mfma_f32_16x16x32_bf16 v[216:219], a[192:195], a[108:111], v[216:219]
    buffer_load_dwordx4 v2, s[8:11], s38 offen lds
    v_mfma_f32_16x16x32_bf16 v[220:223], a[196:199], a[108:111], v[220:223]
    buffer_load_dwordx4 a[84:87], v14, s[20:23], s37 offen offset:1024 sc1
    v_mfma_f32_16x16x32_bf16 v[212:215], a[196:199], a[104:107], v[212:215]
    ds_read_b64_tr_b16 a[186:187], v8 offset:30720
    v_add_f32 v92, 1.0, v92
    v_mfma_f32_16x16x32_bf16 v[208:211], a[192:195], a[104:107], v[208:211]
    ds_read_b64_tr_b16 a[188:189], v9 offset:28672
    v_mfma_f32_16x16x32_bf16 v[200:203], a[192:195], a[100:103], v[200:203]
    ds_read_b64_tr_b16 a[190:191], v9 offset:30720
    v_mfma_f32_16x16x32_bf16 v[204:207], a[196:199], a[100:103], v[204:207]
    s_waitcnt lgkmcnt(4)
    v_rcp_f32 v23, v23
    v_mfma_f32_16x16x32_bf16 v[196:199], a[196:199], a[96:99], v[196:199]
    buffer_load_dwordx4 a[88:91], v14, s[20:23], s37 offen offset:2048 sc1
    v_mfma_f32_16x16x32_bf16 v[192:195], a[192:195], a[96:99], v[192:195]
    s_add_u32 s38, s45, 204800
    ds_read_b64_tr_b16 a[196:197], v11 offset:28672
    v_mul_f32 v20, v20, v23
    v_mfma_f32_16x16x32_bf16 v[224:227], a[200:203], a[96:99], v[224:227]
    s_add_u32 m0, s63, 36864
    ds_read_b64_tr_b16 a[198:199], v11 offset:30720
    v_mfma_f32_16x16x32_bf16 v[228:231], a[204:207], a[96:99], v[228:231]
    ds_read_b64_tr_b16 a[192:193], v10 offset:28672
    v_mfma_f32_16x16x32_bf16 v[236:239], a[204:207], a[100:103], v[236:239]
    ds_read_b64_tr_b16 a[194:195], v10 offset:30720
    v_mfma_f32_16x16x32_bf16 v[232:235], a[200:203], a[100:103], v[232:235]
    buffer_load_dwordx4 a[92:95], v14, s[20:23], s37 offen offset:3072 sc1
    v_mfma_f32_16x16x32_bf16 v[240:243], a[200:203], a[104:107], v[240:243]
    s_add_u32 s37, s61, 20480
    v_rcp_f32 v92, v92
    v_mfma_f32_16x16x32_bf16 v[244:247], a[204:207], a[104:107], v[244:247]
    v_permlane16_swap_b32 v29, v31
    v_mfma_f32_16x16x32_bf16 v[252:255], a[204:207], a[108:111], v[252:255]
    buffer_load_dwordx4 v2, s[8:11], s38 offen lds
    v_mfma_f32_16x16x32_bf16 v[248:251], a[200:203], a[108:111], v[248:251]
    ds_read_b64_tr_b16 a[200:201], v8 offset:32768
    v_mul_f32 v21, v21, v92
    v_mfma_f32_16x16x32_bf16 v[120:123], a[208:211], a[124:127], v[120:123]
    buffer_load_dwordx4 a[96:99], v14, s[20:23], s37 offen offset:0 sc1
    v_mfma_f32_16x16x32_bf16 v[124:127], a[212:215], a[124:127], v[124:127]
    ds_read_b64_tr_b16 a[202:203], v8 offset:34816
    v_cvt_pk_bf16_f32 v43, v20, v21
    v_mfma_f32_16x16x32_bf16 v[116:119], a[212:215], a[120:123], v[116:119]
    ds_read_b64_tr_b16 a[204:205], v9 offset:32768
    v_lshlrev_b32 v20, 16, v28
    v_mfma_f32_16x16x32_bf16 v[112:115], a[208:211], a[120:123], v[112:115]
    s_waitcnt lgkmcnt(3)
    ds_read_b64_tr_b16 a[206:207], v9 offset:34816
    v_and_b32 v21, 0xffff0000, v28
    v_mfma_f32_16x16x32_bf16 v[104:107], a[208:211], a[116:119], v[104:107]
    s_add_u32 s38, s46, 204800
    v_sub_f32 v20, v20, v18
    v_sub_f32 v21, v21, v18
    v_mfma_f32_16x16x32_bf16 v[108:111], a[212:215], a[116:119], v[108:111]
    buffer_load_dwordx4 a[100:103], v14, s[20:23], s37 offen offset:1024 sc1
    v_mfma_f32_16x16x32_bf16 v[100:103], a[212:215], a[112:115], v[100:103]
    s_add_u32 m0, s63, 40960
    ds_read_b64_tr_b16 a[212:213], v11 offset:32768
    v_cvt_pk_bf16_f32 v22, v20, v21
    v_mfma_f32_16x16x32_bf16 v[96:99], a[208:211], a[112:115], v[96:99]
    ds_read_b64_tr_b16 a[214:215], v11 offset:34816
    v_lshlrev_b32 v20, 16, v22
    v_mfma_f32_16x16x32_bf16 v[128:131], a[184:187], a[112:115], v[128:131]
    ds_read_b64_tr_b16 a[208:209], v10 offset:32768
    v_and_b32 v21, 0xffff0000, v22
    v_mfma_f32_16x16x32_bf16 v[132:135], a[188:191], a[112:115], v[132:135]
    ds_read_b64_tr_b16 a[210:211], v10 offset:34816
    v_mul_f32 v20, v20, v19
    v_mfma_f32_16x16x32_bf16 v[140:143], a[188:191], a[116:119], v[140:143]
    buffer_load_dwordx4 a[104:107], v14, s[20:23], s37 offen offset:2048 sc1
    v_mfma_f32_16x16x32_bf16 v[136:139], a[184:187], a[116:119], v[136:139]
    v_mul_f32 v21, v21, v19
    v_cvt_pk_bf16_f32 v22, v20, v21
    v_mfma_f32_16x16x32_bf16 v[144:147], a[184:187], a[120:123], v[144:147]
    buffer_load_dwordx4 v2, s[8:11], s38 offen lds
    v_mfma_f32_16x16x32_bf16 v[148:151], a[188:191], a[120:123], v[148:151]
    v_lshlrev_b32 v20, 16, v22
    v_and_b32 v21, 0xffff0000, v22
    v_mfma_f32_16x16x32_bf16 v[156:159], a[188:191], a[124:127], v[156:159]
    v_mul_f32 v23, s92, v20
    v_mul_f32 v92, s92, v21
    v_mfma_f32_16x16x32_bf16 v[152:155], a[184:187], a[124:127], v[152:155]
    buffer_load_dwordx4 a[108:111], v14, s[20:23], s37 offen offset:3072 sc1
    v_mfma_f32_16x16x32_bf16 v[184:187], a[192:195], a[124:127], v[184:187]
    v_exp_f32 v23, v23
    v_mfma_f32_16x16x32_bf16 v[188:191], a[196:199], a[124:127], v[188:191]
    s_waitcnt vmcnt(32) lgkmcnt(0)
    v_exp_f32 v92, v92
    v_mfma_f32_16x16x32_bf16 v[180:183], a[196:199], a[120:123], v[180:183]
    s_barrier
    v_mfma_f32_16x16x32_bf16 v[176:179], a[192:195], a[120:123], v[176:179]
    s_add_u32 s38, s47, 204800
    ds_read_b64_tr_b16 a[184:185], v12 offset:49152
    v_add_f32 v23, 1.0, v23
    v_mfma_f32_16x16x32_bf16 v[168:171], a[192:195], a[116:119], v[168:171]
    s_add_u32 m0, s63, 45056
    ds_read_b64_tr_b16 a[186:187], v12 offset:50176
    v_add_f32 v92, 1.0, v92
    v_mfma_f32_16x16x32_bf16 v[172:175], a[196:199], a[116:119], v[172:175]
    ds_read_b64_tr_b16 a[188:189], v12 offset:51200
    v_mfma_f32_16x16x32_bf16 v[164:167], a[196:199], a[112:115], v[164:167]
    ds_read_b64_tr_b16 a[190:191], v12 offset:52224
    v_mfma_f32_16x16x32_bf16 v[160:163], a[192:195], a[112:115], v[160:163]
    ds_read_b64_tr_b16 a[192:193], v13 offset:49152
    v_mfma_f32_16x16x32_bf16 v[192:195], a[200:203], a[112:115], v[192:195]
    ds_read_b64_tr_b16 a[194:195], v13 offset:50176
    v_mfma_f32_16x16x32_bf16 v[196:199], a[204:207], a[112:115], v[196:199]
    ds_read_b64_tr_b16 a[196:197], v13 offset:51200
    v_mfma_f32_16x16x32_bf16 v[204:207], a[204:207], a[116:119], v[204:207]
    buffer_load_dwordx4 v2, s[8:11], s38 offen lds
    v_mfma_f32_16x16x32_bf16 v[200:203], a[200:203], a[116:119], v[200:203]
    ds_read_b64_tr_b16 a[198:199], v13 offset:52224
    v_mfma_f32_16x16x32_bf16 v[208:211], a[200:203], a[120:123], v[208:211]
    v_rcp_f32 v23, v23
    v_mfma_f32_16x16x32_bf16 v[212:215], a[204:207], a[120:123], v[212:215]
    v_rcp_f32 v92, v92
    v_mfma_f32_16x16x32_bf16 v[220:223], a[204:207], a[124:127], v[220:223]
    v_mul_f32 v20, v20, v23
    v_mul_f32 v21, v21, v92
    v_mfma_f32_16x16x32_bf16 v[216:219], a[200:203], a[124:127], v[216:219]
    ds_read_b64_tr_b16 a[200:201], v12 offset:53248
    v_cvt_pk_bf16_f32 v44, v20, v21
    v_mfma_f32_16x16x32_bf16 v[248:251], a[208:211], a[124:127], v[248:251]
    ds_read_b64_tr_b16 a[202:203], v12 offset:54272
    v_lshlrev_b32 v20, 16, v29
    v_mfma_f32_16x16x32_bf16 v[252:255], a[212:215], a[124:127], v[252:255]
    ds_read_b64_tr_b16 a[204:205], v12 offset:55296
    v_and_b32 v21, 0xffff0000, v29
    v_mfma_f32_16x16x32_bf16 v[244:247], a[212:215], a[120:123], v[244:247]
    s_waitcnt lgkmcnt(3)
    ds_read_b64_tr_b16 a[206:207], v12 offset:56320
    v_sub_f32 v20, v20, v18
    v_mfma_f32_16x16x32_bf16 v[240:243], a[208:211], a[120:123], v[240:243]
    v_sub_f32 v21, v21, v18
    v_cvt_pk_bf16_f32 v22, v20, v21
    v_mfma_f32_16x16x32_bf16 v[232:235], a[208:211], a[116:119], v[232:235]
    v_lshlrev_b32 v20, 16, v22
    v_and_b32 v21, 0xffff0000, v22
    v_mfma_f32_16x16x32_bf16 v[236:239], a[212:215], a[116:119], v[236:239]
    v_mul_f32 v20, v20, v19
    v_mul_f32 v21, v21, v19
    v_mfma_f32_16x16x32_bf16 v[228:231], a[212:215], a[112:115], v[228:231]
    v_cvt_pk_bf16_f32 v22, v20, v21
    v_lshlrev_b32 v20, 16, v22
    v_mfma_f32_16x16x32_bf16 v[224:227], a[208:211], a[112:115], v[224:227]
    ds_read_b64_tr_b16 a[208:209], v13 offset:53248
    v_and_b32 v21, 0xffff0000, v22
    v_mfma_f32_16x16x32_bf16 v[96:99], a[184:187], a[128:131], v[96:99]
    ds_read_b64_tr_b16 a[210:211], v13 offset:54272
    v_mul_f32 v23, s92, v20
    v_mfma_f32_16x16x32_bf16 v[96:99], a[188:191], a[0:3], v[96:99]
    ds_read_b64_tr_b16 a[212:213], v13 offset:55296
    v_mul_f32 v92, s92, v21
    v_mfma_f32_16x16x32_bf16 v[104:107], a[188:191], a[4:7], v[104:107]
    ds_read_b64_tr_b16 a[214:215], v13 offset:56320
    v_mfma_f32_16x16x32_bf16 v[104:107], a[184:187], a[132:135], v[104:107]
    v_exp_f32 v23, v23
    v_mfma_f32_16x16x32_bf16 v[112:115], a[184:187], a[136:139], v[112:115]
    v_exp_f32 v92, v92
    v_mfma_f32_16x16x32_bf16 v[112:115], a[188:191], a[8:11], v[112:115]
    v_add_f32 v23, 1.0, v23
    v_add_f32 v92, 1.0, v92
    v_mfma_f32_16x16x32_bf16 v[120:123], a[188:191], a[12:15], v[120:123]
    v_rcp_f32 v23, v23
    v_mfma_f32_16x16x32_bf16 v[120:123], a[184:187], a[140:143], v[120:123]
    ds_read_b64_tr_b16 a[184:185], v12 offset:57344
    v_mul_f32 v20, v20, v23
    v_mfma_f32_16x16x32_bf16 v[124:127], a[192:195], a[140:143], v[124:127]
    ds_read_b64_tr_b16 a[186:187], v12 offset:58368
    v_mfma_f32_16x16x32_bf16 v[124:127], a[196:199], a[12:15], v[124:127]
    ds_read_b64_tr_b16 a[188:189], v12 offset:59392
    v_mfma_f32_16x16x32_bf16 v[116:119], a[196:199], a[8:11], v[116:119]
    s_waitcnt lgkmcnt(3)
    ds_read_b64_tr_b16 a[190:191], v12 offset:60416
    s_add_u32 s38, s45, 81920
    v_mfma_f32_16x16x32_bf16 v[116:119], a[192:195], a[136:139], v[116:119]
    s_mul_i32 s60, s54, 20
    v_rcp_f32 v92, v92
    v_mfma_f32_16x16x32_bf16 v[108:111], a[192:195], a[132:135], v[108:111]
    s_add_u32 m0, s63, 135168
    v_mul_f32 v21, v21, v92
    v_cvt_pk_bf16_f32 v45, v20, v21
    v_mfma_f32_16x16x32_bf16 v[108:111], a[196:199], a[4:7], v[108:111]
    s_mul_i32 s56, s51, 5
    v_lshlrev_b32 v20, 16, v30
    v_and_b32 v21, 0xffff0000, v30
    v_mfma_f32_16x16x32_bf16 v[100:103], a[196:199], a[0:3], v[100:103]
    s_add_u32 s60, s60, s56
    v_sub_f32 v20, v20, v18
    v_sub_f32 v21, v21, v18
    v_mfma_f32_16x16x32_bf16 v[100:103], a[192:195], a[128:131], v[100:103]
    s_lshl_b32 s60, s60, 1
    ds_read_b64_tr_b16 a[192:193], v13 offset:57344
    v_cvt_pk_bf16_f32 v22, v20, v21
    v_mfma_f32_16x16x32_bf16 v[96:99], a[200:203], a[16:19], v[96:99]
    s_and_b32 s56, s53, 1
    ds_read_b64_tr_b16 a[194:195], v13 offset:58368
    v_lshlrev_b32 v20, 16, v22
    v_mfma_f32_16x16x32_bf16 v[96:99], a[204:207], a[32:35], v[96:99]
    s_add_u32 s60, s60, s56
    ds_read_b64_tr_b16 a[196:197], v13 offset:59392
    v_and_b32 v21, 0xffff0000, v22
    v_mfma_f32_16x16x32_bf16 v[104:107], a[204:207], a[36:39], v[104:107]
    buffer_load_dwordx4 v3, s[8:11], s38 offen lds
    v_mfma_f32_16x16x32_bf16 v[104:107], a[200:203], a[20:23], v[104:107]
    s_lshl_b32 s60, s60, 11
    ds_read_b64_tr_b16 a[198:199], v13 offset:60416
    v_mul_f32 v20, v20, v19
    v_mfma_f32_16x16x32_bf16 v[112:115], a[200:203], a[24:27], v[112:115]
    s_add_u32 s37, s60, 50331648
    v_mul_f32 v21, v21, v19
    v_cvt_pk_bf16_f32 v22, v20, v21
    v_mfma_f32_16x16x32_bf16 v[112:115], a[204:207], a[40:43], v[112:115]
    s_xor_b32 s59, s60, 2048
    v_lshlrev_b32 v20, 16, v22
    v_and_b32 v21, 0xffff0000, v22
    v_mfma_f32_16x16x32_bf16 v[120:123], a[204:207], a[44:47], v[120:123]
    s_add_u32 s38, s46, 81920
    v_mul_f32 v23, s92, v20
    v_mul_f32 v92, s92, v21
    v_mfma_f32_16x16x32_bf16 v[120:123], a[200:203], a[28:31], v[120:123]
    s_mul_i32 s57, s53, 2622464
    ds_read_b64_tr_b16 a[200:201], v12 offset:61440
    v_mfma_f32_16x16x32_bf16 v[124:127], a[208:211], a[28:31], v[124:127]
pg_14:
    s_cbranch_execz pg_back
    s_add_u32 m0, s63, 131072
    ds_read_b64_tr_b16 a[202:203], v12 offset:62464
    v_mfma_f32_16x16x32_bf16 v[124:127], a[212:215], a[44:47], v[124:127]
    s_add_u32 s57, s57, 50331648
    ds_read_b64_tr_b16 a[204:205], v12 offset:63488
    v_mfma_f32_16x16x32_bf16 v[116:119], a[212:215], a[40:43], v[116:119]
    s_waitcnt lgkmcnt(3)
    ds_read_b64_tr_b16 a[206:207], v12 offset:64512
    v_add_u32 v12, 65536, v12
    v_mfma_f32_16x16x32_bf16 v[116:119], a[208:211], a[24:27], v[116:119]
    s_add_u32 s59, s59, s57
    v_exp_f32 v23, v23
    v_mfma_f32_16x16x32_bf16 v[108:111], a[208:211], a[20:23], v[108:111]
    s_add_u32 s60, s60, s57
    v_exp_f32 v92, v92
    v_mfma_f32_16x16x32_bf16 v[108:111], a[212:215], a[36:39], v[108:111]
    s_andn2_b32 s61, s2, 7
    v_add_f32 v23, 1.0, v23
    v_add_f32 v92, 1.0, v92
    v_mfma_f32_16x16x32_bf16 v[100:103], a[212:215], a[32:35], v[100:103]
    buffer_load_dwordx4 v3, s[8:11], s38 offen lds
    v_mfma_f32_16x16x32_bf16 v[100:103], a[208:211], a[16:19], v[100:103]
    s_lshl_b32 s61, s61, 2
    ds_read_b64_tr_b16 a[208:209], v13 offset:61440
    v_mfma_f32_16x16x32_bf16 v[96:99], a[184:187], a[48:51], v[96:99]
    s_add_u32 s61, s61, s3
    ds_read_b64_tr_b16 a[210:211], v13 offset:62464
    v_mfma_f32_16x16x32_bf16 v[96:99], a[188:191], a[64:67], v[96:99]
    s_lshl_b32 s61, s61, 7
    ds_read_b64_tr_b16 a[212:213], v13 offset:63488
    v_mfma_f32_16x16x32_bf16 v[104:107], a[188:191], a[68:71], v[104:107]
    s_add_u32 s38, s47, 81920
    ds_read_b64_tr_b16 a[214:215], v13 offset:64512
    v_xor_b32 v7, s56, v1
    v_mfma_f32_16x16x32_bf16 v[104:107], a[184:187], a[52:55], v[104:107]
    s_add_u32 s61, s61, 4194304
    v_rcp_f32 v23, v23
    v_mfma_f32_16x16x32_bf16 v[112:115], a[184:187], a[56:59], v[112:115]
    s_add_u32 m0, s63, 126976
    v_rcp_f32 v92, v92
    v_mfma_f32_16x16x32_bf16 v[112:115], a[188:191], a[72:75], v[112:115]
    v_mul_f32 v20, v20, v23
    v_mul_f32 v21, v21, v92
    v_mfma_f32_16x16x32_bf16 v[120:123], a[188:191], a[76:79], v[120:123]
    v_cvt_pk_bf16_f32 v46, v20, v21
    v_lshlrev_b32 v20, 16, v31
    v_mfma_f32_16x16x32_bf16 v[120:123], a[184:187], a[60:63], v[120:123]
    ds_read_b64_tr_b16 a[184:185], v12 offset:0
    v_and_b32 v21, 0xffff0000, v31
    v_mfma_f32_16x16x32_bf16 v[124:127], a[192:195], a[60:63], v[124:127]
    ds_read_b64_tr_b16 a[186:187], v12 offset:1024
    v_sub_f32 v20, v20, v18
    v_mfma_f32_16x16x32_bf16 v[124:127], a[196:199], a[76:79], v[124:127]
    ds_read_b64_tr_b16 a[188:189], v12 offset:2048
    v_sub_f32 v21, v21, v18
    v_mfma_f32_16x16x32_bf16 v[116:119], a[196:199], a[72:75], v[116:119]
    s_waitcnt lgkmcnt(3)
    ds_read_b64_tr_b16 a[190:191], v12 offset:3072
    v_cvt_pk_bf16_f32 v22, v20, v21
    v_mfma_f32_16x16x32_bf16 v[116:119], a[192:195], a[56:59], v[116:119]
    buffer_load_dwordx4 v3, s[8:11], s38 offen lds
    v_mfma_f32_16x16x32_bf16 v[108:111], a[192:195], a[52:55], v[108:111]
    v_lshlrev_b32 v20, 16, v22
    v_and_b32 v21, 0xffff0000, v22
    v_mfma_f32_16x16x32_bf16 v[108:111], a[196:199], a[68:71], v[108:111]
    v_mul_f32 v20, v20, v19
    v_mul_f32 v21, v21, v19
    v_mfma_f32_16x16x32_bf16 v[100:103], a[196:199], a[64:67], v[100:103]
    s_waitcnt vmcnt(34)
    v_cvt_pk_bf16_f32 v22, v20, v21
    v_lshlrev_b32 v20, 16, v22
    v_mfma_f32_16x16x32_bf16 v[100:103], a[192:195], a[48:51], v[100:103]
    s_waitcnt vmcnt(33)
    v_and_b32 v21, 0xffff0000, v22
    v_mul_f32 v23, s92, v20
    v_mfma_f32_16x16x32_bf16 v[96:99], a[200:203], a[216:219], v[96:99]
    s_add_u32 s38, s45, 122880
    v_exp_f32 v23, v23
    v_mfma_f32_16x16x32_bf16 v[96:99], a[204:207], a[232:235], v[96:99]
    s_add_u32 m0, s63, 122880
    v_mul_f32 v92, s92, v21
    v_add_f32 v23, 1.0, v23
    v_mfma_f32_16x16x32_bf16 v[104:107], a[204:207], a[236:239], v[104:107]
    s_waitcnt vmcnt(31)
    v_exp_f32 v92, v92
    v_mfma_f32_16x16x32_bf16 v[104:107], a[200:203], a[220:223], v[104:107]
    s_waitcnt vmcnt(30)
    v_rcp_f32 v23, v23
    v_mfma_f32_16x16x32_bf16 v[112:115], a[200:203], a[224:227], v[112:115]
    v_permlane16_swap_b32 v32, v34
    v_mfma_f32_16x16x32_bf16 v[112:115], a[204:207], a[240:243], v[112:115]
    v_permlane16_swap_b32 v33, v35
    v_mfma_f32_16x16x32_bf16 v[120:123], a[204:207], a[244:247], v[120:123]
    buffer_load_dwordx4 v3, s[8:11], s38 offen lds
    v_mfma_f32_16x16x32_bf16 v[120:123], a[200:203], a[228:231], v[120:123]
    ds_read_b64_tr_b16 a[200:201], v12 offset:4096
    v_add_f32 v92, 1.0, v92
    v_mfma_f32_16x16x32_bf16 v[124:127], a[208:211], a[228:231], v[124:127]
    ds_read_b64_tr_b16 a[202:203], v12 offset:5120
    v_mul_f32 v20, v20, v23
    v_mfma_f32_16x16x32_bf16 v[124:127], a[212:215], a[244:247], v[124:127]
    ds_read_b64_tr_b16 a[204:205], v12 offset:6144
    v_lshlrev_b32 v7, 2, v7
    v_mfma_f32_16x16x32_bf16 v[116:119], a[212:215], a[240:243], v[116:119]
    s_add_u32 s38, s46, 122880
    ds_read_b64_tr_b16 a[206:207], v12 offset:7168
    v_lshl_add_u32 v7, v1, 9, v7
    v_mfma_f32_16x16x32_bf16 v[116:119], a[208:211], a[224:227], v[116:119]
    v_rcp_f32 v92, v92
    v_mfma_f32_16x16x32_bf16 v[108:111], a[208:211], a[220:223], v[108:111]
    s_add_u32 m0, s63, 118784
    v_mul_f32 v21, v21, v92
    v_cvt_pk_bf16_f32 v47, v20, v21
    v_mfma_f32_16x16x32_bf16 v[108:111], a[212:215], a[236:239], v[108:111]
    s_waitcnt vmcnt(30) lgkmcnt(4)
    v_lshlrev_b32 v20, 16, v32
    v_and_b32 v21, 0xffff0000, v32
    v_mfma_f32_16x16x32_bf16 v[100:103], a[212:215], a[232:235], v[100:103]
    s_waitcnt vmcnt(20)
    v_sub_f32 v20, v20, v16
    v_sub_f32 v21, v21, v16
    v_add_u32 v13, 65536, v13
    v_mfma_f32_16x16x32_bf16 v[100:103], a[208:211], a[216:219], v[100:103]
    s_waitcnt vmcnt(19)
    ds_read_b64_tr_b16 a[192:193], v13 offset:0
    v_cvt_pk_bf16_f32 v22, v20, v21
    v_mfma_f32_16x16x32_bf16 v[96:99], a[184:187], a[152:155], v[96:99]
    ds_read_b64_tr_b16 a[194:195], v13 offset:1024
    v_lshlrev_b32 v20, 16, v22
    v_mfma_f32_16x16x32_bf16 v[96:99], a[188:191], a[168:171], v[96:99]
    ds_read_b64_tr_b16 a[196:197], v13 offset:2048
    v_and_b32 v21, 0xffff0000, v22
    v_mfma_f32_16x16x32_bf16 v[104:107], a[188:191], a[172:175], v[104:107]
    s_waitcnt vmcnt(18)
    ds_read_b64_tr_b16 a[198:199], v13 offset:3072
    v_mul_f32 v20, v20, v17
    v_mfma_f32_16x16x32_bf16 v[104:107], a[184:187], a[156:159], v[104:107]
    buffer_load_dwordx4 v3, s[8:11], s38 offen lds
    v_mfma_f32_16x16x32_bf16 v[112:115], a[184:187], a[160:163], v[112:115]
    s_waitcnt vmcnt(17)
    ds_read_b64_tr_b16 a[208:209], v13 offset:4096
    v_mul_f32 v21, v21, v17
    v_mfma_f32_16x16x32_bf16 v[112:115], a[188:191], a[176:179], v[112:115]
    ds_read_b64_tr_b16 a[210:211], v13 offset:5120
    v_cvt_pk_bf16_f32 v22, v20, v21
    v_mfma_f32_16x16x32_bf16 v[120:123], a[188:191], a[180:183], v[120:123]
    s_add_u32 s38, s47, 122880
    ds_read_b64_tr_b16 a[212:213], v13 offset:6144
    v_lshlrev_b32 v20, 16, v22
    v_mfma_f32_16x16x32_bf16 v[120:123], a[184:187], a[164:167], v[120:123]
    s_waitcnt lgkmcnt(5)
    ds_read_b64_tr_b16 a[214:215], v13 offset:7168
    v_and_b32 v21, 0xffff0000, v22
    v_mfma_f32_16x16x32_bf16 v[124:127], a[192:195], a[164:167], v[124:127]
    s_waitcnt lgkmcnt(4)
    v_mul_f32 v23, s92, v20
    v_mul_f32 v92, s92, v21
    v_mfma_f32_16x16x32_bf16 v[124:127], a[196:199], a[180:183], v[124:127]
    s_add_u32 m0, s63, 114688
    v_exp_f32 v23, v23
    v_mfma_f32_16x16x32_bf16 v[116:119], a[196:199], a[176:179], v[116:119]
    s_barrier
    v_mfma_f32_16x16x32_bf16 v[116:119], a[192:195], a[160:163], v[116:119]
    v_exp_f32 v92, v92
    v_mfma_f32_16x16x32_bf16 v[108:111], a[192:195], a[156:159], v[108:111]
    v_add_f32 v23, 1.0, v23
    v_add_f32 v92, 1.0, v92
    v_mfma_f32_16x16x32_bf16 v[108:111], a[196:199], a[172:175], v[108:111]
    s_waitcnt vmcnt(16)
    v_rcp_f32 v23, v23
    v_mfma_f32_16x16x32_bf16 v[100:103], a[196:199], a[168:171], v[100:103]
    buffer_load_dwordx4 v3, s[8:11], s38 offen lds
    v_mfma_f32_16x16x32_bf16 v[100:103], a[192:195], a[152:155], v[100:103]
    s_waitcnt vmcnt(10)
    v_rcp_f32 v92, v92
    v_mfma_f32_16x16x32_bf16 v[96:99], a[200:203], a[80:83], v[96:99]
    v_mul_f32 v20, v20, v23
    v_mul_f32 v21, v21, v92
    v_mfma_f32_16x16x32_bf16 v[96:99], a[204:207], a[96:99], v[96:99]
    v_cvt_pk_bf16_f32 v48, v20, v21
    v_lshlrev_b32 v20, 16, v33
    v_mfma_f32_16x16x32_bf16 v[104:107], a[204:207], a[100:103], v[104:107]
    s_waitcnt vmcnt(9)
    v_and_b32 v21, 0xffff0000, v33
    v_sub_f32 v20, v20, v16
    v_mfma_f32_16x16x32_bf16 v[104:107], a[200:203], a[84:87], v[104:107]
    s_waitcnt vmcnt(7)
    v_cvt_pk_bf16_f32 v96, v96, v97
    v_cvt_pk_bf16_f32 v97, v98, v99
    v_mfma_f32_16x16x32_bf16 v[112:115], a[200:203], a[88:91], v[112:115]
    s_add_u32 s38, s45, 163840
    v_sub_f32 v21, v21, v16
    v_cvt_pk_bf16_f32 v22, v20, v21
    v_mfma_f32_16x16x32_bf16 v[112:115], a[204:207], a[104:107], v[112:115]
    s_waitcnt lgkmcnt(0)
    v_cvt_pk_bf16_f32 v104, v104, v105
    v_cvt_pk_bf16_f32 v105, v106, v107
    v_mfma_f32_16x16x32_bf16 v[120:123], a[204:207], a[108:111], v[120:123]
    s_add_u32 m0, s63, 110592
    v_lshlrev_b32 v20, 16, v22
    v_and_b32 v21, 0xffff0000, v22
    v_mfma_f32_16x16x32_bf16 v[120:123], a[200:203], a[92:95], v[120:123]
    s_add_u32 s78, s59, 16384
    v_mul_f32 v20, v20, v17
    v_mul_f32 v21, v21, v17
    v_subrev_u32 v8, 73728, v8
    v_mfma_f32_16x16x32_bf16 v[124:127], a[208:211], a[92:95], v[124:127]
    s_and_b32 s56, s66, 0x70000000
    ds_read_b64_tr_b16 a[184:185], v8 offset:0
    v_cvt_pk_bf16_f32 v22, v20, v21
    v_mfma_f32_16x16x32_bf16 v[124:127], a[212:215], a[108:111], v[124:127]
    s_add_u32 s79, s60, 16384
    ds_read_b64_tr_b16 a[186:187], v8 offset:2048
    v_lshlrev_b32 v20, 16, v22
    ds_read_b64_tr_b16 a[188:189], v8 offset:4096
    v_mfma_f32_16x16x32_bf16 v[116:119], a[212:215], a[104:107], v[116:119]
    s_or_b32 s79, s79, s56
    ds_read_b64_tr_b16 a[190:191], v8 offset:6144
    v_and_b32 v21, 0xffff0000, v22
    v_mfma_f32_16x16x32_bf16 v[116:119], a[208:211], a[88:91], v[116:119]
    buffer_load_dwordx4 v3, s[8:11], s38 offen lds
    v_mfma_f32_16x16x32_bf16 v[108:111], a[208:211], a[84:87], v[108:111]
    s_xor_b32 s56, s50, s3
    ds_read_b64_tr_b16 a[200:201], v8 offset:8192
    v_mul_f32 v23, s92, v20
    v_mfma_f32_16x16x32_bf16 v[108:111], a[212:215], a[100:103], v[108:111]
    s_lshl_b32 s56, s56, 3
    ds_read_b64_tr_b16 a[202:203], v8 offset:10240
    v_mul_f32 v92, s92, v21
    v_mfma_f32_16x16x32_bf16 v[100:103], a[212:215], a[96:99], v[100:103]
    s_add_u32 s38, s46, 163840
    ds_read_b64_tr_b16 a[204:205], v8 offset:12288
    v_lshrrev_b32 v88, 1, v1
    v_mfma_f32_16x16x32_bf16 v[100:103], a[208:211], a[80:83], v[100:103]
    s_waitcnt lgkmcnt(5)
    ds_read_b64_tr_b16 a[206:207], v8 offset:14336
    v_cvt_pk_bf16_f32 v106, v108, v109
    v_subrev_u32 v9, 73728, v9
    v_mfma_f32_16x16x32_bf16 v[128:131], a[184:187], a[128:131], v[128:131]
    s_waitcnt lgkmcnt(4)
    ds_read_b64_tr_b16 a[192:193], v9 offset:0
    v_cvt_pk_bf16_f32 v107, v110, v111
    v_mfma_f32_16x16x32_bf16 v[128:131], a[188:191], a[0:3], v[128:131]
    s_add_u32 m0, s63, 106496
    ds_read_b64_tr_b16 a[194:195], v9 offset:2048
    v_cvt_pk_bf16_f32 v98, v100, v101
    ds_read_b64_tr_b16 a[196:197], v9 offset:4096
    v_mfma_f32_16x16x32_bf16 v[136:139], a[188:191], a[4:7], v[136:139]
    s_add_u32 s77, s61, s56
    ds_read_b64_tr_b16 a[198:199], v9 offset:6144
    v_cvt_pk_bf16_f32 v99, v102, v103
    v_mfma_f32_16x16x32_bf16 v[136:139], a[184:187], a[132:135], v[136:139]
    buffer_store_dwordx4 v[96:99], v14, s[24:27], s78 offen offset:0 sc1
    v_cvt_pk_bf16_f32 v100, v112, v113
    v_mfma_f32_16x16x32_bf16 v[144:147], a[184:187], a[136:139], v[144:147]
    s_add_u32 s77, s77, s63
    ds_read_b64_tr_b16 a[208:209], v9 offset:8192
    v_cvt_pk_bf16_f32 v101, v114, v115
    v_mfma_f32_16x16x32_bf16 v[144:147], a[188:191], a[8:11], v[144:147]
    s_lshl_b32 s56, s50, 12
    ds_read_b64_tr_b16 a[210:211], v9 offset:10240
    v_cvt_pk_bf16_f32 v102, v116, v117
    v_mfma_f32_16x16x32_bf16 v[152:155], a[188:191], a[12:15], v[152:155]
    buffer_load_dwordx4 v3, s[8:11], s38 offen lds
    v_mfma_f32_16x16x32_bf16 v[152:155], a[184:187], a[140:143], v[152:155]
    s_waitcnt lgkmcnt(4)
    ds_read_b64_tr_b16 a[212:213], v9 offset:12288
    v_cvt_pk_bf16_f32 v103, v118, v119
    v_mfma_f32_16x16x32_bf16 v[156:159], a[192:195], a[140:143], v[156:159]
    s_waitcnt lgkmcnt(3)
    ds_read_b64_tr_b16 a[214:215], v9 offset:14336
    v_cvt_pk_bf16_f32 v108, v120, v121
    v_mfma_f32_16x16x32_bf16 v[156:159], a[196:199], a[12:15], v[156:159]
    buffer_store_dwordx4 v[104:107], v14, s[24:27], s78 offen offset:1024 sc1
    v_cvt_pk_bf16_f32 v109, v122, v123
    v_mfma_f32_16x16x32_bf16 v[148:151], a[196:199], a[8:11], v[148:151]
    s_add_u32 s38, s47, 163840
    ds_read_b64_tr_b16 a[184:185], v8 offset:16384
    v_cvt_pk_bf16_f32 v110, v124, v125
    v_mfma_f32_16x16x32_bf16 v[148:151], a[192:195], a[136:139], v[148:151]
    s_add_u32 s48, s37, s56
    ds_read_b64_tr_b16 a[186:187], v8 offset:18432
    v_cvt_pk_bf16_f32 v111, v126, v127
    v_mfma_f32_16x16x32_bf16 v[140:143], a[192:195], a[132:135], v[140:143]
    s_add_u32 m0, s63, 102400
    ds_read_b64_tr_b16 a[188:189], v8 offset:20480
    v_min_u32 v88, 1, v88
    v_mfma_f32_16x16x32_bf16 v[140:143], a[196:199], a[4:7], v[140:143]
    ds_read_b64_tr_b16 a[190:191], v8 offset:22528
    v_lshl_or_b32 v7, v88, 30, v7
    v_mfma_f32_16x16x32_bf16 v[132:135], a[196:199], a[0:3], v[132:135]
    v_exp_f32 v23, v23
    v_mfma_f32_16x16x32_bf16 v[132:135], a[192:195], a[128:131], v[132:135]
    buffer_store_dwordx4 v[100:103], v14, s[24:27], s79 offen offset:0 sc1
    v_add_f32 v23, 1.0, v23
    v_mfma_f32_16x16x32_bf16 v[128:131], a[200:203], a[16:19], v[128:131]
    ds_read_b64_tr_b16 a[192:193], v9 offset:16384
    v_mfma_f32_16x16x32_bf16 v[128:131], a[204:207], a[32:35], v[128:131]
    ds_read_b64_tr_b16 a[194:195], v9 offset:18432
    v_mfma_f32_16x16x32_bf16 v[136:139], a[204:207], a[36:39], v[136:139]
    buffer_load_dwordx4 v3, s[8:11], s38 offen lds
    v_mfma_f32_16x16x32_bf16 v[136:139], a[200:203], a[20:23], v[136:139]
    ds_read_b64_tr_b16 a[196:197], v9 offset:20480
    v_mfma_f32_16x16x32_bf16 v[144:147], a[200:203], a[24:27], v[144:147]
    s_waitcnt lgkmcnt(3)
    ds_read_b64_tr_b16 a[198:199], v9 offset:22528
    v_mfma_f32_16x16x32_bf16 v[144:147], a[204:207], a[40:43], v[144:147]
    v_exp_f32 v92, v92
    v_mfma_f32_16x16x32_bf16 v[152:155], a[204:207], a[44:47], v[152:155]
    s_add_u32 s38, s45, 204800
    v_rcp_f32 v23, v23
    v_mfma_f32_16x16x32_bf16 v[152:155], a[200:203], a[28:31], v[152:155]
    buffer_store_dwordx4 v[108:111], v14, s[24:27], s79 offen offset:1024 sc1
    v_add_f32 v92, 1.0, v92
    v_mfma_f32_16x16x32_bf16 v[156:159], a[208:211], a[28:31], v[156:159]
    s_add_u32 m0, s63, 98304
    v_rcp_f32 v92, v92
    v_mfma_f32_16x16x32_bf16 v[156:159], a[212:215], a[44:47], v[156:159]
    s_waitcnt vmcnt(13)
    v_mul_f32 v20, v20, v23
    v_mul_f32 v21, v21, v92
    v_mfma_f32_16x16x32_bf16 v[148:151], a[212:215], a[40:43], v[148:151]
    s_barrier
    v_mfma_f32_16x16x32_bf16 v[148:151], a[208:211], a[24:27], v[148:151]
    ds_read_b64_tr_b16 a[200:201], v8 offset:24576
    v_cvt_pk_bf16_f32 v49, v20, v21
    v_mfma_f32_16x16x32_bf16 v[140:143], a[208:211], a[20:23], v[140:143]
    ds_read_b64_tr_b16 a[202:203], v8 offset:26624
    v_lshlrev_b32 v20, 16, v34
    v_mfma_f32_16x16x32_bf16 v[140:143], a[212:215], a[36:39], v[140:143]
    ds_read_b64_tr_b16 a[204:205], v8 offset:28672
    v_and_b32 v21, 0xffff0000, v34
    v_mfma_f32_16x16x32_bf16 v[132:135], a[212:215], a[32:35], v[132:135]
    buffer_load_dwordx4 v3, s[8:11], s38 offen lds
    v_mfma_f32_16x16x32_bf16 v[132:135], a[208:211], a[16:19], v[132:135]
    ds_read_b64_tr_b16 a[206:207], v8 offset:30720
    v_sub_f32 v20, v20, v16
    v_mfma_f32_16x16x32_bf16 v[128:131], a[184:187], a[48:51], v[128:131]
    ds_read_b64_tr_b16 a[208:209], v9 offset:24576
    v_sub_f32 v21, v21, v16
    v_mfma_f32_16x16x32_bf16 v[128:131], a[188:191], a[64:67], v[128:131]
    ds_read_b64_tr_b16 a[210:211], v9 offset:26624
    v_cvt_pk_bf16_f32 v22, v20, v21
    v_mfma_f32_16x16x32_bf16 v[136:139], a[188:191], a[68:71], v[136:139]
    s_add_u32 s38, s46, 204800
    ds_read_b64_tr_b16 a[212:213], v9 offset:28672
    v_lshlrev_b32 v20, 16, v22
    v_mfma_f32_16x16x32_bf16 v[136:139], a[184:187], a[52:55], v[136:139]
    s_waitcnt lgkmcnt(5)
    ds_read_b64_tr_b16 a[214:215], v9 offset:30720
    v_and_b32 v21, 0xffff0000, v22
    v_mfma_f32_16x16x32_bf16 v[144:147], a[184:187], a[56:59], v[144:147]
    s_add_u32 m0, s63, 94208
    v_mul_f32 v20, v20, v17
    v_mul_f32 v21, v21, v17
    v_mfma_f32_16x16x32_bf16 v[144:147], a[188:191], a[72:75], v[144:147]
    v_cvt_pk_bf16_f32 v22, v20, v21
    v_lshlrev_b32 v20, 16, v22
    v_mfma_f32_16x16x32_bf16 v[152:155], a[188:191], a[76:79], v[152:155]
    v_and_b32 v21, 0xffff0000, v22
    v_mul_f32 v23, s92, v20
    v_mfma_f32_16x16x32_bf16 v[152:155], a[184:187], a[60:63], v[152:155]
    ds_read_b64_tr_b16 a[184:185], v8 offset:32768
    v_mul_f32 v92, s92, v21
    v_mfma_f32_16x16x32_bf16 v[156:159], a[192:195], a[60:63], v[156:159]
    ds_read_b64_tr_b16 a[186:187], v8 offset:34816
    v_mfma_f32_16x16x32_bf16 v[156:159], a[196:199], a[76:79], v[156:159]
    ds_read_b64_tr_b16 a[188:189], v8 offset:36864
    v_mfma_f32_16x16x32_bf16 v[148:151], a[196:199], a[72:75], v[148:151]
    buffer_load_dwordx4 v3, s[8:11], s38 offen lds
    v_mfma_f32_16x16x32_bf16 v[148:151], a[192:195], a[56:59], v[148:151]
    ds_read_b64_tr_b16 a[190:191], v8 offset:38912
    v_mfma_f32_16x16x32_bf16 v[140:143], a[192:195], a[52:55], v[140:143]
    v_exp_f32 v23, v23
    v_mfma_f32_16x16x32_bf16 v[140:143], a[196:199], a[68:71], v[140:143]
    v_exp_f32 v92, v92
    v_mfma_f32_16x16x32_bf16 v[132:135], a[196:199], a[64:67], v[132:135]
    s_waitcnt lgkmcnt(3)
    v_add_f32 v23, 1.0, v23
    v_add_f32 v92, 1.0, v92
    v_mfma_f32_16x16x32_bf16 v[132:135], a[192:195], a[48:51], v[132:135]
    s_add_u32 s38, s47, 204800
    ds_read_b64_tr_b16 a[192:193], v9 offset:32768
    v_mfma_f32_16x16x32_bf16 v[128:131], a[200:203], a[216:219], v[128:131]
    s_add_u32 m0, s63, 90112
    ds_read_b64_tr_b16 a[194:195], v9 offset:34816
    v_mfma_f32_16x16x32_bf16 v[128:131], a[204:207], a[232:235], v[128:131]
    s_add_u32 s63, s37, 16384
    ds_read_b64_tr_b16 a[196:197], v9 offset:36864
    v_mfma_f32_16x16x32_bf16 v[136:139], a[204:207], a[236:239], v[136:139]
    s_add_u32 s37, s7, 1
    ds_read_b64_tr_b16 a[198:199], v9 offset:38912
    v_mfma_f32_16x16x32_bf16 v[136:139], a[200:203], a[220:223], v[136:139]
    v_rcp_f32 v23, v23
    v_mfma_f32_16x16x32_bf16 v[144:147], a[200:203], a[224:227], v[144:147]
    v_rcp_f32 v92, v92
    v_mfma_f32_16x16x32_bf16 v[144:147], a[204:207], a[240:243], v[144:147]
    v_mul_f32 v20, v20, v23
    v_mul_f32 v21, v21, v92
    v_mfma_f32_16x16x32_bf16 v[152:155], a[204:207], a[244:247], v[152:155]
    buffer_load_dwordx4 v3, s[8:11], s38 offen lds
    v_mfma_f32_16x16x32_bf16 v[152:155], a[200:203], a[228:231], v[152:155]
    s_add_u32 s38, s7, 1
    ds_read_b64_tr_b16 a[200:201], v8 offset:40960
    v_cvt_pk_bf16_f32 v50, v20, v21
    v_mfma_f32_16x16x32_bf16 v[156:159], a[208:211], a[228:231], v[156:159]
    ds_read_b64_tr_b16 a[202:203], v8 offset:43008
    v_lshlrev_b32 v20, 16, v35
    v_mfma_f32_16x16x32_bf16 v[156:159], a[212:215], a[244:247], v[156:159]
    ds_read_b64_tr_b16 a[204:205], v8 offset:45056
    v_and_b32 v21, 0xffff0000, v35
    v_mfma_f32_16x16x32_bf16 v[148:151], a[212:215], a[240:243], v[148:151]
    ds_read_b64_tr_b16 a[206:207], v8 offset:47104
    v_sub_f32 v20, v20, v16
    v_mfma_f32_16x16x32_bf16 v[148:151], a[208:211], a[224:227], v[148:151]
    s_waitcnt lgkmcnt(4)
    v_sub_f32 v21, v21, v16
    v_cvt_pk_bf16_f32 v22, v20, v21
    v_mfma_f32_16x16x32_bf16 v[140:143], a[208:211], a[220:223], v[140:143]
    v_lshlrev_b32 v20, 16, v22
    v_and_b32 v21, 0xffff0000, v22
    v_mfma_f32_16x16x32_bf16 v[140:143], a[212:215], a[236:239], v[140:143]
    v_mul_f32 v20, v20, v17
    v_mul_f32 v21, v21, v17
    v_mfma_f32_16x16x32_bf16 v[132:135], a[212:215], a[232:235], v[132:135]
    v_cvt_pk_bf16_f32 v22, v20, v21
    v_lshlrev_b32 v20, 16, v22
    v_mfma_f32_16x16x32_bf16 v[132:135], a[208:211], a[216:219], v[132:135]
    ds_read_b64_tr_b16 a[208:209], v9 offset:40960
    v_and_b32 v21, 0xffff0000, v22
    v_mfma_f32_16x16x32_bf16 v[128:131], a[184:187], a[152:155], v[128:131]
    ds_read_b64_tr_b16 a[210:211], v9 offset:43008
    v_mul_f32 v23, s92, v20
    v_mfma_f32_16x16x32_bf16 v[128:131], a[188:191], a[168:171], v[128:131]
    ds_read_b64_tr_b16 a[212:213], v9 offset:45056
    v_mul_f32 v92, s92, v21
    v_mfma_f32_16x16x32_bf16 v[136:139], a[188:191], a[172:175], v[136:139]
    ds_read_b64_tr_b16 a[214:215], v9 offset:47104
    v_mfma_f32_16x16x32_bf16 v[136:139], a[184:187], a[156:159], v[136:139]
    v_exp_f32 v23, v23
    v_mfma_f32_16x16x32_bf16 v[144:147], a[184:187], a[160:163], v[144:147]
    v_exp_f32 v92, v92
    v_mfma_f32_16x16x32_bf16 v[144:147], a[188:191], a[176:179], v[144:147]
    v_permlane16_swap_b32 v36, v38
    v_mfma_f32_16x16x32_bf16 v[152:155], a[188:191], a[180:183], v[152:155]
    v_permlane16_swap_b32 v37, v39
    v_mfma_f32_16x16x32_bf16 v[152:155], a[184:187], a[164:167], v[152:155]
    v_add_f32 v23, 1.0, v23
    v_add_f32 v92, 1.0, v92
    v_mfma_f32_16x16x32_bf16 v[156:159], a[192:195], a[164:167], v[156:159]
    v_rcp_f32 v23, v23
    v_mfma_f32_16x16x32_bf16 v[156:159], a[196:199], a[180:183], v[156:159]
    v_rcp_f32 v92, v92
    v_mfma_f32_16x16x32_bf16 v[148:151], a[196:199], a[176:179], v[148:151]
    v_mul_f32 v20, v20, v23
    v_mul_f32 v21, v21, v92
    v_mfma_f32_16x16x32_bf16 v[148:151], a[192:195], a[160:163], v[148:151]
    v_cvt_pk_bf16_f32 v51, v20, v21
    v_lshlrev_b32 v20, 16, v36
    v_mfma_f32_16x16x32_bf16 v[140:143], a[192:195], a[156:159], v[140:143]
    v_and_b32 v21, 0xffff0000, v36
    v_sub_f32 v20, v20, v18
    v_mfma_f32_16x16x32_bf16 v[140:143], a[196:199], a[172:175], v[140:143]
    s_waitcnt lgkmcnt(0)
    v_sub_f32 v21, v21, v18
    v_cvt_pk_bf16_f32 v22, v20, v21
    v_mfma_f32_16x16x32_bf16 v[132:135], a[196:199], a[168:171], v[132:135]
    v_lshlrev_b32 v20, 16, v22
    v_and_b32 v21, 0xffff0000, v22
    v_mfma_f32_16x16x32_bf16 v[132:135], a[192:195], a[152:155], v[132:135]
    v_mul_f32 v20, v20, v19
    v_mul_f32 v21, v21, v19
    v_mfma_f32_16x16x32_bf16 v[128:131], a[200:203], a[80:83], v[128:131]
    v_cvt_pk_bf16_f32 v22, v20, v21
    v_lshlrev_b32 v20, 16, v22
    v_mfma_f32_16x16x32_bf16 v[128:131], a[204:207], a[96:99], v[128:131]
    v_and_b32 v21, 0xffff0000, v22
    v_mul_f32 v23, s92, v20
    v_mfma_f32_16x16x32_bf16 v[136:139], a[204:207], a[100:103], v[136:139]
    v_exp_f32 v23, v23
    v_mfma_f32_16x16x32_bf16 v[136:139], a[200:203], a[84:87], v[136:139]
    v_mul_f32 v92, s92, v21
    v_add_f32 v23, 1.0, v23
    v_mfma_f32_16x16x32_bf16 v[144:147], a[200:203], a[88:91], v[144:147]
    v_cvt_pk_bf16_f32 v128, v128, v129
    v_cvt_pk_bf16_f32 v129, v130, v131
    v_mfma_f32_16x16x32_bf16 v[144:147], a[204:207], a[104:107], v[144:147]
    s_xor_b32 s56, s50, 3
    v_exp_f32 v92, v92
    v_mfma_f32_16x16x32_bf16 v[152:155], a[204:207], a[108:111], v[152:155]
    s_lshl_b32 s56, s56, 12
    v_cvt_pk_bf16_f32 v136, v136, v137
    v_cvt_pk_bf16_f32 v137, v138, v139
    v_mfma_f32_16x16x32_bf16 v[152:155], a[200:203], a[92:95], v[152:155]
    s_add_u32 s78, s59, s56
    v_cvt_pk_bf16_f32 v144, v144, v145
    v_cvt_pk_bf16_f32 v145, v146, v147
    v_subrev_u32 v10, 73728, v10
    v_mfma_f32_16x16x32_bf16 v[156:159], a[208:211], a[92:95], v[156:159]
    s_add_u32 s79, s60, s56
    ds_read_b64_tr_b16 a[184:185], v10 offset:0
    v_add_f32 v92, 1.0, v92
    v_mfma_f32_16x16x32_bf16 v[156:159], a[212:215], a[108:111], v[156:159]
    s_xor_b32 s56, s50, 3
    ds_read_b64_tr_b16 a[186:187], v10 offset:2048
    v_cvt_pk_bf16_f32 v152, v152, v153
    ds_read_b64_tr_b16 a[188:189], v10 offset:4096
    v_mfma_f32_16x16x32_bf16 v[148:151], a[212:215], a[104:107], v[148:151]
    s_lshl_b32 s56, s56, 10
    ds_read_b64_tr_b16 a[190:191], v10 offset:6144
    v_cvt_pk_bf16_f32 v153, v154, v155
    v_mfma_f32_16x16x32_bf16 v[148:151], a[208:211], a[88:91], v[148:151]
    ds_read_b64_tr_b16 a[200:201], v10 offset:8192
    v_cvt_pk_bf16_f32 v154, v156, v157
    v_mfma_f32_16x16x32_bf16 v[140:143], a[208:211], a[84:87], v[140:143]
    ds_read_b64_tr_b16 a[202:203], v10 offset:10240
    v_cvt_pk_bf16_f32 v155, v158, v159
    v_mfma_f32_16x16x32_bf16 v[140:143], a[212:215], a[100:103], v[140:143]
    s_waitcnt vmcnt(3)
    ds_read_b64_tr_b16 a[204:205], v10 offset:12288
    v_cvt_pk_bf16_f32 v146, v148, v149
    v_mfma_f32_16x16x32_bf16 v[132:135], a[212:215], a[96:99], v[132:135]
    buffer_store_dword v6, v7, s[24:27], s77 offen offset:32 sc1
    v_mfma_f32_16x16x32_bf16 v[132:135], a[208:211], a[80:83], v[132:135]
    s_waitcnt lgkmcnt(5)
    ds_read_b64_tr_b16 a[206:207], v10 offset:14336
    v_cvt_pk_bf16_f32 v138, v140, v141
    v_subrev_u32 v11, 73728, v11
    v_mfma_f32_16x16x32_bf16 v[160:163], a[184:187], a[128:131], v[160:163]
    s_waitcnt lgkmcnt(4)
    ds_read_b64_tr_b16 a[192:193], v11 offset:0
    v_cvt_pk_bf16_f32 v139, v142, v143
    v_mfma_f32_16x16x32_bf16 v[160:163], a[188:191], a[0:3], v[160:163]
    s_add_u32 s77, s61, s56
    ds_read_b64_tr_b16 a[194:195], v11 offset:2048
    v_cvt_pk_bf16_f32 v130, v132, v133
    ds_read_b64_tr_b16 a[196:197], v11 offset:4096
    v_mfma_f32_16x16x32_bf16 v[168:171], a[188:191], a[4:7], v[168:171]
    ds_read_b64_tr_b16 a[198:199], v11 offset:6144
    v_cvt_pk_bf16_f32 v131, v134, v135
    v_mfma_f32_16x16x32_bf16 v[168:171], a[184:187], a[132:135], v[168:171]
    buffer_store_dwordx4 v[128:131], v14, s[24:27], s78 offen offset:0 sc1
    v_cvt_pk_bf16_f32 v147, v150, v151
    v_mfma_f32_16x16x32_bf16 v[176:179], a[184:187], a[136:139], v[176:179]
    ds_read_b64_tr_b16 a[208:209], v11 offset:8192
    v_mfma_f32_16x16x32_bf16 v[176:179], a[188:191], a[8:11], v[176:179]
    ds_read_b64_tr_b16 a[210:211], v11 offset:10240
    v_mfma_f32_16x16x32_bf16 v[184:187], a[188:191], a[12:15], v[184:187]
    ds_read_b64_tr_b16 a[212:213], v11 offset:12288
    v_mfma_f32_16x16x32_bf16 v[184:187], a[184:187], a[140:143], v[184:187]
    s_waitcnt lgkmcnt(5)
    ds_read_b64_tr_b16 a[214:215], v11 offset:14336
    v_mfma_f32_16x16x32_bf16 v[188:191], a[192:195], a[140:143], v[188:191]
    s_waitcnt lgkmcnt(4)
    ds_read_b64_tr_b16 a[184:185], v10 offset:16384
    v_mfma_f32_16x16x32_bf16 v[188:191], a[196:199], a[12:15], v[188:191]
    buffer_store_dwordx4 v[136:139], v14, s[24:27], s78 offen offset:1024 sc1
    v_add_u32 v8, 90112, v8
    v_mfma_f32_16x16x32_bf16 v[180:183], a[196:199], a[8:11], v[180:183]
    ds_read_b64_tr_b16 a[186:187], v10 offset:18432
    v_mfma_f32_16x16x32_bf16 v[180:183], a[192:195], a[136:139], v[180:183]
    ds_read_b64_tr_b16 a[188:189], v10 offset:20480
    v_mfma_f32_16x16x32_bf16 v[172:175], a[192:195], a[132:135], v[172:175]
    ds_read_b64_tr_b16 a[190:191], v10 offset:22528
    v_mfma_f32_16x16x32_bf16 v[172:175], a[196:199], a[4:7], v[172:175]
    v_rcp_f32 v23, v23
    v_mfma_f32_16x16x32_bf16 v[164:167], a[196:199], a[0:3], v[164:167]
    v_rcp_f32 v92, v92
    v_mfma_f32_16x16x32_bf16 v[164:167], a[192:195], a[128:131], v[164:167]
    buffer_store_dwordx4 v[144:147], v14, s[24:27], s79 offen offset:0 sc1
    v_mul_f32 v20, v20, v23
    v_mfma_f32_16x16x32_bf16 v[160:163], a[200:203], a[16:19], v[160:163]
    ds_read_b64_tr_b16 a[192:193], v11 offset:16384
    v_mul_f32 v21, v21, v92
    v_mfma_f32_16x16x32_bf16 v[160:163], a[204:207], a[32:35], v[160:163]
    ds_read_b64_tr_b16 a[194:195], v11 offset:18432
    v_cvt_pk_bf16_f32 v52, v20, v21
    v_mfma_f32_16x16x32_bf16 v[168:171], a[204:207], a[36:39], v[168:171]
    ds_read_b64_tr_b16 a[196:197], v11 offset:20480
    v_lshlrev_b32 v20, 16, v37
    v_mfma_f32_16x16x32_bf16 v[168:171], a[200:203], a[20:23], v[168:171]
    s_waitcnt lgkmcnt(3)
    ds_read_b64_tr_b16 a[198:199], v11 offset:22528
    v_and_b32 v21, 0xffff0000, v37
    v_mfma_f32_16x16x32_bf16 v[176:179], a[200:203], a[24:27], v[176:179]
    v_sub_f32 v20, v20, v18
    v_sub_f32 v21, v21, v18
    v_mfma_f32_16x16x32_bf16 v[176:179], a[204:207], a[40:43], v[176:179]
    v_cvt_pk_bf16_f32 v22, v20, v21
    v_lshlrev_b32 v20, 16, v22
    v_mfma_f32_16x16x32_bf16 v[184:187], a[204:207], a[44:47], v[184:187]
    v_and_b32 v21, 0xffff0000, v22
    v_mul_f32 v20, v20, v19
    v_mfma_f32_16x16x32_bf16 v[184:187], a[200:203], a[28:31], v[184:187]
    buffer_store_dwordx4 v[152:155], v14, s[24:27], s79 offen offset:1024 sc1
    v_mul_f32 v21, v21, v19
    v_mfma_f32_16x16x32_bf16 v[188:191], a[208:211], a[28:31], v[188:191]
    ds_read_b64_tr_b16 a[200:201], v10 offset:24576
    v_cvt_pk_bf16_f32 v22, v20, v21
    v_mfma_f32_16x16x32_bf16 v[188:191], a[212:215], a[44:47], v[188:191]
    ds_read_b64_tr_b16 a[202:203], v10 offset:26624
    v_lshlrev_b32 v20, 16, v22
    v_mfma_f32_16x16x32_bf16 v[180:183], a[212:215], a[40:43], v[180:183]
pg_15:
    s_cbranch_execz pg_back
    ds_read_b64_tr_b16 a[204:205], v10 offset:28672
    v_and_b32 v21, 0xffff0000, v22
    v_mfma_f32_16x16x32_bf16 v[180:183], a[208:211], a[24:27], v[180:183]
    ds_read_b64_tr_b16 a[206:207], v10 offset:30720
    v_mul_f32 v23, s92, v20
    v_mfma_f32_16x16x32_bf16 v[172:175], a[208:211], a[20:23], v[172:175]
    v_exp_f32 v23, v23
    v_mfma_f32_16x16x32_bf16 v[172:175], a[212:215], a[36:39], v[172:175]
    v_mul_f32 v92, s92, v21
    v_add_f32 v23, 1.0, v23
    v_mfma_f32_16x16x32_bf16 v[164:167], a[212:215], a[32:35], v[164:167]
    v_exp_f32 v92, v92
    v_mfma_f32_16x16x32_bf16 v[164:167], a[208:211], a[16:19], v[164:167]
    ds_read_b64_tr_b16 a[208:209], v11 offset:24576
    v_add_f32 v92, 1.0, v92
    v_mfma_f32_16x16x32_bf16 v[160:163], a[184:187], a[48:51], v[160:163]
    ds_read_b64_tr_b16 a[210:211], v11 offset:26624
    v_mfma_f32_16x16x32_bf16 v[160:163], a[188:191], a[64:67], v[160:163]
    ds_read_b64_tr_b16 a[212:213], v11 offset:28672
    v_mfma_f32_16x16x32_bf16 v[168:171], a[188:191], a[68:71], v[168:171]
    s_waitcnt lgkmcnt(3)
    ds_read_b64_tr_b16 a[214:215], v11 offset:30720
    v_mfma_f32_16x16x32_bf16 v[168:171], a[184:187], a[52:55], v[168:171]
    v_rcp_f32 v23, v23
    v_mfma_f32_16x16x32_bf16 v[176:179], a[184:187], a[56:59], v[176:179]
    v_rcp_f32 v92, v92
    v_mfma_f32_16x16x32_bf16 v[176:179], a[188:191], a[72:75], v[176:179]
    v_mul_f32 v20, v20, v23
    v_mul_f32 v21, v21, v92
    v_mfma_f32_16x16x32_bf16 v[184:187], a[188:191], a[76:79], v[184:187]
    v_cvt_pk_bf16_f32 v53, v20, v21
    v_lshlrev_b32 v20, 16, v38
    v_mfma_f32_16x16x32_bf16 v[184:187], a[184:187], a[60:63], v[184:187]
    ds_read_b64_tr_b16 a[184:185], v10 offset:32768
    v_and_b32 v21, 0xffff0000, v38
    v_mfma_f32_16x16x32_bf16 v[188:191], a[192:195], a[60:63], v[188:191]
    s_load_dwordx16 s[28:43], s[86:87], s67 glc
    ds_read_b64_tr_b16 a[186:187], v10 offset:34816
    v_sub_f32 v20, v20, v18
    v_mfma_f32_16x16x32_bf16 v[188:191], a[196:199], a[76:79], v[188:191]
    ds_read_b64_tr_b16 a[188:189], v10 offset:36864
    v_sub_f32 v21, v21, v18
    v_mfma_f32_16x16x32_bf16 v[180:183], a[196:199], a[72:75], v[180:183]
    ds_read_b64_tr_b16 a[190:191], v10 offset:38912
    v_cvt_pk_bf16_f32 v22, v20, v21
    v_mfma_f32_16x16x32_bf16 v[180:183], a[192:195], a[56:59], v[180:183]
    v_lshlrev_b32 v20, 16, v22
    v_and_b32 v21, 0xffff0000, v22
    v_mfma_f32_16x16x32_bf16 v[172:175], a[192:195], a[52:55], v[172:175]
    v_mul_f32 v20, v20, v19
    v_mul_f32 v21, v21, v19
    v_mfma_f32_16x16x32_bf16 v[172:175], a[196:199], a[68:71], v[172:175]
    v_cvt_pk_bf16_f32 v22, v20, v21
    v_lshlrev_b32 v20, 16, v22
    v_mfma_f32_16x16x32_bf16 v[164:167], a[196:199], a[64:67], v[164:167]
    v_and_b32 v21, 0xffff0000, v22
    v_mul_f32 v23, s92, v20
    v_mfma_f32_16x16x32_bf16 v[164:167], a[192:195], a[48:51], v[164:167]
    ds_read_b64_tr_b16 a[192:193], v11 offset:32768
    v_mul_f32 v92, s92, v21
    v_mfma_f32_16x16x32_bf16 v[160:163], a[200:203], a[216:219], v[160:163]
    ds_read_b64_tr_b16 a[194:195], v11 offset:34816
    v_mfma_f32_16x16x32_bf16 v[160:163], a[204:207], a[232:235], v[160:163]
    ds_read_b64_tr_b16 a[196:197], v11 offset:36864
    v_mfma_f32_16x16x32_bf16 v[168:171], a[204:207], a[236:239], v[168:171]
    s_waitcnt lgkmcnt(3)
    ds_read_b64_tr_b16 a[198:199], v11 offset:38912
    v_mfma_f32_16x16x32_bf16 v[168:171], a[200:203], a[220:223], v[168:171]
    v_exp_f32 v23, v23
    v_mfma_f32_16x16x32_bf16 v[176:179], a[200:203], a[224:227], v[176:179]
    v_exp_f32 v92, v92
    v_mfma_f32_16x16x32_bf16 v[176:179], a[204:207], a[240:243], v[176:179]
    v_add_f32 v23, 1.0, v23
    v_add_f32 v92, 1.0, v92
    v_mfma_f32_16x16x32_bf16 v[184:187], a[204:207], a[244:247], v[184:187]
    v_rcp_f32 v23, v23
    v_mfma_f32_16x16x32_bf16 v[184:187], a[200:203], a[228:231], v[184:187]
    ds_read_b64_tr_b16 a[200:201], v10 offset:40960
    v_mul_f32 v20, v20, v23
    v_mfma_f32_16x16x32_bf16 v[188:191], a[208:211], a[228:231], v[188:191]
    ds_read_b64_tr_b16 a[202:203], v10 offset:43008
    v_mfma_f32_16x16x32_bf16 v[188:191], a[212:215], a[244:247], v[188:191]
    ds_read_b64_tr_b16 a[204:205], v10 offset:45056
    v_mfma_f32_16x16x32_bf16 v[180:183], a[212:215], a[240:243], v[180:183]
    ds_read_b64_tr_b16 a[206:207], v10 offset:47104
    v_mfma_f32_16x16x32_bf16 v[180:183], a[208:211], a[224:227], v[180:183]
    v_rcp_f32 v92, v92
    v_mfma_f32_16x16x32_bf16 v[172:175], a[208:211], a[220:223], v[172:175]
    v_mul_f32 v21, v21, v92
    v_cvt_pk_bf16_f32 v54, v20, v21
    v_mfma_f32_16x16x32_bf16 v[172:175], a[212:215], a[236:239], v[172:175]
    v_lshlrev_b32 v20, 16, v39
    v_and_b32 v21, 0xffff0000, v39
    v_mfma_f32_16x16x32_bf16 v[164:167], a[212:215], a[232:235], v[164:167]
    v_sub_f32 v20, v20, v18
    v_sub_f32 v21, v21, v18
    v_mfma_f32_16x16x32_bf16 v[164:167], a[208:211], a[216:219], v[164:167]
    ds_read_b64_tr_b16 a[208:209], v11 offset:40960
    v_cvt_pk_bf16_f32 v22, v20, v21
    v_mfma_f32_16x16x32_bf16 v[160:163], a[184:187], a[152:155], v[160:163]
    ds_read_b64_tr_b16 a[210:211], v11 offset:43008
    v_lshlrev_b32 v20, 16, v22
    v_mfma_f32_16x16x32_bf16 v[160:163], a[188:191], a[168:171], v[160:163]
    ds_read_b64_tr_b16 a[212:213], v11 offset:45056
    v_and_b32 v21, 0xffff0000, v22
    v_mfma_f32_16x16x32_bf16 v[168:171], a[188:191], a[172:175], v[168:171]
    s_waitcnt lgkmcnt(3)
    ds_read_b64_tr_b16 a[214:215], v11 offset:47104
    v_mul_f32 v20, v20, v19
    v_mfma_f32_16x16x32_bf16 v[168:171], a[184:187], a[156:159], v[168:171]
    v_mul_f32 v21, v21, v19
    v_cvt_pk_bf16_f32 v22, v20, v21
    v_mfma_f32_16x16x32_bf16 v[176:179], a[184:187], a[160:163], v[176:179]
    v_lshlrev_b32 v20, 16, v22
    v_and_b32 v21, 0xffff0000, v22
    v_mfma_f32_16x16x32_bf16 v[176:179], a[188:191], a[176:179], v[176:179]
    v_mul_f32 v23, s92, v20
    v_mul_f32 v92, s92, v21
    v_mfma_f32_16x16x32_bf16 v[184:187], a[188:191], a[180:183], v[184:187]
    v_exp_f32 v23, v23
    v_mfma_f32_16x16x32_bf16 v[184:187], a[184:187], a[164:167], v[184:187]
    v_exp_f32 v92, v92
    v_mfma_f32_16x16x32_bf16 v[188:191], a[192:195], a[164:167], v[188:191]
    v_add_f32 v23, 1.0, v23
    v_add_f32 v92, 1.0, v92
    v_mfma_f32_16x16x32_bf16 v[188:191], a[196:199], a[180:183], v[188:191]
    v_rcp_f32 v23, v23
    v_mfma_f32_16x16x32_bf16 v[180:183], a[196:199], a[176:179], v[180:183]
    s_barrier
    v_mfma_f32_16x16x32_bf16 v[180:183], a[192:195], a[160:163], v[180:183]
    ds_read_b64_tr_b16 a[184:185], v8 offset:45056
    v_mul_f32 v20, v20, v23
    v_mfma_f32_16x16x32_bf16 v[172:175], a[192:195], a[156:159], v[172:175]
    ds_read_b64_tr_b16 a[186:187], v8 offset:47104
    v_mfma_f32_16x16x32_bf16 v[172:175], a[196:199], a[172:175], v[172:175]
    ds_read_b64_tr_b16 a[188:189], v8 offset:40960
    v_mfma_f32_16x16x32_bf16 v[164:167], a[196:199], a[168:171], v[164:167]
    ds_read_b64_tr_b16 a[190:191], v8 offset:43008
    v_add_u32 v9, 90112, v9
    v_mfma_f32_16x16x32_bf16 v[164:167], a[192:195], a[152:155], v[164:167]
    ds_read_b64_tr_b16 a[192:193], v9 offset:45056
    v_mfma_f32_16x16x32_bf16 v[160:163], a[200:203], a[80:83], v[160:163]
    ds_read_b64_tr_b16 a[194:195], v9 offset:47104
    v_mfma_f32_16x16x32_bf16 v[160:163], a[204:207], a[96:99], v[160:163]
    ds_read_b64_tr_b16 a[196:197], v9 offset:40960
    v_mfma_f32_16x16x32_bf16 v[168:171], a[204:207], a[100:103], v[168:171]
    s_waitcnt lgkmcnt(6)
    ds_read_b64_tr_b16 a[198:199], v9 offset:43008
    v_mfma_f32_16x16x32_bf16 v[168:171], a[200:203], a[84:87], v[168:171]
    v_rcp_f32 v92, v92
    v_mfma_f32_16x16x32_bf16 v[176:179], a[200:203], a[88:91], v[176:179]
    v_mul_f32 v21, v21, v92
    v_cvt_pk_bf16_f32 v160, v160, v161
    v_mfma_f32_16x16x32_bf16 v[176:179], a[204:207], a[104:107], v[176:179]
    s_xor_b32 s56, s50, 2
    v_cvt_pk_bf16_f32 v161, v162, v163
    v_cvt_pk_bf16_f32 v55, v20, v21
    v_mfma_f32_16x16x32_bf16 v[184:187], a[204:207], a[108:111], v[184:187]
    s_lshl_b32 s56, s56, 12
    v_cvt_pk_bf16_f32 v168, v168, v169
    v_cvt_pk_bf16_f32 v169, v170, v171
    v_mfma_f32_16x16x32_bf16 v[184:187], a[200:203], a[92:95], v[184:187]
    s_add_u32 s78, s59, s56
    ds_read_b64_tr_b16 a[200:201], v8 offset:36864
    v_cvt_pk_bf16_f32 v176, v176, v177
    v_mfma_f32_16x16x32_bf16 v[188:191], a[208:211], a[92:95], v[188:191]
    s_xor_b32 s81, s53, 1
    ds_read_b64_tr_b16 a[202:203], v8 offset:38912
    v_cvt_pk_bf16_f32 v177, v178, v179
    v_mfma_f32_16x16x32_bf16 v[188:191], a[212:215], a[108:111], v[188:191]
    s_mul_i32 s81, s81, 2622464
    ds_read_b64_tr_b16 a[204:205], v8 offset:32768
    v_cvt_pk_bf16_f32 v184, v184, v185
    v_mfma_f32_16x16x32_bf16 v[180:183], a[212:215], a[104:107], v[180:183]
    s_add_u32 s81, s81, s63
    ds_read_b64_tr_b16 a[206:207], v8 offset:34816
    v_cvt_pk_bf16_f32 v185, v186, v187
    v_mfma_f32_16x16x32_bf16 v[180:183], a[208:211], a[88:91], v[180:183]
    s_waitcnt lgkmcnt(4)
    v_cvt_pk_bf16_f32 v186, v188, v189
    v_cvt_pk_bf16_f32 v187, v190, v191
    v_mfma_f32_16x16x32_bf16 v[172:175], a[208:211], a[84:87], v[172:175]
    s_cmp_eq_u32 s37, s7
    s_cselect_b32 s81, s81, 0x70000000
    s_cselect_b32 s57, 512, 0
    v_mfma_f32_16x16x32_bf16 v[172:175], a[212:215], a[100:103], v[172:175]
    s_or_b32 s80, s80, s57
    v_cvt_pk_bf16_f32 v178, v180, v181
    v_cvt_pk_bf16_f32 v179, v182, v183
    v_mfma_f32_16x16x32_bf16 v[164:167], a[212:215], a[96:99], v[164:167]
    s_waitcnt vmcnt(0)
    v_add_u32 v10, 90112, v10
    v_mfma_f32_16x16x32_bf16 v[164:167], a[208:211], a[80:83], v[164:167]
    buffer_store_dword v6, v7, s[24:27], s77 offen offset:24 sc1
    v_mfma_f32_16x16x32_bf16 v[192:195], a[184:187], a[128:131], v[192:195]
    buffer_load_dwordx4 v[56:59], v14, s[24:27], s81 offen offset:0 sc1
    v_mfma_f32_16x16x32_bf16 v[192:195], a[188:191], a[0:3], v[192:195]
    s_add_u32 s79, s60, s56
    ds_read_b64_tr_b16 a[208:209], v9 offset:36864
    v_cvt_pk_bf16_f32 v170, v172, v173
    v_mfma_f32_16x16x32_bf16 v[200:203], a[188:191], a[4:7], v[200:203]
    s_xor_b32 s56, s50, 2
    ds_read_b64_tr_b16 a[210:211], v9 offset:38912
    v_cvt_pk_bf16_f32 v162, v164, v165
    v_mfma_f32_16x16x32_bf16 v[200:203], a[184:187], a[132:135], v[200:203]
    buffer_load_dwordx4 v[60:63], v14, s[24:27], s81 offen offset:1024 sc1
    v_mfma_f32_16x16x32_bf16 v[208:211], a[184:187], a[136:139], v[208:211]
    s_xor_b32 s81, s53, 2
    ds_read_b64_tr_b16 a[212:213], v9 offset:32768
    v_cvt_pk_bf16_f32 v163, v166, v167
    v_mfma_f32_16x16x32_bf16 v[208:211], a[188:191], a[8:11], v[208:211]
    buffer_store_dwordx4 v[160:163], v14, s[24:27], s78 offen offset:0 sc1
    v_cvt_pk_bf16_f32 v171, v174, v175
    v_mfma_f32_16x16x32_bf16 v[216:219], a[188:191], a[12:15], v[216:219]
    s_mul_i32 s81, s81, 2622464
    ds_read_b64_tr_b16 a[214:215], v9 offset:34816
    s_add_u32 s81, s81, s63
    v_mfma_f32_16x16x32_bf16 v[216:219], a[184:187], a[140:143], v[216:219]
    buffer_store_dwordx4 v[168:171], v14, s[24:27], s78 offen offset:1024 sc1
    v_add_u32 v11, 90112, v11
    v_mfma_f32_16x16x32_bf16 v[220:223], a[192:195], a[140:143], v[220:223]
    s_cmp_eq_u32 s38, s7
    s_cselect_b32 s81, s81, 0x70000000
    s_cselect_b32 s57, 1024, 0
    v_mfma_f32_16x16x32_bf16 v[220:223], a[196:199], a[12:15], v[220:223]
    buffer_load_dwordx4 v[64:67], v14, s[24:27], s81 offen offset:0 sc1
    v_mfma_f32_16x16x32_bf16 v[212:215], a[196:199], a[8:11], v[212:215]
    buffer_load_dwordx4 v[68:71], v14, s[24:27], s81 offen offset:1024 sc1
    v_mfma_f32_16x16x32_bf16 v[212:215], a[192:195], a[136:139], v[212:215]
    s_or_b32 s80, s80, s57
    ds_read_b64_tr_b16 a[184:185], v8 offset:28672
    s_xor_b32 s81, s53, 3
    v_mfma_f32_16x16x32_bf16 v[204:207], a[192:195], a[132:135], v[204:207]
    s_mul_i32 s81, s81, 2622464
    ds_read_b64_tr_b16 a[186:187], v8 offset:30720
    s_add_u32 s81, s81, s63
    v_mfma_f32_16x16x32_bf16 v[204:207], a[196:199], a[4:7], v[204:207]
    s_waitcnt lgkmcnt(2)
    ds_read_b64_tr_b16 a[188:189], v8 offset:24576
    s_lshl_b32 s56, s56, 10
    v_mfma_f32_16x16x32_bf16 v[196:199], a[196:199], a[0:3], v[196:199]
    s_cmp_eq_u32 s39, s7
    s_cselect_b32 s81, s81, 0x70000000
    s_cselect_b32 s57, 2048, 0
    v_mfma_f32_16x16x32_bf16 v[196:199], a[192:195], a[128:131], v[196:199]
    buffer_store_dwordx4 v[176:179], v14, s[24:27], s79 offen offset:0 sc1
    v_mfma_f32_16x16x32_bf16 v[192:195], a[200:203], a[16:19], v[192:195]
    buffer_load_dwordx4 v[72:75], v14, s[24:27], s81 offen offset:0 sc1
    v_mfma_f32_16x16x32_bf16 v[192:195], a[204:207], a[32:35], v[192:195]
    buffer_load_dwordx4 v[76:79], v14, s[24:27], s81 offen offset:1024 sc1
    v_mfma_f32_16x16x32_bf16 v[200:203], a[204:207], a[36:39], v[200:203]
    s_load_dwordx16 s[28:43], s[86:87], s67 glc
    ds_read_b64_tr_b16 a[190:191], v8 offset:26624
    s_or_b32 s80, s80, s57
    v_mfma_f32_16x16x32_bf16 v[200:203], a[200:203], a[20:23], v[200:203]
    s_xor_b32 s81, s53, 4
    ds_read_b64_tr_b16 a[192:193], v9 offset:28672
    s_mul_i32 s81, s81, 2622464
    v_mfma_f32_16x16x32_bf16 v[208:211], a[200:203], a[24:27], v[208:211]
    s_add_u32 s81, s81, s63
    ds_read_b64_tr_b16 a[194:195], v9 offset:30720
    s_add_u32 s77, s61, s56
    v_mfma_f32_16x16x32_bf16 v[208:211], a[204:207], a[40:43], v[208:211]
    s_cmp_eq_u32 s40, s7
    s_cselect_b32 s81, s81, 0x70000000
    s_cselect_b32 s57, 4096, 0
    v_mfma_f32_16x16x32_bf16 v[216:219], a[204:207], a[44:47], v[216:219]
    buffer_load_dwordx4 v[80:83], v14, s[24:27], s81 offen offset:0 sc1
    v_mfma_f32_16x16x32_bf16 v[216:219], a[200:203], a[28:31], v[216:219]
    buffer_store_dwordx4 v[184:187], v14, s[24:27], s79 offen offset:1024 sc1
    v_mfma_f32_16x16x32_bf16 v[220:223], a[208:211], a[28:31], v[220:223]
    buffer_load_dwordx4 v[84:87], v14, s[24:27], s81 offen offset:1024 sc1
    v_mfma_f32_16x16x32_bf16 v[220:223], a[212:215], a[44:47], v[220:223]
    s_or_b32 s80, s80, s57
    ds_read_b64_tr_b16 a[196:197], v9 offset:24576
    s_xor_b32 s81, s53, 5
    v_mfma_f32_16x16x32_bf16 v[212:215], a[212:215], a[40:43], v[212:215]
    s_barrier
    v_mfma_f32_16x16x32_bf16 v[212:215], a[208:211], a[24:27], v[212:215]
    s_mul_i32 s81, s81, 2622464
    ds_read_b64_tr_b16 a[198:199], v9 offset:26624
    s_add_u32 s81, s81, s63
    v_mfma_f32_16x16x32_bf16 v[204:207], a[208:211], a[20:23], v[204:207]
    s_cmp_eq_u32 s41, s7
    s_cselect_b32 s81, s81, 0x70000000
    s_cselect_b32 s57, 8192, 0
    v_mfma_f32_16x16x32_bf16 v[204:207], a[212:215], a[36:39], v[204:207]
    buffer_load_dwordx4 v[88:91], v14, s[24:27], s81 offen offset:0 sc1
    v_mfma_f32_16x16x32_bf16 v[196:199], a[212:215], a[32:35], v[196:199]
    s_waitcnt lgkmcnt(2)
    ds_read_b64_tr_b16 a[200:201], v8 offset:20480
    v_bfe_u32 v20, v1, 2, 2
    v_mfma_f32_16x16x32_bf16 v[196:199], a[208:211], a[16:19], v[196:199]
    buffer_load_dwordx4 v[92:95], v14, s[24:27], s81 offen offset:1024 sc1
    v_mfma_f32_16x16x32_bf16 v[192:195], a[184:187], a[48:51], v[192:195]
    s_or_b32 s80, s80, s57
    ds_read_b64_tr_b16 a[202:203], v8 offset:22528
    v_lshrrev_b32 v21, 4, v1
    v_mfma_f32_16x16x32_bf16 v[192:195], a[188:191], a[64:67], v[192:195]
    s_xor_b32 s81, s53, 6
    ds_read_b64_tr_b16 a[204:205], v8 offset:16384
    v_cmp_eq_u32 vcc, v20, v21
    v_mfma_f32_16x16x32_bf16 v[200:203], a[188:191], a[68:71], v[200:203]
    s_mul_i32 s81, s81, 2622464
    ds_read_b64_tr_b16 a[206:207], v8 offset:18432
    v_and_b32 v20, 1, v1
    v_mfma_f32_16x16x32_bf16 v[200:203], a[184:187], a[52:55], v[200:203]
    s_add_u32 s81, s81, s63
    ds_read_b64_tr_b16 a[208:209], v9 offset:20480
    v_lshlrev_b32 v20, 4, v20
    v_mfma_f32_16x16x32_bf16 v[208:211], a[184:187], a[56:59], v[208:211]
    s_cmp_eq_u32 s42, s7
    s_cselect_b32 s81, s81, 0x70000000
    s_cselect_b32 s57, 16384, 0
    v_mfma_f32_16x16x32_bf16 v[208:211], a[188:191], a[72:75], v[208:211]
    buffer_load_dwordx4 v[96:99], v14, s[24:27], s81 offen offset:0 sc1
    v_mfma_f32_16x16x32_bf16 v[216:219], a[188:191], a[76:79], v[216:219]
    buffer_load_dwordx4 v[100:103], v14, s[24:27], s81 offen offset:1024 sc1
    v_mfma_f32_16x16x32_bf16 v[216:219], a[184:187], a[60:63], v[216:219]
    s_waitcnt lgkmcnt(3)
    ds_read_b64_tr_b16 a[210:211], v9 offset:22528
    v_mov_b32 v21, 0x3f80
    v_mfma_f32_16x16x32_bf16 v[220:223], a[192:195], a[60:63], v[220:223]
    s_or_b32 s80, s80, s57
    ds_read_b64_tr_b16 a[212:213], v9 offset:16384
    v_lshlrev_b32 v20, v20, v21
    v_mfma_f32_16x16x32_bf16 v[220:223], a[196:199], a[76:79], v[220:223]
    s_xor_b32 s81, s53, 7
    ds_read_b64_tr_b16 a[214:215], v9 offset:18432
    v_cndmask_b32 v20, 0, v20, vcc
    v_mfma_f32_16x16x32_bf16 v[212:215], a[196:199], a[72:75], v[212:215]
    s_mul_i32 s81, s81, 2622464
    ds_read_b64_tr_b16 a[184:185], v8 offset:12288
    v_and_b32 v21, 2, v1
    v_mfma_f32_16x16x32_bf16 v[212:215], a[192:195], a[56:59], v[212:215]
    s_add_u32 s81, s81, s63
    ds_read_b64_tr_b16 a[186:187], v8 offset:14336
    v_cmp_eq_u32 vcc, 0, v21
    v_mfma_f32_16x16x32_bf16 v[204:207], a[192:195], a[52:55], v[204:207]
    s_cmp_eq_u32 s43, s7
    s_cselect_b32 s81, s81, 0x70000000
    s_cselect_b32 s57, 32768, 0
    v_mfma_f32_16x16x32_bf16 v[204:207], a[196:199], a[68:71], v[204:207]
    buffer_load_dwordx4 v[104:107], v14, s[24:27], s81 offen offset:0 sc1
    v_mfma_f32_16x16x32_bf16 v[196:199], a[196:199], a[64:67], v[196:199]
    buffer_load_dwordx4 v[108:111], v14, s[24:27], s81 offen offset:1024 sc1
    v_mfma_f32_16x16x32_bf16 v[196:199], a[192:195], a[48:51], v[196:199]
    s_waitcnt lgkmcnt(3)
    ds_read_b64_tr_b16 a[188:189], v8 offset:8192
    v_cndmask_b32 v184, 0, v20, vcc
    v_mfma_f32_16x16x32_bf16 v[192:195], a[200:203], a[216:219], v[192:195]
    s_or_b32 s80, s80, s57
    ds_read_b64_tr_b16 a[190:191], v8 offset:10240
    v_sub_u32 v185, v20, v184
    v_mfma_f32_16x16x32_bf16 v[192:195], a[204:207], a[232:235], v[192:195]
    s_and_b32 s56, s70, 0x7ff
    ds_read_b64_tr_b16 a[192:193], v9 offset:12288
    v_mov_b32 v186, 0
    v_mfma_f32_16x16x32_bf16 v[200:203], a[204:207], a[236:239], v[200:203]
    s_sub_u32 s56, 2047, s56
    ds_read_b64_tr_b16 a[194:195], v9 offset:14336
    v_mov_b32 v187, 0
    v_mfma_f32_16x16x32_bf16 v[200:203], a[200:203], a[220:223], v[200:203]
    s_and_b32 s47, s71, 0x7ff
    ds_read_b64_tr_b16 a[196:197], v9 offset:8192
    v_mov_b32 v188, 0
    v_mfma_f32_16x16x32_bf16 v[208:211], a[200:203], a[224:227], v[208:211]
    s_sub_u32 s47, 2047, s47
    ds_read_b64_tr_b16 a[198:199], v9 offset:10240
    v_mov_b32 v189, 0
    v_mfma_f32_16x16x32_bf16 v[208:211], a[204:207], a[240:243], v[208:211]
    s_lshr_b32 s44, s64, 7
    v_mov_b32 v190, v184
    v_mov_b32 v191, v185
    v_mfma_f32_16x16x32_bf16 v[216:219], a[204:207], a[244:247], v[216:219]
    s_waitcnt lgkmcnt(5)
    v_add_u32 v20, 16, v5
    v_cmp_eq_u32 s[8:9], s56, v5
    v_mfma_f32_16x16x32_bf16 v[216:219], a[200:203], a[228:231], v[216:219]
    s_lshl_b32 s44, s44, 8
    ds_read_b64_tr_b16 a[200:201], v8 offset:4096
    v_cmp_eq_u32 s[10:11], s56, v20
    v_mfma_f32_16x16x32_bf16 v[220:223], a[208:211], a[228:231], v[220:223]
    s_bfe_u32 s56, s64, 0x10006
    ds_read_b64_tr_b16 a[202:203], v8 offset:6144
    v_cmp_eq_u32 s[20:21], s47, v5
    v_mfma_f32_16x16x32_bf16 v[220:223], a[212:215], a[244:247], v[220:223]
    s_or_b64 s[8:9], s[8:9], s[20:21]
    ds_read_b64_tr_b16 a[204:205], v8 offset:0
    v_cmp_eq_u32 s[22:23], s47, v20
    v_mfma_f32_16x16x32_bf16 v[212:215], a[212:215], a[240:243], v[212:215]
    s_or_b64 s[10:11], s[10:11], s[22:23]
    ds_read_b64_tr_b16 a[206:207], v8 offset:2048
    v_lshrrev_b32 v3, 1, v1
    v_mfma_f32_16x16x32_bf16 v[212:215], a[208:211], a[224:227], v[212:215]
    s_or_b32 s46, s8, s10
    v_min_u32 v3, 23, v3
    v_mul_u32_u24 v3, 2560, v3
    v_mfma_f32_16x16x32_bf16 v[204:207], a[208:211], a[220:223], v[204:207]
    s_lshl_b32 s56, s56, 3
    v_and_b32 v20, 1, v1
    v_lshl_add_u32 v3, v20, 2, v3
    v_mfma_f32_16x16x32_bf16 v[204:207], a[212:215], a[236:239], v[204:207]
    s_add_u32 s44, s44, s56
    s_add_u32 s44, s44, 3932320
    s_lshr_b32 s45, s68, 7
    v_mfma_f32_16x16x32_bf16 v[196:199], a[212:215], a[232:235], v[196:199]
    s_waitcnt lgkmcnt(3)
    s_xor_b32 s81, s53, 6
    s_mul_i32 s81, s81, 2622464
    v_mfma_f32_16x16x32_bf16 v[196:199], a[208:211], a[216:219], v[196:199]
    s_add_u32 s81, s81, s48
    ds_read_b64_tr_b16 a[208:209], v9 offset:4096
    s_lshl_b32 s45, s45, 8
    v_mfma_f32_16x16x32_bf16 v[192:195], a[184:187], a[152:155], v[192:195]
    s_bfe_u32 s56, s68, 0x10006
    ds_read_b64_tr_b16 a[210:211], v9 offset:6144
    s_lshl_b32 s56, s56, 3
    v_mfma_f32_16x16x32_bf16 v[192:195], a[188:191], a[168:171], v[192:195]
    s_add_u32 s45, s45, s56
    ds_read_b64_tr_b16 a[212:213], v9 offset:0
    s_add_u32 s45, s45, 3932320
    v_mfma_f32_16x16x32_bf16 v[200:203], a[188:191], a[172:175], v[200:203]
    s_cmp_lg_u32 s46, 0
    s_cselect_b32 s44, s44, 0x70000000
    s_cselect_b32 s45, s45, 0x70000000
    v_mfma_f32_16x16x32_bf16 v[200:203], a[184:187], a[156:159], v[200:203]
    buffer_load_dword v22, v3, s[24:27], s44 offen sc1
    v_mfma_f32_16x16x32_bf16 v[208:211], a[184:187], a[160:163], v[208:211]
    buffer_load_dword v23, v3, s[24:27], s45 offen sc1
    v_mfma_f32_16x16x32_bf16 v[208:211], a[188:191], a[176:179], v[208:211]
    s_load_dwordx16 s[28:43], s[86:87], s67 glc
    ds_read_b64_tr_b16 a[214:215], v9 offset:2048
    v_mfma_f32_16x16x32_bf16 v[216:219], a[188:191], a[180:183], v[216:219]
    s_cmp_eq_u32 s34, s7
    s_cselect_b32 s81, s81, 0x70000000
    s_cselect_b32 s57, 64, 0
    v_mfma_f32_16x16x32_bf16 v[216:219], a[184:187], a[164:167], v[216:219]
    buffer_load_dwordx4 v[128:131], v14, s[24:27], s81 offen offset:0 sc1
    v_mfma_f32_16x16x32_bf16 v[220:223], a[192:195], a[164:167], v[220:223]
    s_or_b32 s80, s80, s57
    ds_read_b64_tr_b16 a[184:185], v10 offset:45056
    v_mfma_f32_16x16x32_bf16 v[220:223], a[196:199], a[180:183], v[220:223]
    buffer_load_dwordx4 v[132:135], v14, s[24:27], s81 offen offset:1024 sc1
    v_mfma_f32_16x16x32_bf16 v[212:215], a[196:199], a[176:179], v[212:215]
    s_xor_b32 s81, s53, 7
    ds_read_b64_tr_b16 a[186:187], v10 offset:47104
    s_mul_i32 s81, s81, 2622464
    v_mfma_f32_16x16x32_bf16 v[212:215], a[192:195], a[160:163], v[212:215]
    s_add_u32 s81, s81, s48
    ds_read_b64_tr_b16 a[188:189], v10 offset:40960
    v_mfma_f32_16x16x32_bf16 v[204:207], a[192:195], a[156:159], v[204:207]
    s_cmp_eq_u32 s35, s7
    s_cselect_b32 s81, s81, 0x70000000
    s_cselect_b32 s57, 128, 0
    v_mfma_f32_16x16x32_bf16 v[204:207], a[196:199], a[172:175], v[204:207]
    buffer_load_dwordx4 v[136:139], v14, s[24:27], s81 offen offset:0 sc1
    v_mfma_f32_16x16x32_bf16 v[196:199], a[196:199], a[168:171], v[196:199]
    s_waitcnt lgkmcnt(3)
    ds_read_b64_tr_b16 a[190:191], v10 offset:43008
    s_or_b32 s80, s80, s57
    v_mfma_f32_16x16x32_bf16 v[196:199], a[192:195], a[152:155], v[196:199]
    ds_read_b64_tr_b16 a[192:193], v11 offset:45056
    v_mfma_f32_16x16x32_bf16 v[192:195], a[200:203], a[80:83], v[192:195]
    buffer_load_dwordx4 v[140:143], v14, s[24:27], s81 offen offset:1024 sc1
    v_mfma_f32_16x16x32_bf16 v[192:195], a[204:207], a[96:99], v[192:195]
    ds_read_b64_tr_b16 a[194:195], v11 offset:47104
    v_mfma_f32_16x16x32_bf16 v[200:203], a[204:207], a[100:103], v[200:203]
    ds_read_b64_tr_b16 a[196:197], v11 offset:40960
    v_mfma_f32_16x16x32_bf16 v[200:203], a[200:203], a[84:87], v[200:203]
    ds_read_b64_tr_b16 a[198:199], v11 offset:43008
    v_mfma_f32_16x16x32_bf16 v[208:211], a[200:203], a[88:91], v[208:211]
    v_mfma_f32_16x16x32_bf16 v[208:211], a[204:207], a[104:107], v[208:211]
    s_xor_b32 s56, s50, 1
    v_cvt_pk_bf16_f32 v192, v192, v193
    v_cvt_pk_bf16_f32 v193, v194, v195
    v_mfma_f32_16x16x32_bf16 v[216:219], a[204:207], a[108:111], v[216:219]
    s_lshl_b32 s56, s56, 12
    v_cvt_pk_bf16_f32 v200, v200, v201
    v_cvt_pk_bf16_f32 v201, v202, v203
    v_mfma_f32_16x16x32_bf16 v[216:219], a[200:203], a[92:95], v[216:219]
    s_add_u32 s78, s59, s56
    ds_read_b64_tr_b16 a[200:201], v10 offset:36864
    v_cvt_pk_bf16_f32 v208, v208, v209
    v_mfma_f32_16x16x32_bf16 v[220:223], a[208:211], a[92:95], v[220:223]
    s_add_u32 s79, s60, s56
    ds_read_b64_tr_b16 a[202:203], v10 offset:38912
    v_cvt_pk_bf16_f32 v209, v210, v211
    v_mfma_f32_16x16x32_bf16 v[220:223], a[212:215], a[108:111], v[220:223]
    s_xor_b32 s56, s50, 1
    ds_read_b64_tr_b16 a[204:205], v10 offset:32768
    v_cvt_pk_bf16_f32 v216, v216, v217
    v_mfma_f32_16x16x32_bf16 v[212:215], a[212:215], a[104:107], v[212:215]
    s_waitcnt lgkmcnt(3)
    ds_read_b64_tr_b16 a[206:207], v10 offset:34816
    v_cvt_pk_bf16_f32 v217, v218, v219
    v_mfma_f32_16x16x32_bf16 v[212:215], a[208:211], a[88:91], v[212:215]
    s_lshl_b32 s56, s56, 10
    v_cvt_pk_bf16_f32 v218, v220, v221
    v_cvt_pk_bf16_f32 v219, v222, v223
    v_mfma_f32_16x16x32_bf16 v[204:207], a[208:211], a[84:87], v[204:207]
    v_lshlrev_b32 v220, 16, v46
    v_mfma_f32_16x16x32_bf16 v[204:207], a[212:215], a[100:103], v[204:207]
    s_waitcnt vmcnt(13)
    v_and_b32 v221, 0xffff0000, v46
    v_cvt_pk_bf16_f32 v210, v212, v213
    v_mfma_f32_16x16x32_bf16 v[196:199], a[212:215], a[96:99], v[196:199]
    buffer_store_dword v6, v7, s[24:27], s77 offen offset:16 sc1
    v_mfma_f32_16x16x32_bf16 v[196:199], a[208:211], a[80:83], v[196:199]
    s_add_u32 s77, s61, s56
    ds_read_b64_tr_b16 a[208:209], v11 offset:36864
    v_cvt_pk_bf16_f32 v202, v204, v205
    v_mfma_f32_16x16x32_bf16 v[224:227], a[184:187], a[128:131], v[224:227]
    ds_read_b64_tr_b16 a[210:211], v11 offset:38912
    v_cvt_pk_bf16_f32 v203, v206, v207
    v_mfma_f32_16x16x32_bf16 v[224:227], a[188:191], a[0:3], v[224:227]
    ds_read_b64_tr_b16 a[212:213], v11 offset:32768
    v_cvt_pk_bf16_f32 v194, v196, v197
    v_mfma_f32_16x16x32_bf16 v[232:235], a[188:191], a[4:7], v[232:235]
    ds_read_b64_tr_b16 a[214:215], v11 offset:34816
    v_cvt_pk_bf16_f32 v195, v198, v199
    v_mfma_f32_16x16x32_bf16 v[232:235], a[184:187], a[132:135], v[232:235]
    buffer_store_dwordx4 v[192:195], v14, s[24:27], s78 offen offset:0 sc1
    v_cvt_pk_bf16_f32 v211, v214, v215
    v_mfma_f32_16x16x32_bf16 v[236:239], a[192:195], a[132:135], v[236:239]
    ds_read_b64_tr_b16 a[184:185], v10 offset:28672
    v_lshlrev_b32 v192, 16, v24
    v_mfma_f32_16x16x32_bf16 v[236:239], a[196:199], a[4:7], v[236:239]
    s_waitcnt lgkmcnt(5)
    ds_read_b64_tr_b16 a[186:187], v10 offset:30720
    v_and_b32 v193, 0xffff0000, v24
    v_mfma_f32_16x16x32_bf16 v[228:231], a[196:199], a[0:3], v[228:231]
    ds_read_b64_tr_b16 a[188:189], v10 offset:24576
    v_lshlrev_b32 v194, 16, v25
    v_mfma_f32_16x16x32_bf16 v[228:231], a[192:195], a[128:131], v[228:231]
    buffer_store_dwordx4 v[200:203], v14, s[24:27], s78 offen offset:1024 sc1
    v_and_b32 v195, 0xffff0000, v25
    v_mfma_f32_16x16x32_bf16 v[224:227], a[200:203], a[16:19], v[224:227]
    ds_read_b64_tr_b16 a[190:191], v10 offset:26624
    v_lshlrev_b32 v196, 16, v26
    v_mfma_f32_16x16x32_bf16 v[224:227], a[204:207], a[32:35], v[224:227]
    s_waitcnt lgkmcnt(4)
    ds_read_b64_tr_b16 a[192:193], v11 offset:28672
    v_and_b32 v197, 0xffff0000, v26
    v_mfma_f32_16x16x32_bf16 v[232:235], a[204:207], a[36:39], v[232:235]
    ds_read_b64_tr_b16 a[194:195], v11 offset:30720
    v_lshlrev_b32 v212, 16, v42
    v_mfma_f32_16x16x32_bf16 v[232:235], a[200:203], a[20:23], v[232:235]
    ds_read_b64_tr_b16 a[196:197], v11 offset:24576
    v_and_b32 v213, 0xffff0000, v42
    v_mfma_f32_16x16x32_bf16 v[236:239], a[208:211], a[20:23], v[236:239]
    ds_read_b64_tr_b16 a[198:199], v11 offset:26624
    v_lshlrev_b32 v198, 16, v27
    v_mfma_f32_16x16x32_bf16 v[236:239], a[212:215], a[36:39], v[236:239]
    s_waitcnt lgkmcnt(5)
    ds_read_b64_tr_b16 a[200:201], v10 offset:20480
    v_and_b32 v199, 0xffff0000, v27
    v_mfma_f32_16x16x32_bf16 v[228:231], a[212:215], a[32:35], v[228:231]
    ds_read_b64_tr_b16 a[202:203], v10 offset:22528
    v_lshlrev_b32 v214, 16, v43
    v_mfma_f32_16x16x32_bf16 v[228:231], a[208:211], a[16:19], v[228:231]
    buffer_store_dwordx4 v[208:211], v14, s[24:27], s79 offen offset:0 sc1
    v_and_b32 v215, 0xffff0000, v43
    v_mfma_f32_16x16x32_bf16 v[224:227], a[184:187], a[48:51], v[224:227]
    s_waitcnt lgkmcnt(5)
    ds_read_b64_tr_b16 a[204:205], v10 offset:16384
    v_lshlrev_b32 v208, 16, v40
    v_mfma_f32_16x16x32_bf16 v[224:227], a[188:191], a[64:67], v[224:227]
    s_waitcnt lgkmcnt(5)
    ds_read_b64_tr_b16 a[206:207], v10 offset:18432
    v_and_b32 v209, 0xffff0000, v40
    v_mfma_f32_16x16x32_bf16 v[232:235], a[188:191], a[68:71], v[232:235]
    s_load_dwordx16 s[28:43], s[86:87], s67 glc
    ds_read_b64_tr_b16 a[208:209], v11 offset:20480
    v_lshlrev_b32 v210, 16, v41
    v_mfma_f32_16x16x32_bf16 v[232:235], a[184:187], a[52:55], v[232:235]
    s_waitcnt lgkmcnt(5)
    ds_read_b64_tr_b16 a[210:211], v11 offset:22528
    v_and_b32 v211, 0xffff0000, v41
    v_mfma_f32_16x16x32_bf16 v[236:239], a[192:195], a[52:55], v[236:239]
    ds_read_b64_tr_b16 a[212:213], v11 offset:16384
    v_lshlrev_b32 v200, 16, v28
    v_mfma_f32_16x16x32_bf16 v[236:239], a[196:199], a[68:71], v[236:239]
    s_waitcnt lgkmcnt(5)
    ds_read_b64_tr_b16 a[214:215], v11 offset:18432
    v_and_b32 v201, 0xffff0000, v28
    v_mfma_f32_16x16x32_bf16 v[228:231], a[196:199], a[64:67], v[228:231]
    s_xor_b32 s81, s53, 4
    ds_read_b64_tr_b16 a[184:185], v10 offset:12288
    v_lshlrev_b32 v202, 16, v29
    v_mfma_f32_16x16x32_bf16 v[228:231], a[192:195], a[48:51], v[228:231]
    buffer_store_dwordx4 v[216:219], v14, s[24:27], s79 offen offset:1024 sc1
    v_and_b32 v203, 0xffff0000, v29
    v_mfma_f32_16x16x32_bf16 v[224:227], a[200:203], a[216:219], v[224:227]
pg_16:
    s_cbranch_execz pg_back
    s_waitcnt lgkmcnt(5)
    ds_read_b64_tr_b16 a[186:187], v10 offset:14336
    v_lshlrev_b32 v216, 16, v44
    v_mfma_f32_16x16x32_bf16 v[224:227], a[204:207], a[232:235], v[224:227]
    s_mul_i32 s81, s81, 2622464
    ds_read_b64_tr_b16 a[188:189], v10 offset:8192
    v_and_b32 v217, 0xffff0000, v44
    v_mfma_f32_16x16x32_bf16 v[232:235], a[204:207], a[236:239], v[232:235]
    s_waitcnt lgkmcnt(5)
    ds_read_b64_tr_b16 a[190:191], v10 offset:10240
    v_lshlrev_b32 v218, 16, v45
    v_mfma_f32_16x16x32_bf16 v[232:235], a[200:203], a[220:223], v[232:235]
    s_add_u32 s81, s81, s48
    ds_read_b64_tr_b16 a[192:193], v11 offset:12288
    v_and_b32 v219, 0xffff0000, v45
    v_mfma_f32_16x16x32_bf16 v[236:239], a[208:211], a[220:223], v[236:239]
    s_waitcnt lgkmcnt(5)
    ds_read_b64_tr_b16 a[194:195], v11 offset:14336
    v_lshlrev_b32 v204, 16, v30
    v_mfma_f32_16x16x32_bf16 v[236:239], a[212:215], a[236:239], v[236:239]
    s_cmp_eq_u32 s32, s7
    s_cselect_b32 s81, s81, 0x70000000
    s_cselect_b32 s57, 16, 0
    ds_read_b64_tr_b16 a[196:197], v11 offset:8192
    v_mfma_f32_16x16x32_bf16 v[228:231], a[212:215], a[232:235], v[228:231]
    s_or_b32 s80, s80, s57
    ds_read_b64_tr_b16 a[198:199], v11 offset:10240
    v_and_b32 v205, 0xffff0000, v30
    v_mfma_f32_16x16x32_bf16 v[228:231], a[208:211], a[216:219], v[228:231]
    s_waitcnt lgkmcnt(6)
    ds_read_b64_tr_b16 a[200:201], v10 offset:4096
    v_lshlrev_b32 v206, 16, v31
    v_mfma_f32_16x16x32_bf16 v[224:227], a[184:187], a[152:155], v[224:227]
    s_waitcnt lgkmcnt(5)
    ds_read_b64_tr_b16 a[202:203], v10 offset:6144
    v_and_b32 v207, 0xffff0000, v31
    v_mfma_f32_16x16x32_bf16 v[224:227], a[188:191], a[168:171], v[224:227]
    ds_read_b64_tr_b16 a[204:205], v10 offset:0
    v_lshlrev_b32 v222, 16, v47
    v_mfma_f32_16x16x32_bf16 v[232:235], a[188:191], a[172:175], v[232:235]
    ds_read_b64_tr_b16 a[206:207], v10 offset:2048
    v_and_b32 v223, 0xffff0000, v47
    v_mfma_f32_16x16x32_bf16 v[232:235], a[184:187], a[156:159], v[232:235]
    s_waitcnt lgkmcnt(6)
    buffer_load_dwordx4 v[144:147], v14, s[24:27], s81 offen offset:0 sc1
    v_mfma_f32_16x16x32_bf16 v[236:239], a[192:195], a[156:159], v[236:239]
    s_waitcnt lgkmcnt(4)
    ds_read_b64_tr_b16 a[208:209], v11 offset:4096
    v_mfma_f32_16x16x32_bf16 v[236:239], a[196:199], a[172:175], v[236:239]
    s_xor_b32 s56, s50, 0
    ds_read_b64_tr_b16 a[210:211], v11 offset:6144
    ds_read_b64_tr_b16 a[212:213], v11 offset:0
    v_mfma_f32_16x16x32_bf16 v[228:231], a[196:199], a[168:171], v[228:231]
    buffer_load_dwordx4 v[148:151], v14, s[24:27], s81 offen offset:1024 sc1
    ds_read_b64_tr_b16 a[214:215], v11 offset:2048
    v_mfma_f32_16x16x32_bf16 v[228:231], a[192:195], a[152:155], v[228:231]
    s_waitcnt lgkmcnt(6)
    ds_read_b64_tr_b16 a[184:185], v10 offset:45056
    s_xor_b32 s81, s53, 5
    v_mfma_f32_16x16x32_bf16 v[224:227], a[200:203], a[80:83], v[224:227]
    s_waitcnt lgkmcnt(5)
    ds_read_b64_tr_b16 a[186:187], v10 offset:47104
    s_mul_i32 s81, s81, 2622464
    v_mfma_f32_16x16x32_bf16 v[224:227], a[204:207], a[96:99], v[224:227]
    s_add_u32 s81, s81, s48
    ds_read_b64_tr_b16 a[188:189], v10 offset:40960
    v_mfma_f32_16x16x32_bf16 v[232:235], a[204:207], a[100:103], v[232:235]
    s_cmp_eq_u32 s33, s7
    s_cselect_b32 s81, s81, 0x70000000
    s_cselect_b32 s57, 32, 0
    ds_read_b64_tr_b16 a[190:191], v10 offset:43008
    v_mfma_f32_16x16x32_bf16 v[232:235], a[200:203], a[84:87], v[232:235]
    s_waitcnt lgkmcnt(6)
    buffer_load_dwordx4 v[152:155], v14, s[24:27], s81 offen offset:0 sc1
    v_mfma_f32_16x16x32_bf16 v[236:239], a[208:211], a[84:87], v[236:239]
    s_waitcnt lgkmcnt(4)
    ds_read_b64_tr_b16 a[192:193], v11 offset:45056
    v_cvt_pk_bf16_f32 v224, v224, v225
    v_mfma_f32_16x16x32_bf16 v[236:239], a[212:215], a[100:103], v[236:239]
    buffer_load_dwordx4 v[156:159], v14, s[24:27], s81 offen offset:1024 sc1
    ds_read_b64_tr_b16 a[194:195], v11 offset:47104
    v_mfma_f32_16x16x32_bf16 v[228:231], a[212:215], a[96:99], v[228:231]
    s_or_b32 s80, s80, s57
    ds_read_b64_tr_b16 a[196:197], v11 offset:40960
    v_cvt_pk_bf16_f32 v225, v226, v227
    ds_read_b64_tr_b16 a[198:199], v11 offset:43008
    v_mfma_f32_16x16x32_bf16 v[228:231], a[208:211], a[80:83], v[228:231]
    s_waitcnt lgkmcnt(6)
    ds_read_b64_tr_b16 a[200:201], v10 offset:36864
    v_cvt_pk_bf16_f32 v232, v232, v233
    v_mfma_f32_16x16x32_bf16 v[240:243], a[184:187], a[136:139], v[240:243]
    s_waitcnt lgkmcnt(5)
    ds_read_b64_tr_b16 a[202:203], v10 offset:38912
    v_cvt_pk_bf16_f32 v233, v234, v235
    v_mfma_f32_16x16x32_bf16 v[240:243], a[188:191], a[8:11], v[240:243]
    s_lshl_b32 s56, s56, 12
    ds_read_b64_tr_b16 a[204:205], v10 offset:32768
    v_cvt_pk_bf16_f32 v226, v228, v229
    v_mfma_f32_16x16x32_bf16 v[248:251], a[188:191], a[12:15], v[248:251]
    s_add_u32 s78, s59, s56
    ds_read_b64_tr_b16 a[206:207], v10 offset:34816
    v_cvt_pk_bf16_f32 v227, v230, v231
    v_mfma_f32_16x16x32_bf16 v[248:251], a[184:187], a[140:143], v[248:251]
    s_waitcnt lgkmcnt(6)
    ds_read_b64_tr_b16 a[208:209], v11 offset:36864
    v_cvt_pk_bf16_f32 v234, v236, v237
    v_mfma_f32_16x16x32_bf16 v[252:255], a[192:195], a[140:143], v[252:255]
    s_waitcnt lgkmcnt(5)
    ds_read_b64_tr_b16 a[210:211], v11 offset:38912
    v_cvt_pk_bf16_f32 v235, v238, v239
    v_mfma_f32_16x16x32_bf16 v[252:255], a[196:199], a[12:15], v[252:255]
    buffer_store_dwordx4 v[224:227], v14, s[24:27], s78 offen offset:0 sc1
    v_mfma_f32_16x16x32_bf16 v[244:247], a[196:199], a[8:11], v[244:247]
    buffer_store_dwordx4 v[232:235], v14, s[24:27], s78 offen offset:1024 sc1
    v_mfma_f32_16x16x32_bf16 v[244:247], a[192:195], a[136:139], v[244:247]
    s_waitcnt lgkmcnt(4)
    ds_read_b64_tr_b16 a[212:213], v11 offset:32768
    s_add_u32 s79, s60, s56
    ds_read_b64_tr_b16 a[214:215], v11 offset:34816
    v_mfma_f32_16x16x32_bf16 v[240:243], a[200:203], a[24:27], v[240:243]
    s_waitcnt lgkmcnt(4)
    ds_read_b64_tr_b16 a[184:185], v10 offset:28672
    v_mfma_f32_16x16x32_bf16 v[240:243], a[204:207], a[40:43], v[240:243]
    ds_read_b64_tr_b16 a[186:187], v10 offset:30720
    ds_read_b64_tr_b16 a[188:189], v10 offset:24576
    v_mfma_f32_16x16x32_bf16 v[248:251], a[204:207], a[44:47], v[248:251]
    ds_read_b64_tr_b16 a[190:191], v10 offset:26624
    v_mfma_f32_16x16x32_bf16 v[248:251], a[200:203], a[28:31], v[248:251]
    s_waitcnt lgkmcnt(6)
    ds_read_b64_tr_b16 a[192:193], v11 offset:28672
    v_mfma_f32_16x16x32_bf16 v[252:255], a[208:211], a[28:31], v[252:255]
    s_waitcnt lgkmcnt(5)
    ds_read_b64_tr_b16 a[194:195], v11 offset:30720
    v_mfma_f32_16x16x32_bf16 v[252:255], a[212:215], a[44:47], v[252:255]
    ds_read_b64_tr_b16 a[196:197], v11 offset:24576
    v_mfma_f32_16x16x32_bf16 v[244:247], a[212:215], a[40:43], v[244:247]
    ds_read_b64_tr_b16 a[198:199], v11 offset:26624
    v_mfma_f32_16x16x32_bf16 v[244:247], a[208:211], a[24:27], v[244:247]
    s_waitcnt lgkmcnt(6)
    ds_read_b64_tr_b16 a[200:201], v10 offset:20480
    v_mfma_f32_16x16x32_bf16 v[240:243], a[184:187], a[56:59], v[240:243]
    s_waitcnt lgkmcnt(5)
    ds_read_b64_tr_b16 a[202:203], v10 offset:22528
    v_mfma_f32_16x16x32_bf16 v[240:243], a[188:191], a[72:75], v[240:243]
    ds_read_b64_tr_b16 a[204:205], v10 offset:16384
    v_mfma_f32_16x16x32_bf16 v[248:251], a[188:191], a[76:79], v[248:251]
    s_xor_b32 s81, s53, 2
    ds_read_b64_tr_b16 a[206:207], v10 offset:18432
    s_mul_i32 s81, s81, 2622464
    v_mfma_f32_16x16x32_bf16 v[248:251], a[184:187], a[60:63], v[248:251]
    s_waitcnt lgkmcnt(6)
    ds_read_b64_tr_b16 a[208:209], v11 offset:20480
    s_add_u32 s81, s81, s48
    v_mfma_f32_16x16x32_bf16 v[252:255], a[192:195], a[60:63], v[252:255]
    s_waitcnt lgkmcnt(5)
    ds_read_b64_tr_b16 a[210:211], v11 offset:22528
    v_mfma_f32_16x16x32_bf16 v[252:255], a[196:199], a[76:79], v[252:255]
    ds_read_b64_tr_b16 a[212:213], v11 offset:16384
    v_mfma_f32_16x16x32_bf16 v[244:247], a[196:199], a[72:75], v[244:247]
    s_cmp_eq_u32 s30, s7
    s_cselect_b32 s81, s81, 0x70000000
    s_cselect_b32 s57, 4, 0
    ds_read_b64_tr_b16 a[214:215], v11 offset:18432
    v_mfma_f32_16x16x32_bf16 v[244:247], a[192:195], a[56:59], v[244:247]
    s_waitcnt lgkmcnt(6)
    ds_read_b64_tr_b16 a[184:185], v10 offset:12288
    s_or_b32 s80, s80, s57
    v_mfma_f32_16x16x32_bf16 v[240:243], a[200:203], a[224:227], v[240:243]
    s_waitcnt lgkmcnt(5)
    ds_read_b64_tr_b16 a[186:187], v10 offset:14336
    v_mfma_f32_16x16x32_bf16 v[240:243], a[204:207], a[240:243], v[240:243]
    ds_read_b64_tr_b16 a[188:189], v10 offset:8192
    v_mfma_f32_16x16x32_bf16 v[248:251], a[204:207], a[244:247], v[248:251]
    ds_read_b64_tr_b16 a[190:191], v10 offset:10240
    v_mfma_f32_16x16x32_bf16 v[248:251], a[200:203], a[228:231], v[248:251]
    s_waitcnt lgkmcnt(6)
    ds_read_b64_tr_b16 a[192:193], v11 offset:12288
    v_mfma_f32_16x16x32_bf16 v[252:255], a[208:211], a[228:231], v[252:255]
    s_waitcnt lgkmcnt(5)
    ds_read_b64_tr_b16 a[194:195], v11 offset:14336
    v_mfma_f32_16x16x32_bf16 v[252:255], a[212:215], a[244:247], v[252:255]
    ds_read_b64_tr_b16 a[196:197], v11 offset:8192
    v_mfma_f32_16x16x32_bf16 v[244:247], a[212:215], a[240:243], v[244:247]
    ds_read_b64_tr_b16 a[198:199], v11 offset:10240
    v_mfma_f32_16x16x32_bf16 v[244:247], a[208:211], a[224:227], v[244:247]
    s_waitcnt lgkmcnt(6)
    ds_read_b64_tr_b16 a[200:201], v10 offset:4096
    v_mfma_f32_16x16x32_bf16 v[240:243], a[184:187], a[160:163], v[240:243]
    s_waitcnt lgkmcnt(5)
    buffer_load_dwordx4 v[160:163], v14, s[24:27], s81 offen offset:0 sc1
    v_mfma_f32_16x16x32_bf16 v[240:243], a[188:191], a[176:179], v[240:243]
    s_waitcnt vmcnt(7)
    ds_read_b64_tr_b16 a[202:203], v10 offset:6144
    ds_read_b64_tr_b16 a[204:205], v10 offset:0
    v_mfma_f32_16x16x32_bf16 v[248:251], a[188:191], a[180:183], v[248:251]
    ds_read_b64_tr_b16 a[206:207], v10 offset:2048
    v_mfma_f32_16x16x32_bf16 v[248:251], a[184:187], a[164:167], v[248:251]
    s_waitcnt lgkmcnt(6)
    ds_read_b64_tr_b16 a[208:209], v11 offset:4096
    v_mfma_f32_16x16x32_bf16 v[252:255], a[192:195], a[164:167], v[252:255]
    s_waitcnt lgkmcnt(5)
    ds_read_b64_tr_b16 a[210:211], v11 offset:6144
    v_mfma_f32_16x16x32_bf16 v[252:255], a[196:199], a[180:183], v[252:255]
    buffer_store_dword v6, v7, s[24:27], s77 offen offset:8 sc1
    ds_read_b64_tr_b16 a[212:213], v11 offset:0
    v_mfma_f32_16x16x32_bf16 v[244:247], a[196:199], a[176:179], v[244:247]
    buffer_load_dwordx4 v[164:167], v14, s[24:27], s81 offen offset:1024 sc1
    ds_read_b64_tr_b16 a[214:215], v11 offset:2048
    v_mfma_f32_16x16x32_bf16 v[244:247], a[192:195], a[160:163], v[244:247]
    s_waitcnt lgkmcnt(6)
    s_xor_b32 s81, s53, 3
    s_mul_i32 s81, s81, 2622464
    v_mfma_f32_16x16x32_bf16 v[240:243], a[200:203], a[88:91], v[240:243]
    s_waitcnt lgkmcnt(4)
    s_add_u32 s81, s81, s48
    v_mfma_f32_16x16x32_bf16 v[240:243], a[204:207], a[104:107], v[240:243]
    s_cmp_eq_u32 s31, s7
    s_cselect_b32 s81, s81, 0x70000000
    s_cselect_b32 s57, 8, 0
    v_mfma_f32_16x16x32_bf16 v[248:251], a[204:207], a[108:111], v[248:251]
    buffer_load_dwordx4 v[168:171], v14, s[24:27], s81 offen offset:0 sc1
    v_mfma_f32_16x16x32_bf16 v[248:251], a[200:203], a[92:95], v[248:251]
    s_waitcnt lgkmcnt(2)
    buffer_load_dwordx4 v[172:175], v14, s[24:27], s81 offen offset:1024 sc1
    v_mfma_f32_16x16x32_bf16 v[252:255], a[208:211], a[92:95], v[252:255]
    s_waitcnt lgkmcnt(0)
    s_or_b32 s80, s80, s57
    s_xor_b32 s81, s53, 1
    v_mfma_f32_16x16x32_bf16 v[252:255], a[212:215], a[108:111], v[252:255]
    s_mul_i32 s81, s81, 2622464
    s_add_u32 s81, s81, s48
    v_mfma_f32_16x16x32_bf16 v[244:247], a[212:215], a[104:107], v[244:247]
    s_cmp_eq_u32 s29, s7
    s_cselect_b32 s81, s81, 0x70000000
    s_cselect_b32 s57, 2, 0
    v_mfma_f32_16x16x32_bf16 v[244:247], a[208:211], a[88:91], v[244:247]
    buffer_load_dwordx4 v[176:179], v14, s[24:27], s81 offen offset:0 sc1
    s_or_b32 s80, s80, s57
    buffer_load_dwordx4 v[180:183], v14, s[24:27], s81 offen offset:1024 sc1
    s_load_dwordx16 s[28:43], s[86:87], s67 glc
post_code:
    s_waitcnt vmcnt(9)
    v_mfma_f32_16x16x32_bf16 v[240:243], v[184:187], v[128:131], v[240:243]
    v_mfma_f32_16x16x32_bf16 v[244:247], v[188:191], v[128:131], v[244:247]
    v_mfma_f32_16x16x32_bf16 v[248:251], v[184:187], v[132:135], v[248:251]
    v_mfma_f32_16x16x32_bf16 v[252:255], v[188:191], v[132:135], v[252:255]
    v_mfma_f32_16x16x32_bf16 v[240:243], v[184:187], v[136:139], v[240:243]
    v_mfma_f32_16x16x32_bf16 v[244:247], v[188:191], v[136:139], v[244:247]
    v_mfma_f32_16x16x32_bf16 v[248:251], v[184:187], v[140:143], v[248:251]
    v_mfma_f32_16x16x32_bf16 v[252:255], v[188:191], v[140:143], v[252:255]
    v_mfma_f32_16x16x32_bf16 v[240:243], v[184:187], v[144:147], v[240:243]
    v_mfma_f32_16x16x32_bf16 v[244:247], v[188:191], v[144:147], v[244:247]
    v_mfma_f32_16x16x32_bf16 v[248:251], v[184:187], v[148:151], v[248:251]
    v_mfma_f32_16x16x32_bf16 v[252:255], v[188:191], v[148:151], v[252:255]
    v_mfma_f32_16x16x32_bf16 v[240:243], v[184:187], v[152:155], v[240:243]
    v_mfma_f32_16x16x32_bf16 v[244:247], v[188:191], v[152:155], v[244:247]
    v_mfma_f32_16x16x32_bf16 v[248:251], v[184:187], v[156:159], v[248:251]
    v_mfma_f32_16x16x32_bf16 v[252:255], v[188:191], v[156:159], v[252:255]
    s_xor_b32 s56, s50, 0
    s_lshl_b32 s56, s56, 10
    s_add_u32 s77, s61, s56
    s_waitcnt vmcnt(7)
    buffer_store_dword v6, v7, s[24:27], s77 offen offset:0 sc1
    s_cmp_lg_u32 s46, 0
    s_cbranch_scc1 routed_a
routed_a_ret:
    s_and_b32 s60, s80, 14
    s_andn2_b32 s79, s80, 14
    s_mov_b32 s47, 2
    s_andn2_b32 s78, 2, s66
    s_cbranch_scc1 ev_loop
    s_load_dwordx16 s[28:43], s[86:87], s67 glc
    v_mfma_f32_16x16x32_bf16 v[112:115], v[184:187], v[56:59], v[112:115]
    v_mfma_f32_16x16x32_bf16 v[116:119], v[188:191], v[56:59], v[116:119]
    v_mfma_f32_16x16x32_bf16 v[120:123], v[184:187], v[60:63], v[120:123]
    v_mfma_f32_16x16x32_bf16 v[124:127], v[188:191], v[60:63], v[124:127]
    v_mfma_f32_16x16x32_bf16 v[112:115], v[184:187], v[64:67], v[112:115]
    v_mfma_f32_16x16x32_bf16 v[116:119], v[188:191], v[64:67], v[116:119]
    v_mfma_f32_16x16x32_bf16 v[120:123], v[184:187], v[68:71], v[120:123]
    v_mfma_f32_16x16x32_bf16 v[124:127], v[188:191], v[68:71], v[124:127]
    v_mfma_f32_16x16x32_bf16 v[112:115], v[184:187], v[72:75], v[112:115]
    v_mfma_f32_16x16x32_bf16 v[116:119], v[188:191], v[72:75], v[116:119]
    v_mfma_f32_16x16x32_bf16 v[120:123], v[184:187], v[76:79], v[120:123]
    v_mfma_f32_16x16x32_bf16 v[124:127], v[188:191], v[76:79], v[124:127]
    v_mfma_f32_16x16x32_bf16 v[112:115], v[184:187], v[80:83], v[112:115]
    v_mfma_f32_16x16x32_bf16 v[116:119], v[188:191], v[80:83], v[116:119]
    v_mfma_f32_16x16x32_bf16 v[120:123], v[184:187], v[84:87], v[120:123]
    v_mfma_f32_16x16x32_bf16 v[124:127], v[188:191], v[84:87], v[124:127]
    v_mfma_f32_16x16x32_bf16 v[112:115], v[184:187], v[88:91], v[112:115]
    v_mfma_f32_16x16x32_bf16 v[116:119], v[188:191], v[88:91], v[116:119]
    v_mfma_f32_16x16x32_bf16 v[120:123], v[184:187], v[92:95], v[120:123]
    v_mfma_f32_16x16x32_bf16 v[124:127], v[188:191], v[92:95], v[124:127]
    v_mfma_f32_16x16x32_bf16 v[112:115], v[184:187], v[96:99], v[112:115]
    v_mfma_f32_16x16x32_bf16 v[116:119], v[188:191], v[96:99], v[116:119]
    v_mfma_f32_16x16x32_bf16 v[120:123], v[184:187], v[100:103], v[120:123]
    v_mfma_f32_16x16x32_bf16 v[124:127], v[188:191], v[100:103], v[124:127]
    v_mfma_f32_16x16x32_bf16 v[112:115], v[184:187], v[104:107], v[112:115]
    v_mfma_f32_16x16x32_bf16 v[116:119], v[188:191], v[104:107], v[116:119]
    v_mfma_f32_16x16x32_bf16 v[120:123], v[184:187], v[108:111], v[120:123]
    v_mfma_f32_16x16x32_bf16 v[124:127], v[188:191], v[108:111], v[124:127]
ev_loop:
    s_mov_b32 s59, 0
    s_cmp_ge_u32 s80, 0xff00
    s_cbranch_scc1 ev_own
    s_cmp_eq_u32 s43, s7
    s_addc_u32 s59, s59, s59
    s_cmp_eq_u32 s42, s7
    s_addc_u32 s59, s59, s59
    s_cmp_eq_u32 s41, s7
    s_addc_u32 s59, s59, s59
    s_cmp_eq_u32 s40, s7
    s_addc_u32 s59, s59, s59
    s_cmp_eq_u32 s39, s7
    s_addc_u32 s59, s59, s59
    s_cmp_eq_u32 s38, s7
    s_addc_u32 s59, s59, s59
    s_cmp_eq_u32 s37, s7
    s_addc_u32 s59, s59, s59
    s_cmp_eq_u32 s36, s7
    s_addc_u32 s59, s59, s59
ev_own:
    s_cmp_eq_u32 s35, s7
    s_addc_u32 s59, s59, s59
    s_cmp_eq_u32 s34, s7
    s_addc_u32 s59, s59, s59
    s_cmp_eq_u32 s33, s7
    s_addc_u32 s59, s59, s59
    s_cmp_eq_u32 s32, s7
    s_addc_u32 s59, s59, s59
    s_cmp_eq_u32 s31, s7
    s_addc_u32 s59, s59, s59
    s_cmp_eq_u32 s30, s7
    s_addc_u32 s59, s59, s59
    s_cmp_eq_u32 s29, s7
    s_addc_u32 s59, s59, s59
    s_cmp_eq_u32 s28, s7
    s_addc_u32 s59, s59, s59
    s_andn2_b32 s59, s59, s80
    s_cbranch_scc0 ev_issued
    s_or_b32 s80, s80, s59
    s_or_b32 s60, s60, s59
    s_mov_b32 s47, 0
    s_bitcmp1_b32 s59, 1
    s_cbranch_scc0 ev_i1
    s_xor_b32 s81, s53, 1
    s_mul_i32 s81, s81, 2622464
    s_add_u32 s81, s81, s48
    buffer_load_dwordx4 v[176:179], v14, s[24:27], s81 offen offset:0 sc1
    buffer_load_dwordx4 v[180:183], v14, s[24:27], s81 offen offset:1024 sc1
ev_i1:
    s_bitcmp1_b32 s59, 2
    s_cbranch_scc0 ev_i2
    s_xor_b32 s81, s53, 2
    s_mul_i32 s81, s81, 2622464
    s_add_u32 s81, s81, s48
    buffer_load_dwordx4 v[160:163], v14, s[24:27], s81 offen offset:0 sc1
    buffer_load_dwordx4 v[164:167], v14, s[24:27], s81 offen offset:1024 sc1
ev_i2:
    s_bitcmp1_b32 s59, 3
    s_cbranch_scc0 ev_i3
    s_xor_b32 s81, s53, 3
    s_mul_i32 s81, s81, 2622464
    s_add_u32 s81, s81, s48
    buffer_load_dwordx4 v[168:171], v14, s[24:27], s81 offen offset:0 sc1
    buffer_load_dwordx4 v[172:175], v14, s[24:27], s81 offen offset:1024 sc1
ev_i3:
    s_lshr_b32 s56, s59, 4
    s_cbranch_scc0 ev_issued
    s_bitcmp1_b32 s59, 4
    s_cbranch_scc0 ev_i4
    s_xor_b32 s81, s53, 4
    s_mul_i32 s81, s81, 2622464
    s_add_u32 s81, s81, s48
    buffer_load_dwordx4 v[144:147], v14, s[24:27], s81 offen offset:0 sc1
    buffer_load_dwordx4 v[148:151], v14, s[24:27], s81 offen offset:1024 sc1
ev_i4:
    s_bitcmp1_b32 s59, 5
    s_cbranch_scc0 ev_i5
    s_xor_b32 s81, s53, 5
    s_mul_i32 s81, s81, 2622464
    s_add_u32 s81, s81, s48
    buffer_load_dwordx4 v[152:155], v14, s[24:27], s81 offen offset:0 sc1
    buffer_load_dwordx4 v[156:159], v14, s[24:27], s81 offen offset:1024 sc1
ev_i5:
    s_bitcmp1_b32 s59, 6
    s_cbranch_scc0 ev_i6
    s_xor_b32 s81, s53, 6
    s_mul_i32 s81, s81, 2622464
    s_add_u32 s81, s81, s48
    buffer_load_dwordx4 v[128:131], v14, s[24:27], s81 offen offset:0 sc1
    buffer_load_dwordx4 v[132:135], v14, s[24:27], s81 offen offset:1024 sc1
ev_i6:
    s_bitcmp1_b32 s59, 7
    s_cbranch_scc0 ev_i7
    s_xor_b32 s81, s53, 7
    s_mul_i32 s81, s81, 2622464
    s_add_u32 s81, s81, s48
    buffer_load_dwordx4 v[136:139], v14, s[24:27], s81 offen offset:0 sc1
    buffer_load_dwordx4 v[140:143], v14, s[24:27], s81 offen offset:1024 sc1
ev_i7:
    s_lshr_b32 s56, s59, 9
    s_cbranch_scc0 ev_issued
    s_bitcmp1_b32 s59, 9
    s_cbranch_scc0 ev_i9
    s_xor_b32 s81, s53, 1
    s_mul_i32 s81, s81, 2622464
    s_add_u32 s81, s81, s63
    buffer_load_dwordx4 v[56:59], v14, s[24:27], s81 offen offset:0 sc1
    buffer_load_dwordx4 v[60:63], v14, s[24:27], s81 offen offset:1024 sc1
ev_i9:
    s_bitcmp1_b32 s59, 10
    s_cbranch_scc0 ev_i10
    s_xor_b32 s81, s53, 2
    s_mul_i32 s81, s81, 2622464
    s_add_u32 s81, s81, s63
    buffer_load_dwordx4 v[64:67], v14, s[24:27], s81 offen offset:0 sc1
    buffer_load_dwordx4 v[68:71], v14, s[24:27], s81 offen offset:1024 sc1
ev_i10:
    s_bitcmp1_b32 s59, 11
    s_cbranch_scc0 ev_i11
    s_xor_b32 s81, s53, 3
    s_mul_i32 s81, s81, 2622464
    s_add_u32 s81, s81, s63
    buffer_load_dwordx4 v[72:75], v14, s[24:27], s81 offen offset:0 sc1
    buffer_load_dwordx4 v[76:79], v14, s[24:27], s81 offen offset:1024 sc1
ev_i11:
    s_bitcmp1_b32 s59, 12
    s_cbranch_scc0 ev_i12
    s_xor_b32 s81, s53, 4
    s_mul_i32 s81, s81, 2622464
    s_add_u32 s81, s81, s63
    buffer_load_dwordx4 v[80:83], v14, s[24:27], s81 offen offset:0 sc1
    buffer_load_dwordx4 v[84:87], v14, s[24:27], s81 offen offset:1024 sc1
ev_i12:
    s_bitcmp1_b32 s59, 13
    s_cbranch_scc0 ev_i13
    s_xor_b32 s81, s53, 5
    s_mul_i32 s81, s81, 2622464
    s_add_u32 s81, s81, s63
    buffer_load_dwordx4 v[88:91], v14, s[24:27], s81 offen offset:0 sc1
    buffer_load_dwordx4 v[92:95], v14, s[24:27], s81 offen offset:1024 sc1
ev_i13:
    s_bitcmp1_b32 s59, 14
    s_cbranch_scc0 ev_i14
    s_xor_b32 s81, s53, 6
    s_mul_i32 s81, s81, 2622464
    s_add_u32 s81, s81, s63
    buffer_load_dwordx4 v[96:99], v14, s[24:27], s81 offen offset:0 sc1
    buffer_load_dwordx4 v[100:103], v14, s[24:27], s81 offen offset:1024 sc1
ev_i14:
    s_bitcmp1_b32 s59, 15
    s_cbranch_scc0 ev_i15
    s_xor_b32 s81, s53, 7
    s_mul_i32 s81, s81, 2622464
    s_add_u32 s81, s81, s63
    buffer_load_dwordx4 v[104:107], v14, s[24:27], s81 offen offset:0 sc1
    buffer_load_dwordx4 v[108:111], v14, s[24:27], s81 offen offset:1024 sc1
ev_i15:
ev_issued:
    s_cmp_eq_u32 s80, 0xffff
    s_cbranch_scc1 ev_acc
    s_load_dwordx16 s[28:43], s[86:87], s67 glc
    s_add_u32 s101, s101, 1
    s_cmp_gt_u32 s101, 0x2000000
    s_cbranch_scc1 ev_done
    s_add_u32 s47, s47, 1
    s_cmp_eq_u32 s47, 3
    s_cbranch_scc0 ev_loop
ev_acc:
    s_waitcnt vmcnt(0)
    s_or_b32 s79, s79, s60
    s_bitcmp1_b32 s60, 1
    s_cbranch_scc0 ev_s1
    v_mfma_f32_16x16x32_bf16 v[240:243], v[184:187], v[176:179], v[240:243]
    v_mfma_f32_16x16x32_bf16 v[244:247], v[188:191], v[176:179], v[244:247]
    v_mfma_f32_16x16x32_bf16 v[248:251], v[184:187], v[180:183], v[248:251]
    v_mfma_f32_16x16x32_bf16 v[252:255], v[188:191], v[180:183], v[252:255]
ev_s1:
    s_bitcmp1_b32 s60, 2
    s_cbranch_scc0 ev_s2
    v_mfma_f32_16x16x32_bf16 v[240:243], v[184:187], v[160:163], v[240:243]
    v_mfma_f32_16x16x32_bf16 v[244:247], v[188:191], v[160:163], v[244:247]
    v_mfma_f32_16x16x32_bf16 v[248:251], v[184:187], v[164:167], v[248:251]
    v_mfma_f32_16x16x32_bf16 v[252:255], v[188:191], v[164:167], v[252:255]
ev_s2:
    s_bitcmp1_b32 s60, 3
    s_cbranch_scc0 ev_s3
    v_mfma_f32_16x16x32_bf16 v[240:243], v[184:187], v[168:171], v[240:243]
    v_mfma_f32_16x16x32_bf16 v[244:247], v[188:191], v[168:171], v[244:247]
    v_mfma_f32_16x16x32_bf16 v[248:251], v[184:187], v[172:175], v[248:251]
    v_mfma_f32_16x16x32_bf16 v[252:255], v[188:191], v[172:175], v[252:255]
ev_s3:
    s_lshr_b32 s56, s60, 4
    s_cbranch_scc0 ev_summed
    s_bitcmp1_b32 s60, 4
    s_cbranch_scc0 ev_s4
    v_mfma_f32_16x16x32_bf16 v[240:243], v[184:187], v[144:147], v[240:243]
    v_mfma_f32_16x16x32_bf16 v[244:247], v[188:191], v[144:147], v[244:247]
    v_mfma_f32_16x16x32_bf16 v[248:251], v[184:187], v[148:151], v[248:251]
    v_mfma_f32_16x16x32_bf16 v[252:255], v[188:191], v[148:151], v[252:255]
ev_s4:
    s_bitcmp1_b32 s60, 5
    s_cbranch_scc0 ev_s5
    v_mfma_f32_16x16x32_bf16 v[240:243], v[184:187], v[152:155], v[240:243]
    v_mfma_f32_16x16x32_bf16 v[244:247], v[188:191], v[152:155], v[244:247]
    v_mfma_f32_16x16x32_bf16 v[248:251], v[184:187], v[156:159], v[248:251]
    v_mfma_f32_16x16x32_bf16 v[252:255], v[188:191], v[156:159], v[252:255]
ev_s5:
    s_bitcmp1_b32 s60, 6
    s_cbranch_scc0 ev_s6
    v_mfma_f32_16x16x32_bf16 v[240:243], v[184:187], v[128:131], v[240:243]
    v_mfma_f32_16x16x32_bf16 v[244:247], v[188:191], v[128:131], v[244:247]
    v_mfma_f32_16x16x32_bf16 v[248:251], v[184:187], v[132:135], v[248:251]
    v_mfma_f32_16x16x32_bf16 v[252:255], v[188:191], v[132:135], v[252:255]
ev_s6:
    s_bitcmp1_b32 s60, 7
    s_cbranch_scc0 ev_s7
    v_mfma_f32_16x16x32_bf16 v[240:243], v[184:187], v[136:139], v[240:243]
    v_mfma_f32_16x16x32_bf16 v[244:247], v[188:191], v[136:139], v[244:247]
    v_mfma_f32_16x16x32_bf16 v[248:251], v[184:187], v[140:143], v[248:251]
    v_mfma_f32_16x16x32_bf16 v[252:255], v[188:191], v[140:143], v[252:255]
ev_s7:
    s_lshr_b32 s56, s60, 9
    s_cbranch_scc0 ev_summed
    s_bitcmp1_b32 s60, 9
    s_cbranch_scc0 ev_s9
    v_mfma_f32_16x16x32_bf16 v[112:115], v[184:187], v[56:59], v[112:115]
    v_mfma_f32_16x16x32_bf16 v[116:119], v[188:191], v[56:59], v[116:119]
    v_mfma_f32_16x16x32_bf16 v[120:123], v[184:187], v[60:63], v[120:123]
    v_mfma_f32_16x16x32_bf16 v[124:127], v[188:191], v[60:63], v[124:127]
ev_s9:
    s_bitcmp1_b32 s60, 10
    s_cbranch_scc0 ev_s10
    v_mfma_f32_16x16x32_bf16 v[112:115], v[184:187], v[64:67], v[112:115]
    v_mfma_f32_16x16x32_bf16 v[116:119], v[188:191], v[64:67], v[116:119]
    v_mfma_f32_16x16x32_bf16 v[120:123], v[184:187], v[68:71], v[120:123]
    v_mfma_f32_16x16x32_bf16 v[124:127], v[188:191], v[68:71], v[124:127]
ev_s10:
    s_bitcmp1_b32 s60, 11
    s_cbranch_scc0 ev_s11
    v_mfma_f32_16x16x32_bf16 v[112:115], v[184:187], v[72:75], v[112:115]
    v_mfma_f32_16x16x32_bf16 v[116:119], v[188:191], v[72:75], v[116:119]
    v_mfma_f32_16x16x32_bf16 v[120:123], v[184:187], v[76:79], v[120:123]
    v_mfma_f32_16x16x32_bf16 v[124:127], v[188:191], v[76:79], v[124:127]
ev_s11:
    s_bitcmp1_b32 s60, 12
    s_cbranch_scc0 ev_s12
    v_mfma_f32_16x16x32_bf16 v[112:115], v[184:187], v[80:83], v[112:115]
    v_mfma_f32_16x16x32_bf16 v[116:119], v[188:191], v[80:83], v[116:119]
    v_mfma_f32_16x16x32_bf16 v[120:123], v[184:187], v[84:87], v[120:123]
    v_mfma_f32_16x16x32_bf16 v[124:127], v[188:191], v[84:87], v[124:127]
ev_s12:
    s_bitcmp1_b32 s60, 13
    s_cbranch_scc0 ev_s13
    v_mfma_f32_16x16x32_bf16 v[112:115], v[184:187], v[88:91], v[112:115]
    v_mfma_f32_16x16x32_bf16 v[116:119], v[188:191], v[88:91], v[116:119]
    v_mfma_f32_16x16x32_bf16 v[120:123], v[184:187], v[92:95], v[120:123]
    v_mfma_f32_16x16x32_bf16 v[124:127], v[188:191], v[92:95], v[124:127]
ev_s13:
    s_bitcmp1_b32 s60, 14
    s_cbranch_scc0 ev_s14
    v_mfma_f32_16x16x32_bf16 v[112:115], v[184:187], v[96:99], v[112:115]
    v_mfma_f32_16x16x32_bf16 v[116:119], v[188:191], v[96:99], v[116:119]
    v_mfma_f32_16x16x32_bf16 v[120:123], v[184:187], v[100:103], v[120:123]
    v_mfma_f32_16x16x32_bf16 v[124:127], v[188:191], v[100:103], v[124:127]
ev_s14:
    s_bitcmp1_b32 s60, 15
    s_cbranch_scc0 ev_s15
    v_mfma_f32_16x16x32_bf16 v[112:115], v[184:187], v[104:107], v[112:115]
    v_mfma_f32_16x16x32_bf16 v[116:119], v[188:191], v[104:107], v[116:119]
    v_mfma_f32_16x16x32_bf16 v[120:123], v[184:187], v[108:111], v[120:123]
    v_mfma_f32_16x16x32_bf16 v[124:127], v[188:191], v[108:111], v[124:127]
ev_s15:
ev_summed:
    s_mov_b32 s60, 0
    s_cmp_lg_u32 s46, 0
    s_cbranch_scc1 routed
routed_ret:
    s_bfe_u32 s56, s79, 524288
    s_cmp_eq_u32 s56, 0xff
    s_cbranch_scc0 ev_f0
    s_bitcmp1_b32 s78, 0
    s_cbranch_scc1 ev_f0
    s_bitset1_b32 s78, 0
    v_pk_fma_f32 v[240:241], v[240:241], v[208:209], v[192:193]
    v_pk_fma_f32 v[242:243], v[242:243], v[210:211], v[194:195]
    v_pk_fma_f32 v[244:245], v[244:245], v[212:213], v[196:197]
    v_pk_fma_f32 v[246:247], v[246:247], v[214:215], v[198:199]
    v_cvt_pk_bf16_f32 v240, v240, v241
    v_cvt_pk_bf16_f32 v241, v242, v243
    v_cvt_pk_bf16_f32 v242, v244, v245
    v_cvt_pk_bf16_f32 v243, v246, v247
    s_nop 1
    v_permlane16_swap_b32 v240, v242
    v_permlane16_swap_b32 v241, v243
    buffer_store_dwordx4 v[240:243], v4, s[16:19], s64 offen sc1
    v_pk_fma_f32 v[248:249], v[248:249], v[216:217], v[200:201]
    v_pk_fma_f32 v[250:251], v[250:251], v[218:219], v[202:203]
    v_pk_fma_f32 v[252:253], v[252:253], v[220:221], v[204:205]
    v_pk_fma_f32 v[254:255], v[254:255], v[222:223], v[206:207]
    v_cvt_pk_bf16_f32 v248, v248, v249
    v_cvt_pk_bf16_f32 v249, v250, v251
    v_cvt_pk_bf16_f32 v250, v252, v253
    v_cvt_pk_bf16_f32 v251, v254, v255
    s_nop 1
    v_permlane16_swap_b32 v248, v250
    v_permlane16_swap_b32 v249, v251
    buffer_store_dwordx4 v[248:251], v4, s[16:19], s65 offen sc1
ev_f0:
    s_bfe_u32 s56, s79, 524296
    s_cmp_eq_u32 s56, 0xff
    s_cbranch_scc0 ev_f1
    s_bitcmp1_b32 s78, 1
    s_cbranch_scc1 ev_f1
    s_bitset1_b32 s78, 1
    v_lshlrev_b32 v56, 16, v32
    v_and_b32 v57, 0xffff0000, v32
    v_lshlrev_b32 v72, 16, v48
    v_and_b32 v73, 0xffff0000, v48
    v_lshlrev_b32 v58, 16, v33
    v_and_b32 v59, 0xffff0000, v33
    v_lshlrev_b32 v74, 16, v49
    v_and_b32 v75, 0xffff0000, v49
    v_lshlrev_b32 v60, 16, v34
    v_and_b32 v61, 0xffff0000, v34
    v_lshlrev_b32 v76, 16, v50
    v_and_b32 v77, 0xffff0000, v50
    v_lshlrev_b32 v62, 16, v35
    v_and_b32 v63, 0xffff0000, v35
    v_lshlrev_b32 v78, 16, v51
    v_and_b32 v79, 0xffff0000, v51
    v_lshlrev_b32 v64, 16, v36
    v_and_b32 v65, 0xffff0000, v36
    v_lshlrev_b32 v80, 16, v52
    v_and_b32 v81, 0xffff0000, v52
    v_lshlrev_b32 v66, 16, v37
    v_and_b32 v67, 0xffff0000, v37
    v_lshlrev_b32 v82, 16, v53
    v_and_b32 v83, 0xffff0000, v53
    v_lshlrev_b32 v68, 16, v38
    v_and_b32 v69, 0xffff0000, v38
    v_lshlrev_b32 v84, 16, v54
    v_and_b32 v85, 0xffff0000, v54
    v_lshlrev_b32 v70, 16, v39
    v_and_b32 v71, 0xffff0000, v39
    v_lshlrev_b32 v86, 16, v55
    v_and_b32 v87, 0xffff0000, v55
    v_pk_fma_f32 v[112:113], v[112:113], v[72:73], v[56:57]
    v_pk_fma_f32 v[114:115], v[114:115], v[74:75], v[58:59]
    v_pk_fma_f32 v[116:117], v[116:117], v[76:77], v[60:61]
    v_pk_fma_f32 v[118:119], v[118:119], v[78:79], v[62:63]
    v_cvt_pk_bf16_f32 v112, v112, v113
    v_cvt_pk_bf16_f32 v113, v114, v115
    v_cvt_pk_bf16_f32 v114, v116, v117
    v_cvt_pk_bf16_f32 v115, v118, v119
    s_nop 1
    v_permlane16_swap_b32 v112, v114
    v_permlane16_swap_b32 v113, v115
    buffer_store_dwordx4 v[112:115], v4, s[16:19], s68 offen sc1
    v_pk_fma_f32 v[120:121], v[120:121], v[80:81], v[64:65]
    v_pk_fma_f32 v[122:123], v[122:123], v[82:83], v[66:67]
    v_pk_fma_f32 v[124:125], v[124:125], v[84:85], v[68:69]
    v_pk_fma_f32 v[126:127], v[126:127], v[86:87], v[70:71]
    v_cvt_pk_bf16_f32 v120, v120, v121
    v_cvt_pk_bf16_f32 v121, v122, v123
    v_cvt_pk_bf16_f32 v122, v124, v125
    v_cvt_pk_bf16_f32 v123, v126, v127
    s_nop 1
    v_permlane16_swap_b32 v120, v122
    v_permlane16_swap_b32 v121, v123
    buffer_store_dwordx4 v[120:123], v4, s[16:19], s69 offen sc1
ev_f1:
    s_cmp_eq_u32 s78, 3
    s_cbranch_scc0 ev_loop
ev_done:
    s_or_b32 s56, s2, s3
    s_cmp_eq_u32 s56, 0
    s_cselect_b32 s56, 0, 0x7ffffff0
    s_add_u32 s56, s56, 3203072
    buffer_store_dword v6, v15, s[24:27], s56 offen
main_fin:
main_end:
    s_endpgm
spin_o0:
    s_load_dwordx4 s[72:75], s[86:87], s5 glc
    s_add_u32 s101, s101, 1
    s_cmp_gt_u32 s101, 0x2000000
    s_waitcnt lgkmcnt(0)
    s_cbranch_scc1 spin_o0_ret
    s_sub_u32 s78, s72, s77
    s_sub_u32 s79, s73, s77
    s_max_u32 s78, s78, s79
    s_sub_u32 s79, s74, s77
    s_max_u32 s78, s78, s79
    s_sub_u32 s79, s75, s77
    s_max_u32 s78, s78, s79
    s_cmp_gt_u32 s78, 5
    s_cbranch_scc1 spin_o0
    s_branch spin_o0_ret
spin_o1:
    s_load_dwordx4 s[72:75], s[86:87], s5 glc
    s_add_u32 s101, s101, 1
    s_cmp_gt_u32 s101, 0x2000000
    s_waitcnt lgkmcnt(0)
    s_cbranch_scc1 spin_o1_ret
    s_sub_u32 s78, s72, s77
    s_sub_u32 s79, s73, s77
    s_max_u32 s78, s78, s79
    s_sub_u32 s79, s74, s77
    s_max_u32 s78, s78, s79
    s_sub_u32 s79, s75, s77
    s_max_u32 s78, s78, s79
    s_cmp_gt_u32 s78, 4
    s_cbranch_scc1 spin_o1
    s_branch spin_o1_ret
spin_o2:
    s_load_dwordx4 s[72:75], s[86:87], s5 glc
    s_add_u32 s101, s101, 1
    s_cmp_gt_u32 s101, 0x2000000
    s_waitcnt lgkmcnt(0)
    s_cbranch_scc1 spin_o2_ret
    s_sub_u32 s78, s72, s77
    s_sub_u32 s79, s73, s77
    s_max_u32 s78, s78, s79
    s_sub_u32 s79, s74, s77
    s_max_u32 s78, s78, s79
    s_sub_u32 s79, s75, s77
    s_max_u32 s78, s78, s79
    s_cmp_gt_u32 s78, 3
    s_cbranch_scc1 spin_o2
    s_branch spin_o2_ret
spin_o3:
    s_load_dwordx4 s[72:75], s[86:87], s5 glc
    s_add_u32 s101, s101, 1
    s_cmp_gt_u32 s101, 0x2000000
    s_waitcnt lgkmcnt(0)
    s_cbranch_scc1 spin_o3_ret
    s_sub_u32 s78, s72, s77
    s_sub_u32 s79, s73, s77
    s_max_u32 s78, s78, s79
    s_sub_u32 s79, s74, s77
    s_max_u32 s78, s78, s79
    s_sub_u32 s79, s75, s77
    s_max_u32 s78, s78, s79
    s_cmp_gt_u32 s78, 2
    s_cbranch_scc1 spin_o3
    s_branch spin_o3_ret
spin_o4:
    s_load_dwordx4 s[72:75], s[86:87], s5 glc
    s_add_u32 s101, s101, 1
    s_cmp_gt_u32 s101, 0x2000000
    s_waitcnt lgkmcnt(0)
    s_cbranch_scc1 spin_o4_ret
    s_sub_u32 s78, s72, s77
    s_sub_u32 s79, s73, s77
    s_max_u32 s78, s78, s79
    s_sub_u32 s79, s74, s77
    s_max_u32 s78, s78, s79
    s_sub_u32 s79, s75, s77
    s_max_u32 s78, s78, s79
    s_cmp_gt_u32 s78, 1
    s_cbranch_scc1 spin_o4
    s_branch spin_o4_ret
spin_o5:
    s_load_dwordx4 s[72:75], s[86:87], s5 glc
    s_add_u32 s101, s101, 1
    s_cmp_gt_u32 s101, 0x2000000
    s_waitcnt lgkmcnt(0)
    s_cbranch_scc1 spin_o5_ret
    s_sub_u32 s78, s72, s77
    s_sub_u32 s79, s73, s77
    s_max_u32 s78, s78, s79
    s_sub_u32 s79, s74, s77
    s_max_u32 s78, s78, s79
    s_sub_u32 s79, s75, s77
    s_max_u32 s78, s78, s79
    s_cmp_gt_u32 s78, 0
    s_cbranch_scc1 spin_o5
    s_branch spin_o5_ret
routed_a:
    v_xor_b32 v22, s7, v22
    v_xor_b32 v23, s7, v23
    v_or_b32 v22, v22, v23
    v_cmp_ne_u32 vcc, 0, v22
    s_cbranch_vccnz spin_y
spin_y_ret:
    v_cmp_lt_u32 vcc, 31, v1
    v_mov_b32 v2, s70
    v_mov_b32 v5, s71
    v_cndmask_b32 v2, v2, v5, vcc
    v_and_b32 v12, 8, v1
    v_mov_b32 v5, s64
    v_mov_b32 v13, s68
    v_cmp_ne_u32 vcc, 0, v12
    s_nop 1
    v_cndmask_b32 v5, v5, v13, vcc
    v_and_b32 v13, 7, v1
    v_lshl_add_u32 v5, v13, 3, v5
    v_lshrrev_b32 v12, 5, v1
    v_bfe_u32 v13, v1, 4, 1
    v_lshl_add_u32 v12, v13, 1, v12
    v_mul_u32_u24 v12, 2560, v12
    v_lshl_add_u32 v21, v5, 1, v12
    s_mov_b32 s56, 3670016
    buffer_load_dwordx4 v[192:195], v21, s[24:27], s56 offen sc1
    s_add_u32 s56, s56, 10240
    buffer_load_dwordx4 v[196:199], v21, s[24:27], s56 offen sc1
    s_add_u32 s56, s56, 10240
    buffer_load_dwordx4 v[200:203], v21, s[24:27], s56 offen sc1
    s_add_u32 s56, s56, 10240
    buffer_load_dwordx4 v[204:207], v21, s[24:27], s56 offen sc1
    s_add_u32 s56, s56, 10240
    buffer_load_dwordx4 v[208:211], v21, s[24:27], s56 offen sc1
    s_add_u32 s56, s56, 10240
    buffer_load_dwordx4 v[212:215], v21, s[24:27], s56 offen sc1
    s_add_u32 s56, s56, 10240
    buffer_load_dwordx4 v[216:219], v21, s[24:27], s56 offen sc1
    s_add_u32 s56, s56, 10240
    buffer_load_dwordx4 v[220:223], v21, s[24:27], s56 offen sc1
    s_add_u32 s56, s56, 10240
    buffer_load_dwordx4 v[224:227], v21, s[24:27], s56 offen sc1
    s_add_u32 s56, s56, 10240
    buffer_load_dwordx4 v[228:231], v21, s[24:27], s56 offen sc1
    s_add_u32 s56, s56, 10240
    buffer_load_dwordx4 v[232:235], v21, s[24:27], s56 offen sc1
    s_add_u32 s56, s56, 10240
    buffer_load_dwordx4 v[236:239], v21, s[24:27], s56 offen sc1
    s_add_u32 s56, s56, 10240
    v_and_b32 v12, 0x7ff, v2
    v_sub_u32 v12, 2047, v12
    v_mul_u32_u24 v13, 1280, v12
    v_add_u32 v13, v13, v5
    v_lshlrev_b32 v12, 3, v12
    s_mov_b32 s57, 3211264
    buffer_load_dwordx2 v[8:9], v13, s[12:15], 0 offen
    buffer_load_dwordx2 v[10:11], v12, s[24:27], s57 offen sc1
    v_and_b32 v2, 0xffff0000, v2
    v_ashrrev_i32 v12, 31, v2
    v_not_b32 v12, v12
    v_or_b32 v12, 0x80000000, v12
    v_xor_b32 v2, v2, v12
    v_and_b32 v2, 0xffff0000, v2
    v_mul_f32 v2, s92, v2
    v_exp_f32 v2, v2
    s_nop 0
    v_add_f32 v2, 1.0, v2
    v_rcp_f32 v2, v2
    s_nop 0
    v_cvt_pk_bf16_f32 v2, v2, v2
    v_and_b32 v2, 0xffff0000, v2
    s_lshl_b32 s56, s3, 9
    s_add_u32 s56, s56, 61440
    v_lshlrev_b32 v12, 3, v1
    v_add_u32 v12, s56, v12
    v_lshrrev_b32 v13, 4, v1
    v_lshlrev_b32 v13, 3, v13
    v_add_u32 v13, s56, v13
    v_add_u32 v21, 256, v13
    v_cndmask_b32 v22, v13, v21, s[20:21]
    v_cndmask_b32 v23, v13, v21, s[22:23]
    s_branch routed_a_ret
routed:
    v_pk_add_f32 v[192:193], v[192:193], v[196:197]
    v_pk_add_f32 v[194:195], v[194:195], v[198:199]
    v_pk_add_f32 v[192:193], v[192:193], v[200:201]
    v_pk_add_f32 v[194:195], v[194:195], v[202:203]
    v_pk_add_f32 v[192:193], v[192:193], v[204:205]
    v_pk_add_f32 v[194:195], v[194:195], v[206:207]
    v_pk_add_f32 v[192:193], v[192:193], v[208:209]
    v_pk_add_f32 v[194:195], v[194:195], v[210:211]
    v_pk_add_f32 v[192:193], v[192:193], v[212:213]
    v_pk_add_f32 v[194:195], v[194:195], v[214:215]
    v_pk_add_f32 v[192:193], v[192:193], v[216:217]
    v_pk_add_f32 v[194:195], v[194:195], v[218:219]
    v_pk_add_f32 v[192:193], v[192:193], v[220:221]
    v_pk_add_f32 v[194:195], v[194:195], v[222:223]
    v_pk_add_f32 v[192:193], v[192:193], v[224:225]
    v_pk_add_f32 v[194:195], v[194:195], v[226:227]
    v_pk_add_f32 v[192:193], v[192:193], v[228:229]
    v_pk_add_f32 v[194:195], v[194:195], v[230:231]
    v_pk_add_f32 v[192:193], v[192:193], v[232:233]
    v_pk_add_f32 v[194:195], v[194:195], v[234:235]
    v_pk_add_f32 v[192:193], v[192:193], v[236:237]
    v_pk_add_f32 v[194:195], v[194:195], v[238:239]
    v_mov_b32 v196, v192
    v_mov_b32 v197, v193
    v_mov_b32 v198, v194
    v_mov_b32 v199, v195
    v_lshlrev_b32 v16, 16, v8
    v_and_b32 v17, 0xffff0000, v8
    v_lshlrev_b32 v18, 16, v9
    v_and_b32 v19, 0xffff0000, v9
    v_permlane16_swap_b32 v192, v196
    v_permlane16_swap_b32 v193, v197
    v_permlane16_swap_b32 v194, v198
    v_permlane16_swap_b32 v195, v199
    v_sub_f32 v16, v16, v10
    v_cvt_pk_bf16_f32 v16, v16, v16
    v_and_b32 v16, 0xffff0000, v16
    v_mul_f32 v16, v16, v11
    v_cvt_pk_bf16_f32 v16, v16, v16
    v_and_b32 v16, 0xffff0000, v16
    v_sub_f32 v17, v17, v10
    v_cvt_pk_bf16_f32 v17, v17, v17
    v_and_b32 v17, 0xffff0000, v17
    v_mul_f32 v17, v17, v11
    v_cvt_pk_bf16_f32 v17, v17, v17
    v_and_b32 v17, 0xffff0000, v17
    v_sub_f32 v18, v18, v10
    v_cvt_pk_bf16_f32 v18, v18, v18
    v_and_b32 v18, 0xffff0000, v18
    v_mul_f32 v18, v18, v11
    v_cvt_pk_bf16_f32 v18, v18, v18
    v_and_b32 v18, 0xffff0000, v18
    v_sub_f32 v19, v19, v10
    v_cvt_pk_bf16_f32 v19, v19, v19
    v_and_b32 v19, 0xffff0000, v19
    v_mul_f32 v19, v19, v11
    v_cvt_pk_bf16_f32 v19, v19, v19
    v_and_b32 v19, 0xffff0000, v19
    v_pk_add_f32 v[192:193], v[192:193], v[196:197]
    v_pk_add_f32 v[194:195], v[194:195], v[198:199]
    v_cvt_pk_bf16_f32 v192, v192, v192
    v_and_b32 v192, 0xffff0000, v192
    v_mul_f32 v192, v192, v2
    v_cvt_pk_bf16_f32 v192, v192, v192
    v_and_b32 v192, 0xffff0000, v192
    v_add_f32 v192, v192, v16
    v_cvt_pk_bf16_f32 v192, v192, v192
    v_and_b32 v192, 0xffff0000, v192
    v_mul_f32 v196, s92, v192
    v_cvt_pk_bf16_f32 v193, v193, v193
    v_and_b32 v193, 0xffff0000, v193
    v_mul_f32 v193, v193, v2
    v_cvt_pk_bf16_f32 v193, v193, v193
    v_and_b32 v193, 0xffff0000, v193
    v_add_f32 v193, v193, v17
    v_cvt_pk_bf16_f32 v193, v193, v193
    v_and_b32 v193, 0xffff0000, v193
    v_mul_f32 v197, s92, v193
    v_cvt_pk_bf16_f32 v194, v194, v194
    v_and_b32 v194, 0xffff0000, v194
    v_mul_f32 v194, v194, v2
    v_cvt_pk_bf16_f32 v194, v194, v194
    v_and_b32 v194, 0xffff0000, v194
    v_add_f32 v194, v194, v18
    v_cvt_pk_bf16_f32 v194, v194, v194
    v_and_b32 v194, 0xffff0000, v194
    v_mul_f32 v198, s92, v194
    v_cvt_pk_bf16_f32 v195, v195, v195
    v_and_b32 v195, 0xffff0000, v195
    v_mul_f32 v195, v195, v2
    v_cvt_pk_bf16_f32 v195, v195, v195
    v_and_b32 v195, 0xffff0000, v195
    v_add_f32 v195, v195, v19
    v_cvt_pk_bf16_f32 v195, v195, v195
    v_and_b32 v195, 0xffff0000, v195
    v_mul_f32 v199, s92, v195
    v_exp_f32 v196, v196
    v_exp_f32 v197, v197
    v_exp_f32 v198, v198
    v_exp_f32 v199, v199
    v_add_f32 v196, 1.0, v196
    v_add_f32 v197, 1.0, v197
    v_add_f32 v198, 1.0, v198
    v_add_f32 v199, 1.0, v199
    v_rcp_f32 v196, v196
    v_rcp_f32 v197, v197
    v_rcp_f32 v198, v198
    v_rcp_f32 v199, v199
    v_mul_f32 v192, v192, v196
    v_mul_f32 v193, v193, v197
    v_mul_f32 v194, v194, v198
    v_mul_f32 v195, v195, v199
    v_cvt_pk_bf16_f32 v192, v192, v193
    v_cvt_pk_bf16_f32 v193, v194, v195
    ds_write_b64 v12, v[192:193]
    s_mov_b64 exec, s[8:9]
    ds_read2_b64 v[40:43], v22 offset0:0 offset1:4
    ds_read2_b64 v[48:51], v22 offset0:8 offset1:12
    s_mov_b64 exec, s[10:11]
    ds_read2_b64 v[44:47], v23 offset0:0 offset1:4
    ds_read2_b64 v[52:55], v23 offset0:8 offset1:12
    s_mov_b64 exec, -1
    s_mov_b32 s46, 0
    s_waitcnt lgkmcnt(0)
    v_lshlrev_b32 v192, 16, v24
    v_and_b32 v193, 0xffff0000, v24
    v_lshlrev_b32 v208, 16, v40
    v_and_b32 v209, 0xffff0000, v40
    v_lshlrev_b32 v194, 16, v25
    v_and_b32 v195, 0xffff0000, v25
    v_lshlrev_b32 v210, 16, v41
    v_and_b32 v211, 0xffff0000, v41
    v_lshlrev_b32 v196, 16, v26
    v_and_b32 v197, 0xffff0000, v26
    v_lshlrev_b32 v212, 16, v42
    v_and_b32 v213, 0xffff0000, v42
    v_lshlrev_b32 v198, 16, v27
    v_and_b32 v199, 0xffff0000, v27
    v_lshlrev_b32 v214, 16, v43
    v_and_b32 v215, 0xffff0000, v43
    v_lshlrev_b32 v200, 16, v28
    v_and_b32 v201, 0xffff0000, v28
    v_lshlrev_b32 v216, 16, v44
    v_and_b32 v217, 0xffff0000, v44
    v_lshlrev_b32 v202, 16, v29
    v_and_b32 v203, 0xffff0000, v29
    v_lshlrev_b32 v218, 16, v45
    v_and_b32 v219, 0xffff0000, v45
    v_lshlrev_b32 v204, 16, v30
    v_and_b32 v205, 0xffff0000, v30
    v_lshlrev_b32 v220, 16, v46
    v_and_b32 v221, 0xffff0000, v46
    v_lshlrev_b32 v206, 16, v31
    v_and_b32 v207, 0xffff0000, v31
    v_lshlrev_b32 v222, 16, v47
    v_and_b32 v223, 0xffff0000, v47
    s_branch routed_ret
spin_y:
    s_add_u32 s101, s101, 1
    s_cmp_gt_u32 s101, 0x2000000
    s_cbranch_scc1 spin_y_x
    buffer_load_dword v22, v3, s[24:27], s44 offen sc1
    buffer_load_dword v23, v3, s[24:27], s45 offen sc1
    s_waitcnt vmcnt(0)
    v_xor_b32 v22, s7, v22
    v_xor_b32 v23, s7, v23
    v_or_b32 v22, v22, v23
    v_cmp_ne_u32 vcc, 0, v22
    s_cbranch_vccnz spin_y
spin_y_x:
    s_branch spin_y_ret
spin_rec:
    s_add_u32 s101, s101, 1
    s_cmp_gt_u32 s101, 0x2000000
    s_cbranch_scc1 spin_rec_x
    buffer_load_dwordx4 v[32:35], v17, s[24:27], s47 offen offset:0 sc1
    buffer_load_dwordx4 v[36:39], v17, s[24:27], s47 offen offset:1024 sc1
    buffer_load_dwordx4 v[40:43], v17, s[24:27], s47 offen offset:2048 sc1
    buffer_load_dwordx4 v[44:47], v17, s[24:27], s47 offen offset:3072 sc1
    s_waitcnt vmcnt(0)
    v_xor_b32 v34, s7, v34
    v_xor_b32 v38, s7, v38
    v_xor_b32 v42, s7, v42
    v_xor_b32 v46, s7, v46
    v_or3_b32 v34, v34, v38, v42
    v_or_b32 v34, v34, v46
    v_cmp_ne_u32 vcc, 0, v34
    s_cbranch_vccnz spin_rec
spin_rec_x:
    s_branch spin_rec_ret
spin_gu:
    s_add_u32 s101, s101, 1
    s_cmp_gt_u32 s101, 0x2000000
    s_cbranch_scc1 spin_gu_x
    buffer_load_dword v23, v22, s[24:27], s42 offen sc1
    s_waitcnt vmcnt(0)
    v_cmp_ne_u32 vcc, s7, v23
    s_cbranch_vccnz spin_gu
spin_gu_x:
    s_branch spin_gu_ret
rare:
    s_nop 7
    s_nop 7
    v_and_b32 v21, 15, v1
    v_mul_u32_u24 v21, 384, v21
    v_bfe_u32 v22, v1, 4, 1
    v_bfe_u32 v23, v1, 5, 1
    v_lshl_add_u32 v22, v22, 1, v23
    v_lshl_add_u32 v21, v22, 4, v21
    v_mov_b32 v24, 0
    v_mov_b32 v25, 0
    v_mov_b32 v26, 0
    v_mov_b32 v27, 0
    v_mov_b32 v28, 0
    v_mov_b32 v29, 0
    v_mov_b32 v30, 0
    v_mov_b32 v31, 0
    v_mov_b32 v32, 0
    v_mov_b32 v33, 0
    v_mov_b32 v34, 0
    v_mov_b32 v35, 0
    v_mov_b32 v36, 0
    v_mov_b32 v37, 0
    v_mov_b32 v38, 0
    v_mov_b32 v39, 0
    v_mov_b32 v16, 0xff800000
    v_mov_b32 v17, 0xff800000
    v_mov_b32 v18, 0xff800000
    v_mov_b32 v19, 0xff800000
    s_mov_b32 s78, 0
rare_pass:
    s_mov_b32 s77, 0
rare_loop:
    buffer_load_dwordx4 a[216:219], v21, s[12:15], s77 offen offset:0
    buffer_load_dwordx4 a[220:223], v21, s[12:15], s77 offen offset:64
    buffer_load_dwordx4 a[224:227], v21, s[12:15], s77 offen offset:128
    buffer_load_dwordx4 a[228:231], v21, s[12:15], s77 offen offset:192
    buffer_load_dwordx4 a[232:235], v21, s[12:15], s77 offen offset:256
    buffer_load_dwordx4 a[236:239], v21, s[12:15], s77 offen offset:320
    s_waitcnt vmcnt(0)
    v_mfma_f32_16x16x32_bf16 v[40:43], a[216:219], a[0:3], v[24:27]
    v_mfma_f32_16x16x32_bf16 v[44:47], a[216:219], a[4:7], v[28:31]
    v_mfma_f32_16x16x32_bf16 v[48:51], a[216:219], a[8:11], v[32:35]
    v_mfma_f32_16x16x32_bf16 v[52:55], a[216:219], a[12:15], v[36:39]
    v_mfma_f32_16x16x32_bf16 v[40:43], a[220:223], a[16:19], v[40:43]
    v_mfma_f32_16x16x32_bf16 v[44:47], a[220:223], a[20:23], v[44:47]
    v_mfma_f32_16x16x32_bf16 v[48:51], a[220:223], a[24:27], v[48:51]
    v_mfma_f32_16x16x32_bf16 v[52:55], a[220:223], a[28:31], v[52:55]
    v_mfma_f32_16x16x32_bf16 v[40:43], a[224:227], a[32:35], v[40:43]
    v_mfma_f32_16x16x32_bf16 v[44:47], a[224:227], a[36:39], v[44:47]
    v_mfma_f32_16x16x32_bf16 v[48:51], a[224:227], a[40:43], v[48:51]
    v_mfma_f32_16x16x32_bf16 v[52:55], a[224:227], a[44:47], v[52:55]
    v_mfma_f32_16x16x32_bf16 v[40:43], a[228:231], a[48:51], v[40:43]
    v_mfma_f32_16x16x32_bf16 v[44:47], a[228:231], a[52:55], v[44:47]
    v_mfma_f32_16x16x32_bf16 v[48:51], a[228:231], a[56:59], v[48:51]
    v_mfma_f32_16x16x32_bf16 v[52:55], a[228:231], a[60:63], v[52:55]
    v_mfma_f32_16x16x32_bf16 v[40:43], a[232:235], a[64:67], v[40:43]
    v_mfma_f32_16x16x32_bf16 v[44:47], a[232:235], a[68:71], v[44:47]
    v_mfma_f32_16x16x32_bf16 v[48:51], a[232:235], a[72:75], v[48:51]
    v_mfma_f32_16x16x32_bf16 v[52:55], a[232:235], a[76:79], v[52:55]
    v_mfma_f32_16x16x32_bf16 v[40:43], a[236:239], a[80:83], v[40:43]
    v_mfma_f32_16x16x32_bf16 v[44:47], a[236:239], a[84:87], v[44:47]
    v_mfma_f32_16x16x32_bf16 v[48:51], a[236:239], a[88:91], v[48:51]
    v_mfma_f32_16x16x32_bf16 v[52:55], a[236:239], a[92:95], v[52:55]
    s_nop 7
    s_cmp_eq_u32 s78, 0
    s_cbranch_scc0 rare_p2
    v_max3_f32 v16, v16, v40, v41
    v_max3_f32 v16, v16, v42, v43
    v_max3_f32 v17, v17, v44, v45
    v_max3_f32 v17, v17, v46, v47
    v_max3_f32 v18, v18, v48, v49
    v_max3_f32 v18, v18, v50, v51
    v_max3_f32 v19, v19, v52, v53
    v_max3_f32 v19, v19, v54, v55
    s_add_u32 s77, s77, 6144
    s_cmp_lt_u32 s77, 196608
    s_cbranch_scc1 rare_loop
    v_mov_b32 v22, v16
    s_nop 1
    v_permlane16_swap_b32 v16, v22
    s_nop 1
    v_max_f32 v16, v16, v22
    v_mov_b32 v22, v16
    s_nop 1
    v_permlane32_swap_b32 v16, v22
    s_nop 1
    v_max_f32 v16, v16, v22
    v_sub_f32 v24, 0, v16
    v_sub_f32 v25, 0, v16
    v_sub_f32 v26, 0, v16
    v_sub_f32 v27, 0, v16
    v_mov_b32 v22, v17
    s_nop 1
    v_permlane16_swap_b32 v17, v22
    s_nop 1
    v_max_f32 v17, v17, v22
    v_mov_b32 v22, v17
    s_nop 1
    v_permlane32_swap_b32 v17, v22
    s_nop 1
    v_max_f32 v17, v17, v22
    v_sub_f32 v28, 0, v17
    v_sub_f32 v29, 0, v17
    v_sub_f32 v30, 0, v17
    v_sub_f32 v31, 0, v17
    v_mov_b32 v22, v18
    s_nop 1
    v_permlane16_swap_b32 v18, v22
    s_nop 1
    v_max_f32 v18, v18, v22
    v_mov_b32 v22, v18
    s_nop 1
    v_permlane32_swap_b32 v18, v22
    s_nop 1
    v_max_f32 v18, v18, v22
    v_sub_f32 v32, 0, v18
    v_sub_f32 v33, 0, v18
    v_sub_f32 v34, 0, v18
    v_sub_f32 v35, 0, v18
    v_mov_b32 v22, v19
    s_nop 1
    v_permlane16_swap_b32 v19, v22
    s_nop 1
    v_max_f32 v19, v19, v22
    v_mov_b32 v22, v19
    s_nop 1
    v_permlane32_swap_b32 v19, v22
    s_nop 1
    v_max_f32 v19, v19, v22
    v_sub_f32 v36, 0, v19
    v_sub_f32 v37, 0, v19
    v_sub_f32 v38, 0, v19
    v_sub_f32 v39, 0, v19
    s_mov_b32 s78, 1
    s_branch rare_pass
rare_p2:
    v_exp_f32 v40, v40
    v_exp_f32 v41, v41
    v_exp_f32 v42, v42
    v_exp_f32 v43, v43
    v_exp_f32 v44, v44
    v_exp_f32 v45, v45
    v_exp_f32 v46, v46
    v_exp_f32 v47, v47
    v_exp_f32 v48, v48
    v_exp_f32 v49, v49
    v_exp_f32 v50, v50
    v_exp_f32 v51, v51
    v_exp_f32 v52, v52
    v_exp_f32 v53, v53
    v_exp_f32 v54, v54
    v_exp_f32 v55, v55
    s_cmp_eq_u32 s77, 0
    s_cbranch_scc0 rare_d0
    v_cvt_pk_bf16_f32 v22, v40, v41
    v_cvt_pk_bf16_f32 v23, v42, v43
    v_accvgpr_write_b32 a96, v22
    v_accvgpr_write_b32 a97, v23
    v_cvt_pk_bf16_f32 v22, v44, v45
    v_cvt_pk_bf16_f32 v23, v46, v47
    v_accvgpr_write_b32 a104, v22
    v_accvgpr_write_b32 a105, v23
    v_cvt_pk_bf16_f32 v22, v48, v49
    v_cvt_pk_bf16_f32 v23, v50, v51
    v_accvgpr_write_b32 a112, v22
    v_accvgpr_write_b32 a113, v23
    v_cvt_pk_bf16_f32 v22, v52, v53
    v_cvt_pk_bf16_f32 v23, v54, v55
    v_accvgpr_write_b32 a120, v22
    v_accvgpr_write_b32 a121, v23
rare_d0:
    s_cmp_eq_u32 s77, 6144
    s_cbranch_scc0 rare_d1
    v_cvt_pk_bf16_f32 v22, v40, v41
    v_cvt_pk_bf16_f32 v23, v42, v43
    v_accvgpr_write_b32 a98, v22
    v_accvgpr_write_b32 a99, v23
    v_cvt_pk_bf16_f32 v22, v44, v45
    v_cvt_pk_bf16_f32 v23, v46, v47
    v_accvgpr_write_b32 a106, v22
    v_accvgpr_write_b32 a107, v23
    v_cvt_pk_bf16_f32 v22, v48, v49
    v_cvt_pk_bf16_f32 v23, v50, v51
    v_accvgpr_write_b32 a114, v22
    v_accvgpr_write_b32 a115, v23
    v_cvt_pk_bf16_f32 v22, v52, v53
    v_cvt_pk_bf16_f32 v23, v54, v55
    v_accvgpr_write_b32 a122, v22
    v_accvgpr_write_b32 a123, v23
rare_d1:
    s_cmp_eq_u32 s77, 12288
    s_cbranch_scc0 rare_d2
    v_cvt_pk_bf16_f32 v22, v40, v41
    v_cvt_pk_bf16_f32 v23, v42, v43
    v_accvgpr_write_b32 a100, v22
    v_accvgpr_write_b32 a101, v23
    v_cvt_pk_bf16_f32 v22, v44, v45
    v_cvt_pk_bf16_f32 v23, v46, v47
    v_accvgpr_write_b32 a108, v22
    v_accvgpr_write_b32 a109, v23
    v_cvt_pk_bf16_f32 v22, v48, v49
    v_cvt_pk_bf16_f32 v23, v50, v51
    v_accvgpr_write_b32 a116, v22
    v_accvgpr_write_b32 a117, v23
    v_cvt_pk_bf16_f32 v22, v52, v53
    v_cvt_pk_bf16_f32 v23, v54, v55
    v_accvgpr_write_b32 a124, v22
    v_accvgpr_write_b32 a125, v23
rare_d2:
    s_cmp_eq_u32 s77, 18432
    s_cbranch_scc0 rare_d3
    v_cvt_pk_bf16_f32 v22, v40, v41
    v_cvt_pk_bf16_f32 v23, v42, v43
    v_accvgpr_write_b32 a102, v22
    v_accvgpr_write_b32 a103, v23
    v_cvt_pk_bf16_f32 v22, v44, v45
    v_cvt_pk_bf16_f32 v23, v46, v47
    v_accvgpr_write_b32 a110, v22
    v_accvgpr_write_b32 a111, v23
    v_cvt_pk_bf16_f32 v22, v48, v49
    v_cvt_pk_bf16_f32 v23, v50, v51
    v_accvgpr_write_b32 a118, v22
    v_accvgpr_write_b32 a119, v23
    v_cvt_pk_bf16_f32 v22, v52, v53
    v_cvt_pk_bf16_f32 v23, v54, v55
    v_accvgpr_write_b32 a126, v22
    v_accvgpr_write_b32 a127, v23
rare_d3:
    s_cmp_eq_u32 s77, 24576
    s_cbranch_scc0 rare_d4
    v_cvt_pk_bf16_f32 v22, v40, v41
    v_cvt_pk_bf16_f32 v23, v42, v43
    v_accvgpr_write_b32 a128, v22
    v_accvgpr_write_b32 a129, v23
    v_cvt_pk_bf16_f32 v22, v44, v45
    v_cvt_pk_bf16_f32 v23, v46, v47
    v_accvgpr_write_b32 a136, v22
    v_accvgpr_write_b32 a137, v23
    v_cvt_pk_bf16_f32 v22, v48, v49
    v_cvt_pk_bf16_f32 v23, v50, v51
    v_accvgpr_write_b32 a144, v22
    v_accvgpr_write_b32 a145, v23
    v_cvt_pk_bf16_f32 v120, v52, v53
    v_cvt_pk_bf16_f32 v121, v54, v55
rare_d4:
    s_cmp_eq_u32 s77, 30720
    s_cbranch_scc0 rare_d5
    v_cvt_pk_bf16_f32 v22, v40, v41
    v_cvt_pk_bf16_f32 v23, v42, v43
    v_accvgpr_write_b32 a130, v22
    v_accvgpr_write_b32 a131, v23
    v_cvt_pk_bf16_f32 v22, v44, v45
    v_cvt_pk_bf16_f32 v23, v46, v47
    v_accvgpr_write_b32 a138, v22
    v_accvgpr_write_b32 a139, v23
    v_cvt_pk_bf16_f32 v22, v48, v49
    v_cvt_pk_bf16_f32 v23, v50, v51
    v_accvgpr_write_b32 a146, v22
    v_accvgpr_write_b32 a147, v23
    v_cvt_pk_bf16_f32 v122, v52, v53
    v_cvt_pk_bf16_f32 v123, v54, v55
rare_d5:
    s_cmp_eq_u32 s77, 36864
    s_cbranch_scc0 rare_d6
    v_cvt_pk_bf16_f32 v22, v40, v41
    v_cvt_pk_bf16_f32 v23, v42, v43
    v_accvgpr_write_b32 a132, v22
    v_accvgpr_write_b32 a133, v23
    v_cvt_pk_bf16_f32 v22, v44, v45
    v_cvt_pk_bf16_f32 v23, v46, v47
    v_accvgpr_write_b32 a140, v22
    v_accvgpr_write_b32 a141, v23
    v_cvt_pk_bf16_f32 v22, v48, v49
    v_cvt_pk_bf16_f32 v23, v50, v51
    v_accvgpr_write_b32 a148, v22
    v_accvgpr_write_b32 a149, v23
    v_cvt_pk_bf16_f32 v124, v52, v53
    v_cvt_pk_bf16_f32 v125, v54, v55
rare_d6:
    s_cmp_eq_u32 s77, 43008
    s_cbranch_scc0 rare_d7
    v_cvt_pk_bf16_f32 v22, v40, v41
    v_cvt_pk_bf16_f32 v23, v42, v43
    v_accvgpr_write_b32 a134, v22
    v_accvgpr_write_b32 a135, v23
    v_cvt_pk_bf16_f32 v22, v44, v45
    v_cvt_pk_bf16_f32 v23, v46, v47
    v_accvgpr_write_b32 a142, v22
    v_accvgpr_write_b32 a143, v23
    v_cvt_pk_bf16_f32 v22, v48, v49
    v_cvt_pk_bf16_f32 v23, v50, v51
    v_accvgpr_write_b32 a150, v22
    v_accvgpr_write_b32 a151, v23
    v_cvt_pk_bf16_f32 v126, v52, v53
    v_cvt_pk_bf16_f32 v127, v54, v55
rare_d7:
    s_cmp_eq_u32 s77, 49152
    s_cbranch_scc0 rare_d8
    v_cvt_pk_bf16_f32 v128, v40, v41
    v_cvt_pk_bf16_f32 v129, v42, v43
    v_cvt_pk_bf16_f32 v136, v44, v45
    v_cvt_pk_bf16_f32 v137, v46, v47
    v_cvt_pk_bf16_f32 v144, v48, v49
    v_cvt_pk_bf16_f32 v145, v50, v51
    v_cvt_pk_bf16_f32 v152, v52, v53
    v_cvt_pk_bf16_f32 v153, v54, v55
rare_d8:
    s_cmp_eq_u32 s77, 55296
    s_cbranch_scc0 rare_d9
    v_cvt_pk_bf16_f32 v130, v40, v41
    v_cvt_pk_bf16_f32 v131, v42, v43
    v_cvt_pk_bf16_f32 v138, v44, v45
    v_cvt_pk_bf16_f32 v139, v46, v47
    v_cvt_pk_bf16_f32 v146, v48, v49
    v_cvt_pk_bf16_f32 v147, v50, v51
    v_cvt_pk_bf16_f32 v154, v52, v53
    v_cvt_pk_bf16_f32 v155, v54, v55
rare_d9:
    s_cmp_eq_u32 s77, 61440
    s_cbranch_scc0 rare_d10
    v_cvt_pk_bf16_f32 v132, v40, v41
    v_cvt_pk_bf16_f32 v133, v42, v43
    v_cvt_pk_bf16_f32 v140, v44, v45
    v_cvt_pk_bf16_f32 v141, v46, v47
    v_cvt_pk_bf16_f32 v148, v48, v49
    v_cvt_pk_bf16_f32 v149, v50, v51
    v_cvt_pk_bf16_f32 v156, v52, v53
    v_cvt_pk_bf16_f32 v157, v54, v55
rare_d10:
    s_cmp_eq_u32 s77, 67584
    s_cbranch_scc0 rare_d11
    v_cvt_pk_bf16_f32 v134, v40, v41
    v_cvt_pk_bf16_f32 v135, v42, v43
    v_cvt_pk_bf16_f32 v142, v44, v45
    v_cvt_pk_bf16_f32 v143, v46, v47
    v_cvt_pk_bf16_f32 v150, v48, v49
    v_cvt_pk_bf16_f32 v151, v50, v51
    v_cvt_pk_bf16_f32 v158, v52, v53
    v_cvt_pk_bf16_f32 v159, v54, v55
rare_d11:
    s_cmp_eq_u32 s77, 73728
    s_cbranch_scc0 rare_d12
    v_cvt_pk_bf16_f32 v160, v40, v41
    v_cvt_pk_bf16_f32 v161, v42, v43
    v_cvt_pk_bf16_f32 v168, v44, v45
    v_cvt_pk_bf16_f32 v169, v46, v47
    v_cvt_pk_bf16_f32 v176, v48, v49
    v_cvt_pk_bf16_f32 v177, v50, v51
    v_cvt_pk_bf16_f32 v184, v52, v53
    v_cvt_pk_bf16_f32 v185, v54, v55
rare_d12:
    s_cmp_eq_u32 s77, 79872
    s_cbranch_scc0 rare_d13
    v_cvt_pk_bf16_f32 v162, v40, v41
    v_cvt_pk_bf16_f32 v163, v42, v43
    v_cvt_pk_bf16_f32 v170, v44, v45
    v_cvt_pk_bf16_f32 v171, v46, v47
    v_cvt_pk_bf16_f32 v178, v48, v49
    v_cvt_pk_bf16_f32 v179, v50, v51
    v_cvt_pk_bf16_f32 v186, v52, v53
    v_cvt_pk_bf16_f32 v187, v54, v55
rare_d13:
    s_cmp_eq_u32 s77, 86016
    s_cbranch_scc0 rare_d14
    v_cvt_pk_bf16_f32 v164, v40, v41
    v_cvt_pk_bf16_f32 v165, v42, v43
    v_cvt_pk_bf16_f32 v172, v44, v45
    v_cvt_pk_bf16_f32 v173, v46, v47
    v_cvt_pk_bf16_f32 v180, v48, v49
    v_cvt_pk_bf16_f32 v181, v50, v51
    v_cvt_pk_bf16_f32 v188, v52, v53
    v_cvt_pk_bf16_f32 v189, v54, v55
rare_d14:
    s_cmp_eq_u32 s77, 92160
    s_cbranch_scc0 rare_d15
    v_cvt_pk_bf16_f32 v166, v40, v41
    v_cvt_pk_bf16_f32 v167, v42, v43
    v_cvt_pk_bf16_f32 v174, v44, v45
    v_cvt_pk_bf16_f32 v175, v46, v47
    v_cvt_pk_bf16_f32 v182, v48, v49
    v_cvt_pk_bf16_f32 v183, v50, v51
    v_cvt_pk_bf16_f32 v190, v52, v53
    v_cvt_pk_bf16_f32 v191, v54, v55
rare_d15:
    s_cmp_eq_u32 s77, 98304
    s_cbranch_scc0 rare_d16
    v_cvt_pk_bf16_f32 v192, v40, v41
    v_cvt_pk_bf16_f32 v193, v42, v43
    v_cvt_pk_bf16_f32 v200, v44, v45
    v_cvt_pk_bf16_f32 v201, v46, v47
    v_cvt_pk_bf16_f32 v208, v48, v49
    v_cvt_pk_bf16_f32 v209, v50, v51
    v_cvt_pk_bf16_f32 v216, v52, v53
    v_cvt_pk_bf16_f32 v217, v54, v55
rare_d16:
    s_cmp_eq_u32 s77, 104448
    s_cbranch_scc0 rare_d17
    v_cvt_pk_bf16_f32 v194, v40, v41
    v_cvt_pk_bf16_f32 v195, v42, v43
    v_cvt_pk_bf16_f32 v202, v44, v45
    v_cvt_pk_bf16_f32 v203, v46, v47
    v_cvt_pk_bf16_f32 v210, v48, v49
    v_cvt_pk_bf16_f32 v211, v50, v51
    v_cvt_pk_bf16_f32 v218, v52, v53
    v_cvt_pk_bf16_f32 v219, v54, v55
rare_d17:
    s_cmp_eq_u32 s77, 110592
    s_cbranch_scc0 rare_d18
    v_cvt_pk_bf16_f32 v196, v40, v41
    v_cvt_pk_bf16_f32 v197, v42, v43
    v_cvt_pk_bf16_f32 v204, v44, v45
    v_cvt_pk_bf16_f32 v205, v46, v47
    v_cvt_pk_bf16_f32 v212, v48, v49
    v_cvt_pk_bf16_f32 v213, v50, v51
    v_cvt_pk_bf16_f32 v220, v52, v53
    v_cvt_pk_bf16_f32 v221, v54, v55
rare_d18:
    s_cmp_eq_u32 s77, 116736
    s_cbranch_scc0 rare_d19
    v_cvt_pk_bf16_f32 v198, v40, v41
    v_cvt_pk_bf16_f32 v199, v42, v43
    v_cvt_pk_bf16_f32 v206, v44, v45
    v_cvt_pk_bf16_f32 v207, v46, v47
    v_cvt_pk_bf16_f32 v214, v48, v49
    v_cvt_pk_bf16_f32 v215, v50, v51
    v_cvt_pk_bf16_f32 v222, v52, v53
    v_cvt_pk_bf16_f32 v223, v54, v55
rare_d19:
    s_cmp_eq_u32 s77, 122880
    s_cbranch_scc0 rare_d20
    v_cvt_pk_bf16_f32 v224, v40, v41
    v_cvt_pk_bf16_f32 v225, v42, v43
    v_cvt_pk_bf16_f32 v232, v44, v45
    v_cvt_pk_bf16_f32 v233, v46, v47
    v_cvt_pk_bf16_f32 v240, v48, v49
    v_cvt_pk_bf16_f32 v241, v50, v51
    v_cvt_pk_bf16_f32 v248, v52, v53
    v_cvt_pk_bf16_f32 v249, v54, v55
rare_d20:
    s_cmp_eq_u32 s77, 129024
    s_cbranch_scc0 rare_d21
    v_cvt_pk_bf16_f32 v226, v40, v41
    v_cvt_pk_bf16_f32 v227, v42, v43
    v_cvt_pk_bf16_f32 v234, v44, v45
    v_cvt_pk_bf16_f32 v235, v46, v47
    v_cvt_pk_bf16_f32 v242, v48, v49
    v_cvt_pk_bf16_f32 v243, v50, v51
    v_cvt_pk_bf16_f32 v250, v52, v53
    v_cvt_pk_bf16_f32 v251, v54, v55
rare_d21:
    s_cmp_eq_u32 s77, 135168
    s_cbranch_scc0 rare_d22
    v_cvt_pk_bf16_f32 v228, v40, v41
    v_cvt_pk_bf16_f32 v229, v42, v43
    v_cvt_pk_bf16_f32 v236, v44, v45
    v_cvt_pk_bf16_f32 v237, v46, v47
    v_cvt_pk_bf16_f32 v244, v48, v49
    v_cvt_pk_bf16_f32 v245, v50, v51
    v_cvt_pk_bf16_f32 v252, v52, v53
    v_cvt_pk_bf16_f32 v253, v54, v55
rare_d22:
    s_cmp_eq_u32 s77, 141312
    s_cbranch_scc0 rare_d23
    v_cvt_pk_bf16_f32 v230, v40, v41
    v_cvt_pk_bf16_f32 v231, v42, v43
    v_cvt_pk_bf16_f32 v238, v44, v45
    v_cvt_pk_bf16_f32 v239, v46, v47
    v_cvt_pk_bf16_f32 v246, v48, v49
    v_cvt_pk_bf16_f32 v247, v50, v51
    v_cvt_pk_bf16_f32 v254, v52, v53
    v_cvt_pk_bf16_f32 v255, v54, v55
rare_d23:
    s_cmp_eq_u32 s77, 147456
    s_cbranch_scc0 rare_d24
    v_cvt_pk_bf16_f32 v56, v40, v41
    v_cvt_pk_bf16_f32 v57, v42, v43
    v_cvt_pk_bf16_f32 v64, v44, v45
    v_cvt_pk_bf16_f32 v65, v46, v47
    v_cvt_pk_bf16_f32 v72, v48, v49
    v_cvt_pk_bf16_f32 v73, v50, v51
    v_cvt_pk_bf16_f32 v80, v52, v53
    v_cvt_pk_bf16_f32 v81, v54, v55
rare_d24:
    s_cmp_eq_u32 s77, 153600
    s_cbranch_scc0 rare_d25
    v_cvt_pk_bf16_f32 v58, v40, v41
    v_cvt_pk_bf16_f32 v59, v42, v43
    v_cvt_pk_bf16_f32 v66, v44, v45
    v_cvt_pk_bf16_f32 v67, v46, v47
    v_cvt_pk_bf16_f32 v74, v48, v49
    v_cvt_pk_bf16_f32 v75, v50, v51
    v_cvt_pk_bf16_f32 v82, v52, v53
    v_cvt_pk_bf16_f32 v83, v54, v55
rare_d25:
    s_cmp_eq_u32 s77, 159744
    s_cbranch_scc0 rare_d26
    v_cvt_pk_bf16_f32 v60, v40, v41
    v_cvt_pk_bf16_f32 v61, v42, v43
    v_cvt_pk_bf16_f32 v68, v44, v45
    v_cvt_pk_bf16_f32 v69, v46, v47
    v_cvt_pk_bf16_f32 v76, v48, v49
    v_cvt_pk_bf16_f32 v77, v50, v51
    v_cvt_pk_bf16_f32 v84, v52, v53
    v_cvt_pk_bf16_f32 v85, v54, v55
rare_d26:
    s_cmp_eq_u32 s77, 165888
    s_cbranch_scc0 rare_d27
    v_cvt_pk_bf16_f32 v62, v40, v41
    v_cvt_pk_bf16_f32 v63, v42, v43
    v_cvt_pk_bf16_f32 v70, v44, v45
    v_cvt_pk_bf16_f32 v71, v46, v47
    v_cvt_pk_bf16_f32 v78, v48, v49
    v_cvt_pk_bf16_f32 v79, v50, v51
    v_cvt_pk_bf16_f32 v86, v52, v53
    v_cvt_pk_bf16_f32 v87, v54, v55
rare_d27:
    s_cmp_eq_u32 s77, 172032
    s_cbranch_scc0 rare_d28
    v_cvt_pk_bf16_f32 v88, v40, v41
    v_cvt_pk_bf16_f32 v89, v42, v43
    v_cvt_pk_bf16_f32 v96, v44, v45
    v_cvt_pk_bf16_f32 v97, v46, v47
    v_cvt_pk_bf16_f32 v104, v48, v49
    v_cvt_pk_bf16_f32 v105, v50, v51
    v_cvt_pk_bf16_f32 v112, v52, v53
    v_cvt_pk_bf16_f32 v113, v54, v55
rare_d28:
    s_cmp_eq_u32 s77, 178176
    s_cbranch_scc0 rare_d29
    v_cvt_pk_bf16_f32 v90, v40, v41
    v_cvt_pk_bf16_f32 v91, v42, v43
    v_cvt_pk_bf16_f32 v98, v44, v45
    v_cvt_pk_bf16_f32 v99, v46, v47
    v_cvt_pk_bf16_f32 v106, v48, v49
    v_cvt_pk_bf16_f32 v107, v50, v51
    v_cvt_pk_bf16_f32 v114, v52, v53
    v_cvt_pk_bf16_f32 v115, v54, v55
rare_d29:
    s_cmp_eq_u32 s77, 184320
    s_cbranch_scc0 rare_d30
    v_cvt_pk_bf16_f32 v92, v40, v41
    v_cvt_pk_bf16_f32 v93, v42, v43
    v_cvt_pk_bf16_f32 v100, v44, v45
    v_cvt_pk_bf16_f32 v101, v46, v47
    v_cvt_pk_bf16_f32 v108, v48, v49
    v_cvt_pk_bf16_f32 v109, v50, v51
    v_cvt_pk_bf16_f32 v116, v52, v53
    v_cvt_pk_bf16_f32 v117, v54, v55
rare_d30:
    s_cmp_eq_u32 s77, 190464
    s_cbranch_scc0 rare_d31
    v_cvt_pk_bf16_f32 v94, v40, v41
    v_cvt_pk_bf16_f32 v95, v42, v43
    v_cvt_pk_bf16_f32 v102, v44, v45
    v_cvt_pk_bf16_f32 v103, v46, v47
    v_cvt_pk_bf16_f32 v110, v48, v49
    v_cvt_pk_bf16_f32 v111, v50, v51
    v_cvt_pk_bf16_f32 v118, v52, v53
    v_cvt_pk_bf16_f32 v119, v54, v55
rare_d31:
    s_add_u32 s77, s77, 6144
    s_cmp_lt_u32 s77, 196608
    s_cbranch_scc1 rare_loop
    ds_read_b64_tr_b16 a[216:217], v8 offset:0
    ds_read_b64_tr_b16 a[218:219], v8 offset:2048
    ds_read_b64_tr_b16 a[220:221], v9 offset:0
    ds_read_b64_tr_b16 a[222:223], v9 offset:2048
    s_waitcnt lgkmcnt(0)
    v_mfma_f32_16x16x32_bf16 a[152:155], a[216:219], a[96:99], 0
    v_mfma_f32_16x16x32_bf16 a[156:159], a[216:219], a[104:107], 0
    v_mfma_f32_16x16x32_bf16 a[160:163], a[216:219], a[112:115], 0
    v_mfma_f32_16x16x32_bf16 a[164:167], a[216:219], a[120:123], 0
    v_mfma_f32_16x16x32_bf16 a[168:171], a[220:223], a[96:99], 0
    v_mfma_f32_16x16x32_bf16 a[172:175], a[220:223], a[104:107], 0
    v_mfma_f32_16x16x32_bf16 a[176:179], a[220:223], a[112:115], 0
    v_mfma_f32_16x16x32_bf16 a[180:183], a[220:223], a[120:123], 0
    ds_read_b64_tr_b16 a[216:217], v8 offset:4096
    ds_read_b64_tr_b16 a[218:219], v8 offset:6144
    ds_read_b64_tr_b16 a[220:221], v9 offset:4096
    ds_read_b64_tr_b16 a[222:223], v9 offset:6144
    s_waitcnt lgkmcnt(0)
    v_mfma_f32_16x16x32_bf16 a[152:155], a[216:219], a[100:103], a[152:155]
    v_mfma_f32_16x16x32_bf16 a[156:159], a[216:219], a[108:111], a[156:159]
    v_mfma_f32_16x16x32_bf16 a[160:163], a[216:219], a[116:119], a[160:163]
    v_mfma_f32_16x16x32_bf16 a[164:167], a[216:219], a[124:127], a[164:167]
    v_mfma_f32_16x16x32_bf16 a[168:171], a[220:223], a[100:103], a[168:171]
    v_mfma_f32_16x16x32_bf16 a[172:175], a[220:223], a[108:111], a[172:175]
    v_mfma_f32_16x16x32_bf16 a[176:179], a[220:223], a[116:119], a[176:179]
    v_mfma_f32_16x16x32_bf16 a[180:183], a[220:223], a[124:127], a[180:183]
    ds_read_b64_tr_b16 a[216:217], v8 offset:8192
    ds_read_b64_tr_b16 a[218:219], v8 offset:10240
    ds_read_b64_tr_b16 a[220:221], v9 offset:8192
    ds_read_b64_tr_b16 a[222:223], v9 offset:10240
    s_waitcnt lgkmcnt(0)
    v_mfma_f32_16x16x32_bf16 a[152:155], a[216:219], a[128:131], a[152:155]
    v_mfma_f32_16x16x32_bf16 a[156:159], a[216:219], a[136:139], a[156:159]
    v_mfma_f32_16x16x32_bf16 a[160:163], a[216:219], a[144:147], a[160:163]
    v_mfma_f32_16x16x32_bf16 a[164:167], a[216:219], v[120:123], a[164:167]
    v_mfma_f32_16x16x32_bf16 a[168:171], a[220:223], a[128:131], a[168:171]
    v_mfma_f32_16x16x32_bf16 a[172:175], a[220:223], a[136:139], a[172:175]
    v_mfma_f32_16x16x32_bf16 a[176:179], a[220:223], a[144:147], a[176:179]
    v_mfma_f32_16x16x32_bf16 a[180:183], a[220:223], v[120:123], a[180:183]
    ds_read_b64_tr_b16 a[216:217], v8 offset:12288
    ds_read_b64_tr_b16 a[218:219], v8 offset:14336
    ds_read_b64_tr_b16 a[220:221], v9 offset:12288
    ds_read_b64_tr_b16 a[222:223], v9 offset:14336
    s_waitcnt lgkmcnt(0)
    v_mfma_f32_16x16x32_bf16 a[152:155], a[216:219], a[132:135], a[152:155]
    v_mfma_f32_16x16x32_bf16 a[156:159], a[216:219], a[140:143], a[156:159]
    v_mfma_f32_16x16x32_bf16 a[160:163], a[216:219], a[148:151], a[160:163]
    v_mfma_f32_16x16x32_bf16 a[164:167], a[216:219], v[124:127], a[164:167]
    v_mfma_f32_16x16x32_bf16 a[168:171], a[220:223], a[132:135], a[168:171]
    v_mfma_f32_16x16x32_bf16 a[172:175], a[220:223], a[140:143], a[172:175]
    v_mfma_f32_16x16x32_bf16 a[176:179], a[220:223], a[148:151], a[176:179]
    v_mfma_f32_16x16x32_bf16 a[180:183], a[220:223], v[124:127], a[180:183]
    ds_read_b64_tr_b16 a[216:217], v8 offset:16384
    ds_read_b64_tr_b16 a[218:219], v8 offset:18432
    ds_read_b64_tr_b16 a[220:221], v9 offset:16384
    ds_read_b64_tr_b16 a[222:223], v9 offset:18432
    s_waitcnt lgkmcnt(0)
    v_mfma_f32_16x16x32_bf16 a[152:155], a[216:219], v[128:131], a[152:155]
    v_mfma_f32_16x16x32_bf16 a[156:159], a[216:219], v[136:139], a[156:159]
    v_mfma_f32_16x16x32_bf16 a[160:163], a[216:219], v[144:147], a[160:163]
    v_mfma_f32_16x16x32_bf16 a[164:167], a[216:219], v[152:155], a[164:167]
    v_mfma_f32_16x16x32_bf16 a[168:171], a[220:223], v[128:131], a[168:171]
    v_mfma_f32_16x16x32_bf16 a[172:175], a[220:223], v[136:139], a[172:175]
    v_mfma_f32_16x16x32_bf16 a[176:179], a[220:223], v[144:147], a[176:179]
    v_mfma_f32_16x16x32_bf16 a[180:183], a[220:223], v[152:155], a[180:183]
    ds_read_b64_tr_b16 a[216:217], v8 offset:20480
    ds_read_b64_tr_b16 a[218:219], v8 offset:22528
    ds_read_b64_tr_b16 a[220:221], v9 offset:20480
    ds_read_b64_tr_b16 a[222:223], v9 offset:22528
    s_waitcnt lgkmcnt(0)
    v_mfma_f32_16x16x32_bf16 a[152:155], a[216:219], v[132:135], a[152:155]
    v_mfma_f32_16x16x32_bf16 a[156:159], a[216:219], v[140:143], a[156:159]
    v_mfma_f32_16x16x32_bf16 a[160:163], a[216:219], v[148:151], a[160:163]
    v_mfma_f32_16x16x32_bf16 a[164:167], a[216:219], v[156:159], a[164:167]
    v_mfma_f32_16x16x32_bf16 a[168:171], a[220:223], v[132:135], a[168:171]
    v_mfma_f32_16x16x32_bf16 a[172:175], a[220:223], v[140:143], a[172:175]
    v_mfma_f32_16x16x32_bf16 a[176:179], a[220:223], v[148:151], a[176:179]
    v_mfma_f32_16x16x32_bf16 a[180:183], a[220:223], v[156:159], a[180:183]
    ds_read_b64_tr_b16 a[216:217], v8 offset:24576
    ds_read_b64_tr_b16 a[218:219], v8 offset:26624
    ds_read_b64_tr_b16 a[220:221], v9 offset:24576
    ds_read_b64_tr_b16 a[222:223], v9 offset:26624
    s_waitcnt lgkmcnt(0)
    v_mfma_f32_16x16x32_bf16 a[152:155], a[216:219], v[160:163], a[152:155]
    v_mfma_f32_16x16x32_bf16 a[156:159], a[216:219], v[168:171], a[156:159]
    v_mfma_f32_16x16x32_bf16 a[160:163], a[216:219], v[176:179], a[160:163]
    v_mfma_f32_16x16x32_bf16 a[164:167], a[216:219], v[184:187], a[164:167]
    v_mfma_f32_16x16x32_bf16 a[168:171], a[220:223], v[160:163], a[168:171]
    v_mfma_f32_16x16x32_bf16 a[172:175], a[220:223], v[168:171], a[172:175]
    v_mfma_f32_16x16x32_bf16 a[176:179], a[220:223], v[176:179], a[176:179]
    v_mfma_f32_16x16x32_bf16 a[180:183], a[220:223], v[184:187], a[180:183]
    ds_read_b64_tr_b16 a[216:217], v8 offset:28672
    ds_read_b64_tr_b16 a[218:219], v8 offset:30720
    ds_read_b64_tr_b16 a[220:221], v9 offset:28672
    ds_read_b64_tr_b16 a[222:223], v9 offset:30720
    s_waitcnt lgkmcnt(0)
    v_mfma_f32_16x16x32_bf16 a[152:155], a[216:219], v[164:167], a[152:155]
    v_mfma_f32_16x16x32_bf16 a[156:159], a[216:219], v[172:175], a[156:159]
    v_mfma_f32_16x16x32_bf16 a[160:163], a[216:219], v[180:183], a[160:163]
    v_mfma_f32_16x16x32_bf16 a[164:167], a[216:219], v[188:191], a[164:167]
    v_mfma_f32_16x16x32_bf16 a[168:171], a[220:223], v[164:167], a[168:171]
    v_mfma_f32_16x16x32_bf16 a[172:175], a[220:223], v[172:175], a[172:175]
    v_mfma_f32_16x16x32_bf16 a[176:179], a[220:223], v[180:183], a[176:179]
    v_mfma_f32_16x16x32_bf16 a[180:183], a[220:223], v[188:191], a[180:183]
    ds_read_b64_tr_b16 a[216:217], v8 offset:32768
    ds_read_b64_tr_b16 a[218:219], v8 offset:34816
    ds_read_b64_tr_b16 a[220:221], v9 offset:32768
    ds_read_b64_tr_b16 a[222:223], v9 offset:34816
    s_waitcnt lgkmcnt(0)
    v_mfma_f32_16x16x32_bf16 a[152:155], a[216:219], v[192:195], a[152:155]
    v_mfma_f32_16x16x32_bf16 a[156:159], a[216:219], v[200:203], a[156:159]
    v_mfma_f32_16x16x32_bf16 a[160:163], a[216:219], v[208:211], a[160:163]
    v_mfma_f32_16x16x32_bf16 a[164:167], a[216:219], v[216:219], a[164:167]
    v_mfma_f32_16x16x32_bf16 a[168:171], a[220:223], v[192:195], a[168:171]
    v_mfma_f32_16x16x32_bf16 a[172:175], a[220:223], v[200:203], a[172:175]
    v_mfma_f32_16x16x32_bf16 a[176:179], a[220:223], v[208:211], a[176:179]
    v_mfma_f32_16x16x32_bf16 a[180:183], a[220:223], v[216:219], a[180:183]
    ds_read_b64_tr_b16 a[216:217], v8 offset:36864
    ds_read_b64_tr_b16 a[218:219], v8 offset:38912
    ds_read_b64_tr_b16 a[220:221], v9 offset:36864
    ds_read_b64_tr_b16 a[222:223], v9 offset:38912
    s_waitcnt lgkmcnt(0)
    v_mfma_f32_16x16x32_bf16 a[152:155], a[216:219], v[196:199], a[152:155]
    v_mfma_f32_16x16x32_bf16 a[156:159], a[216:219], v[204:207], a[156:159]
    v_mfma_f32_16x16x32_bf16 a[160:163], a[216:219], v[212:215], a[160:163]
    v_mfma_f32_16x16x32_bf16 a[164:167], a[216:219], v[220:223], a[164:167]
    v_mfma_f32_16x16x32_bf16 a[168:171], a[220:223], v[196:199], a[168:171]
    v_mfma_f32_16x16x32_bf16 a[172:175], a[220:223], v[204:207], a[172:175]
    v_mfma_f32_16x16x32_bf16 a[176:179], a[220:223], v[212:215], a[176:179]
    v_mfma_f32_16x16x32_bf16 a[180:183], a[220:223], v[220:223], a[180:183]
    ds_read_b64_tr_b16 a[216:217], v8 offset:40960
    ds_read_b64_tr_b16 a[218:219], v8 offset:43008
    ds_read_b64_tr_b16 a[220:221], v9 offset:40960
    ds_read_b64_tr_b16 a[222:223], v9 offset:43008
    s_waitcnt lgkmcnt(0)
    v_mfma_f32_16x16x32_bf16 a[152:155], a[216:219], v[224:227], a[152:155]
    v_mfma_f32_16x16x32_bf16 a[156:159], a[216:219], v[232:235], a[156:159]
    v_mfma_f32_16x16x32_bf16 a[160:163], a[216:219], v[240:243], a[160:163]
    v_mfma_f32_16x16x32_bf16 a[164:167], a[216:219], v[248:251], a[164:167]
    v_mfma_f32_16x16x32_bf16 a[168:171], a[220:223], v[224:227], a[168:171]
    v_mfma_f32_16x16x32_bf16 a[172:175], a[220:223], v[232:235], a[172:175]
    v_mfma_f32_16x16x32_bf16 a[176:179], a[220:223], v[240:243], a[176:179]
    v_mfma_f32_16x16x32_bf16 a[180:183], a[220:223], v[248:251], a[180:183]
    ds_read_b64_tr_b16 a[216:217], v8 offset:45056
    ds_read_b64_tr_b16 a[218:219], v8 offset:47104
    ds_read_b64_tr_b16 a[220:221], v9 offset:45056
    ds_read_b64_tr_b16 a[222:223], v9 offset:47104
    s_waitcnt lgkmcnt(0)
    v_mfma_f32_16x16x32_bf16 a[152:155], a[216:219], v[228:231], a[152:155]
    v_mfma_f32_16x16x32_bf16 a[156:159], a[216:219], v[236:239], a[156:159]
    v_mfma_f32_16x16x32_bf16 a[160:163], a[216:219], v[244:247], a[160:163]
    v_mfma_f32_16x16x32_bf16 a[164:167], a[216:219], v[252:255], a[164:167]
    v_mfma_f32_16x16x32_bf16 a[168:171], a[220:223], v[228:231], a[168:171]
    v_mfma_f32_16x16x32_bf16 a[172:175], a[220:223], v[236:239], a[172:175]
    v_mfma_f32_16x16x32_bf16 a[176:179], a[220:223], v[244:247], a[176:179]
    v_mfma_f32_16x16x32_bf16 a[180:183], a[220:223], v[252:255], a[180:183]
    ds_read_b64_tr_b16 a[216:217], v8 offset:49152
    ds_read_b64_tr_b16 a[218:219], v8 offset:51200
    ds_read_b64_tr_b16 a[220:221], v9 offset:49152
    ds_read_b64_tr_b16 a[222:223], v9 offset:51200
    s_waitcnt lgkmcnt(0)
    v_mfma_f32_16x16x32_bf16 a[152:155], a[216:219], v[56:59], a[152:155]
    v_mfma_f32_16x16x32_bf16 a[156:159], a[216:219], v[64:67], a[156:159]
    v_mfma_f32_16x16x32_bf16 a[160:163], a[216:219], v[72:75], a[160:163]
    v_mfma_f32_16x16x32_bf16 a[164:167], a[216:219], v[80:83], a[164:167]
    v_mfma_f32_16x16x32_bf16 a[168:171], a[220:223], v[56:59], a[168:171]
    v_mfma_f32_16x16x32_bf16 a[172:175], a[220:223], v[64:67], a[172:175]
    v_mfma_f32_16x16x32_bf16 a[176:179], a[220:223], v[72:75], a[176:179]
    v_mfma_f32_16x16x32_bf16 a[180:183], a[220:223], v[80:83], a[180:183]
    ds_read_b64_tr_b16 a[216:217], v8 offset:53248
    ds_read_b64_tr_b16 a[218:219], v8 offset:55296
    ds_read_b64_tr_b16 a[220:221], v9 offset:53248
    ds_read_b64_tr_b16 a[222:223], v9 offset:55296
    s_waitcnt lgkmcnt(0)
    v_mfma_f32_16x16x32_bf16 a[152:155], a[216:219], v[60:63], a[152:155]
    v_mfma_f32_16x16x32_bf16 a[156:159], a[216:219], v[68:71], a[156:159]
    v_mfma_f32_16x16x32_bf16 a[160:163], a[216:219], v[76:79], a[160:163]
    v_mfma_f32_16x16x32_bf16 a[164:167], a[216:219], v[84:87], a[164:167]
    v_mfma_f32_16x16x32_bf16 a[168:171], a[220:223], v[60:63], a[168:171]
    v_mfma_f32_16x16x32_bf16 a[172:175], a[220:223], v[68:71], a[172:175]
    v_mfma_f32_16x16x32_bf16 a[176:179], a[220:223], v[76:79], a[176:179]
    v_mfma_f32_16x16x32_bf16 a[180:183], a[220:223], v[84:87], a[180:183]
    ds_read_b64_tr_b16 a[216:217], v8 offset:57344
    ds_read_b64_tr_b16 a[218:219], v8 offset:59392
    ds_read_b64_tr_b16 a[220:221], v9 offset:57344
    ds_read_b64_tr_b16 a[222:223], v9 offset:59392
    s_waitcnt lgkmcnt(0)
    v_mfma_f32_16x16x32_bf16 a[152:155], a[216:219], v[88:91], a[152:155]
    v_mfma_f32_16x16x32_bf16 a[156:159], a[216:219], v[96:99], a[156:159]
    v_mfma_f32_16x16x32_bf16 a[160:163], a[216:219], v[104:107], a[160:163]
    v_mfma_f32_16x16x32_bf16 a[164:167], a[216:219], v[112:115], a[164:167]
    v_mfma_f32_16x16x32_bf16 a[168:171], a[220:223], v[88:91], a[168:171]
    v_mfma_f32_16x16x32_bf16 a[172:175], a[220:223], v[96:99], a[172:175]
    v_mfma_f32_16x16x32_bf16 a[176:179], a[220:223], v[104:107], a[176:179]
    v_mfma_f32_16x16x32_bf16 a[180:183], a[220:223], v[112:115], a[180:183]
    ds_read_b64_tr_b16 a[216:217], v8 offset:61440
    ds_read_b64_tr_b16 a[218:219], v8 offset:63488
    ds_read_b64_tr_b16 a[220:221], v9 offset:61440
    ds_read_b64_tr_b16 a[222:223], v9 offset:63488
    s_waitcnt lgkmcnt(0)
    v_mfma_f32_16x16x32_bf16 a[152:155], a[216:219], v[92:95], a[152:155]
    v_mfma_f32_16x16x32_bf16 a[156:159], a[216:219], v[100:103], a[156:159]
    v_mfma_f32_16x16x32_bf16 a[160:163], a[216:219], v[108:111], a[160:163]
    v_mfma_f32_16x16x32_bf16 a[164:167], a[216:219], v[116:119], a[164:167]
    v_mfma_f32_16x16x32_bf16 a[168:171], a[220:223], v[92:95], a[168:171]
    v_mfma_f32_16x16x32_bf16 a[172:175], a[220:223], v[100:103], a[172:175]
    v_mfma_f32_16x16x32_bf16 a[176:179], a[220:223], v[108:111], a[176:179]
    v_mfma_f32_16x16x32_bf16 a[180:183], a[220:223], v[116:119], a[180:183]
    v_mov_b32 v24, 0
    v_mov_b32 v25, 0
    v_mov_b32 v26, 0
    v_mov_b32 v27, 0
    v_mov_b32 v28, 0
    v_mov_b32 v29, 0
    v_mov_b32 v30, 0
    v_mov_b32 v31, 0
    v_mov_b32 v32, 0
    v_mov_b32 v33, 0
    v_mov_b32 v34, 0
    v_mov_b32 v35, 0
    v_mov_b32 v36, 0
    v_mov_b32 v37, 0
    v_mov_b32 v38, 0
    v_mov_b32 v39, 0
    s_nop 1
    v_smfmac_f32_16x16x64_bf16 v[24:27], a[248:251], a[96:103], v20
    v_smfmac_f32_16x16x64_bf16 v[28:31], a[248:251], a[104:111], v20
    v_smfmac_f32_16x16x64_bf16 v[32:35], a[248:251], a[112:119], v20
    v_smfmac_f32_16x16x64_bf16 v[36:39], a[248:251], a[120:127], v20
    v_smfmac_f32_16x16x64_bf16 v[24:27], a[248:251], a[128:135], v20
    v_smfmac_f32_16x16x64_bf16 v[28:31], a[248:251], a[136:143], v20
    v_smfmac_f32_16x16x64_bf16 v[32:35], a[248:251], a[144:151], v20
    v_smfmac_f32_16x16x64_bf16 v[36:39], a[248:251], v[120:127], v20
    v_smfmac_f32_16x16x64_bf16 v[24:27], a[248:251], v[128:135], v20
    v_smfmac_f32_16x16x64_bf16 v[28:31], a[248:251], v[136:143], v20
    v_smfmac_f32_16x16x64_bf16 v[32:35], a[248:251], v[144:151], v20
    v_smfmac_f32_16x16x64_bf16 v[36:39], a[248:251], v[152:159], v20
    v_smfmac_f32_16x16x64_bf16 v[24:27], a[248:251], v[160:167], v20
    v_smfmac_f32_16x16x64_bf16 v[28:31], a[248:251], v[168:175], v20
    v_smfmac_f32_16x16x64_bf16 v[32:35], a[248:251], v[176:183], v20
    v_smfmac_f32_16x16x64_bf16 v[36:39], a[248:251], v[184:191], v20
    v_smfmac_f32_16x16x64_bf16 v[24:27], a[248:251], v[192:199], v20
    v_smfmac_f32_16x16x64_bf16 v[28:31], a[248:251], v[200:207], v20
    v_smfmac_f32_16x16x64_bf16 v[32:35], a[248:251], v[208:215], v20
    v_smfmac_f32_16x16x64_bf16 v[36:39], a[248:251], v[216:223], v20
    v_smfmac_f32_16x16x64_bf16 v[24:27], a[248:251], v[224:231], v20
    v_smfmac_f32_16x16x64_bf16 v[28:31], a[248:251], v[232:239], v20
    v_smfmac_f32_16x16x64_bf16 v[32:35], a[248:251], v[240:247], v20
    v_smfmac_f32_16x16x64_bf16 v[36:39], a[248:251], v[248:255], v20
    v_smfmac_f32_16x16x64_bf16 v[24:27], a[248:251], v[56:63], v20
    v_smfmac_f32_16x16x64_bf16 v[28:31], a[248:251], v[64:71], v20
    v_smfmac_f32_16x16x64_bf16 v[32:35], a[248:251], v[72:79], v20
    v_smfmac_f32_16x16x64_bf16 v[36:39], a[248:251], v[80:87], v20
    v_smfmac_f32_16x16x64_bf16 v[24:27], a[248:251], v[88:95], v20
    v_smfmac_f32_16x16x64_bf16 v[28:31], a[248:251], v[96:103], v20
    v_smfmac_f32_16x16x64_bf16 v[32:35], a[248:251], v[104:111], v20
    v_smfmac_f32_16x16x64_bf16 v[36:39], a[248:251], v[112:119], v20
    s_nop 15
    v_add_f32 v24, v24, v25
    v_add_f32 v28, v28, v29
    v_add_f32 v32, v32, v33
    v_add_f32 v36, v36, v37
    v_rcp_f32 v16, v24
    v_rcp_f32 v17, v28
    v_rcp_f32 v18, v32
    v_rcp_f32 v19, v36
    s_nop 1
    s_branch rare_ret
code_end:
    s_endpgm
.section .rodata,"a"
.p2align 6
.amdhsa_kernel recurrent_scan__sliding_block_cached__moe_arch_mod__prompt_kernel
  .amdhsa_next_free_vgpr 512
  .amdhsa_next_free_sgpr 102
  .amdhsa_accum_offset 256
  .amdhsa_group_segment_fixed_size 0
  .amdhsa_kernarg_size 104
  .amdhsa_user_sgpr_count 2
  .amdhsa_user_sgpr_kernarg_segment_ptr 1
  .amdhsa_system_sgpr_workgroup_id_x 1
  .amdhsa_float_denorm_mode_32 3
.end_amdhsa_kernel
```

```asm
; @launch grid=(256,1,1) block=(256,1,1) lds=163840
.amdgcn_target "amdgcn-amd-amdhsa--gfx950"
.text
.globl recurrent_scan__sliding_block_cached__moe_arch_mod__prompt_kernel
.p2align 12
.p2align 8
.type recurrent_scan__sliding_block_cached__moe_arch_mod__prompt_kernel,@function
recurrent_scan__sliding_block_cached__moe_arch_mod__prompt_kernel:
    s_cmp_ge_u32 s2, 256
    s_cbranch_scc1 main_end
    s_load_dwordx16 s[64:79], s[0:1], 0
    s_load_dwordx4 s[80:83], s[0:1], 64
    s_load_dwordx2 s[84:85], s[0:1], 80
    s_load_dwordx2 s[86:87], s[0:1], 96
    s_lshr_b32 s56, s2, 3
    s_lshl_b32 s56, s56, 10
    v_lshrrev_b32 v18, 5, v0
    v_lshlrev_b32 v18, 7, v18
    v_add_u32 v18, s56, v18
    s_getpc_b64 s[88:89]
code0:
    v_and_b32 v19, 3, v0
    v_lshl_add_u32 v19, v19, 15, v18
    v_min_u32 v19, code_end-code0-4, v19
    global_load_dword a252, v19, s[88:89]
    v_lshrrev_b32 v17, 6, v0
    v_lshlrev_b32 v17, 12, v17
    v_and_b32 v1, 63, v0
    v_lshl_add_u32 v17, v1, 4, v17
    v_lshrrev_b32 v29, 6, v0
    v_mov_b32 v16, v0
    v_readfirstlane_b32 s3, v29
    s_and_b32 s53, s2, 7
    s_lshr_b32 s52, s2, 5
    s_bfe_u32 s51, s2, 0x20003
    s_lshl_b32 s50, s53, 2
    s_add_u32 s50, s50, s51
    s_lshl_b32 s60, s2, 3
    s_lshl_b32 s56, s3, 1
    s_add_u32 s60, s60, s56
    v_bfe_u32 v240, v1, 2, 1
    v_add_u32 v240, s60, v240
    v_lshrrev_b32 v241, 3, v1
    v_lshlrev_b32 v241, 6, v241
    v_and_b32 v29, 3, v1
    v_lshl_add_u32 v241, v29, 4, v241
    v_mul_u32_u24 v242, 1280, v240
    v_add_u32 v242, v242, v241
    v_lshrrev_b32 v29, 4, v1
    v_lshlrev_b32 v29, 1, v29
    v_and_b32 v7, 7, v1
    v_xor_b32 v7, v7, v29
    v_lshlrev_b32 v7, 4, v7
    v_lshrrev_b32 v29, 5, v1
    v_lshlrev_b32 v29, 3, v29
    v_bfe_u32 v5, v1, 3, 2
    v_add_u32 v5, v5, v29
    v_mul_u32_u24 v2, 12288, v5
    v_add_u32 v2, v2, v7
    v_add_u32 v3, 196608, v2
    s_lshl_b32 s54, s52, 2
    s_add_u32 s54, s54, s3
    s_mul_i32 s49, s3, 6144
    s_lshr_b32 s59, s3, 1
    s_lshl_b32 s59, s59, 5
    s_and_b32 s56, s3, 1
    s_lshl_b32 s56, s56, 2
    s_add_u32 s59, s59, s56
    s_mul_i32 s36, s59, 12288
    s_mov_b32 s37, 786432
    s_add_u32 s45, s51, s52
    s_and_b32 s45, s45, 3
    s_lshl_b32 s45, s45, 2
    s_lshr_b32 s45, 0x5050, s45
    s_and_b32 s45, s45, 15
    s_mul_i32 s56, s45, 786432
    s_add_u32 s36, s36, s56
    s_lshl_b32 s45, s45, 13
    s_andn2_b32 s56, 2, s2
    s_lshl_b32 s56, s56, 9
    s_add_u32 s45, s45, s56
    s_mul_i32 s56, s50, 384
    s_sub_u32 s57, 7864320, s56
    s_waitcnt lgkmcnt(0)
    s_mov_b32 s12, s64
    s_and_b32 s13, s65, 0xffff
    s_mov_b32 s14, 2621440
    s_mov_b32 s15, 0x00020000
    s_mov_b32 s16, s76
    s_and_b32 s17, s77, 0xffff
    s_mov_b32 s18, 1280
    s_mov_b32 s19, 0x00020000
    buffer_load_dwordx4 v[64:67], v242, s[12:15], 0 offen
    buffer_load_dwordx4 v[68:71], v242, s[12:15], 0 offen offset:512
    buffer_load_dwordx4 v[72:75], v242, s[12:15], 0 offen offset:1024
    v_mov_b32 v25, 3203072
    global_load_dword v26, v25, s[86:87] sc1
    s_lshr_b32 s44, s2, 3
    s_lshl_b32 s44, s44, 7
    s_add_u32 s44, s44, 4128768
    s_load_dword s93, s[86:87], s44 glc
    s_add_u32 s8, s70, s56
    s_addc_u32 s9, s71, 0
    s_and_b32 s9, s9, 0xffff
    s_mov_b32 s10, s57
    s_mov_b32 s11, 0x00020000
    s_add_u32 m0, s49, 49152
    s_nop 0
    buffer_load_dwordx4 v2, s[8:11], s36 offen offset:0 lds
    s_add_u32 m0, s49, 50048
    s_nop 0
    buffer_load_dwordx4 v2, s[8:11], s36 offen offset:128 lds
    s_add_u32 m0, s49, 50944
    s_nop 0
    buffer_load_dwordx4 v2, s[8:11], s36 offen offset:256 lds
    s_add_u32 m0, s49, 52224
    s_nop 0
    buffer_load_dwordx4 v3, s[8:11], s36 offen offset:0 lds
    s_add_u32 m0, s49, 53120
    s_nop 0
    buffer_load_dwordx4 v3, s[8:11], s36 offen offset:128 lds
    s_add_u32 m0, s49, 54016
    s_nop 0
    buffer_load_dwordx4 v3, s[8:11], s36 offen offset:256 lds
    s_add_u32 s36, s36, s37
    s_sub_u32 s55, s36, 7864320
    s_min_u32 s36, s36, s55
    buffer_load_dwordx4 v[76:79], v241, s[16:19], 0 offen offset:0
    buffer_load_dwordx4 v[80:83], v241, s[16:19], 0 offen offset:512
    buffer_load_dwordx4 v[84:87], v241, s[16:19], 0 offen offset:1024
    s_mov_b32 s24, s86
    s_and_b32 s25, s87, 0xffff
    s_mov_b32 s26, 268435456
    s_mov_b32 s27, 0x00020000
    v_lshrrev_b32 v243, 6, v240
    v_mul_u32_u24 v243, 81920, v243
    v_bfe_u32 v29, v240, 4, 2
    v_lshl_add_u32 v243, v29, 10, v243
    v_and_b32 v29, 15, v240
    v_lshl_add_u32 v243, v29, 6, v243
    v_lshrrev_b32 v29, 3, v1
    v_lshl_add_u32 v243, v29, 12, v243
    v_and_b32 v29, 3, v1
    v_lshl_add_u32 v243, v29, 4, v243
    s_mov_b32 s38, 0x3acccccd
    s_mov_b32 s39, 0x3727c5ac
    s_mov_b32 s41, 0
    s_mov_b32 s42, 32768
    s_mov_b32 s43, 65536
    v_bfe_u32 v29, v1, 2, 3
    v_lshlrev_b32 v8, 7, v29
    v_lshrrev_b32 v29, 1, v29
    v_xor_b32 v29, 0, v29
    v_lshl_add_u32 v8, v29, 5, v8
    v_and_b32 v29, 3, v1
    v_lshl_add_u32 v8, v29, 3, v8
    v_lshrrev_b32 v29, 5, v1
    v_mul_u32_u24 v29, 3072, v29
    v_add_u32 v8, v8, v29
    v_add_u32 v8, 49152, v8
    v_xor_b32 v9, 32, v8
    v_xor_b32 v10, 64, v8
    v_xor_b32 v11, 96, v8
    v_and_b32 v15, 15, v1
    v_lshlrev_b32 v15, 6, v15
    v_lshrrev_b32 v29, 4, v1
    v_lshl_add_u32 v15, v29, 4, v15
    s_and_b32 s56, s2, 1
    s_lshl_b32 s56, s56, 11
    v_add_u32 v15, s56, v15
    v_xor_b32 v14, 2048, v15
    s_mul_i32 s56, s54, 81920
    s_add_u32 s56, s56, 0
    s_add_u32 s20, s86, s56
    s_addc_u32 s21, s87, 0
    s_and_b32 s21, s21, 0xffff
    s_mov_b32 s22, 81920
    s_mov_b32 s23, 0x00020000
    s_lshl_b32 s46, s54, 7
    s_add_u32 s46, s46, 4128768
    s_mov_b32 s101, 0
    s_lshl_b32 s56, s53, 12
    s_add_u32 s46, s46, s56
    s_load_dword s92, s[86:87], s46 glc
    s_lshr_b32 s6, s2, 3
    s_lshl_b32 s6, s6, 7
    s_lshl_b32 s56, s53, 2
    s_add_u32 s6, s6, s56
    s_add_u32 s6, s6, 4128768
    s_cmp_eq_u32 s3, 0
    s_cselect_b32 s6, s6, 0x70000000
    v_lshlrev_b32 v20, 12, v1
    s_waitcnt vmcnt(10)
    v_lshlrev_b32 v96, 16, v64
    v_and_b32 v97, 0xffff0000, v64
    v_lshlrev_b32 v98, 16, v65
    v_and_b32 v99, 0xffff0000, v65
    v_lshlrev_b32 v100, 16, v66
    v_and_b32 v101, 0xffff0000, v66
    v_lshlrev_b32 v102, 16, v67
    v_and_b32 v103, 0xffff0000, v67
    v_lshlrev_b32 v104, 16, v68
    v_and_b32 v105, 0xffff0000, v68
    v_lshlrev_b32 v106, 16, v69
    v_and_b32 v107, 0xffff0000, v69
    v_lshlrev_b32 v108, 16, v70
    v_and_b32 v109, 0xffff0000, v70
    v_lshlrev_b32 v110, 16, v71
    v_and_b32 v111, 0xffff0000, v71
    v_lshlrev_b32 v112, 16, v72
    v_and_b32 v113, 0xffff0000, v72
    v_lshlrev_b32 v114, 16, v73
    v_and_b32 v115, 0xffff0000, v73
    v_lshlrev_b32 v116, 16, v74
    v_and_b32 v117, 0xffff0000, v74
    v_lshlrev_b32 v118, 16, v75
    v_and_b32 v119, 0xffff0000, v75
    v_pk_add_f32 v[120:121], v[96:97], v[98:99]
    v_pk_add_f32 v[122:123], v[100:101], v[102:103]
    v_pk_add_f32 v[120:121], v[120:121], v[104:105]
    v_pk_add_f32 v[122:123], v[122:123], v[106:107]
    v_pk_add_f32 v[120:121], v[120:121], v[108:109]
    v_pk_add_f32 v[122:123], v[122:123], v[110:111]
    s_mov_b32 exec_hi, 0
    v_pk_add_f32 v[120:121], v[120:121], v[112:113]
    v_pk_add_f32 v[122:123], v[122:123], v[114:115]
    v_pk_add_f32 v[120:121], v[120:121], v[116:117]
    v_pk_add_f32 v[122:123], v[122:123], v[118:119]
    s_mov_b64 exec, -1
    v_pk_add_f32 v[120:121], v[120:121], v[122:123]
    v_add_f32 v120, v120, v121
    s_nop 1
    v_add_f32_dpp v120, v120, v120 quad_perm:[1,0,3,2] row_mask:0xf bank_mask:0xf
    s_nop 1
    v_add_f32_dpp v120, v120, v120 quad_perm:[2,3,0,1] row_mask:0xf bank_mask:0xf
    s_nop 1
    v_add_f32_dpp v120, v120, v120 row_ror:8 row_mask:0xf bank_mask:0xf
    v_mov_b32 v124, v120
    s_nop 1
    v_permlane16_swap_b32 v120, v124
    s_nop 1
    v_add_f32 v120, v120, v124
    v_mov_b32 v124, v120
    s_nop 1
    v_permlane32_swap_b32 v120, v124
    s_nop 1
    v_add_f32 v120, v120, v124
    v_mul_f32 v126, s38, v120
    v_mul_f32 v128, s38, -v120
    v_mul_f32 v129, s38, -v120
    v_pk_add_f32 v[132:133], v[96:97], v[128:129]
    v_pk_mul_f32 v[120:121], v[132:133], v[132:133]
    v_pk_add_f32 v[134:135], v[98:99], v[128:129]
    v_pk_mul_f32 v[122:123], v[134:135], v[134:135]
    v_pk_add_f32 v[136:137], v[100:101], v[128:129]
    v_pk_fma_f32 v[120:121], v[136:137], v[136:137], v[120:121]
    v_pk_add_f32 v[138:139], v[102:103], v[128:129]
    v_pk_fma_f32 v[122:123], v[138:139], v[138:139], v[122:123]
    v_pk_add_f32 v[132:133], v[104:105], v[128:129]
    v_pk_fma_f32 v[120:121], v[132:133], v[132:133], v[120:121]
    v_pk_add_f32 v[134:135], v[106:107], v[128:129]
    v_pk_fma_f32 v[122:123], v[134:135], v[134:135], v[122:123]
    v_pk_add_f32 v[136:137], v[108:109], v[128:129]
    v_pk_fma_f32 v[120:121], v[136:137], v[136:137], v[120:121]
    v_pk_add_f32 v[138:139], v[110:111], v[128:129]
    v_pk_fma_f32 v[122:123], v[138:139], v[138:139], v[122:123]
    s_mov_b32 exec_hi, 0
    v_pk_add_f32 v[132:133], v[112:113], v[128:129]
    v_pk_fma_f32 v[120:121], v[132:133], v[132:133], v[120:121]
    v_pk_add_f32 v[134:135], v[114:115], v[128:129]
    v_pk_fma_f32 v[122:123], v[134:135], v[134:135], v[122:123]
    v_pk_add_f32 v[136:137], v[116:117], v[128:129]
    v_pk_fma_f32 v[120:121], v[136:137], v[136:137], v[120:121]
    v_pk_add_f32 v[138:139], v[118:119], v[128:129]
    v_pk_fma_f32 v[122:123], v[138:139], v[138:139], v[122:123]
    s_mov_b64 exec, -1
    v_pk_add_f32 v[120:121], v[120:121], v[122:123]
    v_add_f32 v120, v120, v121
    s_nop 1
    v_add_f32_dpp v120, v120, v120 quad_perm:[1,0,3,2] row_mask:0xf bank_mask:0xf
    s_nop 1
    v_add_f32_dpp v120, v120, v120 quad_perm:[2,3,0,1] row_mask:0xf bank_mask:0xf
    s_nop 1
    v_add_f32_dpp v120, v120, v120 row_ror:8 row_mask:0xf bank_mask:0xf
    v_mov_b32 v124, v120
    s_nop 1
    v_permlane16_swap_b32 v120, v124
    s_nop 1
    v_add_f32 v120, v120, v124
    v_mov_b32 v124, v120
    s_nop 1
    v_permlane32_swap_b32 v120, v124
    s_nop 1
    v_add_f32 v120, v120, v124
    v_mul_f32 v130, s38, v120
    v_cvt_pk_bf16_f32 v126, v126, v126
    v_and_b32 v126, 0xffff0000, v126
    v_cvt_pk_bf16_f32 v130, v130, v130
    v_and_b32 v130, 0xffff0000, v130
    v_add_f32 v130, s39, v130
    v_cvt_pk_bf16_f32 v130, v130, v130
    v_and_b32 v130, 0xffff0000, v130
    v_sqrt_f32 v130, v130
    v_sub_f32 v128, 0, v126
    v_cvt_pk_bf16_f32 v130, v130, v130
    v_and_b32 v130, 0xffff0000, v130
    v_rcp_f32 v127, v130
    v_sub_f32 v129, 0, v126
    v_mul_f32 v120, 0x3dd53b95, v127
    v_mul_f32 v121, 0x3dd53b95, v127
    v_mov_b32 v130, v127
    v_mov_b32 v131, v127
    v_pk_add_f32 v[96:97], v[96:97], v[128:129]
    v_pk_mul_f32 v[132:133], v[96:97], v[120:121]
    v_cvt_pk_bf16_f32 v144, v132, v133
    v_pk_add_f32 v[98:99], v[98:99], v[128:129]
    v_pk_mul_f32 v[134:135], v[98:99], v[120:121]
    v_cvt_pk_bf16_f32 v145, v134, v135
    v_pk_add_f32 v[100:101], v[100:101], v[128:129]
    v_pk_mul_f32 v[136:137], v[100:101], v[120:121]
    v_cvt_pk_bf16_f32 v146, v136, v137
    v_pk_add_f32 v[102:103], v[102:103], v[128:129]
    v_pk_mul_f32 v[138:139], v[102:103], v[120:121]
    v_cvt_pk_bf16_f32 v147, v138, v139
    buffer_store_dwordx4 v[144:147], v243, s[24:27], s41 offen sc1
    v_pk_add_f32 v[104:105], v[104:105], v[128:129]
    v_pk_mul_f32 v[132:133], v[104:105], v[120:121]
    v_cvt_pk_bf16_f32 v148, v132, v133
    v_pk_add_f32 v[106:107], v[106:107], v[128:129]
    v_pk_mul_f32 v[134:135], v[106:107], v[120:121]
    v_cvt_pk_bf16_f32 v149, v134, v135
    v_pk_add_f32 v[108:109], v[108:109], v[128:129]
    v_pk_mul_f32 v[136:137], v[108:109], v[120:121]
    v_cvt_pk_bf16_f32 v150, v136, v137
    v_pk_add_f32 v[110:111], v[110:111], v[128:129]
    v_pk_mul_f32 v[138:139], v[110:111], v[120:121]
    v_cvt_pk_bf16_f32 v151, v138, v139
    buffer_store_dwordx4 v[148:151], v243, s[24:27], s42 offen sc1
    v_pk_add_f32 v[112:113], v[112:113], v[128:129]
    v_pk_mul_f32 v[132:133], v[112:113], v[120:121]
    v_cvt_pk_bf16_f32 v152, v132, v133
    v_pk_add_f32 v[114:115], v[114:115], v[128:129]
    v_pk_mul_f32 v[134:135], v[114:115], v[120:121]
    v_cvt_pk_bf16_f32 v153, v134, v135
    v_pk_add_f32 v[116:117], v[116:117], v[128:129]
    v_pk_mul_f32 v[136:137], v[116:117], v[120:121]
    v_cvt_pk_bf16_f32 v154, v136, v137
    v_pk_add_f32 v[118:119], v[118:119], v[128:129]
    v_pk_mul_f32 v[138:139], v[118:119], v[120:121]
    v_cvt_pk_bf16_f32 v155, v138, v139
    s_mov_b32 exec_hi, 0
    buffer_store_dwordx4 v[152:155], v243, s[24:27], s43 offen sc1
    s_mov_b64 exec, -1
    s_waitcnt vmcnt(12)
    v_readfirstlane_b32 s7, v26
    s_lshr_b32 s7, s7, 4
    s_mul_i32 s7, s7, 0x2c9277b5
    s_add_u32 s7, s7, 0x6c564b05
    s_lshl_b32 s7, s7, 4
    s_add_u32 m0, s49, 73728
    s_nop 0
    buffer_load_dwordx4 v2, s[8:11], s36 offen offset:0 lds
    s_add_u32 m0, s49, 74624
    s_nop 0
    buffer_load_dwordx4 v2, s[8:11], s36 offen offset:128 lds
    s_add_u32 m0, s49, 75520
    s_nop 0
    buffer_load_dwordx4 v2, s[8:11], s36 offen offset:256 lds
    s_add_u32 m0, s49, 76800
    s_nop 0
    buffer_load_dwordx4 v3, s[8:11], s36 offen offset:0 lds
    s_add_u32 m0, s49, 77696
    s_nop 0
    buffer_load_dwordx4 v3, s[8:11], s36 offen offset:128 lds
    s_add_u32 m0, s49, 78592
    s_nop 0
    buffer_load_dwordx4 v3, s[8:11], s36 offen offset:256 lds
    s_add_u32 s36, s36, s37
    s_sub_u32 s55, s36, 7864320
    s_min_u32 s36, s36, s55
    s_add_u32 m0, s49, 98304
    s_nop 0
    buffer_load_dwordx4 v2, s[8:11], s36 offen offset:0 lds
    s_add_u32 m0, s49, 99200
    s_nop 0
    buffer_load_dwordx4 v2, s[8:11], s36 offen offset:128 lds
    s_add_u32 m0, s49, 100096
    s_nop 0
    buffer_load_dwordx4 v2, s[8:11], s36 offen offset:256 lds
    s_add_u32 m0, s49, 101376
    s_nop 0
    buffer_load_dwordx4 v3, s[8:11], s36 offen offset:0 lds
    s_add_u32 m0, s49, 102272
    s_nop 0
    buffer_load_dwordx4 v3, s[8:11], s36 offen offset:128 lds
    s_add_u32 m0, s49, 103168
    s_nop 0
    buffer_load_dwordx4 v3, s[8:11], s36 offen offset:256 lds
    s_add_u32 s36, s36, s37
    s_sub_u32 s55, s36, 7864320
    s_min_u32 s36, s36, s55
    s_mov_b64 exec, 0
    s_cmp_eq_u32 s3, 0
    s_cbranch_scc1 pg_0
    s_cmp_eq_u32 s3, 1
    s_cbranch_scc1 pg_1
    s_cmp_eq_u32 s3, 2
    s_cbranch_scc1 pg_2
    s_branch pg_3
pg_back:
    s_mov_b64 exec, -1
    s_waitcnt vmcnt(12) lgkmcnt(0)
    s_barrier
    v_mov_b32 v21, s7
    s_mov_b64 exec, 0xff
    buffer_store_dword v21, v20, s[24:27], s6 offen sc1
    s_mov_b64 exec, 0x11
    v_lshlrev_b32 v29, 3, v240
    s_mov_b32 s56, 3211264
    buffer_store_dwordx2 v[126:127], v29, s[24:27], s56 offen sc1
    s_mov_b64 exec, -1
    s_waitcnt vmcnt(17)
    v_cvt_pk_bf16_f32 v64, v96, v97
    v_lshlrev_b32 v96, 16, v64
    v_and_b32 v97, 0xffff0000, v64
    v_pk_mul_f32 v[96:97], v[96:97], v[130:131]
    v_cvt_pk_bf16_f32 v64, v96, v97
    v_lshlrev_b32 v96, 16, v64
    v_and_b32 v97, 0xffff0000, v64
    v_lshlrev_b32 v132, 16, v76
    v_and_b32 v133, 0xffff0000, v76
    v_pk_mul_f32 v[120:121], v[96:97], v[132:133]
    v_cvt_pk_bf16_f32 v65, v98, v99
    v_lshlrev_b32 v98, 16, v65
    v_and_b32 v99, 0xffff0000, v65
    v_pk_mul_f32 v[98:99], v[98:99], v[130:131]
    v_cvt_pk_bf16_f32 v65, v98, v99
    v_lshlrev_b32 v98, 16, v65
    v_and_b32 v99, 0xffff0000, v65
    v_lshlrev_b32 v134, 16, v77
    v_and_b32 v135, 0xffff0000, v77
    v_pk_mul_f32 v[122:123], v[98:99], v[134:135]
    v_cvt_pk_bf16_f32 v66, v100, v101
    v_lshlrev_b32 v100, 16, v66
    v_and_b32 v101, 0xffff0000, v66
    v_pk_mul_f32 v[100:101], v[100:101], v[130:131]
    v_cvt_pk_bf16_f32 v66, v100, v101
    v_lshlrev_b32 v100, 16, v66
    v_and_b32 v101, 0xffff0000, v66
    v_lshlrev_b32 v136, 16, v78
    v_and_b32 v137, 0xffff0000, v78
    v_pk_fma_f32 v[120:121], v[100:101], v[136:137], v[120:121]
    v_cvt_pk_bf16_f32 v67, v102, v103
    v_lshlrev_b32 v102, 16, v67
    v_and_b32 v103, 0xffff0000, v67
    v_pk_mul_f32 v[102:103], v[102:103], v[130:131]
    v_cvt_pk_bf16_f32 v67, v102, v103
    v_lshlrev_b32 v102, 16, v67
    v_and_b32 v103, 0xffff0000, v67
    v_lshlrev_b32 v138, 16, v79
    v_and_b32 v139, 0xffff0000, v79
    v_pk_fma_f32 v[122:123], v[102:103], v[138:139], v[122:123]
    s_add_u32 m0, s49, 122880
    s_nop 0
    buffer_load_dwordx4 v2, s[8:11], s36 offen offset:0 lds
    s_add_u32 m0, s49, 123776
    s_nop 0
    buffer_load_dwordx4 v2, s[8:11], s36 offen offset:128 lds
    s_add_u32 m0, s49, 124672
    s_nop 0
    buffer_load_dwordx4 v2, s[8:11], s36 offen offset:256 lds
    s_add_u32 m0, s49, 125952
    s_nop 0
    buffer_load_dwordx4 v3, s[8:11], s36 offen offset:0 lds
    s_add_u32 m0, s49, 126848
    s_nop 0
    buffer_load_dwordx4 v3, s[8:11], s36 offen offset:128 lds
    s_add_u32 m0, s49, 127744
    s_nop 0
    buffer_load_dwordx4 v3, s[8:11], s36 offen offset:256 lds
    s_add_u32 s36, s36, s37
    s_sub_u32 s55, s36, 7864320
    s_min_u32 s36, s36, s55
    v_cvt_pk_bf16_f32 v68, v104, v105
    v_lshlrev_b32 v104, 16, v68
    v_and_b32 v105, 0xffff0000, v68
    v_pk_mul_f32 v[104:105], v[104:105], v[130:131]
    v_cvt_pk_bf16_f32 v68, v104, v105
    v_lshlrev_b32 v104, 16, v68
    v_and_b32 v105, 0xffff0000, v68
    v_lshlrev_b32 v132, 16, v80
    v_and_b32 v133, 0xffff0000, v80
    v_pk_fma_f32 v[120:121], v[104:105], v[132:133], v[120:121]
spin_ln:
    s_load_dwordx8 s[28:35], s[86:87], s46 glc
    s_add_u32 s101, s101, 1
    s_cmp_gt_u32 s101, 0x2000000
    s_cselect_b32 s57, 0, -1
    s_waitcnt lgkmcnt(0)
    s_xor_b32 s56, s28, s7
    s_xor_b32 s29, s29, s7
    s_or_b32 s56, s56, s29
    s_xor_b32 s30, s30, s7
    s_or_b32 s56, s56, s30
    s_xor_b32 s31, s31, s7
    s_or_b32 s56, s56, s31
    s_xor_b32 s32, s32, s7
    s_or_b32 s56, s56, s32
    s_xor_b32 s33, s33, s7
    s_or_b32 s56, s56, s33
    s_xor_b32 s34, s34, s7
    s_or_b32 s56, s56, s34
    s_xor_b32 s35, s35, s7
    s_or_b32 s56, s56, s35
    s_and_b32 s56, s56, s57
    s_cbranch_scc1 spin_ln
    s_add_u32 s46, s45, 0
    s_sub_u32 s77, s46, 81920
    s_min_u32 s46, s46, s77
    s_xor_b32 s77, s46, 1024
    buffer_load_dwordx4 a[160:163], v14, s[20:23], s46 offen sc1
    buffer_load_dwordx4 a[164:167], v14, s[20:23], s77 offen sc1
    buffer_load_dwordx4 a[168:171], v15, s[20:23], s46 offen sc1
    buffer_load_dwordx4 a[172:175], v15, s[20:23], s77 offen sc1
    s_add_u32 s46, s45, 4096
    s_sub_u32 s77, s46, 81920
    s_min_u32 s46, s46, s77
    s_xor_b32 s77, s46, 1024
    buffer_load_dwordx4 a[176:179], v14, s[20:23], s46 offen sc1
    buffer_load_dwordx4 a[180:183], v14, s[20:23], s77 offen sc1
    buffer_load_dwordx4 a[184:187], v15, s[20:23], s46 offen sc1
    buffer_load_dwordx4 a[188:191], v15, s[20:23], s77 offen sc1
    v_cvt_pk_bf16_f32 v69, v106, v107
    v_lshlrev_b32 v106, 16, v69
    v_and_b32 v107, 0xffff0000, v69
    v_pk_mul_f32 v[106:107], v[106:107], v[130:131]
    v_cvt_pk_bf16_f32 v69, v106, v107
    v_lshlrev_b32 v106, 16, v69
    v_and_b32 v107, 0xffff0000, v69
    v_lshlrev_b32 v134, 16, v81
    v_and_b32 v135, 0xffff0000, v81
    v_pk_fma_f32 v[122:123], v[106:107], v[134:135], v[122:123]
    s_branch page0
    .p2align 12
    .fill 32, 4, 0xbf810000
page0:
pg_0:
    s_cbranch_execz pg_4
    v_cvt_pk_bf16_f32 v70, v108, v109
    v_lshlrev_b32 v108, 16, v70
    v_and_b32 v109, 0xffff0000, v70
    v_pk_mul_f32 v[108:109], v[108:109], v[130:131]
    v_cvt_pk_bf16_f32 v70, v108, v109
    v_lshlrev_b32 v108, 16, v70
    v_and_b32 v109, 0xffff0000, v70
    v_lshlrev_b32 v136, 16, v82
    v_and_b32 v137, 0xffff0000, v82
    v_pk_fma_f32 v[120:121], v[108:109], v[136:137], v[120:121]
    v_cvt_pk_bf16_f32 v71, v110, v111
    v_lshlrev_b32 v110, 16, v71
    v_and_b32 v111, 0xffff0000, v71
    v_pk_mul_f32 v[110:111], v[110:111], v[130:131]
    v_cvt_pk_bf16_f32 v71, v110, v111
    v_lshlrev_b32 v110, 16, v71
    v_and_b32 v111, 0xffff0000, v71
    v_lshlrev_b32 v138, 16, v83
    v_and_b32 v139, 0xffff0000, v83
    v_pk_fma_f32 v[122:123], v[110:111], v[138:139], v[122:123]
    s_mov_b32 exec_hi, 0
    v_cvt_pk_bf16_f32 v72, v112, v113
    v_lshlrev_b32 v112, 16, v72
    v_and_b32 v113, 0xffff0000, v72
    v_pk_mul_f32 v[112:113], v[112:113], v[130:131]
    v_cvt_pk_bf16_f32 v72, v112, v113
    v_lshlrev_b32 v112, 16, v72
    v_and_b32 v113, 0xffff0000, v72
    v_lshlrev_b32 v132, 16, v84
    v_and_b32 v133, 0xffff0000, v84
    v_pk_fma_f32 v[120:121], v[112:113], v[132:133], v[120:121]
    v_cvt_pk_bf16_f32 v73, v114, v115
    v_lshlrev_b32 v114, 16, v73
    v_and_b32 v115, 0xffff0000, v73
    v_pk_mul_f32 v[114:115], v[114:115], v[130:131]
    v_cvt_pk_bf16_f32 v73, v114, v115
    v_lshlrev_b32 v114, 16, v73
    v_and_b32 v115, 0xffff0000, v73
    v_lshlrev_b32 v134, 16, v85
    v_and_b32 v135, 0xffff0000, v85
    v_pk_fma_f32 v[122:123], v[114:115], v[134:135], v[122:123]
    v_cvt_pk_bf16_f32 v74, v116, v117
    v_lshlrev_b32 v116, 16, v74
    v_and_b32 v117, 0xffff0000, v74
    v_pk_mul_f32 v[116:117], v[116:117], v[130:131]
    v_cvt_pk_bf16_f32 v74, v116, v117
    v_lshlrev_b32 v116, 16, v74
    v_and_b32 v117, 0xffff0000, v74
    v_lshlrev_b32 v136, 16, v86
    v_and_b32 v137, 0xffff0000, v86
    v_pk_fma_f32 v[120:121], v[116:117], v[136:137], v[120:121]
    v_cvt_pk_bf16_f32 v75, v118, v119
    v_lshlrev_b32 v118, 16, v75
    v_and_b32 v119, 0xffff0000, v75
    v_pk_mul_f32 v[118:119], v[118:119], v[130:131]
    v_cvt_pk_bf16_f32 v75, v118, v119
    v_lshlrev_b32 v118, 16, v75
    v_and_b32 v119, 0xffff0000, v75
    v_lshlrev_b32 v138, 16, v87
    v_and_b32 v139, 0xffff0000, v87
    v_pk_fma_f32 v[122:123], v[118:119], v[138:139], v[122:123]
    s_mov_b64 exec, -1
    v_pk_add_f32 v[120:121], v[120:121], v[122:123]
    v_add_f32 v120, v120, v121
    s_nop 1
    v_add_f32_dpp v120, v120, v120 quad_perm:[1,0,3,2] row_mask:0xf bank_mask:0xf
    s_nop 1
    v_add_f32_dpp v120, v120, v120 quad_perm:[2,3,0,1] row_mask:0xf bank_mask:0xf
    s_nop 1
    v_add_f32_dpp v120, v120, v120 row_ror:8 row_mask:0xf bank_mask:0xf
    v_mov_b32 v124, v120
    s_nop 1
    v_permlane16_swap_b32 v120, v124
    s_nop 1
    v_add_f32 v120, v120, v124
    v_mov_b32 v124, v120
    s_nop 1
    v_permlane32_swap_b32 v120, v124
    s_nop 1
    v_add_f32 v120, v120, v124
    v_cvt_pk_bf16_f32 v120, v120, v120
    v_and_b32 v120, 0xffff0000, v120
    v_ashrrev_i32 v122, 31, v120
    v_or_b32 v122, 0x80000000, v122
    v_xor_b32 v120, v120, v122
    v_and_b32 v120, 0xffff0000, v120
    v_sub_u32 v122, 2047, v240
    v_or_b32 v32, v120, v122
    v_mov_b32 v34, s7
    v_mov_b32 v35, s7
    v_mov_b32_dpp v33, v32 row_ror:4 row_mask:0xf bank_mask:0xf
head_code:
    s_waitcnt vmcnt(34)
    s_barrier
    ds_read_b64_tr_b16 a[224:225], v8 offset:0
    ds_read_b64_tr_b16 a[226:227], v8 offset:6144
    ds_read_b64_tr_b16 a[228:229], v9 offset:0
    ds_read_b64_tr_b16 a[230:231], v9 offset:6144
    ds_read_b64_tr_b16 a[232:233], v10 offset:0
    ds_read_b64_tr_b16 a[234:235], v10 offset:6144
    ds_read_b64_tr_b16 a[236:237], v11 offset:0
    ds_read_b64_tr_b16 a[238:239], v11 offset:6144
    ds_read_b64_tr_b16 a[240:241], v8 offset:1024
    ds_read_b64_tr_b16 a[242:243], v8 offset:7168
    ds_read_b64_tr_b16 a[244:245], v9 offset:1024
    ds_read_b64_tr_b16 a[246:247], v9 offset:7168
    s_waitcnt vmcnt(7) lgkmcnt(10)
    v_mfma_f32_16x16x32_bf16 v[64:67], a[224:227], a[160:163], 0
    s_waitcnt vmcnt(6) lgkmcnt(8)
    v_min_u32 v36, 1, v1
    v_lshlrev_b32 v36, 30, v36
    v_mfma_f32_16x16x32_bf16 v[68:71], a[228:231], a[160:163], 0
    s_waitcnt vmcnt(5)
    v_and_b32 v37, 31, v1
    v_lshlrev_b32 v37, 2, v37
    v_mfma_f32_16x16x32_bf16 v[76:79], a[228:231], a[164:167], 0
    s_add_u32 s46, s45, 8192
    v_mov_b32 v38, 0
    s_sub_u32 s77, s46, 81920
    v_mfma_f32_16x16x32_bf16 v[72:75], a[224:227], a[164:167], 0
    s_waitcnt vmcnt(4)
    s_min_u32 s46, s46, s77
    s_xor_b32 s77, s46, 1024
    v_mfma_f32_16x16x32_bf16 v[80:83], a[224:227], a[168:171], 0
    buffer_load_dwordx4 a[96:99], v14, s[20:23], s46 offen sc1
    v_mfma_f32_16x16x32_bf16 v[84:87], a[228:231], a[168:171], 0
    s_lshl2_add_u32 s6, s2, s3
    s_lshl_b32 s6, s6, 4
    s_add_u32 s6, s6, 3162112
    v_mfma_f32_16x16x32_bf16 v[92:95], a[228:231], a[172:175], 0
    s_waitcnt lgkmcnt(0)
    ds_read_b64_tr_b16 a[228:229], v11 offset:1024
    s_lshl2_add_u32 s93, s2, s3
    v_mfma_f32_16x16x32_bf16 v[88:91], a[224:227], a[172:175], 0
    s_lshl_b32 s93, s93, 7
    ds_read_b64_tr_b16 a[230:231], v11 offset:7168
    s_add_u32 s93, s93, 4194304
    v_mfma_f32_16x16x32_bf16 v[120:123], a[232:235], a[172:175], 0
    buffer_store_dword v38, v37, s[24:27], s93 offen sc1
    v_mfma_f32_16x16x32_bf16 v[124:127], a[236:239], a[172:175], 0
    buffer_load_dwordx4 a[100:103], v14, s[20:23], s77 offen sc1
    v_mfma_f32_16x16x32_bf16 v[116:119], a[236:239], a[168:171], 0
    s_mul_i32 s56, s50, 786432
    ds_read_b64_tr_b16 a[224:225], v10 offset:1024
    v_mul_u32_u24 v56, 3072, v5
    v_mfma_f32_16x16x32_bf16 v[112:115], a[232:235], a[168:171], 0
    s_add_u32 s56, s56, 589824
    ds_read_b64_tr_b16 a[226:227], v10 offset:7168
    v_add_u32 v56, v56, v7
    v_mfma_f32_16x16x32_bf16 v[104:107], a[232:235], a[164:167], 0
    s_add_u32 s12, s66, s56
    s_addc_u32 s13, s67, 0
    v_add_u32 v57, 49152, v56
    v_mfma_f32_16x16x32_bf16 v[108:111], a[236:239], a[164:167], 0
    s_and_b32 s13, s13, 0xffff
    v_lshrrev_b32 v29, 3, v1
    v_mul_u32_u24 v31, 384, v29
    v_mfma_f32_16x16x32_bf16 v[100:103], a[236:239], a[160:163], 0
    s_mov_b32 s14, 196608
    ds_read_b64_tr_b16 a[236:237], v9 offset:2048
    v_add_u32 v6, v31, v7
    v_mfma_f32_16x16x32_bf16 v[96:99], a[232:235], a[160:163], 0
    buffer_load_dwordx4 a[104:107], v15, s[20:23], s46 offen sc1
    v_mfma_f32_16x16x32_bf16 v[128:131], a[240:243], a[160:163], 0
    s_mov_b32 s15, 0x00020000
    ds_read_b64_tr_b16 a[238:239], v9 offset:8192
    v_bfe_u32 v29, v1, 4, 1
    v_mfma_f32_16x16x32_bf16 v[132:135], a[244:247], a[160:163], 0
    s_add_u32 s16, s68, s56
    s_addc_u32 s17, s69, 0
    v_bfe_u32 v30, v1, 5, 1
    v_mfma_f32_16x16x32_bf16 v[140:143], a[244:247], a[164:167], 0
    s_and_b32 s17, s17, 0xffff
    ds_read_b64_tr_b16 a[232:233], v8 offset:2048
    v_lshl_add_u32 v29, v29, 1, v30
    v_mfma_f32_16x16x32_bf16 v[136:139], a[240:243], a[164:167], 0
    s_mov_b32 s18, 196608
    ds_read_b64_tr_b16 a[234:235], v8 offset:8192
    v_and_b32 v30, 7, v1
    v_mfma_f32_16x16x32_bf16 v[144:147], a[240:243], a[168:171], 0
    s_mov_b32 s19, 0x00020000
    v_xor_b32 v30, v30, v29
    v_lshl_add_u32 v4, v30, 4, v31
    v_mfma_f32_16x16x32_bf16 v[148:151], a[244:247], a[168:171], 0
    buffer_load_dwordx4 a[108:111], v15, s[20:23], s77 offen sc1
    v_mfma_f32_16x16x32_bf16 v[156:159], a[244:247], a[172:175], 0
    s_waitcnt lgkmcnt(3)
    ds_read_b64_tr_b16 a[244:245], v11 offset:2048
    v_xor_b32 v30, 4, v30
    v_mfma_f32_16x16x32_bf16 v[152:155], a[240:243], a[172:175], 0
    s_add_u32 s46, s45, 12288
    ds_read_b64_tr_b16 a[246:247], v11 offset:8192
    v_lshl_add_u32 v5, v30, 4, v31
    v_mfma_f32_16x16x32_bf16 v[184:187], a[224:227], a[172:175], 0
    s_sub_u32 s77, s46, 81920
    ds_read_b64_tr_b16 a[240:241], v10 offset:2048
    v_add_u32 v5, 3072, v5
    v_mfma_f32_16x16x32_bf16 v[188:191], a[228:231], a[172:175], 0
    s_min_u32 s46, s46, s77
    ds_read_b64_tr_b16 a[242:243], v10 offset:8192
    v_bfe_u32 v30, v1, 1, 1
    v_mfma_f32_16x16x32_bf16 v[180:183], a[228:231], a[168:171], 0
    s_xor_b32 s77, s46, 1024
    v_bfe_u32 v31, v1, 2, 1
    v_lshl_add_u32 v30, v30, 1, v31
    v_mfma_f32_16x16x32_bf16 v[176:179], a[224:227], a[168:171], 0
    s_mov_b32 s28, s78
    v_bfe_u32 v31, v1, 3, 1
    v_lshl_add_u32 v30, v31, 2, v30
    v_mfma_f32_16x16x32_bf16 v[168:171], a[224:227], a[164:167], 0
    buffer_load_dwordx4 a[112:115], v14, s[20:23], s46 offen sc1
    v_mfma_f32_16x16x32_bf16 v[172:175], a[228:231], a[164:167], 0
    s_waitcnt lgkmcnt(3)
    v_xor_b32 v30, v30, v29
    v_lshlrev_b32 v30, 4, v30
    v_mfma_f32_16x16x32_bf16 v[164:167], a[228:231], a[160:163], 0
    s_and_b32 s29, s79, 0xffff
    ds_read_b64_tr_b16 a[228:229], v9 offset:12288
    v_mul_u32_u24 v31, 3072, v31
    v_mfma_f32_16x16x32_bf16 v[160:163], a[224:227], a[160:163], 0
    s_mov_b32 s30, 1966080
    ds_read_b64_tr_b16 a[230:231], v9 offset:18432
    v_and_b32 v29, 7, v1
    v_mfma_f32_16x16x32_bf16 v[192:195], a[232:235], a[160:163], 0
    s_mov_b32 s31, 0x00020000
    ds_read_b64_tr_b16 a[224:225], v8 offset:12288
    v_lshl_add_u32 v31, v29, 7, v31
    v_mfma_f32_16x16x32_bf16 v[196:199], a[236:239], a[160:163], 0
    s_mov_b32 s32, s80
    ds_read_b64_tr_b16 a[226:227], v8 offset:18432
    v_add_u32 v12, v31, v30
    v_mfma_f32_16x16x32_bf16 v[204:207], a[236:239], a[164:167], 0
    buffer_load_dwordx4 a[116:119], v14, s[20:23], s77 offen sc1
    v_mfma_f32_16x16x32_bf16 v[200:203], a[232:235], a[164:167], 0
    s_and_b32 s33, s81, 0xffff
    v_xor_b32 v30, 64, v30
    v_add_u32 v13, v31, v30
    v_mfma_f32_16x16x32_bf16 v[208:211], a[232:235], a[168:171], 0
    s_mov_b32 s34, 1966080
    v_lshrrev_b32 v19, 5, v1
    v_lshlrev_b32 v19, 11, v19
    v_mfma_f32_16x16x32_bf16 v[212:215], a[236:239], a[168:171], 0
    s_waitcnt lgkmcnt(3)
    v_sub_u32 v19, 0xffffa000, v19
    s_mov_b32 s35, 0x00020000
    v_mfma_f32_16x16x32_bf16 v[220:223], a[236:239], a[172:175], 0
    s_min_u32 s58, s2, 239
    ds_read_b64_tr_b16 a[236:237], v11 offset:12288
    s_mul_hi_u32 s56, s58, 178956971
    v_mfma_f32_16x16x32_bf16 v[216:219], a[232:235], a[172:175], 0
    s_mul_i32 s57, s56, 24
    ds_read_b64_tr_b16 a[238:239], v11 offset:18432
    s_sub_u32 s57, s58, s57
    v_mfma_f32_16x16x32_bf16 v[248:251], a[240:243], a[172:175], 0
    s_lshl_b32 s60, s56, 6
    ds_read_b64_tr_b16 a[232:233], v10 offset:12288
    s_add_u32 s60, s60, s59
    v_mfma_f32_16x16x32_bf16 v[252:255], a[244:247], a[172:175], 0
    buffer_load_dwordx4 a[120:123], v15, s[20:23], s46 offen sc1
    v_mfma_f32_16x16x32_bf16 v[244:247], a[244:247], a[168:171], 0
    s_mul_i32 s60, s60, 3072
    ds_read_b64_tr_b16 a[234:235], v10 offset:18432
    s_lshl_b32 s44, s57, 7
    v_mfma_f32_16x16x32_bf16 v[240:243], a[240:243], a[168:171], 0
    s_add_u32 s60, s60, s44
    s_lshl_b32 s61, s56, 7
    s_mul_i32 s62, s56, 1536
    v_mfma_f32_16x16x32_bf16 v[232:235], a[240:243], a[164:167], 0
    s_lshl_b32 s44, s57, 6
    s_add_u32 s62, s62, s44
    s_lshl_b32 s44, s3, 4
    v_mfma_f32_16x16x32_bf16 v[236:239], a[244:247], a[164:167], 0
    s_waitcnt vmcnt(11) lgkmcnt(3)
    s_add_u32 s62, s62, s44
    s_lshl_b32 s62, s62, 4
    v_mfma_f32_16x16x32_bf16 v[228:231], a[244:247], a[160:163], 0
    s_add_u32 s62, s62, 3276800
    ds_read_b64_tr_b16 a[244:245], v9 offset:13312
    s_lshl_b32 s4, s2, 8
    v_mfma_f32_16x16x32_bf16 v[224:227], a[240:243], a[160:163], 0
    buffer_load_dwordx4 a[124:127], v15, s[20:23], s77 offen sc1
    v_mfma_f32_16x16x32_bf16 v[64:67], a[224:227], a[176:179], v[64:67]
    s_waitcnt vmcnt(11)
    ds_read_b64_tr_b16 a[246:247], v9 offset:19456
    s_add_u32 s46, s45, 16384
    v_mfma_f32_16x16x32_bf16 v[68:71], a[228:231], a[176:179], v[68:71]
    s_waitcnt vmcnt(10)
    ds_read_b64_tr_b16 a[240:241], v8 offset:13312
    s_sub_u32 s77, s46, 81920
    v_mfma_f32_16x16x32_bf16 v[76:79], a[228:231], a[180:183], v[76:79]
    s_min_u32 s46, s46, s77
    ds_read_b64_tr_b16 a[242:243], v8 offset:19456
    s_xor_b32 s77, s46, 1024
    v_mfma_f32_16x16x32_bf16 v[72:75], a[224:227], a[180:183], v[72:75]
    s_waitcnt vmcnt(9)
    s_lshl_b32 s44, s3, 2
    s_add_u32 s4, s4, s44
    v_mfma_f32_16x16x32_bf16 v[80:83], a[224:227], a[184:187], v[80:83]
    s_add_u32 s4, s4, 3932160
    s_lshl_b32 s5, s52, 3
    s_add_u32 s5, s5, s53
    v_mfma_f32_16x16x32_bf16 v[84:87], a[228:231], a[184:187], v[84:87]
    s_waitcnt lgkmcnt(3)
    s_lshl_b32 s5, s5, 2
    s_add_u32 s5, s5, s3
    v_mfma_f32_16x16x32_bf16 v[92:95], a[228:231], a[188:191], v[92:95]
    buffer_load_dwordx4 a[128:131], v14, s[20:23], s46 offen sc1
    v_mfma_f32_16x16x32_bf16 v[88:91], a[224:227], a[188:191], v[88:91]
    s_lshl_b32 s5, s5, 7
    ds_read_b64_tr_b16 a[228:229], v11 offset:13312
    s_add_u32 s5, s5, 4096000
    v_mfma_f32_16x16x32_bf16 v[120:123], a[232:235], a[188:191], v[120:123]
    s_lshl_b32 s76, s51, 2
    ds_read_b64_tr_b16 a[230:231], v11 offset:19456
    s_add_u32 s76, s76, s5
    v_mfma_f32_16x16x32_bf16 v[124:127], a[236:239], a[188:191], v[124:127]
    s_mov_b32 s92, 0xbfb8aa3b
    ds_read_b64_tr_b16 a[224:225], v10 offset:13312
    s_lshl_b32 s44, s3, 12
    v_mfma_f32_16x16x32_bf16 v[116:119], a[236:239], a[184:187], v[116:119]
    s_mov_b32 s38, s49
    ds_read_b64_tr_b16 a[226:227], v10 offset:19456
    s_mul_i32 s40, s3, 3072
    v_mfma_f32_16x16x32_bf16 v[112:115], a[232:235], a[184:187], v[112:115]
    s_mov_b32 s47, 3162112
    s_lshl_b32 s63, s3, 10
    v_mfma_f32_16x16x32_bf16 v[104:107], a[232:235], a[180:183], v[104:107]
    buffer_load_dwordx4 a[132:135], v14, s[20:23], s77 offen sc1
    v_mfma_f32_16x16x32_bf16 v[108:111], a[236:239], a[180:183], v[108:111]
    s_waitcnt lgkmcnt(4)
    v_mfma_f32_16x16x32_bf16 v[100:103], a[236:239], a[176:179], v[100:103]
    s_mov_b32 s80, 0xffffff01
    ds_read_b64_tr_b16 a[236:237], v9 offset:14336
    v_mfma_f32_16x16x32_bf16 v[96:99], a[232:235], a[176:179], v[96:99]
    ds_read_b64_tr_b16 a[238:239], v9 offset:20480
    v_mfma_f32_16x16x32_bf16 v[128:131], a[240:243], a[176:179], v[128:131]
    ds_read_b64_tr_b16 a[232:233], v8 offset:14336
    v_mfma_f32_16x16x32_bf16 v[132:135], a[244:247], a[176:179], v[132:135]
    ds_read_b64_tr_b16 a[234:235], v8 offset:20480
    v_mfma_f32_16x16x32_bf16 v[140:143], a[244:247], a[180:183], v[140:143]
    v_mfma_f32_16x16x32_bf16 v[136:139], a[240:243], a[180:183], v[136:139]
    buffer_load_dwordx4 a[136:139], v15, s[20:23], s46 offen sc1
    v_mfma_f32_16x16x32_bf16 v[144:147], a[240:243], a[184:187], v[144:147]
    v_mfma_f32_16x16x32_bf16 v[148:151], a[244:247], a[184:187], v[148:151]
    s_waitcnt lgkmcnt(3)
    v_mfma_f32_16x16x32_bf16 v[156:159], a[244:247], a[188:191], v[156:159]
    ds_read_b64_tr_b16 a[244:245], v11 offset:14336
    ds_read_b64_tr_b16 a[246:247], v11 offset:20480
    v_mfma_f32_16x16x32_bf16 v[152:155], a[240:243], a[188:191], v[152:155]
    ds_read_b64_tr_b16 a[240:241], v10 offset:14336
    ds_read_b64_tr_b16 a[242:243], v10 offset:20480
    v_mfma_f32_16x16x32_bf16 v[184:187], a[224:227], a[188:191], v[184:187]
    v_mfma_f32_16x16x32_bf16 v[188:191], a[228:231], a[188:191], v[188:191]
    buffer_load_dwordx4 a[140:143], v15, s[20:23], s77 offen sc1
    v_mfma_f32_16x16x32_bf16 v[180:183], a[228:231], a[184:187], v[180:183]
    s_add_u32 s46, s45, 20480
    s_sub_u32 s77, s46, 81920
    s_min_u32 s46, s46, s77
    v_mfma_f32_16x16x32_bf16 v[176:179], a[224:227], a[184:187], v[176:179]
    s_xor_b32 s77, s46, 1024
    v_mfma_f32_16x16x32_bf16 v[168:171], a[224:227], a[180:183], v[168:171]
    v_mfma_f32_16x16x32_bf16 v[172:175], a[228:231], a[180:183], v[172:175]
    s_waitcnt lgkmcnt(2)
    v_mfma_f32_16x16x32_bf16 v[164:167], a[228:231], a[176:179], v[164:167]
    s_waitcnt lgkmcnt(0)
    s_barrier
    v_mfma_f32_16x16x32_bf16 v[160:163], a[224:227], a[176:179], v[160:163]
    s_waitcnt vmcnt(11)
    ds_read_b64_tr_b16 a[224:225], v8 offset:24576
    v_mfma_f32_16x16x32_bf16 v[192:195], a[232:235], a[176:179], v[192:195]
    buffer_store_dwordx4 v[32:35], v36, s[24:27], s6 offen sc1
    v_mfma_f32_16x16x32_bf16 v[196:199], a[236:239], a[176:179], v[196:199]
    buffer_load_dwordx4 a[144:147], v14, s[20:23], s46 offen sc1
    v_mfma_f32_16x16x32_bf16 v[204:207], a[236:239], a[180:183], v[204:207]
    ds_read_b64_tr_b16 a[226:227], v8 offset:30720
    v_mfma_f32_16x16x32_bf16 v[200:203], a[232:235], a[180:183], v[200:203]
    ds_read_b64_tr_b16 a[228:229], v8 offset:36864
    v_mfma_f32_16x16x32_bf16 v[208:211], a[232:235], a[184:187], v[208:211]
    ds_read_b64_tr_b16 a[230:231], v8 offset:43008
    v_mfma_f32_16x16x32_bf16 v[212:215], a[236:239], a[184:187], v[212:215]
    v_mfma_f32_16x16x32_bf16 v[220:223], a[236:239], a[188:191], v[220:223]
    buffer_load_dwordx4 a[148:151], v14, s[20:23], s77 offen sc1
    v_mfma_f32_16x16x32_bf16 v[216:219], a[232:235], a[188:191], v[216:219]
    ds_read_b64_tr_b16 a[232:233], v9 offset:24576
    v_mfma_f32_16x16x32_bf16 v[248:251], a[240:243], a[188:191], v[248:251]
    ds_read_b64_tr_b16 a[234:235], v9 offset:30720
    v_mfma_f32_16x16x32_bf16 v[252:255], a[244:247], a[188:191], v[252:255]
    ds_read_b64_tr_b16 a[236:237], v9 offset:36864
    v_mfma_f32_16x16x32_bf16 v[244:247], a[244:247], a[184:187], v[244:247]
    ds_read_b64_tr_b16 a[238:239], v9 offset:43008
    v_mfma_f32_16x16x32_bf16 v[240:243], a[240:243], a[184:187], v[240:243]
    v_mfma_f32_16x16x32_bf16 v[232:235], a[240:243], a[180:183], v[232:235]
    v_mfma_f32_16x16x32_bf16 v[236:239], a[244:247], a[180:183], v[236:239]
    buffer_load_dwordx4 a[152:155], v15, s[20:23], s46 offen sc1
    v_mfma_f32_16x16x32_bf16 v[228:231], a[244:247], a[176:179], v[228:231]
    s_waitcnt vmcnt(11) lgkmcnt(3)
    v_mfma_f32_16x16x32_bf16 v[224:227], a[240:243], a[176:179], v[224:227]
    s_waitcnt vmcnt(10)
    ds_read_b64_tr_b16 a[240:241], v10 offset:24576
    v_mfma_f32_16x16x32_bf16 v[64:67], a[224:227], a[96:99], v[64:67]
    ds_read_b64_tr_b16 a[242:243], v10 offset:30720
    v_mfma_f32_16x16x32_bf16 v[64:67], a[228:231], a[112:115], v[64:67]
    ds_read_b64_tr_b16 a[244:245], v10 offset:36864
    v_mfma_f32_16x16x32_bf16 v[72:75], a[228:231], a[116:119], v[72:75]
    s_waitcnt vmcnt(9)
    ds_read_b64_tr_b16 a[246:247], v10 offset:43008
    v_mfma_f32_16x16x32_bf16 v[72:75], a[224:227], a[100:103], v[72:75]
    buffer_load_dwordx4 a[156:159], v15, s[20:23], s77 offen sc1
    v_mfma_f32_16x16x32_bf16 v[80:83], a[224:227], a[104:107], v[80:83]
    s_waitcnt vmcnt(9)
    s_add_u32 s46, s45, 24576
    s_sub_u32 s77, s46, 81920
    v_mfma_f32_16x16x32_bf16 v[80:83], a[228:231], a[120:123], v[80:83]
    s_waitcnt lgkmcnt(4)
    s_min_u32 s46, s46, s77
    s_xor_b32 s77, s46, 1024
    v_mfma_f32_16x16x32_bf16 v[88:91], a[228:231], a[124:127], v[88:91]
    v_mfma_f32_16x16x32_bf16 v[88:91], a[224:227], a[108:111], v[88:91]
    ds_read_b64_tr_b16 a[224:225], v11 offset:24576
    v_mfma_f32_16x16x32_bf16 v[92:95], a[232:235], a[108:111], v[92:95]
    ds_read_b64_tr_b16 a[226:227], v11 offset:30720
    v_mfma_f32_16x16x32_bf16 v[92:95], a[236:239], a[124:127], v[92:95]
    ds_read_b64_tr_b16 a[228:229], v11 offset:36864
    v_mfma_f32_16x16x32_bf16 v[84:87], a[236:239], a[120:123], v[84:87]
    buffer_load_dwordx4 a[192:195], v14, s[20:23], s46 offen sc1
    v_mfma_f32_16x16x32_bf16 v[84:87], a[232:235], a[104:107], v[84:87]
    ds_read_b64_tr_b16 a[230:231], v11 offset:43008
    v_mfma_f32_16x16x32_bf16 v[76:79], a[232:235], a[100:103], v[76:79]
    v_mfma_f32_16x16x32_bf16 v[76:79], a[236:239], a[116:119], v[76:79]
    s_waitcnt lgkmcnt(4)
    v_mfma_f32_16x16x32_bf16 v[68:71], a[236:239], a[112:115], v[68:71]
    v_mfma_f32_16x16x32_bf16 v[68:71], a[232:235], a[96:99], v[68:71]
    ds_read_b64_tr_b16 a[232:233], v8 offset:25600
    v_mfma_f32_16x16x32_bf16 v[96:99], a[240:243], a[96:99], v[96:99]
    buffer_load_dwordx4 a[196:199], v14, s[20:23], s77 offen sc1
    v_mfma_f32_16x16x32_bf16 v[96:99], a[244:247], a[112:115], v[96:99]
    ds_read_b64_tr_b16 a[234:235], v8 offset:31744
    v_mfma_f32_16x16x32_bf16 v[104:107], a[244:247], a[116:119], v[104:107]
    ds_read_b64_tr_b16 a[236:237], v8 offset:37888
    v_mfma_f32_16x16x32_bf16 v[104:107], a[240:243], a[100:103], v[104:107]
    ds_read_b64_tr_b16 a[238:239], v8 offset:44032
    v_mfma_f32_16x16x32_bf16 v[112:115], a[240:243], a[104:107], v[112:115]
    v_mfma_f32_16x16x32_bf16 v[112:115], a[244:247], a[120:123], v[112:115]
    s_waitcnt lgkmcnt(4)
    v_mfma_f32_16x16x32_bf16 v[120:123], a[244:247], a[124:127], v[120:123]
    v_mfma_f32_16x16x32_bf16 v[120:123], a[240:243], a[108:111], v[120:123]
    buffer_load_dwordx4 a[200:203], v15, s[20:23], s46 offen sc1
    v_mfma_f32_16x16x32_bf16 v[124:127], a[224:227], a[108:111], v[124:127]
    ds_read_b64_tr_b16 a[240:241], v9 offset:25600
    v_mfma_f32_16x16x32_bf16 v[124:127], a[228:231], a[124:127], v[124:127]
    ds_read_b64_tr_b16 a[242:243], v9 offset:31744
    v_mfma_f32_16x16x32_bf16 v[116:119], a[228:231], a[120:123], v[116:119]
    ds_read_b64_tr_b16 a[244:245], v9 offset:37888
    v_mfma_f32_16x16x32_bf16 v[116:119], a[224:227], a[104:107], v[116:119]
    ds_read_b64_tr_b16 a[246:247], v9 offset:44032
    v_mfma_f32_16x16x32_bf16 v[108:111], a[224:227], a[100:103], v[108:111]
    v_mfma_f32_16x16x32_bf16 v[108:111], a[228:231], a[116:119], v[108:111]
    buffer_load_dwordx4 a[204:207], v15, s[20:23], s77 offen sc1
    v_mfma_f32_16x16x32_bf16 v[100:103], a[228:231], a[112:115], v[100:103]
    s_waitcnt lgkmcnt(4)
    s_add_u32 m0, s49, 0
    v_mfma_f32_16x16x32_bf16 v[100:103], a[224:227], a[96:99], v[100:103]
    ds_read_b64_tr_b16 a[224:225], v10 offset:25600
    v_mfma_f32_16x16x32_bf16 v[128:131], a[232:235], a[96:99], v[128:131]
    ds_read_b64_tr_b16 a[226:227], v10 offset:31744
    v_mfma_f32_16x16x32_bf16 v[128:131], a[236:239], a[112:115], v[128:131]
    ds_read_b64_tr_b16 a[228:229], v10 offset:37888
    v_mfma_f32_16x16x32_bf16 v[136:139], a[236:239], a[116:119], v[136:139]
    ds_read_b64_tr_b16 a[230:231], v10 offset:44032
    v_mfma_f32_16x16x32_bf16 v[136:139], a[232:235], a[100:103], v[136:139]
    v_mfma_f32_16x16x32_bf16 v[144:147], a[232:235], a[104:107], v[144:147]
    buffer_load_dwordx4 v2, s[8:11], s36 offen offset:0 lds
    v_mfma_f32_16x16x32_bf16 v[144:147], a[236:239], a[120:123], v[144:147]
    s_waitcnt lgkmcnt(4)
    s_addk_i32 m0, 896
    v_mfma_f32_16x16x32_bf16 v[152:155], a[236:239], a[124:127], v[152:155]
    v_mfma_f32_16x16x32_bf16 v[152:155], a[232:235], a[108:111], v[152:155]
    ds_read_b64_tr_b16 a[232:233], v11 offset:25600
    v_mfma_f32_16x16x32_bf16 v[156:159], a[240:243], a[108:111], v[156:159]
    ds_read_b64_tr_b16 a[234:235], v11 offset:31744
    v_mfma_f32_16x16x32_bf16 v[156:159], a[244:247], a[124:127], v[156:159]
    ds_read_b64_tr_b16 a[236:237], v11 offset:37888
    v_mfma_f32_16x16x32_bf16 v[148:151], a[244:247], a[120:123], v[148:151]
    buffer_load_dwordx4 v2, s[8:11], s36 offen offset:128 lds
    v_mfma_f32_16x16x32_bf16 v[148:151], a[240:243], a[104:107], v[148:151]
    s_addk_i32 m0, 896
    ds_read_b64_tr_b16 a[238:239], v11 offset:44032
    v_mfma_f32_16x16x32_bf16 v[140:143], a[240:243], a[100:103], v[140:143]
    v_mfma_f32_16x16x32_bf16 v[140:143], a[244:247], a[116:119], v[140:143]
    s_waitcnt lgkmcnt(4)
    v_mfma_f32_16x16x32_bf16 v[132:135], a[244:247], a[112:115], v[132:135]
    v_mfma_f32_16x16x32_bf16 v[132:135], a[240:243], a[96:99], v[132:135]
    ds_read_b64_tr_b16 a[240:241], v8 offset:26624
    v_mfma_f32_16x16x32_bf16 v[160:163], a[224:227], a[96:99], v[160:163]
    ds_read_b64_tr_b16 a[242:243], v8 offset:32768
    v_mfma_f32_16x16x32_bf16 v[160:163], a[228:231], a[112:115], v[160:163]
    buffer_load_dwordx4 v2, s[8:11], s36 offen offset:256 lds
    v_mfma_f32_16x16x32_bf16 v[168:171], a[228:231], a[116:119], v[168:171]
    s_addk_i32 m0, 1280
    ds_read_b64_tr_b16 a[244:245], v8 offset:38912
    v_mfma_f32_16x16x32_bf16 v[168:171], a[224:227], a[100:103], v[168:171]
    ds_read_b64_tr_b16 a[246:247], v8 offset:45056
    v_mfma_f32_16x16x32_bf16 v[176:179], a[224:227], a[104:107], v[176:179]
    v_add_u32 v8, 49152, v8
    v_mfma_f32_16x16x32_bf16 v[176:179], a[228:231], a[120:123], v[176:179]
    s_waitcnt lgkmcnt(4)
    v_mfma_f32_16x16x32_bf16 v[184:187], a[228:231], a[124:127], v[184:187]
    v_mfma_f32_16x16x32_bf16 v[184:187], a[224:227], a[108:111], v[184:187]
    buffer_load_dwordx4 v3, s[8:11], s36 offen offset:0 lds
    v_mfma_f32_16x16x32_bf16 v[188:191], a[232:235], a[108:111], v[188:191]
    s_addk_i32 m0, 896
    ds_read_b64_tr_b16 a[224:225], v9 offset:26624
    v_mfma_f32_16x16x32_bf16 v[188:191], a[236:239], a[124:127], v[188:191]
    ds_read_b64_tr_b16 a[226:227], v9 offset:32768
    v_mfma_f32_16x16x32_bf16 v[180:183], a[236:239], a[120:123], v[180:183]
    ds_read_b64_tr_b16 a[228:229], v9 offset:38912
    v_mfma_f32_16x16x32_bf16 v[180:183], a[232:235], a[104:107], v[180:183]
    ds_read_b64_tr_b16 a[230:231], v9 offset:45056
    v_mfma_f32_16x16x32_bf16 v[172:175], a[232:235], a[100:103], v[172:175]
    v_add_u32 v9, 49152, v9
    v_mfma_f32_16x16x32_bf16 v[172:175], a[236:239], a[116:119], v[172:175]
    s_waitcnt lgkmcnt(4)
    v_mfma_f32_16x16x32_bf16 v[164:167], a[236:239], a[112:115], v[164:167]
    buffer_load_dwordx4 v3, s[8:11], s36 offen offset:128 lds
    v_mfma_f32_16x16x32_bf16 v[164:167], a[232:235], a[96:99], v[164:167]
    s_addk_i32 m0, 896
    ds_read_b64_tr_b16 a[232:233], v10 offset:26624
    v_mfma_f32_16x16x32_bf16 v[192:195], a[240:243], a[96:99], v[192:195]
    ds_read_b64_tr_b16 a[234:235], v10 offset:32768
    v_mfma_f32_16x16x32_bf16 v[192:195], a[244:247], a[112:115], v[192:195]
    ds_read_b64_tr_b16 a[236:237], v10 offset:38912
    v_mfma_f32_16x16x32_bf16 v[200:203], a[244:247], a[116:119], v[200:203]
    ds_read_b64_tr_b16 a[238:239], v10 offset:45056
    v_mfma_f32_16x16x32_bf16 v[200:203], a[240:243], a[100:103], v[200:203]
    v_add_u32 v10, 49152, v10
    v_mfma_f32_16x16x32_bf16 v[208:211], a[240:243], a[104:107], v[208:211]
    buffer_load_dwordx4 v3, s[8:11], s36 offen offset:256 lds
    v_mfma_f32_16x16x32_bf16 v[208:211], a[244:247], a[120:123], v[208:211]
    s_waitcnt lgkmcnt(4)
    s_add_u32 s36, s36, s37
    s_sub_u32 s55, s36, 7864320
    v_mfma_f32_16x16x32_bf16 v[216:219], a[244:247], a[124:127], v[216:219]
    s_min_u32 s36, s36, s55
    s_add_u32 s46, s45, 28672
    s_sub_u32 s77, s46, 81920
    v_mfma_f32_16x16x32_bf16 v[216:219], a[240:243], a[108:111], v[216:219]
    s_min_u32 s46, s46, s77
    ds_read_b64_tr_b16 a[240:241], v11 offset:26624
    s_xor_b32 s77, s46, 1024
    ds_read_b64_tr_b16 a[242:243], v11 offset:32768
    v_mfma_f32_16x16x32_bf16 v[220:223], a[224:227], a[108:111], v[220:223]
    ds_read_b64_tr_b16 a[244:245], v11 offset:38912
    ds_read_b64_tr_b16 a[246:247], v11 offset:45056
    v_mfma_f32_16x16x32_bf16 v[220:223], a[228:231], a[124:127], v[220:223]
    v_add_u32 v11, 49152, v11
    v_mfma_f32_16x16x32_bf16 v[212:215], a[228:231], a[120:123], v[212:215]
    v_mfma_f32_16x16x32_bf16 v[212:215], a[224:227], a[104:107], v[212:215]
    buffer_load_dwordx4 a[208:211], v14, s[20:23], s46 offen sc1
    v_mfma_f32_16x16x32_bf16 v[204:207], a[224:227], a[100:103], v[204:207]
    v_mfma_f32_16x16x32_bf16 v[204:207], a[228:231], a[116:119], v[204:207]
    s_waitcnt lgkmcnt(4)
    v_mfma_f32_16x16x32_bf16 v[196:199], a[228:231], a[112:115], v[196:199]
    s_waitcnt lgkmcnt(0)
    s_barrier
    v_mfma_f32_16x16x32_bf16 v[196:199], a[224:227], a[96:99], v[196:199]
    ds_read_b64_tr_b16 a[224:225], v8 offset:0
    v_mfma_f32_16x16x32_bf16 v[224:227], a[232:235], a[96:99], v[224:227]
    ds_read_b64_tr_b16 a[226:227], v8 offset:6144
    v_mfma_f32_16x16x32_bf16 v[224:227], a[236:239], a[112:115], v[224:227]
pg_1:
    s_cbranch_execz pg_5
    buffer_load_dwordx4 a[212:215], v14, s[20:23], s77 offen sc1
    v_mfma_f32_16x16x32_bf16 v[232:235], a[236:239], a[116:119], v[232:235]
    ds_read_b64_tr_b16 a[228:229], v8 offset:12288
    v_mfma_f32_16x16x32_bf16 v[232:235], a[232:235], a[100:103], v[232:235]
    ds_read_b64_tr_b16 a[230:231], v8 offset:18432
    v_mfma_f32_16x16x32_bf16 v[240:243], a[232:235], a[104:107], v[240:243]
    v_mfma_f32_16x16x32_bf16 v[240:243], a[236:239], a[120:123], v[240:243]
    v_mfma_f32_16x16x32_bf16 v[248:251], a[236:239], a[124:127], v[248:251]
    v_mfma_f32_16x16x32_bf16 v[248:251], a[232:235], a[108:111], v[248:251]
    ds_read_b64_tr_b16 a[232:233], v9 offset:0
    v_mfma_f32_16x16x32_bf16 v[252:255], a[240:243], a[108:111], v[252:255]
    buffer_load_dwordx4 a[216:219], v15, s[20:23], s46 offen sc1
    v_mfma_f32_16x16x32_bf16 v[252:255], a[244:247], a[124:127], v[252:255]
    ds_read_b64_tr_b16 a[234:235], v9 offset:6144
    v_mfma_f32_16x16x32_bf16 v[244:247], a[244:247], a[120:123], v[244:247]
    ds_read_b64_tr_b16 a[236:237], v9 offset:12288
    v_mfma_f32_16x16x32_bf16 v[244:247], a[240:243], a[104:107], v[244:247]
    ds_read_b64_tr_b16 a[238:239], v9 offset:18432
    v_mfma_f32_16x16x32_bf16 v[236:239], a[240:243], a[100:103], v[236:239]
    v_mfma_f32_16x16x32_bf16 v[236:239], a[244:247], a[116:119], v[236:239]
    s_waitcnt vmcnt(21) lgkmcnt(4)
    v_mfma_f32_16x16x32_bf16 v[228:231], a[244:247], a[112:115], v[228:231]
    buffer_load_dwordx4 a[220:223], v15, s[20:23], s77 offen sc1
    v_mfma_f32_16x16x32_bf16 v[228:231], a[240:243], a[96:99], v[228:231]
    s_waitcnt vmcnt(16)
    ds_read_b64_tr_b16 a[240:241], v10 offset:0
    v_and_b32 v22, 1, v1
    v_mfma_f32_16x16x32_bf16 v[64:67], a[224:227], a[128:131], v[64:67]
    s_add_u32 s46, s45, 32768
    ds_read_b64_tr_b16 a[242:243], v10 offset:6144
    s_sub_u32 s77, s46, 81920
    v_mfma_f32_16x16x32_bf16 v[64:67], a[228:231], a[144:147], v[64:67]
    s_min_u32 s46, s46, s77
    ds_read_b64_tr_b16 a[244:245], v10 offset:12288
    s_xor_b32 s77, s46, 1024
    v_mfma_f32_16x16x32_bf16 v[72:75], a[228:231], a[148:151], v[72:75]
    s_waitcnt vmcnt(15)
    ds_read_b64_tr_b16 a[246:247], v10 offset:18432
    s_sub_u32 s56, s5, s4
    v_mfma_f32_16x16x32_bf16 v[72:75], a[224:227], a[132:135], v[72:75]
    s_waitcnt vmcnt(14)
    s_sub_u32 s56, s56, 128
    v_mul_lo_u32 v22, v22, s56
    v_mfma_f32_16x16x32_bf16 v[80:83], a[224:227], a[136:139], v[80:83]
    buffer_load_dword a252, v22, s[24:27], s4 offen offset:128 sc1
    v_mfma_f32_16x16x32_bf16 v[80:83], a[228:231], a[152:155], v[80:83]
    buffer_load_dwordx4 a[0:3], v14, s[20:23], s46 offen sc1
    v_mfma_f32_16x16x32_bf16 v[88:91], a[228:231], a[156:159], v[88:91]
    s_waitcnt lgkmcnt(3)
    v_mfma_f32_16x16x32_bf16 v[88:91], a[224:227], a[140:143], v[88:91]
    ds_read_b64_tr_b16 a[224:225], v11 offset:0
    v_mfma_f32_16x16x32_bf16 v[92:95], a[232:235], a[140:143], v[92:95]
    ds_read_b64_tr_b16 a[226:227], v11 offset:6144
    v_mfma_f32_16x16x32_bf16 v[92:95], a[236:239], a[156:159], v[92:95]
    ds_read_b64_tr_b16 a[228:229], v11 offset:12288
    v_mfma_f32_16x16x32_bf16 v[84:87], a[236:239], a[152:155], v[84:87]
    ds_read_b64_tr_b16 a[230:231], v11 offset:18432
    v_mfma_f32_16x16x32_bf16 v[84:87], a[232:235], a[136:139], v[84:87]
    buffer_load_dwordx4 a[4:7], v14, s[20:23], s77 offen sc1
    v_mfma_f32_16x16x32_bf16 v[76:79], a[232:235], a[132:135], v[76:79]
    v_mfma_f32_16x16x32_bf16 v[76:79], a[236:239], a[148:151], v[76:79]
    s_waitcnt lgkmcnt(4)
    v_mfma_f32_16x16x32_bf16 v[68:71], a[236:239], a[144:147], v[68:71]
    v_mfma_f32_16x16x32_bf16 v[68:71], a[232:235], a[128:131], v[68:71]
    ds_read_b64_tr_b16 a[232:233], v8 offset:1024
    v_mfma_f32_16x16x32_bf16 v[96:99], a[240:243], a[128:131], v[96:99]
    ds_read_b64_tr_b16 a[234:235], v8 offset:7168
    v_mfma_f32_16x16x32_bf16 v[96:99], a[244:247], a[144:147], v[96:99]
    ds_read_b64_tr_b16 a[236:237], v8 offset:13312
    v_mfma_f32_16x16x32_bf16 v[104:107], a[244:247], a[148:151], v[104:107]
    buffer_load_dwordx4 a[8:11], v15, s[20:23], s46 offen sc1
    v_mfma_f32_16x16x32_bf16 v[104:107], a[240:243], a[132:135], v[104:107]
    ds_read_b64_tr_b16 a[238:239], v8 offset:19456
    v_mfma_f32_16x16x32_bf16 v[112:115], a[240:243], a[136:139], v[112:115]
    v_mfma_f32_16x16x32_bf16 v[112:115], a[244:247], a[152:155], v[112:115]
    s_waitcnt lgkmcnt(4)
    v_mfma_f32_16x16x32_bf16 v[120:123], a[244:247], a[156:159], v[120:123]
    v_mfma_f32_16x16x32_bf16 v[120:123], a[240:243], a[140:143], v[120:123]
    ds_read_b64_tr_b16 a[240:241], v9 offset:1024
    v_mfma_f32_16x16x32_bf16 v[124:127], a[224:227], a[140:143], v[124:127]
    buffer_load_dwordx4 a[12:15], v15, s[20:23], s77 offen sc1
    v_mfma_f32_16x16x32_bf16 v[124:127], a[228:231], a[156:159], v[124:127]
    s_addk_i32 m0, 19712
    ds_read_b64_tr_b16 a[242:243], v9 offset:7168
    v_mfma_f32_16x16x32_bf16 v[116:119], a[228:231], a[152:155], v[116:119]
    ds_read_b64_tr_b16 a[244:245], v9 offset:13312
    v_mfma_f32_16x16x32_bf16 v[116:119], a[224:227], a[136:139], v[116:119]
    ds_read_b64_tr_b16 a[246:247], v9 offset:19456
    v_mfma_f32_16x16x32_bf16 v[108:111], a[224:227], a[132:135], v[108:111]
    v_mfma_f32_16x16x32_bf16 v[108:111], a[228:231], a[148:151], v[108:111]
    s_waitcnt lgkmcnt(4)
    v_mfma_f32_16x16x32_bf16 v[100:103], a[228:231], a[144:147], v[100:103]
    v_mfma_f32_16x16x32_bf16 v[100:103], a[224:227], a[128:131], v[100:103]
    buffer_load_dwordx4 v2, s[8:11], s36 offen offset:0 lds
    v_mfma_f32_16x16x32_bf16 v[128:131], a[232:235], a[128:131], v[128:131]
    s_addk_i32 m0, 896
    ds_read_b64_tr_b16 a[224:225], v10 offset:1024
    v_mfma_f32_16x16x32_bf16 v[128:131], a[236:239], a[144:147], v[128:131]
    ds_read_b64_tr_b16 a[226:227], v10 offset:7168
    v_mfma_f32_16x16x32_bf16 v[136:139], a[236:239], a[148:151], v[136:139]
    ds_read_b64_tr_b16 a[228:229], v10 offset:13312
    v_mfma_f32_16x16x32_bf16 v[136:139], a[232:235], a[132:135], v[136:139]
    ds_read_b64_tr_b16 a[230:231], v10 offset:19456
    v_mfma_f32_16x16x32_bf16 v[144:147], a[232:235], a[136:139], v[144:147]
    v_mfma_f32_16x16x32_bf16 v[144:147], a[236:239], a[152:155], v[144:147]
    buffer_load_dwordx4 v2, s[8:11], s36 offen offset:128 lds
    v_mfma_f32_16x16x32_bf16 v[152:155], a[236:239], a[156:159], v[152:155]
    buffer_load_dwordx4 v[32:35], v17, s[24:27], s47 offen offset:0 sc1
    v_mfma_f32_16x16x32_bf16 v[152:155], a[232:235], a[140:143], v[152:155]
    s_waitcnt lgkmcnt(3)
    ds_read_b64_tr_b16 a[232:233], v11 offset:1024
    s_addk_i32 m0, 896
    v_mfma_f32_16x16x32_bf16 v[156:159], a[240:243], a[140:143], v[156:159]
    ds_read_b64_tr_b16 a[234:235], v11 offset:7168
    v_mfma_f32_16x16x32_bf16 v[156:159], a[244:247], a[156:159], v[156:159]
    ds_read_b64_tr_b16 a[236:237], v11 offset:13312
    v_mfma_f32_16x16x32_bf16 v[148:151], a[244:247], a[152:155], v[148:151]
    ds_read_b64_tr_b16 a[238:239], v11 offset:19456
    v_mfma_f32_16x16x32_bf16 v[148:151], a[240:243], a[136:139], v[148:151]
    v_mfma_f32_16x16x32_bf16 v[140:143], a[240:243], a[132:135], v[140:143]
    buffer_load_dwordx4 v2, s[8:11], s36 offen offset:256 lds
    v_mfma_f32_16x16x32_bf16 v[140:143], a[244:247], a[148:151], v[140:143]
    s_waitcnt lgkmcnt(4)
    s_addk_i32 m0, 1280
    v_mfma_f32_16x16x32_bf16 v[132:135], a[244:247], a[144:147], v[132:135]
    v_mfma_f32_16x16x32_bf16 v[132:135], a[240:243], a[128:131], v[132:135]
    ds_read_b64_tr_b16 a[240:241], v8 offset:2048
    v_mfma_f32_16x16x32_bf16 v[160:163], a[224:227], a[128:131], v[160:163]
    ds_read_b64_tr_b16 a[242:243], v8 offset:8192
    v_mfma_f32_16x16x32_bf16 v[160:163], a[228:231], a[144:147], v[160:163]
    ds_read_b64_tr_b16 a[244:245], v8 offset:14336
    v_mfma_f32_16x16x32_bf16 v[168:171], a[228:231], a[148:151], v[168:171]
    buffer_load_dwordx4 v3, s[8:11], s36 offen offset:0 lds
    v_mfma_f32_16x16x32_bf16 v[168:171], a[224:227], a[132:135], v[168:171]
    s_addk_i32 m0, 896
    ds_read_b64_tr_b16 a[246:247], v8 offset:20480
    v_mfma_f32_16x16x32_bf16 v[176:179], a[224:227], a[136:139], v[176:179]
    buffer_load_dwordx4 v[36:39], v17, s[24:27], s47 offen offset:1024 sc1
    v_mfma_f32_16x16x32_bf16 v[176:179], a[228:231], a[152:155], v[176:179]
    s_waitcnt lgkmcnt(4)
    v_mfma_f32_16x16x32_bf16 v[184:187], a[228:231], a[156:159], v[184:187]
    v_mfma_f32_16x16x32_bf16 v[184:187], a[224:227], a[140:143], v[184:187]
    ds_read_b64_tr_b16 a[224:225], v9 offset:2048
    v_mfma_f32_16x16x32_bf16 v[188:191], a[232:235], a[140:143], v[188:191]
    ds_read_b64_tr_b16 a[226:227], v9 offset:8192
    v_mfma_f32_16x16x32_bf16 v[188:191], a[236:239], a[156:159], v[188:191]
    buffer_load_dwordx4 v3, s[8:11], s36 offen offset:128 lds
    v_mfma_f32_16x16x32_bf16 v[180:183], a[236:239], a[152:155], v[180:183]
    s_addk_i32 m0, 896
    ds_read_b64_tr_b16 a[228:229], v9 offset:14336
    v_mfma_f32_16x16x32_bf16 v[180:183], a[232:235], a[136:139], v[180:183]
    ds_read_b64_tr_b16 a[230:231], v9 offset:20480
    v_mfma_f32_16x16x32_bf16 v[172:175], a[232:235], a[132:135], v[172:175]
    v_mfma_f32_16x16x32_bf16 v[172:175], a[236:239], a[148:151], v[172:175]
    s_waitcnt lgkmcnt(4)
    v_mfma_f32_16x16x32_bf16 v[164:167], a[236:239], a[144:147], v[164:167]
    v_mfma_f32_16x16x32_bf16 v[164:167], a[232:235], a[128:131], v[164:167]
    buffer_load_dwordx4 v3, s[8:11], s36 offen offset:256 lds
    v_mfma_f32_16x16x32_bf16 v[192:195], a[240:243], a[128:131], v[192:195]
    s_add_u32 s36, s36, s37
    ds_read_b64_tr_b16 a[232:233], v10 offset:2048
    s_sub_u32 s55, s36, 7864320
    v_mfma_f32_16x16x32_bf16 v[192:195], a[244:247], a[144:147], v[192:195]
    s_min_u32 s36, s36, s55
    ds_read_b64_tr_b16 a[234:235], v10 offset:8192
    s_add_u32 s46, s45, 36864
    v_mfma_f32_16x16x32_bf16 v[200:203], a[244:247], a[148:151], v[200:203]
    s_sub_u32 s77, s46, 81920
    ds_read_b64_tr_b16 a[236:237], v10 offset:14336
    s_min_u32 s46, s46, s77
    v_mfma_f32_16x16x32_bf16 v[200:203], a[240:243], a[132:135], v[200:203]
    s_xor_b32 s77, s46, 1024
    ds_read_b64_tr_b16 a[238:239], v10 offset:20480
    v_mfma_f32_16x16x32_bf16 v[208:211], a[240:243], a[136:139], v[208:211]
    buffer_load_dwordx4 v[40:43], v17, s[24:27], s47 offen offset:2048 sc1
    v_mfma_f32_16x16x32_bf16 v[208:211], a[244:247], a[152:155], v[208:211]
    s_waitcnt lgkmcnt(4)
    v_mfma_f32_16x16x32_bf16 v[216:219], a[244:247], a[156:159], v[216:219]
    buffer_load_dwordx4 a[16:19], v14, s[20:23], s46 offen sc1
    s_cmp_lg_u32 s3, 0
    s_cselect_b64 exec, -1, 0
    s_cbranch_execz pg_last
pg_back2:
    s_mov_b64 exec, -1
    v_mfma_f32_16x16x32_bf16 v[216:219], a[240:243], a[140:143], v[216:219]
    ds_read_b64_tr_b16 a[240:241], v11 offset:2048
    ds_read_b64_tr_b16 a[242:243], v11 offset:8192
    ds_read_b64_tr_b16 a[244:245], v11 offset:14336
    v_mfma_f32_16x16x32_bf16 v[220:223], a[224:227], a[140:143], v[220:223]
    ds_read_b64_tr_b16 a[246:247], v11 offset:20480
    v_mfma_f32_16x16x32_bf16 v[220:223], a[228:231], a[156:159], v[220:223]
    v_mfma_f32_16x16x32_bf16 v[212:215], a[228:231], a[152:155], v[212:215]
    v_mfma_f32_16x16x32_bf16 v[212:215], a[224:227], a[136:139], v[212:215]
    v_mfma_f32_16x16x32_bf16 v[204:207], a[224:227], a[132:135], v[204:207]
    buffer_load_dwordx4 a[20:23], v14, s[20:23], s77 offen sc1
    v_mfma_f32_16x16x32_bf16 v[204:207], a[228:231], a[148:151], v[204:207]
    s_waitcnt lgkmcnt(4)
    v_mfma_f32_16x16x32_bf16 v[196:199], a[228:231], a[144:147], v[196:199]
    s_waitcnt lgkmcnt(0)
    s_barrier
    v_mfma_f32_16x16x32_bf16 v[196:199], a[224:227], a[128:131], v[196:199]
    ds_read_b64_tr_b16 a[224:225], v8 offset:24576
    v_mfma_f32_16x16x32_bf16 v[224:227], a[232:235], a[128:131], v[224:227]
    buffer_load_dwordx4 v[44:47], v17, s[24:27], s47 offen offset:3072 sc1
    v_mfma_f32_16x16x32_bf16 v[224:227], a[236:239], a[144:147], v[224:227]
    ds_read_b64_tr_b16 a[226:227], v8 offset:30720
    v_mfma_f32_16x16x32_bf16 v[232:235], a[236:239], a[148:151], v[232:235]
    ds_read_b64_tr_b16 a[228:229], v8 offset:36864
    v_mfma_f32_16x16x32_bf16 v[232:235], a[232:235], a[132:135], v[232:235]
    buffer_load_dwordx4 a[24:27], v15, s[20:23], s46 offen sc1
    v_mfma_f32_16x16x32_bf16 v[240:243], a[232:235], a[136:139], v[240:243]
    ds_read_b64_tr_b16 a[230:231], v8 offset:43008
    v_mfma_f32_16x16x32_bf16 v[240:243], a[236:239], a[152:155], v[240:243]
    v_mfma_f32_16x16x32_bf16 v[248:251], a[236:239], a[156:159], v[248:251]
    v_mfma_f32_16x16x32_bf16 v[248:251], a[232:235], a[140:143], v[248:251]
    ds_read_b64_tr_b16 a[232:233], v9 offset:24576
    v_mfma_f32_16x16x32_bf16 v[252:255], a[240:243], a[140:143], v[252:255]
    ds_read_b64_tr_b16 a[234:235], v9 offset:30720
    v_mfma_f32_16x16x32_bf16 v[252:255], a[244:247], a[156:159], v[252:255]
    buffer_load_dwordx4 a[28:31], v15, s[20:23], s77 offen sc1
    v_mfma_f32_16x16x32_bf16 v[244:247], a[244:247], a[152:155], v[244:247]
    s_add_u32 s46, s45, 40960
    ds_read_b64_tr_b16 a[236:237], v9 offset:36864
    s_sub_u32 s77, s46, 81920
    v_mfma_f32_16x16x32_bf16 v[244:247], a[240:243], a[136:139], v[244:247]
    s_min_u32 s46, s46, s77
    ds_read_b64_tr_b16 a[238:239], v9 offset:43008
    s_xor_b32 s77, s46, 1024
    v_mfma_f32_16x16x32_bf16 v[236:239], a[240:243], a[132:135], v[236:239]
    v_mfma_f32_16x16x32_bf16 v[236:239], a[244:247], a[148:151], v[236:239]
    s_waitcnt vmcnt(32) lgkmcnt(4)
    v_mfma_f32_16x16x32_bf16 v[228:231], a[244:247], a[144:147], v[228:231]
    s_waitcnt vmcnt(22)
    v_mfma_f32_16x16x32_bf16 v[228:231], a[240:243], a[128:131], v[228:231]
    s_waitcnt vmcnt(21)
    ds_read_b64_tr_b16 a[240:241], v10 offset:24576
    v_mfma_f32_16x16x32_bf16 v[64:67], a[224:227], a[192:195], v[64:67]
    buffer_load_dwordx4 a[32:35], v14, s[20:23], s46 offen sc1
    v_mfma_f32_16x16x32_bf16 v[64:67], a[228:231], a[208:211], v[64:67]
    ds_read_b64_tr_b16 a[242:243], v10 offset:30720
    v_mfma_f32_16x16x32_bf16 v[72:75], a[228:231], a[212:215], v[72:75]
    s_waitcnt vmcnt(21)
    ds_read_b64_tr_b16 a[244:245], v10 offset:36864
    v_mfma_f32_16x16x32_bf16 v[72:75], a[224:227], a[196:199], v[72:75]
    s_waitcnt vmcnt(20)
    ds_read_b64_tr_b16 a[246:247], v10 offset:43008
    v_mfma_f32_16x16x32_bf16 v[80:83], a[224:227], a[200:203], v[80:83]
    v_mfma_f32_16x16x32_bf16 v[80:83], a[228:231], a[216:219], v[80:83]
    s_waitcnt lgkmcnt(4)
    v_mfma_f32_16x16x32_bf16 v[88:91], a[228:231], a[220:223], v[88:91]
    buffer_load_dwordx4 a[36:39], v14, s[20:23], s77 offen sc1
    v_mfma_f32_16x16x32_bf16 v[88:91], a[224:227], a[204:207], v[88:91]
    ds_read_b64_tr_b16 a[224:225], v11 offset:24576
    v_mfma_f32_16x16x32_bf16 v[92:95], a[232:235], a[204:207], v[92:95]
    ds_read_b64_tr_b16 a[226:227], v11 offset:30720
    v_mfma_f32_16x16x32_bf16 v[92:95], a[236:239], a[220:223], v[92:95]
    ds_read_b64_tr_b16 a[228:229], v11 offset:36864
    v_mfma_f32_16x16x32_bf16 v[84:87], a[236:239], a[216:219], v[84:87]
    ds_read_b64_tr_b16 a[230:231], v11 offset:43008
    v_mfma_f32_16x16x32_bf16 v[84:87], a[232:235], a[200:203], v[84:87]
    v_mfma_f32_16x16x32_bf16 v[76:79], a[232:235], a[196:199], v[76:79]
    v_mfma_f32_16x16x32_bf16 v[76:79], a[236:239], a[212:215], v[76:79]
    buffer_load_dwordx4 a[40:43], v15, s[20:23], s46 offen sc1
    v_mfma_f32_16x16x32_bf16 v[68:71], a[236:239], a[208:211], v[68:71]
    s_waitcnt lgkmcnt(3)
    v_mfma_f32_16x16x32_bf16 v[68:71], a[232:235], a[192:195], v[68:71]
    ds_read_b64_tr_b16 a[232:233], v8 offset:25600
    v_mfma_f32_16x16x32_bf16 v[96:99], a[240:243], a[192:195], v[96:99]
    ds_read_b64_tr_b16 a[234:235], v8 offset:31744
    v_mfma_f32_16x16x32_bf16 v[96:99], a[244:247], a[208:211], v[96:99]
    ds_read_b64_tr_b16 a[236:237], v8 offset:37888
    v_mfma_f32_16x16x32_bf16 v[104:107], a[244:247], a[212:215], v[104:107]
    ds_read_b64_tr_b16 a[238:239], v8 offset:44032
    v_mfma_f32_16x16x32_bf16 v[104:107], a[240:243], a[196:199], v[104:107]
    buffer_load_dwordx4 a[44:47], v15, s[20:23], s77 offen sc1
    v_mfma_f32_16x16x32_bf16 v[112:115], a[240:243], a[200:203], v[112:115]
    s_addk_i32 m0, 19712
    v_mfma_f32_16x16x32_bf16 v[112:115], a[244:247], a[216:219], v[112:115]
    s_waitcnt lgkmcnt(4)
    v_mfma_f32_16x16x32_bf16 v[120:123], a[244:247], a[220:223], v[120:123]
    v_mfma_f32_16x16x32_bf16 v[120:123], a[240:243], a[204:207], v[120:123]
    ds_read_b64_tr_b16 a[240:241], v9 offset:25600
    v_mfma_f32_16x16x32_bf16 v[124:127], a[224:227], a[204:207], v[124:127]
    ds_read_b64_tr_b16 a[242:243], v9 offset:31744
    v_mfma_f32_16x16x32_bf16 v[124:127], a[228:231], a[220:223], v[124:127]
    ds_read_b64_tr_b16 a[244:245], v9 offset:37888
    v_mfma_f32_16x16x32_bf16 v[116:119], a[228:231], a[216:219], v[116:119]
    buffer_load_dwordx4 v2, s[8:11], s36 offen offset:0 lds
    v_mfma_f32_16x16x32_bf16 v[116:119], a[224:227], a[200:203], v[116:119]
    s_addk_i32 m0, 896
    ds_read_b64_tr_b16 a[246:247], v9 offset:44032
    v_mfma_f32_16x16x32_bf16 v[108:111], a[224:227], a[196:199], v[108:111]
    v_mfma_f32_16x16x32_bf16 v[108:111], a[228:231], a[212:215], v[108:111]
    s_waitcnt lgkmcnt(4)
    v_mfma_f32_16x16x32_bf16 v[100:103], a[228:231], a[208:211], v[100:103]
    v_mfma_f32_16x16x32_bf16 v[100:103], a[224:227], a[192:195], v[100:103]
    ds_read_b64_tr_b16 a[224:225], v10 offset:25600
    v_mfma_f32_16x16x32_bf16 v[128:131], a[232:235], a[192:195], v[128:131]
    buffer_load_dwordx4 v2, s[8:11], s36 offen offset:128 lds
    v_mfma_f32_16x16x32_bf16 v[128:131], a[236:239], a[208:211], v[128:131]
    s_addk_i32 m0, 896
    ds_read_b64_tr_b16 a[226:227], v10 offset:31744
    v_mfma_f32_16x16x32_bf16 v[136:139], a[236:239], a[212:215], v[136:139]
    ds_read_b64_tr_b16 a[228:229], v10 offset:37888
    v_mfma_f32_16x16x32_bf16 v[136:139], a[232:235], a[196:199], v[136:139]
    ds_read_b64_tr_b16 a[230:231], v10 offset:44032
    v_mfma_f32_16x16x32_bf16 v[144:147], a[232:235], a[200:203], v[144:147]
    v_mfma_f32_16x16x32_bf16 v[144:147], a[236:239], a[216:219], v[144:147]
    s_waitcnt lgkmcnt(4)
    v_mfma_f32_16x16x32_bf16 v[152:155], a[236:239], a[220:223], v[152:155]
    v_mfma_f32_16x16x32_bf16 v[152:155], a[232:235], a[204:207], v[152:155]
    buffer_load_dwordx4 v2, s[8:11], s36 offen offset:256 lds
    v_mfma_f32_16x16x32_bf16 v[156:159], a[240:243], a[204:207], v[156:159]
    s_addk_i32 m0, 1280
    ds_read_b64_tr_b16 a[232:233], v11 offset:25600
    v_mfma_f32_16x16x32_bf16 v[156:159], a[244:247], a[220:223], v[156:159]
    ds_read_b64_tr_b16 a[234:235], v11 offset:31744
    v_mfma_f32_16x16x32_bf16 v[148:151], a[244:247], a[216:219], v[148:151]
    ds_read_b64_tr_b16 a[236:237], v11 offset:37888
    v_mfma_f32_16x16x32_bf16 v[148:151], a[240:243], a[200:203], v[148:151]
    ds_read_b64_tr_b16 a[238:239], v11 offset:44032
    v_mfma_f32_16x16x32_bf16 v[140:143], a[240:243], a[196:199], v[140:143]
    v_mfma_f32_16x16x32_bf16 v[140:143], a[244:247], a[212:215], v[140:143]
    buffer_load_dwordx4 v3, s[8:11], s36 offen offset:0 lds
    v_mfma_f32_16x16x32_bf16 v[132:135], a[244:247], a[208:211], v[132:135]
    s_waitcnt lgkmcnt(4)
    s_addk_i32 m0, 896
    v_mfma_f32_16x16x32_bf16 v[132:135], a[240:243], a[192:195], v[132:135]
    ds_read_b64_tr_b16 a[240:241], v8 offset:26624
    v_mfma_f32_16x16x32_bf16 v[160:163], a[224:227], a[192:195], v[160:163]
    ds_read_b64_tr_b16 a[242:243], v8 offset:32768
    v_mfma_f32_16x16x32_bf16 v[160:163], a[228:231], a[208:211], v[160:163]
    ds_read_b64_tr_b16 a[244:245], v8 offset:38912
    v_mfma_f32_16x16x32_bf16 v[168:171], a[228:231], a[212:215], v[168:171]
    ds_read_b64_tr_b16 a[246:247], v8 offset:45056
    v_mfma_f32_16x16x32_bf16 v[168:171], a[224:227], a[196:199], v[168:171]
    v_subrev_u32 v8, 98304, v8
    v_mfma_f32_16x16x32_bf16 v[176:179], a[224:227], a[200:203], v[176:179]
    buffer_load_dwordx4 v3, s[8:11], s36 offen offset:128 lds
    v_mfma_f32_16x16x32_bf16 v[176:179], a[228:231], a[216:219], v[176:179]
    s_waitcnt lgkmcnt(4)
    s_addk_i32 m0, 896
    v_mfma_f32_16x16x32_bf16 v[184:187], a[228:231], a[220:223], v[184:187]
    v_mfma_f32_16x16x32_bf16 v[184:187], a[224:227], a[204:207], v[184:187]
    ds_read_b64_tr_b16 a[224:225], v9 offset:26624
    v_mfma_f32_16x16x32_bf16 v[188:191], a[232:235], a[204:207], v[188:191]
    ds_read_b64_tr_b16 a[226:227], v9 offset:32768
    v_mfma_f32_16x16x32_bf16 v[188:191], a[236:239], a[220:223], v[188:191]
    ds_read_b64_tr_b16 a[228:229], v9 offset:38912
    v_mfma_f32_16x16x32_bf16 v[180:183], a[236:239], a[216:219], v[180:183]
    buffer_load_dwordx4 v3, s[8:11], s36 offen offset:256 lds
    v_mfma_f32_16x16x32_bf16 v[180:183], a[232:235], a[200:203], v[180:183]
    s_add_u32 s36, s36, s37
    ds_read_b64_tr_b16 a[230:231], v9 offset:45056
    s_sub_u32 s55, s36, 7864320
    v_mfma_f32_16x16x32_bf16 v[172:175], a[232:235], a[196:199], v[172:175]
    s_min_u32 s36, s36, s55
    v_subrev_u32 v9, 98304, v9
    s_add_u32 s46, s45, 45056
    v_mfma_f32_16x16x32_bf16 v[172:175], a[236:239], a[212:215], v[172:175]
    s_waitcnt lgkmcnt(4)
    s_sub_u32 s77, s46, 81920
    s_min_u32 s46, s46, s77
    v_mfma_f32_16x16x32_bf16 v[164:167], a[236:239], a[208:211], v[164:167]
    s_xor_b32 s77, s46, 1024
    v_mfma_f32_16x16x32_bf16 v[164:167], a[232:235], a[192:195], v[164:167]
    s_waitcnt vmcnt(21)
    ds_read_b64_tr_b16 a[232:233], v10 offset:26624
    v_xor_b32 v34, s7, v34
    v_mfma_f32_16x16x32_bf16 v[192:195], a[240:243], a[192:195], v[192:195]
    s_waitcnt vmcnt(18)
    ds_read_b64_tr_b16 a[234:235], v10 offset:32768
    v_xor_b32 v38, s7, v38
    v_mfma_f32_16x16x32_bf16 v[192:195], a[244:247], a[208:211], v[192:195]
    buffer_load_dwordx4 a[48:51], v14, s[20:23], s46 offen sc1
    v_mfma_f32_16x16x32_bf16 v[200:203], a[244:247], a[212:215], v[200:203]
    s_waitcnt vmcnt(16)
    ds_read_b64_tr_b16 a[236:237], v10 offset:38912
    v_xor_b32 v42, s7, v42
    v_mfma_f32_16x16x32_bf16 v[200:203], a[240:243], a[196:199], v[200:203]
    s_waitcnt vmcnt(13)
    ds_read_b64_tr_b16 a[238:239], v10 offset:45056
    v_xor_b32 v46, s7, v46
    v_mfma_f32_16x16x32_bf16 v[208:211], a[240:243], a[200:203], v[208:211]
    s_lshl_b32 s56, s3, 3
    v_or3_b32 v34, v34, v38, v42
    v_or_b32 v34, v34, v46
    v_mfma_f32_16x16x32_bf16 v[208:211], a[244:247], a[216:219], v[208:211]
    s_waitcnt lgkmcnt(4)
    v_cmp_ne_u32 vcc, 0, v34
    s_add_u32 s56, s56, 147456
    v_mfma_f32_16x16x32_bf16 v[216:219], a[244:247], a[220:223], v[216:219]
    s_cbranch_vccnz spin_rec
spin_rec_ret:
    v_max_u32 v20, v32, v33
    v_mfma_f32_16x16x32_bf16 v[216:219], a[240:243], a[204:207], v[216:219]
    ds_read_b64_tr_b16 a[240:241], v11 offset:26624
    v_min_u32 v21, v32, v33
    ds_read_b64_tr_b16 a[242:243], v11 offset:32768
    v_mfma_f32_16x16x32_bf16 v[220:223], a[224:227], a[204:207], v[220:223]
    ds_read_b64_tr_b16 a[244:245], v11 offset:38912
    v_med3_u32 v21, v20, v21, v36
    ds_read_b64_tr_b16 a[246:247], v11 offset:45056
    v_mfma_f32_16x16x32_bf16 v[220:223], a[228:231], a[220:223], v[220:223]
    buffer_load_dwordx4 a[52:55], v14, s[20:23], s77 offen sc1
    v_mfma_f32_16x16x32_bf16 v[212:215], a[228:231], a[216:219], v[212:215]
    v_max_u32 v20, v20, v36
    v_med3_u32 v21, v20, v21, v37
    v_mfma_f32_16x16x32_bf16 v[212:215], a[224:227], a[200:203], v[212:215]
    v_max_u32 v20, v20, v37
    v_med3_u32 v21, v20, v21, v40
    v_mfma_f32_16x16x32_bf16 v[204:207], a[224:227], a[196:199], v[204:207]
    v_max_u32 v20, v20, v40
    v_med3_u32 v21, v20, v21, v41
    v_mfma_f32_16x16x32_bf16 v[204:207], a[228:231], a[212:215], v[204:207]
    s_waitcnt lgkmcnt(4)
    v_max_u32 v20, v20, v41
    v_med3_u32 v21, v20, v21, v44
    v_mfma_f32_16x16x32_bf16 v[196:199], a[228:231], a[208:211], v[196:199]
    s_waitcnt lgkmcnt(0)
    s_barrier
    v_mfma_f32_16x16x32_bf16 v[196:199], a[224:227], a[192:195], v[196:199]
    buffer_load_dwordx4 a[56:59], v15, s[20:23], s46 offen sc1
    v_mfma_f32_16x16x32_bf16 v[224:227], a[232:235], a[192:195], v[224:227]
    ds_read_b64_tr_b16 a[224:225], v8 offset:0
    v_max_u32 v20, v20, v44
    v_mfma_f32_16x16x32_bf16 v[224:227], a[236:239], a[208:211], v[224:227]
    ds_read_b64_tr_b16 a[226:227], v8 offset:6144
    v_med3_u32 v21, v20, v21, v45
    v_mfma_f32_16x16x32_bf16 v[232:235], a[236:239], a[212:215], v[232:235]
    ds_read_b64_tr_b16 a[228:229], v8 offset:12288
    v_max_u32 v20, v20, v45
    v_mfma_f32_16x16x32_bf16 v[232:235], a[232:235], a[196:199], v[232:235]
    ds_read_b64_tr_b16 a[230:231], v8 offset:18432
    v_mov_b32_dpp v22, v20 row_ror:8 row_mask:0xf bank_mask:0xf
    v_mfma_f32_16x16x32_bf16 v[240:243], a[232:235], a[200:203], v[240:243]
    buffer_load_dwordx4 a[60:63], v15, s[20:23], s77 offen sc1
    v_mfma_f32_16x16x32_bf16 v[240:243], a[236:239], a[216:219], v[240:243]
    s_add_u32 s46, s45, 49152
    v_mov_b32_dpp v23, v21 row_ror:8 row_mask:0xf bank_mask:0xf
    v_min_u32 v24, v20, v22
    v_mfma_f32_16x16x32_bf16 v[248:251], a[236:239], a[220:223], v[248:251]
    s_sub_u32 s77, s46, 81920
    v_max_u32 v20, v20, v22
    v_max3_u32 v21, v24, v21, v23
    v_mfma_f32_16x16x32_bf16 v[248:251], a[232:235], a[204:207], v[248:251]
    s_min_u32 s46, s46, s77
    ds_read_b64_tr_b16 a[232:233], v9 offset:0
    v_mov_b32_dpp v22, v20 row_ror:4 row_mask:0xf bank_mask:0xf
    v_mfma_f32_16x16x32_bf16 v[252:255], a[240:243], a[204:207], v[252:255]
    s_xor_b32 s77, s46, 1024
    ds_read_b64_tr_b16 a[234:235], v9 offset:6144
    v_mov_b32_dpp v23, v21 row_ror:4 row_mask:0xf bank_mask:0xf
    v_mfma_f32_16x16x32_bf16 v[252:255], a[244:247], a[220:223], v[252:255]
    ds_read_b64_tr_b16 a[236:237], v9 offset:12288
    v_min_u32 v24, v20, v22
    v_mfma_f32_16x16x32_bf16 v[244:247], a[244:247], a[216:219], v[244:247]
    ds_read_b64_tr_b16 a[238:239], v9 offset:18432
    v_max_u32 v20, v20, v22
    v_mfma_f32_16x16x32_bf16 v[244:247], a[240:243], a[200:203], v[244:247]
    buffer_load_dwordx4 a[64:67], v14, s[20:23], s46 offen sc1
    v_mfma_f32_16x16x32_bf16 v[236:239], a[240:243], a[196:199], v[236:239]
    v_max3_u32 v21, v24, v21, v23
    v_mov_b32_dpp v22, v20 row_ror:2 row_mask:0xf bank_mask:0xf
    v_mfma_f32_16x16x32_bf16 v[236:239], a[244:247], a[212:215], v[236:239]
    s_waitcnt lgkmcnt(4)
    v_mov_b32_dpp v23, v21 row_ror:2 row_mask:0xf bank_mask:0xf
    v_min_u32 v24, v20, v22
    v_mfma_f32_16x16x32_bf16 v[228:231], a[244:247], a[208:211], v[228:231]
    v_max_u32 v20, v20, v22
    v_max3_u32 v21, v24, v21, v23
    v_mfma_f32_16x16x32_bf16 v[228:231], a[240:243], a[192:195], v[228:231]
    v_mov_b32_dpp v22, v20 row_ror:1 row_mask:0xf bank_mask:0xf
    v_mov_b32_dpp v23, v21 row_ror:1 row_mask:0xf bank_mask:0xf
    v_mfma_f32_16x16x32_bf16 v[64:67], a[224:227], a[0:3], v[64:67]
    v_min_u32 v24, v20, v22
    v_max_u32 v20, v20, v22
    v_mfma_f32_16x16x32_bf16 v[64:67], a[228:231], a[16:19], v[64:67]
    buffer_load_dwordx4 a[68:71], v14, s[20:23], s77 offen sc1
    v_mfma_f32_16x16x32_bf16 v[72:75], a[228:231], a[20:23], v[72:75]
    s_waitcnt vmcnt(17)
    v_max3_u32 v21, v24, v21, v23
    v_mov_b32 v22, v20
    v_mfma_f32_16x16x32_bf16 v[72:75], a[224:227], a[4:7], v[72:75]
    s_waitcnt vmcnt(16)
    v_permlane16_swap_b32 v20, v22
    v_mfma_f32_16x16x32_bf16 v[80:83], a[224:227], a[8:11], v[80:83]
    v_mov_b32 v23, v21
    v_min_u32 v24, v20, v22
    v_mfma_f32_16x16x32_bf16 v[80:83], a[228:231], a[24:27], v[80:83]
    s_waitcnt lgkmcnt(0)
    v_permlane16_swap_b32 v21, v23
    v_mfma_f32_16x16x32_bf16 v[88:91], a[228:231], a[28:31], v[88:91]
    v_max_u32 v20, v20, v22
    v_max3_u32 v21, v24, v21, v23
    v_subrev_u32 v10, 98304, v10
    v_mfma_f32_16x16x32_bf16 v[88:91], a[224:227], a[12:15], v[88:91]
    ds_read_b64_tr_b16 a[240:241], v10 offset:0
    v_mov_b32 v22, v20
    v_mfma_f32_16x16x32_bf16 v[92:95], a[232:235], a[12:15], v[92:95]
    ds_read_b64_tr_b16 a[242:243], v10 offset:6144
    v_mov_b32 v23, v21
    v_mfma_f32_16x16x32_bf16 v[92:95], a[236:239], a[28:31], v[92:95]
    ds_read_b64_tr_b16 a[244:245], v10 offset:12288
    v_subrev_u32 v11, 98304, v11
    v_mfma_f32_16x16x32_bf16 v[84:87], a[236:239], a[24:27], v[84:87]
    ds_read_b64_tr_b16 a[246:247], v10 offset:18432
    v_mfma_f32_16x16x32_bf16 v[84:87], a[232:235], a[8:11], v[84:87]
    buffer_load_dwordx4 a[72:75], v15, s[20:23], s46 offen sc1
    v_mfma_f32_16x16x32_bf16 v[76:79], a[232:235], a[4:7], v[76:79]
    ds_read_b64_tr_b16 a[224:225], v11 offset:0
    v_mfma_f32_16x16x32_bf16 v[76:79], a[236:239], a[20:23], v[76:79]
    ds_read_b64_tr_b16 a[226:227], v11 offset:6144
    v_mfma_f32_16x16x32_bf16 v[68:71], a[236:239], a[16:19], v[68:71]
    buffer_load_dwordx4 a[76:79], v15, s[20:23], s77 offen sc1
    v_mfma_f32_16x16x32_bf16 v[68:71], a[232:235], a[0:3], v[68:71]
    s_waitcnt lgkmcnt(4)
    ds_read_b64_tr_b16 a[228:229], v11 offset:12288
    s_addk_i32 m0, 19712
    v_mfma_f32_16x16x32_bf16 v[96:99], a[240:243], a[0:3], v[96:99]
    s_waitcnt lgkmcnt(3)
    ds_read_b64_tr_b16 a[230:231], v11 offset:18432
    v_mfma_f32_16x16x32_bf16 v[96:99], a[244:247], a[16:19], v[96:99]
    ds_read_b64_tr_b16 a[232:233], v8 offset:1024
    v_mfma_f32_16x16x32_bf16 v[104:107], a[244:247], a[20:23], v[104:107]
    ds_read_b64_tr_b16 a[234:235], v8 offset:7168
    v_mfma_f32_16x16x32_bf16 v[104:107], a[240:243], a[4:7], v[104:107]
    ds_read_b64_tr_b16 a[236:237], v8 offset:13312
    v_mfma_f32_16x16x32_bf16 v[112:115], a[240:243], a[8:11], v[112:115]
    ds_read_b64_tr_b16 a[238:239], v8 offset:19456
    v_mfma_f32_16x16x32_bf16 v[112:115], a[244:247], a[24:27], v[112:115]
    buffer_load_dwordx4 v2, s[8:11], s36 offen offset:0 lds
    v_mfma_f32_16x16x32_bf16 v[120:123], a[244:247], a[28:31], v[120:123]
    s_waitcnt lgkmcnt(5)
    v_permlane32_swap_b32 v20, v22
    v_mfma_f32_16x16x32_bf16 v[120:123], a[240:243], a[12:15], v[120:123]
    s_waitcnt lgkmcnt(4)
    ds_read_b64_tr_b16 a[240:241], v9 offset:1024
    v_min_u32 v24, v20, v22
    v_mfma_f32_16x16x32_bf16 v[124:127], a[224:227], a[12:15], v[124:127]
    s_addk_i32 m0, 896
    ds_read_b64_tr_b16 a[242:243], v9 offset:7168
    v_max_u32 v20, v20, v22
    v_mfma_f32_16x16x32_bf16 v[124:127], a[228:231], a[28:31], v[124:127]
    ds_read_b64_tr_b16 a[244:245], v9 offset:13312
    v_mov_b32 v22, s56
    v_mfma_f32_16x16x32_bf16 v[116:119], a[228:231], a[24:27], v[116:119]
    ds_read_b64_tr_b16 a[246:247], v9 offset:19456
    v_mfma_f32_16x16x32_bf16 v[116:119], a[224:227], a[8:11], v[116:119]
    buffer_load_dwordx4 v2, s[8:11], s36 offen offset:128 lds
    v_mfma_f32_16x16x32_bf16 v[108:111], a[224:227], a[4:7], v[108:111]
    s_addk_i32 m0, 896
    v_permlane32_swap_b32 v21, v23
    v_mfma_f32_16x16x32_bf16 v[108:111], a[228:231], a[20:23], v[108:111]
    s_waitcnt lgkmcnt(4)
    v_max3_u32 v21, v24, v21, v23
    v_mov_b32 v23, 147456
    v_mfma_f32_16x16x32_bf16 v[100:103], a[228:231], a[16:19], v[100:103]
    ds_write_b64 v22, v[20:21]
    v_mfma_f32_16x16x32_bf16 v[100:103], a[224:227], a[0:3], v[100:103]
    ds_read_b64_tr_b16 a[224:225], v10 offset:1024
    v_mfma_f32_16x16x32_bf16 v[128:131], a[232:235], a[0:3], v[128:131]
    ds_read_b64_tr_b16 a[226:227], v10 offset:7168
    v_mfma_f32_16x16x32_bf16 v[128:131], a[236:239], a[16:19], v[128:131]
    ds_read_b64_tr_b16 a[228:229], v10 offset:13312
    v_mfma_f32_16x16x32_bf16 v[136:139], a[236:239], a[20:23], v[136:139]
    buffer_load_dwordx4 v2, s[8:11], s36 offen offset:256 lds
    v_mfma_f32_16x16x32_bf16 v[136:139], a[232:235], a[4:7], v[136:139]
    s_addk_i32 m0, 1280
    ds_read_b64_tr_b16 a[230:231], v10 offset:19456
    v_mfma_f32_16x16x32_bf16 v[144:147], a[232:235], a[8:11], v[144:147]
pg_2:
    s_cbranch_execz pg_6
    v_mfma_f32_16x16x32_bf16 v[144:147], a[236:239], a[24:27], v[144:147]
    s_waitcnt lgkmcnt(4)
    v_mfma_f32_16x16x32_bf16 v[152:155], a[236:239], a[28:31], v[152:155]
    v_mfma_f32_16x16x32_bf16 v[152:155], a[232:235], a[12:15], v[152:155]
    ds_read_b64_tr_b16 a[232:233], v11 offset:1024
    v_mfma_f32_16x16x32_bf16 v[156:159], a[240:243], a[12:15], v[156:159]
    buffer_load_dwordx4 v3, s[8:11], s36 offen offset:0 lds
    v_mfma_f32_16x16x32_bf16 v[156:159], a[244:247], a[28:31], v[156:159]
    s_addk_i32 m0, 896
    ds_read_b64_tr_b16 a[234:235], v11 offset:7168
    v_mfma_f32_16x16x32_bf16 v[148:151], a[244:247], a[24:27], v[148:151]
    ds_read_b64_tr_b16 a[236:237], v11 offset:13312
    v_mfma_f32_16x16x32_bf16 v[148:151], a[240:243], a[8:11], v[148:151]
    ds_read_b64_tr_b16 a[238:239], v11 offset:19456
    v_mfma_f32_16x16x32_bf16 v[140:143], a[240:243], a[4:7], v[140:143]
    v_mfma_f32_16x16x32_bf16 v[140:143], a[244:247], a[20:23], v[140:143]
    s_waitcnt lgkmcnt(4)
    v_mfma_f32_16x16x32_bf16 v[132:135], a[244:247], a[16:19], v[132:135]
    v_mfma_f32_16x16x32_bf16 v[132:135], a[240:243], a[0:3], v[132:135]
    buffer_load_dwordx4 v3, s[8:11], s36 offen offset:128 lds
    v_mfma_f32_16x16x32_bf16 v[160:163], a[224:227], a[0:3], v[160:163]
    s_addk_i32 m0, 896
    ds_read_b64_tr_b16 a[240:241], v8 offset:2048
    v_mfma_f32_16x16x32_bf16 v[160:163], a[228:231], a[16:19], v[160:163]
    ds_read_b64_tr_b16 a[242:243], v8 offset:8192
    v_mfma_f32_16x16x32_bf16 v[168:171], a[228:231], a[20:23], v[168:171]
    ds_read_b64_tr_b16 a[244:245], v8 offset:14336
    v_mfma_f32_16x16x32_bf16 v[168:171], a[224:227], a[4:7], v[168:171]
    ds_read_b64_tr_b16 a[246:247], v8 offset:20480
    v_mfma_f32_16x16x32_bf16 v[176:179], a[224:227], a[8:11], v[176:179]
    v_mfma_f32_16x16x32_bf16 v[176:179], a[228:231], a[24:27], v[176:179]
    buffer_load_dwordx4 v3, s[8:11], s36 offen offset:256 lds
    v_mfma_f32_16x16x32_bf16 v[184:187], a[228:231], a[28:31], v[184:187]
    s_waitcnt lgkmcnt(4)
    s_add_u32 s36, s36, s37
    s_sub_u32 s55, s36, 7864320
    v_mfma_f32_16x16x32_bf16 v[184:187], a[224:227], a[12:15], v[184:187]
    s_min_u32 s36, s36, s55
    ds_read_b64_tr_b16 a[224:225], v9 offset:2048
    s_add_u32 s46, s45, 53248
    v_mfma_f32_16x16x32_bf16 v[188:191], a[232:235], a[12:15], v[188:191]
    s_sub_u32 s77, s46, 81920
    ds_read_b64_tr_b16 a[226:227], v9 offset:8192
    s_min_u32 s46, s46, s77
    v_mfma_f32_16x16x32_bf16 v[188:191], a[236:239], a[28:31], v[188:191]
    s_xor_b32 s77, s46, 1024
    ds_read_b64_tr_b16 a[228:229], v9 offset:14336
    v_mfma_f32_16x16x32_bf16 v[180:183], a[236:239], a[24:27], v[180:183]
    ds_read_b64_tr_b16 a[230:231], v9 offset:20480
    v_mfma_f32_16x16x32_bf16 v[180:183], a[232:235], a[8:11], v[180:183]
    v_mfma_f32_16x16x32_bf16 v[172:175], a[232:235], a[4:7], v[172:175]
    buffer_load_dwordx4 a[80:83], v14, s[20:23], s46 offen sc1
    v_mfma_f32_16x16x32_bf16 v[172:175], a[236:239], a[20:23], v[172:175]
    s_waitcnt lgkmcnt(4)
    v_mfma_f32_16x16x32_bf16 v[164:167], a[236:239], a[16:19], v[164:167]
    v_mfma_f32_16x16x32_bf16 v[164:167], a[232:235], a[0:3], v[164:167]
    ds_read_b64_tr_b16 a[232:233], v10 offset:2048
    v_mfma_f32_16x16x32_bf16 v[192:195], a[240:243], a[0:3], v[192:195]
    ds_read_b64_tr_b16 a[234:235], v10 offset:8192
    v_mfma_f32_16x16x32_bf16 v[192:195], a[244:247], a[16:19], v[192:195]
    ds_read_b64_tr_b16 a[236:237], v10 offset:14336
    v_mfma_f32_16x16x32_bf16 v[200:203], a[244:247], a[20:23], v[200:203]
    buffer_load_dwordx4 a[84:87], v14, s[20:23], s77 offen sc1
    v_mfma_f32_16x16x32_bf16 v[200:203], a[240:243], a[4:7], v[200:203]
    ds_read_b64_tr_b16 a[238:239], v10 offset:20480
    v_mfma_f32_16x16x32_bf16 v[208:211], a[240:243], a[8:11], v[208:211]
    v_mfma_f32_16x16x32_bf16 v[208:211], a[244:247], a[24:27], v[208:211]
    s_waitcnt lgkmcnt(4)
    v_mfma_f32_16x16x32_bf16 v[216:219], a[244:247], a[28:31], v[216:219]
    v_mfma_f32_16x16x32_bf16 v[216:219], a[240:243], a[12:15], v[216:219]
    ds_read_b64_tr_b16 a[240:241], v11 offset:2048
    ds_read_b64_tr_b16 a[242:243], v11 offset:8192
    ds_read_b64_tr_b16 a[244:245], v11 offset:14336
    v_mfma_f32_16x16x32_bf16 v[220:223], a[224:227], a[12:15], v[220:223]
    ds_read_b64_tr_b16 a[246:247], v11 offset:20480
    v_mfma_f32_16x16x32_bf16 v[220:223], a[228:231], a[28:31], v[220:223]
    buffer_load_dwordx4 a[88:91], v15, s[20:23], s46 offen sc1
    v_mfma_f32_16x16x32_bf16 v[212:215], a[228:231], a[24:27], v[212:215]
    v_mfma_f32_16x16x32_bf16 v[212:215], a[224:227], a[8:11], v[212:215]
    v_mfma_f32_16x16x32_bf16 v[204:207], a[224:227], a[4:7], v[204:207]
    v_mfma_f32_16x16x32_bf16 v[204:207], a[228:231], a[20:23], v[204:207]
    s_waitcnt lgkmcnt(4)
    v_mfma_f32_16x16x32_bf16 v[196:199], a[228:231], a[16:19], v[196:199]
    s_waitcnt lgkmcnt(0)
    s_barrier
    v_mfma_f32_16x16x32_bf16 v[196:199], a[224:227], a[0:3], v[196:199]
    buffer_load_dwordx4 a[92:95], v15, s[20:23], s77 offen sc1
    v_mfma_f32_16x16x32_bf16 v[224:227], a[232:235], a[0:3], v[224:227]
    s_add_u32 s46, s45, 57344
    ds_read_b128 v[32:35], v23 offset:0
    v_and_b32 v22, 1, v1
    v_mfma_f32_16x16x32_bf16 v[224:227], a[236:239], a[16:19], v[224:227]
    s_sub_u32 s77, s46, 81920
    ds_read_b128 v[36:39], v23 offset:16
    v_cmp_eq_u32 vcc, 1, v22
    v_mfma_f32_16x16x32_bf16 v[232:235], a[236:239], a[20:23], v[232:235]
    s_min_u32 s46, s46, s77
    ds_read_b64_tr_b16 a[224:225], v8 offset:24576
    v_lshrrev_b32 v24, 4, v1
    v_mfma_f32_16x16x32_bf16 v[232:235], a[232:235], a[4:7], v[232:235]
    s_xor_b32 s77, s46, 1024
    ds_read_b64_tr_b16 a[226:227], v8 offset:30720
    v_bfe_u32 v26, v1, 2, 3
    v_mfma_f32_16x16x32_bf16 v[240:243], a[232:235], a[8:11], v[240:243]
    ds_read_b64_tr_b16 a[228:229], v8 offset:36864
    v_lshlrev_b32 v25, 7, v26
    v_mfma_f32_16x16x32_bf16 v[240:243], a[236:239], a[24:27], v[240:243]
    ds_read_b64_tr_b16 a[230:231], v8 offset:43008
    v_lshrrev_b32 v26, 1, v26
    v_mfma_f32_16x16x32_bf16 v[248:251], a[236:239], a[28:31], v[248:251]
    buffer_load_dwordx4 a[160:163], v14, s[20:23], s46 offen sc1
    v_mfma_f32_16x16x32_bf16 v[248:251], a[232:235], a[12:15], v[248:251]
    s_waitcnt lgkmcnt(5)
    ds_read_b64_tr_b16 a[232:233], v9 offset:24576
    v_max_u32 v20, v32, v33
    v_mfma_f32_16x16x32_bf16 v[252:255], a[240:243], a[12:15], v[252:255]
    ds_read_b64_tr_b16 a[234:235], v9 offset:30720
    v_min_u32 v21, v32, v33
    v_mfma_f32_16x16x32_bf16 v[252:255], a[244:247], a[28:31], v[252:255]
    ds_read_b64_tr_b16 a[236:237], v9 offset:36864
    v_med3_u32 v21, v20, v21, v34
    v_mfma_f32_16x16x32_bf16 v[244:247], a[244:247], a[24:27], v[244:247]
    ds_read_b64_tr_b16 a[238:239], v9 offset:43008
    v_max_u32 v20, v20, v34
    v_mfma_f32_16x16x32_bf16 v[244:247], a[240:243], a[8:11], v[244:247]
    v_med3_u32 v21, v20, v21, v35
    v_max_u32 v20, v20, v35
    v_mfma_f32_16x16x32_bf16 v[236:239], a[240:243], a[4:7], v[236:239]
    buffer_load_dwordx4 a[164:167], v14, s[20:23], s77 offen sc1
    v_mfma_f32_16x16x32_bf16 v[236:239], a[244:247], a[20:23], v[236:239]
    s_waitcnt vmcnt(29) lgkmcnt(4)
    v_med3_u32 v21, v20, v21, v36
    v_max_u32 v20, v20, v36
    v_mfma_f32_16x16x32_bf16 v[228:231], a[244:247], a[16:19], v[228:231]
    s_waitcnt vmcnt(19)
    v_med3_u32 v21, v20, v21, v37
    v_max_u32 v20, v20, v37
    v_mfma_f32_16x16x32_bf16 v[228:231], a[240:243], a[0:3], v[228:231]
    s_waitcnt vmcnt(18)
    ds_read_b64_tr_b16 a[240:241], v10 offset:24576
    v_med3_u32 v21, v20, v21, v38
    v_mfma_f32_16x16x32_bf16 v[64:67], a[224:227], a[32:35], v[64:67]
    ds_read_b64_tr_b16 a[242:243], v10 offset:30720
    v_max_u32 v20, v20, v38
    v_mfma_f32_16x16x32_bf16 v[64:67], a[228:231], a[48:51], v[64:67]
    ds_read_b64_tr_b16 a[244:245], v10 offset:36864
    v_med3_u32 v21, v20, v21, v39
    v_mfma_f32_16x16x32_bf16 v[72:75], a[228:231], a[52:55], v[72:75]
    s_waitcnt vmcnt(17)
    ds_read_b64_tr_b16 a[246:247], v10 offset:43008
    v_max_u32 v20, v20, v39
    v_mfma_f32_16x16x32_bf16 v[72:75], a[224:227], a[36:39], v[72:75]
    buffer_load_dwordx4 a[168:171], v15, s[20:23], s46 offen sc1
    v_mfma_f32_16x16x32_bf16 v[80:83], a[224:227], a[40:43], v[80:83]
    s_waitcnt vmcnt(17)
    v_readfirstlane_b32 s70, v20
    v_readfirstlane_b32 s71, v21
    v_mfma_f32_16x16x32_bf16 v[80:83], a[228:231], a[56:59], v[80:83]
    s_waitcnt lgkmcnt(4)
    v_cndmask_b32 v22, v20, v21, vcc
    v_and_b32 v22, 0x7ff, v22
    v_mfma_f32_16x16x32_bf16 v[88:91], a[228:231], a[60:63], v[88:91]
    v_sub_u32 v22, 2047, v22
    v_mul_u32_u24 v23, 1280, v22
    v_mfma_f32_16x16x32_bf16 v[88:91], a[224:227], a[44:47], v[88:91]
    ds_read_b64_tr_b16 a[224:225], v11 offset:24576
    v_lshl_add_u32 v23, v24, 4, v23
    v_mfma_f32_16x16x32_bf16 v[92:95], a[232:235], a[44:47], v[92:95]
    ds_read_b64_tr_b16 a[226:227], v11 offset:30720
    v_add_u32 v23, s61, v23
    v_mfma_f32_16x16x32_bf16 v[92:95], a[236:239], a[60:63], v[92:95]
    buffer_load_dwordx4 a[172:175], v15, s[20:23], s77 offen sc1
    v_mfma_f32_16x16x32_bf16 v[84:87], a[236:239], a[56:59], v[84:87]
    s_addk_i32 m0, 19712
    ds_read_b64_tr_b16 a[228:229], v11 offset:36864
    v_lshlrev_b32 v24, 3, v22
    v_mfma_f32_16x16x32_bf16 v[84:87], a[232:235], a[40:43], v[84:87]
    ds_read_b64_tr_b16 a[230:231], v11 offset:43008
    v_add_u32 v24, 3211264, v24
    v_mfma_f32_16x16x32_bf16 v[76:79], a[232:235], a[36:39], v[76:79]
    v_xor_b32 v26, s3, v26
    v_lshl_add_u32 v25, v26, 5, v25
    v_mfma_f32_16x16x32_bf16 v[76:79], a[236:239], a[52:55], v[76:79]
    s_waitcnt lgkmcnt(4)
    v_and_b32 v26, 3, v1
    v_lshl_add_u32 v25, v26, 3, v25
    v_mfma_f32_16x16x32_bf16 v[68:71], a[236:239], a[48:51], v[68:71]
    v_lshrrev_b32 v26, 5, v1
    v_mul_u32_u24 v26, 2048, v26
    v_mfma_f32_16x16x32_bf16 v[68:71], a[232:235], a[32:35], v[68:71]
    ds_read_b64_tr_b16 a[232:233], v8 offset:25600
    v_add_u32 v25, v25, v26
    v_mfma_f32_16x16x32_bf16 v[96:99], a[240:243], a[32:35], v[96:99]
    buffer_load_dwordx4 v2, s[8:11], s36 offen offset:0 lds
    v_mfma_f32_16x16x32_bf16 v[96:99], a[244:247], a[48:51], v[96:99]
    s_addk_i32 m0, 896
    ds_read_b64_tr_b16 a[234:235], v8 offset:31744
    v_add_u32 v25, 147456, v25
    v_mfma_f32_16x16x32_bf16 v[104:107], a[244:247], a[52:55], v[104:107]
    ds_read_b64_tr_b16 a[236:237], v8 offset:37888
    v_lshlrev_b32 v26, 4, v1
    v_mfma_f32_16x16x32_bf16 v[104:107], a[240:243], a[36:39], v[104:107]
    ds_read_b64_tr_b16 a[238:239], v8 offset:44032
    v_cmp_gt_u32 vcc, 16, v1
    v_mfma_f32_16x16x32_bf16 v[112:115], a[240:243], a[40:43], v[112:115]
    v_mov_b32 v27, 0x7ffffff0
    v_cndmask_b32 v26, v27, v26, vcc
    v_mfma_f32_16x16x32_bf16 v[112:115], a[244:247], a[56:59], v[112:115]
    s_waitcnt lgkmcnt(4)
    v_min_u32 v27, 1, v1
    v_mfma_f32_16x16x32_bf16 v[120:123], a[244:247], a[60:63], v[120:123]
    buffer_load_dwordx4 v2, s[8:11], s36 offen offset:128 lds
    v_mfma_f32_16x16x32_bf16 v[120:123], a[240:243], a[44:47], v[120:123]
    s_addk_i32 m0, 896
    ds_read_b64_tr_b16 a[240:241], v9 offset:25600
    v_mfma_f32_16x16x32_bf16 v[124:127], a[224:227], a[44:47], v[124:127]
    ds_read_b64_tr_b16 a[242:243], v9 offset:31744
    v_mfma_f32_16x16x32_bf16 v[124:127], a[228:231], a[60:63], v[124:127]
    ds_read_b64_tr_b16 a[244:245], v9 offset:37888
    v_mfma_f32_16x16x32_bf16 v[116:119], a[228:231], a[56:59], v[116:119]
    ds_read_b64_tr_b16 a[246:247], v9 offset:44032
    v_mfma_f32_16x16x32_bf16 v[116:119], a[224:227], a[40:43], v[116:119]
    v_lshlrev_b32 v27, 30, v27
    v_mfma_f32_16x16x32_bf16 v[108:111], a[224:227], a[36:39], v[108:111]
    v_mfma_f32_16x16x32_bf16 v[108:111], a[228:231], a[52:55], v[108:111]
    buffer_load_dwordx4 v2, s[8:11], s36 offen offset:256 lds
    v_mfma_f32_16x16x32_bf16 v[100:103], a[228:231], a[48:51], v[100:103]
    s_waitcnt lgkmcnt(3)
    s_addk_i32 m0, 1280
    v_mfma_f32_16x16x32_bf16 v[100:103], a[224:227], a[32:35], v[100:103]
    ds_read_b64_tr_b16 a[224:225], v10 offset:25600
    v_mfma_f32_16x16x32_bf16 v[128:131], a[232:235], a[32:35], v[128:131]
    ds_read_b64_tr_b16 a[226:227], v10 offset:31744
    v_mfma_f32_16x16x32_bf16 v[128:131], a[236:239], a[48:51], v[128:131]
    ds_read_b64_tr_b16 a[228:229], v10 offset:37888
    v_mfma_f32_16x16x32_bf16 v[136:139], a[236:239], a[52:55], v[136:139]
    ds_read_b64_tr_b16 a[230:231], v10 offset:44032
    v_mfma_f32_16x16x32_bf16 v[136:139], a[232:235], a[36:39], v[136:139]
    buffer_load_dwordx4 v3, s[8:11], s36 offen offset:0 lds
    v_mfma_f32_16x16x32_bf16 v[144:147], a[232:235], a[40:43], v[144:147]
    s_addk_i32 m0, 896
    v_mfma_f32_16x16x32_bf16 v[144:147], a[236:239], a[56:59], v[144:147]
    s_waitcnt lgkmcnt(4)
    v_mfma_f32_16x16x32_bf16 v[152:155], a[236:239], a[60:63], v[152:155]
    v_mfma_f32_16x16x32_bf16 v[152:155], a[232:235], a[44:47], v[152:155]
    ds_read_b64_tr_b16 a[232:233], v11 offset:25600
    v_mfma_f32_16x16x32_bf16 v[156:159], a[240:243], a[44:47], v[156:159]
    ds_read_b64_tr_b16 a[234:235], v11 offset:31744
    v_mfma_f32_16x16x32_bf16 v[156:159], a[244:247], a[60:63], v[156:159]
    ds_read_b64_tr_b16 a[236:237], v11 offset:37888
    v_mfma_f32_16x16x32_bf16 v[148:151], a[244:247], a[56:59], v[148:151]
    buffer_load_dwordx4 v3, s[8:11], s36 offen offset:128 lds
    v_mfma_f32_16x16x32_bf16 v[148:151], a[240:243], a[40:43], v[148:151]
    s_addk_i32 m0, 896
    ds_read_b64_tr_b16 a[238:239], v11 offset:44032
    v_mfma_f32_16x16x32_bf16 v[140:143], a[240:243], a[36:39], v[140:143]
    v_mfma_f32_16x16x32_bf16 v[140:143], a[244:247], a[52:55], v[140:143]
    s_waitcnt lgkmcnt(4)
    v_mfma_f32_16x16x32_bf16 v[132:135], a[244:247], a[48:51], v[132:135]
    v_mfma_f32_16x16x32_bf16 v[132:135], a[240:243], a[32:35], v[132:135]
    ds_read_b64_tr_b16 a[240:241], v8 offset:26624
    v_mfma_f32_16x16x32_bf16 v[160:163], a[224:227], a[32:35], v[160:163]
    buffer_load_dwordx4 v3, s[8:11], s36 offen offset:256 lds
    v_mfma_f32_16x16x32_bf16 v[160:163], a[228:231], a[48:51], v[160:163]
    s_add_u32 s36, s36, s37
    ds_read_b64_tr_b16 a[242:243], v8 offset:32768
    s_sub_u32 s55, s36, 7864320
    v_mfma_f32_16x16x32_bf16 v[168:171], a[228:231], a[52:55], v[168:171]
    global_load_dwordx4 v[48:51], v23, s[64:65]
    v_mfma_f32_16x16x32_bf16 v[168:171], a[224:227], a[36:39], v[168:171]
    global_load_dwordx4 v[52:55], v23, s[64:65] offset:64
    v_mfma_f32_16x16x32_bf16 v[176:179], a[224:227], a[40:43], v[176:179]
    buffer_load_dwordx2 v[40:41], v24, s[24:27], 0 offen sc1
    v_mfma_f32_16x16x32_bf16 v[176:179], a[228:231], a[56:59], v[176:179]
    s_waitcnt lgkmcnt(2)
    ds_read_b64_tr_b16 a[244:245], v8 offset:38912
    s_min_u32 s36, s36, s55
    v_mfma_f32_16x16x32_bf16 v[184:187], a[228:231], a[60:63], v[184:187]
    s_add_u32 s46, s45, 61440
    ds_read_b64_tr_b16 a[246:247], v8 offset:45056
    s_sub_u32 s77, s46, 81920
    v_mfma_f32_16x16x32_bf16 v[184:187], a[224:227], a[44:47], v[184:187]
    s_min_u32 s46, s46, s77
    ds_read_b64_tr_b16 a[224:225], v9 offset:26624
    s_xor_b32 s77, s46, 1024
    v_mfma_f32_16x16x32_bf16 v[188:191], a[232:235], a[44:47], v[188:191]
    buffer_load_dwordx4 a[176:179], v14, s[20:23], s46 offen sc1
    v_mfma_f32_16x16x32_bf16 v[188:191], a[236:239], a[60:63], v[188:191]
    ds_read_b64_tr_b16 a[226:227], v9 offset:32768
    v_mfma_f32_16x16x32_bf16 v[180:183], a[236:239], a[56:59], v[180:183]
    ds_read_b64_tr_b16 a[228:229], v9 offset:38912
    v_mfma_f32_16x16x32_bf16 v[180:183], a[232:235], a[40:43], v[180:183]
    ds_read_b64_tr_b16 a[230:231], v9 offset:45056
    v_mfma_f32_16x16x32_bf16 v[172:175], a[232:235], a[36:39], v[172:175]
    v_add_u32 v8, 49152, v8
    v_mfma_f32_16x16x32_bf16 v[172:175], a[236:239], a[52:55], v[172:175]
    buffer_load_dwordx4 a[180:183], v14, s[20:23], s77 offen sc1
    v_mfma_f32_16x16x32_bf16 v[164:167], a[236:239], a[48:51], v[164:167]
    s_waitcnt lgkmcnt(3)
    v_add_u32 v9, 49152, v9
    v_mfma_f32_16x16x32_bf16 v[164:167], a[232:235], a[32:35], v[164:167]
    ds_read_b64_tr_b16 a[232:233], v10 offset:26624
    v_mfma_f32_16x16x32_bf16 v[192:195], a[240:243], a[32:35], v[192:195]
    ds_read_b64_tr_b16 a[234:235], v10 offset:32768
    v_mfma_f32_16x16x32_bf16 v[192:195], a[244:247], a[48:51], v[192:195]
    ds_read_b64_tr_b16 a[236:237], v10 offset:38912
    v_mfma_f32_16x16x32_bf16 v[200:203], a[244:247], a[52:55], v[200:203]
    ds_read_b64_tr_b16 a[238:239], v10 offset:45056
    v_mfma_f32_16x16x32_bf16 v[200:203], a[240:243], a[36:39], v[200:203]
    v_add_u32 v10, 49152, v10
    v_mfma_f32_16x16x32_bf16 v[208:211], a[240:243], a[40:43], v[208:211]
    buffer_load_dwordx4 a[184:187], v15, s[20:23], s46 offen sc1
    v_mfma_f32_16x16x32_bf16 v[208:211], a[244:247], a[56:59], v[208:211]
    s_waitcnt lgkmcnt(4)
    v_mfma_f32_16x16x32_bf16 v[216:219], a[244:247], a[60:63], v[216:219]
    v_mfma_f32_16x16x32_bf16 v[216:219], a[240:243], a[44:47], v[216:219]
    ds_read_b64_tr_b16 a[240:241], v11 offset:26624
    ds_read_b64_tr_b16 a[242:243], v11 offset:32768
    ds_read_b64_tr_b16 a[244:245], v11 offset:38912
    v_mfma_f32_16x16x32_bf16 v[220:223], a[224:227], a[44:47], v[220:223]
    ds_read_b64_tr_b16 a[246:247], v11 offset:45056
    v_mfma_f32_16x16x32_bf16 v[220:223], a[228:231], a[60:63], v[220:223]
    v_add_u32 v11, 49152, v11
    v_mfma_f32_16x16x32_bf16 v[212:215], a[228:231], a[56:59], v[212:215]
    buffer_load_dwordx4 a[188:191], v15, s[20:23], s77 offen sc1
    v_mfma_f32_16x16x32_bf16 v[212:215], a[224:227], a[40:43], v[212:215]
    s_add_u32 m0, s44, 147456
    v_mfma_f32_16x16x32_bf16 v[204:207], a[224:227], a[36:39], v[204:207]
    v_mfma_f32_16x16x32_bf16 v[204:207], a[228:231], a[52:55], v[204:207]
    s_waitcnt lgkmcnt(4)
    v_mfma_f32_16x16x32_bf16 v[196:199], a[228:231], a[48:51], v[196:199]
    s_waitcnt lgkmcnt(0)
    s_barrier
    v_mfma_f32_16x16x32_bf16 v[196:199], a[224:227], a[32:35], v[196:199]
    ds_read_b64_tr_b16 a[224:225], v8 offset:0
    v_mfma_f32_16x16x32_bf16 v[224:227], a[232:235], a[32:35], v[224:227]
    ds_read_b64_tr_b16 a[226:227], v8 offset:6144
    v_mfma_f32_16x16x32_bf16 v[224:227], a[236:239], a[48:51], v[224:227]
    buffer_load_dwordx4 v56, s[28:31], s60 offen lds
    v_mfma_f32_16x16x32_bf16 v[232:235], a[236:239], a[52:55], v[232:235]
    s_addk_i32 m0, 1024
    ds_read_b64_tr_b16 a[228:229], v8 offset:12288
    v_mfma_f32_16x16x32_bf16 v[232:235], a[232:235], a[36:39], v[232:235]
    ds_read_b64_tr_b16 a[230:231], v8 offset:18432
    v_mfma_f32_16x16x32_bf16 v[240:243], a[232:235], a[40:43], v[240:243]
    v_mfma_f32_16x16x32_bf16 v[240:243], a[236:239], a[56:59], v[240:243]
    v_mfma_f32_16x16x32_bf16 v[248:251], a[236:239], a[60:63], v[248:251]
    v_mfma_f32_16x16x32_bf16 v[248:251], a[232:235], a[44:47], v[248:251]
    buffer_load_dwordx4 v56, s[32:35], s60 offen lds
    v_mfma_f32_16x16x32_bf16 v[252:255], a[240:243], a[44:47], v[252:255]
    s_addk_i32 m0, 1024
    ds_read_b64_tr_b16 a[232:233], v9 offset:0
    v_mfma_f32_16x16x32_bf16 v[252:255], a[244:247], a[60:63], v[252:255]
    ds_read_b64_tr_b16 a[234:235], v9 offset:6144
    v_mfma_f32_16x16x32_bf16 v[244:247], a[244:247], a[56:59], v[244:247]
    ds_read_b64_tr_b16 a[236:237], v9 offset:12288
    v_mfma_f32_16x16x32_bf16 v[244:247], a[240:243], a[40:43], v[244:247]
    ds_read_b64_tr_b16 a[238:239], v9 offset:18432
    v_mfma_f32_16x16x32_bf16 v[236:239], a[240:243], a[36:39], v[236:239]
    v_mfma_f32_16x16x32_bf16 v[236:239], a[244:247], a[52:55], v[236:239]
    s_waitcnt vmcnt(32) lgkmcnt(4)
    v_mfma_f32_16x16x32_bf16 v[228:231], a[244:247], a[48:51], v[228:231]
    buffer_load_dwordx4 v57, s[28:31], s60 offen lds
    v_mfma_f32_16x16x32_bf16 v[228:231], a[240:243], a[32:35], v[228:231]
    s_waitcnt vmcnt(22)
    ds_read_b64_tr_b16 a[240:241], v10 offset:0
    s_addk_i32 m0, 1024
    v_mfma_f32_16x16x32_bf16 v[64:67], a[224:227], a[64:67], v[64:67]
    ds_read_b64_tr_b16 a[242:243], v10 offset:6144
    v_mfma_f32_16x16x32_bf16 v[64:67], a[228:231], a[80:83], v[64:67]
    ds_read_b64_tr_b16 a[244:245], v10 offset:12288
    v_mfma_f32_16x16x32_bf16 v[72:75], a[228:231], a[84:87], v[72:75]
    s_waitcnt vmcnt(21)
    ds_read_b64_tr_b16 a[246:247], v10 offset:18432
    v_mfma_f32_16x16x32_bf16 v[72:75], a[224:227], a[68:71], v[72:75]
    s_waitcnt vmcnt(20)
    v_mfma_f32_16x16x32_bf16 v[80:83], a[224:227], a[72:75], v[80:83]
    buffer_load_dwordx4 v57, s[32:35], s60 offen lds
    v_mfma_f32_16x16x32_bf16 v[80:83], a[228:231], a[88:91], v[80:83]
    s_waitcnt lgkmcnt(4)
    s_add_u32 s46, s45, 65536
    s_sub_u32 s77, s46, 81920
    v_mfma_f32_16x16x32_bf16 v[88:91], a[228:231], a[92:95], v[88:91]
    s_min_u32 s46, s46, s77
    s_xor_b32 s77, s46, 1024
    v_mfma_f32_16x16x32_bf16 v[88:91], a[224:227], a[76:79], v[88:91]
    ds_read_b64_tr_b16 a[224:225], v11 offset:0
    v_mfma_f32_16x16x32_bf16 v[92:95], a[232:235], a[76:79], v[92:95]
    ds_read_b64_tr_b16 a[226:227], v11 offset:6144
    v_mfma_f32_16x16x32_bf16 v[92:95], a[236:239], a[92:95], v[92:95]
    ds_read_b64_tr_b16 a[228:229], v11 offset:12288
    v_mfma_f32_16x16x32_bf16 v[84:87], a[236:239], a[88:91], v[84:87]
    ds_read_b64_tr_b16 a[230:231], v11 offset:18432
    v_mfma_f32_16x16x32_bf16 v[84:87], a[232:235], a[72:75], v[84:87]
    buffer_load_dwordx4 a[96:99], v14, s[20:23], s46 offen sc1
    v_mfma_f32_16x16x32_bf16 v[76:79], a[232:235], a[68:71], v[76:79]
    v_mfma_f32_16x16x32_bf16 v[76:79], a[236:239], a[84:87], v[76:79]
    s_waitcnt lgkmcnt(4)
    v_mfma_f32_16x16x32_bf16 v[68:71], a[236:239], a[80:83], v[68:71]
    v_mfma_f32_16x16x32_bf16 v[68:71], a[232:235], a[64:67], v[68:71]
    ds_read_b64_tr_b16 a[232:233], v8 offset:1024
    v_mfma_f32_16x16x32_bf16 v[96:99], a[240:243], a[64:67], v[96:99]
    ds_read_b64_tr_b16 a[234:235], v8 offset:7168
    v_mfma_f32_16x16x32_bf16 v[96:99], a[244:247], a[80:83], v[96:99]
    buffer_load_dwordx4 a[100:103], v14, s[20:23], s77 offen sc1
    v_mfma_f32_16x16x32_bf16 v[104:107], a[244:247], a[84:87], v[104:107]
    ds_read_b64_tr_b16 a[236:237], v8 offset:13312
    v_mfma_f32_16x16x32_bf16 v[104:107], a[240:243], a[68:71], v[104:107]
    ds_read_b64_tr_b16 a[238:239], v8 offset:19456
    v_mfma_f32_16x16x32_bf16 v[112:115], a[240:243], a[72:75], v[112:115]
    s_add_u32 s88, s88, 32768
    s_addc_u32 s89, s89, 0
    v_mfma_f32_16x16x32_bf16 v[112:115], a[244:247], a[88:91], v[112:115]
    s_waitcnt lgkmcnt(4)
    v_mfma_f32_16x16x32_bf16 v[120:123], a[244:247], a[92:95], v[120:123]
    v_mfma_f32_16x16x32_bf16 v[120:123], a[240:243], a[76:79], v[120:123]
    ds_read_b64_tr_b16 a[240:241], v9 offset:1024
    v_mfma_f32_16x16x32_bf16 v[124:127], a[224:227], a[76:79], v[124:127]
    global_load_dword a252, v18, s[88:89]
    v_mfma_f32_16x16x32_bf16 v[124:127], a[228:231], a[92:95], v[124:127]
    buffer_load_dwordx4 a[104:107], v15, s[20:23], s46 offen sc1
    v_mfma_f32_16x16x32_bf16 v[116:119], a[228:231], a[88:91], v[116:119]
    ds_read_b64_tr_b16 a[242:243], v9 offset:7168
    v_mfma_f32_16x16x32_bf16 v[116:119], a[224:227], a[72:75], v[116:119]
    ds_read_b64_tr_b16 a[244:245], v9 offset:13312
    v_mfma_f32_16x16x32_bf16 v[108:111], a[224:227], a[68:71], v[108:111]
    ds_read_b64_tr_b16 a[246:247], v9 offset:19456
    v_mfma_f32_16x16x32_bf16 v[108:111], a[228:231], a[84:87], v[108:111]
    s_waitcnt lgkmcnt(4)
    v_mfma_f32_16x16x32_bf16 v[100:103], a[228:231], a[80:83], v[100:103]
    buffer_load_dwordx4 a[108:111], v15, s[20:23], s77 offen sc1
    v_mfma_f32_16x16x32_bf16 v[100:103], a[224:227], a[64:67], v[100:103]
    s_add_u32 m0, s49, 122880
    ds_read_b64_tr_b16 a[224:225], v10 offset:1024
    v_mfma_f32_16x16x32_bf16 v[128:131], a[232:235], a[64:67], v[128:131]
    ds_read_b64_tr_b16 a[226:227], v10 offset:7168
    v_mfma_f32_16x16x32_bf16 v[128:131], a[236:239], a[80:83], v[128:131]
    ds_read_b64_tr_b16 a[228:229], v10 offset:13312
    v_mfma_f32_16x16x32_bf16 v[136:139], a[236:239], a[84:87], v[136:139]
    ds_read_b64_tr_b16 a[230:231], v10 offset:19456
    v_mfma_f32_16x16x32_bf16 v[136:139], a[232:235], a[68:71], v[136:139]
    v_mfma_f32_16x16x32_bf16 v[144:147], a[232:235], a[72:75], v[144:147]
    v_mfma_f32_16x16x32_bf16 v[144:147], a[236:239], a[88:91], v[144:147]
    buffer_load_dwordx4 v2, s[8:11], s36 offen offset:0 lds
    v_mfma_f32_16x16x32_bf16 v[152:155], a[236:239], a[92:95], v[152:155]
    s_waitcnt lgkmcnt(3)
    s_addk_i32 m0, 896
    v_mfma_f32_16x16x32_bf16 v[152:155], a[232:235], a[76:79], v[152:155]
    ds_read_b64_tr_b16 a[232:233], v11 offset:1024
    v_mfma_f32_16x16x32_bf16 v[156:159], a[240:243], a[76:79], v[156:159]
    ds_read_b64_tr_b16 a[234:235], v11 offset:7168
    v_mfma_f32_16x16x32_bf16 v[156:159], a[244:247], a[92:95], v[156:159]
    ds_read_b64_tr_b16 a[236:237], v11 offset:13312
    v_mfma_f32_16x16x32_bf16 v[148:151], a[244:247], a[88:91], v[148:151]
    ds_read_b64_tr_b16 a[238:239], v11 offset:19456
    v_mfma_f32_16x16x32_bf16 v[148:151], a[240:243], a[72:75], v[148:151]
    buffer_load_dwordx4 v2, s[8:11], s36 offen offset:128 lds
    v_mfma_f32_16x16x32_bf16 v[140:143], a[240:243], a[68:71], v[140:143]
    s_addk_i32 m0, 896
    v_mfma_f32_16x16x32_bf16 v[140:143], a[244:247], a[84:87], v[140:143]
    s_waitcnt lgkmcnt(4)
    v_mfma_f32_16x16x32_bf16 v[132:135], a[244:247], a[80:83], v[132:135]
    v_mfma_f32_16x16x32_bf16 v[132:135], a[240:243], a[64:67], v[132:135]
    ds_read_b64_tr_b16 a[240:241], v8 offset:2048
    v_mfma_f32_16x16x32_bf16 v[160:163], a[224:227], a[64:67], v[160:163]
    ds_read_b64_tr_b16 a[242:243], v8 offset:8192
    v_mfma_f32_16x16x32_bf16 v[160:163], a[228:231], a[80:83], v[160:163]
    ds_read_b64_tr_b16 a[244:245], v8 offset:14336
    v_mfma_f32_16x16x32_bf16 v[168:171], a[228:231], a[84:87], v[168:171]
    buffer_load_dwordx4 v2, s[8:11], s36 offen offset:256 lds
    v_mfma_f32_16x16x32_bf16 v[168:171], a[224:227], a[68:71], v[168:171]
    s_addk_i32 m0, 1280
    ds_read_b64_tr_b16 a[246:247], v8 offset:20480
    v_mfma_f32_16x16x32_bf16 v[176:179], a[224:227], a[72:75], v[176:179]
    v_mfma_f32_16x16x32_bf16 v[176:179], a[228:231], a[88:91], v[176:179]
    s_waitcnt lgkmcnt(4)
    v_mfma_f32_16x16x32_bf16 v[184:187], a[228:231], a[92:95], v[184:187]
    s_waitcnt vmcnt(18)
    v_lshlrev_b32 v42, 16, v48
    v_and_b32 v43, 0xffff0000, v48
    v_mfma_f32_16x16x32_bf16 v[184:187], a[224:227], a[76:79], v[184:187]
    ds_read_b64_tr_b16 a[224:225], v9 offset:2048
    v_mfma_f32_16x16x32_bf16 v[188:191], a[232:235], a[76:79], v[188:191]
    buffer_load_dwordx4 v3, s[8:11], s36 offen offset:0 lds
    v_mfma_f32_16x16x32_bf16 v[188:191], a[236:239], a[92:95], v[188:191]
    s_addk_i32 m0, 896
    ds_read_b64_tr_b16 a[226:227], v9 offset:8192
    v_mfma_f32_16x16x32_bf16 v[180:183], a[236:239], a[88:91], v[180:183]
    s_waitcnt vmcnt(17)
    ds_read_b64_tr_b16 a[228:229], v9 offset:14336
    v_sub_f32 v42, v42, v40
    v_mfma_f32_16x16x32_bf16 v[180:183], a[232:235], a[72:75], v[180:183]
    ds_read_b64_tr_b16 a[230:231], v9 offset:20480
    v_sub_f32 v43, v43, v40
    v_mfma_f32_16x16x32_bf16 v[172:175], a[232:235], a[68:71], v[172:175]
    v_cvt_pk_bf16_f32 v44, v42, v43
    v_lshlrev_b32 v42, 16, v44
    v_mfma_f32_16x16x32_bf16 v[172:175], a[236:239], a[84:87], v[172:175]
    s_waitcnt lgkmcnt(4)
    v_and_b32 v43, 0xffff0000, v44
    v_mul_f32 v42, v42, v41
    v_mfma_f32_16x16x32_bf16 v[164:167], a[236:239], a[80:83], v[164:167]
    v_mul_f32 v43, v43, v41
    v_cvt_pk_bf16_f32 v48, v42, v43
    v_mfma_f32_16x16x32_bf16 v[164:167], a[232:235], a[64:67], v[164:167]
    buffer_load_dwordx4 v3, s[8:11], s36 offen offset:128 lds
    v_mfma_f32_16x16x32_bf16 v[192:195], a[240:243], a[64:67], v[192:195]
    s_addk_i32 m0, 896
    ds_read_b64_tr_b16 a[232:233], v10 offset:2048
    v_lshlrev_b32 v42, 16, v49
    v_mfma_f32_16x16x32_bf16 v[192:195], a[244:247], a[80:83], v[192:195]
    ds_read_b64_tr_b16 a[234:235], v10 offset:8192
    v_and_b32 v43, 0xffff0000, v49
    v_mfma_f32_16x16x32_bf16 v[200:203], a[244:247], a[84:87], v[200:203]
    ds_read_b64_tr_b16 a[236:237], v10 offset:14336
    v_sub_f32 v42, v42, v40
    v_mfma_f32_16x16x32_bf16 v[200:203], a[240:243], a[68:71], v[200:203]
    ds_read_b64_tr_b16 a[238:239], v10 offset:20480
    v_sub_f32 v43, v43, v40
    v_mfma_f32_16x16x32_bf16 v[208:211], a[240:243], a[72:75], v[208:211]
    v_cvt_pk_bf16_f32 v44, v42, v43
    v_lshlrev_b32 v42, 16, v44
    v_mfma_f32_16x16x32_bf16 v[208:211], a[244:247], a[88:91], v[208:211]
    buffer_load_dwordx4 v3, s[8:11], s36 offen offset:256 lds
    v_mfma_f32_16x16x32_bf16 v[216:219], a[244:247], a[92:95], v[216:219]
    s_waitcnt lgkmcnt(4)
    v_and_b32 v43, 0xffff0000, v44
    v_mul_f32 v42, v42, v41
    v_mfma_f32_16x16x32_bf16 v[216:219], a[240:243], a[76:79], v[216:219]
    s_add_u32 s36, s36, s37
    ds_read_b64_tr_b16 a[240:241], v11 offset:2048
    v_mul_f32 v43, v43, v41
    ds_read_b64_tr_b16 a[242:243], v11 offset:8192
    v_mfma_f32_16x16x32_bf16 v[220:223], a[224:227], a[76:79], v[220:223]
    s_sub_u32 s55, s36, 7864320
    ds_read_b64_tr_b16 a[244:245], v11 offset:14336
    v_cvt_pk_bf16_f32 v49, v42, v43
    ds_read_b64_tr_b16 a[246:247], v11 offset:20480
    v_mfma_f32_16x16x32_bf16 v[220:223], a[228:231], a[92:95], v[220:223]
    s_min_u32 s36, s36, s55
    v_lshlrev_b32 v42, 16, v50
    v_and_b32 v43, 0xffff0000, v50
    v_mfma_f32_16x16x32_bf16 v[212:215], a[228:231], a[88:91], v[212:215]
    s_add_u32 s46, s45, 69632
    v_sub_f32 v42, v42, v40
    v_sub_f32 v43, v43, v40
    v_mfma_f32_16x16x32_bf16 v[212:215], a[224:227], a[72:75], v[212:215]
    s_sub_u32 s77, s46, 81920
    v_cvt_pk_bf16_f32 v44, v42, v43
    v_lshlrev_b32 v42, 16, v44
    v_mfma_f32_16x16x32_bf16 v[204:207], a[224:227], a[68:71], v[204:207]
    s_min_u32 s46, s46, s77
    v_and_b32 v43, 0xffff0000, v44
    v_mul_f32 v42, v42, v41
    v_mfma_f32_16x16x32_bf16 v[204:207], a[228:231], a[84:87], v[204:207]
    buffer_load_dwordx4 a[112:115], v14, s[20:23], s46 offen sc1
    v_mfma_f32_16x16x32_bf16 v[196:199], a[228:231], a[80:83], v[196:199]
    s_waitcnt vmcnt(12) lgkmcnt(0)
    s_barrier
    v_mfma_f32_16x16x32_bf16 v[196:199], a[224:227], a[64:67], v[196:199]
    s_xor_b32 s77, s46, 1024
    ds_read_b64_tr_b16 a[224:225], v8 offset:24576
    v_mul_f32 v43, v43, v41
    v_mfma_f32_16x16x32_bf16 v[224:227], a[232:235], a[64:67], v[224:227]
    ds_read_b64_tr_b16 a[226:227], v8 offset:30720
    v_cvt_pk_bf16_f32 v50, v42, v43
    v_mfma_f32_16x16x32_bf16 v[224:227], a[236:239], a[80:83], v[224:227]
    ds_read_b64_tr_b16 a[228:229], v8 offset:36864
    v_lshlrev_b32 v42, 16, v51
    v_mfma_f32_16x16x32_bf16 v[232:235], a[236:239], a[84:87], v[232:235]
pg_3:
    s_cbranch_execz pg_7
    buffer_load_dwordx4 a[116:119], v14, s[20:23], s77 offen sc1
    v_mfma_f32_16x16x32_bf16 v[232:235], a[232:235], a[68:71], v[232:235]
    ds_read_b64_tr_b16 a[230:231], v8 offset:43008
    v_and_b32 v43, 0xffff0000, v51
    v_mfma_f32_16x16x32_bf16 v[240:243], a[232:235], a[72:75], v[240:243]
    v_sub_f32 v42, v42, v40
    v_sub_f32 v43, v43, v40
    v_mfma_f32_16x16x32_bf16 v[240:243], a[236:239], a[88:91], v[240:243]
    v_cvt_pk_bf16_f32 v44, v42, v43
    v_lshlrev_b32 v42, 16, v44
    v_mfma_f32_16x16x32_bf16 v[248:251], a[236:239], a[92:95], v[248:251]
    v_and_b32 v43, 0xffff0000, v44
    v_mul_f32 v42, v42, v41
    v_mfma_f32_16x16x32_bf16 v[248:251], a[232:235], a[76:79], v[248:251]
    ds_read_b64_tr_b16 a[232:233], v9 offset:24576
    v_mul_f32 v43, v43, v41
    v_mfma_f32_16x16x32_bf16 v[252:255], a[240:243], a[76:79], v[252:255]
    ds_read_b64_tr_b16 a[234:235], v9 offset:30720
    v_cvt_pk_bf16_f32 v51, v42, v43
    v_mfma_f32_16x16x32_bf16 v[252:255], a[244:247], a[92:95], v[252:255]
    buffer_load_dwordx4 a[120:123], v15, s[20:23], s46 offen sc1
    v_mfma_f32_16x16x32_bf16 v[244:247], a[244:247], a[88:91], v[244:247]
    ds_read_b64_tr_b16 a[236:237], v9 offset:36864
    v_lshlrev_b32 v42, 16, v52
    v_mfma_f32_16x16x32_bf16 v[244:247], a[240:243], a[72:75], v[244:247]
    ds_read_b64_tr_b16 a[238:239], v9 offset:43008
    v_and_b32 v43, 0xffff0000, v52
    v_mfma_f32_16x16x32_bf16 v[236:239], a[240:243], a[68:71], v[236:239]
    v_sub_f32 v42, v42, v40
    v_sub_f32 v43, v43, v40
    v_mfma_f32_16x16x32_bf16 v[236:239], a[244:247], a[84:87], v[236:239]
    s_waitcnt lgkmcnt(4)
    v_cvt_pk_bf16_f32 v44, v42, v43
    v_lshlrev_b32 v42, 16, v44
    v_mfma_f32_16x16x32_bf16 v[228:231], a[244:247], a[80:83], v[228:231]
    v_and_b32 v43, 0xffff0000, v44
    v_mul_f32 v42, v42, v41
    v_mfma_f32_16x16x32_bf16 v[228:231], a[240:243], a[64:67], v[228:231]
    buffer_load_dwordx4 a[124:127], v15, s[20:23], s77 offen sc1
    v_mfma_f32_16x16x32_bf16 v[64:67], a[224:227], a[160:163], v[64:67]
    s_add_u32 s46, s45, 73728
    ds_read_b64_tr_b16 a[240:241], v10 offset:24576
    v_mul_f32 v43, v43, v41
    v_mfma_f32_16x16x32_bf16 v[64:67], a[228:231], a[176:179], v[64:67]
    s_sub_u32 s77, s46, 81920
    ds_read_b64_tr_b16 a[242:243], v10 offset:30720
    v_cvt_pk_bf16_f32 v52, v42, v43
    v_mfma_f32_16x16x32_bf16 v[72:75], a[228:231], a[180:183], v[72:75]
    s_min_u32 s46, s46, s77
    ds_read_b64_tr_b16 a[244:245], v10 offset:36864
    v_lshlrev_b32 v42, 16, v53
    v_mfma_f32_16x16x32_bf16 v[72:75], a[224:227], a[164:167], v[72:75]
    s_xor_b32 s77, s46, 1024
    ds_read_b64_tr_b16 a[246:247], v10 offset:43008
    v_and_b32 v43, 0xffff0000, v53
    v_mfma_f32_16x16x32_bf16 v[80:83], a[224:227], a[168:171], v[80:83]
    v_sub_f32 v42, v42, v40
    v_sub_f32 v43, v43, v40
    v_mfma_f32_16x16x32_bf16 v[80:83], a[228:231], a[184:187], v[80:83]
    s_waitcnt lgkmcnt(4)
    v_cvt_pk_bf16_f32 v44, v42, v43
    v_lshlrev_b32 v42, 16, v44
    v_mfma_f32_16x16x32_bf16 v[88:91], a[228:231], a[188:191], v[88:91]
    buffer_load_dwordx4 a[128:131], v14, s[20:23], s46 offen sc1
    v_mfma_f32_16x16x32_bf16 v[88:91], a[224:227], a[172:175], v[88:91]
    ds_read_b64_tr_b16 a[224:225], v11 offset:24576
    v_and_b32 v43, 0xffff0000, v44
    v_mfma_f32_16x16x32_bf16 v[92:95], a[232:235], a[172:175], v[92:95]
    ds_read_b64_tr_b16 a[226:227], v11 offset:30720
    v_mul_f32 v42, v42, v41
    v_mfma_f32_16x16x32_bf16 v[92:95], a[236:239], a[188:191], v[92:95]
    ds_read_b64_tr_b16 a[228:229], v11 offset:36864
    v_mul_f32 v43, v43, v41
    v_mfma_f32_16x16x32_bf16 v[84:87], a[236:239], a[184:187], v[84:87]
    ds_read_b64_tr_b16 a[230:231], v11 offset:43008
    v_cvt_pk_bf16_f32 v53, v42, v43
    v_mfma_f32_16x16x32_bf16 v[84:87], a[232:235], a[168:171], v[84:87]
    v_lshlrev_b32 v42, 16, v54
    v_and_b32 v43, 0xffff0000, v54
    v_mfma_f32_16x16x32_bf16 v[76:79], a[232:235], a[164:167], v[76:79]
    buffer_load_dwordx4 a[132:135], v14, s[20:23], s77 offen sc1
    v_mfma_f32_16x16x32_bf16 v[76:79], a[236:239], a[180:183], v[76:79]
    s_waitcnt lgkmcnt(4)
    v_sub_f32 v42, v42, v40
    v_sub_f32 v43, v43, v40
    v_mfma_f32_16x16x32_bf16 v[68:71], a[236:239], a[176:179], v[68:71]
    v_cvt_pk_bf16_f32 v44, v42, v43
    v_lshlrev_b32 v42, 16, v44
    v_mfma_f32_16x16x32_bf16 v[68:71], a[232:235], a[160:163], v[68:71]
    ds_read_b64_tr_b16 a[232:233], v8 offset:25600
    v_and_b32 v43, 0xffff0000, v44
    v_mfma_f32_16x16x32_bf16 v[96:99], a[240:243], a[160:163], v[96:99]
    ds_read_b64_tr_b16 a[234:235], v8 offset:31744
    v_mul_f32 v42, v42, v41
    v_mfma_f32_16x16x32_bf16 v[96:99], a[244:247], a[176:179], v[96:99]
    ds_read_b64_tr_b16 a[236:237], v8 offset:37888
    v_mul_f32 v43, v43, v41
    v_mfma_f32_16x16x32_bf16 v[104:107], a[244:247], a[180:183], v[104:107]
    ds_read_b64_tr_b16 a[238:239], v8 offset:44032
    v_cvt_pk_bf16_f32 v54, v42, v43
    v_mfma_f32_16x16x32_bf16 v[104:107], a[240:243], a[164:167], v[104:107]
    buffer_load_dwordx4 a[136:139], v15, s[20:23], s46 offen sc1
    v_mfma_f32_16x16x32_bf16 v[112:115], a[240:243], a[168:171], v[112:115]
    v_lshlrev_b32 v42, 16, v55
    v_and_b32 v43, 0xffff0000, v55
    v_mfma_f32_16x16x32_bf16 v[112:115], a[244:247], a[184:187], v[112:115]
    s_waitcnt lgkmcnt(4)
    v_sub_f32 v42, v42, v40
    v_sub_f32 v43, v43, v40
    v_mfma_f32_16x16x32_bf16 v[120:123], a[244:247], a[188:191], v[120:123]
    v_cvt_pk_bf16_f32 v44, v42, v43
    v_lshlrev_b32 v42, 16, v44
    v_mfma_f32_16x16x32_bf16 v[120:123], a[240:243], a[172:175], v[120:123]
    ds_read_b64_tr_b16 a[240:241], v9 offset:25600
    v_and_b32 v43, 0xffff0000, v44
    v_mfma_f32_16x16x32_bf16 v[124:127], a[224:227], a[172:175], v[124:127]
    ds_read_b64_tr_b16 a[242:243], v9 offset:31744
    v_mul_f32 v42, v42, v41
    v_mfma_f32_16x16x32_bf16 v[124:127], a[228:231], a[188:191], v[124:127]
    buffer_load_dwordx4 a[140:143], v15, s[20:23], s77 offen sc1
    v_mfma_f32_16x16x32_bf16 v[116:119], a[228:231], a[184:187], v[116:119]
    s_add_u32 s46, s45, 77824
    ds_read_b64_tr_b16 a[244:245], v9 offset:37888
    v_mul_f32 v43, v43, v41
    v_mfma_f32_16x16x32_bf16 v[116:119], a[224:227], a[168:171], v[116:119]
    s_sub_u32 s77, s46, 81920
    ds_read_b64_tr_b16 a[246:247], v9 offset:44032
    v_cvt_pk_bf16_f32 v55, v42, v43
    v_mfma_f32_16x16x32_bf16 v[108:111], a[224:227], a[164:167], v[108:111]
    s_min_u32 s46, s46, s77
    s_xor_b32 s77, s46, 1024
    v_mfma_f32_16x16x32_bf16 v[108:111], a[228:231], a[180:183], v[108:111]
    s_waitcnt lgkmcnt(4)
    v_mfma_f32_16x16x32_bf16 v[100:103], a[228:231], a[176:179], v[100:103]
    v_mfma_f32_16x16x32_bf16 v[100:103], a[224:227], a[160:163], v[100:103]
    ds_read_b64_tr_b16 a[224:225], v10 offset:25600
    v_mfma_f32_16x16x32_bf16 v[128:131], a[232:235], a[160:163], v[128:131]
    buffer_load_dwordx4 a[144:147], v14, s[20:23], s46 offen sc1
    v_mfma_f32_16x16x32_bf16 v[128:131], a[236:239], a[176:179], v[128:131]
    ds_read_b64_tr_b16 a[226:227], v10 offset:31744
    v_mfma_f32_16x16x32_bf16 v[136:139], a[236:239], a[180:183], v[136:139]
    ds_read_b64_tr_b16 a[228:229], v10 offset:37888
    v_mfma_f32_16x16x32_bf16 v[136:139], a[232:235], a[164:167], v[136:139]
    ds_read_b64_tr_b16 a[230:231], v10 offset:44032
    v_mfma_f32_16x16x32_bf16 v[144:147], a[232:235], a[168:171], v[144:147]
    v_mfma_f32_16x16x32_bf16 v[144:147], a[236:239], a[184:187], v[144:147]
    s_waitcnt lgkmcnt(4)
    v_mfma_f32_16x16x32_bf16 v[152:155], a[236:239], a[188:191], v[152:155]
    buffer_load_dwordx4 a[148:151], v14, s[20:23], s77 offen sc1
    v_mfma_f32_16x16x32_bf16 v[152:155], a[232:235], a[172:175], v[152:155]
    ds_read_b64_tr_b16 a[232:233], v11 offset:25600
    v_mfma_f32_16x16x32_bf16 v[156:159], a[240:243], a[172:175], v[156:159]
    ds_read_b64_tr_b16 a[234:235], v11 offset:31744
    v_mfma_f32_16x16x32_bf16 v[156:159], a[244:247], a[188:191], v[156:159]
    ds_read_b64_tr_b16 a[236:237], v11 offset:37888
    v_mfma_f32_16x16x32_bf16 v[148:151], a[244:247], a[184:187], v[148:151]
    ds_read_b64_tr_b16 a[238:239], v11 offset:44032
    v_mfma_f32_16x16x32_bf16 v[148:151], a[240:243], a[168:171], v[148:151]
    v_mfma_f32_16x16x32_bf16 v[140:143], a[240:243], a[164:167], v[140:143]
    v_mfma_f32_16x16x32_bf16 v[140:143], a[244:247], a[180:183], v[140:143]
    buffer_load_dwordx4 a[152:155], v15, s[20:23], s46 offen sc1
    v_mfma_f32_16x16x32_bf16 v[132:135], a[244:247], a[176:179], v[132:135]
    s_waitcnt lgkmcnt(3)
    v_mfma_f32_16x16x32_bf16 v[132:135], a[240:243], a[160:163], v[132:135]
    ds_read_b64_tr_b16 a[240:241], v8 offset:26624
    v_mfma_f32_16x16x32_bf16 v[160:163], a[224:227], a[160:163], v[160:163]
    ds_read_b64_tr_b16 a[242:243], v8 offset:32768
    v_mfma_f32_16x16x32_bf16 v[160:163], a[228:231], a[176:179], v[160:163]
    ds_read_b64_tr_b16 a[244:245], v8 offset:38912
    v_mfma_f32_16x16x32_bf16 v[168:171], a[228:231], a[180:183], v[168:171]
    ds_read_b64_tr_b16 a[246:247], v8 offset:45056
    v_mfma_f32_16x16x32_bf16 v[168:171], a[224:227], a[164:167], v[168:171]
    buffer_load_dwordx4 a[156:159], v15, s[20:23], s77 offen sc1
    v_mfma_f32_16x16x32_bf16 v[176:179], a[224:227], a[168:171], v[176:179]
    s_add_u32 m0, s49, 0
    ds_read_b64_tr_b16 v[32:33], v25 offset:0
    v_mfma_f32_16x16x32_bf16 v[176:179], a[228:231], a[184:187], v[176:179]
    s_waitcnt lgkmcnt(5)
    ds_read_b64_tr_b16 v[34:35], v25 offset:4096
    v_mfma_f32_16x16x32_bf16 v[184:187], a[228:231], a[188:191], v[184:187]
    ds_read_b64_tr_b16 v[36:37], v25 offset:1024
    v_mfma_f32_16x16x32_bf16 v[184:187], a[224:227], a[172:175], v[184:187]
    ds_read_b64_tr_b16 v[38:39], v25 offset:5120
    v_mfma_f32_16x16x32_bf16 v[188:191], a[232:235], a[172:175], v[188:191]
    ds_read_b64_tr_b16 v[40:41], v25 offset:8192
    v_mfma_f32_16x16x32_bf16 v[188:191], a[236:239], a[188:191], v[188:191]
    ds_read_b64_tr_b16 v[42:43], v25 offset:12288
    v_mfma_f32_16x16x32_bf16 v[180:183], a[236:239], a[184:187], v[180:183]
    buffer_load_dwordx4 v4, s[12:15], s38 offen offset:0 lds
    v_mfma_f32_16x16x32_bf16 v[180:183], a[232:235], a[168:171], v[180:183]
    s_addk_i32 m0, 896
    ds_read_b64_tr_b16 v[44:45], v25 offset:9216
    v_mfma_f32_16x16x32_bf16 v[172:175], a[232:235], a[164:167], v[172:175]
    s_waitcnt lgkmcnt(5)
    ds_read_b64_tr_b16 v[46:47], v25 offset:13312
    ds_read_b64_tr_b16 a[224:225], v9 offset:26624
    v_mfma_f32_16x16x32_bf16 v[172:175], a[236:239], a[180:183], v[172:175]
    ds_read_b64_tr_b16 a[226:227], v9 offset:32768
    v_mfma_f32_16x16x32_bf16 v[164:167], a[236:239], a[176:179], v[164:167]
    ds_read_b64_tr_b16 a[228:229], v9 offset:38912
    v_mfma_f32_16x16x32_bf16 v[164:167], a[232:235], a[160:163], v[164:167]
    ds_read_b64_tr_b16 a[230:231], v9 offset:45056
    v_mfma_f32_16x16x32_bf16 v[192:195], a[240:243], a[160:163], v[192:195]
    ds_read_b64_tr_b16 a[232:233], v10 offset:26624
    v_mfma_f32_16x16x32_bf16 v[192:195], a[244:247], a[176:179], v[192:195]
    s_waitcnt lgkmcnt(7)
    ds_read_b64_tr_b16 a[234:235], v10 offset:32768
    v_mfma_f32_16x16x32_bf16 v[200:203], a[244:247], a[180:183], v[200:203]
    ds_read_b64_tr_b16 a[236:237], v10 offset:38912
    v_mfma_f32_16x16x32_bf16 v[200:203], a[240:243], a[164:167], v[200:203]
    ds_read_b64_tr_b16 a[238:239], v10 offset:45056
    v_mfma_f32_16x16x32_bf16 v[208:211], a[240:243], a[168:171], v[208:211]
    buffer_load_dwordx4 v4, s[12:15], s38 offen offset:128 lds
    v_mfma_f32_16x16x32_bf16 v[208:211], a[244:247], a[184:187], v[208:211]
    s_waitcnt lgkmcnt(5)
    v_add_u32 v8, 49152, v8
    s_addk_i32 m0, 896
    v_mfma_f32_16x16x32_bf16 v[216:219], a[244:247], a[188:191], v[216:219]
    s_waitcnt lgkmcnt(4)
    v_add_u32 v9, 49152, v9
    v_mfma_f32_16x16x32_bf16 v[216:219], a[240:243], a[172:175], v[216:219]
    ds_read_b64_tr_b16 a[240:241], v11 offset:26624
    ds_read_b64_tr_b16 a[242:243], v11 offset:32768
    ds_read_b64_tr_b16 a[244:245], v11 offset:38912
    v_mfma_f32_16x16x32_bf16 v[220:223], a[224:227], a[172:175], v[220:223]
    ds_read_b64_tr_b16 a[246:247], v11 offset:45056
    v_mfma_f32_16x16x32_bf16 v[220:223], a[228:231], a[188:191], v[220:223]
    buffer_load_dwordx4 v4, s[12:15], s38 offen offset:256 lds
    v_mfma_f32_16x16x32_bf16 v[212:215], a[228:231], a[184:187], v[212:215]
    s_addk_i32 m0, 1280
    v_add_u32 v10, 49152, v10
    v_mfma_f32_16x16x32_bf16 v[212:215], a[224:227], a[168:171], v[212:215]
    v_add_u32 v11, 49152, v11
    v_mfma_f32_16x16x32_bf16 v[204:207], a[224:227], a[164:167], v[204:207]
    v_mfma_f32_16x16x32_bf16 v[204:207], a[228:231], a[180:183], v[204:207]
    buffer_load_dwordx4 v5, s[12:15], s38 offen offset:0 lds
    v_mfma_f32_16x16x32_bf16 v[196:199], a[228:231], a[176:179], v[196:199]
    s_waitcnt vmcnt(16) lgkmcnt(0)
    s_barrier
    v_mfma_f32_16x16x32_bf16 v[196:199], a[224:227], a[160:163], v[196:199]
    s_addk_i32 m0, 896
    ds_read_b64_tr_b16 a[224:225], v8 offset:0
    v_mfma_f32_16x16x32_bf16 v[224:227], a[232:235], a[160:163], v[224:227]
    ds_read_b64_tr_b16 a[226:227], v8 offset:6144
    v_mfma_f32_16x16x32_bf16 v[224:227], a[236:239], a[176:179], v[224:227]
    ds_read_b64_tr_b16 a[228:229], v8 offset:12288
    v_mfma_f32_16x16x32_bf16 v[232:235], a[236:239], a[180:183], v[232:235]
    ds_read_b64_tr_b16 a[230:231], v8 offset:18432
    v_mfma_f32_16x16x32_bf16 v[232:235], a[232:235], a[164:167], v[232:235]
    v_mfma_f32_16x16x32_bf16 v[240:243], a[232:235], a[168:171], v[240:243]
    buffer_load_dwordx4 v5, s[12:15], s38 offen offset:128 lds
    v_mfma_f32_16x16x32_bf16 v[240:243], a[236:239], a[184:187], v[240:243]
    s_addk_i32 m0, 896
    v_mfma_f32_16x16x32_bf16 v[248:251], a[236:239], a[188:191], v[248:251]
    v_mfma_f32_16x16x32_bf16 v[248:251], a[232:235], a[172:175], v[248:251]
    ds_read_b64_tr_b16 a[232:233], v8 offset:24576
    v_mfma_f32_16x16x32_bf16 v[20:23], v[48:51], v[32:35], 0
    ds_read_b64_tr_b16 a[234:235], v8 offset:30720
    v_mfma_f32_16x16x32_bf16 v[58:61], v[48:51], v[36:39], 0
    ds_read_b64_tr_b16 a[236:237], v8 offset:36864
    v_mfma_f32_16x16x32_bf16 v[20:23], v[52:55], v[40:43], v[20:23]
    buffer_load_dwordx4 v5, s[12:15], s38 offen offset:256 lds
    v_mfma_f32_16x16x32_bf16 v[58:61], v[52:55], v[44:47], v[58:61]
    s_add_u32 s38, s38, 24576
    ds_read_b64_tr_b16 a[238:239], v8 offset:43008
    s_addk_i32 m0, 19712
    v_mfma_f32_16x16x32_bf16 v[252:255], a[240:243], a[172:175], v[252:255]
    s_mul_i32 s56, s53, 983040
    v_lshlrev_b32 v14, 4, v1
    v_min_u32 v15, 1, v1
    v_mfma_f32_16x16x32_bf16 v[252:255], a[244:247], a[188:191], v[252:255]
    s_mul_i32 s57, s51, 320
    v_mov_b32 v22, v58
    v_mov_b32 v23, v59
    v_mfma_f32_16x16x32_bf16 v[244:247], a[244:247], a[184:187], v[244:247]
    buffer_store_dwordx4 v[20:23], v26, s[24:27], s62 offen sc1
    v_mov_b32 v26, s7
    v_mfma_f32_16x16x32_bf16 v[244:247], a[240:243], a[168:171], v[244:247]
    s_add_u32 s56, s56, s57
    v_lshrrev_b32 v21, 3, v1
    v_mul_u32_u24 v21, 1280, v21
    v_mfma_f32_16x16x32_bf16 v[236:239], a[240:243], a[164:167], v[236:239]
    s_sub_u32 s57, 7864320, s56
    v_and_b32 v22, 16, v1
    v_lshlrev_b32 v22, 1, v22
    v_mfma_f32_16x16x32_bf16 v[236:239], a[244:247], a[180:183], v[236:239]
    buffer_load_dwordx4 v4, s[12:15], s38 offen offset:0 lds
    v_mfma_f32_16x16x32_bf16 v[228:231], a[244:247], a[176:179], v[228:231]
    s_waitcnt vmcnt(19) lgkmcnt(0)
    v_lshlrev_b32 v15, 30, v15
    v_and_b32 v20, 1, v1
    v_mfma_f32_16x16x32_bf16 v[228:231], a[240:243], a[160:163], v[228:231]
    s_waitcnt vmcnt(18)
    ds_read_b64_tr_b16 a[240:241], v9 offset:0
    v_mul_u32_u24 v20, 0xaaaa, v20
    v_mfma_f32_16x16x32_bf16 v[64:67], a[224:227], a[96:99], v[64:67]
    s_addk_i32 m0, 896
    ds_read_b64_tr_b16 a[242:243], v9 offset:6144
    v_add_u32 v20, 0x4444, v20
    v_mfma_f32_16x16x32_bf16 v[64:67], a[228:231], a[112:115], v[64:67]
    s_add_u32 s8, s72, s56
    s_addc_u32 s9, s73, 0
    s_and_b32 s9, s9, 0xffff
    v_mfma_f32_16x16x32_bf16 v[72:75], a[228:231], a[116:119], v[72:75]
    s_waitcnt vmcnt(17)
    ds_read_b64_tr_b16 a[244:245], v9 offset:12288
    s_mov_b32 s10, s57
    v_mfma_f32_16x16x32_bf16 v[72:75], a[224:227], a[100:103], v[72:75]
    buffer_load_dwordx4 v4, s[12:15], s38 offen offset:128 lds
    v_mfma_f32_16x16x32_bf16 v[80:83], a[224:227], a[104:107], v[80:83]
    s_waitcnt vmcnt(17)
    ds_read_b64_tr_b16 a[246:247], v9 offset:18432
    s_addk_i32 m0, 896
    v_mfma_f32_16x16x32_bf16 v[80:83], a[228:231], a[120:123], v[80:83]
    s_waitcnt vmcnt(13)
    s_mov_b32 s11, 0x00020000
    s_mul_i32 s56, s53, 983040
    v_mfma_f32_16x16x32_bf16 v[88:91], a[228:231], a[124:127], v[88:91]
    s_waitcnt vmcnt(9)
    s_mov_b32 s34, 983040
    s_mov_b32 s35, 0x00020000
    v_mfma_f32_16x16x32_bf16 v[88:91], a[224:227], a[108:111], v[88:91]
    s_add_u32 s32, s72, s56
    s_addc_u32 s33, s73, 0
    s_and_b32 s33, s33, 0xffff
    v_mfma_f32_16x16x32_bf16 v[88:91], a[232:235], a[140:143], v[88:91]
    s_mul_i32 s56, s53, 3145728
    ds_read_b64_tr_b16 a[224:225], v9 offset:24576
    s_add_u32 s56, s56, 16777216
    v_mfma_f32_16x16x32_bf16 v[88:91], a[236:239], a[156:159], v[88:91]
    s_add_u32 s20, s86, s56
    s_addc_u32 s21, s87, 0
    s_and_b32 s21, s21, 0xffff
    v_mfma_f32_16x16x32_bf16 v[80:83], a[236:239], a[152:155], v[80:83]
    buffer_load_dwordx4 v4, s[12:15], s38 offen offset:256 lds
    v_mfma_f32_16x16x32_bf16 v[80:83], a[232:235], a[136:139], v[80:83]
    s_addk_i32 m0, 1280
    ds_read_b64_tr_b16 a[226:227], v9 offset:30720
    v_cvt_pk_bf16_f32 v88, v88, v89
    v_mfma_f32_16x16x32_bf16 v[72:75], a[232:235], a[132:135], v[72:75]
    s_mov_b32 s22, 3145728
    ds_read_b64_tr_b16 a[228:229], v9 offset:36864
    v_cvt_pk_bf16_f32 v89, v90, v91
    v_mfma_f32_16x16x32_bf16 v[72:75], a[236:239], a[148:151], v[72:75]
    s_waitcnt lgkmcnt(3)
    ds_read_b64_tr_b16 a[230:231], v9 offset:43008
    v_cvt_pk_bf16_f32 v80, v80, v81
    v_mfma_f32_16x16x32_bf16 v[64:67], a[236:239], a[144:147], v[64:67]
    s_mov_b32 s23, 0x00020000
    v_cvt_pk_bf16_f32 v81, v82, v83
    s_lshl_b32 s55, s51, 5
    v_mfma_f32_16x16x32_bf16 v[64:67], a[232:235], a[128:131], v[64:67]
    s_add_u32 s55, s55, s54
    ds_read_b64_tr_b16 a[232:233], v10 offset:0
    v_cvt_pk_bf16_f32 v72, v72, v73
    v_mfma_f32_16x16x32_bf16 v[68:71], a[240:243], a[96:99], v[68:71]
    buffer_load_dwordx4 v5, s[12:15], s38 offen offset:0 lds
    v_mfma_f32_16x16x32_bf16 v[68:71], a[244:247], a[112:115], v[68:71]
    s_addk_i32 m0, 896
    ds_read_b64_tr_b16 a[234:235], v10 offset:6144
    v_cvt_pk_bf16_f32 v64, v64, v65
    v_mfma_f32_16x16x32_bf16 v[76:79], a[244:247], a[116:119], v[76:79]
    s_mul_i32 s55, s55, 24576
    ds_read_b64_tr_b16 a[236:237], v10 offset:12288
    v_cvt_pk_bf16_f32 v65, v66, v67
    v_mfma_f32_16x16x32_bf16 v[76:79], a[240:243], a[100:103], v[76:79]
    s_lshr_b32 s50, s53, 1
    ds_read_b64_tr_b16 a[238:239], v10 offset:18432
    v_cvt_pk_bf16_f32 v73, v74, v75
    v_mfma_f32_16x16x32_bf16 v[84:87], a[240:243], a[104:107], v[84:87]
    s_xor_b32 s67, s50, 3
    s_lshl_b32 s67, s67, 10
    s_add_u32 s56, s51, 0
    v_mfma_f32_16x16x32_bf16 v[84:87], a[244:247], a[120:123], v[84:87]
    s_waitcnt lgkmcnt(4)
    s_and_b32 s56, s56, 3
    s_mul_i32 s44, s56, 245760
    v_mfma_f32_16x16x32_bf16 v[92:95], a[244:247], a[124:127], v[92:95]
    s_add_u32 s56, s51, 1
    s_and_b32 s56, s56, 3
    s_mul_i32 s45, s56, 245760
    v_mfma_f32_16x16x32_bf16 v[92:95], a[240:243], a[108:111], v[92:95]
    buffer_load_dwordx4 v5, s[12:15], s38 offen offset:128 lds
    v_mfma_f32_16x16x32_bf16 v[92:95], a[224:227], a[140:143], v[92:95]
    s_addk_i32 m0, 896
    ds_read_b64_tr_b16 a[240:241], v10 offset:24576
    s_lshl_b32 s56, s56, 5
    v_mfma_f32_16x16x32_bf16 v[92:95], a[228:231], a[156:159], v[92:95]
    s_add_u32 s56, s56, s54
    ds_read_b64_tr_b16 a[242:243], v10 offset:30720
    s_mul_i32 s59, s56, 24576
    v_mfma_f32_16x16x32_bf16 v[84:87], a[228:231], a[152:155], v[84:87]
    s_add_u32 s56, s51, 2
    ds_read_b64_tr_b16 a[244:245], v10 offset:36864
    s_and_b32 s56, s56, 3
    v_mfma_f32_16x16x32_bf16 v[84:87], a[224:227], a[136:139], v[84:87]
    s_mul_i32 s46, s56, 245760
    ds_read_b64_tr_b16 a[246:247], v10 offset:43008
    v_cvt_pk_bf16_f32 v90, v92, v93
    v_mfma_f32_16x16x32_bf16 v[76:79], a[224:227], a[132:135], v[76:79]
    s_add_u32 s39, s40, 0
    v_permlane16_swap_b32 v88, v90
    v_mfma_f32_16x16x32_bf16 v[76:79], a[228:231], a[148:151], v[76:79]
    buffer_load_dwordx4 v5, s[12:15], s38 offen offset:256 lds
    v_mfma_f32_16x16x32_bf16 v[68:71], a[228:231], a[144:147], v[68:71]
    s_waitcnt lgkmcnt(4)
    v_cvt_pk_bf16_f32 v82, v84, v85
    v_cvt_pk_bf16_f32 v83, v86, v87
    v_mfma_f32_16x16x32_bf16 v[68:71], a[224:227], a[128:131], v[68:71]
    s_add_u32 s38, s38, 24576
    ds_read_b64_tr_b16 a[224:225], v11 offset:0
    v_cvt_pk_bf16_f32 v74, v76, v77
    v_mfma_f32_16x16x32_bf16 v[96:99], a[232:235], a[96:99], v[96:99]
    s_add_u32 m0, s63, 73728
    ds_read_b64_tr_b16 a[226:227], v11 offset:6144
    v_cvt_pk_bf16_f32 v75, v78, v79
    v_mfma_f32_16x16x32_bf16 v[96:99], a[236:239], a[112:115], v[96:99]
    s_lshl_b32 s56, s56, 5
    ds_read_b64_tr_b16 a[228:229], v11 offset:12288
    v_cvt_pk_bf16_f32 v66, v68, v69
    v_mfma_f32_16x16x32_bf16 v[104:107], a[236:239], a[116:119], v[104:107]
    s_add_u32 s56, s56, s54
    ds_read_b64_tr_b16 a[230:231], v11 offset:18432
    v_cvt_pk_bf16_f32 v67, v70, v71
    v_mfma_f32_16x16x32_bf16 v[104:107], a[232:235], a[100:103], v[104:107]
    s_mul_i32 s60, s56, 24576
    v_permlane16_swap_b32 v64, v66
    v_mfma_f32_16x16x32_bf16 v[112:115], a[232:235], a[104:107], v[112:115]
    buffer_load_dwordx4 v6, s[16:19], s39 offen lds
    v_mfma_f32_16x16x32_bf16 v[112:115], a[236:239], a[120:123], v[112:115]
    s_waitcnt lgkmcnt(4)
    v_permlane16_swap_b32 v65, v67
    v_mfma_f32_16x16x32_bf16 v[120:123], a[236:239], a[124:127], v[120:123]
    s_add_u32 s39, s40, 12288
    v_permlane16_swap_b32 v72, v74
    v_mfma_f32_16x16x32_bf16 v[120:123], a[232:235], a[108:111], v[120:123]
    s_addk_i32 m0, 4096
    ds_read_b64_tr_b16 a[232:233], v11 offset:24576
    v_accvgpr_write_b32 a0, v64
    v_mfma_f32_16x16x32_bf16 v[120:123], a[240:243], a[140:143], v[120:123]
    s_add_u32 s56, s51, 3
    ds_read_b64_tr_b16 a[234:235], v11 offset:30720
    v_accvgpr_write_b32 a1, v65
    v_mfma_f32_16x16x32_bf16 v[120:123], a[244:247], a[156:159], v[120:123]
    s_and_b32 s56, s56, 3
    ds_read_b64_tr_b16 a[236:237], v11 offset:36864
    v_accvgpr_write_b32 a2, v66
    v_mfma_f32_16x16x32_bf16 v[112:115], a[244:247], a[152:155], v[112:115]
    buffer_load_dwordx4 v6, s[16:19], s39 offen lds
    v_mfma_f32_16x16x32_bf16 v[112:115], a[240:243], a[136:139], v[112:115]
    s_add_u32 s39, s40, 24576
    ds_read_b64_tr_b16 a[238:239], v11 offset:43008
    v_accvgpr_write_b32 a3, v67
    v_mfma_f32_16x16x32_bf16 v[104:107], a[240:243], a[132:135], v[104:107]
    s_addk_i32 m0, 4096
    v_permlane16_swap_b32 v73, v75
    v_mfma_f32_16x16x32_bf16 v[104:107], a[244:247], a[148:151], v[104:107]
    s_waitcnt lgkmcnt(4)
    v_permlane16_swap_b32 v80, v82
    v_mfma_f32_16x16x32_bf16 v[96:99], a[244:247], a[144:147], v[96:99]
    s_mul_i32 s47, s56, 245760
    v_permlane16_swap_b32 v81, v83
    v_mfma_f32_16x16x32_bf16 v[96:99], a[240:243], a[128:131], v[96:99]
    s_lshl_b32 s56, s56, 5
    ds_read_b64_tr_b16 a[240:241], v8 offset:1024
    v_cvt_pk_bf16_f32 v91, v94, v95
    v_mfma_f32_16x16x32_bf16 v[100:103], a[224:227], a[96:99], v[100:103]
    s_add_u32 s56, s56, s54
    ds_read_b64_tr_b16 a[242:243], v8 offset:7168
    v_accvgpr_write_b32 a4, v72
    v_mfma_f32_16x16x32_bf16 v[100:103], a[228:231], a[112:115], v[100:103]
    buffer_load_dwordx4 v6, s[16:19], s39 offen lds
    v_mfma_f32_16x16x32_bf16 v[108:111], a[228:231], a[116:119], v[108:111]
    s_add_u32 s39, s40, 36864
    ds_read_b64_tr_b16 a[244:245], v8 offset:13312
    v_accvgpr_write_b32 a5, v73
    v_mfma_f32_16x16x32_bf16 v[108:111], a[224:227], a[100:103], v[108:111]
    s_addk_i32 m0, 4096
    ds_read_b64_tr_b16 a[246:247], v8 offset:19456
    v_accvgpr_write_b32 a6, v74
    v_mfma_f32_16x16x32_bf16 v[116:119], a[224:227], a[104:107], v[116:119]
    s_mul_i32 s61, s56, 24576
    v_permlane16_swap_b32 v89, v91
    v_mfma_f32_16x16x32_bf16 v[116:119], a[228:231], a[120:123], v[116:119]
    s_waitcnt lgkmcnt(4)
    v_accvgpr_write_b32 a7, v75
    v_accvgpr_write_b32 a8, v80
    v_mfma_f32_16x16x32_bf16 v[124:127], a[228:231], a[124:127], v[124:127]
    s_mov_b32 s72, s7
    v_accvgpr_write_b32 a9, v81
    v_accvgpr_write_b32 a10, v82
    v_mfma_f32_16x16x32_bf16 v[124:127], a[224:227], a[108:111], v[124:127]
    buffer_load_dwordx4 v6, s[16:19], s39 offen lds
    v_mfma_f32_16x16x32_bf16 v[124:127], a[232:235], a[140:143], v[124:127]
    s_mov_b32 s73, s7
    ds_read_b64_tr_b16 a[224:225], v8 offset:25600
    v_accvgpr_write_b32 a11, v83
    v_mfma_f32_16x16x32_bf16 v[124:127], a[236:239], a[156:159], v[124:127]
    s_mov_b32 s74, s7
    ds_read_b64_tr_b16 a[226:227], v8 offset:31744
    v_accvgpr_write_b32 a12, v88
    v_mfma_f32_16x16x32_bf16 v[116:119], a[236:239], a[152:155], v[116:119]
    s_mov_b32 s75, s7
    ds_read_b64_tr_b16 a[228:229], v8 offset:37888
    v_accvgpr_write_b32 a13, v89
    v_mfma_f32_16x16x32_bf16 v[116:119], a[232:235], a[136:139], v[116:119]
    s_lshl_b32 s56, s50, 6
    ds_read_b64_tr_b16 a[230:231], v8 offset:44032
    v_accvgpr_write_b32 a14, v90
    v_mfma_f32_16x16x32_bf16 v[108:111], a[232:235], a[132:135], v[108:111]
    s_xor_b32 s56, s56, 192
    v_xor_b32 v2, s56, v7
    v_xor_b32 v3, 128, v2
    v_mfma_f32_16x16x32_bf16 v[108:111], a[236:239], a[148:151], v[108:111]
    s_waitcnt lgkmcnt(4)
    v_accvgpr_write_b32 a15, v91
    v_cvt_pk_bf16_f32 v96, v96, v97
    v_mfma_f32_16x16x32_bf16 v[100:103], a[236:239], a[144:147], v[100:103]
    s_and_b32 s56, s51, 1
    v_cvt_pk_bf16_f32 v97, v98, v99
    v_cvt_pk_bf16_f32 v104, v104, v105
    v_mfma_f32_16x16x32_bf16 v[100:103], a[232:235], a[128:131], v[100:103]
    s_lshl_b32 s56, s56, 6
    ds_read_b64_tr_b16 a[232:233], v9 offset:1024
    v_cvt_pk_bf16_f32 v105, v106, v107
    v_mfma_f32_16x16x32_bf16 v[128:131], a[240:243], a[96:99], v[128:131]
    s_mul_i32 s57, s3, 10240
    ds_read_b64_tr_b16 a[234:235], v9 offset:7168
    v_cvt_pk_bf16_f32 v106, v108, v109
    v_mfma_f32_16x16x32_bf16 v[128:131], a[244:247], a[112:115], v[128:131]
    s_add_u32 s56, s56, s57
    ds_read_b64_tr_b16 a[236:237], v9 offset:13312
    v_add_u32 v21, s56, v21
    v_mfma_f32_16x16x32_bf16 v[136:139], a[244:247], a[116:119], v[136:139]
    s_and_b32 s56, s51, 1
    ds_read_b64_tr_b16 a[238:239], v9 offset:19456
    v_add_u32 v2, v2, v21
    v_mfma_f32_16x16x32_bf16 v[136:139], a[240:243], a[100:103], v[136:139]
    s_xor_b32 s56, s56, 1
    v_add_u32 v3, v3, v21
    v_and_b32 v21, 3, v1
    v_mfma_f32_16x16x32_bf16 v[144:147], a[240:243], a[104:107], v[144:147]
    s_lshl_b32 s56, s56, 8
    v_lshlrev_b32 v21, 4, v21
    v_xor_b32 v21, v21, v22
    v_mfma_f32_16x16x32_bf16 v[144:147], a[244:247], a[120:123], v[144:147]
    s_waitcnt lgkmcnt(4)
    v_lshrrev_b32 v22, 2, v1
    v_mul_u32_u24 v22, 1280, v22
    v_mfma_f32_16x16x32_bf16 v[152:155], a[244:247], a[124:127], v[152:155]
    s_and_b32 s57, s3, 1
    v_add_u32 v21, v21, v22
    v_min_u32 v22, 11, v1
    v_mfma_f32_16x16x32_bf16 v[152:155], a[240:243], a[108:111], v[152:155]
    s_mul_i32 s57, s57, 20480
    ds_read_b64_tr_b16 a[240:241], v9 offset:25600
    v_lshlrev_b32 v22, 7, v22
    v_mfma_f32_16x16x32_bf16 v[152:155], a[224:227], a[140:143], v[152:155]
    s_add_u32 s56, s56, s57
    ds_read_b64_tr_b16 a[242:243], v9 offset:31744
    v_add_u32 v7, s56, v21
    v_mfma_f32_16x16x32_bf16 v[152:155], a[228:231], a[156:159], v[152:155]
    s_lshr_b32 s42, s2, 3
    ds_read_b64_tr_b16 a[244:245], v9 offset:37888
    v_mov_b32 v21, 0x3f803f80
    v_mfma_f32_16x16x32_bf16 v[144:147], a[228:231], a[152:155], v[144:147]
    s_lshl_b32 s42, s42, 2
    ds_read_b64_tr_b16 a[246:247], v9 offset:44032
    v_accvgpr_write_b32 a248, v21
    v_mfma_f32_16x16x32_bf16 v[144:147], a[224:227], a[136:139], v[144:147]
    s_add_u32 s42, s42, s3
    v_accvgpr_write_b32 a249, v21
    v_accvgpr_write_b32 a250, v21
    v_mfma_f32_16x16x32_bf16 v[136:139], a[224:227], a[132:135], v[136:139]
    s_mul_i32 s42, s42, 7680
    v_accvgpr_write_b32 a251, v21
    v_cvt_pk_bf16_f32 v98, v100, v101
    v_mfma_f32_16x16x32_bf16 v[136:139], a[228:231], a[148:151], v[136:139]
    s_waitcnt lgkmcnt(4)
    v_permlane16_swap_b32 v96, v98
    v_mfma_f32_16x16x32_bf16 v[128:131], a[228:231], a[144:147], v[128:131]
    v_permlane16_swap_b32 v104, v106
    v_mfma_f32_16x16x32_bf16 v[128:131], a[224:227], a[128:131], v[128:131]
    ds_read_b64_tr_b16 a[224:225], v10 offset:1024
    v_cvt_pk_bf16_f32 v99, v102, v103
    v_mfma_f32_16x16x32_bf16 v[132:135], a[232:235], a[96:99], v[132:135]
pg_4:
    s_cbranch_execz pg_8
    ds_read_b64_tr_b16 a[226:227], v10 offset:7168
    v_cvt_pk_bf16_f32 v107, v110, v111
    v_mfma_f32_16x16x32_bf16 v[132:135], a[236:239], a[112:115], v[132:135]
    ds_read_b64_tr_b16 a[228:229], v10 offset:13312
    v_cvt_pk_bf16_f32 v112, v112, v113
    v_mfma_f32_16x16x32_bf16 v[140:143], a[236:239], a[116:119], v[140:143]
    ds_read_b64_tr_b16 a[230:231], v10 offset:19456
    v_cvt_pk_bf16_f32 v113, v114, v115
    v_mfma_f32_16x16x32_bf16 v[140:143], a[232:235], a[100:103], v[140:143]
    v_permlane16_swap_b32 v97, v99
    v_mfma_f32_16x16x32_bf16 v[148:151], a[232:235], a[104:107], v[148:151]
    s_waitcnt vmcnt(10)
    v_permlane16_swap_b32 v105, v107
    v_mfma_f32_16x16x32_bf16 v[148:151], a[236:239], a[120:123], v[148:151]
    buffer_store_dword v26, v27, s[24:27], s4 offen offset:144 sc1
    v_mfma_f32_16x16x32_bf16 v[156:159], a[236:239], a[124:127], v[156:159]
    s_waitcnt lgkmcnt(3)
    v_cvt_pk_bf16_f32 v114, v116, v117
    v_cvt_pk_bf16_f32 v115, v118, v119
    v_mfma_f32_16x16x32_bf16 v[156:159], a[232:235], a[108:111], v[156:159]
    ds_read_b64_tr_b16 a[232:233], v10 offset:25600
    v_accvgpr_write_b32 a16, v96
    v_mfma_f32_16x16x32_bf16 v[156:159], a[240:243], a[140:143], v[156:159]
    ds_read_b64_tr_b16 a[234:235], v10 offset:31744
    v_accvgpr_write_b32 a17, v97
    v_mfma_f32_16x16x32_bf16 v[156:159], a[244:247], a[156:159], v[156:159]
    ds_read_b64_tr_b16 a[236:237], v10 offset:37888
    v_accvgpr_write_b32 a18, v98
    v_mfma_f32_16x16x32_bf16 v[148:151], a[244:247], a[152:155], v[148:151]
    ds_read_b64_tr_b16 a[238:239], v10 offset:44032
    v_accvgpr_write_b32 a19, v99
    v_mfma_f32_16x16x32_bf16 v[148:151], a[240:243], a[136:139], v[148:151]
    v_permlane16_swap_b32 v112, v114
    v_mfma_f32_16x16x32_bf16 v[140:143], a[240:243], a[132:135], v[140:143]
    v_permlane16_swap_b32 v113, v115
    v_mfma_f32_16x16x32_bf16 v[140:143], a[244:247], a[148:151], v[140:143]
    s_waitcnt lgkmcnt(4)
    v_cvt_pk_bf16_f32 v120, v120, v121
    v_cvt_pk_bf16_f32 v121, v122, v123
    v_mfma_f32_16x16x32_bf16 v[132:135], a[244:247], a[144:147], v[132:135]
    v_cvt_pk_bf16_f32 v122, v124, v125
    v_cvt_pk_bf16_f32 v123, v126, v127
    v_mfma_f32_16x16x32_bf16 v[132:135], a[240:243], a[128:131], v[132:135]
    ds_read_b64_tr_b16 a[240:241], v11 offset:1024
    v_accvgpr_write_b32 a20, v104
    v_mfma_f32_16x16x32_bf16 v[160:163], a[224:227], a[96:99], v[160:163]
    ds_read_b64_tr_b16 a[242:243], v11 offset:7168
    v_accvgpr_write_b32 a21, v105
    v_mfma_f32_16x16x32_bf16 v[160:163], a[228:231], a[112:115], v[160:163]
    ds_read_b64_tr_b16 a[244:245], v11 offset:13312
    v_accvgpr_write_b32 a22, v106
    v_mfma_f32_16x16x32_bf16 v[168:171], a[228:231], a[116:119], v[168:171]
    ds_read_b64_tr_b16 a[246:247], v11 offset:19456
    v_accvgpr_write_b32 a23, v107
    v_mfma_f32_16x16x32_bf16 v[168:171], a[224:227], a[100:103], v[168:171]
    v_permlane16_swap_b32 v120, v122
    v_mfma_f32_16x16x32_bf16 v[176:179], a[224:227], a[104:107], v[176:179]
    v_permlane16_swap_b32 v121, v123
    v_mfma_f32_16x16x32_bf16 v[176:179], a[228:231], a[120:123], v[176:179]
    s_waitcnt lgkmcnt(4)
    v_accvgpr_write_b32 a24, v112
    v_accvgpr_write_b32 a25, v113
    v_mfma_f32_16x16x32_bf16 v[184:187], a[228:231], a[124:127], v[184:187]
    v_accvgpr_write_b32 a26, v114
    v_accvgpr_write_b32 a27, v115
    v_mfma_f32_16x16x32_bf16 v[184:187], a[224:227], a[108:111], v[184:187]
    ds_read_b64_tr_b16 a[224:225], v11 offset:25600
    v_accvgpr_write_b32 a28, v120
    v_mfma_f32_16x16x32_bf16 v[184:187], a[232:235], a[140:143], v[184:187]
    ds_read_b64_tr_b16 a[226:227], v11 offset:31744
    v_accvgpr_write_b32 a29, v121
    v_mfma_f32_16x16x32_bf16 v[184:187], a[236:239], a[156:159], v[184:187]
    ds_read_b64_tr_b16 a[228:229], v11 offset:37888
    v_accvgpr_write_b32 a30, v122
    v_mfma_f32_16x16x32_bf16 v[176:179], a[236:239], a[152:155], v[176:179]
    ds_read_b64_tr_b16 a[230:231], v11 offset:44032
    v_accvgpr_write_b32 a31, v123
    v_mfma_f32_16x16x32_bf16 v[176:179], a[232:235], a[136:139], v[176:179]
    v_cvt_pk_bf16_f32 v128, v128, v129
    v_cvt_pk_bf16_f32 v129, v130, v131
    v_mfma_f32_16x16x32_bf16 v[168:171], a[232:235], a[132:135], v[168:171]
    v_cvt_pk_bf16_f32 v130, v132, v133
    v_cvt_pk_bf16_f32 v131, v134, v135
    v_mfma_f32_16x16x32_bf16 v[168:171], a[236:239], a[148:151], v[168:171]
    s_waitcnt lgkmcnt(4)
    v_permlane16_swap_b32 v128, v130
    v_mfma_f32_16x16x32_bf16 v[160:163], a[236:239], a[144:147], v[160:163]
    v_permlane16_swap_b32 v129, v131
    v_mfma_f32_16x16x32_bf16 v[160:163], a[232:235], a[128:131], v[160:163]
    ds_read_b64_tr_b16 a[232:233], v8 offset:2048
    v_cvt_pk_bf16_f32 v136, v136, v137
    v_mfma_f32_16x16x32_bf16 v[164:167], a[240:243], a[96:99], v[164:167]
    ds_read_b64_tr_b16 a[234:235], v8 offset:8192
    v_cvt_pk_bf16_f32 v137, v138, v139
    v_mfma_f32_16x16x32_bf16 v[164:167], a[244:247], a[112:115], v[164:167]
    ds_read_b64_tr_b16 a[236:237], v8 offset:14336
    v_cvt_pk_bf16_f32 v138, v140, v141
    v_mfma_f32_16x16x32_bf16 v[172:175], a[244:247], a[116:119], v[172:175]
    ds_read_b64_tr_b16 a[238:239], v8 offset:20480
    v_cvt_pk_bf16_f32 v139, v142, v143
    v_mfma_f32_16x16x32_bf16 v[172:175], a[240:243], a[100:103], v[172:175]
    v_permlane16_swap_b32 v136, v138
    v_mfma_f32_16x16x32_bf16 v[180:183], a[240:243], a[104:107], v[180:183]
    v_permlane16_swap_b32 v137, v139
    v_mfma_f32_16x16x32_bf16 v[180:183], a[244:247], a[120:123], v[180:183]
    s_waitcnt lgkmcnt(4)
    v_cvt_pk_bf16_f32 v144, v144, v145
    v_cvt_pk_bf16_f32 v145, v146, v147
    v_mfma_f32_16x16x32_bf16 v[188:191], a[244:247], a[124:127], v[188:191]
    v_cvt_pk_bf16_f32 v146, v148, v149
    v_cvt_pk_bf16_f32 v147, v150, v151
    v_mfma_f32_16x16x32_bf16 v[188:191], a[240:243], a[108:111], v[188:191]
    ds_read_b64_tr_b16 a[240:241], v8 offset:26624
    v_accvgpr_write_b32 a32, v128
    v_mfma_f32_16x16x32_bf16 v[188:191], a[224:227], a[140:143], v[188:191]
    ds_read_b64_tr_b16 a[242:243], v8 offset:32768
    v_accvgpr_write_b32 a33, v129
    v_mfma_f32_16x16x32_bf16 v[188:191], a[228:231], a[156:159], v[188:191]
    ds_read_b64_tr_b16 a[244:245], v8 offset:38912
    v_accvgpr_write_b32 a34, v130
    v_mfma_f32_16x16x32_bf16 v[180:183], a[228:231], a[152:155], v[180:183]
    ds_read_b64_tr_b16 a[246:247], v8 offset:45056
    v_accvgpr_write_b32 a35, v131
    v_mfma_f32_16x16x32_bf16 v[180:183], a[224:227], a[136:139], v[180:183]
    v_permlane16_swap_b32 v144, v146
    v_mfma_f32_16x16x32_bf16 v[172:175], a[224:227], a[132:135], v[172:175]
    s_add_u32 s88, s88, code_end-code0-65536
    s_addc_u32 s89, s89, 0
    v_cvt_pk_bf16_f32 v152, v152, v153
    v_mfma_f32_16x16x32_bf16 v[172:175], a[228:231], a[148:151], v[172:175]
    s_waitcnt lgkmcnt(4)
    v_permlane16_swap_b32 v145, v147
    v_mfma_f32_16x16x32_bf16 v[164:167], a[228:231], a[144:147], v[164:167]
    v_cvt_pk_bf16_f32 v153, v154, v155
    v_cvt_pk_bf16_f32 v154, v156, v157
    v_mfma_f32_16x16x32_bf16 v[164:167], a[224:227], a[128:131], v[164:167]
    ds_read_b64_tr_b16 a[224:225], v9 offset:2048
    v_cvt_pk_bf16_f32 v155, v158, v159
    v_mfma_f32_16x16x32_bf16 v[192:195], a[232:235], a[96:99], v[192:195]
    global_load_dword a252, v18, s[88:89]
    v_mfma_f32_16x16x32_bf16 v[192:195], a[236:239], a[112:115], v[192:195]
    ds_read_b64_tr_b16 a[226:227], v9 offset:8192
    v_accvgpr_write_b32 a36, v136
    v_mfma_f32_16x16x32_bf16 v[200:203], a[236:239], a[116:119], v[200:203]
    ds_read_b64_tr_b16 a[228:229], v9 offset:14336
    v_accvgpr_write_b32 a37, v137
    v_mfma_f32_16x16x32_bf16 v[200:203], a[232:235], a[100:103], v[200:203]
    ds_read_b64_tr_b16 a[230:231], v9 offset:20480
    v_accvgpr_write_b32 a38, v138
    v_mfma_f32_16x16x32_bf16 v[208:211], a[232:235], a[104:107], v[208:211]
    v_permlane16_swap_b32 v152, v154
    v_mfma_f32_16x16x32_bf16 v[208:211], a[236:239], a[120:123], v[208:211]
    s_waitcnt lgkmcnt(4)
    v_permlane16_swap_b32 v153, v155
    v_mfma_f32_16x16x32_bf16 v[216:219], a[236:239], a[124:127], v[216:219]
    v_accvgpr_write_b32 a39, v139
    v_accvgpr_write_b32 a40, v144
    v_mfma_f32_16x16x32_bf16 v[216:219], a[232:235], a[108:111], v[216:219]
    ds_read_b64_tr_b16 a[232:233], v9 offset:26624
    v_accvgpr_write_b32 a41, v145
    v_mfma_f32_16x16x32_bf16 v[216:219], a[240:243], a[140:143], v[216:219]
    ds_read_b64_tr_b16 a[234:235], v9 offset:32768
    v_accvgpr_write_b32 a42, v146
    v_mfma_f32_16x16x32_bf16 v[216:219], a[244:247], a[156:159], v[216:219]
    ds_read_b64_tr_b16 a[236:237], v9 offset:38912
    v_accvgpr_write_b32 a43, v147
    v_mfma_f32_16x16x32_bf16 v[208:211], a[244:247], a[152:155], v[208:211]
    ds_read_b64_tr_b16 a[238:239], v9 offset:45056
    v_accvgpr_write_b32 a44, v152
    v_mfma_f32_16x16x32_bf16 v[208:211], a[240:243], a[136:139], v[208:211]
    v_accvgpr_write_b32 a45, v153
    v_accvgpr_write_b32 a46, v154
    v_mfma_f32_16x16x32_bf16 v[200:203], a[240:243], a[132:135], v[200:203]
    v_accvgpr_write_b32 a47, v155
    v_cvt_pk_bf16_f32 v160, v160, v161
    v_mfma_f32_16x16x32_bf16 v[200:203], a[244:247], a[148:151], v[200:203]
    s_waitcnt lgkmcnt(4)
    v_cvt_pk_bf16_f32 v161, v162, v163
    v_cvt_pk_bf16_f32 v162, v164, v165
    v_mfma_f32_16x16x32_bf16 v[192:195], a[244:247], a[144:147], v[192:195]
    v_cvt_pk_bf16_f32 v163, v166, v167
    v_cvt_pk_bf16_f32 v168, v168, v169
    v_mfma_f32_16x16x32_bf16 v[192:195], a[240:243], a[128:131], v[192:195]
    ds_read_b64_tr_b16 a[240:241], v10 offset:2048
    v_cvt_pk_bf16_f32 v169, v170, v171
    v_mfma_f32_16x16x32_bf16 v[196:199], a[224:227], a[96:99], v[196:199]
    ds_read_b64_tr_b16 a[242:243], v10 offset:8192
    v_cvt_pk_bf16_f32 v170, v172, v173
    v_mfma_f32_16x16x32_bf16 v[196:199], a[228:231], a[112:115], v[196:199]
    ds_read_b64_tr_b16 a[244:245], v10 offset:14336
    v_cvt_pk_bf16_f32 v171, v174, v175
    v_mfma_f32_16x16x32_bf16 v[204:207], a[228:231], a[116:119], v[204:207]
    ds_read_b64_tr_b16 a[246:247], v10 offset:20480
    v_cvt_pk_bf16_f32 v176, v176, v177
    v_mfma_f32_16x16x32_bf16 v[204:207], a[224:227], a[100:103], v[204:207]
    v_permlane16_swap_b32 v160, v162
    v_mfma_f32_16x16x32_bf16 v[212:215], a[224:227], a[104:107], v[212:215]
    v_permlane16_swap_b32 v161, v163
    v_mfma_f32_16x16x32_bf16 v[212:215], a[228:231], a[120:123], v[212:215]
    s_waitcnt lgkmcnt(4)
    v_permlane16_swap_b32 v168, v170
    v_mfma_f32_16x16x32_bf16 v[220:223], a[228:231], a[124:127], v[220:223]
    v_permlane16_swap_b32 v169, v171
    v_mfma_f32_16x16x32_bf16 v[220:223], a[224:227], a[108:111], v[220:223]
    ds_read_b64_tr_b16 a[224:225], v10 offset:26624
    v_cvt_pk_bf16_f32 v177, v178, v179
    v_mfma_f32_16x16x32_bf16 v[220:223], a[232:235], a[140:143], v[220:223]
    ds_read_b64_tr_b16 a[226:227], v10 offset:32768
    v_cvt_pk_bf16_f32 v178, v180, v181
    v_mfma_f32_16x16x32_bf16 v[220:223], a[236:239], a[156:159], v[220:223]
    ds_read_b64_tr_b16 a[228:229], v10 offset:38912
    v_cvt_pk_bf16_f32 v179, v182, v183
    v_mfma_f32_16x16x32_bf16 v[212:215], a[236:239], a[152:155], v[212:215]
    ds_read_b64_tr_b16 a[230:231], v10 offset:45056
    v_accvgpr_write_b32 a48, v160
    v_mfma_f32_16x16x32_bf16 v[212:215], a[232:235], a[136:139], v[212:215]
    v_permlane16_swap_b32 v176, v178
    v_mfma_f32_16x16x32_bf16 v[204:207], a[232:235], a[132:135], v[204:207]
    v_permlane16_swap_b32 v177, v179
    v_mfma_f32_16x16x32_bf16 v[204:207], a[236:239], a[148:151], v[204:207]
    s_waitcnt lgkmcnt(4)
    v_accvgpr_write_b32 a49, v161
    v_accvgpr_write_b32 a50, v162
    v_mfma_f32_16x16x32_bf16 v[196:199], a[236:239], a[144:147], v[196:199]
    v_accvgpr_write_b32 a51, v163
    v_cvt_pk_bf16_f32 v184, v184, v185
    v_mfma_f32_16x16x32_bf16 v[196:199], a[232:235], a[128:131], v[196:199]
    ds_read_b64_tr_b16 a[232:233], v11 offset:2048
    v_cvt_pk_bf16_f32 v185, v186, v187
    ds_read_b64_tr_b16 a[234:235], v11 offset:8192
    v_mfma_f32_16x16x32_bf16 v[224:227], a[240:243], a[96:99], v[224:227]
    ds_read_b64_tr_b16 a[236:237], v11 offset:14336
    v_cvt_pk_bf16_f32 v186, v188, v189
    ds_read_b64_tr_b16 a[238:239], v11 offset:20480
    v_mfma_f32_16x16x32_bf16 v[224:227], a[244:247], a[112:115], v[224:227]
    v_permlane16_swap_b32 v184, v186
    v_mfma_f32_16x16x32_bf16 v[232:235], a[244:247], a[116:119], v[232:235]
    v_cvt_pk_bf16_f32 v187, v190, v191
    v_accvgpr_write_b32 a52, v168
    v_mfma_f32_16x16x32_bf16 v[232:235], a[240:243], a[100:103], v[232:235]
    v_permlane16_swap_b32 v185, v187
    v_mfma_f32_16x16x32_bf16 v[240:243], a[240:243], a[104:107], v[240:243]
    v_accvgpr_write_b32 a53, v169
    v_accvgpr_write_b32 a54, v170
    v_mfma_f32_16x16x32_bf16 v[240:243], a[244:247], a[120:123], v[240:243]
    s_waitcnt lgkmcnt(4)
    v_accvgpr_write_b32 a55, v171
    v_accvgpr_write_b32 a56, v176
    v_mfma_f32_16x16x32_bf16 v[248:251], a[244:247], a[124:127], v[248:251]
    s_waitcnt lgkmcnt(0)
    s_barrier
    v_mfma_f32_16x16x32_bf16 v[248:251], a[240:243], a[108:111], v[248:251]
    s_add_u32 m0, s49, 49152
    ds_read_b128 a[184:187], v12 offset:0
    v_accvgpr_write_b32 a57, v177
    v_mfma_f32_16x16x32_bf16 v[248:251], a[224:227], a[140:143], v[248:251]
    ds_read_b128 a[188:191], v13 offset:0
    v_accvgpr_write_b32 a58, v178
    v_mfma_f32_16x16x32_bf16 v[248:251], a[228:231], a[156:159], v[248:251]
    ds_read_b128 a[192:195], v12 offset:1024
    v_accvgpr_write_b32 a59, v179
    v_mfma_f32_16x16x32_bf16 v[240:243], a[228:231], a[152:155], v[240:243]
    ds_read_b128 a[196:199], v13 offset:1024
    v_accvgpr_write_b32 a60, v184
    v_mfma_f32_16x16x32_bf16 v[240:243], a[224:227], a[136:139], v[240:243]
    ds_read_b128 a[200:203], v12 offset:2048
    v_accvgpr_write_b32 a61, v185
    v_mfma_f32_16x16x32_bf16 v[232:235], a[224:227], a[132:135], v[232:235]
    buffer_load_dwordx4 v4, s[12:15], s38 offen offset:0 lds
    v_mfma_f32_16x16x32_bf16 v[232:235], a[228:231], a[148:151], v[232:235]
    ds_read_b64_tr_b16 a[240:241], v11 offset:26624
    v_accvgpr_write_b32 a62, v186
    v_mfma_f32_16x16x32_bf16 v[224:227], a[228:231], a[144:147], v[224:227]
    ds_read_b64_tr_b16 a[242:243], v11 offset:32768
    v_accvgpr_write_b32 a63, v187
    v_mfma_f32_16x16x32_bf16 v[224:227], a[224:227], a[128:131], v[224:227]
    ds_read_b64_tr_b16 a[244:245], v11 offset:38912
    v_cvt_pk_bf16_f32 v192, v192, v193
    v_mfma_f32_16x16x32_bf16 v[228:231], a[232:235], a[96:99], v[228:231]
    ds_read_b64_tr_b16 a[246:247], v11 offset:45056
    v_cvt_pk_bf16_f32 v193, v194, v195
    v_mfma_f32_16x16x32_bf16 v[228:231], a[236:239], a[112:115], v[228:231]
    v_cvt_pk_bf16_f32 v194, v196, v197
    v_cvt_pk_bf16_f32 v195, v198, v199
    v_mfma_f32_16x16x32_bf16 v[236:239], a[236:239], a[116:119], v[236:239]
    s_addk_i32 m0, 896
    v_permlane16_swap_b32 v192, v194
    v_mfma_f32_16x16x32_bf16 v[236:239], a[232:235], a[100:103], v[236:239]
    v_permlane16_swap_b32 v193, v195
    v_mfma_f32_16x16x32_bf16 v[244:247], a[232:235], a[104:107], v[244:247]
    v_cvt_pk_bf16_f32 v200, v200, v201
    v_cvt_pk_bf16_f32 v201, v202, v203
    v_mfma_f32_16x16x32_bf16 v[244:247], a[236:239], a[120:123], v[244:247]
    s_waitcnt lgkmcnt(2)
    v_cvt_pk_bf16_f32 v202, v204, v205
    v_cvt_pk_bf16_f32 v203, v206, v207
    v_mfma_f32_16x16x32_bf16 v[252:255], a[236:239], a[124:127], v[252:255]
    ds_read_b128 a[204:207], v13 offset:2048
    v_cvt_pk_bf16_f32 v208, v208, v209
    v_mfma_f32_16x16x32_bf16 v[252:255], a[232:235], a[108:111], v[252:255]
    s_waitcnt lgkmcnt(1)
    v_permlane16_swap_b32 v200, v202
    v_mfma_f32_16x16x32_bf16 v[252:255], a[240:243], a[140:143], v[252:255]
    buffer_load_dwordx4 v4, s[12:15], s38 offen offset:128 lds
    v_mfma_f32_16x16x32_bf16 v[252:255], a[244:247], a[156:159], v[252:255]
    v_permlane16_swap_b32 v201, v203
    v_mfma_f32_16x16x32_bf16 v[244:247], a[244:247], a[152:155], v[244:247]
    ds_read_b128 a[208:211], v12 offset:6144
    v_cvt_pk_bf16_f32 v209, v210, v211
    v_mfma_f32_16x16x32_bf16 v[244:247], a[240:243], a[136:139], v[244:247]
    ds_read_b128 a[212:215], v13 offset:6144
    v_cvt_pk_bf16_f32 v210, v212, v213
    v_mfma_f32_16x16x32_bf16 v[236:239], a[240:243], a[132:135], v[236:239]
    ds_read_b128 a[216:219], v12 offset:7168
    v_cvt_pk_bf16_f32 v211, v214, v215
    v_mfma_f32_16x16x32_bf16 v[236:239], a[244:247], a[148:151], v[236:239]
    ds_read_b128 a[220:223], v13 offset:7168
    v_accvgpr_write_b32 a64, v192
    v_mfma_f32_16x16x32_bf16 v[228:231], a[244:247], a[144:147], v[228:231]
    s_addk_i32 m0, 896
    ds_read_b128 a[224:227], v12 offset:8192
    v_accvgpr_write_b32 a65, v193
    v_mfma_f32_16x16x32_bf16 v[228:231], a[240:243], a[128:131], v[228:231]
    ds_read_b128 a[228:231], v13 offset:8192
    v_accvgpr_write_b32 a66, v194
    v_mfma_f32_16x16x32_bf16 v[64:67], a[184:187], a[0:3], 0
    v_permlane16_swap_b32 v208, v210
    v_mfma_f32_16x16x32_bf16 v[64:67], a[188:191], a[16:19], v[64:67]
    v_permlane16_swap_b32 v209, v211
    v_mfma_f32_16x16x32_bf16 v[64:67], a[192:195], a[32:35], v[64:67]
    v_accvgpr_write_b32 a67, v195
    v_cvt_pk_bf16_f32 v216, v216, v217
    v_mfma_f32_16x16x32_bf16 v[64:67], a[196:199], a[48:51], v[64:67]
    v_cvt_pk_bf16_f32 v217, v218, v219
    v_cvt_pk_bf16_f32 v218, v220, v221
    v_mfma_f32_16x16x32_bf16 v[64:67], a[200:203], a[64:67], v[64:67]
    buffer_load_dwordx4 v4, s[12:15], s38 offen offset:256 lds
    v_accvgpr_write_b32 a68, v200
    v_accvgpr_write_b32 a69, v201
    v_accvgpr_write_b32 a70, v202
    v_accvgpr_write_b32 a71, v203
    s_nop 1
    v_mfma_f32_16x16x32_bf16 v[72:75], a[200:203], a[68:71], 0
    v_permlane16_swap_b32 v216, v218
    v_mfma_f32_16x16x32_bf16 v[72:75], a[196:199], a[52:55], v[72:75]
    v_cvt_pk_bf16_f32 v219, v222, v223
    v_accvgpr_write_b32 a72, v208
    v_mfma_f32_16x16x32_bf16 v[72:75], a[192:195], a[36:39], v[72:75]
    v_permlane16_swap_b32 v217, v219
    v_mfma_f32_16x16x32_bf16 v[72:75], a[188:191], a[20:23], v[72:75]
    v_accvgpr_write_b32 a73, v209
    v_accvgpr_write_b32 a74, v210
    v_mfma_f32_16x16x32_bf16 v[72:75], a[184:187], a[4:7], v[72:75]
    v_accvgpr_write_b32 a75, v211
    v_accvgpr_write_b32 a76, v216
    v_mfma_f32_16x16x32_bf16 v[80:83], a[184:187], a[8:11], 0
    s_addk_i32 m0, 1280
    v_accvgpr_write_b32 a77, v217
    v_accvgpr_write_b32 a78, v218
    v_mfma_f32_16x16x32_bf16 v[80:83], a[188:191], a[24:27], v[80:83]
    v_accvgpr_write_b32 a79, v219
    v_cvt_pk_bf16_f32 v224, v224, v225
    v_mfma_f32_16x16x32_bf16 v[80:83], a[192:195], a[40:43], v[80:83]
    v_cvt_pk_bf16_f32 v225, v226, v227
    v_cvt_pk_bf16_f32 v226, v228, v229
    v_mfma_f32_16x16x32_bf16 v[80:83], a[196:199], a[56:59], v[80:83]
    v_cvt_pk_bf16_f32 v227, v230, v231
    v_cvt_pk_bf16_f32 v232, v232, v233
    v_mfma_f32_16x16x32_bf16 v[80:83], a[200:203], a[72:75], v[80:83]
    v_permlane16_swap_b32 v224, v226
    v_mfma_f32_16x16x32_bf16 v[88:91], a[200:203], a[76:79], 0
    v_permlane16_swap_b32 v225, v227
    v_mfma_f32_16x16x32_bf16 v[88:91], a[196:199], a[60:63], v[88:91]
    buffer_load_dwordx4 v5, s[12:15], s38 offen offset:0 lds
    v_mfma_f32_16x16x32_bf16 v[88:91], a[192:195], a[44:47], v[88:91]
    s_waitcnt lgkmcnt(0)
    v_cvt_pk_bf16_f32 v233, v234, v235
    v_cvt_pk_bf16_f32 v234, v236, v237
    v_mfma_f32_16x16x32_bf16 v[88:91], a[188:191], a[28:31], v[88:91]
    v_cvt_pk_bf16_f32 v235, v238, v239
    v_cvt_pk_bf16_f32 v240, v240, v241
    v_mfma_f32_16x16x32_bf16 v[88:91], a[184:187], a[12:15], v[88:91]
    ds_read_b128 a[184:187], v12 offset:12288
    v_cvt_pk_bf16_f32 v241, v242, v243
    v_mfma_f32_16x16x32_bf16 v[64:67], a[204:207], v[224:227], v[64:67]
    ds_read_b128 a[188:191], v13 offset:12288
    v_cvt_pk_bf16_f32 v242, v244, v245
    v_permlane16_swap_b32 v232, v234
    v_permlane16_swap_b32 v233, v235
    s_nop 1
    v_mfma_f32_16x16x32_bf16 v[72:75], a[204:207], v[232:235], v[72:75]
    ds_read_b128 a[192:195], v12 offset:13312
    v_cvt_pk_bf16_f32 v243, v246, v247
    v_permlane16_swap_b32 v240, v242
    v_cvt_pk_bf16_f32 v248, v248, v249
    v_permlane16_swap_b32 v241, v243
    s_nop 1
    v_mfma_f32_16x16x32_bf16 v[80:83], a[204:207], v[240:243], v[80:83]
    s_addk_i32 m0, 896
    ds_read_b128 a[196:199], v13 offset:13312
    v_cvt_pk_bf16_f32 v249, v250, v251
    v_cvt_pk_bf16_f32 v250, v252, v253
    v_cvt_pk_bf16_f32 v251, v254, v255
    v_accvgpr_write_b32 a80, v224
    v_permlane16_swap_b32 v248, v250
    v_permlane16_swap_b32 v249, v251
    s_nop 1
    v_mfma_f32_16x16x32_bf16 v[88:91], a[204:207], v[248:251], v[88:91]
    ds_read_b128 a[200:203], v12 offset:14336
    v_accvgpr_write_b32 a81, v225
    v_mfma_f32_16x16x32_bf16 v[24:27], a[208:211], a[0:3], 0
    ds_read_b128 a[204:207], v13 offset:14336
    v_accvgpr_write_b32 a82, v226
    v_mfma_f32_16x16x32_bf16 v[24:27], a[212:215], a[16:19], v[24:27]
    v_exp_f32 v64, v64
    v_mfma_f32_16x16x32_bf16 v[24:27], a[216:219], a[32:35], v[24:27]
    v_exp_f32 v65, v65
    v_mfma_f32_16x16x32_bf16 v[24:27], a[220:223], a[48:51], v[24:27]
    v_exp_f32 v66, v66
    v_mfma_f32_16x16x32_bf16 v[24:27], a[224:227], a[64:67], v[24:27]
    buffer_load_dwordx4 v5, s[12:15], s38 offen offset:128 lds
    v_accvgpr_write_b32 a83, v227
    s_nop 1
    v_mfma_f32_16x16x32_bf16 v[24:27], a[228:231], a[80:83], v[24:27]
    v_exp_f32 v67, v67
    v_accvgpr_write_b32 a84, v232
    v_accvgpr_write_b32 a85, v233
    v_accvgpr_write_b32 a86, v234
    v_accvgpr_write_b32 a87, v235
    s_nop 1
    v_mfma_f32_16x16x32_bf16 v[28:31], a[228:231], a[84:87], 0
    v_exp_f32 v72, v72
    v_mfma_f32_16x16x32_bf16 v[28:31], a[224:227], a[68:71], v[28:31]
    v_exp_f32 v73, v73
    v_mfma_f32_16x16x32_bf16 v[28:31], a[220:223], a[52:55], v[28:31]
    v_exp_f32 v74, v74
    v_mfma_f32_16x16x32_bf16 v[28:31], a[216:219], a[36:39], v[28:31]
    v_exp_f32 v75, v75
    v_mfma_f32_16x16x32_bf16 v[28:31], a[212:215], a[20:23], v[28:31]
    s_addk_i32 m0, 896
    v_exp_f32 v80, v80
    v_mfma_f32_16x16x32_bf16 v[28:31], a[208:211], a[4:7], v[28:31]
    v_exp_f32 v81, v81
    v_mfma_f32_16x16x32_bf16 v[32:35], a[208:211], a[8:11], 0
    v_exp_f32 v82, v82
    v_mfma_f32_16x16x32_bf16 v[32:35], a[212:215], a[24:27], v[32:35]
    v_exp_f32 v83, v83
    v_mfma_f32_16x16x32_bf16 v[32:35], a[216:219], a[40:43], v[32:35]
    v_exp_f32 v88, v88
    v_mfma_f32_16x16x32_bf16 v[32:35], a[220:223], a[56:59], v[32:35]
    v_exp_f32 v89, v89
    v_mfma_f32_16x16x32_bf16 v[32:35], a[224:227], a[72:75], v[32:35]
    buffer_load_dwordx4 v5, s[12:15], s38 offen offset:256 lds
    v_accvgpr_write_b32 a88, v240
    v_accvgpr_write_b32 a89, v241
    v_accvgpr_write_b32 a90, v242
    v_accvgpr_write_b32 a91, v243
    s_nop 1
    v_mfma_f32_16x16x32_bf16 v[32:35], a[228:231], a[88:91], v[32:35]
    s_add_u32 s38, s38, 24576
    v_exp_f32 v90, v90
    v_accvgpr_write_b32 a92, v248
    v_accvgpr_write_b32 a93, v249
    v_accvgpr_write_b32 a94, v250
    v_accvgpr_write_b32 a95, v251
    s_nop 1
    v_mfma_f32_16x16x32_bf16 v[36:39], a[228:231], a[92:95], 0
    v_exp_f32 v91, v91
    v_mfma_f32_16x16x32_bf16 v[36:39], a[224:227], a[76:79], v[36:39]
    v_cvt_pk_bf16_f32 v64, v64, v65
    v_cvt_pk_bf16_f32 v65, v66, v67
    v_mfma_f32_16x16x32_bf16 v[36:39], a[220:223], a[60:63], v[36:39]
    s_add_u32 s39, s40, 49152
    v_exp_f32 v24, v24
    v_mfma_f32_16x16x32_bf16 v[36:39], a[216:219], a[44:47], v[36:39]
    s_waitcnt lgkmcnt(0)
    v_exp_f32 v25, v25
    v_mfma_f32_16x16x32_bf16 v[36:39], a[212:215], a[28:31], v[36:39]
    s_add_u32 m0, s63, 90112
    ds_read_b128 a[212:215], v13 offset:18432
    v_cvt_pk_bf16_f32 v72, v72, v73
    v_mfma_f32_16x16x32_bf16 v[36:39], a[208:211], a[12:15], v[36:39]
    ds_read_b128 a[220:223], v13 offset:19456
    v_cvt_pk_bf16_f32 v73, v74, v75
    v_mfma_f32_16x16x32_bf16 v[68:71], a[184:187], a[0:3], 0
    ds_read_b128 a[208:211], v12 offset:18432
    v_cvt_pk_bf16_f32 v80, v80, v81
    v_mfma_f32_16x16x32_bf16 v[68:71], a[188:191], a[16:19], v[68:71]
    ds_read_b128 a[216:219], v12 offset:19456
    v_cvt_pk_bf16_f32 v81, v82, v83
    v_mfma_f32_16x16x32_bf16 v[68:71], a[192:195], a[32:35], v[68:71]
    ds_read_b128 a[224:227], v12 offset:20480
    v_cvt_pk_bf16_f32 v88, v88, v89
    v_mfma_f32_16x16x32_bf16 v[68:71], a[196:199], a[48:51], v[68:71]
    ds_read_b128 a[228:231], v13 offset:20480
    v_cvt_pk_bf16_f32 v89, v90, v91
    v_mfma_f32_16x16x32_bf16 v[68:71], a[200:203], a[64:67], v[68:71]
    buffer_load_dwordx4 v6, s[16:19], s39 offen lds
    v_mfma_f32_16x16x32_bf16 v[68:71], a[204:207], a[80:83], v[68:71]
    v_exp_f32 v26, v26
    v_mfma_f32_16x16x32_bf16 v[76:79], a[204:207], a[84:87], 0
    v_exp_f32 v27, v27
    v_mfma_f32_16x16x32_bf16 v[76:79], a[200:203], a[68:71], v[76:79]
    v_exp_f32 v28, v28
    v_mfma_f32_16x16x32_bf16 v[76:79], a[196:199], a[52:55], v[76:79]
    s_add_u32 s39, s40, 61440
    v_exp_f32 v29, v29
    v_mfma_f32_16x16x32_bf16 v[76:79], a[192:195], a[36:39], v[76:79]
    v_exp_f32 v30, v30
    v_mfma_f32_16x16x32_bf16 v[76:79], a[188:191], a[20:23], v[76:79]
    s_addk_i32 m0, 4096
    v_exp_f32 v31, v31
    v_mfma_f32_16x16x32_bf16 v[76:79], a[184:187], a[4:7], v[76:79]
    v_cvt_pk_bf16_f32 v66, v24, v25
    v_cvt_pk_bf16_f32 v67, v26, v27
    v_mfma_f32_16x16x32_bf16 v[84:87], a[184:187], a[8:11], 0
    v_exp_f32 v32, v32
    v_mfma_f32_16x16x32_bf16 v[84:87], a[188:191], a[24:27], v[84:87]
    v_exp_f32 v33, v33
    v_mfma_f32_16x16x32_bf16 v[84:87], a[192:195], a[40:43], v[84:87]
    v_exp_f32 v34, v34
    v_mfma_f32_16x16x32_bf16 v[84:87], a[196:199], a[56:59], v[84:87]
    v_exp_f32 v35, v35
    v_mfma_f32_16x16x32_bf16 v[84:87], a[200:203], a[72:75], v[84:87]
    buffer_load_dwordx4 v6, s[16:19], s39 offen lds
    v_mfma_f32_16x16x32_bf16 v[84:87], a[204:207], a[88:91], v[84:87]
    v_cvt_pk_bf16_f32 v74, v28, v29
    v_cvt_pk_bf16_f32 v75, v30, v31
    v_mfma_f32_16x16x32_bf16 v[92:95], a[204:207], a[92:95], 0
    v_exp_f32 v36, v36
    v_mfma_f32_16x16x32_bf16 v[92:95], a[200:203], a[76:79], v[92:95]
    v_exp_f32 v37, v37
    v_mfma_f32_16x16x32_bf16 v[92:95], a[196:199], a[60:63], v[92:95]
    v_exp_f32 v38, v38
    v_mfma_f32_16x16x32_bf16 v[92:95], a[192:195], a[44:47], v[92:95]
    s_waitcnt lgkmcnt(0)
    v_exp_f32 v39, v39
    v_mfma_f32_16x16x32_bf16 v[92:95], a[188:191], a[28:31], v[92:95]
    s_add_u32 m0, s49, 0
    v_add_u32 v8, v19, v8
    v_add_u32 v9, v19, v9
    v_mfma_f32_16x16x32_bf16 v[92:95], a[184:187], a[12:15], v[92:95]
    v_add_u32 v10, v19, v10
    v_add_u32 v11, v19, v11
    v_mfma_f32_16x16x32_bf16 v[40:43], a[208:211], a[0:3], 0
    s_waitcnt vmcnt(13)
    v_cvt_pk_bf16_f32 v82, v32, v33
    v_cvt_pk_bf16_f32 v83, v34, v35
    v_mfma_f32_16x16x32_bf16 v[40:43], a[212:215], a[16:19], v[40:43]
    s_barrier
    v_mfma_f32_16x16x32_bf16 v[40:43], a[216:219], a[32:35], v[40:43]
    ds_read_b128 a[184:187], v12 offset:24576
    v_cvt_pk_bf16_f32 v90, v36, v37
    v_mfma_f32_16x16x32_bf16 v[40:43], a[220:223], a[48:51], v[40:43]
    ds_read_b128 a[188:191], v13 offset:24576
    v_cvt_pk_bf16_f32 v91, v38, v39
    v_mfma_f32_16x16x32_bf16 v[40:43], a[224:227], a[64:67], v[40:43]
    buffer_load_dwordx4 v4, s[12:15], s38 offen offset:0 lds
    v_mfma_f32_16x16x32_bf16 v[40:43], a[228:231], a[80:83], v[40:43]
    v_exp_f32 v68, v68
    v_mfma_f32_16x16x32_bf16 v[44:47], a[228:231], a[84:87], 0
    v_exp_f32 v69, v69
    v_mfma_f32_16x16x32_bf16 v[44:47], a[224:227], a[68:71], v[44:47]
    ds_read_b128 a[192:195], v12 offset:25600
    v_cvt_pk_bf16_f32 v68, v68, v69
    v_mfma_f32_16x16x32_bf16 v[44:47], a[220:223], a[52:55], v[44:47]
    v_exp_f32 v70, v70
    v_mfma_f32_16x16x32_bf16 v[44:47], a[216:219], a[36:39], v[44:47]
    v_exp_f32 v71, v71
    v_mfma_f32_16x16x32_bf16 v[44:47], a[212:215], a[20:23], v[44:47]
pg_5:
    s_cbranch_execz pg_9
    s_addk_i32 m0, 896
    ds_read_b128 a[196:199], v13 offset:25600
    v_cvt_pk_bf16_f32 v69, v70, v71
    v_mfma_f32_16x16x32_bf16 v[44:47], a[208:211], a[4:7], v[44:47]
    v_exp_f32 v76, v76
    v_mfma_f32_16x16x32_bf16 v[48:51], a[208:211], a[8:11], 0
    buffer_load_dword a252, v22, s[32:35], s42 offen offset:0
    v_mfma_f32_16x16x32_bf16 v[48:51], a[212:215], a[24:27], v[48:51]
    v_exp_f32 v77, v77
    v_mfma_f32_16x16x32_bf16 v[48:51], a[216:219], a[40:43], v[48:51]
    ds_read_b128 a[200:203], v12 offset:26624
    v_cvt_pk_bf16_f32 v76, v76, v77
    v_mfma_f32_16x16x32_bf16 v[48:51], a[220:223], a[56:59], v[48:51]
    v_exp_f32 v78, v78
    v_mfma_f32_16x16x32_bf16 v[48:51], a[224:227], a[72:75], v[48:51]
    buffer_load_dwordx4 v4, s[12:15], s38 offen offset:128 lds
    v_mfma_f32_16x16x32_bf16 v[48:51], a[228:231], a[88:91], v[48:51]
    v_exp_f32 v79, v79
    v_mfma_f32_16x16x32_bf16 v[52:55], a[228:231], a[92:95], 0
    ds_read_b128 a[204:207], v13 offset:26624
    v_cvt_pk_bf16_f32 v77, v78, v79
    v_mfma_f32_16x16x32_bf16 v[52:55], a[224:227], a[76:79], v[52:55]
    v_exp_f32 v84, v84
    v_mfma_f32_16x16x32_bf16 v[52:55], a[220:223], a[60:63], v[52:55]
    v_exp_f32 v85, v85
    v_mfma_f32_16x16x32_bf16 v[52:55], a[216:219], a[44:47], v[52:55]
    s_waitcnt lgkmcnt(1)
    v_exp_f32 v86, v86
    v_mfma_f32_16x16x32_bf16 v[52:55], a[212:215], a[28:31], v[52:55]
    s_addk_i32 m0, 896
    ds_read_b128 a[212:215], v13 offset:30720
    v_cvt_pk_bf16_f32 v84, v84, v85
    v_mfma_f32_16x16x32_bf16 v[52:55], a[208:211], a[12:15], v[52:55]
    v_exp_f32 v87, v87
    v_mfma_f32_16x16x32_bf16 v[96:99], a[184:187], a[0:3], 0
    ds_read_b128 a[220:223], v13 offset:31744
    v_cvt_pk_bf16_f32 v85, v86, v87
    v_mfma_f32_16x16x32_bf16 v[96:99], a[188:191], a[16:19], v[96:99]
    v_exp_f32 v92, v92
    v_mfma_f32_16x16x32_bf16 v[96:99], a[192:195], a[32:35], v[96:99]
    s_waitcnt lgkmcnt(2)
    v_exp_f32 v93, v93
    v_mfma_f32_16x16x32_bf16 v[96:99], a[196:199], a[48:51], v[96:99]
    ds_read_b128 a[208:211], v12 offset:30720
    v_cvt_pk_bf16_f32 v92, v92, v93
    v_mfma_f32_16x16x32_bf16 v[96:99], a[200:203], a[64:67], v[96:99]
    buffer_load_dwordx4 v4, s[12:15], s38 offen offset:256 lds
    v_mfma_f32_16x16x32_bf16 v[96:99], a[204:207], a[80:83], v[96:99]
    v_exp_f32 v94, v94
    v_mfma_f32_16x16x32_bf16 v[104:107], a[204:207], a[84:87], 0
    v_exp_f32 v95, v95
    v_mfma_f32_16x16x32_bf16 v[104:107], a[200:203], a[68:71], v[104:107]
    ds_read_b128 a[216:219], v12 offset:31744
    v_cvt_pk_bf16_f32 v93, v94, v95
    v_mfma_f32_16x16x32_bf16 v[104:107], a[196:199], a[52:55], v[104:107]
    v_exp_f32 v40, v40
    v_mfma_f32_16x16x32_bf16 v[104:107], a[192:195], a[36:39], v[104:107]
    v_exp_f32 v41, v41
    v_mfma_f32_16x16x32_bf16 v[104:107], a[188:191], a[20:23], v[104:107]
    s_addk_i32 m0, 1280
    ds_read_b128 a[224:227], v12 offset:32768
    v_cvt_pk_bf16_f32 v70, v40, v41
    v_mfma_f32_16x16x32_bf16 v[104:107], a[184:187], a[4:7], v[104:107]
    v_exp_f32 v42, v42
    v_mfma_f32_16x16x32_bf16 v[112:115], a[184:187], a[8:11], 0
    v_exp_f32 v43, v43
    v_mfma_f32_16x16x32_bf16 v[112:115], a[188:191], a[24:27], v[112:115]
    ds_read_b128 a[228:231], v13 offset:32768
    v_cvt_pk_bf16_f32 v71, v42, v43
    v_mfma_f32_16x16x32_bf16 v[112:115], a[192:195], a[40:43], v[112:115]
    v_exp_f32 v44, v44
    v_mfma_f32_16x16x32_bf16 v[112:115], a[196:199], a[56:59], v[112:115]
    v_exp_f32 v45, v45
    v_mfma_f32_16x16x32_bf16 v[112:115], a[200:203], a[72:75], v[112:115]
    buffer_load_dwordx4 v5, s[12:15], s38 offen offset:0 lds
    v_mfma_f32_16x16x32_bf16 v[112:115], a[204:207], a[88:91], v[112:115]
    v_exp_f32 v46, v46
    v_mfma_f32_16x16x32_bf16 v[120:123], a[204:207], a[92:95], 0
    ds_read_b64_tr_b16 a[232:233], v8 offset:0
    v_cvt_pk_bf16_f32 v78, v44, v45
    v_mfma_f32_16x16x32_bf16 v[120:123], a[200:203], a[76:79], v[120:123]
    v_exp_f32 v47, v47
    v_mfma_f32_16x16x32_bf16 v[120:123], a[196:199], a[60:63], v[120:123]
    ds_read_b64_tr_b16 a[234:235], v8 offset:2048
    v_cvt_pk_bf16_f32 v79, v46, v47
    v_mfma_f32_16x16x32_bf16 v[120:123], a[192:195], a[44:47], v[120:123]
    s_waitcnt lgkmcnt(2)
    v_exp_f32 v48, v48
    v_mfma_f32_16x16x32_bf16 v[120:123], a[188:191], a[28:31], v[120:123]
    s_addk_i32 m0, 896
    v_exp_f32 v49, v49
    v_mfma_f32_16x16x32_bf16 v[120:123], a[184:187], a[12:15], v[120:123]
    ds_read_b64_tr_b16 a[236:237], v9 offset:0
    v_cvt_pk_bf16_f32 v86, v48, v49
    v_mfma_f32_16x16x32_bf16 v[24:27], a[208:211], a[0:3], 0
    v_exp_f32 v50, v50
    v_mfma_f32_16x16x32_bf16 v[24:27], a[212:215], a[16:19], v[24:27]
    v_exp_f32 v51, v51
    v_mfma_f32_16x16x32_bf16 v[24:27], a[216:219], a[32:35], v[24:27]
    ds_read_b64_tr_b16 a[238:239], v9 offset:2048
    v_cvt_pk_bf16_f32 v87, v50, v51
    v_mfma_f32_16x16x32_bf16 v[24:27], a[220:223], a[48:51], v[24:27]
    v_exp_f32 v52, v52
    v_mfma_f32_16x16x32_bf16 v[24:27], a[224:227], a[64:67], v[24:27]
    buffer_load_dwordx4 v5, s[12:15], s38 offen offset:128 lds
    v_mfma_f32_16x16x32_bf16 v[24:27], a[228:231], a[80:83], v[24:27]
    v_exp_f32 v53, v53
    v_mfma_f32_16x16x32_bf16 v[28:31], a[228:231], a[84:87], 0
    ds_read_b128 a[184:187], v12 offset:36864
    v_cvt_pk_bf16_f32 v94, v52, v53
    v_mfma_f32_16x16x32_bf16 v[28:31], a[224:227], a[68:71], v[28:31]
    v_exp_f32 v54, v54
    v_mfma_f32_16x16x32_bf16 v[28:31], a[220:223], a[52:55], v[28:31]
    v_exp_f32 v55, v55
    v_mfma_f32_16x16x32_bf16 v[28:31], a[216:219], a[36:39], v[28:31]
    ds_read_b128 a[188:191], v13 offset:36864
    v_cvt_pk_bf16_f32 v95, v54, v55
    v_mfma_f32_16x16x32_bf16 v[28:31], a[212:215], a[20:23], v[28:31]
    s_addk_i32 m0, 896
    v_exp_f32 v96, v96
    v_mfma_f32_16x16x32_bf16 v[28:31], a[208:211], a[4:7], v[28:31]
    v_exp_f32 v97, v97
    v_mfma_f32_16x16x32_bf16 v[32:35], a[208:211], a[8:11], 0
    ds_read_b128 a[192:195], v12 offset:37888
    v_cvt_pk_bf16_f32 v96, v96, v97
    v_mfma_f32_16x16x32_bf16 v[32:35], a[212:215], a[24:27], v[32:35]
    v_exp_f32 v98, v98
    v_mfma_f32_16x16x32_bf16 v[32:35], a[216:219], a[40:43], v[32:35]
    v_exp_f32 v99, v99
    v_mfma_f32_16x16x32_bf16 v[32:35], a[220:223], a[56:59], v[32:35]
    ds_read_b128 a[196:199], v13 offset:37888
    v_cvt_pk_bf16_f32 v97, v98, v99
    v_mfma_f32_16x16x32_bf16 v[32:35], a[224:227], a[72:75], v[32:35]
    buffer_load_dwordx4 v5, s[12:15], s38 offen offset:256 lds
    v_mfma_f32_16x16x32_bf16 v[32:35], a[228:231], a[88:91], v[32:35]
    s_add_u32 s38, s38, 24576
    v_exp_f32 v104, v104
    v_mfma_f32_16x16x32_bf16 v[36:39], a[228:231], a[92:95], 0
    v_exp_f32 v105, v105
    v_mfma_f32_16x16x32_bf16 v[36:39], a[224:227], a[76:79], v[36:39]
    ds_read_b128 a[200:203], v12 offset:38912
    v_cvt_pk_bf16_f32 v104, v104, v105
    v_mfma_f32_16x16x32_bf16 v[36:39], a[220:223], a[60:63], v[36:39]
    s_add_u32 s39, s40, 73728
    v_exp_f32 v106, v106
    v_mfma_f32_16x16x32_bf16 v[36:39], a[216:219], a[44:47], v[36:39]
    s_waitcnt lgkmcnt(2)
    v_exp_f32 v107, v107
    v_mfma_f32_16x16x32_bf16 v[36:39], a[212:215], a[28:31], v[36:39]
    s_add_u32 m0, s63, 98304
    ds_read_b128 a[204:207], v13 offset:38912
    v_cvt_pk_bf16_f32 v105, v106, v107
    v_mfma_f32_16x16x32_bf16 v[36:39], a[208:211], a[12:15], v[36:39]
    v_exp_f32 v112, v112
    v_mfma_f32_16x16x32_bf16 a[152:155], a[232:235], v[64:67], 0
    v_exp_f32 v113, v113
    v_mfma_f32_16x16x32_bf16 a[168:171], a[236:239], v[64:67], 0
    v_exp_f32 v114, v114
    v_mfma_f32_16x16x32_bf16 a[172:175], a[236:239], v[72:75], 0
    ds_read_b128 a[208:211], v12 offset:43008
    v_cvt_pk_bf16_f32 v112, v112, v113
    v_mfma_f32_16x16x32_bf16 a[156:159], a[232:235], v[72:75], 0
    v_exp_f32 v115, v115
    v_mfma_f32_16x16x32_bf16 a[160:163], a[232:235], v[80:83], 0
    buffer_load_dwordx4 v6, s[16:19], s39 offen lds
    v_mfma_f32_16x16x32_bf16 a[176:179], a[236:239], v[80:83], 0
    ds_read_b128 a[212:215], v13 offset:43008
    v_cvt_pk_bf16_f32 v113, v114, v115
    v_mfma_f32_16x16x32_bf16 a[180:183], a[236:239], v[88:91], 0
    v_exp_f32 v120, v120
    v_mfma_f32_16x16x32_bf16 a[164:167], a[232:235], v[88:91], 0
    v_exp_f32 v121, v121
    v_mfma_f32_16x16x32_bf16 v[100:103], a[184:187], a[0:3], 0
    s_waitcnt lgkmcnt(2)
    ds_read_b128 a[216:219], v12 offset:44032
    v_cvt_pk_bf16_f32 v120, v120, v121
    v_mfma_f32_16x16x32_bf16 v[100:103], a[188:191], a[16:19], v[100:103]
    s_add_u32 s39, s40, 86016
    v_exp_f32 v122, v122
    v_mfma_f32_16x16x32_bf16 v[100:103], a[192:195], a[32:35], v[100:103]
    s_addk_i32 m0, 4096
    v_exp_f32 v123, v123
    v_mfma_f32_16x16x32_bf16 v[100:103], a[196:199], a[48:51], v[100:103]
    ds_read_b128 a[220:223], v13 offset:44032
    v_cvt_pk_bf16_f32 v121, v122, v123
    v_mfma_f32_16x16x32_bf16 v[100:103], a[200:203], a[64:67], v[100:103]
    v_exp_f32 v24, v24
    v_mfma_f32_16x16x32_bf16 v[100:103], a[204:207], a[80:83], v[100:103]
    v_exp_f32 v25, v25
    v_mfma_f32_16x16x32_bf16 v[108:111], a[204:207], a[84:87], 0
    ds_read_b128 a[224:227], v12 offset:45056
    v_cvt_pk_bf16_f32 v98, v24, v25
    v_mfma_f32_16x16x32_bf16 v[108:111], a[200:203], a[68:71], v[108:111]
    v_exp_f32 v26, v26
    v_mfma_f32_16x16x32_bf16 v[108:111], a[196:199], a[52:55], v[108:111]
    buffer_load_dwordx4 v6, s[16:19], s39 offen lds
    v_mfma_f32_16x16x32_bf16 v[108:111], a[192:195], a[36:39], v[108:111]
    v_exp_f32 v27, v27
    v_mfma_f32_16x16x32_bf16 v[108:111], a[188:191], a[20:23], v[108:111]
    ds_read_b128 a[228:231], v13 offset:45056
    v_cvt_pk_bf16_f32 v99, v26, v27
    v_mfma_f32_16x16x32_bf16 v[108:111], a[184:187], a[4:7], v[108:111]
    v_exp_f32 v28, v28
    v_mfma_f32_16x16x32_bf16 v[116:119], a[184:187], a[8:11], 0
    v_exp_f32 v29, v29
    v_mfma_f32_16x16x32_bf16 v[116:119], a[188:191], a[24:27], v[116:119]
    v_exp_f32 v30, v30
    v_mfma_f32_16x16x32_bf16 v[116:119], a[192:195], a[40:43], v[116:119]
    v_exp_f32 v31, v31
    v_mfma_f32_16x16x32_bf16 v[116:119], a[196:199], a[56:59], v[116:119]
    v_exp_f32 v32, v32
    v_mfma_f32_16x16x32_bf16 v[116:119], a[200:203], a[72:75], v[116:119]
    v_exp_f32 v33, v33
    v_mfma_f32_16x16x32_bf16 v[116:119], a[204:207], a[88:91], v[116:119]
    v_exp_f32 v34, v34
    v_mfma_f32_16x16x32_bf16 v[124:127], a[204:207], a[92:95], 0
    v_exp_f32 v35, v35
    v_mfma_f32_16x16x32_bf16 v[124:127], a[200:203], a[76:79], v[124:127]
    v_cvt_pk_bf16_f32 v106, v28, v29
    v_cvt_pk_bf16_f32 v107, v30, v31
    v_mfma_f32_16x16x32_bf16 v[124:127], a[196:199], a[60:63], v[124:127]
    s_add_u32 m0, s49, 24576
    v_exp_f32 v36, v36
    v_mfma_f32_16x16x32_bf16 v[124:127], a[192:195], a[44:47], v[124:127]
    s_waitcnt lgkmcnt(0)
    v_exp_f32 v37, v37
    v_mfma_f32_16x16x32_bf16 v[124:127], a[188:191], a[28:31], v[124:127]
    v_exp_f32 v38, v38
    v_mfma_f32_16x16x32_bf16 v[124:127], a[184:187], a[12:15], v[124:127]
    v_exp_f32 v39, v39
    v_mfma_f32_16x16x32_bf16 v[40:43], a[208:211], a[0:3], 0
    s_waitcnt vmcnt(11)
    v_cvt_pk_bf16_f32 v114, v32, v33
    v_cvt_pk_bf16_f32 v115, v34, v35
    v_mfma_f32_16x16x32_bf16 v[40:43], a[212:215], a[16:19], v[40:43]
    s_barrier
    v_mfma_f32_16x16x32_bf16 v[40:43], a[216:219], a[32:35], v[40:43]
    buffer_load_dwordx4 v4, s[12:15], s38 offen offset:0 lds
    v_mfma_f32_16x16x32_bf16 v[40:43], a[220:223], a[48:51], v[40:43]
    ds_read_b64_tr_b16 a[240:241], v8 offset:4096
    v_cvt_pk_bf16_f32 v122, v36, v37
    v_mfma_f32_16x16x32_bf16 v[40:43], a[224:227], a[64:67], v[40:43]
    ds_read_b64_tr_b16 a[242:243], v8 offset:6144
    v_cvt_pk_bf16_f32 v123, v38, v39
    v_mfma_f32_16x16x32_bf16 v[40:43], a[228:231], a[80:83], v[40:43]
    v_exp_f32 v100, v100
    v_mfma_f32_16x16x32_bf16 v[44:47], a[228:231], a[84:87], 0
    v_exp_f32 v101, v101
    v_mfma_f32_16x16x32_bf16 v[44:47], a[224:227], a[68:71], v[44:47]
    ds_read_b64_tr_b16 a[244:245], v9 offset:4096
    v_cvt_pk_bf16_f32 v100, v100, v101
    v_mfma_f32_16x16x32_bf16 v[44:47], a[220:223], a[52:55], v[44:47]
    s_addk_i32 m0, 896
    v_exp_f32 v102, v102
    v_mfma_f32_16x16x32_bf16 v[44:47], a[216:219], a[36:39], v[44:47]
    v_exp_f32 v103, v103
    v_mfma_f32_16x16x32_bf16 v[44:47], a[212:215], a[20:23], v[44:47]
    ds_read_b64_tr_b16 a[246:247], v9 offset:6144
    v_cvt_pk_bf16_f32 v101, v102, v103
    v_mfma_f32_16x16x32_bf16 v[44:47], a[208:211], a[4:7], v[44:47]
    v_exp_f32 v108, v108
    v_mfma_f32_16x16x32_bf16 v[48:51], a[208:211], a[8:11], 0
    buffer_load_dword a252, v22, s[32:35], s42 offen offset:1536
    s_add_u32 s42, s42, 3072
    v_mfma_f32_16x16x32_bf16 v[48:51], a[212:215], a[24:27], v[48:51]
    v_exp_f32 v109, v109
    v_mfma_f32_16x16x32_bf16 v[48:51], a[216:219], a[40:43], v[48:51]
    buffer_load_dwordx4 v4, s[12:15], s38 offen offset:128 lds
    v_mfma_f32_16x16x32_bf16 v[48:51], a[220:223], a[56:59], v[48:51]
    ds_read_b128 a[184:187], v12 offset:49152
    v_cvt_pk_bf16_f32 v108, v108, v109
    v_mfma_f32_16x16x32_bf16 v[48:51], a[224:227], a[72:75], v[48:51]
    v_exp_f32 v110, v110
    v_mfma_f32_16x16x32_bf16 v[48:51], a[228:231], a[88:91], v[48:51]
    v_exp_f32 v111, v111
    v_mfma_f32_16x16x32_bf16 v[52:55], a[228:231], a[92:95], 0
    ds_read_b128 a[188:191], v13 offset:49152
    v_cvt_pk_bf16_f32 v109, v110, v111
    v_mfma_f32_16x16x32_bf16 v[52:55], a[224:227], a[76:79], v[52:55]
    v_exp_f32 v116, v116
    v_mfma_f32_16x16x32_bf16 v[52:55], a[220:223], a[60:63], v[52:55]
    s_addk_i32 m0, 896
    ds_read_b128 a[192:195], v12 offset:50176
    v_accvgpr_write_b32 a96, v64
    v_mfma_f32_16x16x32_bf16 v[52:55], a[216:219], a[44:47], v[52:55]
    s_waitcnt lgkmcnt(3)
    v_exp_f32 v117, v117
    v_mfma_f32_16x16x32_bf16 v[52:55], a[212:215], a[28:31], v[52:55]
    ds_read_b128 a[196:199], v13 offset:50176
    v_cvt_pk_bf16_f32 v116, v116, v117
    v_mfma_f32_16x16x32_bf16 v[52:55], a[208:211], a[12:15], v[52:55]
    v_exp_f32 v118, v118
    v_mfma_f32_16x16x32_bf16 a[164:167], a[240:243], v[92:95], a[164:167]
    v_exp_f32 v119, v119
    v_mfma_f32_16x16x32_bf16 a[180:183], a[244:247], v[92:95], a[180:183]
    ds_read_b128 a[200:203], v12 offset:51200
    v_cvt_pk_bf16_f32 v117, v118, v119
    v_mfma_f32_16x16x32_bf16 a[176:179], a[244:247], v[84:87], a[176:179]
    buffer_load_dwordx4 v4, s[12:15], s38 offen offset:256 lds
    v_mfma_f32_16x16x32_bf16 a[160:163], a[240:243], v[84:87], a[160:163]
    ds_read_b128 a[204:207], v13 offset:51200
    v_accvgpr_write_b32 a97, v65
    v_mfma_f32_16x16x32_bf16 a[156:159], a[240:243], v[76:79], a[156:159]
    v_exp_f32 v124, v124
    v_mfma_f32_16x16x32_bf16 a[172:175], a[244:247], v[76:79], a[172:175]
    s_waitcnt lgkmcnt(2)
    v_exp_f32 v125, v125
    v_mfma_f32_16x16x32_bf16 a[168:171], a[244:247], v[68:71], a[168:171]
    ds_read_b128 a[208:211], v12 offset:55296
    v_cvt_pk_bf16_f32 v124, v124, v125
    v_mfma_f32_16x16x32_bf16 a[152:155], a[240:243], v[68:71], a[152:155]
    v_exp_f32 v126, v126
    v_mfma_f32_16x16x32_bf16 v[128:131], a[184:187], a[0:3], 0
    s_addk_i32 m0, 1280
    v_exp_f32 v127, v127
    v_mfma_f32_16x16x32_bf16 v[128:131], a[188:191], a[16:19], v[128:131]
    s_waitcnt lgkmcnt(2)
    ds_read_b128 a[212:215], v13 offset:55296
    v_cvt_pk_bf16_f32 v125, v126, v127
    v_mfma_f32_16x16x32_bf16 v[128:131], a[192:195], a[32:35], v[128:131]
    s_waitcnt lgkmcnt(2)
    v_exp_f32 v40, v40
    v_mfma_f32_16x16x32_bf16 v[128:131], a[196:199], a[48:51], v[128:131]
    ds_read_b128 a[216:219], v12 offset:56320
    v_accvgpr_write_b32 a98, v66
    v_mfma_f32_16x16x32_bf16 v[128:131], a[200:203], a[64:67], v[128:131]
    v_exp_f32 v41, v41
    v_mfma_f32_16x16x32_bf16 v[128:131], a[204:207], a[80:83], v[128:131]
    ds_read_b128 a[220:223], v13 offset:56320
    v_cvt_pk_bf16_f32 v102, v40, v41
    v_mfma_f32_16x16x32_bf16 v[136:139], a[204:207], a[84:87], 0
    buffer_load_dwordx4 v5, s[12:15], s38 offen offset:0 lds
    v_mfma_f32_16x16x32_bf16 v[136:139], a[200:203], a[68:71], v[136:139]
    v_exp_f32 v42, v42
    v_mfma_f32_16x16x32_bf16 v[136:139], a[196:199], a[52:55], v[136:139]
    v_exp_f32 v43, v43
    v_mfma_f32_16x16x32_bf16 v[136:139], a[192:195], a[36:39], v[136:139]
    ds_read_b128 a[224:227], v12 offset:57344
    v_cvt_pk_bf16_f32 v103, v42, v43
    v_mfma_f32_16x16x32_bf16 v[136:139], a[188:191], a[20:23], v[136:139]
    v_exp_f32 v44, v44
    v_mfma_f32_16x16x32_bf16 v[136:139], a[184:187], a[4:7], v[136:139]
    ds_read_b128 a[228:231], v13 offset:57344
    v_accvgpr_write_b32 a99, v67
    v_mfma_f32_16x16x32_bf16 v[144:147], a[184:187], a[8:11], 0
    s_addk_i32 m0, 896
    v_exp_f32 v45, v45
    v_mfma_f32_16x16x32_bf16 v[144:147], a[188:191], a[24:27], v[144:147]
    v_exp_f32 v46, v46
    v_mfma_f32_16x16x32_bf16 v[144:147], a[192:195], a[40:43], v[144:147]
    v_exp_f32 v47, v47
    v_mfma_f32_16x16x32_bf16 v[144:147], a[196:199], a[56:59], v[144:147]
    v_exp_f32 v48, v48
    v_mfma_f32_16x16x32_bf16 v[144:147], a[200:203], a[72:75], v[144:147]
    v_exp_f32 v49, v49
    v_mfma_f32_16x16x32_bf16 v[144:147], a[204:207], a[88:91], v[144:147]
    v_exp_f32 v50, v50
    v_mfma_f32_16x16x32_bf16 v[152:155], a[204:207], a[92:95], 0
    buffer_load_dwordx4 v5, s[12:15], s38 offen offset:128 lds
    v_mfma_f32_16x16x32_bf16 v[152:155], a[200:203], a[76:79], v[152:155]
    ds_read_b64_tr_b16 a[232:233], v8 offset:8192
    v_cvt_pk_bf16_f32 v110, v44, v45
    v_mfma_f32_16x16x32_bf16 v[152:155], a[196:199], a[60:63], v[152:155]
    ds_read_b64_tr_b16 a[234:235], v8 offset:10240
    v_cvt_pk_bf16_f32 v111, v46, v47
    v_mfma_f32_16x16x32_bf16 v[152:155], a[192:195], a[44:47], v[152:155]
    s_waitcnt lgkmcnt(2)
    ds_read_b64_tr_b16 a[236:237], v9 offset:8192
    v_cvt_pk_bf16_f32 v118, v48, v49
    v_mfma_f32_16x16x32_bf16 v[152:155], a[188:191], a[28:31], v[152:155]
    ds_read_b64_tr_b16 a[238:239], v9 offset:10240
    v_accvgpr_write_b32 a100, v68
    v_mfma_f32_16x16x32_bf16 v[152:155], a[184:187], a[12:15], v[152:155]
    v_exp_f32 v51, v51
    v_mfma_f32_16x16x32_bf16 v[24:27], a[208:211], a[0:3], 0
    s_addk_i32 m0, 896
    v_exp_f32 v52, v52
    v_mfma_f32_16x16x32_bf16 v[24:27], a[212:215], a[16:19], v[24:27]
    v_exp_f32 v53, v53
    v_mfma_f32_16x16x32_bf16 v[24:27], a[216:219], a[32:35], v[24:27]
    ds_read_b128 a[184:187], v12 offset:61440
    v_cvt_pk_bf16_f32 v119, v50, v51
    v_mfma_f32_16x16x32_bf16 v[24:27], a[220:223], a[48:51], v[24:27]
    ds_read_b128 a[188:191], v13 offset:61440
    v_cvt_pk_bf16_f32 v126, v52, v53
    v_mfma_f32_16x16x32_bf16 v[24:27], a[224:227], a[64:67], v[24:27]
    ds_read_b128 a[192:195], v12 offset:62464
    v_accvgpr_write_b32 a101, v69
    v_mfma_f32_16x16x32_bf16 v[24:27], a[228:231], a[80:83], v[24:27]
    v_exp_f32 v54, v54
    v_mfma_f32_16x16x32_bf16 v[28:31], a[228:231], a[84:87], 0
    buffer_load_dwordx4 v5, s[12:15], s38 offen offset:256 lds
    v_mfma_f32_16x16x32_bf16 v[28:31], a[224:227], a[68:71], v[28:31]
    s_add_u32 s38, s38, 24576
    v_exp_f32 v55, v55
    v_mfma_f32_16x16x32_bf16 v[28:31], a[220:223], a[52:55], v[28:31]
    ds_read_b128 a[196:199], v13 offset:62464
    v_cvt_pk_bf16_f32 v127, v54, v55
    v_mfma_f32_16x16x32_bf16 v[28:31], a[216:219], a[36:39], v[28:31]
    v_exp_f32 v128, v128
    v_mfma_f32_16x16x32_bf16 v[28:31], a[212:215], a[20:23], v[28:31]
    s_add_u32 s39, s40, 98304
    ds_read_b128 a[200:203], v12 offset:63488
    v_add_u32 v12, 67584, v12
    v_mfma_f32_16x16x32_bf16 v[28:31], a[208:211], a[4:7], v[28:31]
    ds_read_b128 a[204:207], v13 offset:63488
    v_add_u32 v13, 67584, v13
    v_mfma_f32_16x16x32_bf16 v[32:35], a[208:211], a[8:11], 0
    s_add_u32 m0, s63, 106496
    v_exp_f32 v129, v129
    v_mfma_f32_16x16x32_bf16 v[32:35], a[212:215], a[24:27], v[32:35]
    v_exp_f32 v130, v130
    v_mfma_f32_16x16x32_bf16 v[32:35], a[216:219], a[40:43], v[32:35]
    v_exp_f32 v131, v131
    v_mfma_f32_16x16x32_bf16 v[32:35], a[220:223], a[56:59], v[32:35]
    v_exp_f32 v136, v136
    v_mfma_f32_16x16x32_bf16 v[32:35], a[224:227], a[72:75], v[32:35]
    v_exp_f32 v137, v137
    v_mfma_f32_16x16x32_bf16 v[32:35], a[228:231], a[88:91], v[32:35]
    v_exp_f32 v138, v138
    v_mfma_f32_16x16x32_bf16 v[36:39], a[228:231], a[92:95], 0
    buffer_load_dwordx4 v6, s[16:19], s39 offen lds
    v_mfma_f32_16x16x32_bf16 v[36:39], a[224:227], a[76:79], v[36:39]
    v_exp_f32 v139, v139
    v_mfma_f32_16x16x32_bf16 v[36:39], a[220:223], a[60:63], v[36:39]
    v_cvt_pk_bf16_f32 v128, v128, v129
    v_cvt_pk_bf16_f32 v129, v130, v131
    v_mfma_f32_16x16x32_bf16 v[36:39], a[216:219], a[44:47], v[36:39]
    s_waitcnt lgkmcnt(0)
    v_exp_f32 v144, v144
    v_mfma_f32_16x16x32_bf16 v[36:39], a[212:215], a[28:31], v[36:39]
    s_add_u32 s39, s40, 110592
    v_exp_f32 v145, v145
    v_mfma_f32_16x16x32_bf16 v[36:39], a[208:211], a[12:15], v[36:39]
    v_exp_f32 v146, v146
    v_mfma_f32_16x16x32_bf16 a[152:155], a[232:235], v[96:99], a[152:155]
    s_addk_i32 m0, 4096
    v_exp_f32 v147, v147
    v_mfma_f32_16x16x32_bf16 a[168:171], a[236:239], v[96:99], a[168:171]
    v_cvt_pk_bf16_f32 v136, v136, v137
    v_cvt_pk_bf16_f32 v137, v138, v139
    v_mfma_f32_16x16x32_bf16 a[172:175], a[236:239], v[104:107], a[172:175]
    ds_read_b128 a[208:211], v12 offset:0
    v_cvt_pk_bf16_f32 v144, v144, v145
    v_mfma_f32_16x16x32_bf16 a[156:159], a[232:235], v[104:107], a[156:159]
    ds_read_b128 a[212:215], v13 offset:0
    v_cvt_pk_bf16_f32 v145, v146, v147
    v_mfma_f32_16x16x32_bf16 a[160:163], a[232:235], v[112:115], a[160:163]
    ds_read_b128 a[216:219], v12 offset:1024
    v_accvgpr_write_b32 a102, v70
    v_mfma_f32_16x16x32_bf16 a[176:179], a[236:239], v[112:115], a[176:179]
    ds_read_b128 a[220:223], v13 offset:1024
    v_accvgpr_write_b32 a103, v71
    v_mfma_f32_16x16x32_bf16 a[180:183], a[236:239], v[120:123], a[180:183]
    buffer_load_dwordx4 v6, s[16:19], s39 offen lds
    v_mfma_f32_16x16x32_bf16 a[164:167], a[232:235], v[120:123], a[164:167]
    ds_read_b128 a[224:227], v12 offset:2048
    v_accvgpr_write_b32 a104, v72
    v_mfma_f32_16x16x32_bf16 v[132:135], a[184:187], a[0:3], 0
    ds_read_b128 a[228:231], v13 offset:2048
    v_subrev_u32 v12, 67584, v12
    v_mfma_f32_16x16x32_bf16 v[132:135], a[188:191], a[16:19], v[132:135]
    v_exp_f32 v152, v152
    v_mfma_f32_16x16x32_bf16 v[132:135], a[192:195], a[32:35], v[132:135]
    v_exp_f32 v153, v153
    v_mfma_f32_16x16x32_bf16 v[132:135], a[196:199], a[48:51], v[132:135]
    v_exp_f32 v154, v154
    v_mfma_f32_16x16x32_bf16 v[132:135], a[200:203], a[64:67], v[132:135]
    v_exp_f32 v155, v155
    v_mfma_f32_16x16x32_bf16 v[132:135], a[204:207], a[80:83], v[132:135]
    v_exp_f32 v24, v24
    v_mfma_f32_16x16x32_bf16 v[140:143], a[204:207], a[84:87], 0
    v_exp_f32 v25, v25
    v_mfma_f32_16x16x32_bf16 v[140:143], a[200:203], a[68:71], v[140:143]
    v_exp_f32 v26, v26
    v_mfma_f32_16x16x32_bf16 v[140:143], a[196:199], a[52:55], v[140:143]
    v_exp_f32 v27, v27
    v_mfma_f32_16x16x32_bf16 v[140:143], a[192:195], a[36:39], v[140:143]
    v_cvt_pk_bf16_f32 v152, v152, v153
    v_cvt_pk_bf16_f32 v153, v154, v155
    v_mfma_f32_16x16x32_bf16 v[140:143], a[188:191], a[20:23], v[140:143]
    v_exp_f32 v28, v28
    v_mfma_f32_16x16x32_bf16 v[140:143], a[184:187], a[4:7], v[140:143]
    v_exp_f32 v29, v29
    v_mfma_f32_16x16x32_bf16 v[148:151], a[184:187], a[8:11], 0
    v_exp_f32 v30, v30
    v_mfma_f32_16x16x32_bf16 v[148:151], a[188:191], a[24:27], v[148:151]
    v_exp_f32 v31, v31
    v_mfma_f32_16x16x32_bf16 v[148:151], a[192:195], a[40:43], v[148:151]
    v_cvt_pk_bf16_f32 v130, v24, v25
    v_cvt_pk_bf16_f32 v131, v26, v27
    v_mfma_f32_16x16x32_bf16 v[148:151], a[196:199], a[56:59], v[148:151]
    v_exp_f32 v32, v32
    v_mfma_f32_16x16x32_bf16 v[148:151], a[200:203], a[72:75], v[148:151]
    v_exp_f32 v33, v33
    v_mfma_f32_16x16x32_bf16 v[148:151], a[204:207], a[88:91], v[148:151]
    v_exp_f32 v34, v34
    v_mfma_f32_16x16x32_bf16 v[156:159], a[204:207], a[92:95], 0
    v_exp_f32 v35, v35
    v_mfma_f32_16x16x32_bf16 v[156:159], a[200:203], a[76:79], v[156:159]
    v_cvt_pk_bf16_f32 v138, v28, v29
    v_cvt_pk_bf16_f32 v139, v30, v31
    v_mfma_f32_16x16x32_bf16 v[156:159], a[196:199], a[60:63], v[156:159]
    s_add_u32 m0, s49, 49152
    v_exp_f32 v36, v36
    v_mfma_f32_16x16x32_bf16 v[156:159], a[192:195], a[44:47], v[156:159]
    s_waitcnt lgkmcnt(0)
    v_exp_f32 v37, v37
    v_mfma_f32_16x16x32_bf16 v[156:159], a[188:191], a[28:31], v[156:159]
    v_exp_f32 v38, v38
    v_mfma_f32_16x16x32_bf16 v[156:159], a[184:187], a[12:15], v[156:159]
    v_exp_f32 v39, v39
    v_mfma_f32_16x16x32_bf16 v[40:43], a[208:211], a[0:3], 0
    s_waitcnt vmcnt(11)
    v_cvt_pk_bf16_f32 v146, v32, v33
    v_cvt_pk_bf16_f32 v147, v34, v35
    v_mfma_f32_16x16x32_bf16 v[40:43], a[212:215], a[16:19], v[40:43]
    s_barrier
    v_mfma_f32_16x16x32_bf16 v[40:43], a[216:219], a[32:35], v[40:43]
    buffer_load_dwordx4 v4, s[12:15], s38 offen offset:0 lds
    v_mfma_f32_16x16x32_bf16 v[40:43], a[220:223], a[48:51], v[40:43]
    ds_read_b64_tr_b16 a[240:241], v8 offset:12288
    v_cvt_pk_bf16_f32 v154, v36, v37
    v_mfma_f32_16x16x32_bf16 v[40:43], a[224:227], a[64:67], v[40:43]
    ds_read_b64_tr_b16 a[242:243], v8 offset:14336
    v_cvt_pk_bf16_f32 v155, v38, v39
    v_mfma_f32_16x16x32_bf16 v[40:43], a[228:231], a[80:83], v[40:43]
    ds_read_b64_tr_b16 a[244:245], v9 offset:12288
    v_accvgpr_write_b32 a105, v73
    v_mfma_f32_16x16x32_bf16 v[44:47], a[228:231], a[84:87], 0
    ds_read_b64_tr_b16 a[246:247], v9 offset:14336
    v_subrev_u32 v13, 67584, v13
    v_mfma_f32_16x16x32_bf16 v[44:47], a[224:227], a[68:71], v[44:47]
    ds_read_b128 a[184:187], v12 offset:0
    v_accvgpr_write_b32 a106, v74
    v_mfma_f32_16x16x32_bf16 v[44:47], a[220:223], a[52:55], v[44:47]
    s_addk_i32 m0, 896
    ds_read_b128 a[188:191], v13 offset:0
    v_accvgpr_write_b32 a107, v75
    v_mfma_f32_16x16x32_bf16 v[44:47], a[216:219], a[36:39], v[44:47]
    ds_read_b128 a[192:195], v12 offset:1024
    v_accvgpr_write_b32 a108, v76
    v_mfma_f32_16x16x32_bf16 v[44:47], a[212:215], a[20:23], v[44:47]
    ds_read_b128 a[196:199], v13 offset:1024
    v_accvgpr_write_b32 a109, v77
    v_mfma_f32_16x16x32_bf16 v[44:47], a[208:211], a[4:7], v[44:47]
    v_exp_f32 v132, v132
    v_mfma_f32_16x16x32_bf16 v[48:51], a[208:211], a[8:11], 0
    buffer_load_dword a252, v22, s[32:35], s42 offen offset:0
    v_mfma_f32_16x16x32_bf16 v[48:51], a[212:215], a[24:27], v[48:51]
    v_exp_f32 v133, v133
    v_mfma_f32_16x16x32_bf16 v[48:51], a[216:219], a[40:43], v[48:51]
    buffer_load_dwordx4 v4, s[12:15], s38 offen offset:128 lds
    v_mfma_f32_16x16x32_bf16 v[48:51], a[220:223], a[56:59], v[48:51]
    ds_read_b128 a[200:203], v12 offset:2048
    v_cvt_pk_bf16_f32 v132, v132, v133
    v_mfma_f32_16x16x32_bf16 v[48:51], a[224:227], a[72:75], v[48:51]
    v_exp_f32 v134, v134
    v_mfma_f32_16x16x32_bf16 v[48:51], a[228:231], a[88:91], v[48:51]
    ds_read_b128 a[204:207], v13 offset:2048
    v_accvgpr_write_b32 a110, v78
    v_mfma_f32_16x16x32_bf16 v[52:55], a[228:231], a[92:95], 0
    v_exp_f32 v135, v135
    v_mfma_f32_16x16x32_bf16 v[52:55], a[224:227], a[76:79], v[52:55]
    v_exp_f32 v140, v140
    v_mfma_f32_16x16x32_bf16 v[52:55], a[220:223], a[60:63], v[52:55]
    s_addk_i32 m0, 896
    v_exp_f32 v141, v141
    v_mfma_f32_16x16x32_bf16 v[52:55], a[216:219], a[44:47], v[52:55]
    s_waitcnt lgkmcnt(2)
    v_exp_f32 v142, v142
    v_mfma_f32_16x16x32_bf16 v[52:55], a[212:215], a[28:31], v[52:55]
    v_exp_f32 v143, v143
    v_mfma_f32_16x16x32_bf16 v[52:55], a[208:211], a[12:15], v[52:55]
    v_exp_f32 v148, v148
    v_mfma_f32_16x16x32_bf16 a[164:167], a[240:243], v[124:127], a[164:167]
    v_exp_f32 v149, v149
    v_mfma_f32_16x16x32_bf16 a[180:183], a[244:247], v[124:127], a[180:183]
    v_cvt_pk_bf16_f32 v133, v134, v135
    v_cvt_pk_bf16_f32 v140, v140, v141
    v_mfma_f32_16x16x32_bf16 a[176:179], a[244:247], v[116:119], a[176:179]
    buffer_load_dwordx4 v4, s[12:15], s38 offen offset:256 lds
    v_mfma_f32_16x16x32_bf16 a[160:163], a[240:243], v[116:119], a[160:163]
    ds_read_b128 a[208:211], v12 offset:6144
    v_cvt_pk_bf16_f32 v141, v142, v143
    v_mfma_f32_16x16x32_bf16 a[156:159], a[240:243], v[108:111], a[156:159]
    ds_read_b128 a[212:215], v13 offset:6144
    v_cvt_pk_bf16_f32 v148, v148, v149
    v_mfma_f32_16x16x32_bf16 a[172:175], a[244:247], v[108:111], a[172:175]
    ds_read_b128 a[216:219], v12 offset:7168
    v_accvgpr_write_b32 a111, v79
    v_mfma_f32_16x16x32_bf16 a[168:171], a[244:247], v[100:103], a[168:171]
    v_exp_f32 v150, v150
    v_mfma_f32_16x16x32_bf16 a[152:155], a[240:243], v[100:103], a[152:155]
pg_6:
    s_cbranch_execz pg_10
    v_exp_f32 v151, v151
    v_mfma_f32_16x16x32_bf16 v[160:163], a[184:187], a[0:3], 0
    s_addk_i32 m0, 1280
    ds_read_b128 a[220:223], v13 offset:7168
    v_cvt_pk_bf16_f32 v149, v150, v151
    v_mfma_f32_16x16x32_bf16 v[160:163], a[188:191], a[16:19], v[160:163]
    s_waitcnt lgkmcnt(4)
    ds_read_b128 a[224:227], v12 offset:8192
    v_accvgpr_write_b32 a112, v80
    v_mfma_f32_16x16x32_bf16 v[160:163], a[192:195], a[32:35], v[160:163]
    v_exp_f32 v156, v156
    v_mfma_f32_16x16x32_bf16 v[160:163], a[196:199], a[48:51], v[160:163]
    v_exp_f32 v157, v157
    v_mfma_f32_16x16x32_bf16 v[160:163], a[200:203], a[64:67], v[160:163]
    ds_read_b128 a[228:231], v13 offset:8192
    v_cvt_pk_bf16_f32 v156, v156, v157
    v_mfma_f32_16x16x32_bf16 v[160:163], a[204:207], a[80:83], v[160:163]
    v_exp_f32 v158, v158
    v_mfma_f32_16x16x32_bf16 v[168:171], a[204:207], a[84:87], 0
    buffer_load_dwordx4 v5, s[12:15], s38 offen offset:0 lds
    v_mfma_f32_16x16x32_bf16 v[168:171], a[200:203], a[68:71], v[168:171]
    v_exp_f32 v159, v159
    v_mfma_f32_16x16x32_bf16 v[168:171], a[196:199], a[52:55], v[168:171]
    v_exp_f32 v40, v40
    v_mfma_f32_16x16x32_bf16 v[168:171], a[192:195], a[36:39], v[168:171]
    v_exp_f32 v41, v41
    v_mfma_f32_16x16x32_bf16 v[168:171], a[188:191], a[20:23], v[168:171]
    v_exp_f32 v42, v42
    v_mfma_f32_16x16x32_bf16 v[168:171], a[184:187], a[4:7], v[168:171]
    v_exp_f32 v43, v43
    v_mfma_f32_16x16x32_bf16 v[176:179], a[184:187], a[8:11], 0
    s_addk_i32 m0, 896
    v_cvt_pk_bf16_f32 v157, v158, v159
    v_cvt_pk_bf16_f32 v134, v40, v41
    v_mfma_f32_16x16x32_bf16 v[176:179], a[188:191], a[24:27], v[176:179]
    v_exp_f32 v44, v44
    v_mfma_f32_16x16x32_bf16 v[176:179], a[192:195], a[40:43], v[176:179]
    v_exp_f32 v45, v45
    v_mfma_f32_16x16x32_bf16 v[176:179], a[196:199], a[56:59], v[176:179]
    v_exp_f32 v46, v46
    v_mfma_f32_16x16x32_bf16 v[176:179], a[200:203], a[72:75], v[176:179]
    v_exp_f32 v47, v47
    v_mfma_f32_16x16x32_bf16 v[176:179], a[204:207], a[88:91], v[176:179]
    v_cvt_pk_bf16_f32 v135, v42, v43
    v_cvt_pk_bf16_f32 v142, v44, v45
    v_mfma_f32_16x16x32_bf16 v[184:187], a[204:207], a[92:95], 0
    buffer_load_dwordx4 v5, s[12:15], s38 offen offset:128 lds
    v_mfma_f32_16x16x32_bf16 v[184:187], a[200:203], a[76:79], v[184:187]
    ds_read_b64_tr_b16 a[232:233], v8 offset:16384
    v_cvt_pk_bf16_f32 v143, v46, v47
    v_mfma_f32_16x16x32_bf16 v[184:187], a[196:199], a[60:63], v[184:187]
    ds_read_b64_tr_b16 a[234:235], v8 offset:18432
    v_accvgpr_write_b32 a113, v81
    v_mfma_f32_16x16x32_bf16 v[184:187], a[192:195], a[44:47], v[184:187]
    s_waitcnt lgkmcnt(2)
    ds_read_b64_tr_b16 a[236:237], v9 offset:16384
    v_accvgpr_write_b32 a114, v82
    v_mfma_f32_16x16x32_bf16 v[184:187], a[188:191], a[28:31], v[184:187]
    v_exp_f32 v48, v48
    v_mfma_f32_16x16x32_bf16 v[184:187], a[184:187], a[12:15], v[184:187]
    v_exp_f32 v49, v49
    v_mfma_f32_16x16x32_bf16 v[24:27], a[208:211], a[0:3], 0
    s_addk_i32 m0, 896
    ds_read_b64_tr_b16 a[238:239], v9 offset:18432
    v_cvt_pk_bf16_f32 v150, v48, v49
    v_mfma_f32_16x16x32_bf16 v[24:27], a[212:215], a[16:19], v[24:27]
    v_exp_f32 v50, v50
    v_mfma_f32_16x16x32_bf16 v[24:27], a[216:219], a[32:35], v[24:27]
    ds_read_b128 a[184:187], v12 offset:12288
    v_accvgpr_write_b32 a115, v83
    v_mfma_f32_16x16x32_bf16 v[24:27], a[220:223], a[48:51], v[24:27]
    v_exp_f32 v51, v51
    v_mfma_f32_16x16x32_bf16 v[24:27], a[224:227], a[64:67], v[24:27]
    ds_read_b128 a[188:191], v13 offset:12288
    v_cvt_pk_bf16_f32 v151, v50, v51
    v_mfma_f32_16x16x32_bf16 v[24:27], a[228:231], a[80:83], v[24:27]
    v_exp_f32 v52, v52
    v_mfma_f32_16x16x32_bf16 v[28:31], a[228:231], a[84:87], 0
    buffer_load_dwordx4 v5, s[12:15], s38 offen offset:256 lds
    v_mfma_f32_16x16x32_bf16 v[28:31], a[224:227], a[68:71], v[28:31]
    s_add_u32 s38, s38, 24576
    v_exp_f32 v53, v53
    v_mfma_f32_16x16x32_bf16 v[28:31], a[220:223], a[52:55], v[28:31]
    ds_read_b128 a[192:195], v12 offset:13312
    v_cvt_pk_bf16_f32 v158, v52, v53
    v_mfma_f32_16x16x32_bf16 v[28:31], a[216:219], a[36:39], v[28:31]
    ds_read_b128 a[196:199], v13 offset:13312
    v_accvgpr_write_b32 a116, v84
    v_mfma_f32_16x16x32_bf16 v[28:31], a[212:215], a[20:23], v[28:31]
    s_add_u32 s39, s40, 122880
    v_exp_f32 v54, v54
    v_mfma_f32_16x16x32_bf16 v[28:31], a[208:211], a[4:7], v[28:31]
    v_exp_f32 v55, v55
    v_mfma_f32_16x16x32_bf16 v[32:35], a[208:211], a[8:11], 0
    s_add_u32 m0, s63, 114688
    ds_read_b128 a[200:203], v12 offset:14336
    v_cvt_pk_bf16_f32 v159, v54, v55
    v_mfma_f32_16x16x32_bf16 v[32:35], a[212:215], a[24:27], v[32:35]
    v_exp_f32 v160, v160
    v_mfma_f32_16x16x32_bf16 v[32:35], a[216:219], a[40:43], v[32:35]
    v_exp_f32 v161, v161
    v_mfma_f32_16x16x32_bf16 v[32:35], a[220:223], a[56:59], v[32:35]
    ds_read_b128 a[204:207], v13 offset:14336
    v_cvt_pk_bf16_f32 v160, v160, v161
    v_mfma_f32_16x16x32_bf16 v[32:35], a[224:227], a[72:75], v[32:35]
    v_exp_f32 v162, v162
    v_mfma_f32_16x16x32_bf16 v[32:35], a[228:231], a[88:91], v[32:35]
    v_exp_f32 v163, v163
    v_mfma_f32_16x16x32_bf16 v[36:39], a[228:231], a[92:95], 0
    buffer_load_dwordx4 v6, s[16:19], s39 offen lds
    v_mfma_f32_16x16x32_bf16 v[36:39], a[224:227], a[76:79], v[36:39]
    v_exp_f32 v168, v168
    v_mfma_f32_16x16x32_bf16 v[36:39], a[220:223], a[60:63], v[36:39]
    v_exp_f32 v169, v169
    v_mfma_f32_16x16x32_bf16 v[36:39], a[216:219], a[44:47], v[36:39]
    s_waitcnt lgkmcnt(1)
    v_exp_f32 v170, v170
    v_mfma_f32_16x16x32_bf16 v[36:39], a[212:215], a[28:31], v[36:39]
    s_add_u32 s39, s40, 135168
    v_exp_f32 v171, v171
    v_mfma_f32_16x16x32_bf16 v[36:39], a[208:211], a[12:15], v[36:39]
    v_exp_f32 v176, v176
    v_mfma_f32_16x16x32_bf16 a[152:155], a[232:235], v[128:131], a[152:155]
    s_addk_i32 m0, 4096
    v_cvt_pk_bf16_f32 v161, v162, v163
    v_cvt_pk_bf16_f32 v168, v168, v169
    v_mfma_f32_16x16x32_bf16 a[168:171], a[236:239], v[128:131], a[168:171]
    v_exp_f32 v177, v177
    v_mfma_f32_16x16x32_bf16 a[172:175], a[236:239], v[136:139], a[172:175]
    ds_read_b128 a[208:211], v12 offset:18432
    v_cvt_pk_bf16_f32 v169, v170, v171
    v_mfma_f32_16x16x32_bf16 a[156:159], a[232:235], v[136:139], a[156:159]
    ds_read_b128 a[212:215], v13 offset:18432
    v_cvt_pk_bf16_f32 v176, v176, v177
    v_mfma_f32_16x16x32_bf16 a[160:163], a[232:235], v[144:147], a[160:163]
    ds_read_b128 a[216:219], v12 offset:19456
    v_accvgpr_write_b32 a117, v85
    v_mfma_f32_16x16x32_bf16 a[176:179], a[236:239], v[144:147], a[176:179]
    ds_read_b128 a[220:223], v13 offset:19456
    v_accvgpr_write_b32 a118, v86
    v_mfma_f32_16x16x32_bf16 a[180:183], a[236:239], v[152:155], a[180:183]
    buffer_load_dwordx4 v6, s[16:19], s39 offen lds
    v_mfma_f32_16x16x32_bf16 a[164:167], a[232:235], v[152:155], a[164:167]
    ds_read_b128 a[224:227], v12 offset:20480
    v_accvgpr_write_b32 a119, v87
    v_mfma_f32_16x16x32_bf16 v[164:167], a[184:187], a[0:3], 0
    v_exp_f32 v178, v178
    v_mfma_f32_16x16x32_bf16 v[164:167], a[188:191], a[16:19], v[164:167]
    v_exp_f32 v179, v179
    v_mfma_f32_16x16x32_bf16 v[164:167], a[192:195], a[32:35], v[164:167]
    s_waitcnt lgkmcnt(3)
    ds_read_b128 a[228:231], v13 offset:20480
    v_cvt_pk_bf16_f32 v177, v178, v179
    v_mfma_f32_16x16x32_bf16 v[164:167], a[196:199], a[48:51], v[164:167]
    v_exp_f32 v184, v184
    v_mfma_f32_16x16x32_bf16 v[164:167], a[200:203], a[64:67], v[164:167]
    v_exp_f32 v185, v185
    v_mfma_f32_16x16x32_bf16 v[164:167], a[204:207], a[80:83], v[164:167]
    v_exp_f32 v186, v186
    v_mfma_f32_16x16x32_bf16 v[172:175], a[204:207], a[84:87], 0
    v_exp_f32 v187, v187
    v_mfma_f32_16x16x32_bf16 v[172:175], a[200:203], a[68:71], v[172:175]
    v_exp_f32 v24, v24
    v_mfma_f32_16x16x32_bf16 v[172:175], a[196:199], a[52:55], v[172:175]
    v_exp_f32 v25, v25
    v_mfma_f32_16x16x32_bf16 v[172:175], a[192:195], a[36:39], v[172:175]
    v_exp_f32 v26, v26
    v_mfma_f32_16x16x32_bf16 v[172:175], a[188:191], a[20:23], v[172:175]
    v_exp_f32 v27, v27
    v_mfma_f32_16x16x32_bf16 v[172:175], a[184:187], a[4:7], v[172:175]
    v_cvt_pk_bf16_f32 v184, v184, v185
    v_cvt_pk_bf16_f32 v185, v186, v187
    v_mfma_f32_16x16x32_bf16 v[180:183], a[184:187], a[8:11], 0
    v_exp_f32 v28, v28
    v_mfma_f32_16x16x32_bf16 v[180:183], a[188:191], a[24:27], v[180:183]
    v_exp_f32 v29, v29
    v_mfma_f32_16x16x32_bf16 v[180:183], a[192:195], a[40:43], v[180:183]
    v_exp_f32 v30, v30
    v_mfma_f32_16x16x32_bf16 v[180:183], a[196:199], a[56:59], v[180:183]
    v_exp_f32 v31, v31
    v_mfma_f32_16x16x32_bf16 v[180:183], a[200:203], a[72:75], v[180:183]
    v_cvt_pk_bf16_f32 v162, v24, v25
    v_cvt_pk_bf16_f32 v163, v26, v27
    v_mfma_f32_16x16x32_bf16 v[180:183], a[204:207], a[88:91], v[180:183]
    v_exp_f32 v32, v32
    v_mfma_f32_16x16x32_bf16 v[188:191], a[204:207], a[92:95], 0
    v_exp_f32 v33, v33
    v_mfma_f32_16x16x32_bf16 v[188:191], a[200:203], a[76:79], v[188:191]
    v_exp_f32 v34, v34
    v_mfma_f32_16x16x32_bf16 v[188:191], a[196:199], a[60:63], v[188:191]
    s_add_u32 m0, s49, 0
    v_exp_f32 v35, v35
    v_mfma_f32_16x16x32_bf16 v[188:191], a[192:195], a[44:47], v[188:191]
    v_cvt_pk_bf16_f32 v170, v28, v29
    v_cvt_pk_bf16_f32 v171, v30, v31
    v_mfma_f32_16x16x32_bf16 v[188:191], a[188:191], a[28:31], v[188:191]
    v_exp_f32 v36, v36
    v_mfma_f32_16x16x32_bf16 v[188:191], a[184:187], a[12:15], v[188:191]
    s_waitcnt lgkmcnt(0)
    v_exp_f32 v37, v37
    v_mfma_f32_16x16x32_bf16 v[40:43], a[208:211], a[0:3], 0
    s_waitcnt vmcnt(11)
    v_exp_f32 v38, v38
    v_mfma_f32_16x16x32_bf16 v[40:43], a[212:215], a[16:19], v[40:43]
    s_barrier
    v_mfma_f32_16x16x32_bf16 v[40:43], a[216:219], a[32:35], v[40:43]
    buffer_load_dwordx4 v4, s[12:15], s38 offen offset:0 lds
    v_mfma_f32_16x16x32_bf16 v[40:43], a[220:223], a[48:51], v[40:43]
    ds_read_b64_tr_b16 a[240:241], v8 offset:20480
    v_cvt_pk_bf16_f32 v178, v32, v33
    v_mfma_f32_16x16x32_bf16 v[40:43], a[224:227], a[64:67], v[40:43]
    ds_read_b64_tr_b16 a[242:243], v8 offset:22528
    v_cvt_pk_bf16_f32 v179, v34, v35
    v_mfma_f32_16x16x32_bf16 v[40:43], a[228:231], a[80:83], v[40:43]
    ds_read_b64_tr_b16 a[244:245], v9 offset:20480
    v_cvt_pk_bf16_f32 v186, v36, v37
    v_mfma_f32_16x16x32_bf16 v[44:47], a[228:231], a[84:87], 0
    ds_read_b64_tr_b16 a[246:247], v9 offset:22528
    v_accvgpr_write_b32 a120, v88
    v_mfma_f32_16x16x32_bf16 v[44:47], a[224:227], a[68:71], v[44:47]
    ds_read_b128 a[184:187], v12 offset:24576
    v_accvgpr_write_b32 a121, v89
    v_mfma_f32_16x16x32_bf16 v[44:47], a[220:223], a[52:55], v[44:47]
    s_addk_i32 m0, 896
    ds_read_b128 a[188:191], v13 offset:24576
    v_accvgpr_write_b32 a122, v90
    v_mfma_f32_16x16x32_bf16 v[44:47], a[216:219], a[36:39], v[44:47]
    ds_read_b128 a[192:195], v12 offset:25600
    v_accvgpr_write_b32 a123, v91
    v_mfma_f32_16x16x32_bf16 v[44:47], a[212:215], a[20:23], v[44:47]
    v_exp_f32 v39, v39
    v_mfma_f32_16x16x32_bf16 v[44:47], a[208:211], a[4:7], v[44:47]
    ds_read_b128 a[196:199], v13 offset:25600
    v_cvt_pk_bf16_f32 v187, v38, v39
    v_mfma_f32_16x16x32_bf16 v[48:51], a[208:211], a[8:11], 0
    buffer_load_dword a252, v22, s[32:35], s42 offen offset:1536
    s_add_u32 s42, s42, 3072
    v_mfma_f32_16x16x32_bf16 v[48:51], a[212:215], a[24:27], v[48:51]
    v_exp_f32 v164, v164
    v_mfma_f32_16x16x32_bf16 v[48:51], a[216:219], a[40:43], v[48:51]
    buffer_load_dwordx4 v4, s[12:15], s38 offen offset:128 lds
    v_mfma_f32_16x16x32_bf16 v[48:51], a[220:223], a[56:59], v[48:51]
    ds_read_b128 a[200:203], v12 offset:26624
    v_accvgpr_write_b32 a124, v92
    v_mfma_f32_16x16x32_bf16 v[48:51], a[224:227], a[72:75], v[48:51]
    v_exp_f32 v165, v165
    v_mfma_f32_16x16x32_bf16 v[48:51], a[228:231], a[88:91], v[48:51]
    ds_read_b128 a[204:207], v13 offset:26624
    v_cvt_pk_bf16_f32 v164, v164, v165
    v_mfma_f32_16x16x32_bf16 v[52:55], a[228:231], a[92:95], 0
    v_exp_f32 v166, v166
    v_mfma_f32_16x16x32_bf16 v[52:55], a[224:227], a[76:79], v[52:55]
    v_exp_f32 v167, v167
    v_mfma_f32_16x16x32_bf16 v[52:55], a[220:223], a[60:63], v[52:55]
    s_addk_i32 m0, 896
    v_exp_f32 v172, v172
    v_mfma_f32_16x16x32_bf16 v[52:55], a[216:219], a[44:47], v[52:55]
    s_waitcnt lgkmcnt(2)
    v_exp_f32 v173, v173
    v_mfma_f32_16x16x32_bf16 v[52:55], a[212:215], a[28:31], v[52:55]
    v_exp_f32 v174, v174
    v_mfma_f32_16x16x32_bf16 v[52:55], a[208:211], a[12:15], v[52:55]
    v_exp_f32 v175, v175
    v_mfma_f32_16x16x32_bf16 a[164:167], a[240:243], v[156:159], a[164:167]
    v_exp_f32 v180, v180
    v_mfma_f32_16x16x32_bf16 a[180:183], a[244:247], v[156:159], a[180:183]
    v_exp_f32 v181, v181
    v_mfma_f32_16x16x32_bf16 a[176:179], a[244:247], v[148:151], a[176:179]
    buffer_load_dwordx4 v4, s[12:15], s38 offen offset:256 lds
    v_mfma_f32_16x16x32_bf16 a[160:163], a[240:243], v[148:151], a[160:163]
    ds_read_b128 a[208:211], v12 offset:30720
    v_cvt_pk_bf16_f32 v165, v166, v167
    v_mfma_f32_16x16x32_bf16 a[156:159], a[240:243], v[140:143], a[156:159]
    ds_read_b128 a[212:215], v13 offset:30720
    v_cvt_pk_bf16_f32 v172, v172, v173
    v_mfma_f32_16x16x32_bf16 a[172:175], a[244:247], v[140:143], a[172:175]
    ds_read_b128 a[216:219], v12 offset:31744
    v_cvt_pk_bf16_f32 v173, v174, v175
    v_mfma_f32_16x16x32_bf16 a[168:171], a[244:247], v[132:135], a[168:171]
    ds_read_b128 a[220:223], v13 offset:31744
    v_cvt_pk_bf16_f32 v180, v180, v181
    v_mfma_f32_16x16x32_bf16 a[152:155], a[240:243], v[132:135], a[152:155]
    ds_read_b128 a[224:227], v12 offset:32768
    v_accvgpr_write_b32 a125, v93
    v_mfma_f32_16x16x32_bf16 v[192:195], a[184:187], a[0:3], 0
    s_addk_i32 m0, 1280
    ds_read_b128 a[228:231], v13 offset:32768
    v_accvgpr_write_b32 a126, v94
    v_mfma_f32_16x16x32_bf16 v[192:195], a[188:191], a[16:19], v[192:195]
    s_waitcnt lgkmcnt(6)
    v_exp_f32 v182, v182
    v_mfma_f32_16x16x32_bf16 v[192:195], a[192:195], a[32:35], v[192:195]
    v_exp_f32 v183, v183
    v_mfma_f32_16x16x32_bf16 v[192:195], a[196:199], a[48:51], v[192:195]
    v_exp_f32 v188, v188
    v_mfma_f32_16x16x32_bf16 v[192:195], a[200:203], a[64:67], v[192:195]
    v_exp_f32 v189, v189
    v_mfma_f32_16x16x32_bf16 v[192:195], a[204:207], a[80:83], v[192:195]
    v_exp_f32 v190, v190
    v_mfma_f32_16x16x32_bf16 v[200:203], a[204:207], a[84:87], 0
    buffer_load_dwordx4 v5, s[12:15], s38 offen offset:0 lds
    v_mfma_f32_16x16x32_bf16 v[200:203], a[200:203], a[68:71], v[200:203]
    v_exp_f32 v191, v191
    v_mfma_f32_16x16x32_bf16 v[200:203], a[196:199], a[52:55], v[200:203]
    v_exp_f32 v40, v40
    v_mfma_f32_16x16x32_bf16 v[200:203], a[192:195], a[36:39], v[200:203]
    v_exp_f32 v41, v41
    v_mfma_f32_16x16x32_bf16 v[200:203], a[188:191], a[20:23], v[200:203]
    v_cvt_pk_bf16_f32 v181, v182, v183
    v_cvt_pk_bf16_f32 v188, v188, v189
    v_mfma_f32_16x16x32_bf16 v[200:203], a[184:187], a[4:7], v[200:203]
    v_exp_f32 v42, v42
    v_mfma_f32_16x16x32_bf16 v[208:211], a[184:187], a[8:11], 0
    s_addk_i32 m0, 896
    v_exp_f32 v43, v43
    v_mfma_f32_16x16x32_bf16 v[208:211], a[188:191], a[24:27], v[208:211]
    v_cvt_pk_bf16_f32 v189, v190, v191
    v_cvt_pk_bf16_f32 v166, v40, v41
    v_mfma_f32_16x16x32_bf16 v[208:211], a[192:195], a[40:43], v[208:211]
    v_exp_f32 v44, v44
    v_mfma_f32_16x16x32_bf16 v[208:211], a[196:199], a[56:59], v[208:211]
    v_exp_f32 v45, v45
    v_mfma_f32_16x16x32_bf16 v[208:211], a[200:203], a[72:75], v[208:211]
    v_exp_f32 v46, v46
    v_mfma_f32_16x16x32_bf16 v[208:211], a[204:207], a[88:91], v[208:211]
    v_exp_f32 v47, v47
    v_mfma_f32_16x16x32_bf16 v[216:219], a[204:207], a[92:95], 0
    buffer_load_dwordx4 v5, s[12:15], s38 offen offset:128 lds
    v_mfma_f32_16x16x32_bf16 v[216:219], a[200:203], a[76:79], v[216:219]
    ds_read_b64_tr_b16 a[232:233], v8 offset:24576
    v_cvt_pk_bf16_f32 v167, v42, v43
    v_mfma_f32_16x16x32_bf16 v[216:219], a[196:199], a[60:63], v[216:219]
    ds_read_b64_tr_b16 a[234:235], v8 offset:26624
    v_cvt_pk_bf16_f32 v174, v44, v45
    v_mfma_f32_16x16x32_bf16 v[216:219], a[192:195], a[44:47], v[216:219]
    s_waitcnt lgkmcnt(2)
    ds_read_b64_tr_b16 a[236:237], v9 offset:24576
    v_cvt_pk_bf16_f32 v175, v46, v47
    v_mfma_f32_16x16x32_bf16 v[216:219], a[188:191], a[28:31], v[216:219]
    ds_read_b64_tr_b16 a[238:239], v9 offset:26624
    v_accvgpr_write_b32 a127, v95
    v_mfma_f32_16x16x32_bf16 v[216:219], a[184:187], a[12:15], v[216:219]
    v_exp_f32 v48, v48
    v_mfma_f32_16x16x32_bf16 v[24:27], a[208:211], a[0:3], 0
    s_addk_i32 m0, 896
    v_exp_f32 v49, v49
    v_mfma_f32_16x16x32_bf16 v[24:27], a[212:215], a[16:19], v[24:27]
    v_exp_f32 v50, v50
    v_mfma_f32_16x16x32_bf16 v[24:27], a[216:219], a[32:35], v[24:27]
    ds_read_b128 a[184:187], v12 offset:36864
    v_cvt_pk_bf16_f32 v182, v48, v49
    v_mfma_f32_16x16x32_bf16 v[24:27], a[220:223], a[48:51], v[24:27]
    ds_read_b128 a[188:191], v13 offset:36864
    v_accvgpr_write_b32 a128, v96
    v_mfma_f32_16x16x32_bf16 v[24:27], a[224:227], a[64:67], v[24:27]
    ds_read_b128 a[192:195], v12 offset:37888
    v_accvgpr_write_b32 a129, v97
    v_mfma_f32_16x16x32_bf16 v[24:27], a[228:231], a[80:83], v[24:27]
    ds_read_b128 a[196:199], v13 offset:37888
    v_accvgpr_write_b32 a130, v98
    v_mfma_f32_16x16x32_bf16 v[28:31], a[228:231], a[84:87], 0
    buffer_load_dwordx4 v5, s[12:15], s38 offen offset:256 lds
    v_mfma_f32_16x16x32_bf16 v[28:31], a[224:227], a[68:71], v[28:31]
    s_add_u32 s38, s38, 24576
    v_exp_f32 v51, v51
    v_mfma_f32_16x16x32_bf16 v[28:31], a[220:223], a[52:55], v[28:31]
    ds_read_b128 a[200:203], v12 offset:38912
    v_cvt_pk_bf16_f32 v183, v50, v51
    v_mfma_f32_16x16x32_bf16 v[28:31], a[216:219], a[36:39], v[28:31]
    v_exp_f32 v52, v52
    v_mfma_f32_16x16x32_bf16 v[28:31], a[212:215], a[20:23], v[28:31]
    s_add_u32 s39, s40, 147456
    v_exp_f32 v53, v53
    v_mfma_f32_16x16x32_bf16 v[28:31], a[208:211], a[4:7], v[28:31]
    ds_read_b128 a[204:207], v13 offset:38912
    v_cvt_pk_bf16_f32 v190, v52, v53
    v_mfma_f32_16x16x32_bf16 v[32:35], a[208:211], a[8:11], 0
    s_add_u32 m0, s63, 122880
    v_exp_f32 v54, v54
    v_mfma_f32_16x16x32_bf16 v[32:35], a[212:215], a[24:27], v[32:35]
    v_exp_f32 v55, v55
    v_mfma_f32_16x16x32_bf16 v[32:35], a[216:219], a[40:43], v[32:35]
    v_exp_f32 v192, v192
    v_mfma_f32_16x16x32_bf16 v[32:35], a[220:223], a[56:59], v[32:35]
    v_exp_f32 v193, v193
    v_mfma_f32_16x16x32_bf16 v[32:35], a[224:227], a[72:75], v[32:35]
    v_exp_f32 v194, v194
    v_mfma_f32_16x16x32_bf16 v[32:35], a[228:231], a[88:91], v[32:35]
    v_exp_f32 v195, v195
    v_mfma_f32_16x16x32_bf16 v[36:39], a[228:231], a[92:95], 0
    buffer_load_dwordx4 v6, s[16:19], s39 offen lds
    v_mfma_f32_16x16x32_bf16 v[36:39], a[224:227], a[76:79], v[36:39]
    v_exp_f32 v200, v200
    v_mfma_f32_16x16x32_bf16 v[36:39], a[220:223], a[60:63], v[36:39]
    v_exp_f32 v201, v201
    v_mfma_f32_16x16x32_bf16 v[36:39], a[216:219], a[44:47], v[36:39]
    s_waitcnt lgkmcnt(0)
    v_cvt_pk_bf16_f32 v191, v54, v55
    v_cvt_pk_bf16_f32 v192, v192, v193
    v_mfma_f32_16x16x32_bf16 v[36:39], a[212:215], a[28:31], v[36:39]
    s_add_u32 s39, s40, 159744
    v_exp_f32 v202, v202
    v_mfma_f32_16x16x32_bf16 v[36:39], a[208:211], a[12:15], v[36:39]
    v_exp_f32 v203, v203
    v_mfma_f32_16x16x32_bf16 a[152:155], a[232:235], v[160:163], a[152:155]
    s_addk_i32 m0, 4096
    v_cvt_pk_bf16_f32 v193, v194, v195
    v_cvt_pk_bf16_f32 v200, v200, v201
    v_mfma_f32_16x16x32_bf16 a[168:171], a[236:239], v[160:163], a[168:171]
    v_exp_f32 v208, v208
    v_mfma_f32_16x16x32_bf16 a[172:175], a[236:239], v[168:171], a[172:175]
    ds_read_b128 a[208:211], v12 offset:43008
    v_cvt_pk_bf16_f32 v201, v202, v203
    v_mfma_f32_16x16x32_bf16 a[156:159], a[232:235], v[168:171], a[156:159]
    ds_read_b128 a[212:215], v13 offset:43008
    v_accvgpr_write_b32 a131, v99
    v_mfma_f32_16x16x32_bf16 a[160:163], a[232:235], v[176:179], a[160:163]
    ds_read_b128 a[216:219], v12 offset:44032
    v_accvgpr_write_b32 a132, v100
    v_mfma_f32_16x16x32_bf16 a[176:179], a[236:239], v[176:179], a[176:179]
    ds_read_b128 a[220:223], v13 offset:44032
    v_accvgpr_write_b32 a133, v101
    v_mfma_f32_16x16x32_bf16 a[180:183], a[236:239], v[184:187], a[180:183]
    buffer_load_dwordx4 v6, s[16:19], s39 offen lds
    v_mfma_f32_16x16x32_bf16 a[164:167], a[232:235], v[184:187], a[164:167]
    v_exp_f32 v209, v209
    v_mfma_f32_16x16x32_bf16 v[196:199], a[184:187], a[0:3], 0
    ds_read_b128 a[224:227], v12 offset:45056
    v_cvt_pk_bf16_f32 v208, v208, v209
    v_mfma_f32_16x16x32_bf16 v[196:199], a[188:191], a[16:19], v[196:199]
    v_exp_f32 v210, v210
    v_mfma_f32_16x16x32_bf16 v[196:199], a[192:195], a[32:35], v[196:199]
    v_exp_f32 v211, v211
    v_mfma_f32_16x16x32_bf16 v[196:199], a[196:199], a[48:51], v[196:199]
    ds_read_b128 a[228:231], v13 offset:45056
    v_cvt_pk_bf16_f32 v209, v210, v211
    v_mfma_f32_16x16x32_bf16 v[196:199], a[200:203], a[64:67], v[196:199]
    v_exp_f32 v216, v216
    v_mfma_f32_16x16x32_bf16 v[196:199], a[204:207], a[80:83], v[196:199]
    v_exp_f32 v217, v217
    v_mfma_f32_16x16x32_bf16 v[204:207], a[204:207], a[84:87], 0
    v_exp_f32 v218, v218
    v_mfma_f32_16x16x32_bf16 v[204:207], a[200:203], a[68:71], v[204:207]
    v_exp_f32 v219, v219
    v_mfma_f32_16x16x32_bf16 v[204:207], a[196:199], a[52:55], v[204:207]
    v_exp_f32 v24, v24
    v_mfma_f32_16x16x32_bf16 v[204:207], a[192:195], a[36:39], v[204:207]
    v_exp_f32 v25, v25
    v_mfma_f32_16x16x32_bf16 v[204:207], a[188:191], a[20:23], v[204:207]
    v_exp_f32 v26, v26
    v_mfma_f32_16x16x32_bf16 v[204:207], a[184:187], a[4:7], v[204:207]
    v_exp_f32 v27, v27
    v_mfma_f32_16x16x32_bf16 v[212:215], a[184:187], a[8:11], 0
    v_cvt_pk_bf16_f32 v216, v216, v217
    v_cvt_pk_bf16_f32 v217, v218, v219
    v_mfma_f32_16x16x32_bf16 v[212:215], a[188:191], a[24:27], v[212:215]
    v_exp_f32 v28, v28
    v_mfma_f32_16x16x32_bf16 v[212:215], a[192:195], a[40:43], v[212:215]
    v_exp_f32 v29, v29
    v_mfma_f32_16x16x32_bf16 v[212:215], a[196:199], a[56:59], v[212:215]
    v_exp_f32 v30, v30
    v_mfma_f32_16x16x32_bf16 v[212:215], a[200:203], a[72:75], v[212:215]
    v_exp_f32 v31, v31
    v_mfma_f32_16x16x32_bf16 v[212:215], a[204:207], a[88:91], v[212:215]
    v_cvt_pk_bf16_f32 v194, v24, v25
    v_cvt_pk_bf16_f32 v195, v26, v27
    v_mfma_f32_16x16x32_bf16 v[220:223], a[204:207], a[92:95], 0
    v_exp_f32 v32, v32
    v_mfma_f32_16x16x32_bf16 v[220:223], a[200:203], a[76:79], v[220:223]
    v_exp_f32 v33, v33
    v_mfma_f32_16x16x32_bf16 v[220:223], a[196:199], a[60:63], v[220:223]
    s_add_u32 m0, s49, 24576
    v_exp_f32 v34, v34
    v_mfma_f32_16x16x32_bf16 v[220:223], a[192:195], a[44:47], v[220:223]
    s_waitcnt lgkmcnt(0)
    v_exp_f32 v35, v35
    v_mfma_f32_16x16x32_bf16 v[220:223], a[188:191], a[28:31], v[220:223]
    v_cvt_pk_bf16_f32 v202, v28, v29
    v_cvt_pk_bf16_f32 v203, v30, v31
    v_mfma_f32_16x16x32_bf16 v[220:223], a[184:187], a[12:15], v[220:223]
    v_exp_f32 v36, v36
    v_mfma_f32_16x16x32_bf16 v[40:43], a[208:211], a[0:3], 0
    s_waitcnt vmcnt(11)
    v_exp_f32 v37, v37
    v_mfma_f32_16x16x32_bf16 v[40:43], a[212:215], a[16:19], v[40:43]
    s_barrier
    v_mfma_f32_16x16x32_bf16 v[40:43], a[216:219], a[32:35], v[40:43]
    buffer_load_dwordx4 v4, s[12:15], s38 offen offset:0 lds
    v_mfma_f32_16x16x32_bf16 v[40:43], a[220:223], a[48:51], v[40:43]
    ds_read_b64_tr_b16 a[240:241], v8 offset:28672
    v_cvt_pk_bf16_f32 v210, v32, v33
    v_mfma_f32_16x16x32_bf16 v[40:43], a[224:227], a[64:67], v[40:43]
    ds_read_b64_tr_b16 a[242:243], v8 offset:30720
    v_cvt_pk_bf16_f32 v211, v34, v35
    v_mfma_f32_16x16x32_bf16 v[40:43], a[228:231], a[80:83], v[40:43]
    ds_read_b64_tr_b16 a[244:245], v9 offset:28672
    v_cvt_pk_bf16_f32 v218, v36, v37
    v_mfma_f32_16x16x32_bf16 v[44:47], a[228:231], a[84:87], 0
    ds_read_b64_tr_b16 a[246:247], v9 offset:30720
    v_accvgpr_write_b32 a134, v102
    v_mfma_f32_16x16x32_bf16 v[44:47], a[224:227], a[68:71], v[44:47]
    ds_read_b128 a[184:187], v12 offset:49152
    v_accvgpr_write_b32 a135, v103
    v_mfma_f32_16x16x32_bf16 v[44:47], a[220:223], a[52:55], v[44:47]
    s_addk_i32 m0, 896
    ds_read_b128 a[188:191], v13 offset:49152
    v_accvgpr_write_b32 a136, v104
    v_mfma_f32_16x16x32_bf16 v[44:47], a[216:219], a[36:39], v[44:47]
    ds_read_b128 a[192:195], v12 offset:50176
    v_accvgpr_write_b32 a137, v105
    v_mfma_f32_16x16x32_bf16 v[44:47], a[212:215], a[20:23], v[44:47]
    v_exp_f32 v38, v38
    v_mfma_f32_16x16x32_bf16 v[44:47], a[208:211], a[4:7], v[44:47]
    v_exp_f32 v39, v39
    v_mfma_f32_16x16x32_bf16 v[48:51], a[208:211], a[8:11], 0
    buffer_load_dword a252, v22, s[32:35], s42 offen offset:0
    v_mfma_f32_16x16x32_bf16 v[48:51], a[212:215], a[24:27], v[48:51]
    ds_read_b128 a[196:199], v13 offset:50176
    v_cvt_pk_bf16_f32 v219, v38, v39
    v_mfma_f32_16x16x32_bf16 v[48:51], a[216:219], a[40:43], v[48:51]
    buffer_load_dwordx4 v4, s[12:15], s38 offen offset:128 lds
    v_mfma_f32_16x16x32_bf16 v[48:51], a[220:223], a[56:59], v[48:51]
    ds_read_b128 a[200:203], v12 offset:51200
    v_accvgpr_write_b32 a138, v106
    v_mfma_f32_16x16x32_bf16 v[48:51], a[224:227], a[72:75], v[48:51]
    v_exp_f32 v196, v196
    v_mfma_f32_16x16x32_bf16 v[48:51], a[228:231], a[88:91], v[48:51]
    v_exp_f32 v197, v197
    v_mfma_f32_16x16x32_bf16 v[52:55], a[228:231], a[92:95], 0
    ds_read_b128 a[204:207], v13 offset:51200
    v_cvt_pk_bf16_f32 v196, v196, v197
    v_mfma_f32_16x16x32_bf16 v[52:55], a[224:227], a[76:79], v[52:55]
    v_exp_f32 v198, v198
    v_mfma_f32_16x16x32_bf16 v[52:55], a[220:223], a[60:63], v[52:55]
    s_addk_i32 m0, 896
    v_exp_f32 v199, v199
    v_mfma_f32_16x16x32_bf16 v[52:55], a[216:219], a[44:47], v[52:55]
    s_waitcnt lgkmcnt(2)
    v_exp_f32 v204, v204
    v_mfma_f32_16x16x32_bf16 v[52:55], a[212:215], a[28:31], v[52:55]
    v_exp_f32 v205, v205
    v_mfma_f32_16x16x32_bf16 v[52:55], a[208:211], a[12:15], v[52:55]
    v_exp_f32 v206, v206
    v_mfma_f32_16x16x32_bf16 a[164:167], a[240:243], v[188:191], a[164:167]
    v_exp_f32 v207, v207
    v_mfma_f32_16x16x32_bf16 a[180:183], a[244:247], v[188:191], a[180:183]
    v_exp_f32 v212, v212
    v_mfma_f32_16x16x32_bf16 a[176:179], a[244:247], v[180:183], a[176:179]
    buffer_load_dwordx4 v4, s[12:15], s38 offen offset:256 lds
    v_mfma_f32_16x16x32_bf16 a[160:163], a[240:243], v[180:183], a[160:163]
    ds_read_b128 a[208:211], v12 offset:55296
    v_cvt_pk_bf16_f32 v197, v198, v199
    v_mfma_f32_16x16x32_bf16 a[156:159], a[240:243], v[172:175], a[156:159]
    ds_read_b128 a[212:215], v13 offset:55296
    v_cvt_pk_bf16_f32 v204, v204, v205
    v_mfma_f32_16x16x32_bf16 a[172:175], a[244:247], v[172:175], a[172:175]
    ds_read_b128 a[216:219], v12 offset:56320
    v_cvt_pk_bf16_f32 v205, v206, v207
    v_mfma_f32_16x16x32_bf16 a[168:171], a[244:247], v[164:167], a[168:171]
    ds_read_b128 a[220:223], v13 offset:56320
    v_accvgpr_write_b32 a139, v107
    v_mfma_f32_16x16x32_bf16 a[152:155], a[240:243], v[164:167], a[152:155]
    ds_read_b128 a[224:227], v12 offset:57344
    v_accvgpr_write_b32 a140, v108
    v_mfma_f32_16x16x32_bf16 v[224:227], a[184:187], a[0:3], 0
    s_addk_i32 m0, 1280
    v_exp_f32 v213, v213
    v_mfma_f32_16x16x32_bf16 v[224:227], a[188:191], a[16:19], v[224:227]
    s_waitcnt lgkmcnt(5)
    ds_read_b128 a[228:231], v13 offset:57344
    v_cvt_pk_bf16_f32 v212, v212, v213
    v_mfma_f32_16x16x32_bf16 v[224:227], a[192:195], a[32:35], v[224:227]
    v_exp_f32 v214, v214
    v_mfma_f32_16x16x32_bf16 v[224:227], a[196:199], a[48:51], v[224:227]
    v_exp_f32 v215, v215
    v_mfma_f32_16x16x32_bf16 v[224:227], a[200:203], a[64:67], v[224:227]
    v_exp_f32 v220, v220
    v_mfma_f32_16x16x32_bf16 v[224:227], a[204:207], a[80:83], v[224:227]
    v_exp_f32 v221, v221
    v_mfma_f32_16x16x32_bf16 v[232:235], a[204:207], a[84:87], 0
    buffer_load_dwordx4 v5, s[12:15], s38 offen offset:0 lds
    v_mfma_f32_16x16x32_bf16 v[232:235], a[200:203], a[68:71], v[232:235]
    v_exp_f32 v222, v222
    v_mfma_f32_16x16x32_bf16 v[232:235], a[196:199], a[52:55], v[232:235]
    v_exp_f32 v223, v223
    v_mfma_f32_16x16x32_bf16 v[232:235], a[192:195], a[36:39], v[232:235]
    v_exp_f32 v40, v40
    v_mfma_f32_16x16x32_bf16 v[232:235], a[188:191], a[20:23], v[232:235]
    v_exp_f32 v41, v41
    v_mfma_f32_16x16x32_bf16 v[232:235], a[184:187], a[4:7], v[232:235]
    v_cvt_pk_bf16_f32 v213, v214, v215
    v_cvt_pk_bf16_f32 v220, v220, v221
    v_mfma_f32_16x16x32_bf16 v[240:243], a[184:187], a[8:11], 0
    s_addk_i32 m0, 896
    v_exp_f32 v42, v42
    v_mfma_f32_16x16x32_bf16 v[240:243], a[188:191], a[24:27], v[240:243]
pg_7:
    s_cbranch_execz pg_11
    v_exp_f32 v43, v43
    v_mfma_f32_16x16x32_bf16 v[240:243], a[192:195], a[40:43], v[240:243]
    v_cvt_pk_bf16_f32 v221, v222, v223
    v_cvt_pk_bf16_f32 v198, v40, v41
    v_mfma_f32_16x16x32_bf16 v[240:243], a[196:199], a[56:59], v[240:243]
    v_exp_f32 v44, v44
    v_mfma_f32_16x16x32_bf16 v[240:243], a[200:203], a[72:75], v[240:243]
    v_exp_f32 v45, v45
    v_mfma_f32_16x16x32_bf16 v[240:243], a[204:207], a[88:91], v[240:243]
    v_exp_f32 v46, v46
    v_mfma_f32_16x16x32_bf16 v[248:251], a[204:207], a[92:95], 0
    buffer_load_dwordx4 v5, s[12:15], s38 offen offset:128 lds
    v_mfma_f32_16x16x32_bf16 v[248:251], a[200:203], a[76:79], v[248:251]
    ds_read_b64_tr_b16 a[232:233], v8 offset:32768
    v_cvt_pk_bf16_f32 v199, v42, v43
    v_mfma_f32_16x16x32_bf16 v[248:251], a[196:199], a[60:63], v[248:251]
    ds_read_b64_tr_b16 a[234:235], v8 offset:34816
    v_cvt_pk_bf16_f32 v206, v44, v45
    v_mfma_f32_16x16x32_bf16 v[248:251], a[192:195], a[44:47], v[248:251]
    s_waitcnt lgkmcnt(2)
    ds_read_b64_tr_b16 a[236:237], v9 offset:32768
    v_accvgpr_write_b32 a141, v109
    v_mfma_f32_16x16x32_bf16 v[248:251], a[188:191], a[28:31], v[248:251]
    ds_read_b64_tr_b16 a[238:239], v9 offset:34816
    v_accvgpr_write_b32 a142, v110
    v_mfma_f32_16x16x32_bf16 v[248:251], a[184:187], a[12:15], v[248:251]
    v_exp_f32 v47, v47
    v_mfma_f32_16x16x32_bf16 v[24:27], a[208:211], a[0:3], 0
    s_addk_i32 m0, 896
    v_exp_f32 v48, v48
    v_mfma_f32_16x16x32_bf16 v[24:27], a[212:215], a[16:19], v[24:27]
    v_exp_f32 v49, v49
    v_mfma_f32_16x16x32_bf16 v[24:27], a[216:219], a[32:35], v[24:27]
    ds_read_b128 a[184:187], v12 offset:61440
    v_cvt_pk_bf16_f32 v207, v46, v47
    v_mfma_f32_16x16x32_bf16 v[24:27], a[220:223], a[48:51], v[24:27]
    ds_read_b128 a[188:191], v13 offset:61440
    v_cvt_pk_bf16_f32 v214, v48, v49
    v_mfma_f32_16x16x32_bf16 v[24:27], a[224:227], a[64:67], v[24:27]
    ds_read_b128 a[192:195], v12 offset:62464
    v_accvgpr_write_b32 a143, v111
    v_mfma_f32_16x16x32_bf16 v[24:27], a[228:231], a[80:83], v[24:27]
    ds_read_b128 a[196:199], v13 offset:62464
    v_accvgpr_write_b32 a144, v112
    v_mfma_f32_16x16x32_bf16 v[28:31], a[228:231], a[84:87], 0
    buffer_load_dwordx4 v5, s[12:15], s38 offen offset:256 lds
    v_mfma_f32_16x16x32_bf16 v[28:31], a[224:227], a[68:71], v[28:31]
    s_add_u32 s38, s38, 24576
    v_exp_f32 v50, v50
    v_mfma_f32_16x16x32_bf16 v[28:31], a[220:223], a[52:55], v[28:31]
    v_exp_f32 v51, v51
    v_mfma_f32_16x16x32_bf16 v[28:31], a[216:219], a[36:39], v[28:31]
    ds_read_b128 a[200:203], v12 offset:63488
    v_cvt_pk_bf16_f32 v215, v50, v51
    v_mfma_f32_16x16x32_bf16 v[28:31], a[212:215], a[20:23], v[28:31]
    s_add_u32 s39, s40, 172032
    ds_read_b128 a[204:207], v13 offset:63488
    v_add_u32 v12, 67584, v12
    v_mfma_f32_16x16x32_bf16 v[28:31], a[208:211], a[4:7], v[28:31]
    v_exp_f32 v52, v52
    v_mfma_f32_16x16x32_bf16 v[32:35], a[208:211], a[8:11], 0
    s_add_u32 m0, s63, 131072
    v_exp_f32 v53, v53
    v_mfma_f32_16x16x32_bf16 v[32:35], a[212:215], a[24:27], v[32:35]
    v_exp_f32 v54, v54
    v_mfma_f32_16x16x32_bf16 v[32:35], a[216:219], a[40:43], v[32:35]
    v_exp_f32 v55, v55
    v_mfma_f32_16x16x32_bf16 v[32:35], a[220:223], a[56:59], v[32:35]
    v_cvt_pk_bf16_f32 v222, v52, v53
    v_cvt_pk_bf16_f32 v223, v54, v55
    v_mfma_f32_16x16x32_bf16 v[32:35], a[224:227], a[72:75], v[32:35]
    v_exp_f32 v224, v224
    v_mfma_f32_16x16x32_bf16 v[32:35], a[228:231], a[88:91], v[32:35]
    v_exp_f32 v225, v225
    v_mfma_f32_16x16x32_bf16 v[36:39], a[228:231], a[92:95], 0
    buffer_load_dwordx4 v6, s[16:19], s39 offen lds
    v_mfma_f32_16x16x32_bf16 v[36:39], a[224:227], a[76:79], v[36:39]
    v_exp_f32 v226, v226
    v_mfma_f32_16x16x32_bf16 v[36:39], a[220:223], a[60:63], v[36:39]
    v_exp_f32 v227, v227
    v_mfma_f32_16x16x32_bf16 v[36:39], a[216:219], a[44:47], v[36:39]
    s_waitcnt lgkmcnt(0)
    v_exp_f32 v232, v232
    v_mfma_f32_16x16x32_bf16 v[36:39], a[212:215], a[28:31], v[36:39]
    s_add_u32 s39, s40, 184320
    v_exp_f32 v233, v233
    v_mfma_f32_16x16x32_bf16 v[36:39], a[208:211], a[12:15], v[36:39]
    v_exp_f32 v234, v234
    v_mfma_f32_16x16x32_bf16 a[152:155], a[232:235], v[192:195], a[152:155]
    s_addk_i32 m0, 4096
    v_exp_f32 v235, v235
    v_mfma_f32_16x16x32_bf16 a[168:171], a[236:239], v[192:195], a[168:171]
    v_cvt_pk_bf16_f32 v224, v224, v225
    v_cvt_pk_bf16_f32 v225, v226, v227
    v_mfma_f32_16x16x32_bf16 a[172:175], a[236:239], v[200:203], a[172:175]
    ds_read_b128 a[208:211], v12 offset:0
    v_cvt_pk_bf16_f32 v232, v232, v233
    v_mfma_f32_16x16x32_bf16 a[156:159], a[232:235], v[200:203], a[156:159]
    v_exp_f32 v240, v240
    v_mfma_f32_16x16x32_bf16 a[160:163], a[232:235], v[208:211], a[160:163]
    v_exp_f32 v241, v241
    v_mfma_f32_16x16x32_bf16 a[176:179], a[236:239], v[208:211], a[176:179]
    v_exp_f32 v242, v242
    v_mfma_f32_16x16x32_bf16 a[180:183], a[236:239], v[216:219], a[180:183]
    buffer_load_dwordx4 v6, s[16:19], s39 offen lds
    v_mfma_f32_16x16x32_bf16 a[164:167], a[232:235], v[216:219], a[164:167]
    v_exp_f32 v243, v243
    v_mfma_f32_16x16x32_bf16 v[228:231], a[184:187], a[0:3], 0
    v_cvt_pk_bf16_f32 v233, v234, v235
    v_cvt_pk_bf16_f32 v240, v240, v241
    v_mfma_f32_16x16x32_bf16 v[228:231], a[188:191], a[16:19], v[228:231]
    v_exp_f32 v248, v248
    v_mfma_f32_16x16x32_bf16 v[228:231], a[192:195], a[32:35], v[228:231]
    v_exp_f32 v249, v249
    v_mfma_f32_16x16x32_bf16 v[228:231], a[196:199], a[48:51], v[228:231]
    v_exp_f32 v250, v250
    v_mfma_f32_16x16x32_bf16 v[228:231], a[200:203], a[64:67], v[228:231]
    v_exp_f32 v251, v251
    v_mfma_f32_16x16x32_bf16 v[228:231], a[204:207], a[80:83], v[228:231]
    v_cvt_pk_bf16_f32 v241, v242, v243
    v_cvt_pk_bf16_f32 v248, v248, v249
    v_mfma_f32_16x16x32_bf16 v[236:239], a[204:207], a[84:87], 0
    v_exp_f32 v24, v24
    v_mfma_f32_16x16x32_bf16 v[236:239], a[200:203], a[68:71], v[236:239]
    v_exp_f32 v25, v25
    v_mfma_f32_16x16x32_bf16 v[236:239], a[196:199], a[52:55], v[236:239]
    v_exp_f32 v26, v26
    v_mfma_f32_16x16x32_bf16 v[236:239], a[192:195], a[36:39], v[236:239]
    v_exp_f32 v27, v27
    v_mfma_f32_16x16x32_bf16 v[236:239], a[188:191], a[20:23], v[236:239]
    v_cvt_pk_bf16_f32 v249, v250, v251
    v_cvt_pk_bf16_f32 v226, v24, v25
    v_mfma_f32_16x16x32_bf16 v[236:239], a[184:187], a[4:7], v[236:239]
    v_exp_f32 v28, v28
    v_mfma_f32_16x16x32_bf16 v[244:247], a[184:187], a[8:11], 0
    v_exp_f32 v29, v29
    v_mfma_f32_16x16x32_bf16 v[244:247], a[188:191], a[24:27], v[244:247]
    v_exp_f32 v30, v30
    v_add_u32 v13, 67584, v13
    v_mfma_f32_16x16x32_bf16 v[244:247], a[192:195], a[40:43], v[244:247]
    ds_read_b128 a[212:215], v13 offset:0
    v_cvt_pk_bf16_f32 v227, v26, v27
    v_mfma_f32_16x16x32_bf16 v[244:247], a[196:199], a[56:59], v[244:247]
    ds_read_b128 a[216:219], v12 offset:1024
    v_cvt_pk_bf16_f32 v234, v28, v29
    v_mfma_f32_16x16x32_bf16 v[244:247], a[200:203], a[72:75], v[244:247]
    ds_read_b128 a[220:223], v13 offset:1024
    v_accvgpr_write_b32 a145, v113
    v_mfma_f32_16x16x32_bf16 v[244:247], a[204:207], a[88:91], v[244:247]
    ds_read_b128 a[224:227], v12 offset:2048
    v_accvgpr_write_b32 a146, v114
    v_mfma_f32_16x16x32_bf16 v[252:255], a[204:207], a[92:95], 0
    s_add_u32 s39, s40, 128
    ds_read_b128 a[228:231], v13 offset:2048
    v_accvgpr_write_b32 a147, v115
    v_mfma_f32_16x16x32_bf16 v[252:255], a[200:203], a[76:79], v[252:255]
    v_exp_f32 v31, v31
    v_mfma_f32_16x16x32_bf16 v[252:255], a[196:199], a[60:63], v[252:255]
    s_add_u32 m0, s63, 49152
    v_exp_f32 v32, v32
    v_mfma_f32_16x16x32_bf16 v[252:255], a[192:195], a[44:47], v[252:255]
    s_waitcnt lgkmcnt(4)
    v_exp_f32 v33, v33
    v_mfma_f32_16x16x32_bf16 v[252:255], a[188:191], a[28:31], v[252:255]
    v_exp_f32 v34, v34
    v_mfma_f32_16x16x32_bf16 v[252:255], a[184:187], a[12:15], v[252:255]
    s_waitcnt lgkmcnt(2)
    v_exp_f32 v35, v35
    v_mfma_f32_16x16x32_bf16 v[40:43], a[208:211], a[0:3], 0
    s_waitcnt vmcnt(11) lgkmcnt(0)
    v_cvt_pk_bf16_f32 v235, v30, v31
    v_cvt_pk_bf16_f32 v242, v32, v33
    v_mfma_f32_16x16x32_bf16 v[40:43], a[212:215], a[16:19], v[40:43]
    s_barrier
    v_mfma_f32_16x16x32_bf16 v[40:43], a[216:219], a[32:35], v[40:43]
    buffer_load_dwordx4 v6, s[16:19], s39 offen lds
    v_mfma_f32_16x16x32_bf16 v[40:43], a[220:223], a[48:51], v[40:43]
    ds_read_b64_tr_b16 a[240:241], v8 offset:36864
    v_cvt_pk_bf16_f32 v243, v34, v35
    v_mfma_f32_16x16x32_bf16 v[40:43], a[224:227], a[64:67], v[40:43]
    ds_read_b64_tr_b16 a[242:243], v8 offset:38912
    v_subrev_u32 v12, 67584, v12
    v_mfma_f32_16x16x32_bf16 v[40:43], a[228:231], a[80:83], v[40:43]
    ds_read_b64_tr_b16 a[244:245], v9 offset:36864
    v_accvgpr_write_b32 a148, v116
    v_mfma_f32_16x16x32_bf16 v[44:47], a[228:231], a[84:87], 0
    s_add_u32 s39, s40, 12416
    ds_read_b64_tr_b16 a[246:247], v9 offset:38912
    v_subrev_u32 v13, 67584, v13
    v_mfma_f32_16x16x32_bf16 v[44:47], a[224:227], a[68:71], v[44:47]
    ds_read_b128 a[184:187], v12 offset:0
    v_accvgpr_write_b32 a149, v117
    v_mfma_f32_16x16x32_bf16 v[44:47], a[220:223], a[52:55], v[44:47]
    s_addk_i32 m0, 4096
    ds_read_b128 a[188:191], v13 offset:0
    v_accvgpr_write_b32 a150, v118
    v_mfma_f32_16x16x32_bf16 v[44:47], a[216:219], a[36:39], v[44:47]
    ds_read_b128 a[192:195], v12 offset:1024
    v_accvgpr_write_b32 a151, v119
    v_mfma_f32_16x16x32_bf16 v[44:47], a[212:215], a[20:23], v[44:47]
    v_exp_f32 v36, v36
    v_mfma_f32_16x16x32_bf16 v[44:47], a[208:211], a[4:7], v[44:47]
    v_exp_f32 v37, v37
    v_mfma_f32_16x16x32_bf16 v[48:51], a[208:211], a[8:11], 0
    s_lshl_b32 s42, s54, 4
    ds_read_b128 a[196:199], v13 offset:1024
    v_cvt_pk_bf16_f32 v250, v36, v37
    v_mfma_f32_16x16x32_bf16 v[48:51], a[212:215], a[24:27], v[48:51]
    s_mul_i32 s42, s42, 384
    ds_read_b128 a[200:203], v12 offset:2048
    v_and_b32 v22, 15, v1
    v_mfma_f32_16x16x32_bf16 v[48:51], a[216:219], a[40:43], v[48:51]
    buffer_load_dwordx4 v6, s[16:19], s39 offen lds
    v_mfma_f32_16x16x32_bf16 v[48:51], a[220:223], a[56:59], v[48:51]
    ds_read_b128 a[204:207], v13 offset:2048
    v_mul_u32_u24 v22, 384, v22
    v_mfma_f32_16x16x32_bf16 v[48:51], a[224:227], a[72:75], v[48:51]
    buffer_load_dword a252, v22, s[16:19], s42 offen offset:256
    v_mfma_f32_16x16x32_bf16 v[48:51], a[228:231], a[88:91], v[48:51]
    v_exp_f32 v38, v38
    v_mfma_f32_16x16x32_bf16 v[52:55], a[228:231], a[92:95], 0
    s_add_u32 s39, s40, 24704
    v_exp_f32 v39, v39
    v_mfma_f32_16x16x32_bf16 v[52:55], a[224:227], a[76:79], v[52:55]
    v_exp_f32 v228, v228
    v_mfma_f32_16x16x32_bf16 v[52:55], a[220:223], a[60:63], v[52:55]
    s_addk_i32 m0, 4096
    v_exp_f32 v229, v229
    v_mfma_f32_16x16x32_bf16 v[52:55], a[216:219], a[44:47], v[52:55]
    s_waitcnt lgkmcnt(1)
    v_exp_f32 v230, v230
    v_mfma_f32_16x16x32_bf16 v[52:55], a[212:215], a[28:31], v[52:55]
    v_exp_f32 v231, v231
    v_mfma_f32_16x16x32_bf16 v[52:55], a[208:211], a[12:15], v[52:55]
    v_exp_f32 v236, v236
    v_mfma_f32_16x16x32_bf16 a[164:167], a[240:243], v[220:223], a[164:167]
    v_exp_f32 v237, v237
    v_mfma_f32_16x16x32_bf16 a[180:183], a[244:247], v[220:223], a[180:183]
    v_exp_f32 v238, v238
    v_mfma_f32_16x16x32_bf16 a[176:179], a[244:247], v[212:215], a[176:179]
    buffer_load_dwordx4 v6, s[16:19], s39 offen lds
    v_mfma_f32_16x16x32_bf16 a[160:163], a[240:243], v[212:215], a[160:163]
    ds_read_b128 a[208:211], v12 offset:6144
    v_cvt_pk_bf16_f32 v251, v38, v39
    v_mfma_f32_16x16x32_bf16 a[156:159], a[240:243], v[204:207], a[156:159]
    ds_read_b128 a[212:215], v13 offset:6144
    v_cvt_pk_bf16_f32 v228, v228, v229
    v_mfma_f32_16x16x32_bf16 a[172:175], a[244:247], v[204:207], a[172:175]
    ds_read_b128 a[216:219], v12 offset:7168
    v_cvt_pk_bf16_f32 v229, v230, v231
    v_mfma_f32_16x16x32_bf16 a[168:171], a[244:247], v[196:199], a[168:171]
    s_add_u32 s39, s40, 36992
    ds_read_b128 a[220:223], v13 offset:7168
    v_cvt_pk_bf16_f32 v236, v236, v237
    v_mfma_f32_16x16x32_bf16 a[152:155], a[240:243], v[196:199], a[152:155]
    v_exp_f32 v239, v239
    v_mfma_f32_16x16x32_bf16 v[56:59], a[184:187], a[0:3], 0
    s_addk_i32 m0, 4096
    ds_read_b128 a[224:227], v12 offset:8192
    v_cvt_pk_bf16_f32 v237, v238, v239
    v_mfma_f32_16x16x32_bf16 v[56:59], a[188:191], a[16:19], v[56:59]
    v_exp_f32 v244, v244
    v_mfma_f32_16x16x32_bf16 v[56:59], a[192:195], a[32:35], v[56:59]
    s_waitcnt lgkmcnt(4)
    v_exp_f32 v245, v245
    v_mfma_f32_16x16x32_bf16 v[56:59], a[196:199], a[48:51], v[56:59]
    ds_read_b128 a[228:231], v13 offset:8192
    v_cvt_pk_bf16_f32 v244, v244, v245
    v_mfma_f32_16x16x32_bf16 v[56:59], a[200:203], a[64:67], v[56:59]
    v_exp_f32 v246, v246
    v_mfma_f32_16x16x32_bf16 v[56:59], a[204:207], a[80:83], v[56:59]
    v_exp_f32 v247, v247
    v_mfma_f32_16x16x32_bf16 v[64:67], a[204:207], a[84:87], 0
    buffer_load_dwordx4 v6, s[16:19], s39 offen lds
    v_mfma_f32_16x16x32_bf16 v[64:67], a[200:203], a[68:71], v[64:67]
    v_exp_f32 v252, v252
    v_mfma_f32_16x16x32_bf16 v[64:67], a[196:199], a[52:55], v[64:67]
    v_exp_f32 v253, v253
    v_mfma_f32_16x16x32_bf16 v[64:67], a[192:195], a[36:39], v[64:67]
    v_exp_f32 v254, v254
    v_mfma_f32_16x16x32_bf16 v[64:67], a[188:191], a[20:23], v[64:67]
    v_exp_f32 v255, v255
    v_mfma_f32_16x16x32_bf16 v[64:67], a[184:187], a[4:7], v[64:67]
    v_exp_f32 v40, v40
    v_mfma_f32_16x16x32_bf16 v[72:75], a[184:187], a[8:11], 0
    v_exp_f32 v41, v41
    v_mfma_f32_16x16x32_bf16 v[72:75], a[188:191], a[24:27], v[72:75]
    v_exp_f32 v42, v42
    v_mfma_f32_16x16x32_bf16 v[72:75], a[192:195], a[40:43], v[72:75]
    v_exp_f32 v43, v43
    v_mfma_f32_16x16x32_bf16 v[72:75], a[196:199], a[56:59], v[72:75]
    v_cvt_pk_bf16_f32 v245, v246, v247
    v_cvt_pk_bf16_f32 v252, v252, v253
    v_mfma_f32_16x16x32_bf16 v[72:75], a[200:203], a[72:75], v[72:75]
    v_exp_f32 v44, v44
    v_mfma_f32_16x16x32_bf16 v[72:75], a[204:207], a[88:91], v[72:75]
    v_exp_f32 v45, v45
    v_mfma_f32_16x16x32_bf16 v[80:83], a[204:207], a[92:95], 0
    ds_read_b64_tr_b16 a[232:233], v8 offset:40960
    v_cvt_pk_bf16_f32 v253, v254, v255
    v_mfma_f32_16x16x32_bf16 v[80:83], a[200:203], a[76:79], v[80:83]
    ds_read_b64_tr_b16 a[234:235], v8 offset:43008
    v_cvt_pk_bf16_f32 v230, v40, v41
    v_mfma_f32_16x16x32_bf16 v[80:83], a[196:199], a[60:63], v[80:83]
    ds_read_b64_tr_b16 a[236:237], v9 offset:40960
    v_cvt_pk_bf16_f32 v231, v42, v43
    v_mfma_f32_16x16x32_bf16 v[80:83], a[192:195], a[44:47], v[80:83]
    ds_read_b64_tr_b16 a[238:239], v9 offset:43008
    v_cvt_pk_bf16_f32 v238, v44, v45
    v_mfma_f32_16x16x32_bf16 v[80:83], a[188:191], a[28:31], v[80:83]
    s_waitcnt lgkmcnt(4)
    v_exp_f32 v46, v46
    v_mfma_f32_16x16x32_bf16 v[80:83], a[184:187], a[12:15], v[80:83]
    v_exp_f32 v47, v47
    v_mfma_f32_16x16x32_bf16 v[24:27], a[208:211], a[0:3], 0
    v_exp_f32 v48, v48
    v_mfma_f32_16x16x32_bf16 v[24:27], a[212:215], a[16:19], v[24:27]
    v_exp_f32 v49, v49
    v_mfma_f32_16x16x32_bf16 v[24:27], a[216:219], a[32:35], v[24:27]
    ds_read_b128 a[184:187], v12 offset:12288
    v_cvt_pk_bf16_f32 v239, v46, v47
    v_mfma_f32_16x16x32_bf16 v[24:27], a[220:223], a[48:51], v[24:27]
    ds_read_b128 a[188:191], v13 offset:12288
    v_cvt_pk_bf16_f32 v246, v48, v49
    v_mfma_f32_16x16x32_bf16 v[24:27], a[224:227], a[64:67], v[24:27]
    v_exp_f32 v50, v50
    v_mfma_f32_16x16x32_bf16 v[24:27], a[228:231], a[80:83], v[24:27]
    v_exp_f32 v51, v51
    v_mfma_f32_16x16x32_bf16 v[28:31], a[228:231], a[84:87], 0
    ds_read_b128 a[192:195], v12 offset:13312
    v_cvt_pk_bf16_f32 v247, v50, v51
    v_mfma_f32_16x16x32_bf16 v[28:31], a[224:227], a[68:71], v[28:31]
    v_exp_f32 v52, v52
    v_mfma_f32_16x16x32_bf16 v[28:31], a[220:223], a[52:55], v[28:31]
    v_exp_f32 v53, v53
    v_mfma_f32_16x16x32_bf16 v[28:31], a[216:219], a[36:39], v[28:31]
    ds_read_b128 a[196:199], v13 offset:13312
    v_cvt_pk_bf16_f32 v254, v52, v53
    v_mfma_f32_16x16x32_bf16 v[28:31], a[212:215], a[20:23], v[28:31]
    v_exp_f32 v54, v54
    v_mfma_f32_16x16x32_bf16 v[28:31], a[208:211], a[4:7], v[28:31]
    v_exp_f32 v55, v55
    v_mfma_f32_16x16x32_bf16 v[32:35], a[208:211], a[8:11], 0
    ds_read_b128 a[200:203], v12 offset:14336
    v_cvt_pk_bf16_f32 v255, v54, v55
    v_mfma_f32_16x16x32_bf16 v[32:35], a[212:215], a[24:27], v[32:35]
    v_exp_f32 v56, v56
    v_mfma_f32_16x16x32_bf16 v[32:35], a[216:219], a[40:43], v[32:35]
    v_exp_f32 v57, v57
    v_mfma_f32_16x16x32_bf16 v[32:35], a[220:223], a[56:59], v[32:35]
    ds_read_b128 a[204:207], v13 offset:14336
    v_cvt_pk_bf16_f32 v56, v56, v57
    v_mfma_f32_16x16x32_bf16 v[32:35], a[224:227], a[72:75], v[32:35]
    v_exp_f32 v58, v58
    v_mfma_f32_16x16x32_bf16 v[32:35], a[228:231], a[88:91], v[32:35]
    v_exp_f32 v59, v59
    v_mfma_f32_16x16x32_bf16 v[36:39], a[228:231], a[92:95], 0
    v_exp_f32 v64, v64
    v_mfma_f32_16x16x32_bf16 v[36:39], a[224:227], a[76:79], v[36:39]
    v_exp_f32 v65, v65
    v_mfma_f32_16x16x32_bf16 v[36:39], a[220:223], a[60:63], v[36:39]
    v_exp_f32 v66, v66
    v_mfma_f32_16x16x32_bf16 v[36:39], a[216:219], a[44:47], v[36:39]
    s_waitcnt lgkmcnt(1)
    v_exp_f32 v67, v67
    v_mfma_f32_16x16x32_bf16 v[36:39], a[212:215], a[28:31], v[36:39]
    v_exp_f32 v72, v72
    v_mfma_f32_16x16x32_bf16 v[36:39], a[208:211], a[12:15], v[36:39]
    v_exp_f32 v73, v73
    v_mfma_f32_16x16x32_bf16 a[152:155], a[232:235], v[224:227], a[152:155]
    v_exp_f32 v74, v74
    v_mfma_f32_16x16x32_bf16 a[168:171], a[236:239], v[224:227], a[168:171]
    v_exp_f32 v75, v75
    v_mfma_f32_16x16x32_bf16 a[172:175], a[236:239], v[232:235], a[172:175]
    ds_read_b128 a[208:211], v12 offset:18432
    v_cvt_pk_bf16_f32 v57, v58, v59
    v_mfma_f32_16x16x32_bf16 a[156:159], a[232:235], v[232:235], a[156:159]
    ds_read_b128 a[212:215], v13 offset:18432
    v_cvt_pk_bf16_f32 v64, v64, v65
    v_mfma_f32_16x16x32_bf16 a[160:163], a[232:235], v[240:243], a[160:163]
    ds_read_b128 a[216:219], v12 offset:19456
    v_cvt_pk_bf16_f32 v65, v66, v67
    v_mfma_f32_16x16x32_bf16 a[176:179], a[236:239], v[240:243], a[176:179]
    ds_read_b128 a[220:223], v13 offset:19456
    v_cvt_pk_bf16_f32 v72, v72, v73
    v_mfma_f32_16x16x32_bf16 a[180:183], a[236:239], v[248:251], a[180:183]
    ds_read_b128 a[224:227], v12 offset:20480
    v_cvt_pk_bf16_f32 v73, v74, v75
    v_mfma_f32_16x16x32_bf16 a[164:167], a[232:235], v[248:251], a[164:167]
    v_exp_f32 v80, v80
    v_mfma_f32_16x16x32_bf16 v[60:63], a[184:187], a[0:3], 0
    v_exp_f32 v81, v81
    v_mfma_f32_16x16x32_bf16 v[60:63], a[188:191], a[16:19], v[60:63]
    ds_read_b128 a[228:231], v13 offset:20480
    v_cvt_pk_bf16_f32 v80, v80, v81
    v_mfma_f32_16x16x32_bf16 v[60:63], a[192:195], a[32:35], v[60:63]
    s_waitcnt lgkmcnt(4)
    v_exp_f32 v82, v82
    v_mfma_f32_16x16x32_bf16 v[60:63], a[196:199], a[48:51], v[60:63]
    v_exp_f32 v83, v83
    v_mfma_f32_16x16x32_bf16 v[60:63], a[200:203], a[64:67], v[60:63]
    v_exp_f32 v24, v24
    v_mfma_f32_16x16x32_bf16 v[60:63], a[204:207], a[80:83], v[60:63]
    v_exp_f32 v25, v25
    v_mfma_f32_16x16x32_bf16 v[68:71], a[204:207], a[84:87], 0
    v_exp_f32 v26, v26
    v_mfma_f32_16x16x32_bf16 v[68:71], a[200:203], a[68:71], v[68:71]
    v_exp_f32 v27, v27
    v_mfma_f32_16x16x32_bf16 v[68:71], a[196:199], a[52:55], v[68:71]
    v_exp_f32 v28, v28
    v_mfma_f32_16x16x32_bf16 v[68:71], a[192:195], a[36:39], v[68:71]
    v_exp_f32 v29, v29
    v_mfma_f32_16x16x32_bf16 v[68:71], a[188:191], a[20:23], v[68:71]
    v_cvt_pk_bf16_f32 v81, v82, v83
    v_cvt_pk_bf16_f32 v58, v24, v25
    v_mfma_f32_16x16x32_bf16 v[68:71], a[184:187], a[4:7], v[68:71]
    v_exp_f32 v30, v30
    v_mfma_f32_16x16x32_bf16 v[76:79], a[184:187], a[8:11], 0
    v_exp_f32 v31, v31
    v_mfma_f32_16x16x32_bf16 v[76:79], a[188:191], a[24:27], v[76:79]
    v_exp_f32 v32, v32
    v_mfma_f32_16x16x32_bf16 v[76:79], a[192:195], a[40:43], v[76:79]
    v_exp_f32 v33, v33
    v_mfma_f32_16x16x32_bf16 v[76:79], a[196:199], a[56:59], v[76:79]
    v_cvt_pk_bf16_f32 v59, v26, v27
    v_cvt_pk_bf16_f32 v66, v28, v29
    v_mfma_f32_16x16x32_bf16 v[76:79], a[200:203], a[72:75], v[76:79]
    v_exp_f32 v34, v34
    v_mfma_f32_16x16x32_bf16 v[76:79], a[204:207], a[88:91], v[76:79]
    v_exp_f32 v35, v35
    v_mfma_f32_16x16x32_bf16 v[84:87], a[204:207], a[92:95], 0
    s_add_u32 s39, s40, 49280
    v_exp_f32 v36, v36
    v_mfma_f32_16x16x32_bf16 v[84:87], a[200:203], a[76:79], v[84:87]
    v_exp_f32 v37, v37
    v_mfma_f32_16x16x32_bf16 v[84:87], a[196:199], a[60:63], v[84:87]
    s_add_u32 m0, s63, 0
    v_cvt_pk_bf16_f32 v67, v30, v31
    v_cvt_pk_bf16_f32 v74, v32, v33
    v_mfma_f32_16x16x32_bf16 v[84:87], a[192:195], a[44:47], v[84:87]
    v_exp_f32 v38, v38
    v_mfma_f32_16x16x32_bf16 v[84:87], a[188:191], a[28:31], v[84:87]
    v_exp_f32 v39, v39
    v_mfma_f32_16x16x32_bf16 v[84:87], a[184:187], a[12:15], v[84:87]
    s_waitcnt lgkmcnt(0)
    v_exp_f32 v60, v60
    v_mfma_f32_16x16x32_bf16 v[40:43], a[208:211], a[0:3], 0
    s_waitcnt vmcnt(7)
    v_exp_f32 v61, v61
    v_mfma_f32_16x16x32_bf16 v[40:43], a[212:215], a[16:19], v[40:43]
    s_barrier
    v_mfma_f32_16x16x32_bf16 v[40:43], a[216:219], a[32:35], v[40:43]
    buffer_load_dwordx4 v6, s[16:19], s39 offen lds
    v_mfma_f32_16x16x32_bf16 v[40:43], a[220:223], a[48:51], v[40:43]
    ds_read_b64_tr_b16 a[240:241], v8 offset:45056
    v_cvt_pk_bf16_f32 v75, v34, v35
    v_mfma_f32_16x16x32_bf16 v[40:43], a[224:227], a[64:67], v[40:43]
    ds_read_b64_tr_b16 a[242:243], v8 offset:47104
    v_cvt_pk_bf16_f32 v82, v36, v37
    v_mfma_f32_16x16x32_bf16 v[40:43], a[228:231], a[80:83], v[40:43]
    ds_read_b64_tr_b16 a[244:245], v9 offset:45056
    v_cvt_pk_bf16_f32 v83, v38, v39
    v_mfma_f32_16x16x32_bf16 v[44:47], a[228:231], a[84:87], 0
    s_add_u32 s39, s40, 61568
    ds_read_b64_tr_b16 a[246:247], v9 offset:47104
    v_cvt_pk_bf16_f32 v60, v60, v61
    v_mfma_f32_16x16x32_bf16 v[44:47], a[224:227], a[68:71], v[44:47]
    v_exp_f32 v62, v62
    v_mfma_f32_16x16x32_bf16 v[44:47], a[220:223], a[52:55], v[44:47]
    s_addk_i32 m0, 4096
    v_exp_f32 v63, v63
    v_mfma_f32_16x16x32_bf16 v[44:47], a[216:219], a[36:39], v[44:47]
    ds_read_b128 a[184:187], v12 offset:24576
    v_cvt_pk_bf16_f32 v61, v62, v63
    v_mfma_f32_16x16x32_bf16 v[44:47], a[212:215], a[20:23], v[44:47]
    v_exp_f32 v68, v68
    v_mfma_f32_16x16x32_bf16 v[44:47], a[208:211], a[4:7], v[44:47]
    v_exp_f32 v69, v69
    v_mfma_f32_16x16x32_bf16 v[48:51], a[208:211], a[8:11], 0
    s_mov_b32 s28, s82
    ds_read_b128 a[188:191], v13 offset:24576
    v_cvt_pk_bf16_f32 v68, v68, v69
    v_mfma_f32_16x16x32_bf16 v[48:51], a[212:215], a[24:27], v[48:51]
    s_and_b32 s29, s83, 0xffff
    ds_read_b128 a[192:195], v12 offset:25600
    v_and_b32 v22, 15, v1
    v_mfma_f32_16x16x32_bf16 v[48:51], a[216:219], a[40:43], v[48:51]
    buffer_load_dwordx4 v6, s[16:19], s39 offen lds
    v_mfma_f32_16x16x32_bf16 v[48:51], a[220:223], a[56:59], v[48:51]
    s_mov_b32 s30, 1966080
    ds_read_b128 a[196:199], v13 offset:25600
    v_mul_u32_u24 v22, 1280, v22
    v_mfma_f32_16x16x32_bf16 v[48:51], a[224:227], a[72:75], v[48:51]
    s_mov_b32 s31, 0x00020000
    v_exp_f32 v70, v70
    v_mfma_f32_16x16x32_bf16 v[48:51], a[228:231], a[88:91], v[48:51]
    s_mul_hi_u32 s48, s58, 429496730
    v_exp_f32 v71, v71
    v_mfma_f32_16x16x32_bf16 v[52:55], a[228:231], a[92:95], 0
    s_add_u32 s39, s40, 73856
    ds_read_b128 a[200:203], v12 offset:26624
    v_cvt_pk_bf16_f32 v69, v70, v71
    v_mfma_f32_16x16x32_bf16 v[52:55], a[224:227], a[76:79], v[52:55]
    s_mul_i32 s42, s48, 80640
    v_exp_f32 v76, v76
    v_mfma_f32_16x16x32_bf16 v[52:55], a[220:223], a[60:63], v[52:55]
    s_addk_i32 m0, 4096
    v_exp_f32 v77, v77
    v_mfma_f32_16x16x32_bf16 v[52:55], a[216:219], a[44:47], v[52:55]
    s_waitcnt lgkmcnt(2)
    ds_read_b128 a[204:207], v13 offset:26624
    v_cvt_pk_bf16_f32 v76, v76, v77
    v_mfma_f32_16x16x32_bf16 v[52:55], a[212:215], a[28:31], v[52:55]
    s_lshl_b32 s56, s58, 7
    v_exp_f32 v78, v78
    v_mfma_f32_16x16x32_bf16 v[52:55], a[208:211], a[12:15], v[52:55]
    s_add_u32 s42, s42, s56
    v_exp_f32 v79, v79
    v_mfma_f32_16x16x32_bf16 a[164:167], a[240:243], v[252:255], a[164:167]
    s_mul_i32 s56, s3, 20480
    v_exp_f32 v84, v84
    v_mfma_f32_16x16x32_bf16 a[180:183], a[244:247], v[252:255], a[180:183]
    s_add_u32 s42, s42, s56
    v_exp_f32 v85, v85
    v_mfma_f32_16x16x32_bf16 a[176:179], a[244:247], v[244:247], a[176:179]
    buffer_load_dword a252, v22, s[28:31], s42 offen
    v_mfma_f32_16x16x32_bf16 a[160:163], a[240:243], v[244:247], a[160:163]
    buffer_load_dwordx4 v6, s[16:19], s39 offen lds
    v_mfma_f32_16x16x32_bf16 a[156:159], a[240:243], v[236:239], a[156:159]
    s_add_u32 s56, s7, 1
    ds_read_b128 a[208:211], v12 offset:30720
    v_cvt_pk_bf16_f32 v77, v78, v79
    v_mfma_f32_16x16x32_bf16 a[172:175], a[244:247], v[236:239], a[172:175]
    ds_read_b128 a[212:215], v13 offset:30720
    v_cvt_pk_bf16_f32 v84, v84, v85
    v_mfma_f32_16x16x32_bf16 a[168:171], a[244:247], v[228:231], a[168:171]
    s_add_u32 s39, s40, 86144
    ds_read_b128 a[216:219], v12 offset:31744
    v_mov_b32 v4, s56
    v_mfma_f32_16x16x32_bf16 a[152:155], a[240:243], v[228:231], a[152:155]
    s_add_u32 s56, s7, 2
    v_exp_f32 v86, v86
    v_mfma_f32_16x16x32_bf16 v[88:91], a[184:187], a[0:3], 0
    s_waitcnt lgkmcnt(3)
    v_exp_f32 v87, v87
    v_mfma_f32_16x16x32_bf16 v[88:91], a[188:191], a[16:19], v[88:91]
    s_addk_i32 m0, 4096
    ds_read_b128 a[220:223], v13 offset:31744
    v_cvt_pk_bf16_f32 v85, v86, v87
    v_mfma_f32_16x16x32_bf16 v[88:91], a[192:195], a[32:35], v[88:91]
    v_exp_f32 v40, v40
    v_mfma_f32_16x16x32_bf16 v[88:91], a[196:199], a[48:51], v[88:91]
    v_exp_f32 v41, v41
    v_mfma_f32_16x16x32_bf16 v[88:91], a[200:203], a[64:67], v[88:91]
    ds_read_b128 a[224:227], v12 offset:32768
    v_cvt_pk_bf16_f32 v62, v40, v41
    v_mfma_f32_16x16x32_bf16 v[88:91], a[204:207], a[80:83], v[88:91]
    v_exp_f32 v42, v42
    v_mfma_f32_16x16x32_bf16 v[96:99], a[204:207], a[84:87], 0
    buffer_load_dwordx4 v6, s[16:19], s39 offen lds
    v_mfma_f32_16x16x32_bf16 v[96:99], a[200:203], a[68:71], v[96:99]
    v_exp_f32 v43, v43
    v_mfma_f32_16x16x32_bf16 v[96:99], a[196:199], a[52:55], v[96:99]
    ds_read_b128 a[228:231], v13 offset:32768
    v_cvt_pk_bf16_f32 v63, v42, v43
    v_mfma_f32_16x16x32_bf16 v[96:99], a[192:195], a[36:39], v[96:99]
    v_exp_f32 v44, v44
    v_mfma_f32_16x16x32_bf16 v[96:99], a[188:191], a[20:23], v[96:99]
    s_add_u32 s39, s40, 98432
    v_exp_f32 v45, v45
    v_mfma_f32_16x16x32_bf16 v[96:99], a[184:187], a[4:7], v[96:99]
    v_exp_f32 v46, v46
    v_mfma_f32_16x16x32_bf16 v[104:107], a[184:187], a[8:11], 0
    s_addk_i32 m0, 4096
    v_exp_f32 v47, v47
    v_mfma_f32_16x16x32_bf16 v[104:107], a[188:191], a[24:27], v[104:107]
    v_exp_f32 v48, v48
    v_mfma_f32_16x16x32_bf16 v[104:107], a[192:195], a[40:43], v[104:107]
    v_exp_f32 v49, v49
    v_mfma_f32_16x16x32_bf16 v[104:107], a[196:199], a[56:59], v[104:107]
    v_exp_f32 v50, v50
    v_mfma_f32_16x16x32_bf16 v[104:107], a[200:203], a[72:75], v[104:107]
    v_exp_f32 v51, v51
    v_mfma_f32_16x16x32_bf16 v[104:107], a[204:207], a[88:91], v[104:107]
    v_cvt_pk_bf16_f32 v70, v44, v45
    v_cvt_pk_bf16_f32 v71, v46, v47
    v_mfma_f32_16x16x32_bf16 v[112:115], a[204:207], a[92:95], 0
    buffer_load_dwordx4 v6, s[16:19], s39 offen lds
    v_mfma_f32_16x16x32_bf16 v[112:115], a[200:203], a[76:79], v[112:115]
    ds_read_b64_tr_b16 a[232:233], v8 offset:49152
    v_cvt_pk_bf16_f32 v78, v48, v49
    v_mfma_f32_16x16x32_bf16 v[112:115], a[196:199], a[60:63], v[112:115]
    ds_read_b64_tr_b16 a[234:235], v8 offset:51200
    v_cvt_pk_bf16_f32 v79, v50, v51
    v_mfma_f32_16x16x32_bf16 v[112:115], a[192:195], a[44:47], v[112:115]
    s_waitcnt lgkmcnt(2)
    v_exp_f32 v52, v52
    v_mfma_f32_16x16x32_bf16 v[112:115], a[188:191], a[28:31], v[112:115]
pg_8:
    s_cbranch_execz pg_12
    s_add_u32 s39, s40, 110720
    v_exp_f32 v53, v53
    v_mfma_f32_16x16x32_bf16 v[112:115], a[184:187], a[12:15], v[112:115]
    ds_read_b64_tr_b16 a[236:237], v9 offset:49152
    v_cvt_pk_bf16_f32 v86, v52, v53
    v_mfma_f32_16x16x32_bf16 v[24:27], a[208:211], a[0:3], 0
    s_addk_i32 m0, 4096
    v_exp_f32 v54, v54
    v_mfma_f32_16x16x32_bf16 v[24:27], a[212:215], a[16:19], v[24:27]
    v_exp_f32 v55, v55
    v_mfma_f32_16x16x32_bf16 v[24:27], a[216:219], a[32:35], v[24:27]
    ds_read_b64_tr_b16 a[238:239], v9 offset:51200
    v_cvt_pk_bf16_f32 v87, v54, v55
    v_mfma_f32_16x16x32_bf16 v[24:27], a[220:223], a[48:51], v[24:27]
    v_exp_f32 v88, v88
    v_mfma_f32_16x16x32_bf16 v[24:27], a[224:227], a[64:67], v[24:27]
    v_exp_f32 v89, v89
    v_mfma_f32_16x16x32_bf16 v[24:27], a[228:231], a[80:83], v[24:27]
    ds_read_b128 a[184:187], v12 offset:36864
    v_cvt_pk_bf16_f32 v88, v88, v89
    v_mfma_f32_16x16x32_bf16 v[28:31], a[228:231], a[84:87], 0
    buffer_load_dwordx4 v6, s[16:19], s39 offen lds
    v_mfma_f32_16x16x32_bf16 v[28:31], a[224:227], a[68:71], v[28:31]
    v_exp_f32 v90, v90
    v_mfma_f32_16x16x32_bf16 v[28:31], a[220:223], a[52:55], v[28:31]
    v_exp_f32 v91, v91
    v_mfma_f32_16x16x32_bf16 v[28:31], a[216:219], a[36:39], v[28:31]
    ds_read_b128 a[188:191], v13 offset:36864
    v_cvt_pk_bf16_f32 v89, v90, v91
    v_mfma_f32_16x16x32_bf16 v[28:31], a[212:215], a[20:23], v[28:31]
    v_exp_f32 v96, v96
    v_mfma_f32_16x16x32_bf16 v[28:31], a[208:211], a[4:7], v[28:31]
    v_exp_f32 v97, v97
    v_mfma_f32_16x16x32_bf16 v[32:35], a[208:211], a[8:11], 0
    ds_read_b128 a[192:195], v12 offset:37888
    v_cvt_pk_bf16_f32 v96, v96, v97
    v_mfma_f32_16x16x32_bf16 v[32:35], a[212:215], a[24:27], v[32:35]
    v_exp_f32 v98, v98
    v_mfma_f32_16x16x32_bf16 v[32:35], a[216:219], a[40:43], v[32:35]
    v_exp_f32 v99, v99
    v_mfma_f32_16x16x32_bf16 v[32:35], a[220:223], a[56:59], v[32:35]
    ds_read_b128 a[196:199], v13 offset:37888
    v_cvt_pk_bf16_f32 v97, v98, v99
    v_mfma_f32_16x16x32_bf16 v[32:35], a[224:227], a[72:75], v[32:35]
    v_exp_f32 v104, v104
    v_mfma_f32_16x16x32_bf16 v[32:35], a[228:231], a[88:91], v[32:35]
    v_exp_f32 v105, v105
    v_mfma_f32_16x16x32_bf16 v[36:39], a[228:231], a[92:95], 0
    ds_read_b128 a[200:203], v12 offset:38912
    v_cvt_pk_bf16_f32 v104, v104, v105
    v_mfma_f32_16x16x32_bf16 v[36:39], a[224:227], a[76:79], v[36:39]
    v_exp_f32 v106, v106
    v_mfma_f32_16x16x32_bf16 v[36:39], a[220:223], a[60:63], v[36:39]
    v_exp_f32 v107, v107
    v_mfma_f32_16x16x32_bf16 v[36:39], a[216:219], a[44:47], v[36:39]
    s_waitcnt lgkmcnt(2)
    ds_read_b128 a[204:207], v13 offset:38912
    v_cvt_pk_bf16_f32 v105, v106, v107
    v_mfma_f32_16x16x32_bf16 v[36:39], a[212:215], a[28:31], v[36:39]
    v_exp_f32 v112, v112
    v_mfma_f32_16x16x32_bf16 v[36:39], a[208:211], a[12:15], v[36:39]
    v_exp_f32 v113, v113
    v_mfma_f32_16x16x32_bf16 a[152:155], a[232:235], v[56:59], a[152:155]
    v_exp_f32 v114, v114
    v_mfma_f32_16x16x32_bf16 a[168:171], a[236:239], v[56:59], a[168:171]
    v_exp_f32 v115, v115
    v_mfma_f32_16x16x32_bf16 a[172:175], a[236:239], v[64:67], a[172:175]
    ds_read_b128 a[208:211], v12 offset:43008
    v_cvt_pk_bf16_f32 v112, v112, v113
    v_mfma_f32_16x16x32_bf16 a[156:159], a[232:235], v[64:67], a[156:159]
    ds_read_b128 a[212:215], v13 offset:43008
    v_cvt_pk_bf16_f32 v113, v114, v115
    v_mfma_f32_16x16x32_bf16 a[160:163], a[232:235], v[72:75], a[160:163]
    v_exp_f32 v24, v24
    v_mfma_f32_16x16x32_bf16 a[176:179], a[236:239], v[72:75], a[176:179]
    v_exp_f32 v25, v25
    v_mfma_f32_16x16x32_bf16 a[180:183], a[236:239], v[80:83], a[180:183]
    ds_read_b128 a[216:219], v12 offset:44032
    v_cvt_pk_bf16_f32 v90, v24, v25
    v_mfma_f32_16x16x32_bf16 a[164:167], a[232:235], v[80:83], a[164:167]
    ds_read_b128 a[220:223], v13 offset:44032
    v_mov_b32 v24, 0
    v_mfma_f32_16x16x32_bf16 v[92:95], a[184:187], a[0:3], 0
    s_waitcnt lgkmcnt(4)
    ds_read_b128 a[224:227], v12 offset:45056
    v_mov_b32 v25, 0
    v_mfma_f32_16x16x32_bf16 v[92:95], a[188:191], a[16:19], v[92:95]
    v_exp_f32 v26, v26
    v_mfma_f32_16x16x32_bf16 v[92:95], a[192:195], a[32:35], v[92:95]
    v_exp_f32 v27, v27
    v_mfma_f32_16x16x32_bf16 v[92:95], a[196:199], a[48:51], v[92:95]
    ds_read_b128 a[228:231], v13 offset:45056
    v_cvt_pk_bf16_f32 v91, v26, v27
    v_mfma_f32_16x16x32_bf16 v[92:95], a[200:203], a[64:67], v[92:95]
    v_exp_f32 v28, v28
    v_mfma_f32_16x16x32_bf16 v[92:95], a[204:207], a[80:83], v[92:95]
    v_exp_f32 v29, v29
    v_mfma_f32_16x16x32_bf16 v[100:103], a[204:207], a[84:87], 0
    v_exp_f32 v30, v30
    v_mfma_f32_16x16x32_bf16 v[100:103], a[200:203], a[68:71], v[100:103]
    v_exp_f32 v31, v31
    v_mfma_f32_16x16x32_bf16 v[100:103], a[196:199], a[52:55], v[100:103]
    v_exp_f32 v32, v32
    v_mfma_f32_16x16x32_bf16 v[100:103], a[192:195], a[36:39], v[100:103]
    v_exp_f32 v33, v33
    v_mfma_f32_16x16x32_bf16 v[100:103], a[188:191], a[20:23], v[100:103]
    v_exp_f32 v34, v34
    v_mfma_f32_16x16x32_bf16 v[100:103], a[184:187], a[4:7], v[100:103]
    v_exp_f32 v35, v35
    v_mfma_f32_16x16x32_bf16 v[108:111], a[184:187], a[8:11], 0
    v_cvt_pk_bf16_f32 v98, v28, v29
    v_cvt_pk_bf16_f32 v99, v30, v31
    v_mfma_f32_16x16x32_bf16 v[108:111], a[188:191], a[24:27], v[108:111]
    v_exp_f32 v36, v36
    v_mfma_f32_16x16x32_bf16 v[108:111], a[192:195], a[40:43], v[108:111]
    v_exp_f32 v37, v37
    v_mfma_f32_16x16x32_bf16 v[108:111], a[196:199], a[56:59], v[108:111]
    v_exp_f32 v38, v38
    v_mfma_f32_16x16x32_bf16 v[108:111], a[200:203], a[72:75], v[108:111]
    v_exp_f32 v39, v39
    v_mfma_f32_16x16x32_bf16 v[108:111], a[204:207], a[88:91], v[108:111]
    v_cvt_pk_bf16_f32 v106, v32, v33
    v_cvt_pk_bf16_f32 v107, v34, v35
    v_mfma_f32_16x16x32_bf16 v[116:119], a[204:207], a[92:95], 0
    s_add_u32 s39, s40, 123008
    v_cvt_pk_bf16_f32 v114, v36, v37
    v_cvt_pk_bf16_f32 v115, v38, v39
    v_mfma_f32_16x16x32_bf16 v[116:119], a[200:203], a[76:79], v[116:119]
    v_exp_f32 v92, v92
    v_mfma_f32_16x16x32_bf16 v[116:119], a[196:199], a[60:63], v[116:119]
    s_addk_i32 m0, 4096
    v_exp_f32 v93, v93
    v_mfma_f32_16x16x32_bf16 v[116:119], a[192:195], a[44:47], v[116:119]
    s_waitcnt lgkmcnt(0)
    v_exp_f32 v94, v94
    v_mfma_f32_16x16x32_bf16 v[116:119], a[188:191], a[28:31], v[116:119]
    v_exp_f32 v95, v95
    v_mfma_f32_16x16x32_bf16 v[116:119], a[184:187], a[12:15], v[116:119]
    v_exp_f32 v100, v100
    v_mfma_f32_16x16x32_bf16 v[40:43], a[208:211], a[0:3], 0
    s_waitcnt vmcnt(12)
    v_exp_f32 v101, v101
    v_mfma_f32_16x16x32_bf16 v[40:43], a[212:215], a[16:19], v[40:43]
    s_barrier
    v_mfma_f32_16x16x32_bf16 v[40:43], a[216:219], a[32:35], v[40:43]
    buffer_load_dwordx4 v6, s[16:19], s39 offen lds
    v_mfma_f32_16x16x32_bf16 v[40:43], a[220:223], a[48:51], v[40:43]
    s_add_u32 s39, s40, 135296
    ds_read_b64_tr_b16 a[240:241], v8 offset:53248
    v_cvt_pk_bf16_f32 v92, v92, v93
    v_mfma_f32_16x16x32_bf16 v[40:43], a[224:227], a[64:67], v[40:43]
    s_addk_i32 m0, 4096
    ds_read_b64_tr_b16 a[242:243], v8 offset:55296
    v_cvt_pk_bf16_f32 v93, v94, v95
    v_mfma_f32_16x16x32_bf16 v[40:43], a[228:231], a[80:83], v[40:43]
    ds_read_b64_tr_b16 a[244:245], v9 offset:53248
    v_cvt_pk_bf16_f32 v100, v100, v101
    v_mfma_f32_16x16x32_bf16 v[44:47], a[228:231], a[84:87], 0
    ds_read_b64_tr_b16 a[246:247], v9 offset:55296
    v_mov_b32 v28, 0
    v_mfma_f32_16x16x32_bf16 v[44:47], a[224:227], a[68:71], v[44:47]
    v_exp_f32 v102, v102
    v_mfma_f32_16x16x32_bf16 v[44:47], a[220:223], a[52:55], v[44:47]
    v_exp_f32 v103, v103
    v_mfma_f32_16x16x32_bf16 v[44:47], a[216:219], a[36:39], v[44:47]
    v_exp_f32 v108, v108
    v_mfma_f32_16x16x32_bf16 v[44:47], a[212:215], a[20:23], v[44:47]
    buffer_load_dwordx4 v6, s[16:19], s39 offen lds
    v_mfma_f32_16x16x32_bf16 v[44:47], a[208:211], a[4:7], v[44:47]
    s_add_u32 s39, s40, 147584
    v_exp_f32 v109, v109
    v_mfma_f32_16x16x32_bf16 v[48:51], a[208:211], a[8:11], 0
    s_addk_i32 m0, 4096
    v_exp_f32 v110, v110
    v_mfma_f32_16x16x32_bf16 v[48:51], a[212:215], a[24:27], v[48:51]
    v_exp_f32 v111, v111
    v_mfma_f32_16x16x32_bf16 v[48:51], a[216:219], a[40:43], v[48:51]
    v_cvt_pk_bf16_f32 v101, v102, v103
    v_cvt_pk_bf16_f32 v108, v108, v109
    v_mfma_f32_16x16x32_bf16 v[48:51], a[220:223], a[56:59], v[48:51]
    v_exp_f32 v116, v116
    v_mfma_f32_16x16x32_bf16 v[48:51], a[224:227], a[72:75], v[48:51]
    v_exp_f32 v117, v117
    v_mfma_f32_16x16x32_bf16 v[48:51], a[228:231], a[88:91], v[48:51]
    v_exp_f32 v118, v118
    v_mfma_f32_16x16x32_bf16 v[52:55], a[228:231], a[92:95], 0
    buffer_load_dwordx4 v6, s[16:19], s39 offen lds
    v_mfma_f32_16x16x32_bf16 v[52:55], a[224:227], a[76:79], v[52:55]
    s_add_u32 s39, s40, 159872
    v_exp_f32 v119, v119
    v_mfma_f32_16x16x32_bf16 v[52:55], a[220:223], a[60:63], v[52:55]
    s_addk_i32 m0, 4096
    v_cvt_pk_bf16_f32 v109, v110, v111
    v_cvt_pk_bf16_f32 v116, v116, v117
    v_mfma_f32_16x16x32_bf16 v[52:55], a[216:219], a[44:47], v[52:55]
    s_waitcnt lgkmcnt(0)
    v_exp_f32 v40, v40
    v_mfma_f32_16x16x32_bf16 v[52:55], a[212:215], a[28:31], v[52:55]
    v_exp_f32 v41, v41
    v_mfma_f32_16x16x32_bf16 v[52:55], a[208:211], a[12:15], v[52:55]
    v_exp_f32 v42, v42
    v_mfma_f32_16x16x32_bf16 a[164:167], a[240:243], v[84:87], a[164:167]
    v_exp_f32 v43, v43
    v_mfma_f32_16x16x32_bf16 a[180:183], a[244:247], v[84:87], a[180:183]
    v_cvt_pk_bf16_f32 v117, v118, v119
    v_cvt_pk_bf16_f32 v94, v40, v41
    v_mfma_f32_16x16x32_bf16 a[176:179], a[244:247], v[76:79], a[176:179]
    buffer_load_dwordx4 v6, s[16:19], s39 offen lds
    v_mfma_f32_16x16x32_bf16 a[160:163], a[240:243], v[76:79], a[160:163]
    s_add_u32 s39, s40, 172160
    v_exp_f32 v44, v44
    v_mfma_f32_16x16x32_bf16 a[156:159], a[240:243], v[68:71], a[156:159]
    s_addk_i32 m0, 4096
    v_exp_f32 v45, v45
    v_mfma_f32_16x16x32_bf16 a[172:175], a[244:247], v[68:71], a[172:175]
    v_exp_f32 v46, v46
    v_mfma_f32_16x16x32_bf16 a[168:171], a[244:247], v[60:63], a[168:171]
    v_exp_f32 v47, v47
    v_mfma_f32_16x16x32_bf16 a[152:155], a[240:243], v[60:63], a[152:155]
    v_cvt_pk_bf16_f32 v95, v42, v43
    v_cvt_pk_bf16_f32 v102, v44, v45
    v_smfmac_f32_16x16x64_bf16 v[24:27], a[248:251], a[96:103], v20
    v_cvt_pk_bf16_f32 v103, v46, v47
    v_mov_b32 v29, 0
    s_nop 1
    v_smfmac_f32_16x16x64_bf16 v[28:31], a[248:251], a[104:111], v20
    v_mov_b32 v32, 0
    v_mov_b32 v33, 0
    s_nop 1
    v_smfmac_f32_16x16x64_bf16 v[32:35], a[248:251], a[112:119], v20
    buffer_load_dwordx4 v6, s[16:19], s39 offen lds
    v_mov_b32 v36, 0
    v_mov_b32 v37, 0
    s_nop 1
    v_smfmac_f32_16x16x64_bf16 v[36:39], a[248:251], a[120:127], v20
    s_add_u32 s39, s40, 184448
    ds_read_b64_tr_b16 a[232:233], v8 offset:57344
    v_smfmac_f32_16x16x64_bf16 v[24:27], a[248:251], a[128:135], v20
    s_addk_i32 m0, 4096
    ds_read_b64_tr_b16 a[234:235], v8 offset:59392
    v_smfmac_f32_16x16x64_bf16 v[28:31], a[248:251], a[136:143], v20
    ds_read_b64_tr_b16 a[236:237], v9 offset:57344
    v_smfmac_f32_16x16x64_bf16 v[32:35], a[248:251], a[144:151], v20
    ds_read_b64_tr_b16 a[238:239], v9 offset:59392
    v_smfmac_f32_16x16x64_bf16 v[36:39], a[248:251], v[120:127], v20
    v_smfmac_f32_16x16x64_bf16 v[24:27], a[248:251], v[128:135], v20
    v_smfmac_f32_16x16x64_bf16 v[28:31], a[248:251], v[136:143], v20
    v_smfmac_f32_16x16x64_bf16 v[32:35], a[248:251], v[144:151], v20
    buffer_load_dwordx4 v6, s[16:19], s39 offen lds
    v_smfmac_f32_16x16x64_bf16 v[36:39], a[248:251], v[152:159], v20
    s_add_u32 s38, s44, 0
    ds_read_b64_tr_b16 a[240:241], v8 offset:61440
    s_add_u32 s36, s44, 40960
    v_smfmac_f32_16x16x64_bf16 v[24:27], a[248:251], v[160:167], v20
    s_cmp_lt_u32 s3, 2
    s_cselect_b32 s38, s38, s36
    s_add_u32 m0, s63, 155648
    v_smfmac_f32_16x16x64_bf16 v[28:31], a[248:251], v[168:175], v20
    ds_read_b64_tr_b16 a[242:243], v8 offset:63488
    v_smfmac_f32_16x16x64_bf16 v[32:35], a[248:251], v[176:183], v20
    ds_read_b64_tr_b16 a[244:245], v9 offset:61440
    v_smfmac_f32_16x16x64_bf16 v[36:39], a[248:251], v[184:191], v20
    ds_read_b64_tr_b16 a[246:247], v9 offset:63488
    v_smfmac_f32_16x16x64_bf16 v[24:27], a[248:251], v[192:199], v20
    v_smfmac_f32_16x16x64_bf16 v[28:31], a[248:251], v[200:207], v20
    v_smfmac_f32_16x16x64_bf16 v[32:35], a[248:251], v[208:215], v20
    buffer_load_dwordx4 v7, s[8:11], s38 offen lds
    v_smfmac_f32_16x16x64_bf16 v[36:39], a[248:251], v[216:223], v20
    s_add_u32 s38, s44, 0
    ds_read_b64_tr_b16 a[184:185], v10 offset:0
    v_smfmac_f32_16x16x64_bf16 v[24:27], a[248:251], v[224:231], v20
    s_addk_i32 m0, -16384
    ds_read_b64_tr_b16 a[186:187], v10 offset:2048
    v_smfmac_f32_16x16x64_bf16 v[28:31], a[248:251], v[232:239], v20
    ds_read_b64_tr_b16 a[188:189], v10 offset:4096
    v_smfmac_f32_16x16x64_bf16 v[32:35], a[248:251], v[240:247], v20
    s_waitcnt lgkmcnt(3)
    ds_read_b64_tr_b16 a[190:191], v10 offset:6144
    v_smfmac_f32_16x16x64_bf16 v[36:39], a[248:251], v[248:255], v20
    v_smfmac_f32_16x16x64_bf16 v[24:27], a[248:251], v[56:63], v20
    v_smfmac_f32_16x16x64_bf16 v[28:31], a[248:251], v[64:71], v20
    v_smfmac_f32_16x16x64_bf16 v[32:35], a[248:251], v[72:79], v20
    buffer_load_dwordx4 v2, s[8:11], s38 offen lds
    v_smfmac_f32_16x16x64_bf16 v[36:39], a[248:251], v[80:87], v20
    s_add_u32 s38, s44, 0
    ds_read_b64_tr_b16 a[192:193], v10 offset:8192
    v_smfmac_f32_16x16x64_bf16 v[24:27], a[248:251], v[88:95], v20
    s_addk_i32 m0, 4096
    ds_read_b64_tr_b16 a[194:195], v10 offset:10240
    v_smfmac_f32_16x16x64_bf16 v[28:31], a[248:251], v[96:103], v20
    ds_read_b64_tr_b16 a[196:197], v10 offset:12288
    v_exp_f32 v48, v48
    v_exp_f32 v49, v49
    v_exp_f32 v50, v50
    v_exp_f32 v51, v51
    v_cvt_pk_bf16_f32 v110, v48, v49
    v_cvt_pk_bf16_f32 v111, v50, v51
    s_nop 1
    v_smfmac_f32_16x16x64_bf16 v[32:35], a[248:251], v[104:111], v20
    ds_read_b64_tr_b16 a[198:199], v10 offset:14336
    v_add_f32 v24, v24, v25
    v_exp_f32 v52, v52
    v_exp_f32 v53, v53
    v_exp_f32 v54, v54
    v_exp_f32 v55, v55
    v_cvt_pk_bf16_f32 v118, v52, v53
    v_cvt_pk_bf16_f32 v119, v54, v55
    s_nop 1
    v_smfmac_f32_16x16x64_bf16 v[36:39], a[248:251], v[112:119], v20
    v_add_f32 v28, v28, v29
    v_mfma_f32_16x16x32_bf16 a[152:155], a[232:235], v[88:91], a[152:155]
    v_rcp_f32 v16, v24
    v_mfma_f32_16x16x32_bf16 a[168:171], a[236:239], v[88:91], a[168:171]
    v_rcp_f32 v17, v28
    v_mfma_f32_16x16x32_bf16 a[172:175], a[236:239], v[96:99], a[172:175]
    buffer_load_dwordx4 v3, s[8:11], s38 offen lds
    v_mfma_f32_16x16x32_bf16 a[156:159], a[232:235], v[96:99], a[156:159]
    s_add_u32 s38, s44, 40960
    ds_read_b64_tr_b16 a[200:201], v10 offset:16384
    v_add_f32 v32, v32, v33
    v_mfma_f32_16x16x32_bf16 a[160:163], a[232:235], v[104:107], a[160:163]
    s_addk_i32 m0, 4096
    ds_read_b64_tr_b16 a[202:203], v10 offset:18432
    v_add_f32 v36, v36, v37
    v_mfma_f32_16x16x32_bf16 a[176:179], a[236:239], v[104:107], a[176:179]
    ds_read_b64_tr_b16 a[204:205], v10 offset:20480
    v_max3_f32 v21, v24, v28, v32
    v_mfma_f32_16x16x32_bf16 a[180:183], a[236:239], v[112:115], a[180:183]
    s_waitcnt lgkmcnt(3)
    ds_read_b64_tr_b16 a[206:207], v10 offset:22528
    v_max3_f32 v21, v21, v36, v16
    v_mfma_f32_16x16x32_bf16 a[164:167], a[232:235], v[112:115], a[164:167]
    v_rcp_f32 v18, v32
    v_mfma_f32_16x16x32_bf16 a[164:167], a[240:243], v[116:119], a[164:167]
    v_rcp_f32 v19, v36
    v_mfma_f32_16x16x32_bf16 a[180:183], a[244:247], v[116:119], a[180:183]
    v_max3_f32 v21, v21, v17, v18
    v_max_f32 v21, v21, v19
    v_mfma_f32_16x16x32_bf16 a[176:179], a[244:247], v[108:111], a[176:179]
    buffer_load_dwordx4 v2, s[8:11], s38 offen lds
    v_mfma_f32_16x16x32_bf16 a[160:163], a[240:243], v[108:111], a[160:163]
    s_add_u32 s38, s44, 40960
    ds_read_b64_tr_b16 a[208:209], v10 offset:24576
    v_cmp_nge_f32 vcc, 0x5f800000, v21
    v_mfma_f32_16x16x32_bf16 a[156:159], a[240:243], v[100:103], a[156:159]
    s_addk_i32 m0, 4096
    ds_read_b64_tr_b16 a[210:211], v10 offset:26624
    v_mfma_f32_16x16x32_bf16 a[172:175], a[244:247], v[100:103], a[172:175]
    ds_read_b64_tr_b16 a[212:213], v10 offset:28672
    v_mfma_f32_16x16x32_bf16 a[168:171], a[244:247], v[92:95], a[168:171]
    ds_read_b64_tr_b16 a[214:215], v10 offset:30720
    v_mfma_f32_16x16x32_bf16 a[152:155], a[240:243], v[92:95], a[152:155]
    s_cbranch_vccnz rare
rare_ret:
    v_mfma_f32_16x16x32_bf16 v[40:43], a[184:187], a[96:99], 0
    v_subrev_u32 v8, 73728, v8
    v_subrev_u32 v9, 73728, v9
    v_mfma_f32_16x16x32_bf16 v[40:43], a[188:191], a[100:103], v[40:43]
    v_mfma_f32_16x16x32_bf16 v[44:47], a[188:191], a[108:111], 0
    s_barrier
    v_mfma_f32_16x16x32_bf16 v[44:47], a[184:187], a[104:107], v[44:47]
    buffer_load_dwordx4 v3, s[8:11], s38 offen lds
    v_mfma_f32_16x16x32_bf16 v[48:51], a[184:187], a[112:115], 0
    v_accvgpr_read_b32 v21, a152
    v_accvgpr_read_b32 v22, a153
    v_mfma_f32_16x16x32_bf16 v[48:51], a[188:191], a[116:119], v[48:51]
    v_accvgpr_read_b32 v23, a154
    v_accvgpr_read_b32 v5, a155
    v_mfma_f32_16x16x32_bf16 v[52:55], a[188:191], a[124:127], 0
    v_mul_f32 v21, v16, v21
    v_mul_f32 v22, v16, v22
    v_mfma_f32_16x16x32_bf16 v[52:55], a[184:187], a[120:123], v[52:55]
    ds_read_b64_tr_b16 a[184:185], v10 offset:32768
    v_mul_f32 v23, v16, v23
    v_mfma_f32_16x16x32_bf16 v[52:55], a[192:195], v[120:123], v[52:55]
    ds_read_b64_tr_b16 a[186:187], v10 offset:34816
    v_mul_f32 v5, v16, v5
    v_mfma_f32_16x16x32_bf16 v[52:55], a[196:199], v[124:127], v[52:55]
    ds_read_b64_tr_b16 a[188:189], v10 offset:36864
    v_cvt_pk_bf16_f32 v21, v21, v22
    v_mfma_f32_16x16x32_bf16 v[48:51], a[196:199], a[148:151], v[48:51]
    s_waitcnt lgkmcnt(3)
    ds_read_b64_tr_b16 a[190:191], v10 offset:38912
    v_cvt_pk_bf16_f32 v22, v23, v5
    v_mfma_f32_16x16x32_bf16 v[48:51], a[192:195], a[144:147], v[48:51]
    v_accvgpr_write_b32 a0, v21
    v_accvgpr_write_b32 a1, v22
    v_mfma_f32_16x16x32_bf16 v[44:47], a[192:195], a[136:139], v[44:47]
    v_accvgpr_read_b32 v21, a168
    v_accvgpr_read_b32 v22, a169
    v_mfma_f32_16x16x32_bf16 v[44:47], a[196:199], a[140:143], v[44:47]
    v_accvgpr_read_b32 v23, a170
    v_accvgpr_read_b32 v5, a171
    v_mfma_f32_16x16x32_bf16 v[40:43], a[196:199], a[132:135], v[40:43]
    v_mul_f32 v21, v16, v21
    v_mul_f32 v22, v16, v22
    v_mfma_f32_16x16x32_bf16 v[40:43], a[192:195], a[128:131], v[40:43]
    ds_read_b64_tr_b16 a[192:193], v10 offset:40960
    v_mul_f32 v23, v16, v23
    v_mfma_f32_16x16x32_bf16 v[40:43], a[200:203], v[128:131], v[40:43]
    ds_read_b64_tr_b16 a[194:195], v10 offset:43008
    v_mul_f32 v5, v16, v5
    v_mfma_f32_16x16x32_bf16 v[40:43], a[204:207], v[132:135], v[40:43]
    ds_read_b64_tr_b16 a[196:197], v10 offset:45056
    v_cvt_pk_bf16_f32 v21, v21, v22
    v_mfma_f32_16x16x32_bf16 v[44:47], a[204:207], v[140:143], v[44:47]
    ds_read_b64_tr_b16 a[198:199], v10 offset:47104
    v_cvt_pk_bf16_f32 v22, v23, v5
    v_mfma_f32_16x16x32_bf16 v[44:47], a[200:203], v[136:139], v[44:47]
    v_accvgpr_write_b32 a2, v21
    v_accvgpr_write_b32 a3, v22
    v_mfma_f32_16x16x32_bf16 v[48:51], a[200:203], v[144:147], v[48:51]
    buffer_store_dwordx4 a[0:3], v14, s[20:23], s55 offen offset:0 sc1
    v_accvgpr_read_b32 v21, a156
    v_mfma_f32_16x16x32_bf16 v[48:51], a[204:207], v[148:151], v[48:51]
    v_accvgpr_read_b32 v22, a157
    v_accvgpr_read_b32 v23, a158
    v_mfma_f32_16x16x32_bf16 v[52:55], a[204:207], v[156:159], v[52:55]
    v_accvgpr_read_b32 v5, a159
    v_mul_f32 v21, v17, v21
    v_mfma_f32_16x16x32_bf16 v[52:55], a[200:203], v[152:155], v[52:55]
    ds_read_b64_tr_b16 a[200:201], v10 offset:49152
    v_mul_f32 v22, v17, v22
    v_mfma_f32_16x16x32_bf16 v[52:55], a[208:211], v[184:187], v[52:55]
    ds_read_b64_tr_b16 a[202:203], v10 offset:51200
    v_mul_f32 v23, v17, v23
    v_mfma_f32_16x16x32_bf16 v[52:55], a[212:215], v[188:191], v[52:55]
    ds_read_b64_tr_b16 a[204:205], v10 offset:53248
    v_mul_f32 v5, v17, v5
    v_mfma_f32_16x16x32_bf16 v[48:51], a[212:215], v[180:183], v[48:51]
    s_waitcnt lgkmcnt(3)
    ds_read_b64_tr_b16 a[206:207], v10 offset:55296
    v_cvt_pk_bf16_f32 v21, v21, v22
    v_mfma_f32_16x16x32_bf16 v[48:51], a[208:211], v[176:179], v[48:51]
    v_cvt_pk_bf16_f32 v22, v23, v5
    v_accvgpr_write_b32 a4, v21
    v_mfma_f32_16x16x32_bf16 v[44:47], a[208:211], v[168:171], v[44:47]
    v_accvgpr_write_b32 a5, v22
    v_accvgpr_read_b32 v21, a172
    v_mfma_f32_16x16x32_bf16 v[44:47], a[212:215], v[172:175], v[44:47]
    v_accvgpr_read_b32 v22, a173
    v_accvgpr_read_b32 v23, a174
    v_mfma_f32_16x16x32_bf16 v[40:43], a[212:215], v[164:167], v[40:43]
    v_accvgpr_read_b32 v5, a175
    v_mul_f32 v21, v17, v21
    v_mfma_f32_16x16x32_bf16 v[40:43], a[208:211], v[160:163], v[40:43]
    ds_read_b64_tr_b16 a[208:209], v10 offset:57344
    v_mul_f32 v22, v17, v22
    v_mfma_f32_16x16x32_bf16 v[40:43], a[184:187], v[192:195], v[40:43]
    ds_read_b64_tr_b16 a[210:211], v10 offset:59392
    v_mul_f32 v23, v17, v23
    v_mfma_f32_16x16x32_bf16 v[40:43], a[188:191], v[196:199], v[40:43]
    ds_read_b64_tr_b16 a[212:213], v10 offset:61440
    v_mul_f32 v5, v17, v5
    v_mfma_f32_16x16x32_bf16 v[44:47], a[188:191], v[204:207], v[44:47]
    ds_read_b64_tr_b16 a[214:215], v10 offset:63488
    v_cvt_pk_bf16_f32 v21, v21, v22
    v_mfma_f32_16x16x32_bf16 v[44:47], a[184:187], v[200:203], v[44:47]
    v_cvt_pk_bf16_f32 v22, v23, v5
    v_accvgpr_write_b32 a6, v21
    v_mfma_f32_16x16x32_bf16 v[48:51], a[184:187], v[208:211], v[48:51]
    v_accvgpr_write_b32 a7, v22
    v_accvgpr_read_b32 v21, a160
    v_mfma_f32_16x16x32_bf16 v[48:51], a[188:191], v[212:215], v[48:51]
    buffer_store_dwordx4 a[4:7], v14, s[20:23], s55 offen offset:1024 sc1
    v_accvgpr_read_b32 v22, a161
    v_mfma_f32_16x16x32_bf16 v[52:55], a[188:191], v[220:223], v[52:55]
    v_accvgpr_read_b32 v23, a162
    v_accvgpr_read_b32 v5, a163
    v_mfma_f32_16x16x32_bf16 v[52:55], a[184:187], v[216:219], v[52:55]
    ds_read_b64_tr_b16 a[184:185], v11 offset:0
    v_mul_f32 v21, v18, v21
    v_mfma_f32_16x16x32_bf16 v[52:55], a[192:195], v[248:251], v[52:55]
    ds_read_b64_tr_b16 a[186:187], v11 offset:2048
    v_mul_f32 v22, v18, v22
    v_mfma_f32_16x16x32_bf16 v[52:55], a[196:199], v[252:255], v[52:55]
    ds_read_b64_tr_b16 a[188:189], v11 offset:4096
    v_mul_f32 v23, v18, v23
    v_mfma_f32_16x16x32_bf16 v[48:51], a[196:199], v[244:247], v[48:51]
    s_waitcnt lgkmcnt(3)
    ds_read_b64_tr_b16 a[190:191], v11 offset:6144
    v_mul_f32 v5, v18, v5
    v_mfma_f32_16x16x32_bf16 v[48:51], a[192:195], v[240:243], v[48:51]
    v_cvt_pk_bf16_f32 v21, v21, v22
    v_cvt_pk_bf16_f32 v22, v23, v5
    v_mfma_f32_16x16x32_bf16 v[44:47], a[192:195], v[232:235], v[44:47]
    v_accvgpr_write_b32 a8, v21
    v_accvgpr_write_b32 a9, v22
    v_mfma_f32_16x16x32_bf16 v[44:47], a[196:199], v[236:239], v[44:47]
    v_accvgpr_read_b32 v21, a176
    v_accvgpr_read_b32 v22, a177
    v_mfma_f32_16x16x32_bf16 v[40:43], a[196:199], v[228:231], v[40:43]
    v_accvgpr_read_b32 v23, a178
    v_accvgpr_read_b32 v5, a179
    v_mfma_f32_16x16x32_bf16 v[40:43], a[192:195], v[224:227], v[40:43]
    ds_read_b64_tr_b16 a[192:193], v11 offset:8192
    v_mul_f32 v21, v18, v21
    v_mfma_f32_16x16x32_bf16 v[40:43], a[200:203], v[56:59], v[40:43]
    ds_read_b64_tr_b16 a[194:195], v11 offset:10240
    v_mul_f32 v22, v18, v22
    v_mfma_f32_16x16x32_bf16 v[40:43], a[204:207], v[60:63], v[40:43]
    ds_read_b64_tr_b16 a[196:197], v11 offset:12288
    v_mul_f32 v23, v18, v23
    v_mfma_f32_16x16x32_bf16 v[44:47], a[204:207], v[68:71], v[44:47]
    ds_read_b64_tr_b16 a[198:199], v11 offset:14336
    v_mul_f32 v5, v18, v5
    v_mfma_f32_16x16x32_bf16 v[44:47], a[200:203], v[64:67], v[44:47]
    v_cvt_pk_bf16_f32 v21, v21, v22
    v_cvt_pk_bf16_f32 v22, v23, v5
    v_mfma_f32_16x16x32_bf16 v[48:51], a[200:203], v[72:75], v[48:51]
    v_accvgpr_write_b32 a10, v21
    v_accvgpr_write_b32 a11, v22
    v_mfma_f32_16x16x32_bf16 v[48:51], a[204:207], v[76:79], v[48:51]
    buffer_store_dwordx4 a[8:11], v14, s[20:23], s55 offen offset:2048 sc1
    v_accvgpr_read_b32 v21, a164
    v_mfma_f32_16x16x32_bf16 v[52:55], a[204:207], v[84:87], v[52:55]
    v_accvgpr_read_b32 v22, a165
    v_accvgpr_read_b32 v23, a166
    v_mfma_f32_16x16x32_bf16 v[52:55], a[200:203], v[80:83], v[52:55]
    ds_read_b64_tr_b16 a[200:201], v11 offset:16384
    v_accvgpr_read_b32 v5, a167
    v_mfma_f32_16x16x32_bf16 v[52:55], a[208:211], v[112:115], v[52:55]
    ds_read_b64_tr_b16 a[202:203], v11 offset:18432
    v_mul_f32 v21, v19, v21
    v_mfma_f32_16x16x32_bf16 v[52:55], a[212:215], v[116:119], v[52:55]
    ds_read_b64_tr_b16 a[204:205], v11 offset:20480
    v_mul_f32 v22, v19, v22
    v_mfma_f32_16x16x32_bf16 v[48:51], a[212:215], v[108:111], v[48:51]
    s_waitcnt lgkmcnt(3)
    ds_read_b64_tr_b16 a[206:207], v11 offset:22528
    v_mul_f32 v23, v19, v23
    v_mfma_f32_16x16x32_bf16 v[48:51], a[208:211], v[104:107], v[48:51]
    v_mul_f32 v5, v19, v5
    v_cvt_pk_bf16_f32 v21, v21, v22
    v_mfma_f32_16x16x32_bf16 v[44:47], a[208:211], v[96:99], v[44:47]
    v_cvt_pk_bf16_f32 v22, v23, v5
    v_accvgpr_write_b32 a12, v21
    v_mfma_f32_16x16x32_bf16 v[44:47], a[212:215], v[100:103], v[44:47]
    v_accvgpr_write_b32 a13, v22
    v_accvgpr_read_b32 v21, a180
    v_mfma_f32_16x16x32_bf16 v[40:43], a[212:215], v[92:95], v[40:43]
    v_accvgpr_read_b32 v22, a181
    v_accvgpr_read_b32 v23, a182
    v_mfma_f32_16x16x32_bf16 v[40:43], a[208:211], v[88:91], v[40:43]
    ds_read_b64_tr_b16 a[208:209], v11 offset:24576
    v_accvgpr_read_b32 v5, a183
    v_mfma_f32_16x16x32_bf16 v[24:27], a[184:187], a[96:99], 0
    ds_read_b64_tr_b16 a[210:211], v11 offset:26624
    v_mul_f32 v21, v19, v21
    v_mfma_f32_16x16x32_bf16 v[24:27], a[188:191], a[100:103], v[24:27]
    ds_read_b64_tr_b16 a[212:213], v11 offset:28672
    v_mul_f32 v22, v19, v22
    v_mfma_f32_16x16x32_bf16 v[28:31], a[188:191], a[108:111], 0
    ds_read_b64_tr_b16 a[214:215], v11 offset:30720
    v_mul_f32 v23, v19, v23
    v_mfma_f32_16x16x32_bf16 v[28:31], a[184:187], a[104:107], v[28:31]
    v_mul_f32 v5, v19, v5
    v_cvt_pk_bf16_f32 v21, v21, v22
    v_mfma_f32_16x16x32_bf16 v[32:35], a[184:187], a[112:115], 0
    v_cvt_pk_bf16_f32 v22, v23, v5
    v_accvgpr_write_b32 a14, v21
    v_mfma_f32_16x16x32_bf16 v[32:35], a[188:191], a[116:119], v[32:35]
    v_accvgpr_write_b32 a15, v22
    v_mul_f32 v40, v16, v40
    v_mfma_f32_16x16x32_bf16 v[36:39], a[188:191], a[124:127], 0
    buffer_store_dwordx4 a[12:15], v14, s[20:23], s55 offen offset:3072 sc1
    v_mul_f32 v41, v16, v41
    v_mfma_f32_16x16x32_bf16 v[36:39], a[184:187], a[120:123], v[36:39]
    s_add_u32 s55, s55, 4096
    ds_read_b64_tr_b16 a[184:185], v11 offset:32768
    v_mul_f32 v42, v16, v42
    v_mfma_f32_16x16x32_bf16 v[36:39], a[192:195], v[120:123], v[36:39]
    ds_read_b64_tr_b16 a[186:187], v11 offset:34816
    v_mul_f32 v43, v16, v43
    v_mfma_f32_16x16x32_bf16 v[36:39], a[196:199], v[124:127], v[36:39]
    ds_read_b64_tr_b16 a[188:189], v11 offset:36864
    v_cvt_pk_bf16_f32 v40, v40, v41
    v_mfma_f32_16x16x32_bf16 v[32:35], a[196:199], a[148:151], v[32:35]
    s_waitcnt lgkmcnt(3)
    ds_read_b64_tr_b16 a[190:191], v11 offset:38912
    v_cvt_pk_bf16_f32 v41, v42, v43
    v_mfma_f32_16x16x32_bf16 v[32:35], a[192:195], a[144:147], v[32:35]
    v_accvgpr_write_b32 a16, v40
    v_accvgpr_write_b32 a17, v41
    v_mfma_f32_16x16x32_bf16 v[28:31], a[192:195], a[136:139], v[28:31]
    v_mul_f32 v44, v17, v44
    v_mul_f32 v45, v17, v45
    v_mfma_f32_16x16x32_bf16 v[28:31], a[196:199], a[140:143], v[28:31]
    v_mul_f32 v46, v17, v46
    v_mul_f32 v47, v17, v47
    v_mfma_f32_16x16x32_bf16 v[24:27], a[196:199], a[132:135], v[24:27]
    v_cvt_pk_bf16_f32 v44, v44, v45
    v_cvt_pk_bf16_f32 v45, v46, v47
    v_mfma_f32_16x16x32_bf16 v[24:27], a[192:195], a[128:131], v[24:27]
pg_9:
    s_cbranch_execz pg_13
    ds_read_b64_tr_b16 a[192:193], v11 offset:40960
    v_accvgpr_write_b32 a20, v44
    v_mfma_f32_16x16x32_bf16 v[24:27], a[200:203], v[128:131], v[24:27]
    ds_read_b64_tr_b16 a[194:195], v11 offset:43008
    v_accvgpr_write_b32 a21, v45
    v_mfma_f32_16x16x32_bf16 v[24:27], a[204:207], v[132:135], v[24:27]
    ds_read_b64_tr_b16 a[196:197], v11 offset:45056
    v_mul_f32 v48, v18, v48
    v_mfma_f32_16x16x32_bf16 v[28:31], a[204:207], v[140:143], v[28:31]
    ds_read_b64_tr_b16 a[198:199], v11 offset:47104
    v_mul_f32 v49, v18, v49
    v_mfma_f32_16x16x32_bf16 v[28:31], a[200:203], v[136:139], v[28:31]
    v_mul_f32 v50, v18, v50
    v_mul_f32 v51, v18, v51
    v_mfma_f32_16x16x32_bf16 v[32:35], a[200:203], v[144:147], v[32:35]
    v_cvt_pk_bf16_f32 v48, v48, v49
    v_cvt_pk_bf16_f32 v49, v50, v51
    v_mfma_f32_16x16x32_bf16 v[32:35], a[204:207], v[148:151], v[32:35]
    v_accvgpr_write_b32 a24, v48
    v_accvgpr_write_b32 a25, v49
    v_mfma_f32_16x16x32_bf16 v[36:39], a[204:207], v[156:159], v[36:39]
    v_mul_f32 v52, v19, v52
    v_mul_f32 v53, v19, v53
    v_mfma_f32_16x16x32_bf16 v[36:39], a[200:203], v[152:155], v[36:39]
    ds_read_b64_tr_b16 a[200:201], v11 offset:49152
    v_mul_f32 v54, v19, v54
    v_mfma_f32_16x16x32_bf16 v[36:39], a[208:211], v[184:187], v[36:39]
    ds_read_b64_tr_b16 a[202:203], v11 offset:51200
    v_mul_f32 v55, v19, v55
    v_mfma_f32_16x16x32_bf16 v[36:39], a[212:215], v[188:191], v[36:39]
    ds_read_b64_tr_b16 a[204:205], v11 offset:53248
    v_cvt_pk_bf16_f32 v52, v52, v53
    v_mfma_f32_16x16x32_bf16 v[32:35], a[212:215], v[180:183], v[32:35]
    s_waitcnt lgkmcnt(3)
    ds_read_b64_tr_b16 a[206:207], v11 offset:55296
    v_cvt_pk_bf16_f32 v53, v54, v55
    v_mfma_f32_16x16x32_bf16 v[32:35], a[208:211], v[176:179], v[32:35]
    v_accvgpr_write_b32 a28, v52
    v_accvgpr_write_b32 a29, v53
    v_mfma_f32_16x16x32_bf16 v[28:31], a[208:211], v[168:171], v[28:31]
    v_subrev_u32 v10, 73728, v10
    v_mfma_f32_16x16x32_bf16 v[28:31], a[212:215], v[172:175], v[28:31]
    v_mfma_f32_16x16x32_bf16 v[24:27], a[212:215], v[164:167], v[24:27]
    v_mfma_f32_16x16x32_bf16 v[24:27], a[208:211], v[160:163], v[24:27]
    ds_read_b64_tr_b16 a[208:209], v11 offset:57344
    v_mfma_f32_16x16x32_bf16 v[24:27], a[184:187], v[192:195], v[24:27]
    ds_read_b64_tr_b16 a[210:211], v11 offset:59392
    v_mfma_f32_16x16x32_bf16 v[24:27], a[188:191], v[196:199], v[24:27]
    ds_read_b64_tr_b16 a[212:213], v11 offset:61440
    v_mfma_f32_16x16x32_bf16 v[28:31], a[188:191], v[204:207], v[28:31]
    ds_read_b64_tr_b16 a[214:215], v11 offset:63488
    v_mfma_f32_16x16x32_bf16 v[28:31], a[184:187], v[200:203], v[28:31]
    s_add_u32 s39, s40, 256
    v_subrev_u32 v11, 73728, v11
    v_mfma_f32_16x16x32_bf16 v[32:35], a[184:187], v[208:211], v[32:35]
    v_mfma_f32_16x16x32_bf16 v[32:35], a[188:191], v[212:215], v[32:35]
    s_add_u32 m0, s63, 73728
    v_mfma_f32_16x16x32_bf16 v[36:39], a[188:191], v[220:223], v[36:39]
    v_mfma_f32_16x16x32_bf16 v[36:39], a[184:187], v[216:219], v[36:39]
    v_mfma_f32_16x16x32_bf16 v[36:39], a[192:195], v[248:251], v[36:39]
    v_mfma_f32_16x16x32_bf16 v[36:39], a[196:199], v[252:255], v[36:39]
    s_waitcnt vmcnt(17) lgkmcnt(0)
    v_mfma_f32_16x16x32_bf16 v[32:35], a[196:199], v[244:247], v[32:35]
    s_barrier
    v_mfma_f32_16x16x32_bf16 v[32:35], a[192:195], v[240:243], v[32:35]
    buffer_load_dwordx4 v6, s[16:19], s39 offen lds
    v_mfma_f32_16x16x32_bf16 v[28:31], a[192:195], v[232:235], v[28:31]
    s_add_u32 s39, s40, 12544
    ds_read_b64_tr_b16 a[184:185], v8 offset:49152
    v_mfma_f32_16x16x32_bf16 v[28:31], a[196:199], v[236:239], v[28:31]
    ds_read_b64_tr_b16 a[186:187], v8 offset:51200
    v_mfma_f32_16x16x32_bf16 v[24:27], a[196:199], v[228:231], v[24:27]
    s_addk_i32 m0, 4096
    ds_read_b64_tr_b16 a[188:189], v8 offset:53248
    v_mfma_f32_16x16x32_bf16 v[24:27], a[192:195], v[224:227], v[24:27]
    ds_read_b64_tr_b16 a[190:191], v8 offset:55296
    v_mfma_f32_16x16x32_bf16 v[24:27], a[200:203], v[56:59], v[24:27]
    ds_read_b64_tr_b16 a[192:193], v8 offset:57344
    v_mfma_f32_16x16x32_bf16 v[24:27], a[204:207], v[60:63], v[24:27]
    ds_read_b64_tr_b16 a[194:195], v8 offset:59392
    v_mfma_f32_16x16x32_bf16 v[28:31], a[204:207], v[68:71], v[28:31]
    ds_read_b64_tr_b16 a[196:197], v8 offset:61440
    v_mfma_f32_16x16x32_bf16 v[28:31], a[200:203], v[64:67], v[28:31]
    ds_read_b64_tr_b16 a[198:199], v8 offset:63488
    v_mfma_f32_16x16x32_bf16 v[32:35], a[200:203], v[72:75], v[32:35]
    buffer_load_dwordx4 v6, s[16:19], s39 offen lds
    v_mfma_f32_16x16x32_bf16 v[32:35], a[204:207], v[76:79], v[32:35]
    s_add_u32 s39, s40, 24832
    v_mfma_f32_16x16x32_bf16 v[36:39], a[204:207], v[84:87], v[36:39]
    v_mfma_f32_16x16x32_bf16 v[36:39], a[200:203], v[80:83], v[36:39]
    s_addk_i32 m0, 4096
    ds_read_b64_tr_b16 a[200:201], v8 offset:0
    v_mfma_f32_16x16x32_bf16 v[36:39], a[208:211], v[112:115], v[36:39]
    ds_read_b64_tr_b16 a[202:203], v8 offset:2048
    v_mfma_f32_16x16x32_bf16 v[36:39], a[212:215], v[116:119], v[36:39]
    ds_read_b64_tr_b16 a[204:205], v8 offset:4096
    v_mfma_f32_16x16x32_bf16 v[32:35], a[212:215], v[108:111], v[32:35]
    s_waitcnt lgkmcnt(3)
    ds_read_b64_tr_b16 a[206:207], v8 offset:6144
    v_mfma_f32_16x16x32_bf16 v[32:35], a[208:211], v[104:107], v[32:35]
    v_mfma_f32_16x16x32_bf16 v[28:31], a[208:211], v[96:99], v[28:31]
    v_mfma_f32_16x16x32_bf16 v[28:31], a[212:215], v[100:103], v[28:31]
    buffer_load_dwordx4 v6, s[16:19], s39 offen lds
    v_mfma_f32_16x16x32_bf16 v[24:27], a[212:215], v[92:95], v[24:27]
    s_add_u32 s39, s40, 37120
    v_mul_f32 v36, v19, v36
    v_mfma_f32_16x16x32_bf16 v[24:27], a[208:211], v[88:91], v[24:27]
    ds_read_b64_tr_b16 a[208:209], v8 offset:8192
    v_mul_f32 v32, v18, v32
    v_mfma_f32_16x16x32_bf16 v[40:43], a[184:187], a[96:99], 0
    s_addk_i32 m0, 4096
    ds_read_b64_tr_b16 a[210:211], v8 offset:10240
    v_mul_f32 v28, v17, v28
    v_mfma_f32_16x16x32_bf16 v[40:43], a[188:191], a[100:103], v[40:43]
    ds_read_b64_tr_b16 a[212:213], v8 offset:12288
    v_mul_f32 v24, v16, v24
    v_mfma_f32_16x16x32_bf16 v[44:47], a[188:191], a[108:111], 0
    s_waitcnt vmcnt(3)
    ds_read_b64_tr_b16 a[214:215], v8 offset:14336
    v_mul_f32 v25, v16, v25
    v_mfma_f32_16x16x32_bf16 v[44:47], a[184:187], a[104:107], v[44:47]
    buffer_store_dword v4, v15, s[24:27], s76 offen sc1
    v_mfma_f32_16x16x32_bf16 v[48:51], a[184:187], a[112:115], 0
    v_mov_b32 v4, s56
    v_mul_f32 v26, v16, v26
    v_mfma_f32_16x16x32_bf16 v[48:51], a[188:191], a[116:119], v[48:51]
    s_add_u32 s56, s7, 3
    v_mul_f32 v27, v16, v27
    v_cvt_pk_bf16_f32 v24, v24, v25
    v_mfma_f32_16x16x32_bf16 v[52:55], a[188:191], a[124:127], 0
    buffer_load_dwordx4 v6, s[16:19], s39 offen lds
    v_mfma_f32_16x16x32_bf16 v[52:55], a[184:187], a[120:123], v[52:55]
    s_add_u32 s39, s40, 49408
    v_cvt_pk_bf16_f32 v25, v26, v27
    v_accvgpr_write_b32 a18, v24
    v_mfma_f32_16x16x32_bf16 v[52:55], a[192:195], v[120:123], v[52:55]
    v_accvgpr_write_b32 a19, v25
    v_mul_f32 v29, v17, v29
    v_mfma_f32_16x16x32_bf16 v[52:55], a[196:199], v[124:127], v[52:55]
    buffer_store_dwordx4 a[16:19], v14, s[20:23], s55 offen offset:0 sc1
    v_mul_f32 v30, v17, v30
    v_mfma_f32_16x16x32_bf16 v[48:51], a[196:199], a[148:151], v[48:51]
    s_addk_i32 m0, 4096
    v_mul_f32 v31, v17, v31
    v_cvt_pk_bf16_f32 v28, v28, v29
    v_mfma_f32_16x16x32_bf16 v[48:51], a[192:195], a[144:147], v[48:51]
    v_cvt_pk_bf16_f32 v29, v30, v31
    v_accvgpr_write_b32 a22, v28
    v_mfma_f32_16x16x32_bf16 v[44:47], a[192:195], a[136:139], v[44:47]
    v_accvgpr_write_b32 a23, v29
    v_mfma_f32_16x16x32_bf16 v[44:47], a[196:199], a[140:143], v[44:47]
    buffer_store_dwordx4 a[20:23], v14, s[20:23], s55 offen offset:1024 sc1
    v_mul_f32 v33, v18, v33
    v_mfma_f32_16x16x32_bf16 v[40:43], a[196:199], a[132:135], v[40:43]
    s_waitcnt lgkmcnt(0)
    v_mul_f32 v34, v18, v34
    v_mul_f32 v35, v18, v35
    v_mfma_f32_16x16x32_bf16 v[40:43], a[192:195], a[128:131], v[40:43]
    buffer_load_dwordx4 v6, s[16:19], s39 offen lds
    v_mfma_f32_16x16x32_bf16 v[40:43], a[200:203], v[128:131], v[40:43]
    s_add_u32 s39, s40, 61696
    v_cvt_pk_bf16_f32 v32, v32, v33
    v_cvt_pk_bf16_f32 v33, v34, v35
    v_mfma_f32_16x16x32_bf16 v[40:43], a[204:207], v[132:135], v[40:43]
    v_accvgpr_write_b32 a26, v32
    v_accvgpr_write_b32 a27, v33
    v_mfma_f32_16x16x32_bf16 v[44:47], a[204:207], v[140:143], v[44:47]
    buffer_store_dwordx4 a[24:27], v14, s[20:23], s55 offen offset:2048 sc1
    v_mul_f32 v37, v19, v37
    v_mfma_f32_16x16x32_bf16 v[44:47], a[200:203], v[136:139], v[44:47]
    s_addk_i32 m0, 4096
    v_mul_f32 v38, v19, v38
    v_mfma_f32_16x16x32_bf16 v[48:51], a[200:203], v[144:147], v[48:51]
    s_barrier
    v_mfma_f32_16x16x32_bf16 v[48:51], a[204:207], v[148:151], v[48:51]
    ds_read_b64_tr_b16 a[184:185], v8 offset:16384
    v_mul_f32 v39, v19, v39
    v_mfma_f32_16x16x32_bf16 v[52:55], a[204:207], v[156:159], v[52:55]
    ds_read_b64_tr_b16 a[186:187], v8 offset:18432
    v_cvt_pk_bf16_f32 v36, v36, v37
    v_mfma_f32_16x16x32_bf16 v[52:55], a[200:203], v[152:155], v[52:55]
    ds_read_b64_tr_b16 a[188:189], v8 offset:20480
    v_cvt_pk_bf16_f32 v37, v38, v39
    v_mfma_f32_16x16x32_bf16 v[52:55], a[208:211], v[184:187], v[52:55]
    buffer_load_dwordx4 v6, s[16:19], s39 offen lds
    v_mfma_f32_16x16x32_bf16 v[52:55], a[212:215], v[188:191], v[52:55]
    s_add_u32 s39, s40, 73984
    ds_read_b64_tr_b16 a[190:191], v8 offset:22528
    v_accvgpr_write_b32 a30, v36
    v_mfma_f32_16x16x32_bf16 v[48:51], a[212:215], v[180:183], v[48:51]
    ds_read_b64_tr_b16 a[192:193], v8 offset:24576
    v_accvgpr_write_b32 a31, v37
    v_mfma_f32_16x16x32_bf16 v[48:51], a[208:211], v[176:179], v[48:51]
    buffer_store_dwordx4 a[28:31], v14, s[20:23], s55 offen offset:3072 sc1
    v_mfma_f32_16x16x32_bf16 v[44:47], a[208:211], v[168:171], v[44:47]
    s_addk_i32 m0, 4096
    ds_read_b64_tr_b16 a[194:195], v8 offset:26624
    s_add_u32 s55, s55, 4096
    v_mfma_f32_16x16x32_bf16 v[44:47], a[212:215], v[172:175], v[44:47]
    s_waitcnt lgkmcnt(4)
    ds_read_b64_tr_b16 a[196:197], v8 offset:28672
    v_mfma_f32_16x16x32_bf16 v[40:43], a[212:215], v[164:167], v[40:43]
    ds_read_b64_tr_b16 a[198:199], v8 offset:30720
    v_mfma_f32_16x16x32_bf16 v[40:43], a[208:211], v[160:163], v[40:43]
    ds_read_b64_tr_b16 a[200:201], v8 offset:32768
    v_mfma_f32_16x16x32_bf16 v[40:43], a[184:187], v[192:195], v[40:43]
    s_waitcnt lgkmcnt(5)
    ds_read_b64_tr_b16 a[202:203], v8 offset:34816
    v_mfma_f32_16x16x32_bf16 v[40:43], a[188:191], v[196:199], v[40:43]
    buffer_load_dwordx4 v6, s[16:19], s39 offen lds
    v_mfma_f32_16x16x32_bf16 v[44:47], a[188:191], v[204:207], v[44:47]
    s_add_u32 s39, s40, 86272
    ds_read_b64_tr_b16 a[204:205], v8 offset:36864
    v_mfma_f32_16x16x32_bf16 v[44:47], a[184:187], v[200:203], v[44:47]
    ds_read_b64_tr_b16 a[206:207], v8 offset:38912
    v_mfma_f32_16x16x32_bf16 v[48:51], a[184:187], v[208:211], v[48:51]
    s_addk_i32 m0, 4096
    ds_read_b64_tr_b16 a[208:209], v8 offset:40960
    v_mfma_f32_16x16x32_bf16 v[48:51], a[188:191], v[212:215], v[48:51]
    s_waitcnt lgkmcnt(5)
    ds_read_b64_tr_b16 a[210:211], v8 offset:43008
    v_mfma_f32_16x16x32_bf16 v[52:55], a[188:191], v[220:223], v[52:55]
    ds_read_b64_tr_b16 a[212:213], v8 offset:45056
    v_mfma_f32_16x16x32_bf16 v[52:55], a[184:187], v[216:219], v[52:55]
    ds_read_b64_tr_b16 a[214:215], v8 offset:47104
    v_mfma_f32_16x16x32_bf16 v[52:55], a[192:195], v[248:251], v[52:55]
    ds_read_b64_tr_b16 a[184:185], v9 offset:49152
    v_mfma_f32_16x16x32_bf16 v[52:55], a[196:199], v[252:255], v[52:55]
    ds_read_b64_tr_b16 a[186:187], v9 offset:51200
    v_mfma_f32_16x16x32_bf16 v[48:51], a[196:199], v[244:247], v[48:51]
    buffer_load_dwordx4 v6, s[16:19], s39 offen lds
    v_mfma_f32_16x16x32_bf16 v[48:51], a[192:195], v[240:243], v[48:51]
    s_add_u32 s39, s40, 98560
    ds_read_b64_tr_b16 a[188:189], v9 offset:53248
    v_mfma_f32_16x16x32_bf16 v[44:47], a[192:195], v[232:235], v[44:47]
    s_waitcnt lgkmcnt(5)
    ds_read_b64_tr_b16 a[190:191], v9 offset:55296
    v_mfma_f32_16x16x32_bf16 v[44:47], a[196:199], v[236:239], v[44:47]
    s_addk_i32 m0, 4096
    v_add_u32 v8, 73728, v8
    v_mfma_f32_16x16x32_bf16 v[40:43], a[196:199], v[228:231], v[40:43]
    v_mfma_f32_16x16x32_bf16 v[40:43], a[192:195], v[224:227], v[40:43]
    ds_read_b64_tr_b16 a[192:193], v9 offset:57344
    v_mfma_f32_16x16x32_bf16 v[40:43], a[200:203], v[56:59], v[40:43]
    ds_read_b64_tr_b16 a[194:195], v9 offset:59392
    v_mfma_f32_16x16x32_bf16 v[40:43], a[204:207], v[60:63], v[40:43]
    ds_read_b64_tr_b16 a[196:197], v9 offset:61440
    v_mfma_f32_16x16x32_bf16 v[44:47], a[204:207], v[68:71], v[44:47]
    ds_read_b64_tr_b16 a[198:199], v9 offset:63488
    v_mfma_f32_16x16x32_bf16 v[44:47], a[200:203], v[64:67], v[44:47]
    buffer_load_dwordx4 v6, s[16:19], s39 offen lds
    v_mfma_f32_16x16x32_bf16 v[48:51], a[200:203], v[72:75], v[48:51]
    s_add_u32 s39, s40, 110848
    v_mfma_f32_16x16x32_bf16 v[48:51], a[204:207], v[76:79], v[48:51]
    v_mfma_f32_16x16x32_bf16 v[52:55], a[204:207], v[84:87], v[52:55]
    s_waitcnt lgkmcnt(3)
    s_addk_i32 m0, 4096
    v_mfma_f32_16x16x32_bf16 v[52:55], a[200:203], v[80:83], v[52:55]
    ds_read_b64_tr_b16 a[200:201], v9 offset:0
    v_mfma_f32_16x16x32_bf16 v[52:55], a[208:211], v[112:115], v[52:55]
    ds_read_b64_tr_b16 a[202:203], v9 offset:2048
    v_mfma_f32_16x16x32_bf16 v[52:55], a[212:215], v[116:119], v[52:55]
    ds_read_b64_tr_b16 a[204:205], v9 offset:4096
    v_mfma_f32_16x16x32_bf16 v[48:51], a[212:215], v[108:111], v[48:51]
    ds_read_b64_tr_b16 a[206:207], v9 offset:6144
    v_mfma_f32_16x16x32_bf16 v[48:51], a[208:211], v[104:107], v[48:51]
    v_mfma_f32_16x16x32_bf16 v[44:47], a[208:211], v[96:99], v[44:47]
    buffer_load_dwordx4 v6, s[16:19], s39 offen lds
    v_mfma_f32_16x16x32_bf16 v[44:47], a[212:215], v[100:103], v[44:47]
    s_add_u32 s39, s40, 123136
    v_mul_f32 v52, v19, v52
    v_mfma_f32_16x16x32_bf16 v[40:43], a[212:215], v[92:95], v[40:43]
    v_mul_f32 v53, v19, v53
    v_mfma_f32_16x16x32_bf16 v[40:43], a[208:211], v[88:91], v[40:43]
    s_addk_i32 m0, 4096
    ds_read_b64_tr_b16 a[208:209], v9 offset:8192
    v_mul_f32 v48, v18, v48
    v_mfma_f32_16x16x32_bf16 v[24:27], a[184:187], a[96:99], 0
    ds_read_b64_tr_b16 a[210:211], v9 offset:10240
    v_mul_f32 v44, v17, v44
    v_mfma_f32_16x16x32_bf16 v[24:27], a[188:191], a[100:103], v[24:27]
    ds_read_b64_tr_b16 a[212:213], v9 offset:12288
    v_mul_f32 v40, v16, v40
    v_mfma_f32_16x16x32_bf16 v[28:31], a[188:191], a[108:111], 0
    ds_read_b64_tr_b16 a[214:215], v9 offset:14336
    v_mul_f32 v41, v16, v41
    v_mfma_f32_16x16x32_bf16 v[28:31], a[184:187], a[104:107], v[28:31]
    s_waitcnt lgkmcnt(4)
    v_mul_f32 v42, v16, v42
    v_mul_f32 v43, v16, v43
    v_mfma_f32_16x16x32_bf16 v[32:35], a[184:187], a[112:115], 0
    v_cvt_pk_bf16_f32 v40, v40, v41
    v_cvt_pk_bf16_f32 v41, v42, v43
    v_mfma_f32_16x16x32_bf16 v[32:35], a[188:191], a[116:119], v[32:35]
    buffer_load_dwordx4 v6, s[16:19], s39 offen lds
    v_mfma_f32_16x16x32_bf16 v[36:39], a[188:191], a[124:127], 0
    s_add_u32 s39, s40, 135424
    v_accvgpr_write_b32 a32, v40
    v_accvgpr_write_b32 a33, v41
    v_mfma_f32_16x16x32_bf16 v[36:39], a[184:187], a[120:123], v[36:39]
    ds_read_b64_tr_b16 a[184:185], v9 offset:16384
    v_mul_f32 v45, v17, v45
    v_mfma_f32_16x16x32_bf16 v[36:39], a[192:195], v[120:123], v[36:39]
    s_addk_i32 m0, 4096
    ds_read_b64_tr_b16 a[186:187], v9 offset:18432
    v_mul_f32 v46, v17, v46
    v_mfma_f32_16x16x32_bf16 v[36:39], a[196:199], v[124:127], v[36:39]
    ds_read_b64_tr_b16 a[188:189], v9 offset:20480
    v_mul_f32 v47, v17, v47
    v_mfma_f32_16x16x32_bf16 v[32:35], a[196:199], a[148:151], v[32:35]
    ds_read_b64_tr_b16 a[190:191], v9 offset:22528
    v_cvt_pk_bf16_f32 v44, v44, v45
    v_mfma_f32_16x16x32_bf16 v[32:35], a[192:195], a[144:147], v[32:35]
    v_cvt_pk_bf16_f32 v45, v46, v47
    v_accvgpr_write_b32 a36, v44
    v_mfma_f32_16x16x32_bf16 v[28:31], a[192:195], a[136:139], v[28:31]
    v_accvgpr_write_b32 a37, v45
    v_mfma_f32_16x16x32_bf16 v[28:31], a[196:199], a[140:143], v[28:31]
    v_mul_f32 v49, v18, v49
    v_mfma_f32_16x16x32_bf16 v[24:27], a[196:199], a[132:135], v[24:27]
    buffer_load_dwordx4 v6, s[16:19], s39 offen lds
    v_mfma_f32_16x16x32_bf16 v[24:27], a[192:195], a[128:131], v[24:27]
    s_add_u32 s39, s40, 147712
    ds_read_b64_tr_b16 a[192:193], v9 offset:24576
    v_mul_f32 v50, v18, v50
    v_mfma_f32_16x16x32_bf16 v[24:27], a[200:203], v[128:131], v[24:27]
    ds_read_b64_tr_b16 a[194:195], v9 offset:26624
    v_mul_f32 v51, v18, v51
    v_mfma_f32_16x16x32_bf16 v[24:27], a[204:207], v[132:135], v[24:27]
    s_addk_i32 m0, 4096
    ds_read_b64_tr_b16 a[196:197], v9 offset:28672
    v_cvt_pk_bf16_f32 v48, v48, v49
    v_mfma_f32_16x16x32_bf16 v[28:31], a[204:207], v[140:143], v[28:31]
    s_waitcnt lgkmcnt(3)
    ds_read_b64_tr_b16 a[198:199], v9 offset:30720
    v_cvt_pk_bf16_f32 v49, v50, v51
    v_mfma_f32_16x16x32_bf16 v[28:31], a[200:203], v[136:139], v[28:31]
    v_accvgpr_write_b32 a40, v48
    v_accvgpr_write_b32 a41, v49
    v_mfma_f32_16x16x32_bf16 v[32:35], a[200:203], v[144:147], v[32:35]
    v_mul_f32 v54, v19, v54
    v_mul_f32 v55, v19, v55
    v_mfma_f32_16x16x32_bf16 v[32:35], a[204:207], v[148:151], v[32:35]
    v_cvt_pk_bf16_f32 v52, v52, v53
    v_cvt_pk_bf16_f32 v53, v54, v55
    v_mfma_f32_16x16x32_bf16 v[36:39], a[204:207], v[156:159], v[36:39]
    v_accvgpr_write_b32 a44, v52
    v_accvgpr_write_b32 a45, v53
    v_mfma_f32_16x16x32_bf16 v[36:39], a[200:203], v[152:155], v[36:39]
    buffer_load_dwordx4 v6, s[16:19], s39 offen lds
    v_mfma_f32_16x16x32_bf16 v[36:39], a[208:211], v[184:187], v[36:39]
    s_add_u32 s39, s40, 160000
    ds_read_b64_tr_b16 a[200:201], v9 offset:32768
    v_mfma_f32_16x16x32_bf16 v[36:39], a[212:215], v[188:191], v[36:39]
    s_waitcnt vmcnt(7)
    ds_read_b64_tr_b16 a[202:203], v9 offset:34816
    v_mfma_f32_16x16x32_bf16 v[32:35], a[212:215], v[180:183], v[32:35]
    buffer_store_dword v4, v15, s[24:27], s76 offen sc1
    v_mfma_f32_16x16x32_bf16 v[32:35], a[208:211], v[176:179], v[32:35]
    s_addk_i32 m0, 4096
    ds_read_b64_tr_b16 a[204:205], v9 offset:36864
    v_mfma_f32_16x16x32_bf16 v[28:31], a[208:211], v[168:171], v[28:31]
    ds_read_b64_tr_b16 a[206:207], v9 offset:38912
    v_mfma_f32_16x16x32_bf16 v[28:31], a[212:215], v[172:175], v[28:31]
    v_mov_b32 v4, s56
    v_mfma_f32_16x16x32_bf16 v[24:27], a[212:215], v[164:167], v[24:27]
    s_add_u32 s56, s7, 4
    v_mfma_f32_16x16x32_bf16 v[24:27], a[208:211], v[160:163], v[24:27]
    ds_read_b64_tr_b16 a[208:209], v9 offset:40960
    v_mfma_f32_16x16x32_bf16 v[24:27], a[184:187], v[192:195], v[24:27]
    buffer_load_dwordx4 v6, s[16:19], s39 offen lds
    v_mfma_f32_16x16x32_bf16 v[24:27], a[188:191], v[196:199], v[24:27]
    s_load_dwordx4 s[72:75], s[86:87], s5 glc
    ds_read_b64_tr_b16 a[210:211], v9 offset:43008
    s_add_u32 s39, s40, 172288
    v_mfma_f32_16x16x32_bf16 v[28:31], a[188:191], v[204:207], v[28:31]
    ds_read_b64_tr_b16 a[212:213], v9 offset:45056
    v_mfma_f32_16x16x32_bf16 v[28:31], a[184:187], v[200:203], v[28:31]
    s_waitcnt lgkmcnt(5)
    ds_read_b64_tr_b16 a[214:215], v9 offset:47104
    s_add_u32 m0, s63, 131072
    v_mfma_f32_16x16x32_bf16 v[32:35], a[184:187], v[208:211], v[32:35]
    v_add_u32 v9, 73728, v9
    v_mfma_f32_16x16x32_bf16 v[32:35], a[188:191], v[212:215], v[32:35]
    v_mfma_f32_16x16x32_bf16 v[36:39], a[188:191], v[220:223], v[36:39]
    v_mfma_f32_16x16x32_bf16 v[36:39], a[184:187], v[216:219], v[36:39]
    ds_read_b64_tr_b16 a[184:185], v10 offset:49152
    v_mfma_f32_16x16x32_bf16 v[36:39], a[192:195], v[248:251], v[36:39]
    ds_read_b64_tr_b16 a[186:187], v10 offset:51200
    v_mfma_f32_16x16x32_bf16 v[36:39], a[196:199], v[252:255], v[36:39]
    buffer_load_dwordx4 v6, s[16:19], s39 offen lds
    v_mfma_f32_16x16x32_bf16 v[32:35], a[196:199], v[244:247], v[32:35]
    s_add_u32 s39, s40, 184576
    ds_read_b64_tr_b16 a[188:189], v10 offset:53248
    v_mfma_f32_16x16x32_bf16 v[32:35], a[192:195], v[240:243], v[32:35]
    ds_read_b64_tr_b16 a[190:191], v10 offset:55296
    v_mfma_f32_16x16x32_bf16 v[28:31], a[192:195], v[232:235], v[28:31]
    s_addk_i32 m0, 4096
    v_mfma_f32_16x16x32_bf16 v[28:31], a[196:199], v[236:239], v[28:31]
    v_mfma_f32_16x16x32_bf16 v[24:27], a[196:199], v[228:231], v[24:27]
    s_waitcnt lgkmcnt(5)
    v_mfma_f32_16x16x32_bf16 v[24:27], a[192:195], v[224:227], v[24:27]
    ds_read_b64_tr_b16 a[192:193], v10 offset:57344
    v_mfma_f32_16x16x32_bf16 v[24:27], a[200:203], v[56:59], v[24:27]
    ds_read_b64_tr_b16 a[194:195], v10 offset:59392
    v_mfma_f32_16x16x32_bf16 v[24:27], a[204:207], v[60:63], v[24:27]
    ds_read_b64_tr_b16 a[196:197], v10 offset:61440
    v_mfma_f32_16x16x32_bf16 v[28:31], a[204:207], v[68:71], v[28:31]
    buffer_load_dwordx4 v6, s[16:19], s39 offen lds
    v_mfma_f32_16x16x32_bf16 v[28:31], a[200:203], v[64:67], v[28:31]
    ds_read_b64_tr_b16 a[198:199], v10 offset:63488
    v_mfma_f32_16x16x32_bf16 v[32:35], a[200:203], v[72:75], v[32:35]
    v_mov_b32 v6, s7
    v_mfma_f32_16x16x32_bf16 v[32:35], a[204:207], v[76:79], v[32:35]
    v_mfma_f32_16x16x32_bf16 v[36:39], a[204:207], v[84:87], v[36:39]
    s_waitcnt lgkmcnt(5)
    v_mfma_f32_16x16x32_bf16 v[36:39], a[200:203], v[80:83], v[36:39]
    ds_read_b64_tr_b16 a[200:201], v10 offset:0
    v_mfma_f32_16x16x32_bf16 v[36:39], a[208:211], v[112:115], v[36:39]
    ds_read_b64_tr_b16 a[202:203], v10 offset:2048
    v_mfma_f32_16x16x32_bf16 v[36:39], a[212:215], v[116:119], v[36:39]
    ds_read_b64_tr_b16 a[204:205], v10 offset:4096
    v_mfma_f32_16x16x32_bf16 v[32:35], a[212:215], v[108:111], v[32:35]
    s_add_u32 s77, s7, 1
    ds_read_b64_tr_b16 a[206:207], v10 offset:6144
    v_mfma_f32_16x16x32_bf16 v[32:35], a[208:211], v[104:107], v[32:35]
    v_mfma_f32_16x16x32_bf16 v[28:31], a[208:211], v[96:99], v[28:31]
    v_mfma_f32_16x16x32_bf16 v[28:31], a[212:215], v[100:103], v[28:31]
    v_mfma_f32_16x16x32_bf16 v[24:27], a[212:215], v[92:95], v[24:27]
    s_waitcnt lgkmcnt(5)
    v_mul_f32 v36, v19, v36
    v_mfma_f32_16x16x32_bf16 v[24:27], a[208:211], v[88:91], v[24:27]
    ds_read_b64_tr_b16 a[208:209], v10 offset:8192
    v_mfma_f32_16x16x32_bf16 v[40:43], a[184:187], a[96:99], 0
    s_lshl_b32 s42, s48, 8
    ds_read_b64_tr_b16 a[210:211], v10 offset:10240
    v_lshrrev_b32 v22, 2, v1
    v_mfma_f32_16x16x32_bf16 v[40:43], a[188:191], a[100:103], v[40:43]
    s_add_u32 s42, s42, 3932304
    ds_read_b64_tr_b16 a[212:213], v10 offset:12288
    v_min_u32 v22, 9, v22
    v_mfma_f32_16x16x32_bf16 v[44:47], a[188:191], a[108:111], 0
    ds_read_b64_tr_b16 a[214:215], v10 offset:14336
    v_mul_u32_u24 v22, 6144, v22
    v_mfma_f32_16x16x32_bf16 v[44:47], a[184:187], a[104:107], v[44:47]
    v_and_b32 v23, 3, v1
    v_lshl_add_u32 v22, v23, 2, v22
    v_mfma_f32_16x16x32_bf16 v[48:51], a[184:187], a[112:115], 0
    buffer_load_dword v23, v22, s[24:27], s42 offen sc1
    v_mfma_f32_16x16x32_bf16 v[48:51], a[188:191], a[116:119], v[48:51]
    v_mul_f32 v24, v16, v24
    v_mul_f32 v25, v16, v25
    v_mfma_f32_16x16x32_bf16 v[52:55], a[188:191], a[124:127], 0
    s_waitcnt lgkmcnt(5)
    v_mul_f32 v26, v16, v26
    v_mul_f32 v27, v16, v27
    v_mfma_f32_16x16x32_bf16 v[52:55], a[184:187], a[120:123], v[52:55]
    ds_read_b64_tr_b16 a[184:185], v10 offset:16384
    v_cvt_pk_bf16_f32 v24, v24, v25
    v_mfma_f32_16x16x32_bf16 v[52:55], a[192:195], v[120:123], v[52:55]
    ds_read_b64_tr_b16 a[186:187], v10 offset:18432
    v_cvt_pk_bf16_f32 v25, v26, v27
    v_mfma_f32_16x16x32_bf16 v[52:55], a[196:199], v[124:127], v[52:55]
    ds_read_b64_tr_b16 a[188:189], v10 offset:20480
    v_accvgpr_write_b32 a34, v24
    v_mfma_f32_16x16x32_bf16 v[48:51], a[196:199], a[148:151], v[48:51]
    ds_read_b64_tr_b16 a[190:191], v10 offset:22528
    v_accvgpr_write_b32 a35, v25
    v_mfma_f32_16x16x32_bf16 v[48:51], a[192:195], a[144:147], v[48:51]
    buffer_store_dwordx4 a[32:35], v14, s[20:23], s55 offen offset:0 sc1
    v_mul_f32 v28, v17, v28
    v_mfma_f32_16x16x32_bf16 v[44:47], a[192:195], a[136:139], v[44:47]
    v_mul_f32 v29, v17, v29
    v_mul_f32 v30, v17, v30
    v_mfma_f32_16x16x32_bf16 v[44:47], a[196:199], a[140:143], v[44:47]
    v_mul_f32 v31, v17, v31
    v_cvt_pk_bf16_f32 v28, v28, v29
    v_mfma_f32_16x16x32_bf16 v[40:43], a[196:199], a[132:135], v[40:43]
    s_waitcnt lgkmcnt(5)
    v_cvt_pk_bf16_f32 v29, v30, v31
    v_accvgpr_write_b32 a38, v28
    v_mfma_f32_16x16x32_bf16 v[40:43], a[192:195], a[128:131], v[40:43]
    s_sub_u32 s78, s72, s77
    ds_read_b64_tr_b16 a[192:193], v10 offset:24576
    v_accvgpr_write_b32 a39, v29
    v_mfma_f32_16x16x32_bf16 v[40:43], a[200:203], v[128:131], v[40:43]
    buffer_store_dwordx4 a[36:39], v14, s[20:23], s55 offen offset:1024 sc1
    v_mul_f32 v32, v18, v32
    v_mfma_f32_16x16x32_bf16 v[40:43], a[204:207], v[132:135], v[40:43]
    s_sub_u32 s79, s73, s77
    ds_read_b64_tr_b16 a[194:195], v10 offset:26624
    v_mul_f32 v33, v18, v33
    v_mfma_f32_16x16x32_bf16 v[44:47], a[204:207], v[140:143], v[44:47]
    s_max_u32 s78, s78, s79
    ds_read_b64_tr_b16 a[196:197], v10 offset:28672
    v_mul_f32 v34, v18, v34
    v_mfma_f32_16x16x32_bf16 v[44:47], a[200:203], v[136:139], v[44:47]
    s_sub_u32 s79, s74, s77
    ds_read_b64_tr_b16 a[198:199], v10 offset:30720
    v_mul_f32 v35, v18, v35
    v_mfma_f32_16x16x32_bf16 v[48:51], a[200:203], v[144:147], v[48:51]
    s_max_u32 s78, s78, s79
    v_cvt_pk_bf16_f32 v32, v32, v33
    v_cvt_pk_bf16_f32 v33, v34, v35
    v_mfma_f32_16x16x32_bf16 v[48:51], a[204:207], v[148:151], v[48:51]
    s_sub_u32 s79, s75, s77
    v_accvgpr_write_b32 a42, v32
    v_accvgpr_write_b32 a43, v33
    v_mfma_f32_16x16x32_bf16 v[52:55], a[204:207], v[156:159], v[52:55]
    buffer_store_dwordx4 a[40:43], v14, s[20:23], s55 offen offset:2048 sc1
    v_mul_f32 v37, v19, v37
    v_mfma_f32_16x16x32_bf16 v[52:55], a[200:203], v[152:155], v[52:55]
    s_waitcnt lgkmcnt(3)
    ds_read_b64_tr_b16 a[200:201], v10 offset:32768
    v_mul_f32 v38, v19, v38
    v_mfma_f32_16x16x32_bf16 v[52:55], a[208:211], v[184:187], v[52:55]
    s_max_u32 s78, s78, s79
    ds_read_b64_tr_b16 a[202:203], v10 offset:34816
    v_mul_f32 v39, v19, v39
    v_mfma_f32_16x16x32_bf16 v[52:55], a[212:215], v[188:191], v[52:55]
    s_cmp_gt_u32 s78, 5
    s_cbranch_scc1 spin_o0
spin_o0_ret:
    v_cvt_pk_bf16_f32 v36, v36, v37
    v_mfma_f32_16x16x32_bf16 v[48:51], a[212:215], v[180:183], v[48:51]
    s_add_u32 s37, s59, 0
    ds_read_b64_tr_b16 a[204:205], v10 offset:36864
    v_cvt_pk_bf16_f32 v37, v38, v39
    v_mfma_f32_16x16x32_bf16 v[48:51], a[208:211], v[176:179], v[48:51]
    buffer_load_dwordx4 a[216:219], v14, s[20:23], s37 offen offset:0 sc1
    v_mfma_f32_16x16x32_bf16 v[44:47], a[208:211], v[168:171], v[44:47]
    ds_read_b64_tr_b16 a[206:207], v10 offset:38912
    v_accvgpr_write_b32 a46, v36
    v_mfma_f32_16x16x32_bf16 v[44:47], a[212:215], v[172:175], v[44:47]
    v_accvgpr_write_b32 a47, v37
    v_mfma_f32_16x16x32_bf16 v[40:43], a[212:215], v[164:167], v[40:43]
    buffer_store_dwordx4 a[44:47], v14, s[20:23], s55 offen offset:3072 sc1
    v_mfma_f32_16x16x32_bf16 v[40:43], a[208:211], v[160:163], v[40:43]
    s_add_u32 s55, s55, 4096
    ds_read_b64_tr_b16 a[208:209], v10 offset:40960
    v_mfma_f32_16x16x32_bf16 v[40:43], a[184:187], v[192:195], v[40:43]
    ds_read_b64_tr_b16 a[210:211], v10 offset:43008
    v_mfma_f32_16x16x32_bf16 v[40:43], a[188:191], v[196:199], v[40:43]
    buffer_load_dwordx4 a[220:223], v14, s[20:23], s37 offen offset:1024 sc1
    v_mfma_f32_16x16x32_bf16 v[44:47], a[188:191], v[204:207], v[44:47]
    ds_read_b64_tr_b16 a[212:213], v10 offset:45056
    v_mfma_f32_16x16x32_bf16 v[44:47], a[184:187], v[200:203], v[44:47]
    ds_read_b64_tr_b16 a[214:215], v10 offset:47104
    v_mfma_f32_16x16x32_bf16 v[48:51], a[184:187], v[208:211], v[48:51]
    s_waitcnt lgkmcnt(4)
    v_add_u32 v10, 73728, v10
    v_mfma_f32_16x16x32_bf16 v[48:51], a[188:191], v[212:215], v[48:51]
    v_mfma_f32_16x16x32_bf16 v[52:55], a[188:191], v[220:223], v[52:55]
    v_mfma_f32_16x16x32_bf16 v[52:55], a[184:187], v[216:219], v[52:55]
    ds_read_b64_tr_b16 a[184:185], v11 offset:49152
    v_mfma_f32_16x16x32_bf16 v[52:55], a[192:195], v[248:251], v[52:55]
    ds_read_b64_tr_b16 a[186:187], v11 offset:51200
    v_mfma_f32_16x16x32_bf16 v[52:55], a[196:199], v[252:255], v[52:55]
    ds_read_b64_tr_b16 a[188:189], v11 offset:53248
    v_mfma_f32_16x16x32_bf16 v[48:51], a[196:199], v[244:247], v[48:51]
    buffer_load_dwordx4 a[224:227], v14, s[20:23], s37 offen offset:2048 sc1
    v_mfma_f32_16x16x32_bf16 v[48:51], a[192:195], v[240:243], v[48:51]
    ds_read_b64_tr_b16 a[190:191], v11 offset:55296
    v_mfma_f32_16x16x32_bf16 v[44:47], a[192:195], v[232:235], v[44:47]
    v_mfma_f32_16x16x32_bf16 v[44:47], a[196:199], v[236:239], v[44:47]
    v_mfma_f32_16x16x32_bf16 v[40:43], a[196:199], v[228:231], v[40:43]
    v_mfma_f32_16x16x32_bf16 v[40:43], a[192:195], v[224:227], v[40:43]
    ds_read_b64_tr_b16 a[192:193], v11 offset:57344
    v_mfma_f32_16x16x32_bf16 v[40:43], a[200:203], v[56:59], v[40:43]
pg_10:
    s_cbranch_execz pg_14
    ds_read_b64_tr_b16 a[194:195], v11 offset:59392
    v_mfma_f32_16x16x32_bf16 v[40:43], a[204:207], v[60:63], v[40:43]
    ds_read_b64_tr_b16 a[196:197], v11 offset:61440
    v_mfma_f32_16x16x32_bf16 v[44:47], a[204:207], v[68:71], v[44:47]
    s_waitcnt lgkmcnt(3)
    ds_read_b64_tr_b16 a[198:199], v11 offset:63488
    v_mfma_f32_16x16x32_bf16 v[44:47], a[200:203], v[64:67], v[44:47]
    buffer_load_dwordx4 a[228:231], v14, s[20:23], s37 offen offset:3072 sc1
    v_mfma_f32_16x16x32_bf16 v[48:51], a[200:203], v[72:75], v[48:51]
    v_mfma_f32_16x16x32_bf16 v[48:51], a[204:207], v[76:79], v[48:51]
    v_mfma_f32_16x16x32_bf16 v[52:55], a[204:207], v[84:87], v[52:55]
    v_mfma_f32_16x16x32_bf16 v[52:55], a[200:203], v[80:83], v[52:55]
    ds_read_b64_tr_b16 a[200:201], v11 offset:0
    v_mfma_f32_16x16x32_bf16 v[52:55], a[208:211], v[112:115], v[52:55]
    ds_read_b64_tr_b16 a[202:203], v11 offset:2048
    v_mfma_f32_16x16x32_bf16 v[52:55], a[212:215], v[116:119], v[52:55]
    ds_read_b64_tr_b16 a[204:205], v11 offset:4096
    v_mfma_f32_16x16x32_bf16 v[48:51], a[212:215], v[108:111], v[48:51]
    ds_read_b64_tr_b16 a[206:207], v11 offset:6144
    v_mfma_f32_16x16x32_bf16 v[48:51], a[208:211], v[104:107], v[48:51]
    v_mfma_f32_16x16x32_bf16 v[44:47], a[208:211], v[96:99], v[44:47]
    v_mfma_f32_16x16x32_bf16 v[44:47], a[212:215], v[100:103], v[44:47]
    v_mfma_f32_16x16x32_bf16 v[40:43], a[212:215], v[92:95], v[40:43]
    s_add_u32 s37, s60, 0
    v_mul_f32 v52, v19, v52
    v_mfma_f32_16x16x32_bf16 v[40:43], a[208:211], v[88:91], v[40:43]
    ds_read_b64_tr_b16 a[208:209], v11 offset:8192
    v_mfma_f32_16x16x32_bf16 v[24:27], a[184:187], a[96:99], 0
    s_waitcnt vmcnt(8)
    ds_read_b64_tr_b16 a[210:211], v11 offset:10240
    v_cmp_ne_u32 vcc, s7, v23
    v_mfma_f32_16x16x32_bf16 v[24:27], a[188:191], a[100:103], v[24:27]
    s_cbranch_vccnz spin_gu
spin_gu_ret:
    v_mul_f32 v44, v17, v44
    v_mfma_f32_16x16x32_bf16 v[28:31], a[188:191], a[108:111], 0
    ds_read_b64_tr_b16 a[212:213], v11 offset:12288
    v_mul_f32 v40, v16, v40
    v_mfma_f32_16x16x32_bf16 v[28:31], a[184:187], a[104:107], v[28:31]
    s_waitcnt lgkmcnt(3)
    ds_read_b64_tr_b16 a[214:215], v11 offset:14336
    v_mul_f32 v41, v16, v41
    v_mfma_f32_16x16x32_bf16 v[32:35], a[184:187], a[112:115], 0
    buffer_load_dwordx4 a[232:235], v14, s[20:23], s37 offen offset:0 sc1
    v_mfma_f32_16x16x32_bf16 v[32:35], a[188:191], a[116:119], v[32:35]
    v_mul_f32 v42, v16, v42
    v_mul_f32 v43, v16, v43
    v_mfma_f32_16x16x32_bf16 v[36:39], a[188:191], a[124:127], 0
    v_cvt_pk_bf16_f32 v40, v40, v41
    v_cvt_pk_bf16_f32 v41, v42, v43
    v_mfma_f32_16x16x32_bf16 v[36:39], a[184:187], a[120:123], v[36:39]
    ds_read_b64_tr_b16 a[184:185], v11 offset:16384
    v_accvgpr_write_b32 a48, v40
    v_mfma_f32_16x16x32_bf16 v[36:39], a[192:195], v[120:123], v[36:39]
    ds_read_b64_tr_b16 a[186:187], v11 offset:18432
    v_accvgpr_write_b32 a49, v41
    v_mfma_f32_16x16x32_bf16 v[36:39], a[196:199], v[124:127], v[36:39]
    ds_read_b64_tr_b16 a[188:189], v11 offset:20480
    v_mul_f32 v45, v17, v45
    v_mfma_f32_16x16x32_bf16 v[32:35], a[196:199], a[148:151], v[32:35]
    ds_read_b64_tr_b16 a[190:191], v11 offset:22528
    v_mul_f32 v46, v17, v46
    v_mfma_f32_16x16x32_bf16 v[32:35], a[192:195], a[144:147], v[32:35]
    v_mul_f32 v47, v17, v47
    v_cvt_pk_bf16_f32 v44, v44, v45
    v_mfma_f32_16x16x32_bf16 v[28:31], a[192:195], a[136:139], v[28:31]
    v_cvt_pk_bf16_f32 v45, v46, v47
    v_accvgpr_write_b32 a52, v44
    v_mfma_f32_16x16x32_bf16 v[28:31], a[196:199], a[140:143], v[28:31]
    buffer_load_dwordx4 a[236:239], v14, s[20:23], s37 offen offset:1024 sc1
    v_mfma_f32_16x16x32_bf16 v[24:27], a[196:199], a[132:135], v[24:27]
    v_accvgpr_write_b32 a53, v45
    v_mul_f32 v48, v18, v48
    v_mfma_f32_16x16x32_bf16 v[24:27], a[192:195], a[128:131], v[24:27]
    ds_read_b64_tr_b16 a[192:193], v11 offset:24576
    v_mul_f32 v49, v18, v49
    v_mfma_f32_16x16x32_bf16 v[24:27], a[200:203], v[128:131], v[24:27]
    ds_read_b64_tr_b16 a[194:195], v11 offset:26624
    v_mul_f32 v50, v18, v50
    v_mfma_f32_16x16x32_bf16 v[24:27], a[204:207], v[132:135], v[24:27]
    ds_read_b64_tr_b16 a[196:197], v11 offset:28672
    v_mul_f32 v51, v18, v51
    v_mfma_f32_16x16x32_bf16 v[28:31], a[204:207], v[140:143], v[28:31]
    s_waitcnt lgkmcnt(3)
    ds_read_b64_tr_b16 a[198:199], v11 offset:30720
    v_cvt_pk_bf16_f32 v48, v48, v49
    v_mfma_f32_16x16x32_bf16 v[28:31], a[200:203], v[136:139], v[28:31]
    v_cvt_pk_bf16_f32 v49, v50, v51
    v_accvgpr_write_b32 a56, v48
    v_mfma_f32_16x16x32_bf16 v[32:35], a[200:203], v[144:147], v[32:35]
    v_accvgpr_write_b32 a57, v49
    v_mul_f32 v53, v19, v53
    v_mfma_f32_16x16x32_bf16 v[32:35], a[204:207], v[148:151], v[32:35]
    v_mul_f32 v54, v19, v54
    v_mul_f32 v55, v19, v55
    v_mfma_f32_16x16x32_bf16 v[36:39], a[204:207], v[156:159], v[36:39]
    buffer_load_dwordx4 a[240:243], v14, s[20:23], s37 offen offset:2048 sc1
    v_mfma_f32_16x16x32_bf16 v[36:39], a[200:203], v[152:155], v[36:39]
    ds_read_b64_tr_b16 a[200:201], v11 offset:32768
    v_cvt_pk_bf16_f32 v52, v52, v53
    v_mfma_f32_16x16x32_bf16 v[36:39], a[208:211], v[184:187], v[36:39]
    ds_read_b64_tr_b16 a[202:203], v11 offset:34816
    v_cvt_pk_bf16_f32 v53, v54, v55
    v_mfma_f32_16x16x32_bf16 v[36:39], a[212:215], v[188:191], v[36:39]
    ds_read_b64_tr_b16 a[204:205], v11 offset:36864
    v_accvgpr_write_b32 a60, v52
    v_mfma_f32_16x16x32_bf16 v[32:35], a[212:215], v[180:183], v[32:35]
    s_waitcnt vmcnt(6)
    ds_read_b64_tr_b16 a[206:207], v11 offset:38912
    v_accvgpr_write_b32 a61, v53
    v_mfma_f32_16x16x32_bf16 v[32:35], a[208:211], v[176:179], v[32:35]
    buffer_store_dword v4, v15, s[24:27], s76 offen sc1
    v_mfma_f32_16x16x32_bf16 v[28:31], a[208:211], v[168:171], v[28:31]
    v_mov_b32 v4, s56
    v_mfma_f32_16x16x32_bf16 v[28:31], a[212:215], v[172:175], v[28:31]
    v_cmp_gt_u32 vcc, 16, v1
    v_mfma_f32_16x16x32_bf16 v[24:27], a[212:215], v[164:167], v[24:27]
    v_mfma_f32_16x16x32_bf16 v[24:27], a[208:211], v[160:163], v[24:27]
    buffer_load_dwordx4 a[244:247], v14, s[20:23], s37 offen offset:3072 sc1
    v_mfma_f32_16x16x32_bf16 v[24:27], a[184:187], v[192:195], v[24:27]
    ds_read_b64_tr_b16 a[208:209], v11 offset:40960
    v_mfma_f32_16x16x32_bf16 v[24:27], a[188:191], v[196:199], v[24:27]
    ds_read_b64_tr_b16 a[210:211], v11 offset:43008
    v_mfma_f32_16x16x32_bf16 v[28:31], a[188:191], v[204:207], v[28:31]
    s_add_u32 s37, s61, 0
    ds_read_b64_tr_b16 a[212:213], v11 offset:45056
    v_mfma_f32_16x16x32_bf16 v[28:31], a[184:187], v[200:203], v[28:31]
    s_waitcnt lgkmcnt(3)
    ds_read_b64_tr_b16 a[214:215], v11 offset:47104
    s_add_u32 s38, s44, 81920
    v_mfma_f32_16x16x32_bf16 v[32:35], a[184:187], v[208:211], v[32:35]
    s_add_u32 s36, s44, 122880
    v_add_u32 v11, 73728, v11
    v_mfma_f32_16x16x32_bf16 v[32:35], a[188:191], v[212:215], v[32:35]
    s_cmp_lt_u32 s3, 2
    s_cselect_b32 s38, s38, s36
    s_add_u32 m0, s63, 16384
    v_mfma_f32_16x16x32_bf16 v[36:39], a[188:191], v[220:223], v[36:39]
    v_mfma_f32_16x16x32_bf16 v[36:39], a[184:187], v[216:219], v[36:39]
    v_mfma_f32_16x16x32_bf16 v[36:39], a[192:195], v[248:251], v[36:39]
    buffer_load_dwordx4 a[152:155], v14, s[20:23], s37 offen offset:0 sc1
    v_mfma_f32_16x16x32_bf16 v[36:39], a[196:199], v[252:255], v[36:39]
    s_waitcnt lgkmcnt(0)
    v_mfma_f32_16x16x32_bf16 v[32:35], a[196:199], v[244:247], v[32:35]
    s_barrier
    v_mfma_f32_16x16x32_bf16 v[32:35], a[192:195], v[240:243], v[32:35]
    buffer_load_dwordx4 v7, s[8:11], s38 offen lds
    v_mfma_f32_16x16x32_bf16 v[28:31], a[192:195], v[232:235], v[28:31]
    ds_read_b64_tr_b16 a[184:185], v8 offset:0
    v_mfma_f32_16x16x32_bf16 v[28:31], a[196:199], v[236:239], v[28:31]
    ds_read_b64_tr_b16 a[186:187], v8 offset:2048
    v_mfma_f32_16x16x32_bf16 v[24:27], a[196:199], v[228:231], v[24:27]
    ds_read_b64_tr_b16 a[188:189], v8 offset:4096
    v_mfma_f32_16x16x32_bf16 v[24:27], a[192:195], v[224:227], v[24:27]
    s_add_u32 s38, s44, 81920
    ds_read_b64_tr_b16 a[190:191], v8 offset:6144
    v_mfma_f32_16x16x32_bf16 v[24:27], a[200:203], v[56:59], v[24:27]
    ds_read_b64_tr_b16 a[192:193], v8 offset:8192
    v_mfma_f32_16x16x32_bf16 v[24:27], a[204:207], v[60:63], v[24:27]
    buffer_load_dwordx4 a[156:159], v14, s[20:23], s37 offen offset:1024 sc1
    v_mfma_f32_16x16x32_bf16 v[28:31], a[204:207], v[68:71], v[28:31]
    s_addk_i32 m0, -16384
    ds_read_b64_tr_b16 a[194:195], v8 offset:10240
    v_mfma_f32_16x16x32_bf16 v[28:31], a[200:203], v[64:67], v[28:31]
    ds_read_b64_tr_b16 a[196:197], v8 offset:12288
    v_mfma_f32_16x16x32_bf16 v[32:35], a[200:203], v[72:75], v[32:35]
    ds_read_b64_tr_b16 a[198:199], v8 offset:14336
    v_mfma_f32_16x16x32_bf16 v[32:35], a[204:207], v[76:79], v[32:35]
    v_mfma_f32_16x16x32_bf16 v[36:39], a[204:207], v[84:87], v[36:39]
    v_mfma_f32_16x16x32_bf16 v[36:39], a[200:203], v[80:83], v[36:39]
    buffer_load_dwordx4 v2, s[8:11], s38 offen lds
    v_mfma_f32_16x16x32_bf16 v[36:39], a[208:211], v[112:115], v[36:39]
    ds_read_b64_tr_b16 a[200:201], v8 offset:16384
    v_mfma_f32_16x16x32_bf16 v[36:39], a[212:215], v[116:119], v[36:39]
    ds_read_b64_tr_b16 a[202:203], v8 offset:18432
    v_mfma_f32_16x16x32_bf16 v[32:35], a[212:215], v[108:111], v[32:35]
    buffer_load_dwordx4 a[160:163], v14, s[20:23], s37 offen offset:2048 sc1
    v_mfma_f32_16x16x32_bf16 v[32:35], a[208:211], v[104:107], v[32:35]
    s_load_dwordx4 s[72:75], s[86:87], s5 glc
    ds_read_b64_tr_b16 a[204:205], v8 offset:20480
    s_add_u32 s38, s44, 81920
    v_mfma_f32_16x16x32_bf16 v[28:31], a[208:211], v[96:99], v[28:31]
    s_waitcnt lgkmcnt(5)
    ds_read_b64_tr_b16 a[206:207], v8 offset:22528
    v_mfma_f32_16x16x32_bf16 v[28:31], a[212:215], v[100:103], v[28:31]
    s_add_u32 m0, s63, 4096
    v_mul_f32 v32, v18, v32
    v_mul_f32 v33, v18, v33
    v_mfma_f32_16x16x32_bf16 v[24:27], a[212:215], v[92:95], v[24:27]
    v_mul_f32 v34, v18, v34
    v_mfma_f32_16x16x32_bf16 v[24:27], a[208:211], v[88:91], v[24:27]
    ds_read_b64_tr_b16 a[208:209], v8 offset:24576
    v_mfma_f32_16x16x32_bf16 v[40:43], a[184:187], a[96:99], 0
    ds_read_b64_tr_b16 a[210:211], v8 offset:26624
    v_mul_f32 v28, v17, v28
    v_mfma_f32_16x16x32_bf16 v[40:43], a[188:191], a[100:103], v[40:43]
    ds_read_b64_tr_b16 a[212:213], v8 offset:28672
    v_mul_f32 v29, v17, v29
    v_mfma_f32_16x16x32_bf16 v[44:47], a[188:191], a[108:111], 0
    ds_read_b64_tr_b16 a[214:215], v8 offset:30720
    v_mul_f32 v24, v16, v24
    v_mfma_f32_16x16x32_bf16 v[44:47], a[184:187], a[104:107], v[44:47]
    buffer_load_dwordx4 a[164:167], v14, s[20:23], s37 offen offset:3072 sc1
    v_mfma_f32_16x16x32_bf16 v[48:51], a[184:187], a[112:115], 0
    buffer_load_dwordx4 v3, s[8:11], s38 offen lds
    v_mfma_f32_16x16x32_bf16 v[48:51], a[188:191], a[116:119], v[48:51]
    v_mul_f32 v25, v16, v25
    v_mul_f32 v26, v16, v26
    v_mfma_f32_16x16x32_bf16 v[52:55], a[188:191], a[124:127], 0
    s_waitcnt lgkmcnt(5)
    v_mul_f32 v27, v16, v27
    v_cvt_pk_bf16_f32 v24, v24, v25
    v_mfma_f32_16x16x32_bf16 v[52:55], a[184:187], a[120:123], v[52:55]
    s_add_u32 s38, s44, 122880
    ds_read_b64_tr_b16 a[184:185], v8 offset:32768
    v_cvt_pk_bf16_f32 v25, v26, v27
    v_mfma_f32_16x16x32_bf16 v[52:55], a[192:195], v[120:123], v[52:55]
    ds_read_b64_tr_b16 a[186:187], v8 offset:34816
    v_accvgpr_write_b32 a50, v24
    v_mfma_f32_16x16x32_bf16 v[52:55], a[196:199], v[124:127], v[52:55]
    s_addk_i32 m0, 4096
    ds_read_b64_tr_b16 a[188:189], v8 offset:36864
    v_accvgpr_write_b32 a51, v25
    v_mfma_f32_16x16x32_bf16 v[48:51], a[196:199], a[148:151], v[48:51]
    buffer_store_dwordx4 a[48:51], v14, s[20:23], s55 offen offset:0 sc1
    v_mul_f32 v30, v17, v30
    v_mfma_f32_16x16x32_bf16 v[48:51], a[192:195], a[144:147], v[48:51]
    ds_read_b64_tr_b16 a[190:191], v8 offset:38912
    v_mul_f32 v31, v17, v31
    v_mfma_f32_16x16x32_bf16 v[44:47], a[192:195], a[136:139], v[44:47]
    v_cvt_pk_bf16_f32 v28, v28, v29
    v_cvt_pk_bf16_f32 v29, v30, v31
    v_mfma_f32_16x16x32_bf16 v[44:47], a[196:199], a[140:143], v[44:47]
    v_accvgpr_write_b32 a54, v28
    v_accvgpr_write_b32 a55, v29
    v_mfma_f32_16x16x32_bf16 v[40:43], a[196:199], a[132:135], v[40:43]
    buffer_store_dwordx4 a[52:55], v14, s[20:23], s55 offen offset:1024 sc1
    v_mul_f32 v35, v18, v35
    v_mfma_f32_16x16x32_bf16 v[40:43], a[192:195], a[128:131], v[40:43]
    buffer_load_dwordx4 v2, s[8:11], s38 offen lds
    v_mfma_f32_16x16x32_bf16 v[40:43], a[200:203], v[128:131], v[40:43]
    s_waitcnt lgkmcnt(3)
    ds_read_b64_tr_b16 a[192:193], v8 offset:40960
    v_cvt_pk_bf16_f32 v32, v32, v33
    v_mfma_f32_16x16x32_bf16 v[40:43], a[204:207], v[132:135], v[40:43]
    ds_read_b64_tr_b16 a[194:195], v8 offset:43008
    v_cvt_pk_bf16_f32 v33, v34, v35
    v_mfma_f32_16x16x32_bf16 v[44:47], a[204:207], v[140:143], v[44:47]
    ds_read_b64_tr_b16 a[196:197], v8 offset:45056
    v_accvgpr_write_b32 a58, v32
    v_mfma_f32_16x16x32_bf16 v[44:47], a[200:203], v[136:139], v[44:47]
    s_add_u32 s38, s44, 122880
    ds_read_b64_tr_b16 a[198:199], v8 offset:47104
    v_accvgpr_write_b32 a59, v33
    v_mfma_f32_16x16x32_bf16 v[48:51], a[200:203], v[144:147], v[48:51]
    buffer_store_dwordx4 a[56:59], v14, s[20:23], s55 offen offset:2048 sc1
    v_mul_f32 v36, v19, v36
    v_mfma_f32_16x16x32_bf16 v[48:51], a[204:207], v[148:151], v[48:51]
    s_addk_i32 m0, 4096
    v_mul_f32 v37, v19, v37
    v_mul_f32 v38, v19, v38
    v_mfma_f32_16x16x32_bf16 v[52:55], a[204:207], v[156:159], v[52:55]
    v_mul_f32 v39, v19, v39
    v_cvt_pk_bf16_f32 v36, v36, v37
    v_mfma_f32_16x16x32_bf16 v[52:55], a[200:203], v[152:155], v[52:55]
    ds_read_b64_tr_b16 a[200:201], v8 offset:49152
    v_cvt_pk_bf16_f32 v37, v38, v39
    v_mfma_f32_16x16x32_bf16 v[52:55], a[208:211], v[184:187], v[52:55]
    ds_read_b64_tr_b16 a[202:203], v8 offset:51200
    v_accvgpr_write_b32 a62, v36
    v_mfma_f32_16x16x32_bf16 v[52:55], a[212:215], v[188:191], v[52:55]
    ds_read_b64_tr_b16 a[204:205], v8 offset:53248
    v_accvgpr_write_b32 a63, v37
    v_mfma_f32_16x16x32_bf16 v[48:51], a[212:215], v[180:183], v[48:51]
    buffer_store_dwordx4 a[60:63], v14, s[20:23], s55 offen offset:3072 sc1
    v_mfma_f32_16x16x32_bf16 v[48:51], a[208:211], v[176:179], v[48:51]
    buffer_load_dwordx4 v3, s[8:11], s38 offen lds
    v_mfma_f32_16x16x32_bf16 v[44:47], a[208:211], v[168:171], v[44:47]
    s_add_u32 s55, s55, 4096
    ds_read_b64_tr_b16 a[206:207], v8 offset:55296
    v_mfma_f32_16x16x32_bf16 v[44:47], a[212:215], v[172:175], v[44:47]
    s_waitcnt lgkmcnt(6)
    v_mfma_f32_16x16x32_bf16 v[40:43], a[212:215], v[164:167], v[40:43]
    s_add_u32 s77, s7, 2
    v_mfma_f32_16x16x32_bf16 v[40:43], a[208:211], v[160:163], v[40:43]
    s_add_u32 s38, s44, 163840
    ds_read_b64_tr_b16 a[208:209], v8 offset:57344
    s_add_u32 s36, s45, 0
    v_mfma_f32_16x16x32_bf16 v[40:43], a[184:187], v[192:195], v[40:43]
    s_cmp_lt_u32 s3, 2
    s_cselect_b32 s38, s38, s36
    v_mfma_f32_16x16x32_bf16 v[40:43], a[188:191], v[196:199], v[40:43]
    s_addk_i32 m0, 24576
    ds_read_b64_tr_b16 a[210:211], v8 offset:59392
    v_mfma_f32_16x16x32_bf16 v[44:47], a[188:191], v[204:207], v[44:47]
    ds_read_b64_tr_b16 a[212:213], v8 offset:61440
    v_mfma_f32_16x16x32_bf16 v[44:47], a[184:187], v[200:203], v[44:47]
    ds_read_b64_tr_b16 a[214:215], v8 offset:63488
    v_mfma_f32_16x16x32_bf16 v[48:51], a[184:187], v[208:211], v[48:51]
    v_add_u32 v8, 65536, v8
    v_mfma_f32_16x16x32_bf16 v[48:51], a[188:191], v[212:215], v[48:51]
    v_mfma_f32_16x16x32_bf16 v[52:55], a[188:191], v[220:223], v[52:55]
    s_waitcnt lgkmcnt(5)
    v_mfma_f32_16x16x32_bf16 v[52:55], a[184:187], v[216:219], v[52:55]
    buffer_load_dwordx4 v7, s[8:11], s38 offen lds
    v_mfma_f32_16x16x32_bf16 v[52:55], a[192:195], v[248:251], v[52:55]
    ds_read_b64_tr_b16 a[184:185], v9 offset:0
    v_mfma_f32_16x16x32_bf16 v[52:55], a[196:199], v[252:255], v[52:55]
    ds_read_b64_tr_b16 a[186:187], v9 offset:2048
    v_mfma_f32_16x16x32_bf16 v[48:51], a[196:199], v[244:247], v[48:51]
    ds_read_b64_tr_b16 a[188:189], v9 offset:4096
    v_mfma_f32_16x16x32_bf16 v[48:51], a[192:195], v[240:243], v[48:51]
    s_add_u32 s38, s44, 163840
    ds_read_b64_tr_b16 a[190:191], v9 offset:6144
    v_mfma_f32_16x16x32_bf16 v[44:47], a[192:195], v[232:235], v[44:47]
    v_mfma_f32_16x16x32_bf16 v[44:47], a[196:199], v[236:239], v[44:47]
    s_addk_i32 m0, -16384
    v_mfma_f32_16x16x32_bf16 v[40:43], a[196:199], v[228:231], v[40:43]
    s_waitcnt lgkmcnt(4)
    s_sub_u32 s78, s72, s77
    s_sub_u32 s79, s73, s77
    v_mfma_f32_16x16x32_bf16 v[40:43], a[192:195], v[224:227], v[40:43]
    s_max_u32 s78, s78, s79
    ds_read_b64_tr_b16 a[192:193], v9 offset:8192
    s_sub_u32 s79, s74, s77
    v_mfma_f32_16x16x32_bf16 v[40:43], a[200:203], v[56:59], v[40:43]
    s_max_u32 s78, s78, s79
    ds_read_b64_tr_b16 a[194:195], v9 offset:10240
    s_sub_u32 s79, s75, s77
    v_mfma_f32_16x16x32_bf16 v[40:43], a[204:207], v[60:63], v[40:43]
    s_max_u32 s78, s78, s79
    ds_read_b64_tr_b16 a[196:197], v9 offset:12288
    v_mfma_f32_16x16x32_bf16 v[44:47], a[204:207], v[68:71], v[44:47]
    s_cmp_gt_u32 s78, 4
    s_cbranch_scc1 spin_o1
spin_o1_ret:
    s_add_u32 s37, s59, 4096
    v_mfma_f32_16x16x32_bf16 v[44:47], a[200:203], v[64:67], v[44:47]
    buffer_load_dwordx4 v2, s[8:11], s38 offen lds
    v_mfma_f32_16x16x32_bf16 v[48:51], a[200:203], v[72:75], v[48:51]
    ds_read_b64_tr_b16 a[198:199], v9 offset:14336
    v_mfma_f32_16x16x32_bf16 v[48:51], a[204:207], v[76:79], v[48:51]
    v_mfma_f32_16x16x32_bf16 v[52:55], a[204:207], v[84:87], v[52:55]
    v_mfma_f32_16x16x32_bf16 v[52:55], a[200:203], v[80:83], v[52:55]
    s_add_u32 s38, s44, 163840
    ds_read_b64_tr_b16 a[200:201], v9 offset:16384
    v_mfma_f32_16x16x32_bf16 v[52:55], a[208:211], v[112:115], v[52:55]
    buffer_load_dwordx4 a[168:171], v14, s[20:23], s37 offen offset:0 sc1
    v_mfma_f32_16x16x32_bf16 v[52:55], a[212:215], v[116:119], v[52:55]
    s_addk_i32 m0, 4096
    ds_read_b64_tr_b16 a[202:203], v9 offset:18432
    v_mfma_f32_16x16x32_bf16 v[48:51], a[212:215], v[108:111], v[48:51]
    ds_read_b64_tr_b16 a[204:205], v9 offset:20480
    v_mfma_f32_16x16x32_bf16 v[48:51], a[208:211], v[104:107], v[48:51]
    s_waitcnt lgkmcnt(3)
    ds_read_b64_tr_b16 a[206:207], v9 offset:22528
    v_mfma_f32_16x16x32_bf16 v[44:47], a[208:211], v[96:99], v[44:47]
    v_mul_f32 v52, v19, v52
    v_mfma_f32_16x16x32_bf16 v[44:47], a[212:215], v[100:103], v[44:47]
    v_mul_f32 v53, v19, v53
    v_mfma_f32_16x16x32_bf16 v[40:43], a[212:215], v[92:95], v[40:43]
    v_mul_f32 v54, v19, v54
    v_mfma_f32_16x16x32_bf16 v[40:43], a[208:211], v[88:91], v[40:43]
    buffer_load_dwordx4 v3, s[8:11], s38 offen lds
    v_mfma_f32_16x16x32_bf16 v[24:27], a[184:187], a[96:99], 0
    ds_read_b64_tr_b16 a[208:209], v9 offset:24576
    v_mfma_f32_16x16x32_bf16 v[24:27], a[188:191], a[100:103], v[24:27]
    buffer_load_dwordx4 a[172:175], v14, s[20:23], s37 offen offset:1024 sc1
    v_mfma_f32_16x16x32_bf16 v[28:31], a[188:191], a[108:111], 0
    ds_read_b64_tr_b16 a[210:211], v9 offset:26624
    v_mul_f32 v44, v17, v44
    v_mfma_f32_16x16x32_bf16 v[28:31], a[184:187], a[104:107], v[28:31]
    s_add_u32 s38, s45, 0
    ds_read_b64_tr_b16 a[212:213], v9 offset:28672
    v_mul_f32 v40, v16, v40
    v_mfma_f32_16x16x32_bf16 v[32:35], a[184:187], a[112:115], 0
    ds_read_b64_tr_b16 a[214:215], v9 offset:30720
    v_mul_f32 v41, v16, v41
    v_mfma_f32_16x16x32_bf16 v[32:35], a[188:191], a[116:119], v[32:35]
    s_addk_i32 m0, 4096
    v_mul_f32 v42, v16, v42
    v_mul_f32 v43, v16, v43
    v_mfma_f32_16x16x32_bf16 v[36:39], a[188:191], a[124:127], 0
    v_cvt_pk_bf16_f32 v40, v40, v41
    v_cvt_pk_bf16_f32 v41, v42, v43
    v_mfma_f32_16x16x32_bf16 v[36:39], a[184:187], a[120:123], v[36:39]
    ds_read_b64_tr_b16 a[184:185], v9 offset:32768
    v_accvgpr_write_b32 a64, v40
    v_mfma_f32_16x16x32_bf16 v[36:39], a[192:195], v[120:123], v[36:39]
    ds_read_b64_tr_b16 a[186:187], v9 offset:34816
    v_accvgpr_write_b32 a65, v41
    v_mfma_f32_16x16x32_bf16 v[36:39], a[196:199], v[124:127], v[36:39]
    ds_read_b64_tr_b16 a[188:189], v9 offset:36864
    v_mul_f32 v45, v17, v45
    v_mfma_f32_16x16x32_bf16 v[32:35], a[196:199], a[148:151], v[32:35]
    s_waitcnt lgkmcnt(4)
    ds_read_b64_tr_b16 a[190:191], v9 offset:38912
    v_mul_f32 v46, v17, v46
    v_mfma_f32_16x16x32_bf16 v[32:35], a[192:195], a[144:147], v[32:35]
    buffer_load_dwordx4 a[176:179], v14, s[20:23], s37 offen offset:2048 sc1
    v_mfma_f32_16x16x32_bf16 v[28:31], a[192:195], a[136:139], v[28:31]
    buffer_load_dwordx4 v2, s[8:11], s38 offen lds
    v_mfma_f32_16x16x32_bf16 v[28:31], a[196:199], a[140:143], v[28:31]
    s_mov_b32 s12, s64
    v_mul_f32 v47, v17, v47
    v_cvt_pk_bf16_f32 v44, v44, v45
    v_mfma_f32_16x16x32_bf16 v[24:27], a[196:199], a[132:135], v[24:27]
    s_and_b32 s13, s65, 0xffff
    v_cvt_pk_bf16_f32 v45, v46, v47
    v_accvgpr_write_b32 a68, v44
    v_mfma_f32_16x16x32_bf16 v[24:27], a[192:195], a[128:131], v[24:27]
    s_add_u32 s38, s45, 0
    ds_read_b64_tr_b16 a[192:193], v9 offset:40960
    v_accvgpr_write_b32 a69, v45
    v_mfma_f32_16x16x32_bf16 v[24:27], a[200:203], v[128:131], v[24:27]
    s_mov_b32 s14, 2621440
    ds_read_b64_tr_b16 a[194:195], v9 offset:43008
    v_mul_f32 v48, v18, v48
    v_mfma_f32_16x16x32_bf16 v[24:27], a[204:207], v[132:135], v[24:27]
    s_addk_i32 m0, 4096
    ds_read_b64_tr_b16 a[196:197], v9 offset:45056
    v_mul_f32 v49, v18, v49
    v_mfma_f32_16x16x32_bf16 v[28:31], a[204:207], v[140:143], v[28:31]
    s_mov_b32 s15, 0x00020000
    ds_read_b64_tr_b16 a[198:199], v9 offset:47104
    v_mul_f32 v50, v18, v50
    v_mfma_f32_16x16x32_bf16 v[28:31], a[200:203], v[136:139], v[28:31]
    buffer_load_dwordx4 a[180:183], v14, s[20:23], s37 offen offset:3072 sc1
    v_mfma_f32_16x16x32_bf16 v[32:35], a[200:203], v[144:147], v[32:35]
    s_lshl_b32 s56, s54, 1
    v_mul_f32 v51, v18, v51
    v_cvt_pk_bf16_f32 v48, v48, v49
    v_mfma_f32_16x16x32_bf16 v[32:35], a[204:207], v[148:151], v[32:35]
    s_and_b32 s57, s53, 1
    v_cvt_pk_bf16_f32 v49, v50, v51
    v_accvgpr_write_b32 a72, v48
    v_mfma_f32_16x16x32_bf16 v[36:39], a[204:207], v[156:159], v[36:39]
    s_waitcnt lgkmcnt(3)
    v_accvgpr_write_b32 a73, v49
    v_mul_f32 v55, v19, v55
    v_mfma_f32_16x16x32_bf16 v[36:39], a[200:203], v[152:155], v[36:39]
    buffer_load_dwordx4 v3, s[8:11], s38 offen lds
    v_mfma_f32_16x16x32_bf16 v[36:39], a[208:211], v[184:187], v[36:39]
    s_waitcnt vmcnt(10)
    ds_read_b64_tr_b16 a[200:201], v9 offset:49152
    v_cvt_pk_bf16_f32 v52, v52, v53
    v_mfma_f32_16x16x32_bf16 v[36:39], a[212:215], v[188:191], v[36:39]
    buffer_store_dword v4, v15, s[24:27], s76 offen sc1
    v_mfma_f32_16x16x32_bf16 v[32:35], a[212:215], v[180:183], v[32:35]
    s_add_u32 s56, s56, s57
    ds_read_b64_tr_b16 a[202:203], v9 offset:51200
    v_cvt_pk_bf16_f32 v53, v54, v55
    v_mfma_f32_16x16x32_bf16 v[32:35], a[208:211], v[176:179], v[32:35]
    s_add_u32 s38, s46, 0
    ds_read_b64_tr_b16 a[204:205], v9 offset:53248
    v_accvgpr_write_b32 a76, v52
    v_mfma_f32_16x16x32_bf16 v[28:31], a[208:211], v[168:171], v[28:31]
    s_add_u32 s36, s47, 0
    ds_read_b64_tr_b16 a[206:207], v9 offset:55296
    v_accvgpr_write_b32 a77, v53
    v_mfma_f32_16x16x32_bf16 v[28:31], a[212:215], v[172:175], v[28:31]
    s_cmp_lt_u32 s3, 2
    s_cselect_b32 s38, s38, s36
    s_addk_i32 m0, 24576
    v_mfma_f32_16x16x32_bf16 v[24:27], a[212:215], v[164:167], v[24:27]
    s_lshl_b32 s6, s56, 5
    s_andn2_b32 s56, 2, s53
    s_lshl3_add_u32 s6, s56, s6
    v_mfma_f32_16x16x32_bf16 v[24:27], a[208:211], v[160:163], v[24:27]
    s_mul_i32 s56, s51, 320
    ds_read_b64_tr_b16 a[208:209], v9 offset:57344
    s_and_b32 s57, s51, 1
    v_mfma_f32_16x16x32_bf16 v[24:27], a[184:187], v[192:195], v[24:27]
    s_add_u32 s64, s57, s50
    ds_read_b64_tr_b16 a[210:211], v9 offset:59392
    s_lshl_b32 s64, s64, 6
    v_mfma_f32_16x16x32_bf16 v[24:27], a[188:191], v[196:199], v[24:27]
    s_add_u32 s64, s64, s56
    ds_read_b64_tr_b16 a[212:213], v9 offset:61440
    s_xor_b32 s57, s57, 1
    v_mfma_f32_16x16x32_bf16 v[28:31], a[188:191], v[204:207], v[28:31]
    s_lshl_b32 s57, s57, 8
    ds_read_b64_tr_b16 a[214:215], v9 offset:63488
    s_add_u32 s68, s56, s57
    v_mfma_f32_16x16x32_bf16 v[28:31], a[184:187], v[200:203], v[28:31]
    s_waitcnt lgkmcnt(4)
    v_add_u32 v9, 65536, v9
    v_mfma_f32_16x16x32_bf16 v[32:35], a[184:187], v[208:211], v[32:35]
    buffer_load_dwordx4 v7, s[8:11], s38 offen lds
    v_mfma_f32_16x16x32_bf16 v[32:35], a[188:191], v[212:215], v[32:35]
    s_add_u32 s56, s7, 5
    v_mov_b32 v4, s56
    v_mfma_f32_16x16x32_bf16 v[36:39], a[188:191], v[220:223], v[36:39]
    v_mfma_f32_16x16x32_bf16 v[36:39], a[184:187], v[216:219], v[36:39]
    s_add_u32 s38, s46, 0
    ds_read_b64_tr_b16 a[184:185], v10 offset:0
    v_mfma_f32_16x16x32_bf16 v[36:39], a[192:195], v[248:251], v[36:39]
    ds_read_b64_tr_b16 a[186:187], v10 offset:2048
    v_mfma_f32_16x16x32_bf16 v[36:39], a[196:199], v[252:255], v[36:39]
    s_addk_i32 m0, -16384
    ds_read_b64_tr_b16 a[188:189], v10 offset:4096
    v_mfma_f32_16x16x32_bf16 v[32:35], a[196:199], v[244:247], v[32:35]
    ds_read_b64_tr_b16 a[190:191], v10 offset:6144
    v_mfma_f32_16x16x32_bf16 v[32:35], a[192:195], v[240:243], v[32:35]
    v_mfma_f32_16x16x32_bf16 v[28:31], a[192:195], v[232:235], v[28:31]
    v_mfma_f32_16x16x32_bf16 v[28:31], a[196:199], v[236:239], v[28:31]
    v_mfma_f32_16x16x32_bf16 v[24:27], a[196:199], v[228:231], v[24:27]
    v_mfma_f32_16x16x32_bf16 v[24:27], a[192:195], v[224:227], v[24:27]
    buffer_load_dwordx4 v2, s[8:11], s38 offen lds
    v_mfma_f32_16x16x32_bf16 v[24:27], a[200:203], v[56:59], v[24:27]
    ds_read_b64_tr_b16 a[192:193], v10 offset:8192
    v_mfma_f32_16x16x32_bf16 v[24:27], a[204:207], v[60:63], v[24:27]
    ds_read_b64_tr_b16 a[194:195], v10 offset:10240
    v_mfma_f32_16x16x32_bf16 v[28:31], a[204:207], v[68:71], v[28:31]
    ds_read_b64_tr_b16 a[196:197], v10 offset:12288
    v_mfma_f32_16x16x32_bf16 v[28:31], a[200:203], v[64:67], v[28:31]
    s_waitcnt lgkmcnt(3)
    ds_read_b64_tr_b16 a[198:199], v10 offset:14336
    s_add_u32 s38, s46, 0
    v_mfma_f32_16x16x32_bf16 v[32:35], a[200:203], v[72:75], v[32:35]
    v_mfma_f32_16x16x32_bf16 v[32:35], a[204:207], v[76:79], v[32:35]
    s_addk_i32 m0, 4096
    v_mfma_f32_16x16x32_bf16 v[36:39], a[204:207], v[84:87], v[36:39]
    v_mfma_f32_16x16x32_bf16 v[36:39], a[200:203], v[80:83], v[36:39]
    ds_read_b64_tr_b16 a[200:201], v10 offset:16384
    v_mfma_f32_16x16x32_bf16 v[36:39], a[208:211], v[112:115], v[36:39]
    ds_read_b64_tr_b16 a[202:203], v10 offset:18432
    v_mfma_f32_16x16x32_bf16 v[36:39], a[212:215], v[116:119], v[36:39]
    ds_read_b64_tr_b16 a[204:205], v10 offset:20480
    v_mfma_f32_16x16x32_bf16 v[32:35], a[212:215], v[108:111], v[32:35]
    ds_read_b64_tr_b16 a[206:207], v10 offset:22528
    v_mfma_f32_16x16x32_bf16 v[32:35], a[208:211], v[104:107], v[32:35]
    buffer_load_dwordx4 v3, s[8:11], s38 offen lds
    v_mfma_f32_16x16x32_bf16 v[28:31], a[208:211], v[96:99], v[28:31]
    v_mfma_f32_16x16x32_bf16 v[28:31], a[212:215], v[100:103], v[28:31]
    v_mfma_f32_16x16x32_bf16 v[24:27], a[212:215], v[92:95], v[24:27]
    v_mul_f32 v36, v19, v36
    v_mfma_f32_16x16x32_bf16 v[24:27], a[208:211], v[88:91], v[24:27]
    s_add_u32 s38, s47, 0
    ds_read_b64_tr_b16 a[208:209], v10 offset:24576
    v_mul_f32 v32, v18, v32
    v_mfma_f32_16x16x32_bf16 v[40:43], a[184:187], a[96:99], 0
    s_mul_i32 s57, s48, 10
    ds_read_b64_tr_b16 a[210:211], v10 offset:26624
    v_lshrrev_b32 v5, 5, v1
    v_mfma_f32_16x16x32_bf16 v[40:43], a[188:191], a[100:103], v[40:43]
    s_addk_i32 m0, 4096
    ds_read_b64_tr_b16 a[212:213], v10 offset:28672
    v_lshlrev_b32 v5, 3, v5
    v_mfma_f32_16x16x32_bf16 v[44:47], a[188:191], a[108:111], 0
    s_waitcnt lgkmcnt(3)
    ds_read_b64_tr_b16 a[214:215], v10 offset:30720
    v_bfe_u32 v22, v1, 3, 2
    v_mfma_f32_16x16x32_bf16 v[44:47], a[184:187], a[104:107], v[44:47]
    s_sub_u32 s57, s58, s57
    v_add_u32 v22, v22, v5
    v_mul_u32_u24 v22, 1280, v22
    v_mfma_f32_16x16x32_bf16 v[48:51], a[184:187], a[112:115], 0
    s_mul_i32 s62, s48, 1280
    v_lshrrev_b32 v5, 4, v1
    v_lshlrev_b32 v5, 1, v5
    v_mfma_f32_16x16x32_bf16 v[48:51], a[188:191], a[116:119], v[48:51]
    s_lshl_b32 s56, s57, 6
    v_and_b32 v23, 7, v1
    v_xor_b32 v23, v23, v5
    v_mfma_f32_16x16x32_bf16 v[52:55], a[188:191], a[124:127], 0
    s_add_u32 s62, s62, s56
    v_lshlrev_b32 v23, 4, v23
    v_add_u32 v22, v22, v23
    v_mfma_f32_16x16x32_bf16 v[52:55], a[184:187], a[120:123], v[52:55]
    buffer_load_dwordx4 v2, s[8:11], s38 offen lds
    v_mfma_f32_16x16x32_bf16 v[52:55], a[192:195], v[120:123], v[52:55]
    s_lshl_b32 s56, s3, 4
    ds_read_b64_tr_b16 a[184:185], v10 offset:32768
    v_add_u32 v23, 20480, v22
    v_mfma_f32_16x16x32_bf16 v[52:55], a[196:199], v[124:127], v[52:55]
    s_add_u32 s62, s62, s56
    ds_read_b64_tr_b16 a[186:187], v10 offset:34816
    v_mul_f32 v24, v16, v24
    v_mfma_f32_16x16x32_bf16 v[48:51], a[196:199], a[148:151], v[48:51]
    s_lshl_b32 s62, s62, 2
    ds_read_b64_tr_b16 a[188:189], v10 offset:36864
    v_mul_f32 v25, v16, v25
    v_mfma_f32_16x16x32_bf16 v[48:51], a[192:195], a[144:147], v[48:51]
    s_add_u32 s38, s47, 0
    ds_read_b64_tr_b16 a[190:191], v10 offset:38912
    v_mul_f32 v26, v16, v26
    v_mfma_f32_16x16x32_bf16 v[44:47], a[192:195], a[136:139], v[44:47]
pg_11:
    s_cbranch_execz pg_15
    s_add_u32 s62, s62, 3670016
    v_mul_f32 v27, v16, v27
    v_cvt_pk_bf16_f32 v24, v24, v25
    v_mfma_f32_16x16x32_bf16 v[44:47], a[196:199], a[140:143], v[44:47]
    s_addk_i32 m0, 4096
    v_cvt_pk_bf16_f32 v25, v26, v27
    v_accvgpr_write_b32 a66, v24
    v_mfma_f32_16x16x32_bf16 v[40:43], a[196:199], a[132:135], v[40:43]
    s_lshl_b32 s41, s48, 6
    v_accvgpr_write_b32 a67, v25
    v_mul_f32 v28, v17, v28
    v_mfma_f32_16x16x32_bf16 v[40:43], a[192:195], a[128:131], v[40:43]
    buffer_store_dwordx4 a[64:67], v14, s[20:23], s55 offen offset:0 sc1
    v_mul_f32 v29, v17, v29
    v_mfma_f32_16x16x32_bf16 v[40:43], a[200:203], v[128:131], v[40:43]
    s_lshr_b32 s56, s3, 1
    ds_read_b64_tr_b16 a[192:193], v10 offset:40960
    v_mul_f32 v30, v17, v30
    v_mfma_f32_16x16x32_bf16 v[40:43], a[204:207], v[132:135], v[40:43]
    s_lshl_b32 s56, s56, 5
    ds_read_b64_tr_b16 a[194:195], v10 offset:43008
    v_mul_f32 v31, v17, v31
    v_mfma_f32_16x16x32_bf16 v[44:47], a[204:207], v[140:143], v[44:47]
    s_add_u32 s41, s41, s56
    ds_read_b64_tr_b16 a[196:197], v10 offset:45056
    v_cvt_pk_bf16_f32 v28, v28, v29
    v_mfma_f32_16x16x32_bf16 v[44:47], a[200:203], v[136:139], v[44:47]
    s_waitcnt lgkmcnt(3)
    ds_read_b64_tr_b16 a[198:199], v10 offset:47104
    v_cvt_pk_bf16_f32 v29, v30, v31
    v_mfma_f32_16x16x32_bf16 v[48:51], a[200:203], v[144:147], v[48:51]
    buffer_load_dwordx4 v3, s[8:11], s38 offen lds
    v_mfma_f32_16x16x32_bf16 v[48:51], a[204:207], v[148:151], v[48:51]
    s_and_b32 s56, s3, 1
    v_accvgpr_write_b32 a70, v28
    v_accvgpr_write_b32 a71, v29
    v_mfma_f32_16x16x32_bf16 v[52:55], a[204:207], v[156:159], v[52:55]
    buffer_store_dwordx4 a[68:71], v14, s[20:23], s55 offen offset:1024 sc1
    v_mul_f32 v33, v18, v33
    v_mfma_f32_16x16x32_bf16 v[52:55], a[200:203], v[152:155], v[52:55]
    s_lshl_b32 s56, s56, 2
    ds_read_b64_tr_b16 a[200:201], v10 offset:49152
    v_mul_f32 v34, v18, v34
    v_mfma_f32_16x16x32_bf16 v[52:55], a[208:211], v[184:187], v[52:55]
    s_add_u32 s41, s41, s56
    ds_read_b64_tr_b16 a[202:203], v10 offset:51200
    v_mul_f32 v35, v18, v35
    v_mfma_f32_16x16x32_bf16 v[52:55], a[212:215], v[188:191], v[52:55]
    s_add_u32 s56, s3, 0
    ds_read_b64_tr_b16 a[204:205], v10 offset:53248
    v_cvt_pk_bf16_f32 v32, v32, v33
    v_mfma_f32_16x16x32_bf16 v[48:51], a[212:215], v[180:183], v[48:51]
    s_min_u32 s56, s56, 9
    ds_read_b64_tr_b16 a[206:207], v10 offset:55296
    v_cvt_pk_bf16_f32 v33, v34, v35
    v_mfma_f32_16x16x32_bf16 v[48:51], a[208:211], v[176:179], v[48:51]
    s_mul_i32 s38, s56, 24576
    v_accvgpr_write_b32 a74, v32
    v_accvgpr_write_b32 a75, v33
    v_mfma_f32_16x16x32_bf16 v[44:47], a[208:211], v[168:171], v[44:47]
    buffer_store_dwordx4 a[72:75], v14, s[20:23], s55 offen offset:2048 sc1
    v_mul_f32 v37, v19, v37
    v_mfma_f32_16x16x32_bf16 v[44:47], a[212:215], v[172:175], v[44:47]
    s_lshl_b32 s56, s56, 10
    v_mul_f32 v38, v19, v38
    v_mul_f32 v39, v19, v39
    v_mfma_f32_16x16x32_bf16 v[40:43], a[212:215], v[164:167], v[40:43]
    s_add_u32 m0, s56, 61440
    v_cvt_pk_bf16_f32 v36, v36, v37
    v_cvt_pk_bf16_f32 v37, v38, v39
    v_mfma_f32_16x16x32_bf16 v[40:43], a[208:211], v[160:163], v[40:43]
    s_mul_i32 s41, s41, 1280
    ds_read_b64_tr_b16 a[208:209], v10 offset:57344
    v_accvgpr_write_b32 a78, v36
    v_mfma_f32_16x16x32_bf16 v[40:43], a[184:187], v[192:195], v[40:43]
    s_lshl_b32 s57, s57, 7
    ds_read_b64_tr_b16 a[210:211], v10 offset:59392
    v_accvgpr_write_b32 a79, v37
    v_mfma_f32_16x16x32_bf16 v[40:43], a[188:191], v[196:199], v[40:43]
    buffer_store_dwordx4 a[76:79], v14, s[20:23], s55 offen offset:3072 sc1
    v_mfma_f32_16x16x32_bf16 v[44:47], a[188:191], v[204:207], v[44:47]
    s_add_u32 s56, s3, 4
    ds_read_b64_tr_b16 a[212:213], v10 offset:61440
    s_min_u32 s56, s56, 9
    v_mfma_f32_16x16x32_bf16 v[44:47], a[184:187], v[200:203], v[44:47]
    s_waitcnt lgkmcnt(3)
    ds_read_b64_tr_b16 a[214:215], v10 offset:63488
    s_add_u32 s55, s55, 4096
    v_mfma_f32_16x16x32_bf16 v[48:51], a[184:187], v[208:211], v[48:51]
    s_add_u32 s41, s41, s57
    v_add_u32 v10, 65536, v10
    s_lshl_b32 s57, s48, 10
    v_mfma_f32_16x16x32_bf16 v[48:51], a[188:191], v[212:215], v[48:51]
    s_add_u32 s38, s38, s57
    s_add_u32 s38, s38, 3276800
    s_lshl_b32 s57, s48, 10
    v_mfma_f32_16x16x32_bf16 v[52:55], a[188:191], v[220:223], v[52:55]
    buffer_load_dwordx4 v14, s[24:27], s38 offen sc1 lds
    v_mfma_f32_16x16x32_bf16 v[52:55], a[184:187], v[216:219], v[52:55]
    s_mul_i32 s38, s56, 24576
    ds_read_b64_tr_b16 a[184:185], v11 offset:0
    s_add_u32 s38, s38, s57
    v_mfma_f32_16x16x32_bf16 v[52:55], a[192:195], v[248:251], v[52:55]
    s_add_u32 s38, s38, 3276800
    ds_read_b64_tr_b16 a[186:187], v11 offset:2048
    s_lshl_b32 s56, s56, 10
    v_mfma_f32_16x16x32_bf16 v[52:55], a[196:199], v[252:255], v[52:55]
    s_add_u32 m0, s56, 61440
    ds_read_b64_tr_b16 a[188:189], v11 offset:4096
    s_lshl_b32 s43, s3, 11
    v_mfma_f32_16x16x32_bf16 v[48:51], a[196:199], v[244:247], v[48:51]
    buffer_load_dwordx4 v14, s[24:27], s38 offen sc1 lds
    v_mfma_f32_16x16x32_bf16 v[48:51], a[192:195], v[240:243], v[48:51]
    s_add_u32 s56, s3, 8
    ds_read_b64_tr_b16 a[190:191], v11 offset:6144
    s_min_u32 s56, s56, 9
    v_mfma_f32_16x16x32_bf16 v[44:47], a[192:195], v[232:235], v[44:47]
    s_mul_i32 s38, s56, 24576
    s_lshl_b32 s57, s48, 10
    s_add_u32 s38, s38, s57
    v_mfma_f32_16x16x32_bf16 v[44:47], a[196:199], v[236:239], v[44:47]
    s_add_u32 s38, s38, 3276800
    s_lshl_b32 s56, s56, 10
    s_add_u32 m0, s56, 61440
    v_mfma_f32_16x16x32_bf16 v[40:43], a[196:199], v[228:231], v[40:43]
    s_add_u32 s56, s7, 6
    v_lshrrev_b32 v12, 2, v1
    v_mfma_f32_16x16x32_bf16 v[40:43], a[192:195], v[224:227], v[40:43]
    ds_read_b64_tr_b16 a[192:193], v11 offset:8192
    v_mfma_f32_16x16x32_bf16 v[40:43], a[200:203], v[56:59], v[40:43]
    s_load_dwordx4 s[72:75], s[86:87], s5 glc
    ds_read_b64_tr_b16 a[194:195], v11 offset:10240
    v_mfma_f32_16x16x32_bf16 v[40:43], a[204:207], v[60:63], v[40:43]
    ds_read_b64_tr_b16 a[196:197], v11 offset:12288
    v_mfma_f32_16x16x32_bf16 v[44:47], a[204:207], v[68:71], v[44:47]
    s_waitcnt lgkmcnt(5)
    ds_read_b64_tr_b16 a[198:199], v11 offset:14336
    v_mfma_f32_16x16x32_bf16 v[44:47], a[200:203], v[64:67], v[44:47]
    buffer_load_dwordx4 v14, s[24:27], s38 offen sc1 lds
    v_mfma_f32_16x16x32_bf16 v[48:51], a[200:203], v[72:75], v[48:51]
    v_lshlrev_b32 v12, 6, v12
    v_mfma_f32_16x16x32_bf16 v[48:51], a[204:207], v[76:79], v[48:51]
    v_and_b32 v21, 3, v1
    v_mfma_f32_16x16x32_bf16 v[52:55], a[204:207], v[84:87], v[52:55]
    v_lshl_add_u32 v12, v21, 3, v12
    v_mfma_f32_16x16x32_bf16 v[52:55], a[200:203], v[80:83], v[52:55]
    ds_read_b64_tr_b16 a[200:201], v11 offset:16384
    v_mfma_f32_16x16x32_bf16 v[52:55], a[208:211], v[112:115], v[52:55]
    ds_read_b64_tr_b16 a[202:203], v11 offset:18432
    v_mfma_f32_16x16x32_bf16 v[52:55], a[212:215], v[116:119], v[52:55]
    ds_read_b64_tr_b16 a[204:205], v11 offset:20480
    v_mfma_f32_16x16x32_bf16 v[48:51], a[212:215], v[108:111], v[48:51]
    ds_read_b64_tr_b16 a[206:207], v11 offset:22528
    v_mfma_f32_16x16x32_bf16 v[48:51], a[208:211], v[104:107], v[48:51]
    v_and_b32 v21, 16, v1
    v_mfma_f32_16x16x32_bf16 v[44:47], a[208:211], v[96:99], v[44:47]
    v_lshl_add_u32 v12, v21, 1, v12
    v_mfma_f32_16x16x32_bf16 v[44:47], a[212:215], v[100:103], v[44:47]
    v_mul_f32 v52, v19, v52
    v_mfma_f32_16x16x32_bf16 v[40:43], a[212:215], v[92:95], v[40:43]
    s_waitcnt lgkmcnt(5)
    v_mul_f32 v53, v19, v53
    v_mul_f32 v48, v18, v48
    v_mfma_f32_16x16x32_bf16 v[40:43], a[208:211], v[88:91], v[40:43]
    s_add_u32 s37, s60, 4096
    ds_read_b64_tr_b16 a[208:209], v11 offset:24576
    v_mul_f32 v44, v17, v44
    v_mfma_f32_16x16x32_bf16 v[24:27], a[184:187], a[96:99], 0
    ds_read_b64_tr_b16 a[210:211], v11 offset:26624
    v_mul_f32 v45, v17, v45
    v_mfma_f32_16x16x32_bf16 v[24:27], a[188:191], a[100:103], v[24:27]
    ds_read_b64_tr_b16 a[212:213], v11 offset:28672
    v_mul_f32 v40, v16, v40
    v_mfma_f32_16x16x32_bf16 v[28:31], a[188:191], a[108:111], 0
    ds_read_b64_tr_b16 a[214:215], v11 offset:30720
    v_mul_f32 v41, v16, v41
    v_mfma_f32_16x16x32_bf16 v[28:31], a[184:187], a[104:107], v[28:31]
    v_mul_f32 v42, v16, v42
    v_mul_f32 v43, v16, v43
    v_mfma_f32_16x16x32_bf16 v[32:35], a[184:187], a[112:115], 0
    buffer_load_dwordx4 a[96:99], v14, s[20:23], s37 offen offset:0 sc1
    v_mfma_f32_16x16x32_bf16 v[32:35], a[188:191], a[116:119], v[32:35]
    v_cvt_pk_bf16_f32 v40, v40, v41
    v_cvt_pk_bf16_f32 v41, v42, v43
    v_mfma_f32_16x16x32_bf16 v[36:39], a[188:191], a[124:127], 0
    s_waitcnt lgkmcnt(5)
    v_accvgpr_write_b32 a80, v40
    v_accvgpr_write_b32 a81, v41
    v_mfma_f32_16x16x32_bf16 v[36:39], a[184:187], a[120:123], v[36:39]
    ds_read_b64_tr_b16 a[184:185], v11 offset:32768
    v_mul_f32 v46, v17, v46
    v_mfma_f32_16x16x32_bf16 v[36:39], a[192:195], v[120:123], v[36:39]
    ds_read_b64_tr_b16 a[186:187], v11 offset:34816
    v_mul_f32 v47, v17, v47
    v_mfma_f32_16x16x32_bf16 v[36:39], a[196:199], v[124:127], v[36:39]
    ds_read_b64_tr_b16 a[188:189], v11 offset:36864
    v_cvt_pk_bf16_f32 v44, v44, v45
    v_mfma_f32_16x16x32_bf16 v[32:35], a[196:199], a[148:151], v[32:35]
    ds_read_b64_tr_b16 a[190:191], v11 offset:38912
    v_cvt_pk_bf16_f32 v45, v46, v47
    v_mfma_f32_16x16x32_bf16 v[32:35], a[192:195], a[144:147], v[32:35]
    v_accvgpr_write_b32 a84, v44
    v_accvgpr_write_b32 a85, v45
    v_mfma_f32_16x16x32_bf16 v[28:31], a[192:195], a[136:139], v[28:31]
    v_mul_f32 v49, v18, v49
    v_mul_f32 v50, v18, v50
    v_mfma_f32_16x16x32_bf16 v[28:31], a[196:199], a[140:143], v[28:31]
    v_mul_f32 v51, v18, v51
    v_cvt_pk_bf16_f32 v48, v48, v49
    v_mfma_f32_16x16x32_bf16 v[24:27], a[196:199], a[132:135], v[24:27]
    buffer_load_dwordx4 a[100:103], v14, s[20:23], s37 offen offset:1024 sc1
    v_mfma_f32_16x16x32_bf16 v[24:27], a[192:195], a[128:131], v[24:27]
    s_waitcnt lgkmcnt(4)
    ds_read_b64_tr_b16 a[192:193], v11 offset:40960
    v_cvt_pk_bf16_f32 v49, v50, v51
    v_mfma_f32_16x16x32_bf16 v[24:27], a[200:203], v[128:131], v[24:27]
    ds_read_b64_tr_b16 a[194:195], v11 offset:43008
    v_accvgpr_write_b32 a88, v48
    v_mfma_f32_16x16x32_bf16 v[24:27], a[204:207], v[132:135], v[24:27]
    ds_read_b64_tr_b16 a[196:197], v11 offset:45056
    v_accvgpr_write_b32 a89, v49
    v_mfma_f32_16x16x32_bf16 v[28:31], a[204:207], v[140:143], v[28:31]
    ds_read_b64_tr_b16 a[198:199], v11 offset:47104
    v_mfma_f32_16x16x32_bf16 v[28:31], a[200:203], v[136:139], v[28:31]
    v_mul_f32 v54, v19, v54
    v_mfma_f32_16x16x32_bf16 v[32:35], a[200:203], v[144:147], v[32:35]
    v_mul_f32 v55, v19, v55
    v_cvt_pk_bf16_f32 v52, v52, v53
    v_mfma_f32_16x16x32_bf16 v[32:35], a[204:207], v[148:151], v[32:35]
    v_cvt_pk_bf16_f32 v53, v54, v55
    v_accvgpr_write_b32 a92, v52
    v_mfma_f32_16x16x32_bf16 v[36:39], a[204:207], v[156:159], v[36:39]
    v_accvgpr_write_b32 a93, v53
    v_mfma_f32_16x16x32_bf16 v[36:39], a[200:203], v[152:155], v[36:39]
    ds_read_b64_tr_b16 a[200:201], v11 offset:49152
    v_mfma_f32_16x16x32_bf16 v[36:39], a[208:211], v[184:187], v[36:39]
    buffer_load_dwordx4 a[104:107], v14, s[20:23], s37 offen offset:2048 sc1
    v_mfma_f32_16x16x32_bf16 v[36:39], a[212:215], v[188:191], v[36:39]
    ds_read_b64_tr_b16 a[202:203], v11 offset:51200
    v_mfma_f32_16x16x32_bf16 v[32:35], a[212:215], v[180:183], v[32:35]
    ds_read_b64_tr_b16 a[204:205], v11 offset:53248
    v_mfma_f32_16x16x32_bf16 v[32:35], a[208:211], v[176:179], v[32:35]
    s_waitcnt lgkmcnt(5)
    ds_read_b64_tr_b16 a[206:207], v11 offset:55296
    v_mfma_f32_16x16x32_bf16 v[28:31], a[208:211], v[168:171], v[28:31]
    v_add_u32 v12, 98304, v12
    v_mfma_f32_16x16x32_bf16 v[28:31], a[212:215], v[172:175], v[28:31]
    s_waitcnt vmcnt(6)
    v_lshrrev_b32 v13, 2, v1
    v_mfma_f32_16x16x32_bf16 v[24:27], a[212:215], v[164:167], v[24:27]
    buffer_store_dword v4, v15, s[24:27], s76 offen sc1
    v_mfma_f32_16x16x32_bf16 v[24:27], a[208:211], v[160:163], v[24:27]
    ds_read_b64_tr_b16 a[208:209], v11 offset:57344
    v_mfma_f32_16x16x32_bf16 v[24:27], a[184:187], v[192:195], v[24:27]
    ds_read_b64_tr_b16 a[210:211], v11 offset:59392
    v_mfma_f32_16x16x32_bf16 v[24:27], a[188:191], v[196:199], v[24:27]
    ds_read_b64_tr_b16 a[212:213], v11 offset:61440
    v_mfma_f32_16x16x32_bf16 v[28:31], a[188:191], v[204:207], v[28:31]
    buffer_load_dwordx4 a[108:111], v14, s[20:23], s37 offen offset:3072 sc1
    v_mfma_f32_16x16x32_bf16 v[28:31], a[184:187], v[200:203], v[28:31]
    ds_read_b64_tr_b16 a[214:215], v11 offset:63488
    v_mfma_f32_16x16x32_bf16 v[32:35], a[184:187], v[208:211], v[32:35]
    v_lshlrev_b32 v13, 6, v13
    v_mfma_f32_16x16x32_bf16 v[32:35], a[188:191], v[212:215], v[32:35]
    v_and_b32 v21, 3, v1
    v_mfma_f32_16x16x32_bf16 v[36:39], a[188:191], v[220:223], v[36:39]
    s_waitcnt lgkmcnt(3)
    v_lshl_add_u32 v13, v21, 3, v13
    s_add_u32 s37, s61, 4096
    v_mfma_f32_16x16x32_bf16 v[36:39], a[184:187], v[216:219], v[36:39]
    v_and_b32 v21, 16, v1
    v_mfma_f32_16x16x32_bf16 v[36:39], a[192:195], v[248:251], v[36:39]
    v_lshl_add_u32 v13, v21, 1, v13
    v_mfma_f32_16x16x32_bf16 v[36:39], a[196:199], v[252:255], v[36:39]
    s_waitcnt lgkmcnt(0)
    v_xor_b32 v13, 32, v13
    v_mfma_f32_16x16x32_bf16 v[32:35], a[196:199], v[244:247], v[32:35]
    s_barrier
    v_mfma_f32_16x16x32_bf16 v[32:35], a[192:195], v[240:243], v[32:35]
    ds_read_b64_tr_b16 a[184:185], v12 offset:57344
    v_mfma_f32_16x16x32_bf16 v[28:31], a[192:195], v[232:235], v[28:31]
    buffer_load_dwordx4 a[112:115], v14, s[20:23], s37 offen offset:0 sc1
    v_mfma_f32_16x16x32_bf16 v[28:31], a[196:199], v[236:239], v[28:31]
    ds_read_b64_tr_b16 a[186:187], v12 offset:58368
    v_mfma_f32_16x16x32_bf16 v[24:27], a[196:199], v[228:231], v[24:27]
    ds_read_b64_tr_b16 a[188:189], v12 offset:59392
    v_add_u32 v13, 98304, v13
    v_mfma_f32_16x16x32_bf16 v[24:27], a[192:195], v[224:227], v[24:27]
    ds_read_b64_tr_b16 a[190:191], v12 offset:60416
    v_mfma_f32_16x16x32_bf16 v[24:27], a[200:203], v[56:59], v[24:27]
    ds_read_b64_tr_b16 a[192:193], v13 offset:57344
    v_mfma_f32_16x16x32_bf16 v[24:27], a[204:207], v[60:63], v[24:27]
    ds_read_b64_tr_b16 a[194:195], v13 offset:58368
    v_mfma_f32_16x16x32_bf16 v[28:31], a[204:207], v[68:71], v[28:31]
    ds_read_b64_tr_b16 a[196:197], v13 offset:59392
    v_mfma_f32_16x16x32_bf16 v[28:31], a[200:203], v[64:67], v[28:31]
    ds_read_b64_tr_b16 a[198:199], v13 offset:60416
    v_mfma_f32_16x16x32_bf16 v[32:35], a[200:203], v[72:75], v[32:35]
    v_mov_b32 v55, s56
    v_mfma_f32_16x16x32_bf16 v[32:35], a[204:207], v[76:79], v[32:35]
    s_lshl_b32 s56, s3, 8
    v_add_u32 v11, 65536, v11
    v_mfma_f32_16x16x32_bf16 v[36:39], a[204:207], v[84:87], v[36:39]
    buffer_load_dwordx4 a[116:119], v14, s[20:23], s37 offen offset:1024 sc1
    v_mfma_f32_16x16x32_bf16 v[36:39], a[200:203], v[80:83], v[36:39]
    s_add_u32 s77, s7, 3
    ds_read_b64_tr_b16 a[200:201], v8 offset:0
    v_mfma_f32_16x16x32_bf16 v[36:39], a[208:211], v[112:115], v[36:39]
    s_add_u32 s56, s56, 71680
    ds_read_b64_tr_b16 a[202:203], v8 offset:2048
    v_mfma_f32_16x16x32_bf16 v[36:39], a[212:215], v[116:119], v[36:39]
    ds_read_b64_tr_b16 a[204:205], v8 offset:8192
    v_mfma_f32_16x16x32_bf16 v[32:35], a[212:215], v[108:111], v[32:35]
    s_waitcnt lgkmcnt(3)
    ds_read_b64_tr_b16 a[206:207], v8 offset:10240
    v_mfma_f32_16x16x32_bf16 v[32:35], a[208:211], v[104:107], v[32:35]
    v_subrev_u32 v12, 81920, v12
    v_mfma_f32_16x16x32_bf16 v[28:31], a[208:211], v[96:99], v[28:31]
    v_subrev_u32 v13, 81920, v13
    v_mfma_f32_16x16x32_bf16 v[28:31], a[212:215], v[100:103], v[28:31]
    v_mul_f32 v36, v19, v36
    v_mfma_f32_16x16x32_bf16 v[24:27], a[212:215], v[92:95], v[24:27]
    v_mul_f32 v37, v19, v37
    v_mfma_f32_16x16x32_bf16 v[24:27], a[208:211], v[88:91], v[24:27]
    ds_read_b64_tr_b16 a[208:209], v9 offset:0
    v_mul_f32 v32, v18, v32
    v_mfma_f32_16x16x32_bf16 v[96:99], a[184:187], a[0:3], 0
    buffer_load_dwordx4 a[120:123], v14, s[20:23], s37 offen offset:2048 sc1
    v_mfma_f32_16x16x32_bf16 v[96:99], a[188:191], a[16:19], v[96:99]
    ds_read_b64_tr_b16 a[210:211], v9 offset:2048
    v_mul_f32 v28, v17, v28
    v_mfma_f32_16x16x32_bf16 v[104:107], a[188:191], a[20:23], 0
    ds_read_b64_tr_b16 a[212:213], v9 offset:8192
    v_mul_f32 v24, v16, v24
    v_mfma_f32_16x16x32_bf16 v[104:107], a[184:187], a[4:7], v[104:107]
    ds_read_b64_tr_b16 a[214:215], v9 offset:10240
    v_mul_f32 v25, v16, v25
    v_mfma_f32_16x16x32_bf16 v[112:115], a[184:187], a[8:11], 0
    v_mul_f32 v26, v16, v26
    v_mul_f32 v27, v16, v27
    v_mfma_f32_16x16x32_bf16 v[112:115], a[188:191], a[24:27], v[112:115]
    v_cvt_pk_bf16_f32 v24, v24, v25
    v_cvt_pk_bf16_f32 v25, v26, v27
    v_mfma_f32_16x16x32_bf16 v[120:123], a[188:191], a[28:31], 0
    v_accvgpr_write_b32 a82, v24
    v_accvgpr_write_b32 a83, v25
    v_mfma_f32_16x16x32_bf16 v[120:123], a[184:187], a[12:15], v[120:123]
    buffer_store_dwordx4 a[80:83], v14, s[20:23], s55 offen offset:0 sc1
    v_mul_f32 v29, v17, v29
    v_mfma_f32_16x16x32_bf16 v[124:127], a[192:195], a[12:15], 0
    ds_read_b64_tr_b16 a[184:185], v10 offset:0
    v_mul_f32 v30, v17, v30
    v_mfma_f32_16x16x32_bf16 v[124:127], a[196:199], a[28:31], v[124:127]
    ds_read_b64_tr_b16 a[186:187], v10 offset:2048
    v_mul_f32 v31, v17, v31
    v_mfma_f32_16x16x32_bf16 v[116:119], a[196:199], a[24:27], 0
    buffer_load_dwordx4 a[124:127], v14, s[20:23], s37 offen offset:3072 sc1
    v_mfma_f32_16x16x32_bf16 v[116:119], a[192:195], a[8:11], v[116:119]
    s_sub_u32 s78, s72, s77
    ds_read_b64_tr_b16 a[188:189], v10 offset:8192
    v_cvt_pk_bf16_f32 v28, v28, v29
    v_mfma_f32_16x16x32_bf16 v[108:111], a[192:195], a[4:7], 0
    s_waitcnt lgkmcnt(3)
    ds_read_b64_tr_b16 a[190:191], v10 offset:10240
    v_cvt_pk_bf16_f32 v29, v30, v31
    v_mfma_f32_16x16x32_bf16 v[108:111], a[196:199], a[20:23], v[108:111]
    s_sub_u32 s79, s73, s77
    v_accvgpr_write_b32 a86, v28
    v_accvgpr_write_b32 a87, v29
    v_mfma_f32_16x16x32_bf16 v[100:103], a[196:199], a[16:19], 0
    buffer_store_dwordx4 a[84:87], v14, s[20:23], s55 offen offset:1024 sc1
    v_mul_f32 v33, v18, v33
    v_mfma_f32_16x16x32_bf16 v[100:103], a[192:195], a[0:3], v[100:103]
    s_max_u32 s78, s78, s79
    ds_read_b64_tr_b16 a[192:193], v11 offset:0
    v_mul_f32 v34, v18, v34
    v_mfma_f32_16x16x32_bf16 v[128:131], a[200:203], a[0:3], 0
    s_sub_u32 s79, s74, s77
    ds_read_b64_tr_b16 a[194:195], v11 offset:2048
    v_mul_f32 v35, v18, v35
    v_mfma_f32_16x16x32_bf16 v[128:131], a[204:207], a[16:19], v[128:131]
    s_max_u32 s78, s78, s79
    ds_read_b64_tr_b16 a[196:197], v11 offset:8192
    v_cvt_pk_bf16_f32 v32, v32, v33
    v_mfma_f32_16x16x32_bf16 v[136:139], a[204:207], a[20:23], 0
    s_sub_u32 s79, s75, s77
    ds_read_b64_tr_b16 a[198:199], v11 offset:10240
    v_cvt_pk_bf16_f32 v33, v34, v35
    v_mfma_f32_16x16x32_bf16 v[136:139], a[200:203], a[4:7], v[136:139]
    s_max_u32 s78, s78, s79
    v_accvgpr_write_b32 a90, v32
    v_accvgpr_write_b32 a91, v33
    v_mfma_f32_16x16x32_bf16 v[144:147], a[200:203], a[8:11], 0
    buffer_store_dwordx4 a[88:91], v14, s[20:23], s55 offen offset:2048 sc1
    v_mul_f32 v38, v19, v38
    v_mfma_f32_16x16x32_bf16 v[144:147], a[204:207], a[24:27], v[144:147]
    s_cmp_gt_u32 s78, 3
    s_cbranch_scc1 spin_o2
spin_o2_ret:
    v_mul_f32 v39, v19, v39
    v_mfma_f32_16x16x32_bf16 v[152:155], a[204:207], a[28:31], 0
    s_add_u32 s37, s59, 8192
    v_cvt_pk_bf16_f32 v36, v36, v37
    v_cvt_pk_bf16_f32 v37, v38, v39
    v_mfma_f32_16x16x32_bf16 v[152:155], a[200:203], a[12:15], v[152:155]
    buffer_load_dwordx4 a[128:131], v14, s[20:23], s37 offen offset:0 sc1
    v_mfma_f32_16x16x32_bf16 v[156:159], a[208:211], a[12:15], 0
    ds_read_b64_tr_b16 a[200:201], v8 offset:4096
    v_accvgpr_write_b32 a94, v36
    v_mfma_f32_16x16x32_bf16 v[156:159], a[212:215], a[28:31], v[156:159]
    ds_read_b64_tr_b16 a[202:203], v8 offset:6144
    v_accvgpr_write_b32 a95, v37
    v_mfma_f32_16x16x32_bf16 v[148:151], a[212:215], a[24:27], 0
    buffer_store_dwordx4 a[92:95], v14, s[20:23], s55 offen offset:3072 sc1
    v_mfma_f32_16x16x32_bf16 v[148:151], a[208:211], a[8:11], v[148:151]
    s_add_u32 s55, s55, 4096
    ds_read_b64_tr_b16 a[204:205], v8 offset:12288
    v_mfma_f32_16x16x32_bf16 v[140:143], a[208:211], a[4:7], 0
    s_waitcnt lgkmcnt(3)
    ds_read_b64_tr_b16 a[206:207], v8 offset:14336
    v_mfma_f32_16x16x32_bf16 v[140:143], a[212:215], a[20:23], v[140:143]
    v_subrev_u32 v8, 139264, v8
    v_mfma_f32_16x16x32_bf16 v[132:135], a[212:215], a[16:19], 0
    buffer_load_dwordx4 a[132:135], v14, s[20:23], s37 offen offset:1024 sc1
    v_mfma_f32_16x16x32_bf16 v[132:135], a[208:211], a[0:3], v[132:135]
    ds_read_b64_tr_b16 a[208:209], v9 offset:4096
    v_mfma_f32_16x16x32_bf16 v[160:163], a[184:187], a[0:3], 0
    ds_read_b64_tr_b16 a[210:211], v9 offset:6144
    v_mfma_f32_16x16x32_bf16 v[160:163], a[188:191], a[16:19], v[160:163]
    ds_read_b64_tr_b16 a[212:213], v9 offset:12288
    v_mfma_f32_16x16x32_bf16 v[168:171], a[188:191], a[20:23], 0
    ds_read_b64_tr_b16 a[214:215], v9 offset:14336
    v_mfma_f32_16x16x32_bf16 v[168:171], a[184:187], a[4:7], v[168:171]
    v_subrev_u32 v9, 139264, v9
    v_mfma_f32_16x16x32_bf16 v[176:179], a[184:187], a[8:11], 0
    v_mfma_f32_16x16x32_bf16 v[176:179], a[188:191], a[24:27], v[176:179]
    v_mfma_f32_16x16x32_bf16 v[184:187], a[188:191], a[28:31], 0
    v_mfma_f32_16x16x32_bf16 v[184:187], a[184:187], a[12:15], v[184:187]
    ds_read_b64_tr_b16 a[184:185], v10 offset:4096
    v_mfma_f32_16x16x32_bf16 v[188:191], a[192:195], a[12:15], 0
    buffer_load_dwordx4 a[136:139], v14, s[20:23], s37 offen offset:2048 sc1
    v_mfma_f32_16x16x32_bf16 v[188:191], a[196:199], a[28:31], v[188:191]
    ds_read_b64_tr_b16 a[186:187], v10 offset:6144
    v_mfma_f32_16x16x32_bf16 v[180:183], a[196:199], a[24:27], 0
    ds_read_b64_tr_b16 a[188:189], v10 offset:12288
    v_mfma_f32_16x16x32_bf16 v[180:183], a[192:195], a[8:11], v[180:183]
    s_waitcnt lgkmcnt(3)
    ds_read_b64_tr_b16 a[190:191], v10 offset:14336
    v_mfma_f32_16x16x32_bf16 v[172:175], a[192:195], a[4:7], 0
    s_add_u32 m0, s43, 114688
    v_subrev_u32 v10, 139264, v10
    v_mfma_f32_16x16x32_bf16 v[172:175], a[196:199], a[20:23], v[172:175]
    v_mfma_f32_16x16x32_bf16 v[164:167], a[196:199], a[16:19], 0
    v_mfma_f32_16x16x32_bf16 v[164:167], a[192:195], a[0:3], v[164:167]
    ds_read_b64_tr_b16 a[192:193], v11 offset:4096
    v_mfma_f32_16x16x32_bf16 v[192:195], a[200:203], a[0:3], 0
    ds_read_b64_tr_b16 a[194:195], v11 offset:6144
    v_mfma_f32_16x16x32_bf16 v[192:195], a[204:207], a[16:19], v[192:195]
    ds_read_b64_tr_b16 a[196:197], v11 offset:12288
    v_mfma_f32_16x16x32_bf16 v[200:203], a[204:207], a[20:23], 0
    buffer_load_dwordx4 a[140:143], v14, s[20:23], s37 offen offset:3072 sc1
    v_mfma_f32_16x16x32_bf16 v[200:203], a[200:203], a[4:7], v[200:203]
    ds_read_b64_tr_b16 a[198:199], v11 offset:14336
    v_mfma_f32_16x16x32_bf16 v[208:211], a[200:203], a[8:11], 0
    buffer_load_dwordx4 v22, s[28:31], s41 offen lds
    v_mfma_f32_16x16x32_bf16 v[208:211], a[204:207], a[24:27], v[208:211]
    v_subrev_u32 v11, 139264, v11
    v_mfma_f32_16x16x32_bf16 v[216:219], a[204:207], a[28:31], 0
    v_add_u32 v21, 61440, v14
    v_mfma_f32_16x16x32_bf16 v[216:219], a[200:203], a[12:15], v[216:219]
    v_mfma_f32_16x16x32_bf16 v[220:223], a[208:211], a[12:15], 0
    s_addk_i32 m0, 1024
    v_mfma_f32_16x16x32_bf16 v[220:223], a[212:215], a[28:31], v[220:223]
    s_waitcnt vmcnt(18) lgkmcnt(0)
    v_mfma_f32_16x16x32_bf16 v[212:215], a[212:215], a[24:27], 0
    s_barrier
    v_mfma_f32_16x16x32_bf16 v[212:215], a[208:211], a[8:11], v[212:215]
    ds_read_b64_tr_b16 a[200:201], v12 offset:0
    v_mfma_f32_16x16x32_bf16 v[204:207], a[208:211], a[4:7], 0
    ds_read_b64_tr_b16 a[202:203], v12 offset:1024
    v_mfma_f32_16x16x32_bf16 v[204:207], a[212:215], a[20:23], v[204:207]
    ds_read_b64_tr_b16 a[204:205], v12 offset:2048
    v_mfma_f32_16x16x32_bf16 v[196:199], a[212:215], a[16:19], 0
    buffer_load_dwordx4 v23, s[28:31], s41 offen lds
    v_mfma_f32_16x16x32_bf16 v[196:199], a[208:211], a[0:3], v[196:199]
    s_mov_b64 s[28:29], 0
    ds_read_b64_tr_b16 a[206:207], v12 offset:3072
    v_mfma_f32_16x16x32_bf16 v[224:227], a[184:187], a[0:3], 0
    s_mov_b64 s[30:31], 0
    ds_read_b64_tr_b16 a[208:209], v13 offset:0
    v_mfma_f32_16x16x32_bf16 v[224:227], a[188:191], a[16:19], v[224:227]
    s_mov_b64 s[32:33], 0
    ds_read_b64_tr_b16 a[210:211], v13 offset:1024
    v_mfma_f32_16x16x32_bf16 v[232:235], a[188:191], a[20:23], 0
    s_add_u32 s38, s45, 40960
    ds_read_b64_tr_b16 a[212:213], v13 offset:2048
    s_add_u32 s36, s44, 204800
    v_mfma_f32_16x16x32_bf16 v[232:235], a[184:187], a[4:7], v[232:235]
    s_cmp_lt_u32 s3, 2
    s_cselect_b32 s38, s38, s36
    v_mfma_f32_16x16x32_bf16 v[240:243], a[184:187], a[8:11], 0
    s_add_u32 m0, s63, 90112
    ds_read_b64_tr_b16 a[214:215], v13 offset:3072
    v_mfma_f32_16x16x32_bf16 v[240:243], a[188:191], a[24:27], v[240:243]
    s_mov_b64 s[34:35], 0
    ds_read_b128 v[56:59], v21 offset:0
    v_mfma_f32_16x16x32_bf16 v[248:251], a[188:191], a[28:31], 0
    ds_read_b128 v[60:63], v21 offset:1024
    v_mfma_f32_16x16x32_bf16 v[248:251], a[184:187], a[12:15], v[248:251]
    ds_read_b128 v[64:67], v21 offset:2048
    v_mfma_f32_16x16x32_bf16 v[252:255], a[192:195], a[12:15], 0
    s_waitcnt lgkmcnt(5)
    ds_read_b64_tr_b16 a[184:185], v8 offset:0
    s_load_dwordx4 s[72:75], s[86:87], s5 glc
    v_mfma_f32_16x16x32_bf16 v[252:255], a[196:199], a[28:31], v[252:255]
    ds_read_b64_tr_b16 a[186:187], v8 offset:2048
    v_mfma_f32_16x16x32_bf16 v[244:247], a[196:199], a[24:27], 0
    buffer_load_dwordx4 v7, s[8:11], s38 offen lds
    v_mfma_f32_16x16x32_bf16 v[244:247], a[192:195], a[8:11], v[244:247]
    s_add_u32 s37, s60, 8192
    ds_read_b64_tr_b16 a[188:189], v8 offset:8192
    v_mfma_f32_16x16x32_bf16 v[236:239], a[192:195], a[4:7], 0
    ds_read_b64_tr_b16 a[190:191], v8 offset:10240
    v_mfma_f32_16x16x32_bf16 v[236:239], a[196:199], a[20:23], v[236:239]
    s_waitcnt lgkmcnt(5)
    ds_read_b128 v[68:71], v21 offset:3072
    v_add_f32 v56, v56, v60
    v_mfma_f32_16x16x32_bf16 v[228:231], a[196:199], a[16:19], 0
    s_add_u32 s38, s45, 40960
    ds_read_b128 v[72:75], v21 offset:4096
    v_add_f32 v57, v57, v61
    v_mfma_f32_16x16x32_bf16 v[228:231], a[192:195], a[0:3], v[228:231]
    s_waitcnt lgkmcnt(6)
    ds_read_b128 v[76:79], v21 offset:5120
    v_add_f32 v58, v58, v62
    v_mfma_f32_16x16x32_bf16 v[96:99], a[200:203], a[32:35], v[96:99]
    buffer_load_dwordx4 a[0:3], v14, s[20:23], s37 offen offset:0 sc1
    v_mfma_f32_16x16x32_bf16 v[96:99], a[204:207], a[48:51], v[96:99]
    s_add_u32 m0, s63, 73728
    ds_read_b64_tr_b16 a[192:193], v9 offset:0
    v_add_f32 v59, v59, v63
    v_mfma_f32_16x16x32_bf16 v[104:107], a[204:207], a[52:55], v[104:107]
    ds_read_b64_tr_b16 a[194:195], v9 offset:2048
    v_add_f32 v56, v56, v64
    v_mfma_f32_16x16x32_bf16 v[104:107], a[200:203], a[36:39], v[104:107]
    ds_read_b64_tr_b16 a[196:197], v9 offset:8192
    v_add_f32 v57, v57, v65
    v_mfma_f32_16x16x32_bf16 v[112:115], a[200:203], a[40:43], v[112:115]
    s_waitcnt lgkmcnt(5)
    ds_read_b64_tr_b16 a[198:199], v9 offset:10240
    v_add_f32 v58, v58, v66
    v_mfma_f32_16x16x32_bf16 v[112:115], a[204:207], a[56:59], v[112:115]
    ds_read_b128 v[80:83], v21 offset:6144
    v_add_f32 v59, v59, v67
    v_mfma_f32_16x16x32_bf16 v[120:123], a[204:207], a[60:63], v[120:123]
    buffer_load_dwordx4 v2, s[8:11], s38 offen lds
    v_mfma_f32_16x16x32_bf16 v[120:123], a[200:203], a[44:47], v[120:123]
    s_waitcnt vmcnt(8)
    ds_read_b128 v[84:87], v21 offset:7168
    v_add_f32 v56, v56, v68
    v_mfma_f32_16x16x32_bf16 v[124:127], a[208:211], a[44:47], v[124:127]
    buffer_store_dword v55, v15, s[24:27], s76 offen sc1
    v_mfma_f32_16x16x32_bf16 v[124:127], a[212:215], a[60:63], v[124:127]
    s_waitcnt lgkmcnt(6)
    ds_read_b64_tr_b16 a[200:201], v10 offset:0
    v_add_f32 v57, v57, v69
    v_mfma_f32_16x16x32_bf16 v[116:119], a[212:215], a[56:59], v[116:119]
    buffer_load_dwordx4 a[4:7], v14, s[20:23], s37 offen offset:1024 sc1
    v_mfma_f32_16x16x32_bf16 v[116:119], a[208:211], a[40:43], v[116:119]
    s_add_u32 s38, s45, 40960
    ds_read_b64_tr_b16 a[202:203], v10 offset:2048
    v_add_f32 v58, v58, v70
    v_mfma_f32_16x16x32_bf16 v[108:111], a[208:211], a[36:39], v[108:111]
    s_addk_i32 m0, 4096
    ds_read_b64_tr_b16 a[204:205], v10 offset:8192
    v_add_f32 v59, v59, v71
    v_mfma_f32_16x16x32_bf16 v[108:111], a[212:215], a[52:55], v[108:111]
    ds_read_b64_tr_b16 a[206:207], v10 offset:10240
    v_add_f32 v56, v56, v72
    v_mfma_f32_16x16x32_bf16 v[100:103], a[212:215], a[48:51], v[100:103]
pg_12:
    s_cbranch_execz pg_back
    ds_read_b128 v[88:91], v21 offset:8192
    v_add_f32 v57, v57, v73
    v_mfma_f32_16x16x32_bf16 v[100:103], a[208:211], a[32:35], v[100:103]
    s_waitcnt lgkmcnt(7)
    ds_read_b128 v[92:95], v21 offset:9216
    v_add_f32 v58, v58, v74
    v_mfma_f32_16x16x32_bf16 v[128:131], a[184:187], a[32:35], v[128:131]
    ds_read_b64_tr_b16 a[208:209], v11 offset:0
    v_add_f32 v59, v59, v75
    v_mfma_f32_16x16x32_bf16 v[128:131], a[188:191], a[48:51], v[128:131]
    ds_read_b64_tr_b16 a[210:211], v11 offset:2048
    v_add_f32 v56, v56, v76
    v_mfma_f32_16x16x32_bf16 v[136:139], a[188:191], a[52:55], v[136:139]
    buffer_load_dwordx4 v3, s[8:11], s38 offen lds
    v_mfma_f32_16x16x32_bf16 v[136:139], a[184:187], a[36:39], v[136:139]
    s_waitcnt lgkmcnt(7)
    ds_read_b64_tr_b16 a[212:213], v11 offset:8192
    v_add_f32 v57, v57, v77
    v_mfma_f32_16x16x32_bf16 v[144:147], a[184:187], a[40:43], v[144:147]
    buffer_load_dwordx4 a[8:11], v14, s[20:23], s37 offen offset:2048 sc1
    v_mfma_f32_16x16x32_bf16 v[144:147], a[188:191], a[56:59], v[144:147]
    ds_read_b64_tr_b16 a[214:215], v11 offset:10240
    v_add_f32 v58, v58, v78
    v_mfma_f32_16x16x32_bf16 v[152:155], a[188:191], a[60:63], v[152:155]
    s_add_u32 s38, s44, 204800
    v_add_f32 v59, v59, v79
    v_add_f32 v56, v56, v80
    v_mfma_f32_16x16x32_bf16 v[152:155], a[184:187], a[44:47], v[152:155]
    ds_read_b64_tr_b16 a[184:185], v8 offset:4096
    v_add_f32 v57, v57, v81
    v_mfma_f32_16x16x32_bf16 v[156:159], a[192:195], a[44:47], v[156:159]
    s_addk_i32 m0, 4096
    ds_read_b64_tr_b16 a[186:187], v8 offset:6144
    v_add_f32 v58, v58, v82
    v_mfma_f32_16x16x32_bf16 v[156:159], a[196:199], a[60:63], v[156:159]
    s_waitcnt lgkmcnt(6)
    ds_read_b64_tr_b16 a[188:189], v8 offset:12288
    v_add_f32 v59, v59, v83
    v_mfma_f32_16x16x32_bf16 v[148:151], a[196:199], a[56:59], v[148:151]
    ds_read_b64_tr_b16 a[190:191], v8 offset:14336
    v_add_f32 v56, v56, v84
    v_mfma_f32_16x16x32_bf16 v[148:151], a[192:195], a[40:43], v[148:151]
    v_add_f32 v57, v57, v85
    v_add_f32 v58, v58, v86
    v_mfma_f32_16x16x32_bf16 v[140:143], a[192:195], a[36:39], v[140:143]
    v_add_f32 v59, v59, v87
    v_add_f32 v56, v56, v88
    v_mfma_f32_16x16x32_bf16 v[140:143], a[196:199], a[52:55], v[140:143]
    v_add_f32 v57, v57, v89
    v_add_f32 v58, v58, v90
    v_mfma_f32_16x16x32_bf16 v[132:135], a[196:199], a[48:51], v[132:135]
    buffer_load_dwordx4 a[12:15], v14, s[20:23], s37 offen offset:3072 sc1
    v_mfma_f32_16x16x32_bf16 v[132:135], a[192:195], a[32:35], v[132:135]
    buffer_load_dwordx4 v2, s[8:11], s38 offen lds
    v_mfma_f32_16x16x32_bf16 v[160:163], a[200:203], a[32:35], v[160:163]
    ds_read_b64_tr_b16 a[192:193], v9 offset:4096
    v_add_f32 v59, v59, v91
    v_mfma_f32_16x16x32_bf16 v[160:163], a[204:207], a[48:51], v[160:163]
    ds_read_b64_tr_b16 a[194:195], v9 offset:6144
    v_add_f32 v56, v56, v92
    v_mfma_f32_16x16x32_bf16 v[168:171], a[204:207], a[52:55], v[168:171]
    s_add_u32 s37, s61, 8192
    ds_read_b64_tr_b16 a[196:197], v9 offset:12288
    v_add_f32 v57, v57, v93
    v_mfma_f32_16x16x32_bf16 v[168:171], a[200:203], a[36:39], v[168:171]
    s_waitcnt lgkmcnt(5)
    ds_read_b64_tr_b16 a[198:199], v9 offset:14336
    v_add_f32 v58, v58, v94
    v_mfma_f32_16x16x32_bf16 v[176:179], a[200:203], a[40:43], v[176:179]
    s_add_u32 s38, s44, 204800
    v_add_f32 v59, v59, v95
    v_cvt_pk_bf16_f32 v56, v56, v56
    v_mfma_f32_16x16x32_bf16 v[176:179], a[204:207], a[56:59], v[176:179]
    s_addk_i32 m0, 4096
    v_and_b32 v56, 0xffff0000, v56
    v_cvt_pk_bf16_f32 v57, v57, v57
    v_mfma_f32_16x16x32_bf16 v[184:187], a[204:207], a[60:63], v[184:187]
    v_and_b32 v57, 0xffff0000, v57
    v_cvt_pk_bf16_f32 v58, v58, v58
    v_mfma_f32_16x16x32_bf16 v[184:187], a[200:203], a[44:47], v[184:187]
    ds_read_b64_tr_b16 a[200:201], v10 offset:4096
    v_and_b32 v58, 0xffff0000, v58
    v_mfma_f32_16x16x32_bf16 v[188:191], a[208:211], a[44:47], v[188:191]
    buffer_load_dwordx4 a[16:19], v14, s[20:23], s37 offen offset:0 sc1
    v_mfma_f32_16x16x32_bf16 v[188:191], a[212:215], a[60:63], v[188:191]
    ds_read_b64_tr_b16 a[202:203], v10 offset:6144
    v_cvt_pk_bf16_f32 v59, v59, v59
    v_mfma_f32_16x16x32_bf16 v[180:183], a[212:215], a[56:59], v[180:183]
    buffer_load_dwordx4 v3, s[8:11], s38 offen lds
    v_mfma_f32_16x16x32_bf16 v[180:183], a[208:211], a[40:43], v[180:183]
    ds_read_b64_tr_b16 a[204:205], v10 offset:12288
    v_and_b32 v59, 0xffff0000, v59
    v_mfma_f32_16x16x32_bf16 v[172:175], a[208:211], a[36:39], v[172:175]
    ds_read_b64_tr_b16 a[206:207], v10 offset:14336
    v_mul_f32 v60, s92, v56
    v_mfma_f32_16x16x32_bf16 v[172:175], a[212:215], a[52:55], v[172:175]
    v_exp_f32 v60, v60
    v_mfma_f32_16x16x32_bf16 v[164:167], a[212:215], a[48:51], v[164:167]
    s_waitcnt lgkmcnt(3)
    v_add_f32 v60, 1.0, v60
    v_mul_f32 v61, s92, v57
    v_mfma_f32_16x16x32_bf16 v[164:167], a[208:211], a[32:35], v[164:167]
    s_add_u32 s38, s46, 40960
    ds_read_b64_tr_b16 a[208:209], v11 offset:4096
    v_lshlrev_b32 v64, 1, v1
    v_mfma_f32_16x16x32_bf16 v[192:195], a[184:187], a[32:35], v[192:195]
    s_add_u32 s36, s47, 40960
    ds_read_b64_tr_b16 a[210:211], v11 offset:6144
    v_add_u32 v64, s56, v64
    v_mfma_f32_16x16x32_bf16 v[192:195], a[188:191], a[48:51], v[192:195]
    s_cmp_lt_u32 s3, 2
    s_cselect_b32 s38, s38, s36
    v_and_b32 v65, 1, v1
    v_mfma_f32_16x16x32_bf16 v[200:203], a[188:191], a[52:55], v[200:203]
    s_addk_i32 m0, 24576
    ds_read_b64_tr_b16 a[212:213], v11 offset:12288
    v_lshlrev_b32 v65, 7, v65
    v_mfma_f32_16x16x32_bf16 v[200:203], a[184:187], a[36:39], v[200:203]
    s_add_u32 s77, s7, 4
    ds_read_b64_tr_b16 a[214:215], v11 offset:14336
    v_lshrrev_b32 v67, 4, v1
    v_mfma_f32_16x16x32_bf16 v[208:211], a[184:187], a[40:43], v[208:211]
    buffer_load_dwordx4 a[20:23], v14, s[20:23], s37 offen offset:1024 sc1
    v_mfma_f32_16x16x32_bf16 v[208:211], a[188:191], a[56:59], v[208:211]
    v_rcp_f32 v60, v60
    v_mfma_f32_16x16x32_bf16 v[216:219], a[188:191], a[60:63], v[216:219]
    buffer_load_dwordx4 v7, s[8:11], s38 offen lds
    v_mfma_f32_16x16x32_bf16 v[216:219], a[184:187], a[44:47], v[216:219]
    v_exp_f32 v61, v61
    v_mfma_f32_16x16x32_bf16 v[220:223], a[192:195], a[44:47], v[220:223]
    v_mul_f32 v56, v56, v60
    v_cvt_pk_bf16_f32 v56, v56, v56
    v_mfma_f32_16x16x32_bf16 v[220:223], a[196:199], a[60:63], v[220:223]
    s_waitcnt lgkmcnt(0)
    v_and_b32 v56, 0xffff0000, v56
    v_mul_f32 v56, v56, v58
    v_mfma_f32_16x16x32_bf16 v[212:215], a[196:199], a[56:59], v[212:215]
    s_barrier
    v_mfma_f32_16x16x32_bf16 v[212:215], a[192:195], a[40:43], v[212:215]
    s_add_u32 s38, s46, 40960
    ds_read_b64_tr_b16 a[184:185], v12 offset:20480
    v_add_f32 v61, 1.0, v61
    v_mfma_f32_16x16x32_bf16 v[204:207], a[192:195], a[36:39], v[204:207]
    buffer_load_dwordx4 a[24:27], v14, s[20:23], s37 offen offset:2048 sc1
    v_mfma_f32_16x16x32_bf16 v[204:207], a[196:199], a[52:55], v[204:207]
    s_addk_i32 m0, -16384
    ds_read_b64_tr_b16 a[186:187], v12 offset:21504
    v_lshl_add_u32 v65, v67, 4, v65
    v_mfma_f32_16x16x32_bf16 v[196:199], a[196:199], a[48:51], v[196:199]
    ds_read_b64_tr_b16 a[188:189], v12 offset:22528
    v_add_u32 v65, s56, v65
    v_mfma_f32_16x16x32_bf16 v[196:199], a[192:195], a[32:35], v[196:199]
    ds_read_b64_tr_b16 a[190:191], v12 offset:23552
    v_bfe_u32 v67, v1, 2, 3
    v_mfma_f32_16x16x32_bf16 v[224:227], a[200:203], a[32:35], v[224:227]
    ds_read_b64_tr_b16 a[192:193], v13 offset:20480
    v_lshlrev_b32 v66, 7, v67
    v_mfma_f32_16x16x32_bf16 v[224:227], a[204:207], a[48:51], v[224:227]
    ds_read_b64_tr_b16 a[194:195], v13 offset:21504
    v_lshrrev_b32 v67, 1, v67
    v_mfma_f32_16x16x32_bf16 v[232:235], a[204:207], a[52:55], v[232:235]
    buffer_load_dwordx4 v2, s[8:11], s38 offen lds
    v_mfma_f32_16x16x32_bf16 v[232:235], a[200:203], a[36:39], v[232:235]
    ds_read_b64_tr_b16 a[196:197], v13 offset:22528
    v_xor_b32 v67, s3, v67
    v_mfma_f32_16x16x32_bf16 v[240:243], a[200:203], a[40:43], v[240:243]
    ds_read_b64_tr_b16 a[198:199], v13 offset:23552
    v_lshl_add_u32 v66, v67, 5, v66
    v_mfma_f32_16x16x32_bf16 v[240:243], a[204:207], a[56:59], v[240:243]
    v_rcp_f32 v61, v61
    v_mfma_f32_16x16x32_bf16 v[248:251], a[204:207], a[60:63], v[248:251]
    buffer_load_dwordx4 a[28:31], v14, s[20:23], s37 offen offset:3072 sc1
    v_mfma_f32_16x16x32_bf16 v[248:251], a[200:203], a[44:47], v[248:251]
    s_add_u32 s38, s46, 40960
    ds_read_b64_tr_b16 a[200:201], v8 offset:20480
    v_mul_f32 v57, v57, v61
    v_mfma_f32_16x16x32_bf16 v[252:255], a[208:211], a[44:47], v[252:255]
    s_addk_i32 m0, 4096
    ds_read_b64_tr_b16 a[202:203], v8 offset:22528
    v_cvt_pk_bf16_f32 v57, v57, v57
    v_mfma_f32_16x16x32_bf16 v[252:255], a[212:215], a[60:63], v[252:255]
    s_sub_u32 s78, s72, s77
    ds_read_b64_tr_b16 a[204:205], v8 offset:28672
    v_and_b32 v57, 0xffff0000, v57
    v_mfma_f32_16x16x32_bf16 v[244:247], a[212:215], a[56:59], v[244:247]
    s_waitcnt lgkmcnt(4)
    ds_read_b64_tr_b16 a[206:207], v8 offset:30720
    v_mul_f32 v57, v57, v59
    v_mfma_f32_16x16x32_bf16 v[244:247], a[208:211], a[40:43], v[244:247]
    s_sub_u32 s79, s73, s77
    v_cvt_pk_bf16_f32 v56, v56, v57
    v_and_b32 v67, 3, v1
    v_mfma_f32_16x16x32_bf16 v[236:239], a[208:211], a[36:39], v[236:239]
    ds_write_b16 v64, v56
    v_mfma_f32_16x16x32_bf16 v[236:239], a[212:215], a[52:55], v[236:239]
    ds_write_b16_d16_hi v64, v56 offset:128
    v_mfma_f32_16x16x32_bf16 v[228:231], a[212:215], a[48:51], v[228:231]
    buffer_load_dwordx4 v3, s[8:11], s38 offen lds
    v_mfma_f32_16x16x32_bf16 v[228:231], a[208:211], a[32:35], v[228:231]
    s_max_u32 s78, s78, s79
    ds_read_b128 v[68:71], v65
    v_lshl_add_u32 v66, v67, 3, v66
    v_mfma_f32_16x16x32_bf16 v[96:99], a[184:187], a[64:67], v[96:99]
    s_sub_u32 s79, s74, s77
    ds_read_b128 v[72:75], v65 offset:64
    v_lshrrev_b32 v67, 5, v1
    v_mfma_f32_16x16x32_bf16 v[96:99], a[188:191], a[216:219], v[96:99]
    s_max_u32 s78, s78, s79
    ds_read_b64_tr_b16 a[208:209], v9 offset:20480
    v_mul_u32_u24 v67, 1024, v67
    v_mfma_f32_16x16x32_bf16 v[104:107], a[188:191], a[220:223], v[104:107]
    s_sub_u32 s79, s75, s77
    ds_read_b64_tr_b16 a[210:211], v9 offset:22528
    v_add_u32 v66, v66, v67
    v_mfma_f32_16x16x32_bf16 v[104:107], a[184:187], a[68:71], v[104:107]
    s_waitcnt lgkmcnt(5)
    ds_read_b64_tr_b16 a[212:213], v9 offset:28672
    v_add_u32 v66, 114688, v66
    v_mfma_f32_16x16x32_bf16 v[112:115], a[184:187], a[72:75], v[112:115]
    s_max_u32 s78, s78, s79
    ds_read_b64_tr_b16 a[214:215], v9 offset:30720
    v_lshlrev_b32 v62, 2, v1
    v_mfma_f32_16x16x32_bf16 v[112:115], a[188:191], a[224:227], v[112:115]
    s_cmp_gt_u32 s78, 2
    s_cbranch_scc1 spin_o3
spin_o3_ret:
    v_mov_b32 v67, 0x7ffffff0
    v_mfma_f32_16x16x32_bf16 v[120:123], a[188:191], a[228:231], v[120:123]
    s_load_dwordx4 s[72:75], s[86:87], s5 glc
    v_cndmask_b32 v62, v67, v62, vcc
    s_add_u32 s37, s59, 12288
    v_mfma_f32_16x16x32_bf16 v[120:123], a[184:187], a[76:79], v[120:123]
    buffer_load_dwordx4 a[32:35], v14, s[20:23], s37 offen offset:0 sc1
    v_mfma_f32_16x16x32_bf16 v[124:127], a[192:195], a[76:79], v[124:127]
    s_add_u32 s38, s47, 40960
    ds_read_b64_tr_b16 a[184:185], v10 offset:20480
    s_add_u32 m0, s63, 102400
    v_mfma_f32_16x16x32_bf16 v[124:127], a[196:199], a[228:231], v[124:127]
    ds_read_b64_tr_b16 a[186:187], v10 offset:22528
    v_mfma_f32_16x16x32_bf16 v[116:119], a[196:199], a[224:227], v[116:119]
    buffer_load_dwordx4 a[36:39], v14, s[20:23], s37 offen offset:1024 sc1
    v_mfma_f32_16x16x32_bf16 v[116:119], a[192:195], a[72:75], v[116:119]
    buffer_load_dwordx4 v2, s[8:11], s38 offen lds
    v_mfma_f32_16x16x32_bf16 v[108:111], a[192:195], a[68:71], v[108:111]
    ds_read_b64_tr_b16 a[188:189], v10 offset:28672
    v_mfma_f32_16x16x32_bf16 v[108:111], a[196:199], a[220:223], v[108:111]
    ds_read_b64_tr_b16 a[190:191], v10 offset:30720
    v_mfma_f32_16x16x32_bf16 v[100:103], a[196:199], a[216:219], v[100:103]
    s_waitcnt lgkmcnt(6)
    s_add_u32 s38, s47, 40960
    v_mfma_f32_16x16x32_bf16 v[100:103], a[192:195], a[64:67], v[100:103]
    ds_read_b64_tr_b16 a[192:193], v11 offset:20480
    v_mfma_f32_16x16x32_bf16 v[128:131], a[200:203], a[64:67], v[128:131]
    s_addk_i32 m0, 4096
    ds_read_b64_tr_b16 a[194:195], v11 offset:22528
    v_mfma_f32_16x16x32_bf16 v[128:131], a[204:207], a[216:219], v[128:131]
    ds_read_b64_tr_b16 a[196:197], v11 offset:28672
    v_mfma_f32_16x16x32_bf16 v[136:139], a[204:207], a[220:223], v[136:139]
    ds_read_b64_tr_b16 a[198:199], v11 offset:30720
    v_mfma_f32_16x16x32_bf16 v[136:139], a[200:203], a[68:71], v[136:139]
    v_mfma_f32_16x16x32_bf16 v[144:147], a[200:203], a[72:75], v[144:147]
    buffer_load_dwordx4 a[40:43], v14, s[20:23], s37 offen offset:2048 sc1
    v_mfma_f32_16x16x32_bf16 v[144:147], a[204:207], a[224:227], v[144:147]
    v_mfma_f32_16x16x32_bf16 v[152:155], a[204:207], a[228:231], v[152:155]
    buffer_load_dwordx4 v3, s[8:11], s38 offen lds
    v_mfma_f32_16x16x32_bf16 v[152:155], a[200:203], a[76:79], v[152:155]
    s_waitcnt lgkmcnt(4)
    ds_read_b64_tr_b16 a[200:201], v8 offset:24576
    v_mfma_f32_16x16x32_bf16 v[156:159], a[208:211], a[76:79], v[156:159]
    ds_read_b64_tr_b16 a[202:203], v8 offset:26624
    v_mfma_f32_16x16x32_bf16 v[156:159], a[212:215], a[228:231], v[156:159]
    ds_read_b64_tr_b16 a[204:205], v8 offset:32768
    v_mfma_f32_16x16x32_bf16 v[148:151], a[212:215], a[224:227], v[148:151]
    s_add_u32 s38, s45, 81920
    ds_read_b64_tr_b16 a[206:207], v8 offset:34816
    s_add_u32 s36, s46, 81920
    v_mfma_f32_16x16x32_bf16 v[148:151], a[208:211], a[72:75], v[148:151]
    s_cmp_lt_u32 s3, 2
    s_cselect_b32 s38, s38, s36
    v_mfma_f32_16x16x32_bf16 v[140:143], a[208:211], a[68:71], v[140:143]
    s_add_u32 m0, s63, 139264
    v_mfma_f32_16x16x32_bf16 v[140:143], a[212:215], a[220:223], v[140:143]
    v_mfma_f32_16x16x32_bf16 v[132:135], a[212:215], a[216:219], v[132:135]
    buffer_load_dwordx4 a[44:47], v14, s[20:23], s37 offen offset:3072 sc1
    v_mfma_f32_16x16x32_bf16 v[132:135], a[208:211], a[64:67], v[132:135]
    ds_read_b64_tr_b16 a[208:209], v9 offset:24576
    v_mfma_f32_16x16x32_bf16 v[160:163], a[184:187], a[64:67], v[160:163]
    ds_read_b64_tr_b16 a[210:211], v9 offset:26624
    v_mfma_f32_16x16x32_bf16 v[160:163], a[188:191], a[216:219], v[160:163]
    ds_read_b64_tr_b16 a[212:213], v9 offset:32768
    v_mfma_f32_16x16x32_bf16 v[168:171], a[188:191], a[220:223], v[168:171]
    s_waitcnt lgkmcnt(5)
    ds_read_b64_tr_b16 a[214:215], v9 offset:34816
    s_add_u32 s37, s60, 12288
    v_mfma_f32_16x16x32_bf16 v[168:171], a[184:187], a[68:71], v[168:171]
    buffer_load_dwordx4 v7, s[8:11], s38 offen lds
    v_mfma_f32_16x16x32_bf16 v[176:179], a[184:187], a[72:75], v[176:179]
    v_mfma_f32_16x16x32_bf16 v[176:179], a[188:191], a[224:227], v[176:179]
    v_mfma_f32_16x16x32_bf16 v[184:187], a[188:191], a[228:231], v[184:187]
    v_mfma_f32_16x16x32_bf16 v[184:187], a[184:187], a[76:79], v[184:187]
    ds_read_b64_tr_b16 a[184:185], v10 offset:24576
    v_mfma_f32_16x16x32_bf16 v[188:191], a[192:195], a[76:79], v[188:191]
    buffer_load_dwordx4 a[48:51], v14, s[20:23], s37 offen offset:0 sc1
    v_mfma_f32_16x16x32_bf16 v[188:191], a[196:199], a[228:231], v[188:191]
    s_mov_b32 s16, s84
    ds_read_b64_tr_b16 a[186:187], v10 offset:26624
    v_and_b32 v5, 15, v1
    v_mfma_f32_16x16x32_bf16 v[180:183], a[196:199], a[224:227], v[180:183]
    s_and_b32 s17, s85, 0xffff
    ds_read_b64_tr_b16 a[188:189], v10 offset:32768
    v_add_u32 v5, s6, v5
    v_mfma_f32_16x16x32_bf16 v[180:183], a[192:195], a[72:75], v[180:183]
    s_mov_b32 s18, 2621440
    ds_read_b64_tr_b16 a[190:191], v10 offset:34816
    v_bfe_u32 v50, v1, 4, 1
    v_mfma_f32_16x16x32_bf16 v[172:175], a[192:195], a[68:71], v[172:175]
    s_mov_b32 s19, 0x00020000
    v_bfe_u32 v51, v1, 5, 1
    v_lshl_add_u32 v50, v50, 1, v51
    v_mfma_f32_16x16x32_bf16 v[172:175], a[196:199], a[220:223], v[172:175]
    s_and_b32 s56, s53, 4
    v_mul_u32_u24 v4, 1280, v5
    v_lshl_add_u32 v4, v50, 4, v4
    v_mfma_f32_16x16x32_bf16 v[164:167], a[196:199], a[216:219], v[164:167]
    s_waitcnt lgkmcnt(5)
    v_xor_b32 v51, 16, v5
    v_mul_u32_u24 v35, 1280, v51
    v_mfma_f32_16x16x32_bf16 v[164:167], a[192:195], a[64:67], v[164:167]
    s_add_u32 s38, s47, 81920
    ds_read_b64_tr_b16 a[192:193], v11 offset:24576
    v_lshl_add_u32 v34, v50, 4, v35
    v_mfma_f32_16x16x32_bf16 v[192:195], a[200:203], a[64:67], v[192:195]
    s_add_u32 s36, s45, 122880
    ds_read_b64_tr_b16 a[194:195], v11 offset:26624
    v_and_b32 v51, 0xfffffff7, v51
    v_mfma_f32_16x16x32_bf16 v[192:195], a[204:207], a[216:219], v[192:195]
    s_cmp_lt_u32 s3, 2
    s_cselect_b32 s38, s38, s36
    v_lshrrev_b32 v50, 4, v1
    v_mfma_f32_16x16x32_bf16 v[200:203], a[204:207], a[220:223], v[200:203]
    s_addk_i32 m0, 4096
    ds_read_b64_tr_b16 a[196:197], v11 offset:32768
    s_lshl_b32 s56, s56, 1
    v_mfma_f32_16x16x32_bf16 v[200:203], a[200:203], a[68:71], v[200:203]
    ds_read_b64_tr_b16 a[198:199], v11 offset:34816
    v_or_b32 v37, s56, v51
    v_mfma_f32_16x16x32_bf16 v[208:211], a[200:203], a[72:75], v[208:211]
    buffer_load_dwordx4 a[52:55], v14, s[20:23], s37 offen offset:1024 sc1
    v_mfma_f32_16x16x32_bf16 v[208:211], a[204:207], a[224:227], v[208:211]
    s_xor_b32 s56, s56, 8
    v_mul_u32_u24 v35, 1280, v37
    v_lshl_add_u32 v35, v50, 3, v35
    v_mfma_f32_16x16x32_bf16 v[216:219], a[204:207], a[228:231], v[216:219]
    buffer_load_dwordx4 v7, s[8:11], s38 offen lds
    v_mfma_f32_16x16x32_bf16 v[216:219], a[200:203], a[76:79], v[216:219]
    s_waitcnt lgkmcnt(4)
    v_xor_b32 v50, s56, v1
    v_and_b32 v50, 8, v50
    v_mfma_f32_16x16x32_bf16 v[220:223], a[208:211], a[76:79], v[220:223]
    v_lshl_add_u32 v35, v50, 2, v35
    v_lshlrev_b32 v52, 3, v37
    v_mfma_f32_16x16x32_bf16 v[220:223], a[212:215], a[228:231], v[220:223]
    s_waitcnt vmcnt(27) lgkmcnt(0)
    v_add_u32 v52, 3211264, v52
    v_lshlrev_b32 v50, 3, v5
    v_mfma_f32_16x16x32_bf16 v[212:215], a[212:215], a[224:227], v[212:215]
    s_barrier
    v_mfma_f32_16x16x32_bf16 v[212:215], a[208:211], a[72:75], v[212:215]
    ds_read_b64_tr_b16 a[200:201], v12 offset:40960
    v_add_u32 v50, 3211264, v50
    v_mfma_f32_16x16x32_bf16 v[204:207], a[208:211], a[68:71], v[204:207]
    buffer_load_dwordx4 a[56:59], v14, s[20:23], s37 offen offset:2048 sc1
    v_mfma_f32_16x16x32_bf16 v[204:207], a[212:215], a[220:223], v[204:207]
    ds_read_b64_tr_b16 a[202:203], v12 offset:41984
    v_xor_b32 v51, 128, v50
    v_mfma_f32_16x16x32_bf16 v[196:199], a[212:215], a[216:219], v[196:199]
    ds_read_b64_tr_b16 a[204:205], v12 offset:43008
    v_mfma_f32_16x16x32_bf16 v[196:199], a[208:211], a[64:67], v[196:199]
    ds_read_b64_tr_b16 a[206:207], v12 offset:44032
    v_mfma_f32_16x16x32_bf16 v[224:227], a[184:187], a[64:67], v[224:227]
    ds_read_b64_tr_b16 a[208:209], v13 offset:40960
    v_mfma_f32_16x16x32_bf16 v[224:227], a[188:191], a[216:219], v[224:227]
    ds_read_b64_tr_b16 a[210:211], v13 offset:41984
    v_mfma_f32_16x16x32_bf16 v[232:235], a[188:191], a[220:223], v[232:235]
    s_add_u32 s38, s46, 122880
    ds_read_b64_tr_b16 a[212:213], v13 offset:43008
    s_add_u32 s36, s47, 122880
    v_mfma_f32_16x16x32_bf16 v[232:235], a[184:187], a[68:71], v[232:235]
    s_cmp_lt_u32 s3, 2
    s_cselect_b32 s38, s38, s36
    v_mfma_f32_16x16x32_bf16 v[240:243], a[184:187], a[72:75], v[240:243]
    s_addk_i32 m0, 4096
    ds_read_b64_tr_b16 a[214:215], v13 offset:44032
    v_mfma_f32_16x16x32_bf16 v[240:243], a[188:191], a[224:227], v[240:243]
    v_add_u32 v12, 73728, v12
    v_mfma_f32_16x16x32_bf16 v[248:251], a[188:191], a[228:231], v[248:251]
    buffer_load_dwordx4 a[60:63], v14, s[20:23], s37 offen offset:3072 sc1
    v_mfma_f32_16x16x32_bf16 v[248:251], a[184:187], a[76:79], v[248:251]
    ds_read_b64_tr_b16 a[184:185], v8 offset:40960
    v_mfma_f32_16x16x32_bf16 v[252:255], a[192:195], a[76:79], v[252:255]
    ds_read_b64_tr_b16 a[186:187], v8 offset:43008
    v_mfma_f32_16x16x32_bf16 v[252:255], a[196:199], a[228:231], v[252:255]
    ds_read_b64_tr_b16 a[188:189], v8 offset:49152
    v_mfma_f32_16x16x32_bf16 v[244:247], a[196:199], a[224:227], v[244:247]
    s_waitcnt lgkmcnt(4)
    ds_read_b64_tr_b16 a[190:191], v8 offset:51200
    s_add_u32 s37, s61, 12288
    v_mfma_f32_16x16x32_bf16 v[244:247], a[192:195], a[72:75], v[244:247]
    buffer_load_dwordx4 v7, s[8:11], s38 offen lds
    v_mfma_f32_16x16x32_bf16 v[236:239], a[192:195], a[68:71], v[236:239]
    v_add_u32 v13, 73728, v13
    v_mfma_f32_16x16x32_bf16 v[236:239], a[196:199], a[220:223], v[236:239]
    v_mfma_f32_16x16x32_bf16 v[228:231], a[196:199], a[216:219], v[228:231]
    v_mfma_f32_16x16x32_bf16 v[228:231], a[192:195], a[64:67], v[228:231]
    ds_read_b64_tr_b16 a[192:193], v9 offset:40960
    v_mfma_f32_16x16x32_bf16 v[96:99], a[200:203], a[232:235], v[96:99]
    buffer_load_dwordx4 a[64:67], v14, s[20:23], s37 offen offset:0 sc1
    v_mfma_f32_16x16x32_bf16 v[96:99], a[204:207], a[152:155], v[96:99]
    buffer_load_dwordx2 v[16:17], v50, s[24:27], 0 offen sc1
    v_mfma_f32_16x16x32_bf16 v[104:107], a[204:207], a[156:159], v[104:107]
    ds_read_b64_tr_b16 a[194:195], v9 offset:43008
    v_mfma_f32_16x16x32_bf16 v[104:107], a[200:203], a[236:239], v[104:107]
    ds_read_b64_tr_b16 a[196:197], v9 offset:49152
    v_mfma_f32_16x16x32_bf16 v[112:115], a[200:203], a[240:243], v[112:115]
    ds_read_b64_tr_b16 a[198:199], v9 offset:51200
    v_mfma_f32_16x16x32_bf16 v[112:115], a[204:207], a[160:163], v[112:115]
    ds_read_b64_tr_b16 v[76:77], v66 offset:0
    v_mfma_f32_16x16x32_bf16 v[120:123], a[204:207], a[164:167], v[120:123]
    s_waitcnt lgkmcnt(4)
    ds_read_b64_tr_b16 v[78:79], v66 offset:2048
    s_add_u32 s38, s45, 163840
    v_mfma_f32_16x16x32_bf16 v[120:123], a[200:203], a[244:247], v[120:123]
    s_add_u32 s36, s46, 163840
    ds_read_b64_tr_b16 v[80:81], v66 offset:4096
    v_mfma_f32_16x16x32_bf16 v[124:127], a[208:211], a[244:247], v[124:127]
    s_cmp_lt_u32 s3, 2
    s_cselect_b32 s38, s38, s36
    s_addk_i32 m0, 4096
    v_mfma_f32_16x16x32_bf16 v[124:127], a[212:215], a[164:167], v[124:127]
    ds_read_b64_tr_b16 v[82:83], v66 offset:6144
    v_mfma_f32_16x16x32_bf16 v[116:119], a[212:215], a[160:163], v[116:119]
    buffer_load_dwordx4 a[68:71], v14, s[20:23], s37 offen offset:1024 sc1
    v_mfma_f32_16x16x32_bf16 v[116:119], a[208:211], a[240:243], v[116:119]
    s_add_u32 s77, s7, 5
    ds_read_b64_tr_b16 a[200:201], v10 offset:40960
    v_mfma_f32_16x16x32_bf16 v[108:111], a[208:211], a[236:239], v[108:111]
    ds_read_b64_tr_b16 a[202:203], v10 offset:43008
    v_mfma_f32_16x16x32_bf16 v[108:111], a[212:215], a[156:159], v[108:111]
    ds_read_b64_tr_b16 a[204:205], v10 offset:49152
    v_mfma_f32_16x16x32_bf16 v[100:103], a[212:215], a[152:155], v[100:103]
    buffer_load_dwordx4 v7, s[8:11], s38 offen lds
    v_mfma_f32_16x16x32_bf16 v[100:103], a[208:211], a[232:235], v[100:103]
    buffer_load_dwordx2 v[18:19], v51, s[24:27], 0 offen sc1
    v_mfma_f32_16x16x32_bf16 v[128:131], a[184:187], a[232:235], v[128:131]
    ds_read_b64_tr_b16 a[206:207], v10 offset:51200
    v_mfma_f32_16x16x32_bf16 v[128:131], a[188:191], a[152:155], v[128:131]
    s_waitcnt lgkmcnt(4)
    ds_read_b64_tr_b16 a[208:209], v11 offset:40960
    v_mfma_f32_16x16x32_bf16 v[136:139], a[188:191], a[156:159], v[136:139]
    ds_read_b64_tr_b16 a[210:211], v11 offset:43008
    v_mfma_f32_16x16x32_bf16 v[136:139], a[184:187], a[236:239], v[136:139]
    ds_read_b64_tr_b16 a[212:213], v11 offset:49152
    v_mfma_f32_16x16x32_bf16 v[144:147], a[184:187], a[240:243], v[144:147]
    buffer_load_dwordx4 a[72:75], v14, s[20:23], s37 offen offset:2048 sc1
    v_mfma_f32_16x16x32_bf16 v[144:147], a[188:191], a[160:163], v[144:147]
    ds_read_b64_tr_b16 a[214:215], v11 offset:51200
    v_mfma_f32_16x16x32_bf16 v[152:155], a[188:191], a[164:167], v[152:155]
    v_mfma_f32_16x16x32_bf16 v[152:155], a[184:187], a[244:247], v[152:155]
    ds_read_b64_tr_b16 a[184:185], v8 offset:45056
    v_mfma_f32_16x16x32_bf16 v[156:159], a[192:195], a[244:247], v[156:159]
    ds_read_b64_tr_b16 a[186:187], v8 offset:47104
    v_mfma_f32_16x16x32_bf16 v[156:159], a[196:199], a[164:167], v[156:159]
    ds_read_b64_tr_b16 a[188:189], v8 offset:53248
    v_mfma_f32_16x16x32_bf16 v[148:151], a[196:199], a[160:163], v[148:151]
    s_waitcnt lgkmcnt(4)
    ds_read_b64_tr_b16 a[190:191], v8 offset:55296
    s_add_u32 s38, s47, 163840
    v_mfma_f32_16x16x32_bf16 v[148:151], a[192:195], a[240:243], v[148:151]
    s_add_u32 s36, s45, 204800
    v_add_u32 v8, 73728, v8
    v_mfma_f32_16x16x32_bf16 v[140:143], a[192:195], a[236:239], v[140:143]
    buffer_load_dwordx2 v[38:39], v52, s[24:27], 0 offen sc1
    v_mfma_f32_16x16x32_bf16 v[140:143], a[196:199], a[156:159], v[140:143]
    s_cmp_lt_u32 s3, 2
    s_cselect_b32 s38, s38, s36
    s_addk_i32 m0, 4096
    v_mfma_f32_16x16x32_bf16 v[132:135], a[196:199], a[152:155], v[132:135]
    buffer_load_dwordx4 a[76:79], v14, s[20:23], s37 offen offset:3072 sc1
    v_mfma_f32_16x16x32_bf16 v[132:135], a[192:195], a[232:235], v[132:135]
    s_sub_u32 s78, s72, s77
    ds_read_b64_tr_b16 a[192:193], v9 offset:45056
    s_sub_u32 s79, s73, s77
    v_mfma_f32_16x16x32_bf16 v[84:87], v[68:71], v[76:79], 0
    s_max_u32 s78, s78, s79
    ds_read_b64_tr_b16 a[194:195], v9 offset:47104
    s_sub_u32 s79, s74, s77
    v_mfma_f32_16x16x32_bf16 v[84:87], v[72:75], v[80:83], v[84:87]
    s_max_u32 s78, s78, s79
    ds_read_b64_tr_b16 a[196:197], v9 offset:53248
    s_sub_u32 s79, s75, s77
    v_mfma_f32_16x16x32_bf16 v[160:163], a[200:203], a[232:235], v[160:163]
    buffer_load_dwordx4 v7, s[8:11], s38 offen lds
    v_mfma_f32_16x16x32_bf16 v[160:163], a[204:207], a[152:155], v[160:163]
    s_max_u32 s78, s78, s79
    ds_read_b64_tr_b16 a[198:199], v9 offset:55296
    s_add_u32 s37, s59, 16384
    v_mfma_f32_16x16x32_bf16 v[168:171], a[204:207], a[156:159], v[168:171]
    buffer_store_dword v84, v62, s[24:27], s62 offen sc1
    v_mfma_f32_16x16x32_bf16 v[168:171], a[200:203], a[236:239], v[168:171]
    buffer_store_dword v85, v62, s[24:27], s62 offen offset:2560 sc1
    v_mfma_f32_16x16x32_bf16 v[176:179], a[200:203], a[240:243], v[176:179]
    s_cmp_gt_u32 s78, 1
    s_cbranch_scc1 spin_o4
spin_o4_ret:
    v_mfma_f32_16x16x32_bf16 v[176:179], a[204:207], a[160:163], v[176:179]
    v_add_u32 v9, 73728, v9
    v_mfma_f32_16x16x32_bf16 v[184:187], a[204:207], a[164:167], v[184:187]
    buffer_load_dwordx4 a[216:219], v14, s[20:23], s37 offen offset:0 sc1
    v_mfma_f32_16x16x32_bf16 v[184:187], a[200:203], a[244:247], v[184:187]
    s_waitcnt lgkmcnt(1)
    ds_read_b64_tr_b16 a[200:201], v10 offset:45056
    v_mfma_f32_16x16x32_bf16 v[188:191], a[208:211], a[244:247], v[188:191]
    buffer_load_dwordx2 v[32:33], v35, s[12:15], s68 offen
    v_mfma_f32_16x16x32_bf16 v[188:191], a[212:215], a[164:167], v[188:191]
    ds_read_b64_tr_b16 a[202:203], v10 offset:47104
    v_mfma_f32_16x16x32_bf16 v[180:183], a[212:215], a[160:163], v[180:183]
    ds_read_b64_tr_b16 a[204:205], v10 offset:53248
    v_mfma_f32_16x16x32_bf16 v[180:183], a[208:211], a[240:243], v[180:183]
    ds_read_b64_tr_b16 a[206:207], v10 offset:55296
    v_mfma_f32_16x16x32_bf16 v[172:175], a[208:211], a[236:239], v[172:175]
    s_add_u32 s38, s46, 204800
    v_add_u32 v10, 73728, v10
    s_add_u32 s36, s47, 204800
    v_mfma_f32_16x16x32_bf16 v[172:175], a[212:215], a[156:159], v[172:175]
    s_cmp_lt_u32 s3, 2
    s_cselect_b32 s38, s38, s36
    v_mfma_f32_16x16x32_bf16 v[164:167], a[212:215], a[152:155], v[164:167]
    s_addk_i32 m0, 4096
    v_mfma_f32_16x16x32_bf16 v[164:167], a[208:211], a[232:235], v[164:167]
    ds_read_b64_tr_b16 a[208:209], v11 offset:45056
    v_mfma_f32_16x16x32_bf16 v[192:195], a[184:187], a[232:235], v[192:195]
    buffer_load_dwordx4 a[220:223], v14, s[20:23], s37 offen offset:1024 sc1
    v_mfma_f32_16x16x32_bf16 v[192:195], a[188:191], a[152:155], v[192:195]
    ds_read_b64_tr_b16 a[210:211], v11 offset:47104
    v_mfma_f32_16x16x32_bf16 v[200:203], a[188:191], a[156:159], v[200:203]
    ds_read_b64_tr_b16 a[212:213], v11 offset:53248
    v_mfma_f32_16x16x32_bf16 v[200:203], a[184:187], a[236:239], v[200:203]
    ds_read_b64_tr_b16 a[214:215], v11 offset:55296
    v_mfma_f32_16x16x32_bf16 v[208:211], a[184:187], a[240:243], v[208:211]
    buffer_load_dwordx4 v7, s[8:11], s38 offen lds
    v_mfma_f32_16x16x32_bf16 v[208:211], a[188:191], a[160:163], v[208:211]
    v_add_u32 v11, 73728, v11
    v_mfma_f32_16x16x32_bf16 v[216:219], a[188:191], a[164:167], v[216:219]
    buffer_load_dwordx4 v[24:27], v4, s[12:15], s64 offen
    v_mfma_f32_16x16x32_bf16 v[216:219], a[184:187], a[244:247], v[216:219]
    s_waitcnt lgkmcnt(3)
    v_mfma_f32_16x16x32_bf16 v[220:223], a[192:195], a[244:247], v[220:223]
    v_mfma_f32_16x16x32_bf16 v[220:223], a[196:199], a[164:167], v[220:223]
    s_waitcnt vmcnt(35) lgkmcnt(1)
    v_mfma_f32_16x16x32_bf16 v[212:215], a[196:199], a[160:163], v[212:215]
    s_barrier
    v_mfma_f32_16x16x32_bf16 v[212:215], a[192:195], a[240:243], v[212:215]
    buffer_load_dwordx4 a[224:227], v14, s[20:23], s37 offen offset:2048 sc1
    v_mfma_f32_16x16x32_bf16 v[204:207], a[192:195], a[236:239], v[204:207]
    ds_read_b64_tr_b16 a[184:185], v12 offset:0
    v_mfma_f32_16x16x32_bf16 v[204:207], a[196:199], a[156:159], v[204:207]
    ds_read_b64_tr_b16 a[186:187], v12 offset:1024
    v_mfma_f32_16x16x32_bf16 v[196:199], a[196:199], a[152:155], v[196:199]
    ds_read_b64_tr_b16 a[188:189], v12 offset:2048
    v_mfma_f32_16x16x32_bf16 v[196:199], a[192:195], a[232:235], v[196:199]
    ds_read_b64_tr_b16 a[190:191], v12 offset:3072
    v_mfma_f32_16x16x32_bf16 v[224:227], a[200:203], a[232:235], v[224:227]
    s_add_u32 s38, s45, 81920
    ds_read_b64_tr_b16 a[192:193], v13 offset:0
    v_mfma_f32_16x16x32_bf16 v[224:227], a[204:207], a[152:155], v[224:227]
    ds_read_b64_tr_b16 a[194:195], v13 offset:1024
    v_mfma_f32_16x16x32_bf16 v[232:235], a[204:207], a[156:159], v[232:235]
    s_add_u32 m0, s63, 0
    ds_read_b64_tr_b16 a[196:197], v13 offset:2048
    v_mfma_f32_16x16x32_bf16 v[232:235], a[200:203], a[236:239], v[232:235]
pg_13:
    s_cbranch_execz pg_back
    ds_read_b64_tr_b16 a[198:199], v13 offset:3072
    v_mfma_f32_16x16x32_bf16 v[240:243], a[200:203], a[240:243], v[240:243]
    buffer_load_dwordx4 a[228:231], v14, s[20:23], s37 offen offset:3072 sc1
    v_mfma_f32_16x16x32_bf16 v[240:243], a[204:207], a[160:163], v[240:243]
    buffer_load_dwordx4 v[28:31], v34, s[12:15], s64 offen
    v_mfma_f32_16x16x32_bf16 v[248:251], a[204:207], a[164:167], v[248:251]
    s_waitcnt lgkmcnt(4)
    v_mfma_f32_16x16x32_bf16 v[248:251], a[200:203], a[244:247], v[248:251]
    ds_read_b64_tr_b16 a[200:201], v8 offset:0
    v_mfma_f32_16x16x32_bf16 v[252:255], a[208:211], a[244:247], v[252:255]
    buffer_load_dwordx4 v2, s[8:11], s38 offen lds
    v_mfma_f32_16x16x32_bf16 v[252:255], a[212:215], a[164:167], v[252:255]
    ds_read_b64_tr_b16 a[202:203], v8 offset:2048
    v_mfma_f32_16x16x32_bf16 v[244:247], a[212:215], a[160:163], v[244:247]
    s_add_u32 s37, s60, 16384
    ds_read_b64_tr_b16 a[204:205], v8 offset:8192
    v_mfma_f32_16x16x32_bf16 v[244:247], a[208:211], a[240:243], v[244:247]
    ds_read_b64_tr_b16 a[206:207], v8 offset:10240
    v_mfma_f32_16x16x32_bf16 v[236:239], a[208:211], a[236:239], v[236:239]
    v_mfma_f32_16x16x32_bf16 v[236:239], a[212:215], a[156:159], v[236:239]
    v_mfma_f32_16x16x32_bf16 v[228:231], a[212:215], a[152:155], v[228:231]
    s_add_u32 s38, s46, 81920
    v_mfma_f32_16x16x32_bf16 v[228:231], a[208:211], a[232:235], v[228:231]
    ds_read_b64_tr_b16 a[208:209], v9 offset:0
    v_mfma_f32_16x16x32_bf16 v[96:99], a[184:187], a[168:171], v[96:99]
    buffer_load_dwordx4 a[232:235], v14, s[20:23], s37 offen offset:0 sc1
    v_mfma_f32_16x16x32_bf16 v[96:99], a[188:191], a[80:83], v[96:99]
    s_addk_i32 m0, 4096
    ds_read_b64_tr_b16 a[210:211], v9 offset:2048
    v_mfma_f32_16x16x32_bf16 v[104:107], a[188:191], a[84:87], v[104:107]
    ds_read_b64_tr_b16 a[212:213], v9 offset:8192
    v_mfma_f32_16x16x32_bf16 v[104:107], a[184:187], a[172:175], v[104:107]
    s_waitcnt lgkmcnt(3)
    ds_read_b64_tr_b16 a[214:215], v9 offset:10240
    v_mfma_f32_16x16x32_bf16 v[112:115], a[184:187], a[176:179], v[112:115]
    v_mfma_f32_16x16x32_bf16 v[112:115], a[188:191], a[88:91], v[112:115]
    v_mfma_f32_16x16x32_bf16 v[120:123], a[188:191], a[92:95], v[120:123]
    buffer_load_dwordx4 v2, s[8:11], s38 offen lds
    v_mfma_f32_16x16x32_bf16 v[120:123], a[184:187], a[180:183], v[120:123]
    ds_read_b64_tr_b16 a[184:185], v10 offset:0
    v_mfma_f32_16x16x32_bf16 v[124:127], a[192:195], a[180:183], v[124:127]
    ds_read_b64_tr_b16 a[186:187], v10 offset:2048
    v_mfma_f32_16x16x32_bf16 v[124:127], a[196:199], a[92:95], v[124:127]
    ds_read_b64_tr_b16 a[188:189], v10 offset:8192
    v_mfma_f32_16x16x32_bf16 v[116:119], a[196:199], a[88:91], v[116:119]
    buffer_load_dwordx4 a[236:239], v14, s[20:23], s37 offen offset:1024 sc1
    v_mfma_f32_16x16x32_bf16 v[116:119], a[192:195], a[176:179], v[116:119]
    ds_read_b64_tr_b16 a[190:191], v10 offset:10240
    v_mfma_f32_16x16x32_bf16 v[108:111], a[192:195], a[172:175], v[108:111]
    s_add_u32 s38, s47, 81920
    v_mfma_f32_16x16x32_bf16 v[108:111], a[196:199], a[84:87], v[108:111]
    v_mfma_f32_16x16x32_bf16 v[100:103], a[196:199], a[80:83], v[100:103]
    s_addk_i32 m0, 4096
    v_mfma_f32_16x16x32_bf16 v[100:103], a[192:195], a[168:171], v[100:103]
    ds_read_b64_tr_b16 a[192:193], v11 offset:0
    v_mfma_f32_16x16x32_bf16 v[128:131], a[200:203], a[168:171], v[128:131]
    ds_read_b64_tr_b16 a[194:195], v11 offset:2048
    v_mfma_f32_16x16x32_bf16 v[128:131], a[204:207], a[80:83], v[128:131]
    ds_read_b64_tr_b16 a[196:197], v11 offset:8192
    v_mfma_f32_16x16x32_bf16 v[136:139], a[204:207], a[84:87], v[136:139]
    s_waitcnt lgkmcnt(3)
    ds_read_b64_tr_b16 a[198:199], v11 offset:10240
    v_lshrrev_b32 v65, 1, v1
    v_mfma_f32_16x16x32_bf16 v[136:139], a[200:203], a[172:175], v[136:139]
    s_and_b32 s39, s70, 0x7ff
    v_min_u32 v65, 23, v65
    v_mul_u32_u24 v65, 2560, v65
    v_mfma_f32_16x16x32_bf16 v[144:147], a[200:203], a[176:179], v[144:147]
    buffer_load_dwordx4 a[240:243], v14, s[20:23], s37 offen offset:2048 sc1
    v_mfma_f32_16x16x32_bf16 v[144:147], a[204:207], a[88:91], v[144:147]
    buffer_load_dwordx4 v2, s[8:11], s38 offen lds
    v_mfma_f32_16x16x32_bf16 v[152:155], a[204:207], a[92:95], v[152:155]
    s_sub_u32 s39, 2047, s39
    v_and_b32 v56, 1, v1
    v_lshl_add_u32 v65, v56, 2, v65
    v_mfma_f32_16x16x32_bf16 v[152:155], a[200:203], a[180:183], v[152:155]
    s_and_b32 s40, s71, 0x7ff
    ds_read_b64_tr_b16 a[200:201], v8 offset:4096
    v_cmp_lt_u32 vcc, 31, v1
    v_mfma_f32_16x16x32_bf16 v[156:159], a[208:211], a[180:183], v[156:159]
    s_load_dwordx4 s[72:75], s[86:87], s5 glc
    ds_read_b64_tr_b16 a[202:203], v8 offset:6144
    v_mov_b32 v54, s70
    v_mfma_f32_16x16x32_bf16 v[156:159], a[212:215], a[92:95], v[156:159]
    s_sub_u32 s40, 2047, s40
    ds_read_b64_tr_b16 a[204:205], v8 offset:12288
    v_mov_b32 v64, s71
    v_mfma_f32_16x16x32_bf16 v[148:151], a[212:215], a[88:91], v[148:151]
    s_add_u32 s38, s45, 122880
    ds_read_b64_tr_b16 a[206:207], v8 offset:14336
    v_cndmask_b32 v54, v54, v64, vcc
    v_mfma_f32_16x16x32_bf16 v[148:151], a[208:211], a[176:179], v[148:151]
    s_xor_b32 s56, s39, s6
    v_bfe_i32 v56, v1, 3, 1
    v_and_b32 v57, 7, v1
    v_mfma_f32_16x16x32_bf16 v[140:143], a[208:211], a[172:175], v[140:143]
    s_add_u32 m0, s63, 12288
    s_xor_b32 s57, s40, s6
    s_min_u32 s56, s56, s57
    v_mfma_f32_16x16x32_bf16 v[140:143], a[212:215], a[84:87], v[140:143]
    s_cmp_lt_u32 s56, 32
    s_cselect_b32 s43, 0, 0x70000000
    s_cselect_b32 s58, s7, 0
    v_mfma_f32_16x16x32_bf16 v[132:135], a[212:215], a[80:83], v[132:135]
    buffer_load_dwordx4 a[244:247], v14, s[20:23], s37 offen offset:3072 sc1
    v_mfma_f32_16x16x32_bf16 v[132:135], a[208:211], a[168:171], v[132:135]
    s_lshr_b32 s41, s64, 7
    ds_read_b64_tr_b16 a[208:209], v9 offset:4096
    v_or_b32 v65, s43, v65
    v_mfma_f32_16x16x32_bf16 v[160:163], a[184:187], a[168:171], v[160:163]
    s_lshl_b32 s41, s41, 8
    ds_read_b64_tr_b16 a[210:211], v9 offset:6144
    s_bfe_u32 s56, s64, 0x10006
    v_mfma_f32_16x16x32_bf16 v[160:163], a[188:191], a[80:83], v[160:163]
    s_lshl3_add_u32 s41, s56, s41
    ds_read_b64_tr_b16 a[212:213], v9 offset:12288
    s_add_u32 s41, s41, 3932320
    v_mfma_f32_16x16x32_bf16 v[168:171], a[188:191], a[84:87], v[168:171]
    s_waitcnt lgkmcnt(5)
    ds_read_b64_tr_b16 a[214:215], v9 offset:14336
    s_add_u32 s37, s61, 16384
    v_mfma_f32_16x16x32_bf16 v[168:171], a[184:187], a[172:175], v[168:171]
    buffer_load_dwordx4 v2, s[8:11], s38 offen lds
    v_mfma_f32_16x16x32_bf16 v[176:179], a[184:187], a[176:179], v[176:179]
    s_waitcnt vmcnt(16)
    s_lshr_b32 s42, s68, 7
    s_lshl_b32 s42, s42, 8
    v_mfma_f32_16x16x32_bf16 v[176:179], a[188:191], a[88:91], v[176:179]
    buffer_store_dword v6, v15, s[24:27], s4 offen offset:160 sc1
    v_mfma_f32_16x16x32_bf16 v[184:187], a[188:191], a[92:95], v[184:187]
    s_bfe_u32 s56, s68, 0x10006
    s_lshl3_add_u32 s42, s56, s42
    s_add_u32 s42, s42, 3932320
    v_mfma_f32_16x16x32_bf16 v[184:187], a[184:187], a[180:183], v[184:187]
    s_sub_u32 s56, s68, s64
    ds_read_b64_tr_b16 a[184:185], v10 offset:4096
    v_and_b32 v56, s56, v56
    v_mfma_f32_16x16x32_bf16 v[188:191], a[192:195], a[180:183], v[188:191]
    buffer_load_dwordx4 a[152:155], v14, s[20:23], s37 offen offset:0 sc1
    v_mfma_f32_16x16x32_bf16 v[188:191], a[196:199], a[92:95], v[188:191]
    s_add_u32 s38, s46, 122880
    ds_read_b64_tr_b16 a[186:187], v10 offset:6144
    v_lshl_add_u32 v64, v57, 3, v56
    v_mfma_f32_16x16x32_bf16 v[180:183], a[196:199], a[88:91], v[180:183]
    s_addk_i32 m0, 4096
    ds_read_b64_tr_b16 a[188:189], v10 offset:12288
    v_add_u32 v55, s64, v64
    v_mfma_f32_16x16x32_bf16 v[180:183], a[192:195], a[176:179], v[180:183]
    s_or_b32 s57, s64, s43
    ds_read_b64_tr_b16 a[190:191], v10 offset:14336
    v_add_u32 v64, s57, v64
    v_mfma_f32_16x16x32_bf16 v[172:175], a[192:195], a[172:175], v[172:175]
    s_add_u32 s55, s43, 3670016
    v_lshrrev_b32 v56, 5, v1
    v_bfe_u32 v57, v1, 4, 1
    v_mfma_f32_16x16x32_bf16 v[172:175], a[196:199], a[84:87], v[172:175]
    s_add_u32 s56, s43, 3211264
    v_lshl_add_u32 v56, v57, 1, v56
    v_mul_u32_u24 v56, 2560, v56
    v_mfma_f32_16x16x32_bf16 v[164:167], a[196:199], a[80:83], v[164:167]
    s_waitcnt lgkmcnt(5)
    v_lshl_add_u32 v55, v55, 1, v56
    v_and_b32 v56, 0x7ff, v54
    v_mfma_f32_16x16x32_bf16 v[164:167], a[192:195], a[168:171], v[164:167]
    ds_read_b64_tr_b16 a[192:193], v11 offset:4096
    v_sub_u32 v56, 2047, v56
    v_mfma_f32_16x16x32_bf16 v[192:195], a[200:203], a[168:171], v[192:195]
    buffer_load_dwordx4 v2, s[8:11], s38 offen lds
    v_mfma_f32_16x16x32_bf16 v[192:195], a[204:207], a[80:83], v[192:195]
    ds_read_b64_tr_b16 a[194:195], v11 offset:6144
    v_mul_u32_u24 v57, 1280, v56
    v_mfma_f32_16x16x32_bf16 v[200:203], a[204:207], a[84:87], v[200:203]
    buffer_load_dwordx4 a[156:159], v14, s[20:23], s37 offen offset:1024 sc1
    v_mfma_f32_16x16x32_bf16 v[200:203], a[200:203], a[172:175], v[200:203]
    s_add_u32 s77, s7, 6
    ds_read_b64_tr_b16 a[196:197], v11 offset:12288
    v_add_u32 v57, v57, v64
    v_mfma_f32_16x16x32_bf16 v[208:211], a[200:203], a[176:179], v[208:211]
    buffer_load_dwordx2 v[66:67], v57, s[12:15], 0 offen
    v_mfma_f32_16x16x32_bf16 v[208:211], a[204:207], a[88:91], v[208:211]
    ds_read_b64_tr_b16 a[198:199], v11 offset:14336
    v_lshlrev_b32 v56, 3, v56
    v_mfma_f32_16x16x32_bf16 v[216:219], a[204:207], a[92:95], v[216:219]
    buffer_load_dwordx2 v[68:69], v56, s[24:27], s56 offen sc1
    v_mfma_f32_16x16x32_bf16 v[216:219], a[200:203], a[180:183], v[216:219]
    s_waitcnt lgkmcnt(5)
    v_and_b32 v54, 0xffff0000, v54
    v_ashrrev_i32 v56, 31, v54
    v_mfma_f32_16x16x32_bf16 v[220:223], a[208:211], a[180:183], v[220:223]
    s_add_u32 s38, s47, 122880
    v_not_b32 v56, v56
    v_or_b32 v56, 0x80000000, v56
    v_mfma_f32_16x16x32_bf16 v[220:223], a[212:215], a[92:95], v[220:223]
    s_addk_i32 m0, 4096
    v_xor_b32 v54, v54, v56
    v_and_b32 v54, 0xffff0000, v54
    v_mfma_f32_16x16x32_bf16 v[212:215], a[212:215], a[88:91], v[212:215]
    s_barrier
    v_mfma_f32_16x16x32_bf16 v[212:215], a[208:211], a[176:179], v[212:215]
    ds_read_b64_tr_b16 a[200:201], v12 offset:20480
    v_mul_f32 v54, s92, v54
    v_mfma_f32_16x16x32_bf16 v[204:207], a[208:211], a[172:175], v[204:207]
    buffer_load_dwordx4 a[160:163], v14, s[20:23], s37 offen offset:2048 sc1
    v_mfma_f32_16x16x32_bf16 v[204:207], a[212:215], a[84:87], v[204:207]
    ds_read_b64_tr_b16 a[202:203], v12 offset:21504
    v_mfma_f32_16x16x32_bf16 v[196:199], a[212:215], a[80:83], v[196:199]
    buffer_load_dwordx4 v2, s[8:11], s38 offen lds
    v_mfma_f32_16x16x32_bf16 v[196:199], a[208:211], a[168:171], v[196:199]
    s_waitcnt lgkmcnt(4)
    ds_read_b64_tr_b16 a[204:205], v13 offset:20480
    v_mfma_f32_16x16x32_bf16 v[224:227], a[184:187], a[168:171], v[224:227]
    ds_read_b64_tr_b16 a[206:207], v13 offset:21504
    v_mfma_f32_16x16x32_bf16 v[224:227], a[188:191], a[80:83], v[224:227]
    ds_read_b64_tr_b16 a[208:209], v8 offset:20480
    v_mfma_f32_16x16x32_bf16 v[232:235], a[188:191], a[84:87], v[232:235]
    ds_read_b64_tr_b16 a[210:211], v8 offset:22528
    v_mfma_f32_16x16x32_bf16 v[232:235], a[184:187], a[172:175], v[232:235]
    ds_read_b64_tr_b16 a[212:213], v9 offset:20480
    v_mfma_f32_16x16x32_bf16 v[240:243], a[184:187], a[176:179], v[240:243]
    s_add_u32 s38, s45, 163840
    ds_read_b64_tr_b16 a[214:215], v9 offset:22528
    v_mfma_f32_16x16x32_bf16 v[240:243], a[188:191], a[88:91], v[240:243]
    v_exp_f32 v54, v54
    v_mfma_f32_16x16x32_bf16 v[248:251], a[188:191], a[92:95], v[248:251]
    buffer_load_dwordx4 a[164:167], v14, s[20:23], s37 offen offset:3072 sc1
    v_mfma_f32_16x16x32_bf16 v[248:251], a[184:187], a[180:183], v[248:251]
    s_waitcnt lgkmcnt(6)
    ds_read_b64_tr_b16 a[188:189], v11 offset:20480
    v_add_f32 v54, 1.0, v54
    v_mfma_f32_16x16x32_bf16 v[252:255], a[192:195], a[180:183], v[252:255]
    s_addk_i32 m0, 4096
    ds_read_b64_tr_b16 a[190:191], v11 offset:22528
    s_sub_u32 s78, s72, s77
    v_mfma_f32_16x16x32_bf16 v[252:255], a[196:199], a[92:95], v[252:255]
    s_sub_u32 s79, s73, s77
    ds_read_b64_tr_b16 a[184:185], v10 offset:20480
    s_max_u32 s78, s78, s79
    v_mfma_f32_16x16x32_bf16 v[244:247], a[196:199], a[88:91], v[244:247]
    s_sub_u32 s79, s74, s77
    ds_read_b64_tr_b16 a[186:187], v10 offset:22528
    s_max_u32 s78, s78, s79
    v_mfma_f32_16x16x32_bf16 v[244:247], a[192:195], a[176:179], v[244:247]
    s_sub_u32 s79, s75, s77
    v_rcp_f32 v54, v54
    v_mfma_f32_16x16x32_bf16 v[236:239], a[192:195], a[172:175], v[236:239]
    buffer_load_dwordx4 v2, s[8:11], s38 offen lds
    v_mfma_f32_16x16x32_bf16 v[236:239], a[196:199], a[84:87], v[236:239]
    s_max_u32 s78, s78, s79
    v_cvt_pk_bf16_f32 v54, v54, v54
    v_and_b32 v54, 0xffff0000, v54
    v_mfma_f32_16x16x32_bf16 v[228:231], a[196:199], a[80:83], v[228:231]
    s_waitcnt lgkmcnt(3)
    s_add_u32 s37, s59, 20480
    v_mfma_f32_16x16x32_bf16 v[228:231], a[192:195], a[168:171], v[228:231]
    s_waitcnt vmcnt(24)
    ds_read_b64_tr_b16 a[192:193], v8 offset:24576
    v_lshlrev_b32 v20, 16, v32
    v_mfma_f32_16x16x32_bf16 v[96:99], a[200:203], a[96:99], v[96:99]
    s_cmp_gt_u32 s78, 0
    s_cbranch_scc1 spin_o5
spin_o5_ret:
    v_and_b32 v21, 0xffff0000, v32
    v_mfma_f32_16x16x32_bf16 v[100:103], a[204:207], a[96:99], v[100:103]
    buffer_load_dwordx4 a[168:171], v14, s[20:23], s37 offen offset:0 sc1
    v_mfma_f32_16x16x32_bf16 v[108:111], a[204:207], a[100:103], v[108:111]
    s_xor_b32 s77, s50, 2
    ds_read_b64_tr_b16 a[194:195], v8 offset:26624
    v_sub_f32 v20, v20, v38
    v_mfma_f32_16x16x32_bf16 v[104:107], a[200:203], a[100:103], v[104:107]
    s_lshl_b32 s77, s77, 10
    ds_read_b64_tr_b16 a[196:197], v9 offset:24576
    v_sub_f32 v21, v21, v38
    v_mfma_f32_16x16x32_bf16 v[112:115], a[200:203], a[104:107], v[112:115]
    s_add_u32 s38, s46, 163840
    ds_read_b64_tr_b16 a[198:199], v9 offset:26624
    v_cvt_pk_bf16_f32 v22, v20, v21
    v_mfma_f32_16x16x32_bf16 v[116:119], a[204:207], a[104:107], v[116:119]
    s_addk_i32 m0, 4096
    v_lshlrev_b32 v20, 16, v22
    v_and_b32 v21, 0xffff0000, v22
    v_mfma_f32_16x16x32_bf16 v[124:127], a[204:207], a[108:111], v[124:127]
    s_waitcnt vmcnt(22)
    ds_read_b64_tr_b16 a[204:205], v11 offset:24576
    v_mul_f32 v20, v20, v39
    v_mfma_f32_16x16x32_bf16 v[120:123], a[200:203], a[108:111], v[120:123]
    s_lshr_b32 s56, s2, 3
    ds_read_b64_tr_b16 a[206:207], v11 offset:26624
    v_mul_f32 v21, v21, v39
    v_mfma_f32_16x16x32_bf16 v[152:155], a[208:211], a[108:111], v[152:155]
    s_lshl2_add_u32 s56, s56, s3
    ds_read_b64_tr_b16 a[200:201], v10 offset:24576
    v_cvt_pk_bf16_f32 v22, v20, v21
    v_mfma_f32_16x16x32_bf16 v[156:159], a[212:215], a[108:111], v[156:159]
    s_lshl_b32 s56, s56, 7
    ds_read_b64_tr_b16 a[202:203], v10 offset:26624
    v_lshlrev_b32 v20, 16, v22
    v_mfma_f32_16x16x32_bf16 v[148:151], a[212:215], a[104:107], v[148:151]
    s_waitcnt lgkmcnt(5)
    v_and_b32 v21, 0xffff0000, v22
    v_mul_f32 v23, s92, v20
    v_mfma_f32_16x16x32_bf16 v[144:147], a[208:211], a[104:107], v[144:147]
    buffer_load_dwordx4 a[172:175], v14, s[20:23], s37 offen offset:1024 sc1
    v_mfma_f32_16x16x32_bf16 v[136:139], a[208:211], a[100:103], v[136:139]
    buffer_load_dwordx4 v2, s[8:11], s38 offen lds
    v_mfma_f32_16x16x32_bf16 v[140:143], a[212:215], a[100:103], v[140:143]
    s_add_u32 s56, s56, rare-code_end+16384
    v_exp_f32 v23, v23
    v_mfma_f32_16x16x32_bf16 v[132:135], a[212:215], a[96:99], v[132:135]
    ds_read_b64_tr_b16 a[212:213], v13 offset:22528
    v_mul_f32 v36, s92, v21
    v_mfma_f32_16x16x32_bf16 v[128:131], a[208:211], a[96:99], v[128:131]
    ds_read_b64_tr_b16 a[214:215], v13 offset:23552
    v_add_f32 v23, 1.0, v23
    v_mfma_f32_16x16x32_bf16 v[160:163], a[184:187], a[96:99], v[160:163]
    s_add_u32 s38, s47, 163840
    ds_read_b64_tr_b16 a[208:209], v12 offset:22528
    v_mov_b32 v70, s56
    v_mfma_f32_16x16x32_bf16 v[164:167], a[188:191], a[96:99], v[164:167]
    global_load_dword a252, v70, s[88:89]
    v_mfma_f32_16x16x32_bf16 v[172:175], a[188:191], a[100:103], v[172:175]
    s_addk_i32 m0, 4096
    ds_read_b64_tr_b16 a[210:211], v12 offset:23552
    v_mfma_f32_16x16x32_bf16 v[168:171], a[184:187], a[100:103], v[168:171]
    s_waitcnt vmcnt(22)
    v_exp_f32 v36, v36
    v_mfma_f32_16x16x32_bf16 v[176:179], a[184:187], a[104:107], v[176:179]
    buffer_load_dwordx4 a[176:179], v14, s[20:23], s37 offen offset:2048 sc1
    v_mfma_f32_16x16x32_bf16 v[180:183], a[188:191], a[104:107], v[180:183]
    v_rcp_f32 v23, v23
    v_mfma_f32_16x16x32_bf16 v[188:191], a[188:191], a[108:111], v[188:191]
    s_waitcnt lgkmcnt(2)
    v_add_f32 v36, 1.0, v36
    v_mul_f32 v20, v20, v23
    v_mfma_f32_16x16x32_bf16 v[184:187], a[184:187], a[108:111], v[184:187]
    ds_read_b64_tr_b16 a[184:185], v8 offset:28672
    v_mfma_f32_16x16x32_bf16 v[216:219], a[192:195], a[108:111], v[216:219]
    buffer_load_dwordx4 v2, s[8:11], s38 offen lds
    v_mfma_f32_16x16x32_bf16 v[220:223], a[196:199], a[108:111], v[220:223]
    ds_read_b64_tr_b16 a[186:187], v8 offset:30720
    v_mfma_f32_16x16x32_bf16 v[212:215], a[196:199], a[104:107], v[212:215]
    ds_read_b64_tr_b16 a[188:189], v9 offset:28672
    v_mfma_f32_16x16x32_bf16 v[208:211], a[192:195], a[104:107], v[208:211]
    ds_read_b64_tr_b16 a[190:191], v9 offset:30720
    v_mfma_f32_16x16x32_bf16 v[200:203], a[192:195], a[100:103], v[200:203]
    v_rcp_f32 v36, v36
    v_mfma_f32_16x16x32_bf16 v[204:207], a[196:199], a[100:103], v[204:207]
    v_mul_f32 v21, v21, v36
    v_cvt_pk_bf16_f32 v48, v20, v21
    v_mfma_f32_16x16x32_bf16 v[196:199], a[196:199], a[96:99], v[196:199]
    buffer_load_dwordx4 a[180:183], v14, s[20:23], s37 offen offset:3072 sc1
    v_mfma_f32_16x16x32_bf16 v[192:195], a[192:195], a[96:99], v[192:195]
    s_add_u32 s38, s45, 204800
    ds_read_b64_tr_b16 a[196:197], v11 offset:28672
    v_lshlrev_b32 v20, 16, v33
    v_mfma_f32_16x16x32_bf16 v[224:227], a[200:203], a[96:99], v[224:227]
    s_addk_i32 m0, 4096
    ds_read_b64_tr_b16 a[198:199], v11 offset:30720
    v_and_b32 v21, 0xffff0000, v33
    v_mfma_f32_16x16x32_bf16 v[228:231], a[204:207], a[96:99], v[228:231]
    ds_read_b64_tr_b16 a[192:193], v10 offset:28672
    v_sub_f32 v20, v20, v38
    v_mfma_f32_16x16x32_bf16 v[236:239], a[204:207], a[100:103], v[236:239]
    s_add_u32 s37, s60, 20480
    ds_read_b64_tr_b16 a[194:195], v10 offset:30720
    v_sub_f32 v21, v21, v38
    v_mfma_f32_16x16x32_bf16 v[232:235], a[200:203], a[100:103], v[232:235]
    v_cvt_pk_bf16_f32 v22, v20, v21
    v_lshlrev_b32 v20, 16, v22
    v_mfma_f32_16x16x32_bf16 v[240:243], a[200:203], a[104:107], v[240:243]
    v_and_b32 v21, 0xffff0000, v22
    v_mul_f32 v20, v20, v39
    v_mfma_f32_16x16x32_bf16 v[244:247], a[204:207], a[104:107], v[244:247]
    s_waitcnt lgkmcnt(4)
    v_mul_f32 v21, v21, v39
    v_cvt_pk_bf16_f32 v22, v20, v21
    v_mfma_f32_16x16x32_bf16 v[252:255], a[204:207], a[108:111], v[252:255]
    buffer_load_dwordx4 v2, s[8:11], s38 offen lds
    v_mfma_f32_16x16x32_bf16 v[248:251], a[200:203], a[108:111], v[248:251]
    ds_read_b64_tr_b16 a[200:201], v8 offset:32768
    v_lshlrev_b32 v20, 16, v22
    v_mfma_f32_16x16x32_bf16 v[120:123], a[208:211], a[124:127], v[120:123]
    buffer_load_dwordx4 a[80:83], v14, s[20:23], s37 offen offset:0 sc1
    v_mfma_f32_16x16x32_bf16 v[124:127], a[212:215], a[124:127], v[124:127]
    ds_read_b64_tr_b16 a[202:203], v8 offset:34816
    v_and_b32 v21, 0xffff0000, v22
    v_mfma_f32_16x16x32_bf16 v[116:119], a[212:215], a[120:123], v[116:119]
    ds_read_b64_tr_b16 a[204:205], v9 offset:32768
    v_mul_f32 v23, s92, v20
    v_mfma_f32_16x16x32_bf16 v[112:115], a[208:211], a[120:123], v[112:115]
    ds_read_b64_tr_b16 a[206:207], v9 offset:34816
    v_mul_f32 v36, s92, v21
    v_mfma_f32_16x16x32_bf16 v[104:107], a[208:211], a[116:119], v[104:107]
    s_add_u32 s38, s46, 204800
    v_exp_f32 v23, v23
    v_mfma_f32_16x16x32_bf16 v[108:111], a[212:215], a[116:119], v[108:111]
    v_exp_f32 v36, v36
    v_mfma_f32_16x16x32_bf16 v[100:103], a[212:215], a[112:115], v[100:103]
    s_addk_i32 m0, 4096
    ds_read_b64_tr_b16 a[212:213], v11 offset:32768
    v_add_f32 v23, 1.0, v23
    v_mfma_f32_16x16x32_bf16 v[96:99], a[208:211], a[112:115], v[96:99]
    ds_read_b64_tr_b16 a[214:215], v11 offset:34816
    v_add_f32 v36, 1.0, v36
    v_mfma_f32_16x16x32_bf16 v[128:131], a[184:187], a[112:115], v[128:131]
    ds_read_b64_tr_b16 a[208:209], v10 offset:32768
    v_mfma_f32_16x16x32_bf16 v[132:135], a[188:191], a[112:115], v[132:135]
    s_waitcnt lgkmcnt(4)
    ds_read_b64_tr_b16 a[210:211], v10 offset:34816
    v_mfma_f32_16x16x32_bf16 v[140:143], a[188:191], a[116:119], v[140:143]
    buffer_load_dwordx4 a[84:87], v14, s[20:23], s37 offen offset:1024 sc1
    v_mfma_f32_16x16x32_bf16 v[136:139], a[184:187], a[116:119], v[136:139]
    v_rcp_f32 v23, v23
    v_mfma_f32_16x16x32_bf16 v[144:147], a[184:187], a[120:123], v[144:147]
    buffer_load_dwordx4 v2, s[8:11], s38 offen lds
    v_mfma_f32_16x16x32_bf16 v[148:151], a[188:191], a[120:123], v[148:151]
    v_rcp_f32 v36, v36
    v_mfma_f32_16x16x32_bf16 v[156:159], a[188:191], a[124:127], v[156:159]
    v_permlane16_swap_b32 v24, v26
    v_mfma_f32_16x16x32_bf16 v[152:155], a[184:187], a[124:127], v[152:155]
    v_permlane16_swap_b32 v25, v27
    v_mfma_f32_16x16x32_bf16 v[184:187], a[192:195], a[124:127], v[184:187]
    v_mul_f32 v20, v20, v23
    v_mul_f32 v21, v21, v36
    v_mfma_f32_16x16x32_bf16 v[188:191], a[196:199], a[124:127], v[188:191]
    s_waitcnt lgkmcnt(0)
    v_cvt_pk_bf16_f32 v49, v20, v21
    v_lshlrev_b32 v20, 16, v24
    v_mfma_f32_16x16x32_bf16 v[180:183], a[196:199], a[120:123], v[180:183]
    s_barrier
    v_mfma_f32_16x16x32_bf16 v[176:179], a[192:195], a[120:123], v[176:179]
    s_add_u32 s38, s47, 204800
    ds_read_b64_tr_b16 a[184:185], v12 offset:49152
    v_and_b32 v21, 0xffff0000, v24
    v_mfma_f32_16x16x32_bf16 v[168:171], a[192:195], a[116:119], v[168:171]
    buffer_load_dwordx4 a[88:91], v14, s[20:23], s37 offen offset:2048 sc1
    v_mfma_f32_16x16x32_bf16 v[172:175], a[196:199], a[116:119], v[172:175]
    s_addk_i32 m0, 4096
    ds_read_b64_tr_b16 a[186:187], v12 offset:50176
    v_sub_f32 v20, v20, v16
    v_mfma_f32_16x16x32_bf16 v[164:167], a[196:199], a[112:115], v[164:167]
    s_waitcnt vmcnt(17)
    ds_read_b64_tr_b16 a[188:189], v12 offset:51200
    v_sub_f32 v21, v21, v16
    v_mfma_f32_16x16x32_bf16 v[160:163], a[192:195], a[112:115], v[160:163]
    ds_read_b64_tr_b16 a[190:191], v12 offset:52224
    v_cvt_pk_bf16_f32 v22, v20, v21
    v_mfma_f32_16x16x32_bf16 v[192:195], a[200:203], a[112:115], v[192:195]
    ds_read_b64_tr_b16 a[192:193], v13 offset:49152
    v_lshlrev_b32 v20, 16, v22
    v_mfma_f32_16x16x32_bf16 v[196:199], a[204:207], a[112:115], v[196:199]
    ds_read_b64_tr_b16 a[194:195], v13 offset:50176
    v_and_b32 v21, 0xffff0000, v22
    v_mfma_f32_16x16x32_bf16 v[204:207], a[204:207], a[116:119], v[204:207]
    buffer_load_dwordx4 v2, s[8:11], s38 offen lds
    v_mfma_f32_16x16x32_bf16 v[200:203], a[200:203], a[116:119], v[200:203]
    ds_read_b64_tr_b16 a[196:197], v13 offset:51200
    v_mul_f32 v20, v20, v17
    v_mfma_f32_16x16x32_bf16 v[208:211], a[200:203], a[120:123], v[208:211]
    ds_read_b64_tr_b16 a[198:199], v13 offset:52224
    v_lshlrev_b32 v50, 16, v66
    v_mfma_f32_16x16x32_bf16 v[212:215], a[204:207], a[120:123], v[212:215]
    s_waitcnt vmcnt(17)
    v_and_b32 v51, 0xffff0000, v66
    v_lshlrev_b32 v52, 16, v67
    v_mfma_f32_16x16x32_bf16 v[220:223], a[204:207], a[124:127], v[220:223]
    buffer_load_dwordx4 a[92:95], v14, s[20:23], s37 offen offset:3072 sc1
    v_mfma_f32_16x16x32_bf16 v[216:219], a[200:203], a[124:127], v[216:219]
    ds_read_b64_tr_b16 a[200:201], v12 offset:53248
    v_and_b32 v53, 0xffff0000, v67
    v_mfma_f32_16x16x32_bf16 v[248:251], a[208:211], a[124:127], v[248:251]
    ds_read_b64_tr_b16 a[202:203], v12 offset:54272
    v_sub_f32 v50, v50, v68
    v_mfma_f32_16x16x32_bf16 v[252:255], a[212:215], a[124:127], v[252:255]
    ds_read_b64_tr_b16 a[204:205], v12 offset:55296
    v_sub_f32 v51, v51, v68
    v_mfma_f32_16x16x32_bf16 v[244:247], a[212:215], a[120:123], v[244:247]
    s_waitcnt lgkmcnt(4)
    ds_read_b64_tr_b16 a[206:207], v12 offset:56320
    v_sub_f32 v52, v52, v68
    v_mfma_f32_16x16x32_bf16 v[240:243], a[208:211], a[120:123], v[240:243]
    s_add_u32 s37, s61, 20480
    v_sub_f32 v53, v53, v68
    v_cvt_pk_bf16_f32 v51, v50, v51
    v_mfma_f32_16x16x32_bf16 v[232:235], a[208:211], a[116:119], v[232:235]
    v_lshlrev_b32 v50, 16, v51
    v_and_b32 v51, 0xffff0000, v51
    v_mfma_f32_16x16x32_bf16 v[236:239], a[212:215], a[116:119], v[236:239]
    v_cvt_pk_bf16_f32 v53, v52, v53
    v_lshlrev_b32 v52, 16, v53
    v_mfma_f32_16x16x32_bf16 v[228:231], a[212:215], a[112:115], v[228:231]
    v_and_b32 v53, 0xffff0000, v53
    v_mul_f32 v50, v50, v69
    v_mfma_f32_16x16x32_bf16 v[224:227], a[208:211], a[112:115], v[224:227]
    ds_read_b64_tr_b16 a[208:209], v13 offset:53248
    v_mul_f32 v51, v51, v69
    v_mfma_f32_16x16x32_bf16 v[96:99], a[184:187], a[128:131], v[96:99]
    buffer_load_dwordx4 a[96:99], v14, s[20:23], s37 offen offset:0 sc1
    v_mfma_f32_16x16x32_bf16 v[96:99], a[188:191], a[0:3], v[96:99]
    ds_read_b64_tr_b16 a[210:211], v13 offset:54272
    v_mul_f32 v52, v52, v69
    v_mfma_f32_16x16x32_bf16 v[104:107], a[188:191], a[4:7], v[104:107]
    ds_read_b64_tr_b16 a[212:213], v13 offset:55296
    v_mul_f32 v53, v53, v69
    v_mfma_f32_16x16x32_bf16 v[104:107], a[184:187], a[132:135], v[104:107]
    ds_read_b64_tr_b16 a[214:215], v13 offset:56320
    v_cvt_pk_bf16_f32 v51, v50, v51
    v_mfma_f32_16x16x32_bf16 v[112:115], a[184:187], a[136:139], v[112:115]
    v_lshlrev_b32 v50, 16, v51
    v_and_b32 v51, 0xffff0000, v51
    v_mfma_f32_16x16x32_bf16 v[112:115], a[188:191], a[8:11], v[112:115]
    v_cvt_pk_bf16_f32 v53, v52, v53
    v_lshlrev_b32 v52, 16, v53
    v_mfma_f32_16x16x32_bf16 v[120:123], a[188:191], a[12:15], v[120:123]
    s_waitcnt lgkmcnt(3)
    v_and_b32 v53, 0xffff0000, v53
    v_mul_f32 v21, v21, v17
    v_mfma_f32_16x16x32_bf16 v[120:123], a[184:187], a[140:143], v[120:123]
    ds_read_b64_tr_b16 a[184:185], v12 offset:57344
    v_cvt_pk_bf16_f32 v22, v20, v21
    v_mfma_f32_16x16x32_bf16 v[124:127], a[192:195], a[140:143], v[124:127]
    ds_read_b64_tr_b16 a[186:187], v12 offset:58368
    v_lshlrev_b32 v20, 16, v22
    v_mfma_f32_16x16x32_bf16 v[124:127], a[196:199], a[12:15], v[124:127]
    ds_read_b64_tr_b16 a[188:189], v12 offset:59392
    v_and_b32 v21, 0xffff0000, v22
    v_mfma_f32_16x16x32_bf16 v[116:119], a[196:199], a[8:11], v[116:119]
    buffer_load_dwordx4 a[100:103], v14, s[20:23], s37 offen offset:1024 sc1
    v_mfma_f32_16x16x32_bf16 v[116:119], a[192:195], a[136:139], v[116:119]
    s_lshl2_add_u32 s60, s54, s51
    ds_read_b64_tr_b16 a[190:191], v12 offset:60416
    v_lshrrev_b32 v70, 1, v1
    v_mfma_f32_16x16x32_bf16 v[108:111], a[192:195], a[132:135], v[108:111]
    s_mul_i32 s60, s60, 163840
    v_min_u32 v70, 1, v70
    v_and_b32 v39, 7, v1
    v_mfma_f32_16x16x32_bf16 v[108:111], a[196:199], a[4:7], v[108:111]
    s_add_u32 s60, s60, 50331648
    v_mul_f32 v23, s92, v20
    v_mul_f32 v36, s92, v21
    v_mfma_f32_16x16x32_bf16 v[100:103], a[196:199], a[0:3], v[100:103]
    s_mul_i32 s56, s53, 2560
    v_exp_f32 v23, v23
    v_mfma_f32_16x16x32_bf16 v[100:103], a[192:195], a[128:131], v[100:103]
    s_add_u32 s59, s60, s56
    ds_read_b64_tr_b16 a[192:193], v13 offset:57344
    v_add_f32 v23, 1.0, v23
    v_mfma_f32_16x16x32_bf16 v[96:99], a[200:203], a[16:19], v[96:99]
    s_mul_i32 s56, s53, 20480
    ds_read_b64_tr_b16 a[194:195], v13 offset:58368
    s_add_u32 s60, s60, s56
    v_mfma_f32_16x16x32_bf16 v[96:99], a[204:207], a[32:35], v[96:99]
    s_andn2_b32 s61, s2, 7
    ds_read_b64_tr_b16 a[196:197], v13 offset:59392
    s_lshl_b32 s61, s61, 2
    v_mfma_f32_16x16x32_bf16 v[104:107], a[204:207], a[36:39], v[104:107]
    s_add_u32 s61, s61, s3
    ds_read_b64_tr_b16 a[198:199], v13 offset:60416
    s_lshl_b32 s61, s61, 7
    v_mfma_f32_16x16x32_bf16 v[104:107], a[200:203], a[20:23], v[104:107]
    s_waitcnt lgkmcnt(4)
    v_exp_f32 v36, v36
    v_mfma_f32_16x16x32_bf16 v[112:115], a[200:203], a[24:27], v[112:115]
    buffer_load_dwordx4 a[104:107], v14, s[20:23], s37 offen offset:2048 sc1
    v_mfma_f32_16x16x32_bf16 v[112:115], a[204:207], a[40:43], v[112:115]
    s_add_u32 s61, s61, 4194304
    v_rcp_f32 v23, v23
    v_mfma_f32_16x16x32_bf16 v[120:123], a[204:207], a[44:47], v[120:123]
    s_and_b32 s56, s53, 1
    v_xor_b32 v7, s56, v1
    v_add_u32 v2, 1, v7
    v_mfma_f32_16x16x32_bf16 v[120:123], a[200:203], a[28:31], v[120:123]
    s_andn2_b32 s56, 4, s53
    ds_read_b64_tr_b16 a[200:201], v12 offset:61440
    v_lshlrev_b32 v7, 2, v7
    v_mfma_f32_16x16x32_bf16 v[124:127], a[208:211], a[28:31], v[124:127]
    s_lshl_b32 s56, s56, 1
    ds_read_b64_tr_b16 a[202:203], v12 offset:62464
    v_lshl_add_u32 v7, v1, 9, v7
    v_mfma_f32_16x16x32_bf16 v[124:127], a[212:215], a[44:47], v[124:127]
    s_add_u32 s67, s61, s67
    ds_read_b64_tr_b16 a[204:205], v12 offset:63488
    v_lshl_or_b32 v7, v70, 30, v7
    v_mfma_f32_16x16x32_bf16 v[116:119], a[212:215], a[40:43], v[116:119]
    s_add_u32 s77, s61, s77
    ds_read_b64_tr_b16 a[206:207], v12 offset:64512
    v_lshrrev_b32 v70, 4, v1
    v_mfma_f32_16x16x32_bf16 v[116:119], a[208:211], a[24:27], v[116:119]
    s_add_u32 s38, s45, 81920
    v_lshl_add_u32 v39, v70, 3, v39
    v_lshlrev_b32 v39, 4, v39
    v_mfma_f32_16x16x32_bf16 v[108:111], a[208:211], a[20:23], v[108:111]
    s_add_u32 m0, s63, 135168
    v_and_b32 v70, 8, v1
    v_mul_u32_u24 v38, 1280, v70
    v_mfma_f32_16x16x32_bf16 v[108:111], a[212:215], a[36:39], v[108:111]
    buffer_load_dwordx4 v3, s[8:11], s38 offen lds
    v_mfma_f32_16x16x32_bf16 v[100:103], a[212:215], a[32:35], v[100:103]
pg_14:
    s_cbranch_execz pg_back
    buffer_load_dwordx4 a[108:111], v14, s[20:23], s37 offen offset:3072 sc1
    v_mfma_f32_16x16x32_bf16 v[100:103], a[208:211], a[16:19], v[100:103]
    s_add_u32 s38, s46, 81920
    ds_read_b64_tr_b16 a[208:209], v13 offset:61440
    v_add_u32 v38, v38, v39
    v_mfma_f32_16x16x32_bf16 v[96:99], a[184:187], a[48:51], v[96:99]
    s_addk_i32 m0, -4096
    ds_read_b64_tr_b16 a[210:211], v13 offset:62464
    v_xor_b32 v70, s56, v70
    v_mfma_f32_16x16x32_bf16 v[96:99], a[188:191], a[64:67], v[96:99]
    buffer_load_dwordx4 v3, s[8:11], s38 offen lds
    v_mfma_f32_16x16x32_bf16 v[104:107], a[188:191], a[68:71], v[104:107]
    s_add_u32 s38, s47, 81920
    ds_read_b64_tr_b16 a[212:213], v13 offset:63488
    v_add_u32 v39, v39, v70
    v_mfma_f32_16x16x32_bf16 v[104:107], a[184:187], a[52:55], v[104:107]
    s_waitcnt lgkmcnt(3)
    ds_read_b64_tr_b16 a[214:215], v13 offset:64512
    v_cmp_ne_u32 s[74:75], 0, v70
    v_mfma_f32_16x16x32_bf16 v[112:115], a[184:187], a[56:59], v[112:115]
    s_add_u32 m0, s63, 126976
    v_add_f32 v36, 1.0, v36
    v_mul_f32 v20, v20, v23
    v_mfma_f32_16x16x32_bf16 v[112:115], a[188:191], a[72:75], v[112:115]
    v_rcp_f32 v36, v36
    v_mfma_f32_16x16x32_bf16 v[120:123], a[188:191], a[76:79], v[120:123]
    v_mul_f32 v21, v21, v36
    v_cvt_pk_bf16_f32 v40, v20, v21
    v_mfma_f32_16x16x32_bf16 v[120:123], a[184:187], a[60:63], v[120:123]
    v_lshlrev_b32 v20, 16, v25
    v_and_b32 v21, 0xffff0000, v25
    v_mfma_f32_16x16x32_bf16 v[124:127], a[192:195], a[60:63], v[124:127]
    v_sub_f32 v20, v20, v16
    v_sub_f32 v21, v21, v16
    v_mfma_f32_16x16x32_bf16 v[124:127], a[196:199], a[76:79], v[124:127]
    v_cvt_pk_bf16_f32 v22, v20, v21
    v_lshlrev_b32 v20, 16, v22
    v_mfma_f32_16x16x32_bf16 v[116:119], a[196:199], a[72:75], v[116:119]
    buffer_load_dwordx4 v3, s[8:11], s38 offen lds
    v_mfma_f32_16x16x32_bf16 v[116:119], a[192:195], a[56:59], v[116:119]
    v_and_b32 v21, 0xffff0000, v22
    v_mul_f32 v20, v20, v17
    v_mfma_f32_16x16x32_bf16 v[108:111], a[192:195], a[52:55], v[108:111]
    v_mul_f32 v21, v21, v17
    v_cvt_pk_bf16_f32 v22, v20, v21
    v_mfma_f32_16x16x32_bf16 v[108:111], a[196:199], a[68:71], v[108:111]
    v_lshlrev_b32 v20, 16, v22
    v_and_b32 v21, 0xffff0000, v22
    v_mfma_f32_16x16x32_bf16 v[100:103], a[196:199], a[64:67], v[100:103]
    s_add_u32 s38, s45, 122880
    v_mul_f32 v23, s92, v20
    v_mul_f32 v36, s92, v21
    v_mfma_f32_16x16x32_bf16 v[100:103], a[192:195], a[48:51], v[100:103]
    v_exp_f32 v23, v23
    v_mfma_f32_16x16x32_bf16 v[96:99], a[200:203], a[216:219], v[96:99]
    s_addk_i32 m0, -4096
    v_exp_f32 v36, v36
    v_mfma_f32_16x16x32_bf16 v[96:99], a[204:207], a[232:235], v[96:99]
    v_add_f32 v23, 1.0, v23
    v_add_f32 v36, 1.0, v36
    v_mfma_f32_16x16x32_bf16 v[104:107], a[204:207], a[236:239], v[104:107]
    v_rcp_f32 v23, v23
    v_mfma_f32_16x16x32_bf16 v[104:107], a[200:203], a[220:223], v[104:107]
    v_rcp_f32 v36, v36
    v_mfma_f32_16x16x32_bf16 v[112:115], a[200:203], a[224:227], v[112:115]
    v_mul_f32 v20, v20, v23
    v_mul_f32 v21, v21, v36
    v_mfma_f32_16x16x32_bf16 v[112:115], a[204:207], a[240:243], v[112:115]
    s_waitcnt lgkmcnt(0)
    v_cvt_pk_bf16_f32 v41, v20, v21
    v_lshlrev_b32 v20, 16, v26
    v_mfma_f32_16x16x32_bf16 v[120:123], a[204:207], a[244:247], v[120:123]
    buffer_load_dwordx4 v3, s[8:11], s38 offen lds
    v_add_u32 v12, 65536, v12
    v_mfma_f32_16x16x32_bf16 v[120:123], a[200:203], a[228:231], v[120:123]
    ds_read_b64_tr_b16 a[184:185], v12 offset:0
    v_and_b32 v21, 0xffff0000, v26
    v_mfma_f32_16x16x32_bf16 v[124:127], a[208:211], a[228:231], v[124:127]
    ds_read_b64_tr_b16 a[186:187], v12 offset:1024
    v_sub_f32 v20, v20, v16
    v_mfma_f32_16x16x32_bf16 v[124:127], a[212:215], a[244:247], v[124:127]
    ds_read_b64_tr_b16 a[188:189], v12 offset:2048
    v_sub_f32 v21, v21, v16
    v_mfma_f32_16x16x32_bf16 v[116:119], a[212:215], a[240:243], v[116:119]
    s_add_u32 s38, s46, 122880
    ds_read_b64_tr_b16 a[190:191], v12 offset:3072
    v_cvt_pk_bf16_f32 v22, v20, v21
    v_mfma_f32_16x16x32_bf16 v[116:119], a[208:211], a[224:227], v[116:119]
    buffer_load_dword v58, v65, s[24:27], s41 offen sc1
    v_mfma_f32_16x16x32_bf16 v[108:111], a[208:211], a[220:223], v[108:111]
    buffer_load_dword v59, v65, s[24:27], s42 offen sc1
    v_mfma_f32_16x16x32_bf16 v[108:111], a[212:215], a[236:239], v[108:111]
    s_addk_i32 m0, -4096
    ds_read_b64_tr_b16 a[200:201], v12 offset:4096
    v_lshlrev_b32 v20, 16, v22
    v_mfma_f32_16x16x32_bf16 v[100:103], a[212:215], a[232:235], v[100:103]
    s_waitcnt vmcnt(23)
    ds_read_b64_tr_b16 a[202:203], v12 offset:5120
    v_and_b32 v21, 0xffff0000, v22
    v_add_u32 v13, 65536, v13
    v_mfma_f32_16x16x32_bf16 v[100:103], a[208:211], a[216:219], v[100:103]
    s_waitcnt vmcnt(22) lgkmcnt(4)
    ds_read_b64_tr_b16 a[192:193], v13 offset:0
    v_mul_f32 v20, v20, v17
    v_mfma_f32_16x16x32_bf16 v[96:99], a[184:187], a[152:155], v[96:99]
    s_waitcnt lgkmcnt(3)
    ds_read_b64_tr_b16 a[194:195], v13 offset:1024
    v_mul_f32 v21, v21, v17
    v_mfma_f32_16x16x32_bf16 v[96:99], a[188:191], a[168:171], v[96:99]
    ds_read_b64_tr_b16 a[196:197], v13 offset:2048
    v_cvt_pk_bf16_f32 v22, v20, v21
    v_mfma_f32_16x16x32_bf16 v[104:107], a[188:191], a[172:175], v[104:107]
    s_waitcnt vmcnt(19)
    ds_read_b64_tr_b16 a[198:199], v13 offset:3072
    v_lshlrev_b32 v20, 16, v22
    v_mfma_f32_16x16x32_bf16 v[104:107], a[184:187], a[156:159], v[104:107]
    buffer_load_dwordx4 v3, s[8:11], s38 offen lds
    v_mfma_f32_16x16x32_bf16 v[112:115], a[184:187], a[160:163], v[112:115]
    s_waitcnt vmcnt(18)
    ds_read_b64_tr_b16 a[204:205], v12 offset:6144
    v_and_b32 v21, 0xffff0000, v22
    v_mfma_f32_16x16x32_bf16 v[112:115], a[188:191], a[176:179], v[112:115]
    ds_read_b64_tr_b16 a[206:207], v12 offset:7168
    v_mul_f32 v23, s92, v20
    v_mfma_f32_16x16x32_bf16 v[120:123], a[188:191], a[180:183], v[120:123]
    s_add_u32 s38, s47, 122880
    ds_read_b64_tr_b16 a[208:209], v13 offset:4096
    v_mul_f32 v36, s92, v21
    v_mfma_f32_16x16x32_bf16 v[120:123], a[184:187], a[164:167], v[120:123]
    s_waitcnt lgkmcnt(5)
    ds_read_b64_tr_b16 a[210:211], v13 offset:5120
    v_mfma_f32_16x16x32_bf16 v[124:127], a[192:195], a[164:167], v[124:127]
    s_waitcnt lgkmcnt(4)
    ds_read_b64_tr_b16 a[212:213], v13 offset:6144
    s_addk_i32 m0, -4096
    v_mfma_f32_16x16x32_bf16 v[124:127], a[196:199], a[180:183], v[124:127]
    ds_read_b64_tr_b16 a[214:215], v13 offset:7168
    v_subrev_u32 v8, 73728, v8
    v_mfma_f32_16x16x32_bf16 v[116:119], a[196:199], a[176:179], v[116:119]
    s_barrier
    v_mfma_f32_16x16x32_bf16 v[116:119], a[192:195], a[160:163], v[116:119]
    ds_read_b64_tr_b16 a[184:185], v8 offset:0
    v_mfma_f32_16x16x32_bf16 v[108:111], a[192:195], a[156:159], v[108:111]
    ds_read_b64_tr_b16 a[186:187], v8 offset:2048
    v_mfma_f32_16x16x32_bf16 v[108:111], a[196:199], a[172:175], v[108:111]
    s_waitcnt vmcnt(16)
    ds_read_b64_tr_b16 a[188:189], v8 offset:4096
    v_mfma_f32_16x16x32_bf16 v[100:103], a[196:199], a[168:171], v[100:103]
    buffer_load_dwordx4 v3, s[8:11], s38 offen lds
    v_mfma_f32_16x16x32_bf16 v[100:103], a[192:195], a[152:155], v[100:103]
    s_waitcnt vmcnt(10) lgkmcnt(4)
    ds_read_b64_tr_b16 a[190:191], v8 offset:6144
    v_subrev_u32 v9, 73728, v9
    v_mfma_f32_16x16x32_bf16 v[96:99], a[200:203], a[80:83], v[96:99]
    ds_read_b64_tr_b16 a[192:193], v9 offset:0
    v_mfma_f32_16x16x32_bf16 v[96:99], a[204:207], a[96:99], v[96:99]
    ds_read_b64_tr_b16 a[194:195], v9 offset:2048
    v_mfma_f32_16x16x32_bf16 v[104:107], a[204:207], a[100:103], v[104:107]
    s_waitcnt vmcnt(9)
    ds_read_b64_tr_b16 a[196:197], v9 offset:4096
    s_add_u32 s38, s45, 163840
    v_mfma_f32_16x16x32_bf16 v[104:107], a[200:203], a[84:87], v[104:107]
    s_waitcnt vmcnt(7)
    ds_read_b64_tr_b16 a[198:199], v9 offset:6144
    v_cvt_pk_bf16_f32 v96, v96, v97
    v_mfma_f32_16x16x32_bf16 v[112:115], a[200:203], a[88:91], v[112:115]
    s_addk_i32 m0, -4096
    v_cvt_pk_bf16_f32 v97, v98, v99
    v_mfma_f32_16x16x32_bf16 v[112:115], a[204:207], a[104:107], v[112:115]
    s_xor_b32 s78, s53, 3
    v_cvt_pk_bf16_f32 v104, v104, v105
    v_cvt_pk_bf16_f32 v105, v106, v107
    v_mfma_f32_16x16x32_bf16 v[120:123], a[204:207], a[108:111], v[120:123]
    s_waitcnt lgkmcnt(4)
    v_exp_f32 v23, v23
    v_mfma_f32_16x16x32_bf16 v[120:123], a[200:203], a[92:95], v[120:123]
    s_and_b32 s78, s78, 3
    ds_read_b64_tr_b16 a[200:201], v8 offset:8192
    v_cvt_pk_bf16_f32 v112, v112, v113
    v_mfma_f32_16x16x32_bf16 v[124:127], a[208:211], a[92:95], v[124:127]
    s_mul_i32 s78, s78, 2560
    ds_read_b64_tr_b16 a[202:203], v8 offset:10240
    v_cvt_pk_bf16_f32 v113, v114, v115
    v_mfma_f32_16x16x32_bf16 v[124:127], a[212:215], a[108:111], v[124:127]
    s_add_u32 s78, s78, s60
    ds_read_b64_tr_b16 a[204:205], v8 offset:12288
    v_add_f32 v23, 1.0, v23
    v_mfma_f32_16x16x32_bf16 v[116:119], a[212:215], a[104:107], v[116:119]
    buffer_load_dwordx4 v3, s[8:11], s38 offen lds
    v_mfma_f32_16x16x32_bf16 v[116:119], a[208:211], a[88:91], v[116:119]
    s_xor_b32 s79, s53, 1
    ds_read_b64_tr_b16 a[206:207], v8 offset:14336
    s_and_b32 s79, s79, 3
    v_mfma_f32_16x16x32_bf16 v[108:111], a[208:211], a[84:87], v[108:111]
    s_mul_i32 s79, s79, 2560
    v_exp_f32 v36, v36
    v_mfma_f32_16x16x32_bf16 v[108:111], a[212:215], a[100:103], v[108:111]
    s_add_u32 s79, s79, s60
    v_cvt_pk_bf16_f32 v114, v116, v117
    v_cvt_pk_bf16_f32 v115, v118, v119
    v_mfma_f32_16x16x32_bf16 v[100:103], a[212:215], a[96:99], v[100:103]
    s_add_u32 s38, s46, 163840
    v_mov_b32_dpp v116, v120 row_ror:8 row_mask:0xf bank_mask:0xf
    v_mov_b32_dpp v117, v121 row_ror:8 row_mask:0xf bank_mask:0xf
    v_mfma_f32_16x16x32_bf16 v[100:103], a[208:211], a[80:83], v[100:103]
    ds_read_b64_tr_b16 a[208:209], v9 offset:8192
    v_cvt_pk_bf16_f32 v106, v108, v109
    v_mfma_f32_16x16x32_bf16 v[128:131], a[184:187], a[128:131], v[128:131]
    s_addk_i32 m0, -4096
    ds_read_b64_tr_b16 a[210:211], v9 offset:10240
    v_cvt_pk_bf16_f32 v107, v110, v111
    v_mfma_f32_16x16x32_bf16 v[128:131], a[188:191], a[0:3], v[128:131]
    ds_read_b64_tr_b16 a[212:213], v9 offset:12288
    v_cvt_pk_bf16_f32 v98, v100, v101
    v_mfma_f32_16x16x32_bf16 v[136:139], a[188:191], a[4:7], v[136:139]
    s_waitcnt lgkmcnt(3)
    ds_read_b64_tr_b16 a[214:215], v9 offset:14336
    v_cvt_pk_bf16_f32 v99, v102, v103
    v_mfma_f32_16x16x32_bf16 v[136:139], a[184:187], a[132:135], v[136:139]
    buffer_store_dwordx4 v[96:99], v38, s[24:27], s78 offen offset:2048 sc1
    v_mov_b32_dpp v118, v122 row_ror:8 row_mask:0xf bank_mask:0xf
    v_mfma_f32_16x16x32_bf16 v[144:147], a[184:187], a[136:139], v[144:147]
    s_xor_b32 s78, s53, 2
    v_mov_b32_dpp v119, v123 row_ror:8 row_mask:0xf bank_mask:0xf
    v_cvt_pk_bf16_f32 v120, v120, v121
    v_mfma_f32_16x16x32_bf16 v[144:147], a[188:191], a[8:11], v[144:147]
    s_and_b32 s78, s78, 3
    v_cvt_pk_bf16_f32 v121, v122, v123
    v_cvt_pk_bf16_f32 v122, v124, v125
    v_mfma_f32_16x16x32_bf16 v[152:155], a[188:191], a[12:15], v[152:155]
    buffer_load_dwordx4 v3, s[8:11], s38 offen lds
    v_mfma_f32_16x16x32_bf16 v[152:155], a[184:187], a[140:143], v[152:155]
    buffer_store_dwordx4 v[104:107], v38, s[24:27], s79 offen offset:2048 sc1
    v_cvt_pk_bf16_f32 v123, v126, v127
    v_mfma_f32_16x16x32_bf16 v[156:159], a[192:195], a[140:143], v[156:159]
    s_mul_i32 s78, s78, 2560
    ds_read_b64_tr_b16 a[184:185], v8 offset:16384
    v_add_f32 v36, 1.0, v36
    v_mfma_f32_16x16x32_bf16 v[156:159], a[196:199], a[12:15], v[156:159]
    s_add_u32 s78, s78, s60
    ds_read_b64_tr_b16 a[186:187], v8 offset:18432
    v_cndmask_b32 v124, v116, v124, s[74:75]
    v_mfma_f32_16x16x32_bf16 v[148:151], a[196:199], a[8:11], v[148:151]
    s_xor_b32 s79, s53, 0
    ds_read_b64_tr_b16 a[188:189], v8 offset:20480
    v_cndmask_b32 v125, v117, v125, s[74:75]
    v_mfma_f32_16x16x32_bf16 v[148:151], a[192:195], a[136:139], v[148:151]
    s_and_b32 s79, s79, 3
    ds_read_b64_tr_b16 a[190:191], v8 offset:22528
    v_cndmask_b32 v126, v118, v126, s[74:75]
    v_mfma_f32_16x16x32_bf16 v[140:143], a[192:195], a[132:135], v[140:143]
    s_mul_i32 s79, s79, 2560
    v_rcp_f32 v23, v23
    v_mfma_f32_16x16x32_bf16 v[140:143], a[196:199], a[4:7], v[140:143]
    s_add_u32 s79, s79, s60
    v_rcp_f32 v36, v36
    v_mfma_f32_16x16x32_bf16 v[132:135], a[196:199], a[0:3], v[132:135]
    s_add_u32 s38, s47, 163840
    v_mul_f32 v20, v20, v23
    v_mul_f32 v21, v21, v36
    v_mfma_f32_16x16x32_bf16 v[132:135], a[192:195], a[128:131], v[132:135]
    buffer_store_dwordx4 v[112:115], v38, s[24:27], s78 offen offset:2048 sc1
    v_cvt_pk_bf16_f32 v42, v20, v21
    v_mfma_f32_16x16x32_bf16 v[128:131], a[200:203], a[16:19], v[128:131]
    s_addk_i32 m0, -4096
    ds_read_b64_tr_b16 a[192:193], v9 offset:16384
    v_lshlrev_b32 v20, 16, v27
    v_mfma_f32_16x16x32_bf16 v[128:131], a[204:207], a[32:35], v[128:131]
    ds_read_b64_tr_b16 a[194:195], v9 offset:18432
    v_and_b32 v21, 0xffff0000, v27
    v_mfma_f32_16x16x32_bf16 v[136:139], a[204:207], a[36:39], v[136:139]
    buffer_load_dwordx4 v3, s[8:11], s38 offen lds
    v_mfma_f32_16x16x32_bf16 v[136:139], a[200:203], a[20:23], v[136:139]
    ds_read_b64_tr_b16 a[196:197], v9 offset:20480
    v_sub_f32 v20, v20, v16
    v_mfma_f32_16x16x32_bf16 v[144:147], a[200:203], a[24:27], v[144:147]
    s_waitcnt lgkmcnt(3)
    ds_read_b64_tr_b16 a[198:199], v9 offset:22528
    v_sub_f32 v21, v21, v16
    v_mfma_f32_16x16x32_bf16 v[144:147], a[204:207], a[40:43], v[144:147]
    v_lshlrev_b32 v16, 4, v2
    v_cvt_pk_bf16_f32 v22, v20, v21
    v_mfma_f32_16x16x32_bf16 v[152:155], a[204:207], a[44:47], v[152:155]
    s_add_u32 s38, s45, 204800
    v_lshlrev_b32 v20, 16, v22
    v_and_b32 v21, 0xffff0000, v22
    v_mfma_f32_16x16x32_bf16 v[152:155], a[200:203], a[28:31], v[152:155]
    buffer_store_dwordx4 v[120:123], v38, s[24:27], s79 offen offset:2048 sc1
    v_mul_f32 v20, v20, v17
    v_mfma_f32_16x16x32_bf16 v[156:159], a[208:211], a[28:31], v[156:159]
    s_addk_i32 m0, -4096
    v_mul_f32 v21, v21, v17
    v_lshlrev_b32 v17, 6, v2
    v_mfma_f32_16x16x32_bf16 v[156:159], a[212:215], a[44:47], v[156:159]
    v_cvt_pk_bf16_f32 v22, v20, v21
    v_lshlrev_b32 v20, 16, v22
    v_mfma_f32_16x16x32_bf16 v[148:151], a[212:215], a[40:43], v[148:151]
    s_barrier
    v_mfma_f32_16x16x32_bf16 v[148:151], a[208:211], a[24:27], v[148:151]
    s_waitcnt vmcnt(10)
    ds_read_b64_tr_b16 a[200:201], v8 offset:24576
    v_xor_b32 v58, s58, v58
    v_mfma_f32_16x16x32_bf16 v[140:143], a[208:211], a[20:23], v[140:143]
    s_waitcnt vmcnt(9)
    ds_read_b64_tr_b16 a[202:203], v8 offset:26624
    v_xor_b32 v59, s58, v59
    v_mfma_f32_16x16x32_bf16 v[140:143], a[212:215], a[36:39], v[140:143]
    ds_read_b64_tr_b16 a[204:205], v8 offset:28672
    v_or_b32 v58, v58, v59
    v_mfma_f32_16x16x32_bf16 v[132:135], a[212:215], a[32:35], v[132:135]
    buffer_load_dwordx4 v3, s[8:11], s38 offen lds
    v_mfma_f32_16x16x32_bf16 v[132:135], a[208:211], a[16:19], v[132:135]
    ds_read_b64_tr_b16 a[206:207], v8 offset:30720
    v_cmp_ne_u32 vcc, 0, v58
    v_mfma_f32_16x16x32_bf16 v[128:131], a[184:187], a[48:51], v[128:131]
    s_cbranch_vccnz spin_y
spin_y_ret:
    v_and_b32 v21, 0xffff0000, v22
    v_mfma_f32_16x16x32_bf16 v[128:131], a[188:191], a[64:67], v[128:131]
    ds_read_b64_tr_b16 a[208:209], v9 offset:24576
    v_mul_f32 v23, s92, v20
    v_mfma_f32_16x16x32_bf16 v[136:139], a[188:191], a[68:71], v[136:139]
    s_add_u32 s38, s46, 204800
    ds_read_b64_tr_b16 a[210:211], v9 offset:26624
    v_mul_f32 v36, s92, v21
    v_mfma_f32_16x16x32_bf16 v[136:139], a[184:187], a[52:55], v[136:139]
    ds_read_b64_tr_b16 a[212:213], v9 offset:28672
    v_cndmask_b32 v127, v119, v127, s[74:75]
    v_mfma_f32_16x16x32_bf16 v[144:147], a[184:187], a[56:59], v[144:147]
    s_waitcnt lgkmcnt(4)
    ds_read_b64_tr_b16 a[214:215], v9 offset:30720
    s_addk_i32 m0, -4096
    v_mfma_f32_16x16x32_bf16 v[144:147], a[188:191], a[72:75], v[144:147]
    buffer_load_dwordx4 v[116:119], v55, s[24:27], s55 offen sc1
    v_mfma_f32_16x16x32_bf16 v[152:155], a[188:191], a[76:79], v[152:155]
    s_add_u32 s55, s55, 10240
    v_exp_f32 v23, v23
    v_mfma_f32_16x16x32_bf16 v[152:155], a[184:187], a[60:63], v[152:155]
    buffer_load_dwordx4 v[120:123], v55, s[24:27], s55 offen sc1
    v_mfma_f32_16x16x32_bf16 v[156:159], a[192:195], a[60:63], v[156:159]
    s_add_u32 s55, s55, 10240
    ds_read_b64_tr_b16 a[184:185], v8 offset:32768
    v_add_f32 v23, 1.0, v23
    v_mfma_f32_16x16x32_bf16 v[156:159], a[196:199], a[76:79], v[156:159]
    buffer_load_dwordx4 v[56:59], v55, s[24:27], s55 offen sc1
    v_mfma_f32_16x16x32_bf16 v[148:151], a[196:199], a[72:75], v[148:151]
    buffer_load_dwordx4 v3, s[8:11], s38 offen lds
    v_mfma_f32_16x16x32_bf16 v[148:151], a[192:195], a[56:59], v[148:151]
    s_add_u32 s55, s55, 10240
    ds_read_b64_tr_b16 a[186:187], v8 offset:34816
    v_mfma_f32_16x16x32_bf16 v[140:143], a[192:195], a[52:55], v[140:143]
    buffer_load_dwordx4 v[60:63], v55, s[24:27], s55 offen sc1
    v_mfma_f32_16x16x32_bf16 v[140:143], a[196:199], a[68:71], v[140:143]
    s_add_u32 s55, s55, 10240
    ds_read_b64_tr_b16 a[188:189], v8 offset:36864
    v_mfma_f32_16x16x32_bf16 v[132:135], a[196:199], a[64:67], v[132:135]
    s_waitcnt lgkmcnt(3)
    ds_read_b64_tr_b16 a[190:191], v8 offset:38912
    s_add_u32 s38, s47, 204800
    v_mfma_f32_16x16x32_bf16 v[132:135], a[192:195], a[48:51], v[132:135]
    ds_read_b64_tr_b16 a[192:193], v9 offset:32768
    v_mfma_f32_16x16x32_bf16 v[128:131], a[200:203], a[216:219], v[128:131]
    buffer_load_dwordx4 v[64:67], v55, s[24:27], s55 offen sc1
    v_mfma_f32_16x16x32_bf16 v[128:131], a[204:207], a[232:235], v[128:131]
    s_add_u32 s55, s55, 10240
    ds_read_b64_tr_b16 a[194:195], v9 offset:34816
    s_addk_i32 m0, -4096
    v_mfma_f32_16x16x32_bf16 v[136:139], a[204:207], a[236:239], v[136:139]
    ds_read_b64_tr_b16 a[196:197], v9 offset:36864
    v_mfma_f32_16x16x32_bf16 v[136:139], a[200:203], a[220:223], v[136:139]
    ds_read_b64_tr_b16 a[198:199], v9 offset:38912
    v_mfma_f32_16x16x32_bf16 v[144:147], a[200:203], a[224:227], v[144:147]
    buffer_load_dwordx4 v[68:71], v55, s[24:27], s55 offen sc1
    v_mfma_f32_16x16x32_bf16 v[144:147], a[204:207], a[240:243], v[144:147]
    s_add_u32 s55, s55, 10240
    v_exp_f32 v36, v36
    v_mfma_f32_16x16x32_bf16 v[152:155], a[204:207], a[244:247], v[152:155]
    buffer_load_dwordx4 v3, s[8:11], s38 offen lds
    v_mfma_f32_16x16x32_bf16 v[152:155], a[200:203], a[228:231], v[152:155]
    ds_read_b64_tr_b16 a[200:201], v8 offset:40960
    v_add_f32 v36, 1.0, v36
    v_mfma_f32_16x16x32_bf16 v[156:159], a[208:211], a[228:231], v[156:159]
    buffer_load_dwordx4 v[72:75], v55, s[24:27], s55 offen sc1
    v_mfma_f32_16x16x32_bf16 v[156:159], a[212:215], a[244:247], v[156:159]
    s_add_u32 s55, s55, 10240
    ds_read_b64_tr_b16 a[202:203], v8 offset:43008
    v_mfma_f32_16x16x32_bf16 v[148:151], a[212:215], a[240:243], v[148:151]
    ds_read_b64_tr_b16 a[204:205], v8 offset:45056
    v_mfma_f32_16x16x32_bf16 v[148:151], a[208:211], a[224:227], v[148:151]
    s_waitcnt lgkmcnt(3)
    ds_read_b64_tr_b16 a[206:207], v8 offset:47104
    v_mfma_f32_16x16x32_bf16 v[140:143], a[208:211], a[220:223], v[140:143]
    buffer_load_dwordx4 v[76:79], v55, s[24:27], s55 offen sc1
    v_mfma_f32_16x16x32_bf16 v[140:143], a[212:215], a[236:239], v[140:143]
    s_add_u32 s55, s55, 10240
    v_rcp_f32 v23, v23
    v_mfma_f32_16x16x32_bf16 v[132:135], a[212:215], a[232:235], v[132:135]
    v_rcp_f32 v36, v36
    v_mfma_f32_16x16x32_bf16 v[132:135], a[208:211], a[216:219], v[132:135]
    ds_read_b64_tr_b16 a[208:209], v9 offset:40960
    v_mul_f32 v20, v20, v23
    v_mfma_f32_16x16x32_bf16 v[128:131], a[184:187], a[152:155], v[128:131]
    buffer_load_dwordx4 v[80:83], v55, s[24:27], s55 offen sc1
    v_mfma_f32_16x16x32_bf16 v[128:131], a[188:191], a[168:171], v[128:131]
    s_add_u32 s55, s55, 10240
    ds_read_b64_tr_b16 a[210:211], v9 offset:43008
    v_mul_f32 v21, v21, v36
    v_mfma_f32_16x16x32_bf16 v[136:139], a[188:191], a[172:175], v[136:139]
    ds_read_b64_tr_b16 a[212:213], v9 offset:45056
    v_cvt_pk_bf16_f32 v43, v20, v21
    v_mfma_f32_16x16x32_bf16 v[136:139], a[184:187], a[156:159], v[136:139]
    ds_read_b64_tr_b16 a[214:215], v9 offset:47104
    v_mfma_f32_16x16x32_bf16 v[144:147], a[184:187], a[160:163], v[144:147]
    buffer_load_dwordx4 v[84:87], v55, s[24:27], s55 offen sc1
    v_mfma_f32_16x16x32_bf16 v[144:147], a[188:191], a[176:179], v[144:147]
    s_add_u32 s55, s55, 10240
    v_permlane16_swap_b32 v28, v30
    v_mfma_f32_16x16x32_bf16 v[152:155], a[188:191], a[180:183], v[152:155]
    v_permlane16_swap_b32 v29, v31
    v_mfma_f32_16x16x32_bf16 v[152:155], a[184:187], a[164:167], v[152:155]
    v_lshlrev_b32 v20, 16, v28
    v_and_b32 v21, 0xffff0000, v28
    v_mfma_f32_16x16x32_bf16 v[156:159], a[192:195], a[164:167], v[156:159]
    buffer_load_dwordx4 v[88:91], v55, s[24:27], s55 offen sc1
    v_mfma_f32_16x16x32_bf16 v[156:159], a[196:199], a[180:183], v[156:159]
    s_add_u32 s55, s55, 10240
    v_sub_f32 v20, v20, v18
    v_sub_f32 v21, v21, v18
    v_mfma_f32_16x16x32_bf16 v[148:151], a[196:199], a[176:179], v[148:151]
    v_cvt_pk_bf16_f32 v22, v20, v21
    v_lshlrev_b32 v20, 16, v22
    v_mfma_f32_16x16x32_bf16 v[148:151], a[192:195], a[160:163], v[148:151]
    v_and_b32 v21, 0xffff0000, v22
    v_mul_f32 v20, v20, v19
    v_mfma_f32_16x16x32_bf16 v[140:143], a[192:195], a[156:159], v[140:143]
    buffer_load_dwordx4 v[92:95], v55, s[24:27], s55 offen sc1
    v_mfma_f32_16x16x32_bf16 v[140:143], a[196:199], a[172:175], v[140:143]
    s_waitcnt lgkmcnt(0)
    v_mul_f32 v21, v21, v19
    v_cvt_pk_bf16_f32 v22, v20, v21
    v_mfma_f32_16x16x32_bf16 v[132:135], a[196:199], a[168:171], v[132:135]
    v_lshlrev_b32 v20, 16, v22
    v_and_b32 v21, 0xffff0000, v22
    v_mfma_f32_16x16x32_bf16 v[132:135], a[192:195], a[152:155], v[132:135]
    v_mul_f32 v23, s92, v20
    v_mul_f32 v36, s92, v21
    v_mfma_f32_16x16x32_bf16 v[128:131], a[200:203], a[80:83], v[128:131]
    v_exp_f32 v23, v23
    v_mfma_f32_16x16x32_bf16 v[128:131], a[204:207], a[96:99], v[128:131]
    v_exp_f32 v36, v36
    v_mfma_f32_16x16x32_bf16 v[136:139], a[204:207], a[100:103], v[136:139]
    v_add_f32 v23, 1.0, v23
    v_add_f32 v36, 1.0, v36
    v_mfma_f32_16x16x32_bf16 v[136:139], a[200:203], a[84:87], v[136:139]
    v_rcp_f32 v23, v23
    v_mfma_f32_16x16x32_bf16 v[144:147], a[200:203], a[88:91], v[144:147]
    v_rcp_f32 v36, v36
    v_mfma_f32_16x16x32_bf16 v[144:147], a[204:207], a[104:107], v[144:147]
    s_xor_b32 s78, s53, 7
    v_cvt_pk_bf16_f32 v128, v128, v129
    v_cvt_pk_bf16_f32 v129, v130, v131
    v_mfma_f32_16x16x32_bf16 v[152:155], a[204:207], a[108:111], v[152:155]
    s_mul_i32 s78, s78, 2560
    v_cvt_pk_bf16_f32 v136, v136, v137
    v_cvt_pk_bf16_f32 v137, v138, v139
    v_mfma_f32_16x16x32_bf16 v[152:155], a[200:203], a[92:95], v[152:155]
    s_add_u32 s78, s78, s60
    v_cvt_pk_bf16_f32 v144, v144, v145
    v_cvt_pk_bf16_f32 v145, v146, v147
    v_subrev_u32 v10, 73728, v10
    v_mfma_f32_16x16x32_bf16 v[156:159], a[208:211], a[92:95], v[156:159]
    s_xor_b32 s79, s53, 6
    ds_read_b64_tr_b16 a[184:185], v10 offset:0
    v_mul_f32 v20, v20, v23
    v_mfma_f32_16x16x32_bf16 v[156:159], a[212:215], a[108:111], v[156:159]
    s_mul_i32 s79, s79, 2560
    ds_read_b64_tr_b16 a[186:187], v10 offset:2048
    v_cvt_pk_bf16_f32 v152, v152, v153
    ds_read_b64_tr_b16 a[188:189], v10 offset:4096
    v_mfma_f32_16x16x32_bf16 v[148:151], a[212:215], a[104:107], v[148:151]
    s_add_u32 s79, s79, s60
    ds_read_b64_tr_b16 a[190:191], v10 offset:6144
    v_cvt_pk_bf16_f32 v153, v154, v155
    v_mfma_f32_16x16x32_bf16 v[148:151], a[208:211], a[88:91], v[148:151]
    s_load_dwordx8 s[28:35], s[86:87], s93 glc
    ds_read_b64_tr_b16 a[200:201], v10 offset:8192
    v_cvt_pk_bf16_f32 v154, v156, v157
    v_mfma_f32_16x16x32_bf16 v[140:143], a[208:211], a[84:87], v[140:143]
    s_lshl_b32 s56, s3, 9
    ds_read_b64_tr_b16 a[202:203], v10 offset:10240
    v_cvt_pk_bf16_f32 v155, v158, v159
    v_mfma_f32_16x16x32_bf16 v[140:143], a[212:215], a[100:103], v[140:143]
    s_add_u32 s56, s56, 61440
    ds_read_b64_tr_b16 a[204:205], v10 offset:12288
    v_cvt_pk_bf16_f32 v146, v148, v149
    v_mfma_f32_16x16x32_bf16 v[132:135], a[212:215], a[96:99], v[132:135]
    ds_read_b64_tr_b16 a[206:207], v10 offset:14336
    v_cvt_pk_bf16_f32 v147, v150, v151
    v_mfma_f32_16x16x32_bf16 v[132:135], a[208:211], a[80:83], v[132:135]
    s_waitcnt lgkmcnt(6)
    v_cvt_pk_bf16_f32 v138, v140, v141
    v_cvt_pk_bf16_f32 v139, v142, v143
    v_subrev_u32 v11, 73728, v11
    v_mfma_f32_16x16x32_bf16 v[160:163], a[184:187], a[128:131], v[160:163]
    s_waitcnt lgkmcnt(4)
    ds_read_b64_tr_b16 a[192:193], v11 offset:0
    v_mul_f32 v21, v21, v36
    v_mfma_f32_16x16x32_bf16 v[160:163], a[188:191], a[0:3], v[160:163]
    ds_read_b64_tr_b16 a[194:195], v11 offset:2048
    v_cvt_pk_bf16_f32 v130, v132, v133
    ds_read_b64_tr_b16 a[196:197], v11 offset:4096
    v_mfma_f32_16x16x32_bf16 v[168:171], a[188:191], a[4:7], v[168:171]
    ds_read_b64_tr_b16 a[198:199], v11 offset:6144
    v_cvt_pk_bf16_f32 v131, v134, v135
    v_mfma_f32_16x16x32_bf16 v[168:171], a[184:187], a[132:135], v[168:171]
    buffer_store_dwordx4 v[128:131], v14, s[24:27], s78 offen offset:1024 sc1
    v_cvt_pk_bf16_f32 v44, v20, v21
    v_mfma_f32_16x16x32_bf16 v[176:179], a[184:187], a[136:139], v[176:179]
    ds_read_b64_tr_b16 a[208:209], v11 offset:8192
    v_lshlrev_b32 v20, 16, v29
    v_mfma_f32_16x16x32_bf16 v[176:179], a[188:191], a[8:11], v[176:179]
    buffer_store_dwordx4 v[136:139], v14, s[24:27], s78 offen offset:0 sc1
    v_and_b32 v21, 0xffff0000, v29
    v_mfma_f32_16x16x32_bf16 v[184:187], a[188:191], a[12:15], v[184:187]
    ds_read_b64_tr_b16 a[210:211], v11 offset:10240
    v_sub_f32 v20, v20, v18
    v_mfma_f32_16x16x32_bf16 v[184:187], a[184:187], a[140:143], v[184:187]
    s_waitcnt lgkmcnt(4)
    ds_read_b64_tr_b16 a[212:213], v11 offset:12288
    v_sub_f32 v21, v21, v18
    v_mfma_f32_16x16x32_bf16 v[188:191], a[192:195], a[140:143], v[188:191]
    s_waitcnt lgkmcnt(3)
    ds_read_b64_tr_b16 a[214:215], v11 offset:14336
    v_cvt_pk_bf16_f32 v22, v20, v21
    v_mfma_f32_16x16x32_bf16 v[188:191], a[196:199], a[12:15], v[188:191]
    ds_read_b64_tr_b16 a[184:185], v10 offset:16384
    v_lshlrev_b32 v20, 16, v22
    v_mfma_f32_16x16x32_bf16 v[180:183], a[196:199], a[8:11], v[180:183]
    ds_read_b64_tr_b16 a[186:187], v10 offset:18432
    v_and_b32 v21, 0xffff0000, v22
    v_mfma_f32_16x16x32_bf16 v[180:183], a[192:195], a[136:139], v[180:183]
    buffer_store_dwordx4 v[144:147], v14, s[24:27], s79 offen offset:1024 sc1
    v_mul_f32 v20, v20, v19
    v_mfma_f32_16x16x32_bf16 v[172:175], a[192:195], a[132:135], v[172:175]
    ds_read_b64_tr_b16 a[188:189], v10 offset:20480
    v_mul_f32 v21, v21, v19
    v_mfma_f32_16x16x32_bf16 v[172:175], a[196:199], a[4:7], v[172:175]
    s_waitcnt vmcnt(15)
    ds_read_b64_tr_b16 a[190:191], v10 offset:22528
    v_cvt_pk_bf16_f32 v22, v20, v21
    v_mfma_f32_16x16x32_bf16 v[164:167], a[196:199], a[0:3], v[164:167]
    v_lshlrev_b32 v20, 16, v22
    v_and_b32 v21, 0xffff0000, v22
    v_mfma_f32_16x16x32_bf16 v[164:167], a[192:195], a[128:131], v[164:167]
    ds_read_b64_tr_b16 a[192:193], v11 offset:16384
    v_mul_f32 v23, s92, v20
    v_mfma_f32_16x16x32_bf16 v[160:163], a[200:203], a[16:19], v[160:163]
    ds_read_b64_tr_b16 a[194:195], v11 offset:18432
    v_mul_f32 v36, s92, v21
    v_mfma_f32_16x16x32_bf16 v[160:163], a[204:207], a[32:35], v[160:163]
    buffer_store_dwordx4 v[152:155], v14, s[24:27], s79 offen offset:0 sc1
    v_add_f32 v116, v116, v120
    v_mfma_f32_16x16x32_bf16 v[168:171], a[204:207], a[36:39], v[168:171]
    s_waitcnt vmcnt(15)
    ds_read_b64_tr_b16 a[196:197], v11 offset:20480
    v_add_f32 v117, v117, v121
    v_mfma_f32_16x16x32_bf16 v[168:171], a[200:203], a[20:23], v[168:171]
    s_waitcnt lgkmcnt(6)
    ds_read_b64_tr_b16 a[198:199], v11 offset:22528
    v_add_f32 v118, v118, v122
    v_mfma_f32_16x16x32_bf16 v[176:179], a[200:203], a[24:27], v[176:179]
    v_exp_f32 v23, v23
    v_mfma_f32_16x16x32_bf16 v[176:179], a[204:207], a[40:43], v[176:179]
    v_exp_f32 v36, v36
    v_mfma_f32_16x16x32_bf16 v[184:187], a[204:207], a[44:47], v[184:187]
    v_add_f32 v23, 1.0, v23
    v_add_f32 v36, 1.0, v36
    v_mfma_f32_16x16x32_bf16 v[184:187], a[200:203], a[28:31], v[184:187]
    ds_read_b64_tr_b16 a[200:201], v10 offset:24576
    v_add_f32 v119, v119, v123
    v_mfma_f32_16x16x32_bf16 v[188:191], a[208:211], a[28:31], v[188:191]
    ds_read_b64_tr_b16 a[202:203], v10 offset:26624
    v_add_f32 v116, v116, v56
    v_mfma_f32_16x16x32_bf16 v[188:191], a[212:215], a[44:47], v[188:191]
    s_waitcnt vmcnt(13)
    ds_read_b64_tr_b16 a[204:205], v10 offset:28672
    v_add_f32 v117, v117, v57
    v_mfma_f32_16x16x32_bf16 v[180:183], a[212:215], a[40:43], v[180:183]
    ds_read_b64_tr_b16 a[206:207], v10 offset:30720
    v_add_f32 v118, v118, v58
    v_mfma_f32_16x16x32_bf16 v[180:183], a[208:211], a[24:27], v[180:183]
    s_waitcnt lgkmcnt(6)
    v_rcp_f32 v23, v23
    v_mfma_f32_16x16x32_bf16 v[172:175], a[208:211], a[20:23], v[172:175]
pg_15:
    s_cbranch_execz pg_back
    v_rcp_f32 v36, v36
    v_mfma_f32_16x16x32_bf16 v[172:175], a[212:215], a[36:39], v[172:175]
    v_mul_f32 v20, v20, v23
    v_mul_f32 v21, v21, v36
    v_mfma_f32_16x16x32_bf16 v[164:167], a[212:215], a[32:35], v[164:167]
    v_cvt_pk_bf16_f32 v45, v20, v21
    v_lshlrev_b32 v20, 16, v30
    v_mfma_f32_16x16x32_bf16 v[164:167], a[208:211], a[16:19], v[164:167]
    ds_read_b64_tr_b16 a[208:209], v11 offset:24576
    v_and_b32 v21, 0xffff0000, v30
    v_mfma_f32_16x16x32_bf16 v[160:163], a[184:187], a[48:51], v[160:163]
    ds_read_b64_tr_b16 a[210:211], v11 offset:26624
    v_sub_f32 v20, v20, v18
    v_mfma_f32_16x16x32_bf16 v[160:163], a[188:191], a[64:67], v[160:163]
    ds_read_b64_tr_b16 a[212:213], v11 offset:28672
    v_sub_f32 v21, v21, v18
    v_mfma_f32_16x16x32_bf16 v[168:171], a[188:191], a[68:71], v[168:171]
    s_or_b64 s[88:89], s[28:29], s[30:31]
    ds_read_b64_tr_b16 a[214:215], v11 offset:30720
    v_cvt_pk_bf16_f32 v22, v20, v21
    v_mfma_f32_16x16x32_bf16 v[168:171], a[184:187], a[52:55], v[168:171]
    s_or_b64 s[88:89], s[88:89], s[32:33]
    v_lshlrev_b32 v20, 16, v22
    v_and_b32 v21, 0xffff0000, v22
    v_mfma_f32_16x16x32_bf16 v[176:179], a[184:187], a[56:59], v[176:179]
    s_or_b64 s[88:89], s[88:89], s[34:35]
    v_mul_f32 v20, v20, v19
    v_mul_f32 v21, v21, v19
    v_mfma_f32_16x16x32_bf16 v[176:179], a[188:191], a[72:75], v[176:179]
    s_or_b32 s66, s88, s89
    v_cvt_pk_bf16_f32 v22, v20, v21
    v_lshlrev_b32 v20, 16, v22
    v_mfma_f32_16x16x32_bf16 v[184:187], a[188:191], a[76:79], v[184:187]
    s_waitcnt lgkmcnt(5)
    v_and_b32 v21, 0xffff0000, v22
    v_mul_f32 v23, s92, v20
    v_mfma_f32_16x16x32_bf16 v[184:187], a[184:187], a[60:63], v[184:187]
    ds_read_b64_tr_b16 a[184:185], v10 offset:32768
    v_mul_f32 v36, s92, v21
    v_mfma_f32_16x16x32_bf16 v[188:191], a[192:195], a[60:63], v[188:191]
    s_andn2_b32 s69, s66, s80
    s_cselect_b32 s65, s59, 0x70000000
    v_add_f32 v119, v119, v59
    v_mfma_f32_16x16x32_bf16 v[188:191], a[196:199], a[76:79], v[188:191]
    s_ff1_i32_b32 s69, s69
    ds_read_b64_tr_b16 a[186:187], v10 offset:34816
    v_add_f32 v116, v116, v60
    v_mfma_f32_16x16x32_bf16 v[180:183], a[196:199], a[72:75], v[180:183]
    s_xor_b32 s81, s53, s69
    ds_read_b64_tr_b16 a[188:189], v10 offset:36864
    v_add_f32 v117, v117, v61
    v_mfma_f32_16x16x32_bf16 v[180:183], a[192:195], a[56:59], v[180:183]
    s_mul_i32 s81, s81, 20480
    ds_read_b64_tr_b16 a[190:191], v10 offset:38912
    v_add_f32 v118, v118, v62
    v_mfma_f32_16x16x32_bf16 v[172:175], a[192:195], a[52:55], v[172:175]
    s_add_u32 s81, s81, s65
    v_exp_f32 v23, v23
    v_mfma_f32_16x16x32_bf16 v[172:175], a[196:199], a[68:71], v[172:175]
    s_bitset1_b32 s80, s69
    v_exp_f32 v36, v36
    v_mfma_f32_16x16x32_bf16 v[164:167], a[196:199], a[64:67], v[164:167]
    s_waitcnt lgkmcnt(3)
    v_add_f32 v23, 1.0, v23
    v_add_f32 v36, 1.0, v36
    v_mfma_f32_16x16x32_bf16 v[164:167], a[192:195], a[48:51], v[164:167]
    s_waitcnt vmcnt(12)
    ds_read_b64_tr_b16 a[192:193], v11 offset:32768
    v_add_f32 v119, v119, v63
    v_mfma_f32_16x16x32_bf16 v[160:163], a[200:203], a[216:219], v[160:163]
    ds_read_b64_tr_b16 a[194:195], v11 offset:34816
    v_add_f32 v116, v116, v64
    v_mfma_f32_16x16x32_bf16 v[160:163], a[204:207], a[232:235], v[160:163]
    s_waitcnt vmcnt(11)
    ds_read_b64_tr_b16 a[196:197], v11 offset:36864
    v_add_f32 v117, v117, v65
    v_mfma_f32_16x16x32_bf16 v[168:171], a[204:207], a[236:239], v[168:171]
    ds_read_b64_tr_b16 a[198:199], v11 offset:38912
    v_add_f32 v118, v118, v66
    v_mfma_f32_16x16x32_bf16 v[168:171], a[200:203], a[220:223], v[168:171]
    v_rcp_f32 v23, v23
    v_mfma_f32_16x16x32_bf16 v[176:179], a[200:203], a[224:227], v[176:179]
    buffer_load_dwordx4 v[98:101], v14, s[24:27], s81 offen sc1
    v_mfma_f32_16x16x32_bf16 v[176:179], a[204:207], a[240:243], v[176:179]
    v_rcp_f32 v36, v36
    v_mfma_f32_16x16x32_bf16 v[184:187], a[204:207], a[244:247], v[184:187]
    v_mul_f32 v20, v20, v23
    v_mul_f32 v21, v21, v36
    v_mfma_f32_16x16x32_bf16 v[184:187], a[200:203], a[228:231], v[184:187]
    buffer_load_dwordx4 v[102:105], v14, s[24:27], s81 offen offset:1024 sc1
    v_mfma_f32_16x16x32_bf16 v[188:191], a[208:211], a[228:231], v[188:191]
    ds_read_b64_tr_b16 a[200:201], v10 offset:40960
    v_cvt_pk_bf16_f32 v46, v20, v21
    v_mfma_f32_16x16x32_bf16 v[188:191], a[212:215], a[244:247], v[188:191]
    ds_read_b64_tr_b16 a[202:203], v10 offset:43008
    v_lshlrev_b32 v20, 16, v31
    v_mfma_f32_16x16x32_bf16 v[180:183], a[212:215], a[240:243], v[180:183]
    buffer_load_dwordx2 v[96:97], v39, s[24:27], s81 offen offset:2048 sc1
    v_mfma_f32_16x16x32_bf16 v[180:183], a[208:211], a[224:227], v[180:183]
    ds_read_b64_tr_b16 a[204:205], v10 offset:45056
    v_and_b32 v21, 0xffff0000, v31
    v_mfma_f32_16x16x32_bf16 v[172:175], a[208:211], a[220:223], v[172:175]
    ds_read_b64_tr_b16 a[206:207], v10 offset:47104
    v_sub_f32 v20, v20, v18
    v_mfma_f32_16x16x32_bf16 v[172:175], a[212:215], a[236:239], v[172:175]
    s_waitcnt lgkmcnt(4)
    v_sub_f32 v21, v21, v18
    v_cvt_pk_bf16_f32 v22, v20, v21
    v_mfma_f32_16x16x32_bf16 v[164:167], a[212:215], a[232:235], v[164:167]
    v_lshlrev_b32 v20, 16, v22
    v_and_b32 v21, 0xffff0000, v22
    v_mfma_f32_16x16x32_bf16 v[164:167], a[208:211], a[216:219], v[164:167]
    ds_read_b64_tr_b16 a[208:209], v11 offset:40960
    v_mul_f32 v20, v20, v19
    v_mfma_f32_16x16x32_bf16 v[160:163], a[184:187], a[152:155], v[160:163]
    ds_read_b64_tr_b16 a[210:211], v11 offset:43008
    v_mul_f32 v21, v21, v19
    v_mfma_f32_16x16x32_bf16 v[160:163], a[188:191], a[168:171], v[160:163]
    ds_read_b64_tr_b16 a[212:213], v11 offset:45056
    v_cvt_pk_bf16_f32 v22, v20, v21
    v_mfma_f32_16x16x32_bf16 v[168:171], a[188:191], a[172:175], v[168:171]
    ds_read_b64_tr_b16 a[214:215], v11 offset:47104
    v_lshlrev_b32 v20, 16, v22
    v_mfma_f32_16x16x32_bf16 v[168:171], a[184:187], a[156:159], v[168:171]
    s_waitcnt vmcnt(3)
    v_and_b32 v21, 0xffff0000, v22
    v_mul_f32 v23, s92, v20
    v_mfma_f32_16x16x32_bf16 v[176:179], a[184:187], a[160:163], v[176:179]
    buffer_store_dword v17, v7, s[24:27], s67 offen offset:24 sc1
    v_mfma_f32_16x16x32_bf16 v[176:179], a[188:191], a[176:179], v[176:179]
    s_xor_b32 s67, s50, 1
    v_lshlrev_b32 v17, 2, v2
    v_mul_f32 v36, s92, v21
    v_mfma_f32_16x16x32_bf16 v[184:187], a[188:191], a[180:183], v[184:187]
    s_lshl_b32 s67, s67, 10
    v_exp_f32 v23, v23
    v_mfma_f32_16x16x32_bf16 v[184:187], a[184:187], a[164:167], v[184:187]
    s_add_u32 s67, s61, s67
    v_exp_f32 v36, v36
    v_mfma_f32_16x16x32_bf16 v[188:191], a[192:195], a[164:167], v[188:191]
    v_add_f32 v23, 1.0, v23
    v_add_f32 v36, 1.0, v36
    v_mfma_f32_16x16x32_bf16 v[188:191], a[196:199], a[180:183], v[188:191]
    v_rcp_f32 v23, v23
    v_mfma_f32_16x16x32_bf16 v[180:183], a[196:199], a[176:179], v[180:183]
    s_barrier
    v_mfma_f32_16x16x32_bf16 v[180:183], a[192:195], a[160:163], v[180:183]
    v_rcp_f32 v36, v36
    v_mfma_f32_16x16x32_bf16 v[172:175], a[192:195], a[156:159], v[172:175]
    v_mul_f32 v20, v20, v23
    v_mul_f32 v21, v21, v36
    v_mfma_f32_16x16x32_bf16 v[172:175], a[196:199], a[172:175], v[172:175]
    s_waitcnt lgkmcnt(0)
    v_cvt_pk_bf16_f32 v47, v20, v21
    v_add_f32 v119, v119, v67
    v_mfma_f32_16x16x32_bf16 v[164:167], a[196:199], a[168:171], v[164:167]
    v_add_f32 v116, v116, v68
    v_add_f32 v117, v117, v69
    v_mfma_f32_16x16x32_bf16 v[164:167], a[192:195], a[152:155], v[164:167]
    v_add_f32 v118, v118, v70
    v_add_f32 v119, v119, v71
    v_mfma_f32_16x16x32_bf16 v[160:163], a[200:203], a[80:83], v[160:163]
    s_load_dwordx8 s[28:35], s[86:87], s93 glc
    v_add_f32 v116, v116, v72
    v_add_f32 v117, v117, v73
    v_mfma_f32_16x16x32_bf16 v[160:163], a[204:207], a[96:99], v[160:163]
    v_add_f32 v118, v118, v74
    v_add_f32 v119, v119, v75
    v_mfma_f32_16x16x32_bf16 v[168:171], a[204:207], a[100:103], v[168:171]
    v_add_f32 v116, v116, v76
    v_add_f32 v117, v117, v77
    v_mfma_f32_16x16x32_bf16 v[168:171], a[200:203], a[84:87], v[168:171]
    v_add_f32 v118, v118, v78
    v_add_f32 v119, v119, v79
    v_mfma_f32_16x16x32_bf16 v[176:179], a[200:203], a[88:91], v[176:179]
    v_cvt_pk_bf16_f32 v160, v160, v161
    v_cvt_pk_bf16_f32 v161, v162, v163
    v_mfma_f32_16x16x32_bf16 v[176:179], a[204:207], a[104:107], v[176:179]
    s_xor_b32 s78, s53, 5
    v_add_f32 v116, v116, v80
    v_cvt_pk_bf16_f32 v168, v168, v169
    v_mfma_f32_16x16x32_bf16 v[184:187], a[204:207], a[108:111], v[184:187]
    s_mul_i32 s78, s78, 2560
    v_cvt_pk_bf16_f32 v169, v170, v171
    v_add_f32 v117, v117, v81
    v_mfma_f32_16x16x32_bf16 v[184:187], a[200:203], a[92:95], v[184:187]
    s_add_u32 s78, s78, s60
    v_cvt_pk_bf16_f32 v176, v176, v177
    v_cvt_pk_bf16_f32 v177, v178, v179
    v_add_u32 v8, 90112, v8
    v_mfma_f32_16x16x32_bf16 v[188:191], a[208:211], a[92:95], v[188:191]
    s_xor_b32 s79, s53, 4
    ds_read_b64_tr_b16 a[184:185], v8 offset:45056
    v_add_f32 v118, v118, v82
    v_mfma_f32_16x16x32_bf16 v[188:191], a[212:215], a[108:111], v[188:191]
    s_mul_i32 s79, s79, 2560
    ds_read_b64_tr_b16 a[186:187], v8 offset:47104
    v_cvt_pk_bf16_f32 v184, v184, v185
    ds_read_b64_tr_b16 a[188:189], v8 offset:40960
    v_mfma_f32_16x16x32_bf16 v[180:183], a[212:215], a[104:107], v[180:183]
    s_add_u32 s79, s79, s60
    ds_read_b64_tr_b16 a[190:191], v8 offset:43008
    v_cvt_pk_bf16_f32 v185, v186, v187
    v_mfma_f32_16x16x32_bf16 v[180:183], a[208:211], a[88:91], v[180:183]
    ds_read_b64_tr_b16 a[200:201], v8 offset:36864
    v_cvt_pk_bf16_f32 v186, v188, v189
    v_mfma_f32_16x16x32_bf16 v[172:175], a[208:211], a[84:87], v[172:175]
    ds_read_b64_tr_b16 a[202:203], v8 offset:38912
    v_cvt_pk_bf16_f32 v187, v190, v191
    v_mfma_f32_16x16x32_bf16 v[172:175], a[212:215], a[100:103], v[172:175]
    ds_read_b64_tr_b16 a[204:205], v8 offset:32768
    v_add_f32 v119, v119, v83
    v_mfma_f32_16x16x32_bf16 v[164:167], a[212:215], a[96:99], v[164:167]
    ds_read_b64_tr_b16 a[206:207], v8 offset:34816
    v_cvt_pk_bf16_f32 v178, v180, v181
    v_mfma_f32_16x16x32_bf16 v[164:167], a[208:211], a[80:83], v[164:167]
    s_waitcnt lgkmcnt(6)
    v_cvt_pk_bf16_f32 v179, v182, v183
    v_cvt_pk_bf16_f32 v170, v172, v173
    v_add_u32 v9, 90112, v9
    v_mfma_f32_16x16x32_bf16 v[192:195], a[184:187], a[128:131], v[192:195]
    s_waitcnt lgkmcnt(4)
    ds_read_b64_tr_b16 a[192:193], v9 offset:45056
    v_cvt_pk_bf16_f32 v171, v174, v175
    v_mfma_f32_16x16x32_bf16 v[192:195], a[188:191], a[0:3], v[192:195]
    ds_read_b64_tr_b16 a[194:195], v9 offset:47104
    v_cvt_pk_bf16_f32 v162, v164, v165
    ds_read_b64_tr_b16 a[196:197], v9 offset:40960
    v_mfma_f32_16x16x32_bf16 v[200:203], a[188:191], a[4:7], v[200:203]
    ds_read_b64_tr_b16 a[198:199], v9 offset:43008
    v_cvt_pk_bf16_f32 v163, v166, v167
    v_mfma_f32_16x16x32_bf16 v[200:203], a[184:187], a[132:135], v[200:203]
    buffer_store_dwordx4 v[160:163], v14, s[24:27], s78 offen offset:0 sc1
    v_add_f32 v116, v116, v84
    v_mfma_f32_16x16x32_bf16 v[208:211], a[184:187], a[136:139], v[208:211]
    ds_read_b64_tr_b16 a[208:209], v9 offset:36864
    v_add_f32 v117, v117, v85
    v_mfma_f32_16x16x32_bf16 v[208:211], a[188:191], a[8:11], v[208:211]
    buffer_store_dwordx4 v[168:171], v14, s[24:27], s78 offen offset:1024 sc1
    v_add_f32 v118, v118, v86
    v_mfma_f32_16x16x32_bf16 v[216:219], a[188:191], a[12:15], v[216:219]
    ds_read_b64_tr_b16 a[210:211], v9 offset:38912
    v_add_f32 v119, v119, v87
    v_mfma_f32_16x16x32_bf16 v[216:219], a[184:187], a[140:143], v[216:219]
    s_waitcnt lgkmcnt(4)
    ds_read_b64_tr_b16 a[212:213], v9 offset:32768
    v_add_f32 v116, v116, v88
    v_mfma_f32_16x16x32_bf16 v[220:223], a[192:195], a[140:143], v[220:223]
    s_waitcnt lgkmcnt(3)
    ds_read_b64_tr_b16 a[214:215], v9 offset:34816
    v_add_f32 v117, v117, v89
    v_mfma_f32_16x16x32_bf16 v[220:223], a[196:199], a[12:15], v[220:223]
    ds_read_b64_tr_b16 a[184:185], v8 offset:28672
    v_add_f32 v118, v118, v90
    v_mfma_f32_16x16x32_bf16 v[212:215], a[196:199], a[8:11], v[212:215]
    ds_read_b64_tr_b16 a[186:187], v8 offset:30720
    v_add_f32 v119, v119, v91
    v_mfma_f32_16x16x32_bf16 v[212:215], a[192:195], a[136:139], v[212:215]
    buffer_store_dwordx4 v[176:179], v14, s[24:27], s79 offen offset:0 sc1
    v_add_f32 v116, v116, v92
    v_mfma_f32_16x16x32_bf16 v[204:207], a[192:195], a[132:135], v[204:207]
    s_load_dwordx8 s[28:35], s[86:87], s93 glc
    ds_read_b64_tr_b16 a[188:189], v8 offset:24576
    v_add_f32 v117, v117, v93
    v_mfma_f32_16x16x32_bf16 v[204:207], a[196:199], a[4:7], v[204:207]
    ds_read_b64_tr_b16 a[190:191], v8 offset:26624
    v_add_f32 v118, v118, v94
    v_mfma_f32_16x16x32_bf16 v[196:199], a[196:199], a[0:3], v[196:199]
    v_add_f32 v119, v119, v95
    v_mov_b32 v120, v116
    v_mfma_f32_16x16x32_bf16 v[196:199], a[192:195], a[128:131], v[196:199]
    ds_read_b64_tr_b16 a[192:193], v9 offset:28672
    v_mov_b32 v121, v117
    v_mfma_f32_16x16x32_bf16 v[192:195], a[200:203], a[16:19], v[192:195]
    ds_read_b64_tr_b16 a[194:195], v9 offset:30720
    v_mov_b32 v122, v118
    v_mfma_f32_16x16x32_bf16 v[192:195], a[204:207], a[32:35], v[192:195]
    buffer_store_dwordx4 v[184:187], v14, s[24:27], s79 offen offset:1024 sc1
    v_mov_b32 v123, v119
    v_mfma_f32_16x16x32_bf16 v[200:203], a[204:207], a[36:39], v[200:203]
    ds_read_b64_tr_b16 a[196:197], v9 offset:24576
    v_xor_b32 v20, 16, v5
    v_mfma_f32_16x16x32_bf16 v[200:203], a[200:203], a[20:23], v[200:203]
    s_waitcnt lgkmcnt(8)
    ds_read_b64_tr_b16 a[198:199], v9 offset:26624
    v_cmp_eq_u32 s[8:9], s39, v5
    v_mfma_f32_16x16x32_bf16 v[208:211], a[200:203], a[24:27], v[208:211]
    v_permlane16_swap_b32 v116, v120
    v_mfma_f32_16x16x32_bf16 v[208:211], a[204:207], a[40:43], v[208:211]
    v_permlane16_swap_b32 v117, v121
    v_mfma_f32_16x16x32_bf16 v[216:219], a[204:207], a[44:47], v[216:219]
    s_waitcnt lgkmcnt(7)
    v_permlane16_swap_b32 v118, v122
    v_mfma_f32_16x16x32_bf16 v[216:219], a[200:203], a[28:31], v[216:219]
    v_permlane16_swap_b32 v119, v123
    v_mfma_f32_16x16x32_bf16 v[220:223], a[208:211], a[28:31], v[220:223]
    s_or_b64 s[88:89], s[28:29], s[30:31]
    v_add_f32 v116, v116, v120
    v_add_f32 v117, v117, v121
    v_mfma_f32_16x16x32_bf16 v[220:223], a[212:215], a[44:47], v[220:223]
    s_or_b64 s[88:89], s[88:89], s[32:33]
    v_add_f32 v118, v118, v122
    v_add_f32 v119, v119, v123
    v_mfma_f32_16x16x32_bf16 v[212:215], a[212:215], a[40:43], v[212:215]
    s_barrier
    v_mfma_f32_16x16x32_bf16 v[212:215], a[208:211], a[24:27], v[212:215]
    s_or_b64 s[88:89], s[88:89], s[34:35]
    ds_read_b64_tr_b16 a[200:201], v8 offset:20480
    v_cvt_pk_bf16_f32 v117, v116, v117
    v_mfma_f32_16x16x32_bf16 v[204:207], a[208:211], a[20:23], v[204:207]
    s_or_b32 s66, s88, s89
    ds_read_b64_tr_b16 a[202:203], v8 offset:22528
    v_lshlrev_b32 v116, 16, v117
    v_mfma_f32_16x16x32_bf16 v[204:207], a[212:215], a[36:39], v[204:207]
    s_waitcnt lgkmcnt(6)
    ds_read_b64_tr_b16 a[204:205], v8 offset:16384
    v_and_b32 v117, 0xffff0000, v117
    v_mfma_f32_16x16x32_bf16 v[196:199], a[212:215], a[32:35], v[196:199]
    s_andn2_b32 s69, s66, s80
    s_cselect_b32 s65, s59, 0x70000000
    v_cvt_pk_bf16_f32 v119, v118, v119
    v_mfma_f32_16x16x32_bf16 v[196:199], a[208:211], a[16:19], v[196:199]
    s_ff1_i32_b32 s69, s69
    ds_read_b64_tr_b16 a[206:207], v8 offset:18432
    v_lshlrev_b32 v118, 16, v119
    v_mfma_f32_16x16x32_bf16 v[192:195], a[184:187], a[48:51], v[192:195]
    s_xor_b32 s72, s53, s69
    ds_read_b64_tr_b16 a[208:209], v9 offset:20480
    v_and_b32 v119, 0xffff0000, v119
    v_mfma_f32_16x16x32_bf16 v[192:195], a[188:191], a[64:67], v[192:195]
    s_mul_i32 s72, s72, 20480
    ds_read_b64_tr_b16 a[210:211], v9 offset:22528
    v_mul_f32 v116, v116, v54
    v_mfma_f32_16x16x32_bf16 v[200:203], a[188:191], a[68:71], v[200:203]
    s_add_u32 s72, s72, s65
    ds_read_b64_tr_b16 a[212:213], v9 offset:16384
    v_mul_f32 v117, v117, v54
    v_mfma_f32_16x16x32_bf16 v[200:203], a[184:187], a[52:55], v[200:203]
    s_waitcnt lgkmcnt(7)
    ds_read_b64_tr_b16 a[214:215], v9 offset:18432
    v_mul_f32 v118, v118, v54
    v_mfma_f32_16x16x32_bf16 v[208:211], a[184:187], a[56:59], v[208:211]
    s_bitset1_b32 s80, s69
    v_mul_f32 v119, v119, v54
    v_cvt_pk_bf16_f32 v117, v116, v117
    v_mfma_f32_16x16x32_bf16 v[208:211], a[188:191], a[72:75], v[208:211]
    v_lshlrev_b32 v116, 16, v117
    v_and_b32 v117, 0xffff0000, v117
    v_mfma_f32_16x16x32_bf16 v[216:219], a[188:191], a[76:79], v[216:219]
    v_cvt_pk_bf16_f32 v119, v118, v119
    v_lshlrev_b32 v118, 16, v119
    v_mfma_f32_16x16x32_bf16 v[216:219], a[184:187], a[60:63], v[216:219]
    ds_read_b64_tr_b16 a[184:185], v8 offset:12288
    v_and_b32 v119, 0xffff0000, v119
    v_mfma_f32_16x16x32_bf16 v[220:223], a[192:195], a[60:63], v[220:223]
    ds_read_b64_tr_b16 a[186:187], v8 offset:14336
    v_add_f32 v116, v116, v50
    v_mfma_f32_16x16x32_bf16 v[220:223], a[196:199], a[76:79], v[220:223]
    ds_read_b64_tr_b16 a[188:189], v8 offset:8192
    v_add_f32 v117, v117, v51
    v_mfma_f32_16x16x32_bf16 v[212:215], a[196:199], a[72:75], v[212:215]
    s_waitcnt lgkmcnt(5)
    ds_read_b64_tr_b16 a[190:191], v8 offset:10240
    v_add_f32 v118, v118, v52
    v_mfma_f32_16x16x32_bf16 v[212:215], a[192:195], a[56:59], v[212:215]
    buffer_load_dwordx4 v[108:111], v14, s[24:27], s72 offen sc1
    v_mfma_f32_16x16x32_bf16 v[204:207], a[192:195], a[52:55], v[204:207]
    v_add_f32 v119, v119, v53
    v_cvt_pk_bf16_f32 v117, v116, v117
    v_mfma_f32_16x16x32_bf16 v[204:207], a[196:199], a[68:71], v[204:207]
    buffer_load_dwordx4 v[112:115], v14, s[24:27], s72 offen offset:1024 sc1
    v_mfma_f32_16x16x32_bf16 v[196:199], a[196:199], a[64:67], v[196:199]
    v_lshlrev_b32 v116, 16, v117
    v_and_b32 v117, 0xffff0000, v117
    v_mfma_f32_16x16x32_bf16 v[196:199], a[192:195], a[48:51], v[196:199]
    ds_read_b64_tr_b16 a[192:193], v9 offset:12288
    v_cvt_pk_bf16_f32 v119, v118, v119
    v_mfma_f32_16x16x32_bf16 v[192:195], a[200:203], a[216:219], v[192:195]
    buffer_load_dwordx2 v[106:107], v39, s[24:27], s72 offen offset:2048 sc1
    v_mfma_f32_16x16x32_bf16 v[192:195], a[204:207], a[232:235], v[192:195]
    s_or_b64 s[88:89], s[28:29], s[30:31]
    ds_read_b64_tr_b16 a[194:195], v9 offset:14336
    v_lshlrev_b32 v118, 16, v119
    v_mfma_f32_16x16x32_bf16 v[200:203], a[204:207], a[236:239], v[200:203]
    s_or_b64 s[88:89], s[88:89], s[32:33]
    ds_read_b64_tr_b16 a[196:197], v9 offset:8192
    v_and_b32 v119, 0xffff0000, v119
    v_mfma_f32_16x16x32_bf16 v[200:203], a[200:203], a[220:223], v[200:203]
    s_or_b64 s[88:89], s[88:89], s[34:35]
    ds_read_b64_tr_b16 a[198:199], v9 offset:10240
    v_mul_f32 v120, s92, v116
    v_mfma_f32_16x16x32_bf16 v[208:211], a[200:203], a[224:227], v[208:211]
    s_or_b32 s66, s88, s89
    v_exp_f32 v120, v120
    v_mfma_f32_16x16x32_bf16 v[208:211], a[204:207], a[240:243], v[208:211]
    v_mul_f32 v121, s92, v117
    v_mul_f32 v122, s92, v118
    v_mfma_f32_16x16x32_bf16 v[216:219], a[204:207], a[244:247], v[216:219]
    s_waitcnt lgkmcnt(5)
    v_exp_f32 v121, v121
    v_mfma_f32_16x16x32_bf16 v[216:219], a[200:203], a[228:231], v[216:219]
    s_andn2_b32 s69, s66, s80
    s_cselect_b32 s65, s59, 0x70000000
    v_mul_f32 v123, s92, v119
    v_mfma_f32_16x16x32_bf16 v[220:223], a[208:211], a[228:231], v[220:223]
    s_ff1_i32_b32 s69, s69
    ds_read_b64_tr_b16 a[200:201], v8 offset:4096
    v_add_f32 v120, 1.0, v120
    v_mfma_f32_16x16x32_bf16 v[220:223], a[212:215], a[244:247], v[220:223]
    s_xor_b32 s73, s53, s69
    ds_read_b64_tr_b16 a[202:203], v8 offset:6144
    v_add_f32 v121, 1.0, v121
    v_mfma_f32_16x16x32_bf16 v[212:215], a[212:215], a[240:243], v[212:215]
    s_mul_i32 s73, s73, 20480
    ds_read_b64_tr_b16 a[204:205], v8 offset:0
    v_cmp_eq_u32 s[10:11], s39, v20
    v_mfma_f32_16x16x32_bf16 v[212:215], a[208:211], a[224:227], v[212:215]
    s_add_u32 s73, s73, s65
    ds_read_b64_tr_b16 a[206:207], v8 offset:2048
    v_cmp_eq_u32 s[20:21], s40, v5
    v_mfma_f32_16x16x32_bf16 v[204:207], a[208:211], a[220:223], v[204:207]
    s_bitset1_b32 s80, s69
    v_exp_f32 v122, v122
    v_mfma_f32_16x16x32_bf16 v[204:207], a[212:215], a[236:239], v[204:207]
    s_andn2_b32 s69, s66, s80
    s_cselect_b32 s65, s59, 0x70000000
    v_add_f32 v122, 1.0, v122
    v_mfma_f32_16x16x32_bf16 v[196:199], a[212:215], a[232:235], v[196:199]
    s_waitcnt lgkmcnt(6)
    v_exp_f32 v123, v123
    v_mfma_f32_16x16x32_bf16 v[196:199], a[208:211], a[216:219], v[196:199]
    s_ff1_i32_b32 s69, s69
    ds_read_b64_tr_b16 a[208:209], v9 offset:4096
    v_add_f32 v123, 1.0, v123
    v_mfma_f32_16x16x32_bf16 v[192:195], a[184:187], a[152:155], v[192:195]
    s_xor_b32 s81, s53, s69
    ds_read_b64_tr_b16 a[210:211], v9 offset:6144
    v_cmp_eq_u32 s[22:23], s40, v20
    v_mfma_f32_16x16x32_bf16 v[192:195], a[188:191], a[168:171], v[192:195]
    s_mul_i32 s81, s81, 20480
    ds_read_b64_tr_b16 a[212:213], v9 offset:0
    v_lshl_add_u32 v12, v1, 3, s56
    v_mfma_f32_16x16x32_bf16 v[200:203], a[188:191], a[172:175], v[200:203]
    buffer_load_dwordx4 v[130:133], v14, s[24:27], s73 offen sc1
    v_mfma_f32_16x16x32_bf16 v[200:203], a[184:187], a[156:159], v[200:203]
    s_waitcnt vmcnt(4)
    ds_read_b64_tr_b16 a[214:215], v9 offset:2048
    v_lshrrev_b32 v21, 4, v1
    v_mfma_f32_16x16x32_bf16 v[208:211], a[184:187], a[160:163], v[208:211]
    buffer_store_dword v16, v7, s[24:27], s77 offen offset:16 sc1
    v_mfma_f32_16x16x32_bf16 v[208:211], a[188:191], a[176:179], v[208:211]
    buffer_load_dwordx4 v[134:137], v14, s[24:27], s73 offen offset:1024 sc1
    v_mfma_f32_16x16x32_bf16 v[216:219], a[188:191], a[180:183], v[216:219]
    s_waitcnt lgkmcnt(3)
    v_lshlrev_b32 v16, 0, v2
    v_lshl_add_u32 v21, v21, 3, s56
    v_mfma_f32_16x16x32_bf16 v[216:219], a[184:187], a[164:167], v[216:219]
    s_xor_b32 s77, s50, 0
    v_rcp_f32 v120, v120
    v_mfma_f32_16x16x32_bf16 v[220:223], a[192:195], a[164:167], v[220:223]
    buffer_load_dwordx2 v[128:129], v39, s[24:27], s73 offen offset:2048 sc1
    v_mfma_f32_16x16x32_bf16 v[220:223], a[196:199], a[180:183], v[220:223]
    s_lshl_b32 s77, s77, 10
    v_rcp_f32 v121, v121
    v_mfma_f32_16x16x32_bf16 v[212:215], a[196:199], a[176:179], v[212:215]
    s_add_u32 s77, s61, s77
    v_rcp_f32 v122, v122
    v_mfma_f32_16x16x32_bf16 v[212:215], a[192:195], a[160:163], v[212:215]
    s_add_u32 s81, s81, s65
    v_rcp_f32 v123, v123
    v_mfma_f32_16x16x32_bf16 v[204:207], a[192:195], a[156:159], v[204:207]
    s_bitset1_b32 s80, s69
    v_mul_f32 v116, v116, v120
    v_mul_f32 v117, v117, v121
    v_mfma_f32_16x16x32_bf16 v[204:207], a[196:199], a[172:175], v[204:207]
    s_or_b64 s[8:9], s[8:9], s[20:21]
    v_mul_f32 v118, v118, v122
    v_mul_f32 v119, v119, v123
    v_mfma_f32_16x16x32_bf16 v[196:199], a[196:199], a[168:171], v[196:199]
    buffer_load_dwordx4 v[140:143], v14, s[24:27], s81 offen sc1
    v_mfma_f32_16x16x32_bf16 v[196:199], a[192:195], a[152:155], v[196:199]
    s_or_b64 s[10:11], s[10:11], s[22:23]
    v_cvt_pk_bf16_f32 v116, v116, v117
    v_cvt_pk_bf16_f32 v117, v118, v119
    v_mfma_f32_16x16x32_bf16 v[192:195], a[200:203], a[80:83], v[192:195]
    ds_write_b64 v12, v[116:117]
    v_mfma_f32_16x16x32_bf16 v[192:195], a[204:207], a[96:99], v[192:195]
    buffer_load_dwordx4 v[144:147], v14, s[24:27], s81 offen offset:1024 sc1
    v_mfma_f32_16x16x32_bf16 v[200:203], a[204:207], a[100:103], v[200:203]
    v_add_u32 v20, 256, v21
    v_cndmask_b32 v22, v21, v20, s[20:21]
    v_mfma_f32_16x16x32_bf16 v[200:203], a[200:203], a[84:87], v[200:203]
    s_mov_b64 exec, s[8:9]
    ds_read2_b64 v[40:43], v22 offset0:0 offset1:4
    s_mov_b64 exec, -1
    v_mfma_f32_16x16x32_bf16 v[208:211], a[200:203], a[88:91], v[208:211]
    buffer_load_dwordx2 v[138:139], v39, s[24:27], s81 offen offset:2048 sc1
    v_mfma_f32_16x16x32_bf16 v[208:211], a[204:207], a[104:107], v[208:211]
    s_waitcnt lgkmcnt(2)
    v_cvt_pk_bf16_f32 v192, v192, v193
    v_cvt_pk_bf16_f32 v193, v194, v195
    v_mfma_f32_16x16x32_bf16 v[216:219], a[204:207], a[108:111], v[216:219]
    s_xor_b32 s78, s53, 3
    v_cvt_pk_bf16_f32 v200, v200, v201
    v_cvt_pk_bf16_f32 v201, v202, v203
    v_mfma_f32_16x16x32_bf16 v[216:219], a[200:203], a[92:95], v[216:219]
    s_mul_i32 s78, s78, 2560
    v_cvt_pk_bf16_f32 v208, v208, v209
    v_cvt_pk_bf16_f32 v209, v210, v211
    v_add_u32 v10, 90112, v10
    v_mfma_f32_16x16x32_bf16 v[220:223], a[208:211], a[92:95], v[220:223]
    s_add_u32 s78, s78, s60
    ds_read_b64_tr_b16 a[184:185], v10 offset:45056
    v_cndmask_b32 v23, v21, v20, s[22:23]
    v_mfma_f32_16x16x32_bf16 v[220:223], a[212:215], a[108:111], v[220:223]
    s_mov_b64 exec, s[10:11]
    ds_read2_b64 v[44:47], v23 offset0:0 offset1:4
    s_mov_b64 exec, -1
    ds_read_b64_tr_b16 a[186:187], v10 offset:47104
    v_mfma_f32_16x16x32_bf16 v[212:215], a[212:215], a[104:107], v[212:215]
    s_xor_b32 s79, s53, 2
    ds_read_b64_tr_b16 a[188:189], v10 offset:40960
    v_cvt_pk_bf16_f32 v216, v216, v217
    ds_read_b64_tr_b16 a[190:191], v10 offset:43008
    v_mfma_f32_16x16x32_bf16 v[212:215], a[208:211], a[88:91], v[212:215]
    s_mul_i32 s79, s79, 2560
    ds_read_b64_tr_b16 a[200:201], v10 offset:36864
    v_cvt_pk_bf16_f32 v217, v218, v219
    v_add_u32 v11, 90112, v11
    v_mfma_f32_16x16x32_bf16 v[204:207], a[208:211], a[84:87], v[204:207]
    s_add_u32 s79, s79, s60
    ds_read_b64_tr_b16 a[192:193], v11 offset:45056
    v_cvt_pk_bf16_f32 v218, v220, v221
    v_mfma_f32_16x16x32_bf16 v[204:207], a[212:215], a[100:103], v[204:207]
    s_load_dwordx8 s[28:35], s[86:87], s93 glc
    ds_read_b64_tr_b16 a[194:195], v11 offset:47104
    v_cvt_pk_bf16_f32 v210, v212, v213
    ds_read_b64_tr_b16 a[196:197], v11 offset:40960
    v_mfma_f32_16x16x32_bf16 v[196:199], a[212:215], a[96:99], v[196:199]
    s_waitcnt lgkmcnt(8)
    ds_read_b64_tr_b16 a[198:199], v11 offset:43008
    v_cvt_pk_bf16_f32 v211, v214, v215
    v_mfma_f32_16x16x32_bf16 v[196:199], a[208:211], a[80:83], v[196:199]
    s_waitcnt lgkmcnt(7)
    ds_read_b64_tr_b16 a[202:203], v10 offset:38912
    v_cvt_pk_bf16_f32 v202, v204, v205
    v_mfma_f32_16x16x32_bf16 v[224:227], a[184:187], a[128:131], v[224:227]
    s_waitcnt lgkmcnt(6)
    ds_read_b64_tr_b16 a[204:205], v10 offset:32768
    v_cvt_pk_bf16_f32 v203, v206, v207
    v_mfma_f32_16x16x32_bf16 v[224:227], a[188:191], a[0:3], v[224:227]
    ds_read_b64_tr_b16 a[206:207], v10 offset:34816
    v_cvt_pk_bf16_f32 v194, v196, v197
    v_mfma_f32_16x16x32_bf16 v[232:235], a[188:191], a[4:7], v[232:235]
    ds_read_b64_tr_b16 a[208:209], v11 offset:36864
    v_cvt_pk_bf16_f32 v195, v198, v199
    v_mfma_f32_16x16x32_bf16 v[232:235], a[184:187], a[132:135], v[232:235]
    s_waitcnt lgkmcnt(6)
    buffer_store_dwordx4 v[192:195], v14, s[24:27], s78 offen offset:1024 sc1
    v_cvt_pk_bf16_f32 v219, v222, v223
    v_mfma_f32_16x16x32_bf16 v[236:239], a[192:195], a[132:135], v[236:239]
    s_waitcnt lgkmcnt(4)
    ds_read_b64_tr_b16 a[210:211], v11 offset:38912
    v_cmp_eq_u32 s[20:21], s39, v37
    v_mfma_f32_16x16x32_bf16 v[236:239], a[196:199], a[4:7], v[236:239]
    ds_read_b64_tr_b16 a[212:213], v11 offset:32768
    v_cmp_eq_u32 s[22:23], s40, v37
    v_mfma_f32_16x16x32_bf16 v[228:231], a[196:199], a[0:3], v[228:231]
    s_waitcnt lgkmcnt(5)
    ds_read_b64_tr_b16 a[214:215], v11 offset:34816
    v_cndmask_b32 v13, v21, v20, s[22:23]
    v_mfma_f32_16x16x32_bf16 v[228:231], a[192:195], a[128:131], v[228:231]
    buffer_store_dwordx4 v[200:203], v14, s[24:27], s78 offen offset:0 sc1
    v_and_b32 v20, 8, v39
    v_mfma_f32_16x16x32_bf16 v[224:227], a[200:203], a[16:19], v[224:227]
    s_waitcnt lgkmcnt(4)
    ds_read_b64_tr_b16 a[184:185], v10 offset:28672
    v_lshl_add_u32 v13, v20, 2, v13
    v_mfma_f32_16x16x32_bf16 v[224:227], a[204:207], a[32:35], v[224:227]
    s_or_b64 s[20:21], s[20:21], s[22:23]
    ds_read_b64_tr_b16 a[186:187], v10 offset:30720
    v_bfe_u32 v20, v1, 2, 2
    ds_read_b64_tr_b16 a[188:189], v10 offset:24576
    v_mfma_f32_16x16x32_bf16 v[232:235], a[204:207], a[36:39], v[232:235]
    s_mov_b64 exec, s[20:21]
    ds_read_b64 v[48:49], v13 offset:64
    s_mov_b64 exec, -1
    ds_read_b64_tr_b16 a[190:191], v10 offset:26624
    v_mfma_f32_16x16x32_bf16 v[232:235], a[200:203], a[20:23], v[232:235]
    s_waitcnt lgkmcnt(7)
    ds_read_b64_tr_b16 a[192:193], v11 offset:28672
    v_lshrrev_b32 v21, 4, v1
    v_mfma_f32_16x16x32_bf16 v[236:239], a[208:211], a[20:23], v[236:239]
    s_waitcnt lgkmcnt(6)
    ds_read_b64_tr_b16 a[194:195], v11 offset:30720
    v_cmp_eq_u32 vcc, v20, v21
    v_mfma_f32_16x16x32_bf16 v[236:239], a[212:215], a[36:39], v[236:239]
    ds_read_b64_tr_b16 a[196:197], v11 offset:24576
    v_and_b32 v20, 1, v1
    v_mfma_f32_16x16x32_bf16 v[228:231], a[212:215], a[32:35], v[228:231]
    ds_read_b64_tr_b16 a[198:199], v11 offset:26624
    v_lshlrev_b32 v20, 4, v20
    v_mfma_f32_16x16x32_bf16 v[228:231], a[208:211], a[16:19], v[228:231]
    s_waitcnt lgkmcnt(7)
    buffer_store_dwordx4 v[208:211], v14, s[24:27], s79 offen offset:1024 sc1
    v_mov_b32 v21, 0x3f80
    v_mfma_f32_16x16x32_bf16 v[224:227], a[184:187], a[48:51], v[224:227]
    s_waitcnt lgkmcnt(4)
    ds_read_b64_tr_b16 a[200:201], v10 offset:20480
    v_lshlrev_b32 v20, v20, v21
    v_mfma_f32_16x16x32_bf16 v[224:227], a[188:191], a[64:67], v[224:227]
    ds_read_b64_tr_b16 a[202:203], v10 offset:22528
    v_cndmask_b32 v20, 0, v20, vcc
    ds_read_b64_tr_b16 a[204:205], v10 offset:16384
    v_mfma_f32_16x16x32_bf16 v[232:235], a[188:191], a[68:71], v[232:235]
    ds_read_b64_tr_b16 a[206:207], v10 offset:18432
    v_and_b32 v21, 2, v1
    v_mfma_f32_16x16x32_bf16 v[232:235], a[184:187], a[52:55], v[232:235]
    s_waitcnt lgkmcnt(6)
    ds_read_b64_tr_b16 a[208:209], v11 offset:20480
    v_cmp_eq_u32 vcc, 0, v21
    v_mfma_f32_16x16x32_bf16 v[236:239], a[192:195], a[52:55], v[236:239]
    s_waitcnt lgkmcnt(5)
    ds_read_b64_tr_b16 a[210:211], v11 offset:22528
    v_cndmask_b32 v184, 0, v20, vcc
    v_mfma_f32_16x16x32_bf16 v[236:239], a[196:199], a[68:71], v[236:239]
pg_last:
    s_cbranch_execz pg_back2
    ds_read_b64_tr_b16 a[212:213], v11 offset:16384
    v_sub_u32 v185, v20, v184
    v_mfma_f32_16x16x32_bf16 v[228:231], a[196:199], a[64:67], v[228:231]
    ds_read_b64_tr_b16 a[214:215], v11 offset:18432
    v_mov_b32 v186, 0
    v_mfma_f32_16x16x32_bf16 v[228:231], a[192:195], a[48:51], v[228:231]
    s_waitcnt lgkmcnt(6)
    buffer_store_dwordx4 v[216:219], v14, s[24:27], s79 offen offset:0 sc1
    v_mov_b32 v187, 0
    v_mfma_f32_16x16x32_bf16 v[224:227], a[200:203], a[216:219], v[224:227]
    s_waitcnt lgkmcnt(4)
    ds_read_b64_tr_b16 a[184:185], v10 offset:12288
    v_mov_b32 v188, 0
    v_mfma_f32_16x16x32_bf16 v[224:227], a[204:207], a[232:235], v[224:227]
    ds_read_b64_tr_b16 a[186:187], v10 offset:14336
    v_mov_b32 v189, 0
    ds_read_b64_tr_b16 a[188:189], v10 offset:8192
    v_mfma_f32_16x16x32_bf16 v[232:235], a[204:207], a[236:239], v[232:235]
    ds_read_b64_tr_b16 a[190:191], v10 offset:10240
    v_mov_b32 v190, v184
    v_mfma_f32_16x16x32_bf16 v[232:235], a[200:203], a[220:223], v[232:235]
    s_waitcnt lgkmcnt(6)
    ds_read_b64_tr_b16 a[192:193], v11 offset:12288
    v_mov_b32 v191, v185
    v_mfma_f32_16x16x32_bf16 v[236:239], a[208:211], a[220:223], v[236:239]
    s_waitcnt lgkmcnt(5)
    ds_read_b64_tr_b16 a[194:195], v11 offset:14336
    v_lshlrev_b32 v192, 16, v24
    v_mfma_f32_16x16x32_bf16 v[236:239], a[212:215], a[236:239], v[236:239]
    ds_read_b64_tr_b16 a[196:197], v11 offset:8192
    v_and_b32 v193, 0xffff0000, v24
    v_mfma_f32_16x16x32_bf16 v[228:231], a[212:215], a[232:235], v[228:231]
    ds_read_b64_tr_b16 a[198:199], v11 offset:10240
    v_lshlrev_b32 v208, 16, v40
    v_mfma_f32_16x16x32_bf16 v[228:231], a[208:211], a[216:219], v[228:231]
    s_waitcnt lgkmcnt(6)
    ds_read_b64_tr_b16 a[200:201], v10 offset:4096
    v_and_b32 v209, 0xffff0000, v40
    v_mfma_f32_16x16x32_bf16 v[224:227], a[184:187], a[152:155], v[224:227]
    s_waitcnt lgkmcnt(5)
    ds_read_b64_tr_b16 a[202:203], v10 offset:6144
    v_lshlrev_b32 v194, 16, v25
    v_mfma_f32_16x16x32_bf16 v[224:227], a[188:191], a[168:171], v[224:227]
    ds_read_b64_tr_b16 a[204:205], v10 offset:0
    v_and_b32 v195, 0xffff0000, v25
    v_mfma_f32_16x16x32_bf16 v[232:235], a[188:191], a[172:175], v[232:235]
    ds_read_b64_tr_b16 a[206:207], v10 offset:2048
    v_lshlrev_b32 v210, 16, v41
    v_mfma_f32_16x16x32_bf16 v[232:235], a[184:187], a[156:159], v[232:235]
    s_waitcnt lgkmcnt(6)
    ds_read_b64_tr_b16 a[208:209], v11 offset:4096
    v_and_b32 v211, 0xffff0000, v41
    v_mfma_f32_16x16x32_bf16 v[236:239], a[192:195], a[156:159], v[236:239]
    s_waitcnt lgkmcnt(5)
    ds_read_b64_tr_b16 a[210:211], v11 offset:6144
    v_lshlrev_b32 v196, 16, v26
    v_mfma_f32_16x16x32_bf16 v[236:239], a[196:199], a[172:175], v[236:239]
    s_xor_b32 s78, s53, 1
    ds_read_b64_tr_b16 a[212:213], v11 offset:0
    v_and_b32 v197, 0xffff0000, v26
    v_mfma_f32_16x16x32_bf16 v[228:231], a[196:199], a[168:171], v[228:231]
    s_mul_i32 s78, s78, 2560
    ds_read_b64_tr_b16 a[214:215], v11 offset:2048
    v_lshlrev_b32 v212, 16, v42
    v_mfma_f32_16x16x32_bf16 v[228:231], a[192:195], a[152:155], v[228:231]
    s_waitcnt lgkmcnt(6)
    ds_read_b64_tr_b16 a[184:185], v10 offset:45056
    v_and_b32 v213, 0xffff0000, v42
    v_mfma_f32_16x16x32_bf16 v[224:227], a[200:203], a[80:83], v[224:227]
    s_waitcnt lgkmcnt(5)
    ds_read_b64_tr_b16 a[186:187], v10 offset:47104
    v_lshlrev_b32 v198, 16, v27
    v_mfma_f32_16x16x32_bf16 v[224:227], a[204:207], a[96:99], v[224:227]
    s_add_u32 s78, s78, s60
    ds_read_b64_tr_b16 a[188:189], v10 offset:40960
    v_and_b32 v199, 0xffff0000, v27
    v_mfma_f32_16x16x32_bf16 v[232:235], a[204:207], a[100:103], v[232:235]
    s_or_b64 s[88:89], s[28:29], s[30:31]
    ds_read_b64_tr_b16 a[190:191], v10 offset:43008
    v_lshlrev_b32 v214, 16, v43
    v_mfma_f32_16x16x32_bf16 v[232:235], a[200:203], a[84:87], v[232:235]
    s_waitcnt lgkmcnt(6)
    ds_read_b64_tr_b16 a[192:193], v11 offset:45056
    v_cvt_pk_bf16_f32 v224, v224, v225
    v_mfma_f32_16x16x32_bf16 v[236:239], a[208:211], a[84:87], v[236:239]
    s_waitcnt lgkmcnt(5)
    ds_read_b64_tr_b16 a[194:195], v11 offset:47104
    v_cvt_pk_bf16_f32 v225, v226, v227
    v_mfma_f32_16x16x32_bf16 v[236:239], a[212:215], a[100:103], v[236:239]
    s_or_b64 s[88:89], s[88:89], s[32:33]
    ds_read_b64_tr_b16 a[196:197], v11 offset:40960
    v_cvt_pk_bf16_f32 v232, v232, v233
    v_mfma_f32_16x16x32_bf16 v[228:231], a[212:215], a[96:99], v[228:231]
    s_or_b64 s[88:89], s[88:89], s[34:35]
    ds_read_b64_tr_b16 a[198:199], v11 offset:43008
    v_cvt_pk_bf16_f32 v233, v234, v235
    v_mfma_f32_16x16x32_bf16 v[228:231], a[208:211], a[80:83], v[228:231]
    s_waitcnt lgkmcnt(6)
    ds_read_b64_tr_b16 a[200:201], v10 offset:36864
    v_cvt_pk_bf16_f32 v234, v236, v237
    v_mfma_f32_16x16x32_bf16 v[240:243], a[184:187], a[136:139], v[240:243]
    s_waitcnt lgkmcnt(5)
    ds_read_b64_tr_b16 a[202:203], v10 offset:38912
    v_cvt_pk_bf16_f32 v235, v238, v239
    v_mfma_f32_16x16x32_bf16 v[240:243], a[188:191], a[8:11], v[240:243]
    s_or_b32 s66, s88, s89
    ds_read_b64_tr_b16 a[204:205], v10 offset:32768
    v_cvt_pk_bf16_f32 v226, v228, v229
    v_mfma_f32_16x16x32_bf16 v[248:251], a[188:191], a[12:15], v[248:251]
    s_andn2_b32 s69, s66, s80
    s_cselect_b32 s65, s59, 0x70000000
    v_cvt_pk_bf16_f32 v227, v230, v231
    ds_read_b64_tr_b16 a[206:207], v10 offset:34816
    v_mfma_f32_16x16x32_bf16 v[248:251], a[184:187], a[140:143], v[248:251]
    s_waitcnt lgkmcnt(6)
    buffer_store_dwordx4 v[224:227], v14, s[24:27], s78 offen offset:0 sc1
    v_and_b32 v215, 0xffff0000, v43
    v_mfma_f32_16x16x32_bf16 v[252:255], a[192:195], a[140:143], v[252:255]
    s_waitcnt lgkmcnt(4)
    buffer_store_dwordx4 v[232:235], v14, s[24:27], s78 offen offset:1024 sc1
    v_lshlrev_b32 v200, 16, v28
    v_mfma_f32_16x16x32_bf16 v[252:255], a[196:199], a[12:15], v[252:255]
    s_ff1_i32_b32 s69, s69
    ds_read_b64_tr_b16 a[208:209], v11 offset:36864
    v_and_b32 v201, 0xffff0000, v28
    ds_read_b64_tr_b16 a[210:211], v11 offset:38912
    v_mfma_f32_16x16x32_bf16 v[244:247], a[196:199], a[8:11], v[244:247]
    s_xor_b32 s72, s53, s69
    ds_read_b64_tr_b16 a[212:213], v11 offset:32768
    v_lshlrev_b32 v216, 16, v44
    ds_read_b64_tr_b16 a[214:215], v11 offset:34816
    v_mfma_f32_16x16x32_bf16 v[244:247], a[192:195], a[136:139], v[244:247]
    s_waitcnt lgkmcnt(6)
    ds_read_b64_tr_b16 a[184:185], v10 offset:28672
    v_and_b32 v217, 0xffff0000, v44
    v_mfma_f32_16x16x32_bf16 v[240:243], a[200:203], a[24:27], v[240:243]
    s_waitcnt lgkmcnt(5)
    ds_read_b64_tr_b16 a[186:187], v10 offset:30720
    v_lshlrev_b32 v202, 16, v29
    v_mfma_f32_16x16x32_bf16 v[240:243], a[204:207], a[40:43], v[240:243]
    s_mul_i32 s72, s72, 20480
    ds_read_b64_tr_b16 a[188:189], v10 offset:24576
    v_and_b32 v203, 0xffff0000, v29
    v_mfma_f32_16x16x32_bf16 v[248:251], a[204:207], a[44:47], v[248:251]
    s_add_u32 s72, s72, s65
    ds_read_b64_tr_b16 a[190:191], v10 offset:26624
    v_lshlrev_b32 v218, 16, v45
    v_mfma_f32_16x16x32_bf16 v[248:251], a[200:203], a[28:31], v[248:251]
    s_waitcnt lgkmcnt(6)
    ds_read_b64_tr_b16 a[192:193], v11 offset:28672
    v_and_b32 v219, 0xffff0000, v45
    v_mfma_f32_16x16x32_bf16 v[252:255], a[208:211], a[28:31], v[252:255]
    s_waitcnt lgkmcnt(5)
    ds_read_b64_tr_b16 a[194:195], v11 offset:30720
    v_lshlrev_b32 v204, 16, v30
    v_mfma_f32_16x16x32_bf16 v[252:255], a[212:215], a[44:47], v[252:255]
    s_bitset1_b32 s80, s69
    ds_read_b64_tr_b16 a[196:197], v11 offset:24576
    v_and_b32 v205, 0xffff0000, v30
    v_mfma_f32_16x16x32_bf16 v[244:247], a[212:215], a[40:43], v[244:247]
    buffer_load_dwordx4 v[58:61], v14, s[24:27], s72 offen sc1
    ds_read_b64_tr_b16 a[198:199], v11 offset:26624
    v_mfma_f32_16x16x32_bf16 v[244:247], a[208:211], a[24:27], v[244:247]
    s_waitcnt lgkmcnt(6)
    ds_read_b64_tr_b16 a[200:201], v10 offset:20480
    v_lshlrev_b32 v220, 16, v46
    v_mfma_f32_16x16x32_bf16 v[240:243], a[184:187], a[56:59], v[240:243]
    s_waitcnt lgkmcnt(5)
    ds_read_b64_tr_b16 a[202:203], v10 offset:22528
    v_and_b32 v221, 0xffff0000, v46
    v_mfma_f32_16x16x32_bf16 v[240:243], a[188:191], a[72:75], v[240:243]
    buffer_load_dwordx4 v[62:65], v14, s[24:27], s72 offen offset:1024 sc1
    ds_read_b64_tr_b16 a[204:205], v10 offset:16384
    v_mfma_f32_16x16x32_bf16 v[248:251], a[188:191], a[76:79], v[248:251]
    s_andn2_b32 s69, s66, s80
    s_cselect_b32 s65, s59, 0x70000000
    v_lshlrev_b32 v206, 16, v31
    ds_read_b64_tr_b16 a[206:207], v10 offset:18432
    v_mfma_f32_16x16x32_bf16 v[248:251], a[184:187], a[60:63], v[248:251]
    s_waitcnt lgkmcnt(6)
    ds_read_b64_tr_b16 a[208:209], v11 offset:20480
    v_and_b32 v207, 0xffff0000, v31
    v_mfma_f32_16x16x32_bf16 v[252:255], a[192:195], a[60:63], v[252:255]
    s_waitcnt lgkmcnt(5)
    buffer_load_dwordx2 v[56:57], v39, s[24:27], s72 offen offset:2048 sc1
    v_mfma_f32_16x16x32_bf16 v[252:255], a[196:199], a[76:79], v[252:255]
    s_ff1_i32_b32 s69, s69
    ds_read_b64_tr_b16 a[210:211], v11 offset:22528
    v_lshlrev_b32 v222, 16, v47
    ds_read_b64_tr_b16 a[212:213], v11 offset:16384
    v_mfma_f32_16x16x32_bf16 v[244:247], a[196:199], a[72:75], v[244:247]
    s_xor_b32 s73, s53, s69
    ds_read_b64_tr_b16 a[214:215], v11 offset:18432
    v_and_b32 v223, 0xffff0000, v47
    v_mfma_f32_16x16x32_bf16 v[244:247], a[192:195], a[56:59], v[244:247]
    s_waitcnt lgkmcnt(6)
    ds_read_b64_tr_b16 a[184:185], v10 offset:12288
    v_lshlrev_b32 v50, 16, v32
    v_mfma_f32_16x16x32_bf16 v[240:243], a[200:203], a[224:227], v[240:243]
    s_waitcnt lgkmcnt(5)
    ds_read_b64_tr_b16 a[186:187], v10 offset:14336
    v_and_b32 v51, 0xffff0000, v32
    v_mfma_f32_16x16x32_bf16 v[240:243], a[204:207], a[240:243], v[240:243]
    s_waitcnt vmcnt(5)
    ds_read_b64_tr_b16 a[188:189], v10 offset:8192
    v_lshlrev_b32 v116, 16, v48
    v_mfma_f32_16x16x32_bf16 v[248:251], a[204:207], a[244:247], v[248:251]
    buffer_store_dword v17, v7, s[24:27], s67 offen offset:8 sc1
    ds_read_b64_tr_b16 a[190:191], v10 offset:10240
    v_mfma_f32_16x16x32_bf16 v[248:251], a[200:203], a[228:231], v[248:251]
    s_waitcnt lgkmcnt(6)
    ds_read_b64_tr_b16 a[192:193], v11 offset:12288
    v_and_b32 v117, 0xffff0000, v48
    v_mfma_f32_16x16x32_bf16 v[252:255], a[208:211], a[228:231], v[252:255]
    s_waitcnt lgkmcnt(5)
    ds_read_b64_tr_b16 a[194:195], v11 offset:14336
    v_lshlrev_b32 v52, 16, v33
    v_mfma_f32_16x16x32_bf16 v[252:255], a[212:215], a[244:247], v[252:255]
    s_mul_i32 s73, s73, 20480
    ds_read_b64_tr_b16 a[196:197], v11 offset:8192
    v_and_b32 v53, 0xffff0000, v33
    v_mfma_f32_16x16x32_bf16 v[244:247], a[212:215], a[240:243], v[244:247]
    s_add_u32 s73, s73, s65
    ds_read_b64_tr_b16 a[198:199], v11 offset:10240
    v_lshlrev_b32 v118, 16, v49
    v_mfma_f32_16x16x32_bf16 v[244:247], a[208:211], a[224:227], v[244:247]
    s_waitcnt lgkmcnt(6)
    buffer_load_dwordx4 v[68:71], v14, s[24:27], s73 offen sc1
    v_mfma_f32_16x16x32_bf16 v[240:243], a[184:187], a[160:163], v[240:243]
    s_waitcnt lgkmcnt(4)
    buffer_load_dwordx4 v[72:75], v14, s[24:27], s73 offen offset:1024 sc1
    ds_read_b64_tr_b16 a[200:201], v10 offset:4096
    v_mfma_f32_16x16x32_bf16 v[240:243], a[188:191], a[176:179], v[240:243]
    buffer_load_dwordx2 v[66:67], v39, s[24:27], s73 offen offset:2048 sc1
    ds_read_b64_tr_b16 a[202:203], v10 offset:6144
    v_mfma_f32_16x16x32_bf16 v[248:251], a[188:191], a[180:183], v[248:251]
    s_bitset1_b32 s80, s69
    ds_read_b64_tr_b16 a[204:205], v10 offset:0
    v_and_b32 v119, 0xffff0000, v49
    ds_read_b64_tr_b16 a[206:207], v10 offset:2048
    v_mfma_f32_16x16x32_bf16 v[248:251], a[184:187], a[164:167], v[248:251]
    s_waitcnt lgkmcnt(6)
    ds_read_b64_tr_b16 a[208:209], v11 offset:4096
    v_mfma_f32_16x16x32_bf16 v[252:255], a[192:195], a[164:167], v[252:255]
    s_waitcnt lgkmcnt(5)
    ds_read_b64_tr_b16 a[210:211], v11 offset:6144
    v_mfma_f32_16x16x32_bf16 v[252:255], a[196:199], a[180:183], v[252:255]
    s_andn2_b32 s69, s66, s80
    s_cselect_b32 s65, s59, 0x70000000
    s_ff1_i32_b32 s69, s69
    ds_read_b64_tr_b16 a[212:213], v11 offset:0
    v_mfma_f32_16x16x32_bf16 v[244:247], a[196:199], a[176:179], v[244:247]
    s_xor_b32 s81, s53, s69
    ds_read_b64_tr_b16 a[214:215], v11 offset:2048
    s_mul_i32 s81, s81, 20480
    v_mfma_f32_16x16x32_bf16 v[244:247], a[192:195], a[160:163], v[244:247]
    s_waitcnt lgkmcnt(6)
    s_add_u32 s81, s81, s65
    s_bitset1_b32 s80, s69
    v_mfma_f32_16x16x32_bf16 v[240:243], a[200:203], a[88:91], v[240:243]
    s_waitcnt lgkmcnt(4)
    buffer_load_dwordx4 v[78:81], v14, s[24:27], s81 offen sc1
    v_mfma_f32_16x16x32_bf16 v[240:243], a[204:207], a[104:107], v[240:243]
    buffer_load_dwordx4 v[82:85], v14, s[24:27], s81 offen offset:1024 sc1
    v_mfma_f32_16x16x32_bf16 v[248:251], a[204:207], a[108:111], v[248:251]
    buffer_load_dwordx2 v[76:77], v39, s[24:27], s81 offen offset:2048 sc1
    v_mfma_f32_16x16x32_bf16 v[248:251], a[200:203], a[92:95], v[248:251]
    s_waitcnt lgkmcnt(2)
    v_mfma_f32_16x16x32_bf16 v[252:255], a[208:211], a[92:95], v[252:255]
    s_waitcnt lgkmcnt(0)
    v_mfma_f32_16x16x32_bf16 v[252:255], a[212:215], a[108:111], v[252:255]
    s_waitcnt vmcnt(10)
    s_load_dwordx8 s[28:35], s[86:87], s93 glc
    v_mfma_f32_16x16x32_bf16 v[244:247], a[212:215], a[104:107], v[244:247]
    buffer_store_dword v16, v7, s[24:27], s77 offen offset:0 sc1
    v_mfma_f32_16x16x32_bf16 v[244:247], a[208:211], a[88:91], v[244:247]
    v_mfma_f32_16x16x32_bf16 v[240:243], v[184:187], v[98:101], v[240:243]
    v_mfma_f32_16x16x32_bf16 v[244:247], v[188:191], v[98:101], v[244:247]
    v_mfma_f32_16x16x32_bf16 v[252:255], v[188:191], v[102:105], v[252:255]
    v_mfma_f32_16x16x32_bf16 v[248:251], v[184:187], v[102:105], v[248:251]
    v_mfma_f32_16x16x32_bf16 v[124:127], v[184:187], v[96:99], v[124:127]
    v_mfma_f32_16x16x32_bf16 v[240:243], v[184:187], v[108:111], v[240:243]
    v_mfma_f32_16x16x32_bf16 v[244:247], v[188:191], v[108:111], v[244:247]
    v_mfma_f32_16x16x32_bf16 v[252:255], v[188:191], v[112:115], v[252:255]
    v_mfma_f32_16x16x32_bf16 v[248:251], v[184:187], v[112:115], v[248:251]
    v_mfma_f32_16x16x32_bf16 v[124:127], v[184:187], v[106:109], v[124:127]
    v_mfma_f32_16x16x32_bf16 v[240:243], v[184:187], v[130:133], v[240:243]
    v_mfma_f32_16x16x32_bf16 v[244:247], v[188:191], v[130:133], v[244:247]
    v_mfma_f32_16x16x32_bf16 v[252:255], v[188:191], v[134:137], v[252:255]
    v_mfma_f32_16x16x32_bf16 v[248:251], v[184:187], v[134:137], v[248:251]
    v_mfma_f32_16x16x32_bf16 v[124:127], v[184:187], v[128:131], v[124:127]
    v_mfma_f32_16x16x32_bf16 v[240:243], v[184:187], v[140:143], v[240:243]
    v_mfma_f32_16x16x32_bf16 v[244:247], v[188:191], v[140:143], v[244:247]
    v_mfma_f32_16x16x32_bf16 v[252:255], v[188:191], v[144:147], v[252:255]
    v_mfma_f32_16x16x32_bf16 v[248:251], v[184:187], v[144:147], v[248:251]
    v_mfma_f32_16x16x32_bf16 v[124:127], v[184:187], v[138:141], v[124:127]
post_code:
    s_cmp_eq_u32 s80, -1
    s_cbranch_scc1 ev_st
    s_or_b64 s[88:89], s[28:29], s[30:31]
    s_or_b64 s[88:89], s[88:89], s[32:33]
    s_or_b64 s[88:89], s[88:89], s[34:35]
    s_or_b32 s66, s88, s89
    s_andn2_b32 s69, s66, s80
    s_cbranch_scc1 ev_i3
    s_branch ev_w3
ev_st:
    s_waitcnt vmcnt(1)
    v_mfma_f32_16x16x32_bf16 v[240:243], v[184:187], v[58:61], v[240:243]
    v_mfma_f32_16x16x32_bf16 v[244:247], v[188:191], v[58:61], v[244:247]
    v_mfma_f32_16x16x32_bf16 v[252:255], v[188:191], v[62:65], v[252:255]
    v_mfma_f32_16x16x32_bf16 v[248:251], v[184:187], v[62:65], v[248:251]
    v_mfma_f32_16x16x32_bf16 v[124:127], v[184:187], v[56:59], v[124:127]
    v_mfma_f32_16x16x32_bf16 v[240:243], v[184:187], v[68:71], v[240:243]
    v_mfma_f32_16x16x32_bf16 v[244:247], v[188:191], v[68:71], v[244:247]
    v_mfma_f32_16x16x32_bf16 v[252:255], v[188:191], v[72:75], v[252:255]
    v_mfma_f32_16x16x32_bf16 v[248:251], v[184:187], v[72:75], v[248:251]
    v_mfma_f32_16x16x32_bf16 v[124:127], v[184:187], v[66:69], v[124:127]
    v_mfma_f32_16x16x32_bf16 v[240:243], v[184:187], v[78:81], v[240:243]
    v_mfma_f32_16x16x32_bf16 v[244:247], v[188:191], v[78:81], v[244:247]
    v_mfma_f32_16x16x32_bf16 v[252:255], v[188:191], v[82:85], v[252:255]
    v_mfma_f32_16x16x32_bf16 v[248:251], v[184:187], v[82:85], v[248:251]
    v_mfma_f32_16x16x32_bf16 v[124:127], v[184:187], v[76:79], v[124:127]
    s_branch ev_sum
ev_w0:
    s_waitcnt lgkmcnt(2)
    s_load_dwordx8 s[28:35], s[86:87], s93 glc
    s_add_u32 s101, s101, 1
    s_cmp_gt_u32 s101, 0x2000000
    s_cbranch_scc1 ev_done
    s_or_b64 s[88:89], s[28:29], s[30:31]
    s_or_b64 s[88:89], s[88:89], s[32:33]
    s_or_b64 s[88:89], s[88:89], s[34:35]
    s_or_b32 s66, s88, s89
    s_andn2_b32 s69, s66, s80
    s_cbranch_scc0 ev_w0
ev_i0:
    s_ff1_i32_b32 s69, s69
    s_xor_b32 s81, s53, s69
    s_mul_i32 s81, s81, 20480
    s_add_u32 s81, s81, s59
    s_bitset1_b32 s80, s69
    s_cmp_eq_u32 s80, -1
    s_cbranch_scc0 ev_n0
    buffer_load_dwordx4 a[122:125], v14, s[24:27], s81 offen sc1
    buffer_load_dwordx4 a[126:129], v14, s[24:27], s81 offen offset:1024 sc1
    buffer_load_dwordx2 a[120:121], v39, s[24:27], s81 offen offset:2048 sc1
    s_branch ev_z
ev_n0:
    buffer_load_dwordx4 v[58:61], v14, s[24:27], s81 offen sc1
    buffer_load_dwordx4 v[62:65], v14, s[24:27], s81 offen offset:1024 sc1
    buffer_load_dwordx2 v[56:57], v39, s[24:27], s81 offen offset:2048 sc1
    s_andn2_b32 s69, s66, s80
    s_cbranch_scc0 ev_w1
ev_i1:
    s_ff1_i32_b32 s69, s69
    s_xor_b32 s81, s53, s69
    s_mul_i32 s81, s81, 20480
    s_add_u32 s81, s81, s59
    s_bitset1_b32 s80, s69
    s_cmp_eq_u32 s80, -1
    s_cbranch_scc1 ev_l1
    buffer_load_dwordx4 v[68:71], v14, s[24:27], s81 offen sc1
    buffer_load_dwordx4 v[72:75], v14, s[24:27], s81 offen offset:1024 sc1
    buffer_load_dwordx2 v[66:67], v39, s[24:27], s81 offen offset:2048 sc1
    s_andn2_b32 s69, s66, s80
    s_cbranch_scc0 ev_w2
ev_i2:
    s_ff1_i32_b32 s69, s69
    s_xor_b32 s81, s53, s69
    s_mul_i32 s81, s81, 20480
    s_add_u32 s81, s81, s59
    s_bitset1_b32 s80, s69
    s_cmp_eq_u32 s80, -1
    s_cbranch_scc1 ev_l2
    buffer_load_dwordx4 v[78:81], v14, s[24:27], s81 offen sc1
    buffer_load_dwordx4 v[82:85], v14, s[24:27], s81 offen offset:1024 sc1
    buffer_load_dwordx2 v[76:77], v39, s[24:27], s81 offen offset:2048 sc1
    s_andn2_b32 s69, s66, s80
    s_cbranch_scc0 ev_w3
ev_i3:
    s_ff1_i32_b32 s69, s69
    s_xor_b32 s81, s53, s69
    s_mul_i32 s81, s81, 20480
    s_add_u32 s81, s81, s59
    s_bitset1_b32 s80, s69
    s_cmp_eq_u32 s80, -1
    s_cbranch_scc1 ev_l3
    buffer_load_dwordx4 a[2:5], v14, s[24:27], s81 offen sc1
    buffer_load_dwordx4 a[6:9], v14, s[24:27], s81 offen offset:1024 sc1
    buffer_load_dwordx2 a[0:1], v39, s[24:27], s81 offen offset:2048 sc1
    s_andn2_b32 s69, s66, s80
    s_cbranch_scc0 ev_w4
ev_i4:
    s_ff1_i32_b32 s69, s69
    s_xor_b32 s81, s53, s69
    s_mul_i32 s81, s81, 20480
    s_add_u32 s81, s81, s59
    s_bitset1_b32 s80, s69
    s_cmp_eq_u32 s80, -1
    s_cbranch_scc1 ev_l4
    buffer_load_dwordx4 a[12:15], v14, s[24:27], s81 offen sc1
    buffer_load_dwordx4 a[16:19], v14, s[24:27], s81 offen offset:1024 sc1
    buffer_load_dwordx2 a[10:11], v39, s[24:27], s81 offen offset:2048 sc1
    s_andn2_b32 s69, s66, s80
    s_cbranch_scc0 ev_w5
ev_i5:
    s_ff1_i32_b32 s69, s69
    s_xor_b32 s81, s53, s69
    s_mul_i32 s81, s81, 20480
    s_add_u32 s81, s81, s59
    s_bitset1_b32 s80, s69
    s_cmp_eq_u32 s80, -1
    s_cbranch_scc1 ev_l5
    buffer_load_dwordx4 a[22:25], v14, s[24:27], s81 offen sc1
    buffer_load_dwordx4 a[26:29], v14, s[24:27], s81 offen offset:1024 sc1
    buffer_load_dwordx2 a[20:21], v39, s[24:27], s81 offen offset:2048 sc1
    s_andn2_b32 s69, s66, s80
    s_cbranch_scc0 ev_w6
ev_i6:
    s_ff1_i32_b32 s69, s69
    s_xor_b32 s81, s53, s69
    s_mul_i32 s81, s81, 20480
    s_add_u32 s81, s81, s59
    s_bitset1_b32 s80, s69
    s_cmp_eq_u32 s80, -1
    s_cbranch_scc1 ev_l6
    buffer_load_dwordx4 a[32:35], v14, s[24:27], s81 offen sc1
    buffer_load_dwordx4 a[36:39], v14, s[24:27], s81 offen offset:1024 sc1
    buffer_load_dwordx2 a[30:31], v39, s[24:27], s81 offen offset:2048 sc1
    s_waitcnt vmcnt(0)
ev_c7:
    v_mfma_f32_16x16x32_bf16 v[240:243], v[184:187], a[32:35], v[240:243]
    v_mfma_f32_16x16x32_bf16 v[244:247], v[188:191], a[32:35], v[244:247]
    v_mfma_f32_16x16x32_bf16 v[252:255], v[188:191], a[36:39], v[252:255]
    v_mfma_f32_16x16x32_bf16 v[248:251], v[184:187], a[36:39], v[248:251]
    v_mfma_f32_16x16x32_bf16 v[124:127], v[184:187], a[30:33], v[124:127]
ev_c6:
    v_mfma_f32_16x16x32_bf16 v[240:243], v[184:187], a[22:25], v[240:243]
    v_mfma_f32_16x16x32_bf16 v[244:247], v[188:191], a[22:25], v[244:247]
    v_mfma_f32_16x16x32_bf16 v[252:255], v[188:191], a[26:29], v[252:255]
    v_mfma_f32_16x16x32_bf16 v[248:251], v[184:187], a[26:29], v[248:251]
    v_mfma_f32_16x16x32_bf16 v[124:127], v[184:187], a[20:23], v[124:127]
ev_c5:
    v_mfma_f32_16x16x32_bf16 v[240:243], v[184:187], a[12:15], v[240:243]
    v_mfma_f32_16x16x32_bf16 v[244:247], v[188:191], a[12:15], v[244:247]
    v_mfma_f32_16x16x32_bf16 v[252:255], v[188:191], a[16:19], v[252:255]
    v_mfma_f32_16x16x32_bf16 v[248:251], v[184:187], a[16:19], v[248:251]
    v_mfma_f32_16x16x32_bf16 v[124:127], v[184:187], a[10:13], v[124:127]
ev_c4:
    v_mfma_f32_16x16x32_bf16 v[240:243], v[184:187], a[2:5], v[240:243]
    v_mfma_f32_16x16x32_bf16 v[244:247], v[188:191], a[2:5], v[244:247]
    v_mfma_f32_16x16x32_bf16 v[252:255], v[188:191], a[6:9], v[252:255]
    v_mfma_f32_16x16x32_bf16 v[248:251], v[184:187], a[6:9], v[248:251]
    v_mfma_f32_16x16x32_bf16 v[124:127], v[184:187], a[0:3], v[124:127]
ev_c3:
    v_mfma_f32_16x16x32_bf16 v[240:243], v[184:187], v[78:81], v[240:243]
    v_mfma_f32_16x16x32_bf16 v[244:247], v[188:191], v[78:81], v[244:247]
    v_mfma_f32_16x16x32_bf16 v[252:255], v[188:191], v[82:85], v[252:255]
    v_mfma_f32_16x16x32_bf16 v[248:251], v[184:187], v[82:85], v[248:251]
    v_mfma_f32_16x16x32_bf16 v[124:127], v[184:187], v[76:79], v[124:127]
ev_c2:
    v_mfma_f32_16x16x32_bf16 v[240:243], v[184:187], v[68:71], v[240:243]
    v_mfma_f32_16x16x32_bf16 v[244:247], v[188:191], v[68:71], v[244:247]
    v_mfma_f32_16x16x32_bf16 v[252:255], v[188:191], v[72:75], v[252:255]
    v_mfma_f32_16x16x32_bf16 v[248:251], v[184:187], v[72:75], v[248:251]
    v_mfma_f32_16x16x32_bf16 v[124:127], v[184:187], v[66:69], v[124:127]
ev_c1:
    v_mfma_f32_16x16x32_bf16 v[240:243], v[184:187], v[58:61], v[240:243]
    v_mfma_f32_16x16x32_bf16 v[244:247], v[188:191], v[58:61], v[244:247]
    v_mfma_f32_16x16x32_bf16 v[252:255], v[188:191], v[62:65], v[252:255]
    v_mfma_f32_16x16x32_bf16 v[248:251], v[184:187], v[62:65], v[248:251]
    v_mfma_f32_16x16x32_bf16 v[124:127], v[184:187], v[56:59], v[124:127]
    s_cmp_lg_u32 s80, -1
    s_cbranch_scc1 ev_w0
ev_z:
    s_waitcnt vmcnt(0)
    v_mfma_f32_16x16x32_bf16 v[240:243], v[184:187], a[122:125], v[240:243]
    v_mfma_f32_16x16x32_bf16 v[244:247], v[188:191], a[122:125], v[244:247]
    v_mfma_f32_16x16x32_bf16 v[252:255], v[188:191], a[126:129], v[252:255]
    v_mfma_f32_16x16x32_bf16 v[248:251], v[184:187], a[126:129], v[248:251]
    v_mfma_f32_16x16x32_bf16 v[124:127], v[184:187], a[120:123], v[124:127]
ev_sum:
    s_nop 4
    v_pk_fma_f32 v[240:241], v[240:241], v[208:209], v[192:193]
    v_pk_fma_f32 v[242:243], v[242:243], v[210:211], v[194:195]
    v_pk_fma_f32 v[244:245], v[244:245], v[212:213], v[196:197]
    v_pk_fma_f32 v[246:247], v[246:247], v[214:215], v[198:199]
    v_cvt_pk_bf16_f32 v240, v240, v241
    v_cvt_pk_bf16_f32 v241, v242, v243
    v_cvt_pk_bf16_f32 v242, v244, v245
    v_cvt_pk_bf16_f32 v243, v246, v247
    s_nop 1
    v_permlane16_swap_b32 v240, v242
    v_permlane16_swap_b32 v241, v243
    buffer_store_dwordx4 v[240:243], v4, s[16:19], s64 offen sc1
    v_pk_fma_f32 v[248:249], v[248:249], v[216:217], v[200:201]
    v_pk_fma_f32 v[250:251], v[250:251], v[218:219], v[202:203]
    v_pk_fma_f32 v[252:253], v[252:253], v[220:221], v[204:205]
    v_pk_fma_f32 v[254:255], v[254:255], v[222:223], v[206:207]
    v_cvt_pk_bf16_f32 v248, v248, v249
    v_cvt_pk_bf16_f32 v249, v250, v251
    v_cvt_pk_bf16_f32 v250, v252, v253
    v_cvt_pk_bf16_f32 v251, v254, v255
    s_nop 1
    v_permlane16_swap_b32 v248, v250
    v_permlane16_swap_b32 v249, v251
    buffer_store_dwordx4 v[248:251], v34, s[16:19], s64 offen sc1
    v_pk_fma_f32 v[124:125], v[124:125], v[116:117], v[50:51]
    v_pk_fma_f32 v[126:127], v[126:127], v[118:119], v[52:53]
    v_cvt_pk_bf16_f32 v124, v124, v125
    v_cvt_pk_bf16_f32 v125, v126, v127
    buffer_store_dwordx2 v[124:125], v35, s[16:19], s68 offen sc1
ev_done:
    s_or_b32 s56, s2, s3
    s_cmp_eq_u32 s56, 0
    s_cselect_b32 s56, 0, 0x7ffffff0
    s_add_u32 s56, s56, 3203072
    buffer_store_dword v6, v15, s[24:27], s56 offen
main_fin:
main_end:
    s_endpgm
ev_w1:
    s_getreg_b32 s56, hwreg(HW_REG_IB_STS, 0, 4)
    s_cmp_eq_u32 s56, 0
    s_cbranch_scc1 ev_d1
    s_waitcnt lgkmcnt(2)
    s_load_dwordx8 s[28:35], s[86:87], s93 glc
    s_add_u32 s101, s101, 1
    s_cmp_gt_u32 s101, 0x2000000
    s_cbranch_scc1 ev_done
    s_or_b64 s[88:89], s[28:29], s[30:31]
    s_or_b64 s[88:89], s[88:89], s[32:33]
    s_or_b64 s[88:89], s[88:89], s[34:35]
    s_or_b32 s66, s88, s89
    s_andn2_b32 s69, s66, s80
    s_cbranch_scc0 ev_w1
    s_branch ev_i1
ev_d1:
    s_waitcnt vmcnt(0)
    s_branch ev_c1
ev_l1:
    buffer_load_dwordx4 a[122:125], v14, s[24:27], s81 offen sc1
    buffer_load_dwordx4 a[126:129], v14, s[24:27], s81 offen offset:1024 sc1
    buffer_load_dwordx2 a[120:121], v39, s[24:27], s81 offen offset:2048 sc1
    s_waitcnt vmcnt(3)
    s_branch ev_c1
ev_w2:
    s_getreg_b32 s56, hwreg(HW_REG_IB_STS, 0, 4)
    s_cmp_eq_u32 s56, 0
    s_cbranch_scc1 ev_d2
    s_waitcnt lgkmcnt(2)
    s_load_dwordx8 s[28:35], s[86:87], s93 glc
    s_add_u32 s101, s101, 1
    s_cmp_gt_u32 s101, 0x2000000
    s_cbranch_scc1 ev_done
    s_or_b64 s[88:89], s[28:29], s[30:31]
    s_or_b64 s[88:89], s[88:89], s[32:33]
    s_or_b64 s[88:89], s[88:89], s[34:35]
    s_or_b32 s66, s88, s89
    s_andn2_b32 s69, s66, s80
    s_cbranch_scc0 ev_w2
    s_branch ev_i2
ev_d2:
    s_waitcnt vmcnt(0)
    s_branch ev_c2
ev_l2:
    buffer_load_dwordx4 a[122:125], v14, s[24:27], s81 offen sc1
    buffer_load_dwordx4 a[126:129], v14, s[24:27], s81 offen offset:1024 sc1
    buffer_load_dwordx2 a[120:121], v39, s[24:27], s81 offen offset:2048 sc1
    s_waitcnt vmcnt(3)
    s_branch ev_c2
ev_w3:
    s_getreg_b32 s56, hwreg(HW_REG_IB_STS, 0, 4)
    s_cmp_eq_u32 s56, 0
    s_cbranch_scc1 ev_d3
    s_waitcnt lgkmcnt(2)
    s_load_dwordx8 s[28:35], s[86:87], s93 glc
    s_add_u32 s101, s101, 1
    s_cmp_gt_u32 s101, 0x2000000
    s_cbranch_scc1 ev_done
    s_or_b64 s[88:89], s[28:29], s[30:31]
    s_or_b64 s[88:89], s[88:89], s[32:33]
    s_or_b64 s[88:89], s[88:89], s[34:35]
    s_or_b32 s66, s88, s89
    s_andn2_b32 s69, s66, s80
    s_cbranch_scc0 ev_w3
    s_branch ev_i3
ev_d3:
    s_waitcnt vmcnt(0)
    s_branch ev_c3
ev_l3:
    buffer_load_dwordx4 a[122:125], v14, s[24:27], s81 offen sc1
    buffer_load_dwordx4 a[126:129], v14, s[24:27], s81 offen offset:1024 sc1
    buffer_load_dwordx2 a[120:121], v39, s[24:27], s81 offen offset:2048 sc1
    s_waitcnt vmcnt(3)
    s_branch ev_c3
ev_w4:
    s_getreg_b32 s56, hwreg(HW_REG_IB_STS, 0, 4)
    s_cmp_eq_u32 s56, 0
    s_cbranch_scc1 ev_d4
    s_waitcnt lgkmcnt(2)
    s_load_dwordx8 s[28:35], s[86:87], s93 glc
    s_add_u32 s101, s101, 1
    s_cmp_gt_u32 s101, 0x2000000
    s_cbranch_scc1 ev_done
    s_or_b64 s[88:89], s[28:29], s[30:31]
    s_or_b64 s[88:89], s[88:89], s[32:33]
    s_or_b64 s[88:89], s[88:89], s[34:35]
    s_or_b32 s66, s88, s89
    s_andn2_b32 s69, s66, s80
    s_cbranch_scc0 ev_w4
    s_branch ev_i4
ev_d4:
    s_waitcnt vmcnt(0)
    s_branch ev_c4
ev_l4:
    buffer_load_dwordx4 a[122:125], v14, s[24:27], s81 offen sc1
    buffer_load_dwordx4 a[126:129], v14, s[24:27], s81 offen offset:1024 sc1
    buffer_load_dwordx2 a[120:121], v39, s[24:27], s81 offen offset:2048 sc1
    s_waitcnt vmcnt(3)
    s_branch ev_c4
ev_w5:
    s_getreg_b32 s56, hwreg(HW_REG_IB_STS, 0, 4)
    s_cmp_eq_u32 s56, 0
    s_cbranch_scc1 ev_d5
    s_waitcnt lgkmcnt(2)
    s_load_dwordx8 s[28:35], s[86:87], s93 glc
    s_add_u32 s101, s101, 1
    s_cmp_gt_u32 s101, 0x2000000
    s_cbranch_scc1 ev_done
    s_or_b64 s[88:89], s[28:29], s[30:31]
    s_or_b64 s[88:89], s[88:89], s[32:33]
    s_or_b64 s[88:89], s[88:89], s[34:35]
    s_or_b32 s66, s88, s89
    s_andn2_b32 s69, s66, s80
    s_cbranch_scc0 ev_w5
    s_branch ev_i5
ev_d5:
    s_waitcnt vmcnt(0)
    s_branch ev_c5
ev_l5:
    buffer_load_dwordx4 a[122:125], v14, s[24:27], s81 offen sc1
    buffer_load_dwordx4 a[126:129], v14, s[24:27], s81 offen offset:1024 sc1
    buffer_load_dwordx2 a[120:121], v39, s[24:27], s81 offen offset:2048 sc1
    s_waitcnt vmcnt(3)
    s_branch ev_c5
ev_w6:
    s_getreg_b32 s56, hwreg(HW_REG_IB_STS, 0, 4)
    s_cmp_eq_u32 s56, 0
    s_cbranch_scc1 ev_d6
    s_waitcnt lgkmcnt(2)
    s_load_dwordx8 s[28:35], s[86:87], s93 glc
    s_add_u32 s101, s101, 1
    s_cmp_gt_u32 s101, 0x2000000
    s_cbranch_scc1 ev_done
    s_or_b64 s[88:89], s[28:29], s[30:31]
    s_or_b64 s[88:89], s[88:89], s[32:33]
    s_or_b64 s[88:89], s[88:89], s[34:35]
    s_or_b32 s66, s88, s89
    s_andn2_b32 s69, s66, s80
    s_cbranch_scc0 ev_w6
    s_branch ev_i6
ev_d6:
    s_waitcnt vmcnt(0)
    s_branch ev_c6
ev_l6:
    buffer_load_dwordx4 a[122:125], v14, s[24:27], s81 offen sc1
    buffer_load_dwordx4 a[126:129], v14, s[24:27], s81 offen offset:1024 sc1
    buffer_load_dwordx2 a[120:121], v39, s[24:27], s81 offen offset:2048 sc1
    s_waitcnt vmcnt(3)
    s_branch ev_c6
spin_o0:
    s_load_dwordx4 s[72:75], s[86:87], s5 glc
    s_add_u32 s101, s101, 1
    s_cmp_gt_u32 s101, 0x2000000
    s_waitcnt lgkmcnt(0)
    s_cbranch_scc1 spin_o0_ret
    s_sub_u32 s78, s72, s77
    s_sub_u32 s79, s73, s77
    s_max_u32 s78, s78, s79
    s_sub_u32 s79, s74, s77
    s_max_u32 s78, s78, s79
    s_sub_u32 s79, s75, s77
    s_max_u32 s78, s78, s79
    s_cmp_gt_u32 s78, 5
    s_cbranch_scc1 spin_o0
    s_branch spin_o0_ret
spin_o1:
    s_load_dwordx4 s[72:75], s[86:87], s5 glc
    s_add_u32 s101, s101, 1
    s_cmp_gt_u32 s101, 0x2000000
    s_waitcnt lgkmcnt(0)
    s_cbranch_scc1 spin_o1_ret
    s_sub_u32 s78, s72, s77
    s_sub_u32 s79, s73, s77
    s_max_u32 s78, s78, s79
    s_sub_u32 s79, s74, s77
    s_max_u32 s78, s78, s79
    s_sub_u32 s79, s75, s77
    s_max_u32 s78, s78, s79
    s_cmp_gt_u32 s78, 4
    s_cbranch_scc1 spin_o1
    s_branch spin_o1_ret
spin_o2:
    s_load_dwordx4 s[72:75], s[86:87], s5 glc
    s_add_u32 s101, s101, 1
    s_cmp_gt_u32 s101, 0x2000000
    s_waitcnt lgkmcnt(0)
    s_cbranch_scc1 spin_o2_ret
    s_sub_u32 s78, s72, s77
    s_sub_u32 s79, s73, s77
    s_max_u32 s78, s78, s79
    s_sub_u32 s79, s74, s77
    s_max_u32 s78, s78, s79
    s_sub_u32 s79, s75, s77
    s_max_u32 s78, s78, s79
    s_cmp_gt_u32 s78, 3
    s_cbranch_scc1 spin_o2
    s_branch spin_o2_ret
spin_o3:
    s_load_dwordx4 s[72:75], s[86:87], s5 glc
    s_add_u32 s101, s101, 1
    s_cmp_gt_u32 s101, 0x2000000
    s_waitcnt lgkmcnt(0)
    s_cbranch_scc1 spin_o3_ret
    s_sub_u32 s78, s72, s77
    s_sub_u32 s79, s73, s77
    s_max_u32 s78, s78, s79
    s_sub_u32 s79, s74, s77
    s_max_u32 s78, s78, s79
    s_sub_u32 s79, s75, s77
    s_max_u32 s78, s78, s79
    s_cmp_gt_u32 s78, 2
    s_cbranch_scc1 spin_o3
    s_branch spin_o3_ret
spin_o4:
    s_load_dwordx4 s[72:75], s[86:87], s5 glc
    s_add_u32 s101, s101, 1
    s_cmp_gt_u32 s101, 0x2000000
    s_waitcnt lgkmcnt(0)
    s_cbranch_scc1 spin_o4_ret
    s_sub_u32 s78, s72, s77
    s_sub_u32 s79, s73, s77
    s_max_u32 s78, s78, s79
    s_sub_u32 s79, s74, s77
    s_max_u32 s78, s78, s79
    s_sub_u32 s79, s75, s77
    s_max_u32 s78, s78, s79
    s_cmp_gt_u32 s78, 1
    s_cbranch_scc1 spin_o4
    s_branch spin_o4_ret
spin_o5:
    s_load_dwordx4 s[72:75], s[86:87], s5 glc
    s_add_u32 s101, s101, 1
    s_cmp_gt_u32 s101, 0x2000000
    s_waitcnt lgkmcnt(0)
    s_cbranch_scc1 spin_o5_ret
    s_sub_u32 s78, s72, s77
    s_sub_u32 s79, s73, s77
    s_max_u32 s78, s78, s79
    s_sub_u32 s79, s74, s77
    s_max_u32 s78, s78, s79
    s_sub_u32 s79, s75, s77
    s_max_u32 s78, s78, s79
    s_cmp_gt_u32 s78, 0
    s_cbranch_scc1 spin_o5
    s_branch spin_o5_ret
spin_y:
    s_add_u32 s101, s101, 1
    s_cmp_gt_u32 s101, 0x2000000
    s_cbranch_scc1 spin_y_x
    buffer_load_dword v58, v65, s[24:27], s41 offen sc1
    buffer_load_dword v59, v65, s[24:27], s42 offen sc1
    s_waitcnt vmcnt(0)
    v_xor_b32 v58, s58, v58
    v_xor_b32 v59, s58, v59
    v_or_b32 v58, v58, v59
    v_cmp_ne_u32 vcc, 0, v58
    s_cbranch_vccnz spin_y
spin_y_x:
    s_branch spin_y_ret
spin_rec:
    s_add_u32 s101, s101, 1
    s_cmp_gt_u32 s101, 0x2000000
    s_cbranch_scc1 spin_rec_x
    buffer_load_dwordx4 v[32:35], v17, s[24:27], s47 offen offset:0 sc1
    buffer_load_dwordx4 v[36:39], v17, s[24:27], s47 offen offset:1024 sc1
    buffer_load_dwordx4 v[40:43], v17, s[24:27], s47 offen offset:2048 sc1
    buffer_load_dwordx4 v[44:47], v17, s[24:27], s47 offen offset:3072 sc1
    s_waitcnt vmcnt(0)
    v_xor_b32 v34, s7, v34
    v_xor_b32 v38, s7, v38
    v_xor_b32 v42, s7, v42
    v_xor_b32 v46, s7, v46
    v_or3_b32 v34, v34, v38, v42
    v_or_b32 v34, v34, v46
    v_cmp_ne_u32 vcc, 0, v34
    s_cbranch_vccnz spin_rec
spin_rec_x:
    s_branch spin_rec_ret
spin_gu:
    s_add_u32 s101, s101, 1
    s_cmp_gt_u32 s101, 0x2000000
    s_cbranch_scc1 spin_gu_x
    buffer_load_dword v23, v22, s[24:27], s42 offen sc1
    s_waitcnt vmcnt(0)
    v_cmp_ne_u32 vcc, s7, v23
    s_cbranch_vccnz spin_gu
spin_gu_x:
    s_branch spin_gu_ret
rare:
    s_nop 7
    s_nop 7
    v_and_b32 v21, 15, v1
    v_mul_u32_u24 v21, 384, v21
    v_bfe_u32 v22, v1, 4, 1
    v_bfe_u32 v23, v1, 5, 1
    v_lshl_add_u32 v22, v22, 1, v23
    v_lshl_add_u32 v21, v22, 4, v21
    v_mov_b32 v24, 0
    v_mov_b32 v25, 0
    v_mov_b32 v26, 0
    v_mov_b32 v27, 0
    v_mov_b32 v28, 0
    v_mov_b32 v29, 0
    v_mov_b32 v30, 0
    v_mov_b32 v31, 0
    v_mov_b32 v32, 0
    v_mov_b32 v33, 0
    v_mov_b32 v34, 0
    v_mov_b32 v35, 0
    v_mov_b32 v36, 0
    v_mov_b32 v37, 0
    v_mov_b32 v38, 0
    v_mov_b32 v39, 0
    v_mov_b32 v16, 0xff800000
    v_mov_b32 v17, 0xff800000
    v_mov_b32 v18, 0xff800000
    v_mov_b32 v19, 0xff800000
    s_mov_b32 s78, 0
rare_pass:
    s_mov_b32 s77, 0
rare_loop:
    buffer_load_dwordx4 a[216:219], v21, s[12:15], s77 offen offset:0
    buffer_load_dwordx4 a[220:223], v21, s[12:15], s77 offen offset:64
    buffer_load_dwordx4 a[224:227], v21, s[12:15], s77 offen offset:128
    buffer_load_dwordx4 a[228:231], v21, s[12:15], s77 offen offset:192
    buffer_load_dwordx4 a[232:235], v21, s[12:15], s77 offen offset:256
    buffer_load_dwordx4 a[236:239], v21, s[12:15], s77 offen offset:320
    s_waitcnt vmcnt(0)
    v_mfma_f32_16x16x32_bf16 v[40:43], a[216:219], a[0:3], v[24:27]
    v_mfma_f32_16x16x32_bf16 v[44:47], a[216:219], a[4:7], v[28:31]
    v_mfma_f32_16x16x32_bf16 v[48:51], a[216:219], a[8:11], v[32:35]
    v_mfma_f32_16x16x32_bf16 v[52:55], a[216:219], a[12:15], v[36:39]
    v_mfma_f32_16x16x32_bf16 v[40:43], a[220:223], a[16:19], v[40:43]
    v_mfma_f32_16x16x32_bf16 v[44:47], a[220:223], a[20:23], v[44:47]
    v_mfma_f32_16x16x32_bf16 v[48:51], a[220:223], a[24:27], v[48:51]
    v_mfma_f32_16x16x32_bf16 v[52:55], a[220:223], a[28:31], v[52:55]
    v_mfma_f32_16x16x32_bf16 v[40:43], a[224:227], a[32:35], v[40:43]
    v_mfma_f32_16x16x32_bf16 v[44:47], a[224:227], a[36:39], v[44:47]
    v_mfma_f32_16x16x32_bf16 v[48:51], a[224:227], a[40:43], v[48:51]
    v_mfma_f32_16x16x32_bf16 v[52:55], a[224:227], a[44:47], v[52:55]
    v_mfma_f32_16x16x32_bf16 v[40:43], a[228:231], a[48:51], v[40:43]
    v_mfma_f32_16x16x32_bf16 v[44:47], a[228:231], a[52:55], v[44:47]
    v_mfma_f32_16x16x32_bf16 v[48:51], a[228:231], a[56:59], v[48:51]
    v_mfma_f32_16x16x32_bf16 v[52:55], a[228:231], a[60:63], v[52:55]
    v_mfma_f32_16x16x32_bf16 v[40:43], a[232:235], a[64:67], v[40:43]
    v_mfma_f32_16x16x32_bf16 v[44:47], a[232:235], a[68:71], v[44:47]
    v_mfma_f32_16x16x32_bf16 v[48:51], a[232:235], a[72:75], v[48:51]
    v_mfma_f32_16x16x32_bf16 v[52:55], a[232:235], a[76:79], v[52:55]
    v_mfma_f32_16x16x32_bf16 v[40:43], a[236:239], a[80:83], v[40:43]
    v_mfma_f32_16x16x32_bf16 v[44:47], a[236:239], a[84:87], v[44:47]
    v_mfma_f32_16x16x32_bf16 v[48:51], a[236:239], a[88:91], v[48:51]
    v_mfma_f32_16x16x32_bf16 v[52:55], a[236:239], a[92:95], v[52:55]
    s_nop 7
    s_cmp_eq_u32 s78, 0
    s_cbranch_scc0 rare_p2
    v_max3_f32 v16, v16, v40, v41
    v_max3_f32 v16, v16, v42, v43
    v_max3_f32 v17, v17, v44, v45
    v_max3_f32 v17, v17, v46, v47
    v_max3_f32 v18, v18, v48, v49
    v_max3_f32 v18, v18, v50, v51
    v_max3_f32 v19, v19, v52, v53
    v_max3_f32 v19, v19, v54, v55
    s_add_u32 s77, s77, 6144
    s_cmp_lt_u32 s77, 196608
    s_cbranch_scc1 rare_loop
    v_mov_b32 v22, v16
    s_nop 1
    v_permlane16_swap_b32 v16, v22
    s_nop 1
    v_max_f32 v16, v16, v22
    v_mov_b32 v22, v16
    s_nop 1
    v_permlane32_swap_b32 v16, v22
    s_nop 1
    v_max_f32 v16, v16, v22
    v_sub_f32 v24, 0, v16
    v_sub_f32 v25, 0, v16
    v_sub_f32 v26, 0, v16
    v_sub_f32 v27, 0, v16
    v_mov_b32 v22, v17
    s_nop 1
    v_permlane16_swap_b32 v17, v22
    s_nop 1
    v_max_f32 v17, v17, v22
    v_mov_b32 v22, v17
    s_nop 1
    v_permlane32_swap_b32 v17, v22
    s_nop 1
    v_max_f32 v17, v17, v22
    v_sub_f32 v28, 0, v17
    v_sub_f32 v29, 0, v17
    v_sub_f32 v30, 0, v17
    v_sub_f32 v31, 0, v17
    v_mov_b32 v22, v18
    s_nop 1
    v_permlane16_swap_b32 v18, v22
    s_nop 1
    v_max_f32 v18, v18, v22
    v_mov_b32 v22, v18
    s_nop 1
    v_permlane32_swap_b32 v18, v22
    s_nop 1
    v_max_f32 v18, v18, v22
    v_sub_f32 v32, 0, v18
    v_sub_f32 v33, 0, v18
    v_sub_f32 v34, 0, v18
    v_sub_f32 v35, 0, v18
    v_mov_b32 v22, v19
    s_nop 1
    v_permlane16_swap_b32 v19, v22
    s_nop 1
    v_max_f32 v19, v19, v22
    v_mov_b32 v22, v19
    s_nop 1
    v_permlane32_swap_b32 v19, v22
    s_nop 1
    v_max_f32 v19, v19, v22
    v_sub_f32 v36, 0, v19
    v_sub_f32 v37, 0, v19
    v_sub_f32 v38, 0, v19
    v_sub_f32 v39, 0, v19
    s_mov_b32 s78, 1
    s_branch rare_pass
rare_p2:
    v_exp_f32 v40, v40
    v_exp_f32 v41, v41
    v_exp_f32 v42, v42
    v_exp_f32 v43, v43
    v_exp_f32 v44, v44
    v_exp_f32 v45, v45
    v_exp_f32 v46, v46
    v_exp_f32 v47, v47
    v_exp_f32 v48, v48
    v_exp_f32 v49, v49
    v_exp_f32 v50, v50
    v_exp_f32 v51, v51
    v_exp_f32 v52, v52
    v_exp_f32 v53, v53
    v_exp_f32 v54, v54
    v_exp_f32 v55, v55
    s_cmp_eq_u32 s77, 0
    s_cbranch_scc0 rare_d0
    v_cvt_pk_bf16_f32 v22, v40, v41
    v_cvt_pk_bf16_f32 v23, v42, v43
    v_accvgpr_write_b32 a96, v22
    v_accvgpr_write_b32 a97, v23
    v_cvt_pk_bf16_f32 v22, v44, v45
    v_cvt_pk_bf16_f32 v23, v46, v47
    v_accvgpr_write_b32 a104, v22
    v_accvgpr_write_b32 a105, v23
    v_cvt_pk_bf16_f32 v22, v48, v49
    v_cvt_pk_bf16_f32 v23, v50, v51
    v_accvgpr_write_b32 a112, v22
    v_accvgpr_write_b32 a113, v23
    v_cvt_pk_bf16_f32 v22, v52, v53
    v_cvt_pk_bf16_f32 v23, v54, v55
    v_accvgpr_write_b32 a120, v22
    v_accvgpr_write_b32 a121, v23
rare_d0:
    s_cmp_eq_u32 s77, 6144
    s_cbranch_scc0 rare_d1
    v_cvt_pk_bf16_f32 v22, v40, v41
    v_cvt_pk_bf16_f32 v23, v42, v43
    v_accvgpr_write_b32 a98, v22
    v_accvgpr_write_b32 a99, v23
    v_cvt_pk_bf16_f32 v22, v44, v45
    v_cvt_pk_bf16_f32 v23, v46, v47
    v_accvgpr_write_b32 a106, v22
    v_accvgpr_write_b32 a107, v23
    v_cvt_pk_bf16_f32 v22, v48, v49
    v_cvt_pk_bf16_f32 v23, v50, v51
    v_accvgpr_write_b32 a114, v22
    v_accvgpr_write_b32 a115, v23
    v_cvt_pk_bf16_f32 v22, v52, v53
    v_cvt_pk_bf16_f32 v23, v54, v55
    v_accvgpr_write_b32 a122, v22
    v_accvgpr_write_b32 a123, v23
rare_d1:
    s_cmp_eq_u32 s77, 12288
    s_cbranch_scc0 rare_d2
    v_cvt_pk_bf16_f32 v22, v40, v41
    v_cvt_pk_bf16_f32 v23, v42, v43
    v_accvgpr_write_b32 a100, v22
    v_accvgpr_write_b32 a101, v23
    v_cvt_pk_bf16_f32 v22, v44, v45
    v_cvt_pk_bf16_f32 v23, v46, v47
    v_accvgpr_write_b32 a108, v22
    v_accvgpr_write_b32 a109, v23
    v_cvt_pk_bf16_f32 v22, v48, v49
    v_cvt_pk_bf16_f32 v23, v50, v51
    v_accvgpr_write_b32 a116, v22
    v_accvgpr_write_b32 a117, v23
    v_cvt_pk_bf16_f32 v22, v52, v53
    v_cvt_pk_bf16_f32 v23, v54, v55
    v_accvgpr_write_b32 a124, v22
    v_accvgpr_write_b32 a125, v23
rare_d2:
    s_cmp_eq_u32 s77, 18432
    s_cbranch_scc0 rare_d3
    v_cvt_pk_bf16_f32 v22, v40, v41
    v_cvt_pk_bf16_f32 v23, v42, v43
    v_accvgpr_write_b32 a102, v22
    v_accvgpr_write_b32 a103, v23
    v_cvt_pk_bf16_f32 v22, v44, v45
    v_cvt_pk_bf16_f32 v23, v46, v47
    v_accvgpr_write_b32 a110, v22
    v_accvgpr_write_b32 a111, v23
    v_cvt_pk_bf16_f32 v22, v48, v49
    v_cvt_pk_bf16_f32 v23, v50, v51
    v_accvgpr_write_b32 a118, v22
    v_accvgpr_write_b32 a119, v23
    v_cvt_pk_bf16_f32 v22, v52, v53
    v_cvt_pk_bf16_f32 v23, v54, v55
    v_accvgpr_write_b32 a126, v22
    v_accvgpr_write_b32 a127, v23
rare_d3:
    s_cmp_eq_u32 s77, 24576
    s_cbranch_scc0 rare_d4
    v_cvt_pk_bf16_f32 v22, v40, v41
    v_cvt_pk_bf16_f32 v23, v42, v43
    v_accvgpr_write_b32 a128, v22
    v_accvgpr_write_b32 a129, v23
    v_cvt_pk_bf16_f32 v22, v44, v45
    v_cvt_pk_bf16_f32 v23, v46, v47
    v_accvgpr_write_b32 a136, v22
    v_accvgpr_write_b32 a137, v23
    v_cvt_pk_bf16_f32 v22, v48, v49
    v_cvt_pk_bf16_f32 v23, v50, v51
    v_accvgpr_write_b32 a144, v22
    v_accvgpr_write_b32 a145, v23
    v_cvt_pk_bf16_f32 v120, v52, v53
    v_cvt_pk_bf16_f32 v121, v54, v55
rare_d4:
    s_cmp_eq_u32 s77, 30720
    s_cbranch_scc0 rare_d5
    v_cvt_pk_bf16_f32 v22, v40, v41
    v_cvt_pk_bf16_f32 v23, v42, v43
    v_accvgpr_write_b32 a130, v22
    v_accvgpr_write_b32 a131, v23
    v_cvt_pk_bf16_f32 v22, v44, v45
    v_cvt_pk_bf16_f32 v23, v46, v47
    v_accvgpr_write_b32 a138, v22
    v_accvgpr_write_b32 a139, v23
    v_cvt_pk_bf16_f32 v22, v48, v49
    v_cvt_pk_bf16_f32 v23, v50, v51
    v_accvgpr_write_b32 a146, v22
    v_accvgpr_write_b32 a147, v23
    v_cvt_pk_bf16_f32 v122, v52, v53
    v_cvt_pk_bf16_f32 v123, v54, v55
rare_d5:
    s_cmp_eq_u32 s77, 36864
    s_cbranch_scc0 rare_d6
    v_cvt_pk_bf16_f32 v22, v40, v41
    v_cvt_pk_bf16_f32 v23, v42, v43
    v_accvgpr_write_b32 a132, v22
    v_accvgpr_write_b32 a133, v23
    v_cvt_pk_bf16_f32 v22, v44, v45
    v_cvt_pk_bf16_f32 v23, v46, v47
    v_accvgpr_write_b32 a140, v22
    v_accvgpr_write_b32 a141, v23
    v_cvt_pk_bf16_f32 v22, v48, v49
    v_cvt_pk_bf16_f32 v23, v50, v51
    v_accvgpr_write_b32 a148, v22
    v_accvgpr_write_b32 a149, v23
    v_cvt_pk_bf16_f32 v124, v52, v53
    v_cvt_pk_bf16_f32 v125, v54, v55
rare_d6:
    s_cmp_eq_u32 s77, 43008
    s_cbranch_scc0 rare_d7
    v_cvt_pk_bf16_f32 v22, v40, v41
    v_cvt_pk_bf16_f32 v23, v42, v43
    v_accvgpr_write_b32 a134, v22
    v_accvgpr_write_b32 a135, v23
    v_cvt_pk_bf16_f32 v22, v44, v45
    v_cvt_pk_bf16_f32 v23, v46, v47
    v_accvgpr_write_b32 a142, v22
    v_accvgpr_write_b32 a143, v23
    v_cvt_pk_bf16_f32 v22, v48, v49
    v_cvt_pk_bf16_f32 v23, v50, v51
    v_accvgpr_write_b32 a150, v22
    v_accvgpr_write_b32 a151, v23
    v_cvt_pk_bf16_f32 v126, v52, v53
    v_cvt_pk_bf16_f32 v127, v54, v55
rare_d7:
    s_cmp_eq_u32 s77, 49152
    s_cbranch_scc0 rare_d8
    v_cvt_pk_bf16_f32 v128, v40, v41
    v_cvt_pk_bf16_f32 v129, v42, v43
    v_cvt_pk_bf16_f32 v136, v44, v45
    v_cvt_pk_bf16_f32 v137, v46, v47
    v_cvt_pk_bf16_f32 v144, v48, v49
    v_cvt_pk_bf16_f32 v145, v50, v51
    v_cvt_pk_bf16_f32 v152, v52, v53
    v_cvt_pk_bf16_f32 v153, v54, v55
rare_d8:
    s_cmp_eq_u32 s77, 55296
    s_cbranch_scc0 rare_d9
    v_cvt_pk_bf16_f32 v130, v40, v41
    v_cvt_pk_bf16_f32 v131, v42, v43
    v_cvt_pk_bf16_f32 v138, v44, v45
    v_cvt_pk_bf16_f32 v139, v46, v47
    v_cvt_pk_bf16_f32 v146, v48, v49
    v_cvt_pk_bf16_f32 v147, v50, v51
    v_cvt_pk_bf16_f32 v154, v52, v53
    v_cvt_pk_bf16_f32 v155, v54, v55
rare_d9:
    s_cmp_eq_u32 s77, 61440
    s_cbranch_scc0 rare_d10
    v_cvt_pk_bf16_f32 v132, v40, v41
    v_cvt_pk_bf16_f32 v133, v42, v43
    v_cvt_pk_bf16_f32 v140, v44, v45
    v_cvt_pk_bf16_f32 v141, v46, v47
    v_cvt_pk_bf16_f32 v148, v48, v49
    v_cvt_pk_bf16_f32 v149, v50, v51
    v_cvt_pk_bf16_f32 v156, v52, v53
    v_cvt_pk_bf16_f32 v157, v54, v55
rare_d10:
    s_cmp_eq_u32 s77, 67584
    s_cbranch_scc0 rare_d11
    v_cvt_pk_bf16_f32 v134, v40, v41
    v_cvt_pk_bf16_f32 v135, v42, v43
    v_cvt_pk_bf16_f32 v142, v44, v45
    v_cvt_pk_bf16_f32 v143, v46, v47
    v_cvt_pk_bf16_f32 v150, v48, v49
    v_cvt_pk_bf16_f32 v151, v50, v51
    v_cvt_pk_bf16_f32 v158, v52, v53
    v_cvt_pk_bf16_f32 v159, v54, v55
rare_d11:
    s_cmp_eq_u32 s77, 73728
    s_cbranch_scc0 rare_d12
    v_cvt_pk_bf16_f32 v160, v40, v41
    v_cvt_pk_bf16_f32 v161, v42, v43
    v_cvt_pk_bf16_f32 v168, v44, v45
    v_cvt_pk_bf16_f32 v169, v46, v47
    v_cvt_pk_bf16_f32 v176, v48, v49
    v_cvt_pk_bf16_f32 v177, v50, v51
    v_cvt_pk_bf16_f32 v184, v52, v53
    v_cvt_pk_bf16_f32 v185, v54, v55
rare_d12:
    s_cmp_eq_u32 s77, 79872
    s_cbranch_scc0 rare_d13
    v_cvt_pk_bf16_f32 v162, v40, v41
    v_cvt_pk_bf16_f32 v163, v42, v43
    v_cvt_pk_bf16_f32 v170, v44, v45
    v_cvt_pk_bf16_f32 v171, v46, v47
    v_cvt_pk_bf16_f32 v178, v48, v49
    v_cvt_pk_bf16_f32 v179, v50, v51
    v_cvt_pk_bf16_f32 v186, v52, v53
    v_cvt_pk_bf16_f32 v187, v54, v55
rare_d13:
    s_cmp_eq_u32 s77, 86016
    s_cbranch_scc0 rare_d14
    v_cvt_pk_bf16_f32 v164, v40, v41
    v_cvt_pk_bf16_f32 v165, v42, v43
    v_cvt_pk_bf16_f32 v172, v44, v45
    v_cvt_pk_bf16_f32 v173, v46, v47
    v_cvt_pk_bf16_f32 v180, v48, v49
    v_cvt_pk_bf16_f32 v181, v50, v51
    v_cvt_pk_bf16_f32 v188, v52, v53
    v_cvt_pk_bf16_f32 v189, v54, v55
rare_d14:
    s_cmp_eq_u32 s77, 92160
    s_cbranch_scc0 rare_d15
    v_cvt_pk_bf16_f32 v166, v40, v41
    v_cvt_pk_bf16_f32 v167, v42, v43
    v_cvt_pk_bf16_f32 v174, v44, v45
    v_cvt_pk_bf16_f32 v175, v46, v47
    v_cvt_pk_bf16_f32 v182, v48, v49
    v_cvt_pk_bf16_f32 v183, v50, v51
    v_cvt_pk_bf16_f32 v190, v52, v53
    v_cvt_pk_bf16_f32 v191, v54, v55
rare_d15:
    s_cmp_eq_u32 s77, 98304
    s_cbranch_scc0 rare_d16
    v_cvt_pk_bf16_f32 v192, v40, v41
    v_cvt_pk_bf16_f32 v193, v42, v43
    v_cvt_pk_bf16_f32 v200, v44, v45
    v_cvt_pk_bf16_f32 v201, v46, v47
    v_cvt_pk_bf16_f32 v208, v48, v49
    v_cvt_pk_bf16_f32 v209, v50, v51
    v_cvt_pk_bf16_f32 v216, v52, v53
    v_cvt_pk_bf16_f32 v217, v54, v55
rare_d16:
    s_cmp_eq_u32 s77, 104448
    s_cbranch_scc0 rare_d17
    v_cvt_pk_bf16_f32 v194, v40, v41
    v_cvt_pk_bf16_f32 v195, v42, v43
    v_cvt_pk_bf16_f32 v202, v44, v45
    v_cvt_pk_bf16_f32 v203, v46, v47
    v_cvt_pk_bf16_f32 v210, v48, v49
    v_cvt_pk_bf16_f32 v211, v50, v51
    v_cvt_pk_bf16_f32 v218, v52, v53
    v_cvt_pk_bf16_f32 v219, v54, v55
rare_d17:
    s_cmp_eq_u32 s77, 110592
    s_cbranch_scc0 rare_d18
    v_cvt_pk_bf16_f32 v196, v40, v41
    v_cvt_pk_bf16_f32 v197, v42, v43
    v_cvt_pk_bf16_f32 v204, v44, v45
    v_cvt_pk_bf16_f32 v205, v46, v47
    v_cvt_pk_bf16_f32 v212, v48, v49
    v_cvt_pk_bf16_f32 v213, v50, v51
    v_cvt_pk_bf16_f32 v220, v52, v53
    v_cvt_pk_bf16_f32 v221, v54, v55
rare_d18:
    s_cmp_eq_u32 s77, 116736
    s_cbranch_scc0 rare_d19
    v_cvt_pk_bf16_f32 v198, v40, v41
    v_cvt_pk_bf16_f32 v199, v42, v43
    v_cvt_pk_bf16_f32 v206, v44, v45
    v_cvt_pk_bf16_f32 v207, v46, v47
    v_cvt_pk_bf16_f32 v214, v48, v49
    v_cvt_pk_bf16_f32 v215, v50, v51
    v_cvt_pk_bf16_f32 v222, v52, v53
    v_cvt_pk_bf16_f32 v223, v54, v55
rare_d19:
    s_cmp_eq_u32 s77, 122880
    s_cbranch_scc0 rare_d20
    v_cvt_pk_bf16_f32 v224, v40, v41
    v_cvt_pk_bf16_f32 v225, v42, v43
    v_cvt_pk_bf16_f32 v232, v44, v45
    v_cvt_pk_bf16_f32 v233, v46, v47
    v_cvt_pk_bf16_f32 v240, v48, v49
    v_cvt_pk_bf16_f32 v241, v50, v51
    v_cvt_pk_bf16_f32 v248, v52, v53
    v_cvt_pk_bf16_f32 v249, v54, v55
rare_d20:
    s_cmp_eq_u32 s77, 129024
    s_cbranch_scc0 rare_d21
    v_cvt_pk_bf16_f32 v226, v40, v41
    v_cvt_pk_bf16_f32 v227, v42, v43
    v_cvt_pk_bf16_f32 v234, v44, v45
    v_cvt_pk_bf16_f32 v235, v46, v47
    v_cvt_pk_bf16_f32 v242, v48, v49
    v_cvt_pk_bf16_f32 v243, v50, v51
    v_cvt_pk_bf16_f32 v250, v52, v53
    v_cvt_pk_bf16_f32 v251, v54, v55
rare_d21:
    s_cmp_eq_u32 s77, 135168
    s_cbranch_scc0 rare_d22
    v_cvt_pk_bf16_f32 v228, v40, v41
    v_cvt_pk_bf16_f32 v229, v42, v43
    v_cvt_pk_bf16_f32 v236, v44, v45
    v_cvt_pk_bf16_f32 v237, v46, v47
    v_cvt_pk_bf16_f32 v244, v48, v49
    v_cvt_pk_bf16_f32 v245, v50, v51
    v_cvt_pk_bf16_f32 v252, v52, v53
    v_cvt_pk_bf16_f32 v253, v54, v55
rare_d22:
    s_cmp_eq_u32 s77, 141312
    s_cbranch_scc0 rare_d23
    v_cvt_pk_bf16_f32 v230, v40, v41
    v_cvt_pk_bf16_f32 v231, v42, v43
    v_cvt_pk_bf16_f32 v238, v44, v45
    v_cvt_pk_bf16_f32 v239, v46, v47
    v_cvt_pk_bf16_f32 v246, v48, v49
    v_cvt_pk_bf16_f32 v247, v50, v51
    v_cvt_pk_bf16_f32 v254, v52, v53
    v_cvt_pk_bf16_f32 v255, v54, v55
rare_d23:
    s_cmp_eq_u32 s77, 147456
    s_cbranch_scc0 rare_d24
    v_cvt_pk_bf16_f32 v56, v40, v41
    v_cvt_pk_bf16_f32 v57, v42, v43
    v_cvt_pk_bf16_f32 v64, v44, v45
    v_cvt_pk_bf16_f32 v65, v46, v47
    v_cvt_pk_bf16_f32 v72, v48, v49
    v_cvt_pk_bf16_f32 v73, v50, v51
    v_cvt_pk_bf16_f32 v80, v52, v53
    v_cvt_pk_bf16_f32 v81, v54, v55
rare_d24:
    s_cmp_eq_u32 s77, 153600
    s_cbranch_scc0 rare_d25
    v_cvt_pk_bf16_f32 v58, v40, v41
    v_cvt_pk_bf16_f32 v59, v42, v43
    v_cvt_pk_bf16_f32 v66, v44, v45
    v_cvt_pk_bf16_f32 v67, v46, v47
    v_cvt_pk_bf16_f32 v74, v48, v49
    v_cvt_pk_bf16_f32 v75, v50, v51
    v_cvt_pk_bf16_f32 v82, v52, v53
    v_cvt_pk_bf16_f32 v83, v54, v55
rare_d25:
    s_cmp_eq_u32 s77, 159744
    s_cbranch_scc0 rare_d26
    v_cvt_pk_bf16_f32 v60, v40, v41
    v_cvt_pk_bf16_f32 v61, v42, v43
    v_cvt_pk_bf16_f32 v68, v44, v45
    v_cvt_pk_bf16_f32 v69, v46, v47
    v_cvt_pk_bf16_f32 v76, v48, v49
    v_cvt_pk_bf16_f32 v77, v50, v51
    v_cvt_pk_bf16_f32 v84, v52, v53
    v_cvt_pk_bf16_f32 v85, v54, v55
rare_d26:
    s_cmp_eq_u32 s77, 165888
    s_cbranch_scc0 rare_d27
    v_cvt_pk_bf16_f32 v62, v40, v41
    v_cvt_pk_bf16_f32 v63, v42, v43
    v_cvt_pk_bf16_f32 v70, v44, v45
    v_cvt_pk_bf16_f32 v71, v46, v47
    v_cvt_pk_bf16_f32 v78, v48, v49
    v_cvt_pk_bf16_f32 v79, v50, v51
    v_cvt_pk_bf16_f32 v86, v52, v53
    v_cvt_pk_bf16_f32 v87, v54, v55
rare_d27:
    s_cmp_eq_u32 s77, 172032
    s_cbranch_scc0 rare_d28
    v_cvt_pk_bf16_f32 v88, v40, v41
    v_cvt_pk_bf16_f32 v89, v42, v43
    v_cvt_pk_bf16_f32 v96, v44, v45
    v_cvt_pk_bf16_f32 v97, v46, v47
    v_cvt_pk_bf16_f32 v104, v48, v49
    v_cvt_pk_bf16_f32 v105, v50, v51
    v_cvt_pk_bf16_f32 v112, v52, v53
    v_cvt_pk_bf16_f32 v113, v54, v55
rare_d28:
    s_cmp_eq_u32 s77, 178176
    s_cbranch_scc0 rare_d29
    v_cvt_pk_bf16_f32 v90, v40, v41
    v_cvt_pk_bf16_f32 v91, v42, v43
    v_cvt_pk_bf16_f32 v98, v44, v45
    v_cvt_pk_bf16_f32 v99, v46, v47
    v_cvt_pk_bf16_f32 v106, v48, v49
    v_cvt_pk_bf16_f32 v107, v50, v51
    v_cvt_pk_bf16_f32 v114, v52, v53
    v_cvt_pk_bf16_f32 v115, v54, v55
rare_d29:
    s_cmp_eq_u32 s77, 184320
    s_cbranch_scc0 rare_d30
    v_cvt_pk_bf16_f32 v92, v40, v41
    v_cvt_pk_bf16_f32 v93, v42, v43
    v_cvt_pk_bf16_f32 v100, v44, v45
    v_cvt_pk_bf16_f32 v101, v46, v47
    v_cvt_pk_bf16_f32 v108, v48, v49
    v_cvt_pk_bf16_f32 v109, v50, v51
    v_cvt_pk_bf16_f32 v116, v52, v53
    v_cvt_pk_bf16_f32 v117, v54, v55
rare_d30:
    s_cmp_eq_u32 s77, 190464
    s_cbranch_scc0 rare_d31
    v_cvt_pk_bf16_f32 v94, v40, v41
    v_cvt_pk_bf16_f32 v95, v42, v43
    v_cvt_pk_bf16_f32 v102, v44, v45
    v_cvt_pk_bf16_f32 v103, v46, v47
    v_cvt_pk_bf16_f32 v110, v48, v49
    v_cvt_pk_bf16_f32 v111, v50, v51
    v_cvt_pk_bf16_f32 v118, v52, v53
    v_cvt_pk_bf16_f32 v119, v54, v55
rare_d31:
    s_add_u32 s77, s77, 6144
    s_cmp_lt_u32 s77, 196608
    s_cbranch_scc1 rare_loop
    ds_read_b64_tr_b16 a[216:217], v8 offset:0
    ds_read_b64_tr_b16 a[218:219], v8 offset:2048
    ds_read_b64_tr_b16 a[220:221], v9 offset:0
    ds_read_b64_tr_b16 a[222:223], v9 offset:2048
    s_waitcnt lgkmcnt(0)
    v_mfma_f32_16x16x32_bf16 a[152:155], a[216:219], a[96:99], 0
    v_mfma_f32_16x16x32_bf16 a[156:159], a[216:219], a[104:107], 0
    v_mfma_f32_16x16x32_bf16 a[160:163], a[216:219], a[112:115], 0
    v_mfma_f32_16x16x32_bf16 a[164:167], a[216:219], a[120:123], 0
    v_mfma_f32_16x16x32_bf16 a[168:171], a[220:223], a[96:99], 0
    v_mfma_f32_16x16x32_bf16 a[172:175], a[220:223], a[104:107], 0
    v_mfma_f32_16x16x32_bf16 a[176:179], a[220:223], a[112:115], 0
    v_mfma_f32_16x16x32_bf16 a[180:183], a[220:223], a[120:123], 0
    ds_read_b64_tr_b16 a[216:217], v8 offset:4096
    ds_read_b64_tr_b16 a[218:219], v8 offset:6144
    ds_read_b64_tr_b16 a[220:221], v9 offset:4096
    ds_read_b64_tr_b16 a[222:223], v9 offset:6144
    s_waitcnt lgkmcnt(0)
    v_mfma_f32_16x16x32_bf16 a[152:155], a[216:219], a[100:103], a[152:155]
    v_mfma_f32_16x16x32_bf16 a[156:159], a[216:219], a[108:111], a[156:159]
    v_mfma_f32_16x16x32_bf16 a[160:163], a[216:219], a[116:119], a[160:163]
    v_mfma_f32_16x16x32_bf16 a[164:167], a[216:219], a[124:127], a[164:167]
    v_mfma_f32_16x16x32_bf16 a[168:171], a[220:223], a[100:103], a[168:171]
    v_mfma_f32_16x16x32_bf16 a[172:175], a[220:223], a[108:111], a[172:175]
    v_mfma_f32_16x16x32_bf16 a[176:179], a[220:223], a[116:119], a[176:179]
    v_mfma_f32_16x16x32_bf16 a[180:183], a[220:223], a[124:127], a[180:183]
    ds_read_b64_tr_b16 a[216:217], v8 offset:8192
    ds_read_b64_tr_b16 a[218:219], v8 offset:10240
    ds_read_b64_tr_b16 a[220:221], v9 offset:8192
    ds_read_b64_tr_b16 a[222:223], v9 offset:10240
    s_waitcnt lgkmcnt(0)
    v_mfma_f32_16x16x32_bf16 a[152:155], a[216:219], a[128:131], a[152:155]
    v_mfma_f32_16x16x32_bf16 a[156:159], a[216:219], a[136:139], a[156:159]
    v_mfma_f32_16x16x32_bf16 a[160:163], a[216:219], a[144:147], a[160:163]
    v_mfma_f32_16x16x32_bf16 a[164:167], a[216:219], v[120:123], a[164:167]
    v_mfma_f32_16x16x32_bf16 a[168:171], a[220:223], a[128:131], a[168:171]
    v_mfma_f32_16x16x32_bf16 a[172:175], a[220:223], a[136:139], a[172:175]
    v_mfma_f32_16x16x32_bf16 a[176:179], a[220:223], a[144:147], a[176:179]
    v_mfma_f32_16x16x32_bf16 a[180:183], a[220:223], v[120:123], a[180:183]
    ds_read_b64_tr_b16 a[216:217], v8 offset:12288
    ds_read_b64_tr_b16 a[218:219], v8 offset:14336
    ds_read_b64_tr_b16 a[220:221], v9 offset:12288
    ds_read_b64_tr_b16 a[222:223], v9 offset:14336
    s_waitcnt lgkmcnt(0)
    v_mfma_f32_16x16x32_bf16 a[152:155], a[216:219], a[132:135], a[152:155]
    v_mfma_f32_16x16x32_bf16 a[156:159], a[216:219], a[140:143], a[156:159]
    v_mfma_f32_16x16x32_bf16 a[160:163], a[216:219], a[148:151], a[160:163]
    v_mfma_f32_16x16x32_bf16 a[164:167], a[216:219], v[124:127], a[164:167]
    v_mfma_f32_16x16x32_bf16 a[168:171], a[220:223], a[132:135], a[168:171]
    v_mfma_f32_16x16x32_bf16 a[172:175], a[220:223], a[140:143], a[172:175]
    v_mfma_f32_16x16x32_bf16 a[176:179], a[220:223], a[148:151], a[176:179]
    v_mfma_f32_16x16x32_bf16 a[180:183], a[220:223], v[124:127], a[180:183]
    ds_read_b64_tr_b16 a[216:217], v8 offset:16384
    ds_read_b64_tr_b16 a[218:219], v8 offset:18432
    ds_read_b64_tr_b16 a[220:221], v9 offset:16384
    ds_read_b64_tr_b16 a[222:223], v9 offset:18432
    s_waitcnt lgkmcnt(0)
    v_mfma_f32_16x16x32_bf16 a[152:155], a[216:219], v[128:131], a[152:155]
    v_mfma_f32_16x16x32_bf16 a[156:159], a[216:219], v[136:139], a[156:159]
    v_mfma_f32_16x16x32_bf16 a[160:163], a[216:219], v[144:147], a[160:163]
    v_mfma_f32_16x16x32_bf16 a[164:167], a[216:219], v[152:155], a[164:167]
    v_mfma_f32_16x16x32_bf16 a[168:171], a[220:223], v[128:131], a[168:171]
    v_mfma_f32_16x16x32_bf16 a[172:175], a[220:223], v[136:139], a[172:175]
    v_mfma_f32_16x16x32_bf16 a[176:179], a[220:223], v[144:147], a[176:179]
    v_mfma_f32_16x16x32_bf16 a[180:183], a[220:223], v[152:155], a[180:183]
    ds_read_b64_tr_b16 a[216:217], v8 offset:20480
    ds_read_b64_tr_b16 a[218:219], v8 offset:22528
    ds_read_b64_tr_b16 a[220:221], v9 offset:20480
    ds_read_b64_tr_b16 a[222:223], v9 offset:22528
    s_waitcnt lgkmcnt(0)
    v_mfma_f32_16x16x32_bf16 a[152:155], a[216:219], v[132:135], a[152:155]
    v_mfma_f32_16x16x32_bf16 a[156:159], a[216:219], v[140:143], a[156:159]
    v_mfma_f32_16x16x32_bf16 a[160:163], a[216:219], v[148:151], a[160:163]
    v_mfma_f32_16x16x32_bf16 a[164:167], a[216:219], v[156:159], a[164:167]
    v_mfma_f32_16x16x32_bf16 a[168:171], a[220:223], v[132:135], a[168:171]
    v_mfma_f32_16x16x32_bf16 a[172:175], a[220:223], v[140:143], a[172:175]
    v_mfma_f32_16x16x32_bf16 a[176:179], a[220:223], v[148:151], a[176:179]
    v_mfma_f32_16x16x32_bf16 a[180:183], a[220:223], v[156:159], a[180:183]
    ds_read_b64_tr_b16 a[216:217], v8 offset:24576
    ds_read_b64_tr_b16 a[218:219], v8 offset:26624
    ds_read_b64_tr_b16 a[220:221], v9 offset:24576
    ds_read_b64_tr_b16 a[222:223], v9 offset:26624
    s_waitcnt lgkmcnt(0)
    v_mfma_f32_16x16x32_bf16 a[152:155], a[216:219], v[160:163], a[152:155]
    v_mfma_f32_16x16x32_bf16 a[156:159], a[216:219], v[168:171], a[156:159]
    v_mfma_f32_16x16x32_bf16 a[160:163], a[216:219], v[176:179], a[160:163]
    v_mfma_f32_16x16x32_bf16 a[164:167], a[216:219], v[184:187], a[164:167]
    v_mfma_f32_16x16x32_bf16 a[168:171], a[220:223], v[160:163], a[168:171]
    v_mfma_f32_16x16x32_bf16 a[172:175], a[220:223], v[168:171], a[172:175]
    v_mfma_f32_16x16x32_bf16 a[176:179], a[220:223], v[176:179], a[176:179]
    v_mfma_f32_16x16x32_bf16 a[180:183], a[220:223], v[184:187], a[180:183]
    ds_read_b64_tr_b16 a[216:217], v8 offset:28672
    ds_read_b64_tr_b16 a[218:219], v8 offset:30720
    ds_read_b64_tr_b16 a[220:221], v9 offset:28672
    ds_read_b64_tr_b16 a[222:223], v9 offset:30720
    s_waitcnt lgkmcnt(0)
    v_mfma_f32_16x16x32_bf16 a[152:155], a[216:219], v[164:167], a[152:155]
    v_mfma_f32_16x16x32_bf16 a[156:159], a[216:219], v[172:175], a[156:159]
    v_mfma_f32_16x16x32_bf16 a[160:163], a[216:219], v[180:183], a[160:163]
    v_mfma_f32_16x16x32_bf16 a[164:167], a[216:219], v[188:191], a[164:167]
    v_mfma_f32_16x16x32_bf16 a[168:171], a[220:223], v[164:167], a[168:171]
    v_mfma_f32_16x16x32_bf16 a[172:175], a[220:223], v[172:175], a[172:175]
    v_mfma_f32_16x16x32_bf16 a[176:179], a[220:223], v[180:183], a[176:179]
    v_mfma_f32_16x16x32_bf16 a[180:183], a[220:223], v[188:191], a[180:183]
    ds_read_b64_tr_b16 a[216:217], v8 offset:32768
    ds_read_b64_tr_b16 a[218:219], v8 offset:34816
    ds_read_b64_tr_b16 a[220:221], v9 offset:32768
    ds_read_b64_tr_b16 a[222:223], v9 offset:34816
    s_waitcnt lgkmcnt(0)
    v_mfma_f32_16x16x32_bf16 a[152:155], a[216:219], v[192:195], a[152:155]
    v_mfma_f32_16x16x32_bf16 a[156:159], a[216:219], v[200:203], a[156:159]
    v_mfma_f32_16x16x32_bf16 a[160:163], a[216:219], v[208:211], a[160:163]
    v_mfma_f32_16x16x32_bf16 a[164:167], a[216:219], v[216:219], a[164:167]
    v_mfma_f32_16x16x32_bf16 a[168:171], a[220:223], v[192:195], a[168:171]
    v_mfma_f32_16x16x32_bf16 a[172:175], a[220:223], v[200:203], a[172:175]
    v_mfma_f32_16x16x32_bf16 a[176:179], a[220:223], v[208:211], a[176:179]
    v_mfma_f32_16x16x32_bf16 a[180:183], a[220:223], v[216:219], a[180:183]
    ds_read_b64_tr_b16 a[216:217], v8 offset:36864
    ds_read_b64_tr_b16 a[218:219], v8 offset:38912
    ds_read_b64_tr_b16 a[220:221], v9 offset:36864
    ds_read_b64_tr_b16 a[222:223], v9 offset:38912
    s_waitcnt lgkmcnt(0)
    v_mfma_f32_16x16x32_bf16 a[152:155], a[216:219], v[196:199], a[152:155]
    v_mfma_f32_16x16x32_bf16 a[156:159], a[216:219], v[204:207], a[156:159]
    v_mfma_f32_16x16x32_bf16 a[160:163], a[216:219], v[212:215], a[160:163]
    v_mfma_f32_16x16x32_bf16 a[164:167], a[216:219], v[220:223], a[164:167]
    v_mfma_f32_16x16x32_bf16 a[168:171], a[220:223], v[196:199], a[168:171]
    v_mfma_f32_16x16x32_bf16 a[172:175], a[220:223], v[204:207], a[172:175]
    v_mfma_f32_16x16x32_bf16 a[176:179], a[220:223], v[212:215], a[176:179]
    v_mfma_f32_16x16x32_bf16 a[180:183], a[220:223], v[220:223], a[180:183]
    ds_read_b64_tr_b16 a[216:217], v8 offset:40960
    ds_read_b64_tr_b16 a[218:219], v8 offset:43008
    ds_read_b64_tr_b16 a[220:221], v9 offset:40960
    ds_read_b64_tr_b16 a[222:223], v9 offset:43008
    s_waitcnt lgkmcnt(0)
    v_mfma_f32_16x16x32_bf16 a[152:155], a[216:219], v[224:227], a[152:155]
    v_mfma_f32_16x16x32_bf16 a[156:159], a[216:219], v[232:235], a[156:159]
    v_mfma_f32_16x16x32_bf16 a[160:163], a[216:219], v[240:243], a[160:163]
    v_mfma_f32_16x16x32_bf16 a[164:167], a[216:219], v[248:251], a[164:167]
    v_mfma_f32_16x16x32_bf16 a[168:171], a[220:223], v[224:227], a[168:171]
    v_mfma_f32_16x16x32_bf16 a[172:175], a[220:223], v[232:235], a[172:175]
    v_mfma_f32_16x16x32_bf16 a[176:179], a[220:223], v[240:243], a[176:179]
    v_mfma_f32_16x16x32_bf16 a[180:183], a[220:223], v[248:251], a[180:183]
    ds_read_b64_tr_b16 a[216:217], v8 offset:45056
    ds_read_b64_tr_b16 a[218:219], v8 offset:47104
    ds_read_b64_tr_b16 a[220:221], v9 offset:45056
    ds_read_b64_tr_b16 a[222:223], v9 offset:47104
    s_waitcnt lgkmcnt(0)
    v_mfma_f32_16x16x32_bf16 a[152:155], a[216:219], v[228:231], a[152:155]
    v_mfma_f32_16x16x32_bf16 a[156:159], a[216:219], v[236:239], a[156:159]
    v_mfma_f32_16x16x32_bf16 a[160:163], a[216:219], v[244:247], a[160:163]
    v_mfma_f32_16x16x32_bf16 a[164:167], a[216:219], v[252:255], a[164:167]
    v_mfma_f32_16x16x32_bf16 a[168:171], a[220:223], v[228:231], a[168:171]
    v_mfma_f32_16x16x32_bf16 a[172:175], a[220:223], v[236:239], a[172:175]
    v_mfma_f32_16x16x32_bf16 a[176:179], a[220:223], v[244:247], a[176:179]
    v_mfma_f32_16x16x32_bf16 a[180:183], a[220:223], v[252:255], a[180:183]
    ds_read_b64_tr_b16 a[216:217], v8 offset:49152
    ds_read_b64_tr_b16 a[218:219], v8 offset:51200
    ds_read_b64_tr_b16 a[220:221], v9 offset:49152
    ds_read_b64_tr_b16 a[222:223], v9 offset:51200
    s_waitcnt lgkmcnt(0)
    v_mfma_f32_16x16x32_bf16 a[152:155], a[216:219], v[56:59], a[152:155]
    v_mfma_f32_16x16x32_bf16 a[156:159], a[216:219], v[64:67], a[156:159]
    v_mfma_f32_16x16x32_bf16 a[160:163], a[216:219], v[72:75], a[160:163]
    v_mfma_f32_16x16x32_bf16 a[164:167], a[216:219], v[80:83], a[164:167]
    v_mfma_f32_16x16x32_bf16 a[168:171], a[220:223], v[56:59], a[168:171]
    v_mfma_f32_16x16x32_bf16 a[172:175], a[220:223], v[64:67], a[172:175]
    v_mfma_f32_16x16x32_bf16 a[176:179], a[220:223], v[72:75], a[176:179]
    v_mfma_f32_16x16x32_bf16 a[180:183], a[220:223], v[80:83], a[180:183]
    ds_read_b64_tr_b16 a[216:217], v8 offset:53248
    ds_read_b64_tr_b16 a[218:219], v8 offset:55296
    ds_read_b64_tr_b16 a[220:221], v9 offset:53248
    ds_read_b64_tr_b16 a[222:223], v9 offset:55296
    s_waitcnt lgkmcnt(0)
    v_mfma_f32_16x16x32_bf16 a[152:155], a[216:219], v[60:63], a[152:155]
    v_mfma_f32_16x16x32_bf16 a[156:159], a[216:219], v[68:71], a[156:159]
    v_mfma_f32_16x16x32_bf16 a[160:163], a[216:219], v[76:79], a[160:163]
    v_mfma_f32_16x16x32_bf16 a[164:167], a[216:219], v[84:87], a[164:167]
    v_mfma_f32_16x16x32_bf16 a[168:171], a[220:223], v[60:63], a[168:171]
    v_mfma_f32_16x16x32_bf16 a[172:175], a[220:223], v[68:71], a[172:175]
    v_mfma_f32_16x16x32_bf16 a[176:179], a[220:223], v[76:79], a[176:179]
    v_mfma_f32_16x16x32_bf16 a[180:183], a[220:223], v[84:87], a[180:183]
    ds_read_b64_tr_b16 a[216:217], v8 offset:57344
    ds_read_b64_tr_b16 a[218:219], v8 offset:59392
    ds_read_b64_tr_b16 a[220:221], v9 offset:57344
    ds_read_b64_tr_b16 a[222:223], v9 offset:59392
    s_waitcnt lgkmcnt(0)
    v_mfma_f32_16x16x32_bf16 a[152:155], a[216:219], v[88:91], a[152:155]
    v_mfma_f32_16x16x32_bf16 a[156:159], a[216:219], v[96:99], a[156:159]
    v_mfma_f32_16x16x32_bf16 a[160:163], a[216:219], v[104:107], a[160:163]
    v_mfma_f32_16x16x32_bf16 a[164:167], a[216:219], v[112:115], a[164:167]
    v_mfma_f32_16x16x32_bf16 a[168:171], a[220:223], v[88:91], a[168:171]
    v_mfma_f32_16x16x32_bf16 a[172:175], a[220:223], v[96:99], a[172:175]
    v_mfma_f32_16x16x32_bf16 a[176:179], a[220:223], v[104:107], a[176:179]
    v_mfma_f32_16x16x32_bf16 a[180:183], a[220:223], v[112:115], a[180:183]
    ds_read_b64_tr_b16 a[216:217], v8 offset:61440
    ds_read_b64_tr_b16 a[218:219], v8 offset:63488
    ds_read_b64_tr_b16 a[220:221], v9 offset:61440
    ds_read_b64_tr_b16 a[222:223], v9 offset:63488
    s_waitcnt lgkmcnt(0)
    v_mfma_f32_16x16x32_bf16 a[152:155], a[216:219], v[92:95], a[152:155]
    v_mfma_f32_16x16x32_bf16 a[156:159], a[216:219], v[100:103], a[156:159]
    v_mfma_f32_16x16x32_bf16 a[160:163], a[216:219], v[108:111], a[160:163]
    v_mfma_f32_16x16x32_bf16 a[164:167], a[216:219], v[116:119], a[164:167]
    v_mfma_f32_16x16x32_bf16 a[168:171], a[220:223], v[92:95], a[168:171]
    v_mfma_f32_16x16x32_bf16 a[172:175], a[220:223], v[100:103], a[172:175]
    v_mfma_f32_16x16x32_bf16 a[176:179], a[220:223], v[108:111], a[176:179]
    v_mfma_f32_16x16x32_bf16 a[180:183], a[220:223], v[116:119], a[180:183]
    v_mov_b32 v24, 0
    v_mov_b32 v25, 0
    v_mov_b32 v26, 0
    v_mov_b32 v27, 0
    v_mov_b32 v28, 0
    v_mov_b32 v29, 0
    v_mov_b32 v30, 0
    v_mov_b32 v31, 0
    v_mov_b32 v32, 0
    v_mov_b32 v33, 0
    v_mov_b32 v34, 0
    v_mov_b32 v35, 0
    v_mov_b32 v36, 0
    v_mov_b32 v37, 0
    v_mov_b32 v38, 0
    v_mov_b32 v39, 0
    s_nop 1
    v_smfmac_f32_16x16x64_bf16 v[24:27], a[248:251], a[96:103], v20
    v_smfmac_f32_16x16x64_bf16 v[28:31], a[248:251], a[104:111], v20
    v_smfmac_f32_16x16x64_bf16 v[32:35], a[248:251], a[112:119], v20
    v_smfmac_f32_16x16x64_bf16 v[36:39], a[248:251], a[120:127], v20
    v_smfmac_f32_16x16x64_bf16 v[24:27], a[248:251], a[128:135], v20
    v_smfmac_f32_16x16x64_bf16 v[28:31], a[248:251], a[136:143], v20
    v_smfmac_f32_16x16x64_bf16 v[32:35], a[248:251], a[144:151], v20
    v_smfmac_f32_16x16x64_bf16 v[36:39], a[248:251], v[120:127], v20
    v_smfmac_f32_16x16x64_bf16 v[24:27], a[248:251], v[128:135], v20
    v_smfmac_f32_16x16x64_bf16 v[28:31], a[248:251], v[136:143], v20
    v_smfmac_f32_16x16x64_bf16 v[32:35], a[248:251], v[144:151], v20
    v_smfmac_f32_16x16x64_bf16 v[36:39], a[248:251], v[152:159], v20
    v_smfmac_f32_16x16x64_bf16 v[24:27], a[248:251], v[160:167], v20
    v_smfmac_f32_16x16x64_bf16 v[28:31], a[248:251], v[168:175], v20
    v_smfmac_f32_16x16x64_bf16 v[32:35], a[248:251], v[176:183], v20
    v_smfmac_f32_16x16x64_bf16 v[36:39], a[248:251], v[184:191], v20
    v_smfmac_f32_16x16x64_bf16 v[24:27], a[248:251], v[192:199], v20
    v_smfmac_f32_16x16x64_bf16 v[28:31], a[248:251], v[200:207], v20
    v_smfmac_f32_16x16x64_bf16 v[32:35], a[248:251], v[208:215], v20
    v_smfmac_f32_16x16x64_bf16 v[36:39], a[248:251], v[216:223], v20
    v_smfmac_f32_16x16x64_bf16 v[24:27], a[248:251], v[224:231], v20
    v_smfmac_f32_16x16x64_bf16 v[28:31], a[248:251], v[232:239], v20
    v_smfmac_f32_16x16x64_bf16 v[32:35], a[248:251], v[240:247], v20
    v_smfmac_f32_16x16x64_bf16 v[36:39], a[248:251], v[248:255], v20
    v_smfmac_f32_16x16x64_bf16 v[24:27], a[248:251], v[56:63], v20
    v_smfmac_f32_16x16x64_bf16 v[28:31], a[248:251], v[64:71], v20
    v_smfmac_f32_16x16x64_bf16 v[32:35], a[248:251], v[72:79], v20
    v_smfmac_f32_16x16x64_bf16 v[36:39], a[248:251], v[80:87], v20
    v_smfmac_f32_16x16x64_bf16 v[24:27], a[248:251], v[88:95], v20
    v_smfmac_f32_16x16x64_bf16 v[28:31], a[248:251], v[96:103], v20
    v_smfmac_f32_16x16x64_bf16 v[32:35], a[248:251], v[104:111], v20
    v_smfmac_f32_16x16x64_bf16 v[36:39], a[248:251], v[112:119], v20
    s_nop 15
    v_add_f32 v24, v24, v25
    v_add_f32 v28, v28, v29
    v_add_f32 v32, v32, v33
    v_add_f32 v36, v36, v37
    v_rcp_f32 v16, v24
    v_rcp_f32 v17, v28
    v_rcp_f32 v18, v32
    v_rcp_f32 v19, v36
    s_nop 1
    s_branch rare_ret
code_end:
    s_endpgm
.section .rodata,"a"
.p2align 6
.amdhsa_kernel recurrent_scan__sliding_block_cached__moe_arch_mod__prompt_kernel
  .amdhsa_next_free_vgpr 512
  .amdhsa_next_free_sgpr 102
  .amdhsa_accum_offset 256
  .amdhsa_group_segment_fixed_size 0
  .amdhsa_kernarg_size 104
  .amdhsa_user_sgpr_count 2
  .amdhsa_user_sgpr_kernarg_segment_ptr 1
  .amdhsa_system_sgpr_workgroup_id_x 1
  .amdhsa_float_denorm_mode_32 3
.end_amdhsa_kernel
```

```asm
; @launch grid=(256,1,1) block=(256,1,1) lds=163840
.amdgcn_target "amdgcn-amd-amdhsa--gfx950"
.text
.globl recurrent_scan__sliding_block_cached__moe_arch_mod__prompt_kernel
.p2align 12
.p2align 8
.type recurrent_scan__sliding_block_cached__moe_arch_mod__prompt_kernel,@function
recurrent_scan__sliding_block_cached__moe_arch_mod__prompt_kernel:
    s_cmp_ge_u32 s2, 256
    s_cbranch_scc1 main_end
    s_load_dwordx16 s[64:79], s[0:1], 0
    s_load_dwordx4 s[80:83], s[0:1], 64
    s_load_dwordx2 s[84:85], s[0:1], 80
    s_load_dwordx2 s[86:87], s[0:1], 96
    s_lshr_b32 s56, s2, 3
    s_lshl_b32 s56, s56, 10
    v_lshrrev_b32 v18, 5, v0
    v_lshlrev_b32 v18, 7, v18
    v_add_u32 v18, s56, v18
    s_getpc_b64 s[88:89]
code0:
    v_and_b32 v19, 3, v0
    v_lshl_add_u32 v19, v19, 15, v18
    v_min_u32 v19, code_end-code0-4, v19
    global_load_dword a252, v19, s[88:89]
    v_lshrrev_b32 v17, 6, v0
    v_lshlrev_b32 v17, 12, v17
    v_and_b32 v1, 63, v0
    v_lshl_add_u32 v17, v1, 4, v17
    v_lshrrev_b32 v29, 6, v0
    v_mov_b32 v16, v0
    v_readfirstlane_b32 s3, v29
    s_and_b32 s53, s2, 7
    s_lshr_b32 s52, s2, 5
    s_bfe_u32 s51, s2, 0x20003
    s_lshl_b32 s50, s53, 2
    s_add_u32 s50, s50, s51
    s_lshl_b32 s60, s2, 3
    s_lshl2_add_u32 s60, s3, s60
    v_bfe_u32 v240, v1, 1, 2
    v_add_u32 v240, s60, v240
    v_lshrrev_b32 v241, 3, v1
    v_lshlrev_b32 v241, 5, v241
    v_and_b32 v29, 1, v1
    v_lshl_add_u32 v241, v29, 4, v241
    v_mul_u32_u24 v242, 1280, v240
    v_add_u32 v242, v242, v241
    s_cmp_lt_u32 s3, 2
    s_cselect_b32 s44, 0, 0x70000000
    v_lshrrev_b32 v29, 4, v1
    v_lshlrev_b32 v29, 1, v29
    v_and_b32 v7, 7, v1
    v_xor_b32 v7, v7, v29
    v_lshlrev_b32 v7, 4, v7
    v_lshrrev_b32 v29, 5, v1
    v_lshlrev_b32 v29, 3, v29
    v_bfe_u32 v5, v1, 3, 2
    v_add_u32 v5, v5, v29
    v_mul_u32_u24 v2, 12288, v5
    v_add_u32 v2, v2, v7
    v_add_u32 v3, 196608, v2
    s_lshl_b32 s54, s52, 2
    s_add_u32 s54, s54, s3
    s_mul_i32 s49, s3, 6144
    s_lshr_b32 s59, s3, 1
    s_lshl_b32 s59, s59, 5
    s_and_b32 s56, s3, 1
    s_lshl_b32 s56, s56, 2
    s_add_u32 s59, s59, s56
    s_mul_i32 s36, s59, 12288
    s_mov_b32 s37, 786432
    s_add_u32 s45, s51, s52
    s_and_b32 s45, s45, 3
    s_lshl_b32 s45, s45, 2
    s_lshr_b32 s45, 0x5050, s45
    s_and_b32 s45, s45, 15
    s_mul_i32 s56, s45, 786432
    s_add_u32 s36, s36, s56
    s_lshl_b32 s45, s45, 13
    s_andn2_b32 s56, 2, s2
    s_lshl_b32 s56, s56, 9
    s_add_u32 s45, s45, s56
    s_mul_i32 s56, s50, 384
    s_sub_u32 s57, 7864320, s56
    s_waitcnt lgkmcnt(0)
    s_mov_b32 s12, s64
    s_and_b32 s13, s65, 0xffff
    s_mov_b32 s14, 2621440
    s_mov_b32 s15, 0x00020000
    s_mov_b32 s16, s76
    s_and_b32 s17, s77, 0xffff
    s_mov_b32 s18, 1280
    s_mov_b32 s19, 0x00020000
    s_cmp_lt_u32 s3, 2
    s_cbranch_scc0 no_lx
    buffer_load_dwordx4 v[64:67], v242, s[12:15], 0 offen offset:0
    buffer_load_dwordx4 v[68:71], v242, s[12:15], 0 offen offset:256
    buffer_load_dwordx4 v[72:75], v242, s[12:15], 0 offen offset:512
    buffer_load_dwordx4 v[76:79], v242, s[12:15], 0 offen offset:768
    buffer_load_dwordx4 v[80:83], v242, s[12:15], 0 offen offset:1024
    buffer_load_dwordx4 v[84:87], v241, s[16:19], 0 offen offset:0
    buffer_load_dwordx4 v[88:91], v241, s[16:19], 0 offen offset:256
    buffer_load_dwordx4 v[92:95], v241, s[16:19], 0 offen offset:512
    buffer_load_dwordx4 v[96:99], v241, s[16:19], 0 offen offset:768
    buffer_load_dwordx4 v[100:103], v241, s[16:19], 0 offen offset:1024
no_lx:
    v_mov_b32 v25, 3203072
    global_load_dword v26, v25, s[86:87] sc1
    s_lshr_b32 s47, s2, 3
    s_lshl_b32 s47, s47, 7
    s_add_u32 s47, s47, 4128768
    s_load_dword s93, s[86:87], s47 glc
    s_add_u32 s8, s70, s56
    s_addc_u32 s9, s71, 0
    s_and_b32 s9, s9, 0xffff
    s_mov_b32 s10, s57
    s_mov_b32 s11, 0x00020000
    s_cmp_lt_u32 s3, 2
    s_cbranch_scc1 no_w0
    s_sub_u32 s47, s36, 393216
    s_add_u32 m0, s49, 36864
    s_nop 0
    buffer_load_dwordx4 v2, s[8:11], s47 offen offset:0 lds
    s_add_u32 m0, s49, 37760
    s_nop 0
    buffer_load_dwordx4 v2, s[8:11], s47 offen offset:128 lds
    s_add_u32 m0, s49, 38656
    s_nop 0
    buffer_load_dwordx4 v2, s[8:11], s47 offen offset:256 lds
    s_add_u32 m0, s49, 39936
    s_nop 0
    buffer_load_dwordx4 v3, s[8:11], s47 offen offset:0 lds
    s_add_u32 m0, s49, 40832
    s_nop 0
    buffer_load_dwordx4 v3, s[8:11], s47 offen offset:128 lds
    s_add_u32 m0, s49, 41728
    s_nop 0
    buffer_load_dwordx4 v3, s[8:11], s47 offen offset:256 lds
    s_add_u32 m0, s49, 49152
    s_nop 0
    buffer_load_dwordx4 v2, s[8:11], s36 offen offset:0 lds
    s_add_u32 m0, s49, 50048
    s_nop 0
    buffer_load_dwordx4 v2, s[8:11], s36 offen offset:128 lds
    s_add_u32 m0, s49, 50944
    s_nop 0
    buffer_load_dwordx4 v2, s[8:11], s36 offen offset:256 lds
    s_add_u32 m0, s49, 52224
    s_nop 0
    buffer_load_dwordx4 v3, s[8:11], s36 offen offset:0 lds
    s_add_u32 m0, s49, 53120
    s_nop 0
    buffer_load_dwordx4 v3, s[8:11], s36 offen offset:128 lds
    s_add_u32 m0, s49, 54016
    s_nop 0
    buffer_load_dwordx4 v3, s[8:11], s36 offen offset:256 lds
    s_add_u32 s36, s36, s37
    s_sub_u32 s55, s36, 7864320
    s_min_u32 s36, s36, s55
no_w0:
    s_mov_b32 s24, s86
    s_and_b32 s25, s87, 0xffff
    s_mov_b32 s26, 268435456
    s_mov_b32 s27, 0x00020000
    s_lshr_b32 s56, s60, 6
    s_mul_i32 s41, s56, 81920
    s_and_b32 s56, s60, 63
    s_lshl_b32 s56, s56, 6
    s_add_u32 s41, s41, s56
    v_lshrrev_b32 v29, 4, v1
    v_and_b32 v243, 15, v1
    v_lshlrev_b32 v243, 4, v243
    v_lshl_add_u32 v243, v29, 12, v243
    s_mov_b32 s38, 0x3acccccd
    s_mov_b32 s42, 0xffff0000
    s_mov_b32 s43, 0x3f803f80
    v_bfe_u32 v29, v1, 2, 3
    v_lshlrev_b32 v8, 7, v29
    v_lshrrev_b32 v29, 1, v29
    v_xor_b32 v29, 0, v29
    v_lshl_add_u32 v8, v29, 5, v8
    v_and_b32 v29, 3, v1
    v_lshl_add_u32 v8, v29, 3, v8
    v_lshrrev_b32 v29, 5, v1
    v_mul_u32_u24 v29, 3072, v29
    v_add_u32 v8, v8, v29
    v_add_u32 v8, 49152, v8
    v_xor_b32 v9, 32, v8
    v_xor_b32 v10, 64, v8
    v_xor_b32 v11, 96, v8
    v_and_b32 v15, 12, v1
    v_lshlrev_b32 v15, 6, v15
    v_and_b32 v29, 3, v1
    v_lshl_add_u32 v15, v29, 5, v15
    v_and_b32 v29, 16, v1
    v_add_u32 v15, v15, v29
    v_and_b32 v29, 32, v1
    v_lshl_add_u32 v15, v29, 2, v15
    s_and_b32 s56, s2, 1
    s_lshl_b32 s56, s56, 11
    v_add_u32 v15, s56, v15
    v_xor_b32 v14, 2048, v15
    s_mul_i32 s56, s54, 81920
    s_add_u32 s56, s56, 0
    s_add_u32 s20, s86, s56
    s_addc_u32 s21, s87, 0
    s_and_b32 s21, s21, 0xffff
    s_mov_b32 s22, 81920
    s_mov_b32 s23, 0x00020000
    s_lshl_b32 s46, s54, 7
    s_add_u32 s46, s46, 4128768
    s_mov_b32 s101, 0
    s_lshl_b32 s56, s53, 12
    s_add_u32 s46, s46, s56
    s_load_dword s92, s[86:87], s46 glc
    s_lshr_b32 s6, s2, 3
    s_lshl_b32 s6, s6, 7
    s_lshl_b32 s56, s53, 2
    s_add_u32 s6, s6, s56
    s_add_u32 s6, s6, 4128768
    s_cmp_eq_u32 s3, 0
    s_cselect_b32 s6, s6, 0x70000000
    v_lshlrev_b32 v20, 12, v1
    v_mov_b32 v144, 0
    v_mov_b32 v145, 0
    v_mov_b32 v146, 0
    v_mov_b32 v147, 0
    s_cmp_lt_u32 s3, 2
    s_cbranch_scc0 no_ln
    s_waitcnt vmcnt(6)
    v_dot2c_f32_bf16 v144, s43, v64
    v_dot2c_f32_bf16 v146, v64, v64
    v_dot2c_f32_bf16 v145, s43, v65
    v_dot2c_f32_bf16 v147, v65, v65
    v_dot2c_f32_bf16 v144, s43, v66
    v_dot2c_f32_bf16 v146, v66, v66
    v_dot2c_f32_bf16 v145, s43, v67
    v_dot2c_f32_bf16 v147, v67, v67
    v_dot2c_f32_bf16 v144, s43, v68
    v_dot2c_f32_bf16 v146, v68, v68
    v_dot2c_f32_bf16 v145, s43, v69
    v_dot2c_f32_bf16 v147, v69, v69
    v_dot2c_f32_bf16 v144, s43, v70
    v_dot2c_f32_bf16 v146, v70, v70
    v_dot2c_f32_bf16 v145, s43, v71
    v_dot2c_f32_bf16 v147, v71, v71
    v_dot2c_f32_bf16 v144, s43, v72
    v_dot2c_f32_bf16 v146, v72, v72
    v_dot2c_f32_bf16 v145, s43, v73
    v_dot2c_f32_bf16 v147, v73, v73
    v_dot2c_f32_bf16 v144, s43, v74
    v_dot2c_f32_bf16 v146, v74, v74
    v_dot2c_f32_bf16 v145, s43, v75
    v_dot2c_f32_bf16 v147, v75, v75
    v_dot2c_f32_bf16 v144, s43, v76
    v_dot2c_f32_bf16 v146, v76, v76
    v_dot2c_f32_bf16 v145, s43, v77
    v_dot2c_f32_bf16 v147, v77, v77
    v_dot2c_f32_bf16 v144, s43, v78
    v_dot2c_f32_bf16 v146, v78, v78
    v_dot2c_f32_bf16 v145, s43, v79
    v_dot2c_f32_bf16 v147, v79, v79
    v_dot2c_f32_bf16 v144, s43, v80
    v_dot2c_f32_bf16 v146, v80, v80
    v_dot2c_f32_bf16 v145, s43, v81
    v_dot2c_f32_bf16 v147, v81, v81
    v_dot2c_f32_bf16 v144, s43, v82
    v_dot2c_f32_bf16 v146, v82, v82
    v_dot2c_f32_bf16 v145, s43, v83
    v_dot2c_f32_bf16 v147, v83, v83
    v_lshlrev_b32 v104, 16, v64
    v_and_b32 v105, s42, v64
    v_lshlrev_b32 v106, 16, v65
    v_add_f32 v144, v144, v145
    v_add_f32 v146, v146, v147
    v_and_b32 v107, s42, v65
    v_add_f32_dpp v144, v144, v144 quad_perm:[1,0,3,2] row_mask:0xf bank_mask:0xf
    v_add_f32_dpp v146, v146, v146 quad_perm:[1,0,3,2] row_mask:0xf bank_mask:0xf
    v_lshlrev_b32 v108, 16, v66
    v_add_f32_dpp v144, v144, v144 row_ror:8 row_mask:0xf bank_mask:0xf
    v_add_f32_dpp v146, v146, v146 row_ror:8 row_mask:0xf bank_mask:0xf
    v_mov_b32 v148, v144
    v_mov_b32 v149, v146
    v_and_b32 v109, s42, v66
    v_permlane16_swap_b32 v144, v148
    v_permlane16_swap_b32 v146, v149
    v_lshlrev_b32 v110, 16, v67
    v_add_f32 v144, v144, v148
    v_add_f32 v146, v146, v149
    v_mov_b32 v148, v144
    v_mov_b32 v149, v146
    v_and_b32 v111, s42, v67
    v_permlane32_swap_b32 v144, v148
    v_permlane32_swap_b32 v146, v149
    v_lshlrev_b32 v112, 16, v68
    v_add_f32 v144, v144, v148
    v_add_f32 v146, v146, v149
    v_mul_f32 v150, s38, v144
    v_mul_f32 v146, s38, v146
    v_fma_f32 v154, -v150, v150, v146
    v_mul_f32 v146, 0x3d800000, v146
    v_cmp_nge_f32 vcc, v154, v146
    s_cbranch_vccnz ln_exact
ln_back:
    v_cvt_pk_bf16_f32 v154, 0, v154
    v_cvt_pk_bf16_f32 v150, 0, v150
    v_add_f32 v154, 0x3727c5ac, v154
    v_cvt_pk_bf16_f32 v154, 0, v154
    v_sqrt_f32 v154, v154
    v_and_b32 v113, s42, v68
    v_cvt_pk_bf16_f32 v154, 0, v154
    v_rcp_f32 v151, v154
    v_lshlrev_b32 v114, 16, v69
    v_mul_f32 v144, 0x3dd53b95, v151
    v_mul_f32 v146, -v150, v144
    v_pk_fma_f32 v[156:157], v[104:105], v[144:145], v[146:147] op_sel_hi:[1,0,0]
    v_cvt_pk_bf16_f32 v160, v156, v157
    v_pk_fma_f32 v[158:159], v[106:107], v[144:145], v[146:147] op_sel_hi:[1,0,0]
    v_cvt_pk_bf16_f32 v161, v158, v159
    v_pk_fma_f32 v[156:157], v[108:109], v[144:145], v[146:147] op_sel_hi:[1,0,0]
    v_cvt_pk_bf16_f32 v162, v156, v157
    v_pk_fma_f32 v[158:159], v[110:111], v[144:145], v[146:147] op_sel_hi:[1,0,0]
    v_cvt_pk_bf16_f32 v163, v158, v159
    buffer_store_dwordx4 v[160:163], v243, s[24:27], s41 offen sc1
    s_addk_i32 s41, 16384
    v_pk_fma_f32 v[156:157], v[112:113], v[144:145], v[146:147] op_sel_hi:[1,0,0]
    v_cvt_pk_bf16_f32 v164, v156, v157
    v_and_b32 v115, s42, v69
    v_pk_fma_f32 v[158:159], v[114:115], v[144:145], v[146:147] op_sel_hi:[1,0,0]
    v_cvt_pk_bf16_f32 v165, v158, v159
    v_lshlrev_b32 v116, 16, v70
    v_and_b32 v117, s42, v70
    v_pk_fma_f32 v[156:157], v[116:117], v[144:145], v[146:147] op_sel_hi:[1,0,0]
    v_cvt_pk_bf16_f32 v166, v156, v157
    v_lshlrev_b32 v118, 16, v71
    v_and_b32 v119, s42, v71
    v_pk_fma_f32 v[158:159], v[118:119], v[144:145], v[146:147] op_sel_hi:[1,0,0]
    v_cvt_pk_bf16_f32 v167, v158, v159
    buffer_store_dwordx4 v[164:167], v243, s[24:27], s41 offen sc1
    s_addk_i32 s41, 16384
    v_lshlrev_b32 v120, 16, v72
    v_and_b32 v121, s42, v72
    v_pk_fma_f32 v[156:157], v[120:121], v[144:145], v[146:147] op_sel_hi:[1,0,0]
    v_cvt_pk_bf16_f32 v168, v156, v157
    v_lshlrev_b32 v122, 16, v73
    v_and_b32 v123, s42, v73
    v_pk_fma_f32 v[158:159], v[122:123], v[144:145], v[146:147] op_sel_hi:[1,0,0]
    v_cvt_pk_bf16_f32 v169, v158, v159
    v_lshlrev_b32 v124, 16, v74
    v_and_b32 v125, s42, v74
    v_pk_fma_f32 v[156:157], v[124:125], v[144:145], v[146:147] op_sel_hi:[1,0,0]
    v_cvt_pk_bf16_f32 v170, v156, v157
    v_lshlrev_b32 v126, 16, v75
    v_and_b32 v127, s42, v75
    v_pk_fma_f32 v[158:159], v[126:127], v[144:145], v[146:147] op_sel_hi:[1,0,0]
    v_cvt_pk_bf16_f32 v171, v158, v159
    buffer_store_dwordx4 v[168:171], v243, s[24:27], s41 offen sc1
    s_addk_i32 s41, 16384
    v_lshlrev_b32 v128, 16, v76
    v_and_b32 v129, s42, v76
    v_pk_fma_f32 v[156:157], v[128:129], v[144:145], v[146:147] op_sel_hi:[1,0,0]
    v_cvt_pk_bf16_f32 v172, v156, v157
    v_lshlrev_b32 v130, 16, v77
    v_and_b32 v131, s42, v77
    v_pk_fma_f32 v[158:159], v[130:131], v[144:145], v[146:147] op_sel_hi:[1,0,0]
    v_cvt_pk_bf16_f32 v173, v158, v159
    v_lshlrev_b32 v132, 16, v78
    v_and_b32 v133, s42, v78
    v_pk_fma_f32 v[156:157], v[132:133], v[144:145], v[146:147] op_sel_hi:[1,0,0]
    v_cvt_pk_bf16_f32 v174, v156, v157
    v_lshlrev_b32 v134, 16, v79
    v_and_b32 v135, s42, v79
    v_pk_fma_f32 v[158:159], v[134:135], v[144:145], v[146:147] op_sel_hi:[1,0,0]
    v_cvt_pk_bf16_f32 v175, v158, v159
    buffer_store_dwordx4 v[172:175], v243, s[24:27], s41 offen sc1
    s_addk_i32 s41, 16384
    v_lshlrev_b32 v136, 16, v80
    v_and_b32 v137, s42, v80
    v_pk_fma_f32 v[156:157], v[136:137], v[144:145], v[146:147] op_sel_hi:[1,0,0]
    v_cvt_pk_bf16_f32 v176, v156, v157
    v_lshlrev_b32 v138, 16, v81
    v_and_b32 v139, s42, v81
    v_pk_fma_f32 v[158:159], v[138:139], v[144:145], v[146:147] op_sel_hi:[1,0,0]
    v_cvt_pk_bf16_f32 v177, v158, v159
    v_lshlrev_b32 v140, 16, v82
    v_and_b32 v141, s42, v82
    v_pk_fma_f32 v[156:157], v[140:141], v[144:145], v[146:147] op_sel_hi:[1,0,0]
    v_cvt_pk_bf16_f32 v178, v156, v157
    v_lshlrev_b32 v142, 16, v83
    v_and_b32 v143, s42, v83
    v_pk_fma_f32 v[158:159], v[142:143], v[144:145], v[146:147] op_sel_hi:[1,0,0]
    v_cvt_pk_bf16_f32 v179, v158, v159
    buffer_store_dwordx4 v[176:179], v243, s[24:27], s41 offen sc1
    s_waitcnt vmcnt(5)
    v_readfirstlane_b32 s7, v26
    s_lshr_b32 s7, s7, 4
    s_mul_i32 s7, s7, 0x2c9277b5
    s_add_u32 s7, s7, 0x6c564b05
    s_lshl_b32 s7, s7, 4
    s_add_u32 s36, s36, s37
    s_sub_u32 s55, s36, 7864320
    s_min_u32 s36, s36, s55
    s_add_u32 s36, s36, s37
    s_sub_u32 s55, s36, 7864320
    s_min_u32 s36, s36, s55
    s_waitcnt vmcnt(0)
ln_join:
    s_waitcnt lgkmcnt(0)
    s_barrier
    v_mov_b32 v21, s7
    s_mov_b64 exec, 0xff
    buffer_store_dword v21, v20, s[24:27], s6 offen sc1
    s_mov_b64 exec, 0x55
    v_lshlrev_b32 v29, 3, v240
    s_add_u32 s56, s44, 3211264
    buffer_store_dwordx2 v[150:151], v29, s[24:27], s56 offen sc1
    s_mov_b64 exec, -1
    s_add_u32 m0, s49, 98304
    s_nop 0
    buffer_load_dwordx4 v2, s[8:11], s36 offen offset:0 lds
    s_add_u32 m0, s49, 99200
    s_nop 0
    buffer_load_dwordx4 v2, s[8:11], s36 offen offset:128 lds
    s_add_u32 m0, s49, 100096
    s_nop 0
    buffer_load_dwordx4 v2, s[8:11], s36 offen offset:256 lds
    s_add_u32 m0, s49, 101376
    s_nop 0
    buffer_load_dwordx4 v3, s[8:11], s36 offen offset:0 lds
    s_add_u32 m0, s49, 102272
    s_nop 0
    buffer_load_dwordx4 v3, s[8:11], s36 offen offset:128 lds
    s_add_u32 m0, s49, 103168
    s_nop 0
    buffer_load_dwordx4 v3, s[8:11], s36 offen offset:256 lds
    s_add_u32 s36, s36, s37
    s_sub_u32 s55, s36, 7864320
    s_min_u32 s36, s36, s55
    v_mov_b32 v144, 0
    v_mov_b32 v145, 0
    s_waitcnt vmcnt(14)
    v_pk_add_f32 v[104:105], v[104:105], v[150:151] op_sel_hi:[1,0] neg_lo:[0,1] neg_hi:[0,1]
    v_cvt_pk_bf16_f32 v104, 0, v104
    v_cvt_pk_bf16_f32 v105, 0, v105
    v_pk_mul_f32 v[104:105], v[104:105], v[150:151] op_sel:[0,1]
    v_cvt_pk_bf16_f32 v104, v104, v105
    v_dot2c_f32_bf16 v144, v104, v84
    v_pk_add_f32 v[106:107], v[106:107], v[150:151] op_sel_hi:[1,0] neg_lo:[0,1] neg_hi:[0,1]
    v_cvt_pk_bf16_f32 v106, 0, v106
    v_cvt_pk_bf16_f32 v107, 0, v107
    v_pk_mul_f32 v[106:107], v[106:107], v[150:151] op_sel:[0,1]
    v_cvt_pk_bf16_f32 v106, v106, v107
    v_dot2c_f32_bf16 v145, v106, v85
    v_pk_add_f32 v[108:109], v[108:109], v[150:151] op_sel_hi:[1,0] neg_lo:[0,1] neg_hi:[0,1]
    v_cvt_pk_bf16_f32 v108, 0, v108
    v_cvt_pk_bf16_f32 v109, 0, v109
    v_pk_mul_f32 v[108:109], v[108:109], v[150:151] op_sel:[0,1]
    v_cvt_pk_bf16_f32 v108, v108, v109
    v_dot2c_f32_bf16 v144, v108, v86
    v_pk_add_f32 v[110:111], v[110:111], v[150:151] op_sel_hi:[1,0] neg_lo:[0,1] neg_hi:[0,1]
    v_cvt_pk_bf16_f32 v110, 0, v110
    v_cvt_pk_bf16_f32 v111, 0, v111
    v_pk_mul_f32 v[110:111], v[110:111], v[150:151] op_sel:[0,1]
    v_cvt_pk_bf16_f32 v110, v110, v111
    v_dot2c_f32_bf16 v145, v110, v87
    v_pk_add_f32 v[112:113], v[112:113], v[150:151] op_sel_hi:[1,0] neg_lo:[0,1] neg_hi:[0,1]
    v_cvt_pk_bf16_f32 v112, 0, v112
    v_cvt_pk_bf16_f32 v113, 0, v113
    v_pk_mul_f32 v[112:113], v[112:113], v[150:151] op_sel:[0,1]
    v_cvt_pk_bf16_f32 v112, v112, v113
    v_dot2c_f32_bf16 v144, v112, v88
    v_pk_add_f32 v[114:115], v[114:115], v[150:151] op_sel_hi:[1,0] neg_lo:[0,1] neg_hi:[0,1]
    v_cvt_pk_bf16_f32 v114, 0, v114
    v_cvt_pk_bf16_f32 v115, 0, v115
    v_pk_mul_f32 v[114:115], v[114:115], v[150:151] op_sel:[0,1]
    v_cvt_pk_bf16_f32 v114, v114, v115
    v_dot2c_f32_bf16 v145, v114, v89
    v_pk_add_f32 v[116:117], v[116:117], v[150:151] op_sel_hi:[1,0] neg_lo:[0,1] neg_hi:[0,1]
    v_cvt_pk_bf16_f32 v116, 0, v116
    v_cvt_pk_bf16_f32 v117, 0, v117
    v_pk_mul_f32 v[116:117], v[116:117], v[150:151] op_sel:[0,1]
    v_cvt_pk_bf16_f32 v116, v116, v117
    v_dot2c_f32_bf16 v144, v116, v90
    v_pk_add_f32 v[118:119], v[118:119], v[150:151] op_sel_hi:[1,0] neg_lo:[0,1] neg_hi:[0,1]
    v_cvt_pk_bf16_f32 v118, 0, v118
    v_cvt_pk_bf16_f32 v119, 0, v119
    v_pk_mul_f32 v[118:119], v[118:119], v[150:151] op_sel:[0,1]
    v_cvt_pk_bf16_f32 v118, v118, v119
    v_dot2c_f32_bf16 v145, v118, v91
    v_pk_add_f32 v[120:121], v[120:121], v[150:151] op_sel_hi:[1,0] neg_lo:[0,1] neg_hi:[0,1]
    v_cvt_pk_bf16_f32 v120, 0, v120
    v_cvt_pk_bf16_f32 v121, 0, v121
    v_pk_mul_f32 v[120:121], v[120:121], v[150:151] op_sel:[0,1]
    v_cvt_pk_bf16_f32 v120, v120, v121
    v_dot2c_f32_bf16 v144, v120, v92
    v_pk_add_f32 v[122:123], v[122:123], v[150:151] op_sel_hi:[1,0] neg_lo:[0,1] neg_hi:[0,1]
    v_cvt_pk_bf16_f32 v122, 0, v122
    v_cvt_pk_bf16_f32 v123, 0, v123
    v_pk_mul_f32 v[122:123], v[122:123], v[150:151] op_sel:[0,1]
    v_cvt_pk_bf16_f32 v122, v122, v123
    v_dot2c_f32_bf16 v145, v122, v93
    v_pk_add_f32 v[124:125], v[124:125], v[150:151] op_sel_hi:[1,0] neg_lo:[0,1] neg_hi:[0,1]
    v_cvt_pk_bf16_f32 v124, 0, v124
    v_cvt_pk_bf16_f32 v125, 0, v125
    v_pk_mul_f32 v[124:125], v[124:125], v[150:151] op_sel:[0,1]
    v_cvt_pk_bf16_f32 v124, v124, v125
    v_dot2c_f32_bf16 v144, v124, v94
    v_pk_add_f32 v[126:127], v[126:127], v[150:151] op_sel_hi:[1,0] neg_lo:[0,1] neg_hi:[0,1]
    v_cvt_pk_bf16_f32 v126, 0, v126
    v_cvt_pk_bf16_f32 v127, 0, v127
    v_pk_mul_f32 v[126:127], v[126:127], v[150:151] op_sel:[0,1]
    v_cvt_pk_bf16_f32 v126, v126, v127
    v_dot2c_f32_bf16 v145, v126, v95
    s_branch page0
no_ln:
    s_mov_b64 exec, 0
    s_cmp_eq_u32 s3, 2
    s_cbranch_scc1 pg_0
    s_branch pg_1
pg_back:
    s_mov_b64 exec, -1
    s_sub_u32 s47, s36, 393216
    s_add_u32 m0, s49, 61440
    s_nop 0
    buffer_load_dwordx4 v2, s[8:11], s47 offen offset:0 lds
    s_add_u32 m0, s49, 62336
    s_nop 0
    buffer_load_dwordx4 v2, s[8:11], s47 offen offset:128 lds
    s_add_u32 m0, s49, 63232
    s_nop 0
    buffer_load_dwordx4 v2, s[8:11], s47 offen offset:256 lds
    s_add_u32 m0, s49, 64512
    s_nop 0
    buffer_load_dwordx4 v3, s[8:11], s47 offen offset:0 lds
    s_add_u32 m0, s49, 65408
    s_nop 0
    buffer_load_dwordx4 v3, s[8:11], s47 offen offset:128 lds
    s_add_u32 m0, s49, 66304
    s_nop 0
    buffer_load_dwordx4 v3, s[8:11], s47 offen offset:256 lds
    s_add_u32 m0, s49, 73728
    s_nop 0
    buffer_load_dwordx4 v2, s[8:11], s36 offen offset:0 lds
    s_add_u32 m0, s49, 74624
    s_nop 0
    buffer_load_dwordx4 v2, s[8:11], s36 offen offset:128 lds
    s_add_u32 m0, s49, 75520
    s_nop 0
    buffer_load_dwordx4 v2, s[8:11], s36 offen offset:256 lds
    s_add_u32 m0, s49, 76800
    s_nop 0
    buffer_load_dwordx4 v3, s[8:11], s36 offen offset:0 lds
    s_add_u32 m0, s49, 77696
    s_nop 0
    buffer_load_dwordx4 v3, s[8:11], s36 offen offset:128 lds
    s_add_u32 m0, s49, 78592
    s_nop 0
    buffer_load_dwordx4 v3, s[8:11], s36 offen offset:256 lds
    s_add_u32 s36, s36, s37
    s_sub_u32 s55, s36, 7864320
    s_min_u32 s36, s36, s55
    s_waitcnt vmcnt(24)
    v_readfirstlane_b32 s7, v26
    s_lshr_b32 s7, s7, 4
    s_mul_i32 s7, s7, 0x2c9277b5
    s_add_u32 s7, s7, 0x6c564b05
    s_lshl_b32 s7, s7, 4
    s_branch ln_join
    .p2align 12
    .fill 32, 4, 0xbf810000
page0:
pg_0:
    s_cbranch_execz pg_2
    v_pk_add_f32 v[128:129], v[128:129], v[150:151] op_sel_hi:[1,0] neg_lo:[0,1] neg_hi:[0,1]
    v_cvt_pk_bf16_f32 v128, 0, v128
    v_cvt_pk_bf16_f32 v129, 0, v129
    v_pk_mul_f32 v[128:129], v[128:129], v[150:151] op_sel:[0,1]
    v_cvt_pk_bf16_f32 v128, v128, v129
    v_dot2c_f32_bf16 v144, v128, v96
    v_pk_add_f32 v[130:131], v[130:131], v[150:151] op_sel_hi:[1,0] neg_lo:[0,1] neg_hi:[0,1]
    v_cvt_pk_bf16_f32 v130, 0, v130
    v_cvt_pk_bf16_f32 v131, 0, v131
    v_pk_mul_f32 v[130:131], v[130:131], v[150:151] op_sel:[0,1]
    v_cvt_pk_bf16_f32 v130, v130, v131
    v_dot2c_f32_bf16 v145, v130, v97
    v_pk_add_f32 v[132:133], v[132:133], v[150:151] op_sel_hi:[1,0] neg_lo:[0,1] neg_hi:[0,1]
    v_cvt_pk_bf16_f32 v132, 0, v132
    v_cvt_pk_bf16_f32 v133, 0, v133
    v_pk_mul_f32 v[132:133], v[132:133], v[150:151] op_sel:[0,1]
    v_cvt_pk_bf16_f32 v132, v132, v133
    v_dot2c_f32_bf16 v144, v132, v98
    v_pk_add_f32 v[134:135], v[134:135], v[150:151] op_sel_hi:[1,0] neg_lo:[0,1] neg_hi:[0,1]
    v_cvt_pk_bf16_f32 v134, 0, v134
    v_cvt_pk_bf16_f32 v135, 0, v135
    v_pk_mul_f32 v[134:135], v[134:135], v[150:151] op_sel:[0,1]
    v_cvt_pk_bf16_f32 v134, v134, v135
    v_dot2c_f32_bf16 v145, v134, v99
spin_ln:
    s_load_dwordx8 s[28:35], s[86:87], s46 glc
    s_add_u32 s101, s101, 1
    s_cmp_gt_u32 s101, 0x2000000
    s_cselect_b32 s57, 0, -1
    s_waitcnt lgkmcnt(0)
    s_xor_b32 s56, s28, s7
    s_xor_b32 s29, s29, s7
    s_or_b32 s56, s56, s29
    s_xor_b32 s30, s30, s7
    s_or_b32 s56, s56, s30
    s_xor_b32 s31, s31, s7
    s_or_b32 s56, s56, s31
    s_xor_b32 s32, s32, s7
    s_or_b32 s56, s56, s32
    s_xor_b32 s33, s33, s7
    s_or_b32 s56, s56, s33
    s_xor_b32 s34, s34, s7
    s_or_b32 s56, s56, s34
    s_xor_b32 s35, s35, s7
    s_or_b32 s56, s56, s35
    s_and_b32 s56, s56, s57
    s_cbranch_scc1 spin_ln
    s_add_u32 s46, s45, 0
    s_sub_u32 s77, s46, 81920
    s_min_u32 s46, s46, s77
    s_xor_b32 s77, s46, 1024
    buffer_load_dwordx4 a[160:163], v14, s[20:23], s46 offen sc1
    buffer_load_dwordx4 a[164:167], v14, s[20:23], s77 offen sc1
    buffer_load_dwordx4 a[168:171], v15, s[20:23], s46 offen sc1
    buffer_load_dwordx4 a[172:175], v15, s[20:23], s77 offen sc1
    s_add_u32 s46, s45, 4096
    s_sub_u32 s77, s46, 81920
    s_min_u32 s46, s46, s77
    s_xor_b32 s77, s46, 1024
    buffer_load_dwordx4 a[176:179], v14, s[20:23], s46 offen sc1
    buffer_load_dwordx4 a[180:183], v14, s[20:23], s77 offen sc1
    buffer_load_dwordx4 a[184:187], v15, s[20:23], s46 offen sc1
    buffer_load_dwordx4 a[188:191], v15, s[20:23], s77 offen sc1
    v_pk_add_f32 v[136:137], v[136:137], v[150:151] op_sel_hi:[1,0] neg_lo:[0,1] neg_hi:[0,1]
    v_cvt_pk_bf16_f32 v136, 0, v136
    v_cvt_pk_bf16_f32 v137, 0, v137
    v_pk_mul_f32 v[136:137], v[136:137], v[150:151] op_sel:[0,1]
    v_cvt_pk_bf16_f32 v136, v136, v137
    v_dot2c_f32_bf16 v144, v136, v100
    v_pk_add_f32 v[138:139], v[138:139], v[150:151] op_sel_hi:[1,0] neg_lo:[0,1] neg_hi:[0,1]
    v_cvt_pk_bf16_f32 v138, 0, v138
    v_cvt_pk_bf16_f32 v139, 0, v139
    v_pk_mul_f32 v[138:139], v[138:139], v[150:151] op_sel:[0,1]
    v_cvt_pk_bf16_f32 v138, v138, v139
    v_dot2c_f32_bf16 v145, v138, v101
    v_pk_add_f32 v[140:141], v[140:141], v[150:151] op_sel_hi:[1,0] neg_lo:[0,1] neg_hi:[0,1]
    v_cvt_pk_bf16_f32 v140, 0, v140
    v_cvt_pk_bf16_f32 v141, 0, v141
    v_pk_mul_f32 v[140:141], v[140:141], v[150:151] op_sel:[0,1]
    v_cvt_pk_bf16_f32 v140, v140, v141
    v_dot2c_f32_bf16 v144, v140, v102
    v_pk_add_f32 v[142:143], v[142:143], v[150:151] op_sel_hi:[1,0] neg_lo:[0,1] neg_hi:[0,1]
    v_cvt_pk_bf16_f32 v142, 0, v142
    v_cvt_pk_bf16_f32 v143, 0, v143
    v_pk_mul_f32 v[142:143], v[142:143], v[150:151] op_sel:[0,1]
    v_cvt_pk_bf16_f32 v142, v142, v143
    v_dot2c_f32_bf16 v145, v142, v103
    s_nop 2
    v_add_f32 v144, v144, v145
    s_nop 0
    s_nop 0
    v_add_f32_dpp v144, v144, v144 quad_perm:[1,0,3,2] row_mask:0xf bank_mask:0xf
    s_nop 0
    s_nop 0
    v_add_f32_dpp v144, v144, v144 row_ror:8 row_mask:0xf bank_mask:0xf
    v_mov_b32 v148, v144
    s_nop 0
    s_nop 0
    v_permlane16_swap_b32 v144, v148
    s_nop 0
    s_nop 0
    v_add_f32 v144, v144, v148
    v_mov_b32 v148, v144
    s_nop 0
    s_nop 0
    v_permlane32_swap_b32 v144, v148
    s_nop 0
    s_nop 0
    v_add_f32 v144, v144, v148
    v_cvt_pk_bf16_f32 v144, 0, v144
    v_ashrrev_i32 v146, 31, v144
    v_or_b32 v146, 0x80000000, v146
    v_xor_b32 v144, v144, v146
    v_and_b32 v144, s42, v144
    v_sub_u32 v146, 2047, v240
    v_or_b32 v144, v144, v146
    s_cmp_lt_u32 s3, 2
    s_cselect_b32 s56, -1, 0
    v_and_b32 v144, s56, v144
    v_mov_b32 v34, s7
    v_mov_b32 v35, s7
    v_max_u32_dpp v32, v144, v144 quad_perm:[2,3,0,1] row_mask:0xf bank_mask:0xf
    v_min_u32_dpp v33, v144, v144 quad_perm:[2,3,0,1] row_mask:0xf bank_mask:0xf
    s_nop 0
    v_min_u32_dpp v146, v32, v32 row_ror:4 row_mask:0xf bank_mask:0xf
    v_max_u32_dpp v33, v33, v33 row_ror:4 row_mask:0xf bank_mask:0xf
    v_max_u32_dpp v32, v32, v32 row_ror:4 row_mask:0xf bank_mask:0xf
    v_max_u32 v33, v33, v146
    s_waitcnt vmcnt(8)
head_code:
    s_waitcnt vmcnt(21)
    s_barrier
    ds_read_b64_tr_b16 a[224:225], v8 offset:0
    ds_read_b64_tr_b16 a[226:227], v8 offset:6144
    ds_read_b64_tr_b16 a[228:229], v9 offset:0
    ds_read_b64_tr_b16 a[230:231], v9 offset:6144
    ds_read_b64_tr_b16 a[232:233], v10 offset:0
    ds_read_b64_tr_b16 a[234:235], v10 offset:6144
    ds_read_b64_tr_b16 a[236:237], v11 offset:0
    ds_read_b64_tr_b16 a[238:239], v11 offset:6144
    ds_read_b64_tr_b16 a[240:241], v8 offset:1024
    ds_read_b64_tr_b16 a[242:243], v8 offset:7168
    ds_read_b64_tr_b16 a[244:245], v9 offset:1024
    ds_read_b64_tr_b16 a[246:247], v9 offset:7168
    s_waitcnt vmcnt(7) lgkmcnt(10)
    v_mfma_f32_16x16x32_bf16 v[64:67], a[224:227], a[160:163], 0
    s_waitcnt vmcnt(6) lgkmcnt(8)
    v_min_u32 v36, 1, v1
    v_lshlrev_b32 v36, 30, v36
    v_mfma_f32_16x16x32_bf16 v[68:71], a[228:231], a[160:163], 0
    s_waitcnt vmcnt(5)
    v_and_b32 v37, 31, v1
    v_lshlrev_b32 v37, 2, v37
    v_mfma_f32_16x16x32_bf16 v[76:79], a[228:231], a[164:167], 0
    s_add_u32 s46, s45, 8192
    v_mov_b32 v38, 0
    s_sub_u32 s77, s46, 81920
    v_mfma_f32_16x16x32_bf16 v[72:75], a[224:227], a[164:167], 0
    s_waitcnt vmcnt(4)
    s_min_u32 s46, s46, s77
    s_xor_b32 s77, s46, 1024
    v_mfma_f32_16x16x32_bf16 v[80:83], a[224:227], a[168:171], 0
    buffer_load_dwordx4 a[96:99], v14, s[20:23], s46 offen sc1
    v_mfma_f32_16x16x32_bf16 v[84:87], a[228:231], a[168:171], 0
    s_lshl2_add_u32 s6, s2, s3
    s_lshl_b32 s6, s6, 4
    s_add_u32 s6, s6, 3162112
    v_mfma_f32_16x16x32_bf16 v[92:95], a[228:231], a[172:175], 0
    s_waitcnt lgkmcnt(0)
    ds_read_b64_tr_b16 a[228:229], v11 offset:1024
    s_lshl2_add_u32 s93, s2, s3
    v_mfma_f32_16x16x32_bf16 v[88:91], a[224:227], a[172:175], 0
    s_lshl_b32 s93, s93, 7
    ds_read_b64_tr_b16 a[230:231], v11 offset:7168
    s_add_u32 s93, s93, 4194304
    v_mfma_f32_16x16x32_bf16 v[120:123], a[232:235], a[172:175], 0
    buffer_store_dword v38, v37, s[24:27], s93 offen sc1
    v_mfma_f32_16x16x32_bf16 v[124:127], a[236:239], a[172:175], 0
    buffer_load_dwordx4 a[100:103], v14, s[20:23], s77 offen sc1
    v_mfma_f32_16x16x32_bf16 v[116:119], a[236:239], a[168:171], 0
    s_mul_i32 s56, s50, 786432
    ds_read_b64_tr_b16 a[224:225], v10 offset:1024
    v_mul_u32_u24 v56, 3072, v5
    v_mfma_f32_16x16x32_bf16 v[112:115], a[232:235], a[168:171], 0
    s_add_u32 s56, s56, 589824
    ds_read_b64_tr_b16 a[226:227], v10 offset:7168
    v_add_u32 v56, v56, v7
    v_mfma_f32_16x16x32_bf16 v[104:107], a[232:235], a[164:167], 0
    s_add_u32 s12, s66, s56
    s_addc_u32 s13, s67, 0
    v_add_u32 v57, 49152, v56
    v_mfma_f32_16x16x32_bf16 v[108:111], a[236:239], a[164:167], 0
    s_and_b32 s13, s13, 0xffff
    v_lshrrev_b32 v29, 3, v1
    v_mul_u32_u24 v31, 384, v29
    v_mfma_f32_16x16x32_bf16 v[100:103], a[236:239], a[160:163], 0
    buffer_load_dwordx4 a[104:107], v15, s[20:23], s46 offen sc1
    v_mfma_f32_16x16x32_bf16 v[96:99], a[232:235], a[160:163], 0
    s_mov_b32 s14, 196608
    ds_read_b64_tr_b16 a[236:237], v9 offset:2048
    v_add_u32 v6, v31, v7
    v_mfma_f32_16x16x32_bf16 v[128:131], a[240:243], a[160:163], 0
    s_mov_b32 s15, 0x00020000
    ds_read_b64_tr_b16 a[238:239], v9 offset:8192
    v_bfe_u32 v29, v1, 4, 1
    v_mfma_f32_16x16x32_bf16 v[132:135], a[244:247], a[160:163], 0
    s_add_u32 s16, s68, s56
    s_addc_u32 s17, s69, 0
    v_bfe_u32 v30, v1, 5, 1
    v_mfma_f32_16x16x32_bf16 v[140:143], a[244:247], a[164:167], 0
    s_and_b32 s17, s17, 0xffff
    ds_read_b64_tr_b16 a[232:233], v8 offset:2048
    v_lshl_add_u32 v29, v29, 1, v30
    v_mfma_f32_16x16x32_bf16 v[136:139], a[240:243], a[164:167], 0
    s_mov_b32 s18, 196608
    ds_read_b64_tr_b16 a[234:235], v8 offset:8192
    v_and_b32 v30, 7, v1
    v_mfma_f32_16x16x32_bf16 v[144:147], a[240:243], a[168:171], 0
    buffer_load_dwordx4 a[108:111], v15, s[20:23], s77 offen sc1
    v_mfma_f32_16x16x32_bf16 v[148:151], a[244:247], a[168:171], 0
    s_waitcnt lgkmcnt(4)
    v_xor_b32 v30, v30, v29
    v_lshl_add_u32 v4, v30, 4, v31
    v_mfma_f32_16x16x32_bf16 v[156:159], a[244:247], a[172:175], 0
    s_add_u32 s46, s45, 12288
    ds_read_b64_tr_b16 a[244:245], v11 offset:2048
    v_xor_b32 v30, 4, v30
    v_mfma_f32_16x16x32_bf16 v[152:155], a[240:243], a[172:175], 0
    s_sub_u32 s77, s46, 81920
    ds_read_b64_tr_b16 a[246:247], v11 offset:8192
    v_lshl_add_u32 v5, v30, 4, v31
    v_mfma_f32_16x16x32_bf16 v[184:187], a[224:227], a[172:175], 0
    s_min_u32 s46, s46, s77
    ds_read_b64_tr_b16 a[240:241], v10 offset:2048
    v_add_u32 v5, 3072, v5
    v_mfma_f32_16x16x32_bf16 v[188:191], a[228:231], a[172:175], 0
    s_xor_b32 s77, s46, 1024
    ds_read_b64_tr_b16 a[242:243], v10 offset:8192
    v_bfe_u32 v30, v1, 1, 1
    v_mfma_f32_16x16x32_bf16 v[180:183], a[228:231], a[168:171], 0
    buffer_load_dwordx4 a[112:115], v14, s[20:23], s46 offen sc1
    v_mfma_f32_16x16x32_bf16 v[176:179], a[224:227], a[168:171], 0
    s_mov_b32 s19, 0x00020000
    v_bfe_u32 v31, v1, 2, 1
    v_lshl_add_u32 v30, v30, 1, v31
    v_mfma_f32_16x16x32_bf16 v[168:171], a[224:227], a[164:167], 0
    s_mov_b32 s28, s78
    v_bfe_u32 v31, v1, 3, 1
    v_lshl_add_u32 v30, v31, 2, v30
    v_mfma_f32_16x16x32_bf16 v[172:175], a[228:231], a[164:167], 0
    s_waitcnt lgkmcnt(3)
    v_xor_b32 v30, v30, v29
    v_lshlrev_b32 v30, 4, v30
    v_mfma_f32_16x16x32_bf16 v[164:167], a[228:231], a[160:163], 0
    s_and_b32 s29, s79, 0xffff
    ds_read_b64_tr_b16 a[228:229], v9 offset:12288
    v_mul_u32_u24 v31, 3072, v31
    v_mfma_f32_16x16x32_bf16 v[160:163], a[224:227], a[160:163], 0
    s_mov_b32 s30, 1966080
    ds_read_b64_tr_b16 a[230:231], v9 offset:18432
    v_and_b32 v29, 7, v1
    v_mfma_f32_16x16x32_bf16 v[192:195], a[232:235], a[160:163], 0
    buffer_load_dwordx4 a[116:119], v14, s[20:23], s77 offen sc1
    v_mfma_f32_16x16x32_bf16 v[196:199], a[236:239], a[160:163], 0
    s_mov_b32 s31, 0x00020000
    ds_read_b64_tr_b16 a[224:225], v8 offset:12288
    v_lshl_add_u32 v31, v29, 7, v31
    v_mfma_f32_16x16x32_bf16 v[204:207], a[236:239], a[164:167], 0
    s_mov_b32 s32, s80
    ds_read_b64_tr_b16 a[226:227], v8 offset:18432
    v_add_u32 v12, v31, v30
    v_mfma_f32_16x16x32_bf16 v[200:203], a[232:235], a[164:167], 0
    s_and_b32 s33, s81, 0xffff
    v_xor_b32 v30, 64, v30
    v_add_u32 v13, v31, v30
    v_mfma_f32_16x16x32_bf16 v[208:211], a[232:235], a[168:171], 0
    s_mov_b32 s34, 1966080
    v_lshrrev_b32 v19, 5, v1
    v_lshlrev_b32 v19, 11, v19
    v_mfma_f32_16x16x32_bf16 v[212:215], a[236:239], a[168:171], 0
    s_waitcnt lgkmcnt(3)
    v_sub_u32 v19, 0xffffa000, v19
    s_mov_b32 s35, 0x00020000
    v_mfma_f32_16x16x32_bf16 v[220:223], a[236:239], a[172:175], 0
    buffer_load_dwordx4 a[120:123], v15, s[20:23], s46 offen sc1
    v_mfma_f32_16x16x32_bf16 v[216:219], a[232:235], a[172:175], 0
    s_min_u32 s58, s2, 239
    ds_read_b64_tr_b16 a[236:237], v11 offset:12288
    s_mul_hi_u32 s56, s58, 178956971
    v_mfma_f32_16x16x32_bf16 v[248:251], a[240:243], a[172:175], 0
    s_mul_i32 s57, s56, 24
    ds_read_b64_tr_b16 a[238:239], v11 offset:18432
    s_sub_u32 s57, s58, s57
    v_mfma_f32_16x16x32_bf16 v[252:255], a[244:247], a[172:175], 0
    s_lshl_b32 s60, s56, 6
    ds_read_b64_tr_b16 a[232:233], v10 offset:12288
    s_add_u32 s60, s60, s59
    v_mfma_f32_16x16x32_bf16 v[244:247], a[244:247], a[168:171], 0
    s_mul_i32 s60, s60, 3072
    ds_read_b64_tr_b16 a[234:235], v10 offset:18432
    s_lshl_b32 s44, s57, 7
    v_mfma_f32_16x16x32_bf16 v[240:243], a[240:243], a[168:171], 0
    s_add_u32 s60, s60, s44
    s_lshl_b32 s61, s56, 7
    s_mul_i32 s62, s56, 1536
    v_mfma_f32_16x16x32_bf16 v[232:235], a[240:243], a[164:167], 0
    buffer_load_dwordx4 a[124:127], v15, s[20:23], s77 offen sc1
    v_mfma_f32_16x16x32_bf16 v[236:239], a[244:247], a[164:167], 0
    s_waitcnt vmcnt(12) lgkmcnt(4)
    s_add_u32 m0, s49, 122880
    s_lshl_b32 s44, s57, 6
    v_mfma_f32_16x16x32_bf16 v[228:231], a[244:247], a[160:163], 0
    s_add_u32 s62, s62, s44
    ds_read_b64_tr_b16 a[244:245], v9 offset:13312
    s_lshl_b32 s44, s3, 4
    v_mfma_f32_16x16x32_bf16 v[224:227], a[240:243], a[160:163], 0
    s_waitcnt vmcnt(11)
    ds_read_b64_tr_b16 a[246:247], v9 offset:19456
    s_add_u32 s62, s62, s44
    v_mfma_f32_16x16x32_bf16 v[64:67], a[224:227], a[176:179], v[64:67]
    s_lshl_b32 s62, s62, 4
    ds_read_b64_tr_b16 a[240:241], v8 offset:13312
    s_add_u32 s62, s62, 3276800
    v_mfma_f32_16x16x32_bf16 v[68:71], a[228:231], a[176:179], v[68:71]
    s_waitcnt vmcnt(10)
    ds_read_b64_tr_b16 a[242:243], v8 offset:19456
    s_lshl_b32 s4, s2, 8
    v_mfma_f32_16x16x32_bf16 v[76:79], a[228:231], a[180:183], v[76:79]
    buffer_load_dwordx4 v2, s[8:11], s36 offen offset:0 lds
    v_mfma_f32_16x16x32_bf16 v[72:75], a[224:227], a[180:183], v[72:75]
    s_waitcnt vmcnt(10)
    s_addk_i32 m0, 896
    s_lshl_b32 s44, s3, 2
    v_mfma_f32_16x16x32_bf16 v[80:83], a[224:227], a[184:187], v[80:83]
    s_add_u32 s4, s4, s44
    s_add_u32 s4, s4, 3932160
    s_lshl_b32 s5, s52, 3
    v_mfma_f32_16x16x32_bf16 v[84:87], a[228:231], a[184:187], v[84:87]
    s_waitcnt lgkmcnt(3)
    s_add_u32 s5, s5, s53
    s_lshl_b32 s5, s5, 2
    v_mfma_f32_16x16x32_bf16 v[92:95], a[228:231], a[188:191], v[92:95]
    s_add_u32 s5, s5, s3
    ds_read_b64_tr_b16 a[228:229], v11 offset:13312
    s_lshl_b32 s5, s5, 7
    v_mfma_f32_16x16x32_bf16 v[88:91], a[224:227], a[188:191], v[88:91]
    s_add_u32 s5, s5, 4096000
    ds_read_b64_tr_b16 a[230:231], v11 offset:19456
    s_lshl_b32 s76, s51, 2
    v_mfma_f32_16x16x32_bf16 v[120:123], a[232:235], a[188:191], v[120:123]
    buffer_load_dwordx4 v2, s[8:11], s36 offen offset:128 lds
    v_mfma_f32_16x16x32_bf16 v[124:127], a[236:239], a[188:191], v[124:127]
    s_addk_i32 m0, 896
    ds_read_b64_tr_b16 a[224:225], v10 offset:13312
    s_add_u32 s76, s76, s5
    v_mfma_f32_16x16x32_bf16 v[116:119], a[236:239], a[184:187], v[116:119]
    s_mov_b32 s92, 0xbfb8aa3b
    ds_read_b64_tr_b16 a[226:227], v10 offset:19456
    s_lshl_b32 s44, s3, 12
    v_mfma_f32_16x16x32_bf16 v[112:115], a[232:235], a[184:187], v[112:115]
    s_mov_b32 s38, s49
    s_mul_i32 s40, s3, 3072
    s_mov_b32 s47, 3162112
    v_mfma_f32_16x16x32_bf16 v[104:107], a[232:235], a[180:183], v[104:107]
    s_lshl_b32 s63, s3, 10
    v_mfma_f32_16x16x32_bf16 v[108:111], a[236:239], a[180:183], v[108:111]
    s_waitcnt lgkmcnt(3)
    v_mfma_f32_16x16x32_bf16 v[100:103], a[236:239], a[176:179], v[100:103]
    buffer_load_dwordx4 v2, s[8:11], s36 offen offset:256 lds
    v_mfma_f32_16x16x32_bf16 v[96:99], a[232:235], a[176:179], v[96:99]
    s_addk_i32 m0, 1280
    ds_read_b64_tr_b16 a[236:237], v9 offset:14336
    v_mfma_f32_16x16x32_bf16 v[128:131], a[240:243], a[176:179], v[128:131]
    s_mov_b32 s80, 0xffffff01
    ds_read_b64_tr_b16 a[238:239], v9 offset:20480
    v_mfma_f32_16x16x32_bf16 v[132:135], a[244:247], a[176:179], v[132:135]
    ds_read_b64_tr_b16 a[232:233], v8 offset:14336
    v_mfma_f32_16x16x32_bf16 v[140:143], a[244:247], a[180:183], v[140:143]
    ds_read_b64_tr_b16 a[234:235], v8 offset:20480
    v_mfma_f32_16x16x32_bf16 v[136:139], a[240:243], a[180:183], v[136:139]
    v_mfma_f32_16x16x32_bf16 v[144:147], a[240:243], a[184:187], v[144:147]
    buffer_load_dwordx4 v3, s[8:11], s36 offen offset:0 lds
    v_mfma_f32_16x16x32_bf16 v[148:151], a[244:247], a[184:187], v[148:151]
    s_waitcnt lgkmcnt(4)
    s_addk_i32 m0, 896
    v_mfma_f32_16x16x32_bf16 v[156:159], a[244:247], a[188:191], v[156:159]
    ds_read_b64_tr_b16 a[244:245], v11 offset:14336
    ds_read_b64_tr_b16 a[246:247], v11 offset:20480
    v_mfma_f32_16x16x32_bf16 v[152:155], a[240:243], a[188:191], v[152:155]
    ds_read_b64_tr_b16 a[240:241], v10 offset:14336
    ds_read_b64_tr_b16 a[242:243], v10 offset:20480
    v_mfma_f32_16x16x32_bf16 v[184:187], a[224:227], a[188:191], v[184:187]
    v_mfma_f32_16x16x32_bf16 v[188:191], a[228:231], a[188:191], v[188:191]
    v_mfma_f32_16x16x32_bf16 v[180:183], a[228:231], a[184:187], v[180:183]
    buffer_load_dwordx4 v3, s[8:11], s36 offen offset:128 lds
    s_cmp_lg_u32 s3, 0
    s_cselect_b64 exec, -1, 0
    s_cbranch_execz pg_last
pg_back2:
    s_mov_b64 exec, -1
    v_mfma_f32_16x16x32_bf16 v[176:179], a[224:227], a[184:187], v[176:179]
    s_addk_i32 m0, 896
    v_mfma_f32_16x16x32_bf16 v[168:171], a[224:227], a[180:183], v[168:171]
    v_mfma_f32_16x16x32_bf16 v[172:175], a[228:231], a[180:183], v[172:175]
    s_waitcnt lgkmcnt(2)
    v_mfma_f32_16x16x32_bf16 v[164:167], a[228:231], a[176:179], v[164:167]
    s_waitcnt lgkmcnt(0)
    s_barrier
    v_mfma_f32_16x16x32_bf16 v[160:163], a[224:227], a[176:179], v[160:163]
    s_waitcnt vmcnt(12)
    ds_read_b64_tr_b16 a[224:225], v8 offset:24576
    v_mfma_f32_16x16x32_bf16 v[192:195], a[232:235], a[176:179], v[192:195]
    buffer_store_dwordx4 v[32:35], v36, s[24:27], s6 offen sc1
    v_mfma_f32_16x16x32_bf16 v[196:199], a[236:239], a[176:179], v[196:199]
    buffer_load_dwordx4 v3, s[8:11], s36 offen offset:256 lds
    v_mfma_f32_16x16x32_bf16 v[204:207], a[236:239], a[180:183], v[204:207]
    s_add_u32 s36, s36, s37
    ds_read_b64_tr_b16 a[226:227], v8 offset:30720
    s_sub_u32 s55, s36, 7864320
    v_mfma_f32_16x16x32_bf16 v[200:203], a[232:235], a[180:183], v[200:203]
    s_min_u32 s36, s36, s55
    ds_read_b64_tr_b16 a[228:229], v8 offset:36864
    s_add_u32 m0, s49, 0
    v_mfma_f32_16x16x32_bf16 v[208:211], a[232:235], a[184:187], v[208:211]
    ds_read_b64_tr_b16 a[230:231], v8 offset:43008
    v_mfma_f32_16x16x32_bf16 v[212:215], a[236:239], a[184:187], v[212:215]
    v_mfma_f32_16x16x32_bf16 v[220:223], a[236:239], a[188:191], v[220:223]
    buffer_load_dwordx4 v2, s[8:11], s36 offen offset:0 lds
    v_mfma_f32_16x16x32_bf16 v[216:219], a[232:235], a[188:191], v[216:219]
    s_addk_i32 m0, 896
    ds_read_b64_tr_b16 a[232:233], v9 offset:24576
    v_mfma_f32_16x16x32_bf16 v[248:251], a[240:243], a[188:191], v[248:251]
    ds_read_b64_tr_b16 a[234:235], v9 offset:30720
    v_mfma_f32_16x16x32_bf16 v[252:255], a[244:247], a[188:191], v[252:255]
    ds_read_b64_tr_b16 a[236:237], v9 offset:36864
    v_mfma_f32_16x16x32_bf16 v[244:247], a[244:247], a[184:187], v[244:247]
    ds_read_b64_tr_b16 a[238:239], v9 offset:43008
    v_mfma_f32_16x16x32_bf16 v[240:243], a[240:243], a[184:187], v[240:243]
    v_mfma_f32_16x16x32_bf16 v[232:235], a[240:243], a[180:183], v[232:235]
    buffer_load_dwordx4 v2, s[8:11], s36 offen offset:128 lds
    v_mfma_f32_16x16x32_bf16 v[236:239], a[244:247], a[180:183], v[236:239]
    s_waitcnt lgkmcnt(4)
    s_addk_i32 m0, 896
    v_mfma_f32_16x16x32_bf16 v[228:231], a[244:247], a[176:179], v[228:231]
    s_waitcnt vmcnt(12)
    v_mfma_f32_16x16x32_bf16 v[224:227], a[240:243], a[176:179], v[224:227]
    s_waitcnt vmcnt(11)
    ds_read_b64_tr_b16 a[240:241], v10 offset:24576
    v_mfma_f32_16x16x32_bf16 v[64:67], a[224:227], a[96:99], v[64:67]
    ds_read_b64_tr_b16 a[242:243], v10 offset:30720
    v_mfma_f32_16x16x32_bf16 v[64:67], a[228:231], a[112:115], v[64:67]
    ds_read_b64_tr_b16 a[244:245], v10 offset:36864
    v_mfma_f32_16x16x32_bf16 v[72:75], a[228:231], a[116:119], v[72:75]
    buffer_load_dwordx4 v2, s[8:11], s36 offen offset:256 lds
    v_mfma_f32_16x16x32_bf16 v[72:75], a[224:227], a[100:103], v[72:75]
    s_waitcnt vmcnt(10)
    ds_read_b64_tr_b16 a[246:247], v10 offset:43008
    s_addk_i32 m0, 1280
    v_mfma_f32_16x16x32_bf16 v[80:83], a[224:227], a[104:107], v[80:83]
    v_mfma_f32_16x16x32_bf16 v[80:83], a[228:231], a[120:123], v[80:83]
    s_waitcnt lgkmcnt(4)
    v_mfma_f32_16x16x32_bf16 v[88:91], a[228:231], a[124:127], v[88:91]
    v_mfma_f32_16x16x32_bf16 v[88:91], a[224:227], a[108:111], v[88:91]
    ds_read_b64_tr_b16 a[224:225], v11 offset:24576
    v_mfma_f32_16x16x32_bf16 v[92:95], a[232:235], a[108:111], v[92:95]
    buffer_load_dwordx4 v3, s[8:11], s36 offen offset:0 lds
    v_mfma_f32_16x16x32_bf16 v[92:95], a[236:239], a[124:127], v[92:95]
    s_addk_i32 m0, 896
    ds_read_b64_tr_b16 a[226:227], v11 offset:30720
    v_mfma_f32_16x16x32_bf16 v[84:87], a[236:239], a[120:123], v[84:87]
    ds_read_b64_tr_b16 a[228:229], v11 offset:36864
    v_mfma_f32_16x16x32_bf16 v[84:87], a[232:235], a[104:107], v[84:87]
    ds_read_b64_tr_b16 a[230:231], v11 offset:43008
    v_mfma_f32_16x16x32_bf16 v[76:79], a[232:235], a[100:103], v[76:79]
    v_mfma_f32_16x16x32_bf16 v[76:79], a[236:239], a[116:119], v[76:79]
    s_waitcnt lgkmcnt(4)
    v_mfma_f32_16x16x32_bf16 v[68:71], a[236:239], a[112:115], v[68:71]
    buffer_load_dwordx4 v3, s[8:11], s36 offen offset:128 lds
    v_mfma_f32_16x16x32_bf16 v[68:71], a[232:235], a[96:99], v[68:71]
    s_addk_i32 m0, 896
    ds_read_b64_tr_b16 a[232:233], v8 offset:25600
    v_mfma_f32_16x16x32_bf16 v[96:99], a[240:243], a[96:99], v[96:99]
    ds_read_b64_tr_b16 a[234:235], v8 offset:31744
    v_mfma_f32_16x16x32_bf16 v[96:99], a[244:247], a[112:115], v[96:99]
    ds_read_b64_tr_b16 a[236:237], v8 offset:37888
    v_mfma_f32_16x16x32_bf16 v[104:107], a[244:247], a[116:119], v[104:107]
    ds_read_b64_tr_b16 a[238:239], v8 offset:44032
    v_mfma_f32_16x16x32_bf16 v[104:107], a[240:243], a[100:103], v[104:107]
    v_mfma_f32_16x16x32_bf16 v[112:115], a[240:243], a[104:107], v[112:115]
    buffer_load_dwordx4 v3, s[8:11], s36 offen offset:256 lds
    v_mfma_f32_16x16x32_bf16 v[112:115], a[244:247], a[120:123], v[112:115]
    s_waitcnt lgkmcnt(4)
    s_add_u32 s36, s36, s37
    s_sub_u32 s55, s36, 7864320
    v_mfma_f32_16x16x32_bf16 v[120:123], a[244:247], a[124:127], v[120:123]
    s_min_u32 s36, s36, s55
    s_add_u32 s46, s45, 16384
    s_sub_u32 s77, s46, 81920
    v_mfma_f32_16x16x32_bf16 v[120:123], a[240:243], a[108:111], v[120:123]
    s_min_u32 s46, s46, s77
    ds_read_b64_tr_b16 a[240:241], v9 offset:25600
    s_xor_b32 s77, s46, 1024
    v_mfma_f32_16x16x32_bf16 v[124:127], a[224:227], a[108:111], v[124:127]
    ds_read_b64_tr_b16 a[242:243], v9 offset:31744
    v_mfma_f32_16x16x32_bf16 v[124:127], a[228:231], a[124:127], v[124:127]
    ds_read_b64_tr_b16 a[244:245], v9 offset:37888
    v_mfma_f32_16x16x32_bf16 v[116:119], a[228:231], a[120:123], v[116:119]
    buffer_load_dwordx4 a[128:131], v14, s[20:23], s46 offen sc1
    v_mfma_f32_16x16x32_bf16 v[116:119], a[224:227], a[104:107], v[116:119]
    ds_read_b64_tr_b16 a[246:247], v9 offset:44032
    v_mfma_f32_16x16x32_bf16 v[108:111], a[224:227], a[100:103], v[108:111]
    v_mfma_f32_16x16x32_bf16 v[108:111], a[228:231], a[116:119], v[108:111]
    s_waitcnt lgkmcnt(4)
    v_mfma_f32_16x16x32_bf16 v[100:103], a[228:231], a[112:115], v[100:103]
    v_mfma_f32_16x16x32_bf16 v[100:103], a[224:227], a[96:99], v[100:103]
    ds_read_b64_tr_b16 a[224:225], v10 offset:25600
    v_mfma_f32_16x16x32_bf16 v[128:131], a[232:235], a[96:99], v[128:131]
    buffer_load_dwordx4 a[132:135], v14, s[20:23], s77 offen sc1
    v_mfma_f32_16x16x32_bf16 v[128:131], a[236:239], a[112:115], v[128:131]
    ds_read_b64_tr_b16 a[226:227], v10 offset:31744
    v_mfma_f32_16x16x32_bf16 v[136:139], a[236:239], a[116:119], v[136:139]
    ds_read_b64_tr_b16 a[228:229], v10 offset:37888
    v_mfma_f32_16x16x32_bf16 v[136:139], a[232:235], a[100:103], v[136:139]
    ds_read_b64_tr_b16 a[230:231], v10 offset:44032
    v_mfma_f32_16x16x32_bf16 v[144:147], a[232:235], a[104:107], v[144:147]
    v_mfma_f32_16x16x32_bf16 v[144:147], a[236:239], a[120:123], v[144:147]
    s_waitcnt lgkmcnt(4)
    v_mfma_f32_16x16x32_bf16 v[152:155], a[236:239], a[124:127], v[152:155]
    buffer_load_dwordx4 a[136:139], v15, s[20:23], s46 offen sc1
    v_mfma_f32_16x16x32_bf16 v[152:155], a[232:235], a[108:111], v[152:155]
    ds_read_b64_tr_b16 a[232:233], v11 offset:25600
    v_mfma_f32_16x16x32_bf16 v[156:159], a[240:243], a[108:111], v[156:159]
    ds_read_b64_tr_b16 a[234:235], v11 offset:31744
    v_mfma_f32_16x16x32_bf16 v[156:159], a[244:247], a[124:127], v[156:159]
    ds_read_b64_tr_b16 a[236:237], v11 offset:37888
    v_mfma_f32_16x16x32_bf16 v[148:151], a[244:247], a[120:123], v[148:151]
    ds_read_b64_tr_b16 a[238:239], v11 offset:44032
    v_mfma_f32_16x16x32_bf16 v[148:151], a[240:243], a[104:107], v[148:151]
    v_mfma_f32_16x16x32_bf16 v[140:143], a[240:243], a[100:103], v[140:143]
    buffer_load_dwordx4 a[140:143], v15, s[20:23], s77 offen sc1
    v_mfma_f32_16x16x32_bf16 v[140:143], a[244:247], a[116:119], v[140:143]
    s_waitcnt lgkmcnt(4)
    s_add_u32 s46, s45, 20480
    s_sub_u32 s77, s46, 81920
    v_mfma_f32_16x16x32_bf16 v[132:135], a[244:247], a[112:115], v[132:135]
    s_min_u32 s46, s46, s77
    s_xor_b32 s77, s46, 1024
    v_mfma_f32_16x16x32_bf16 v[132:135], a[240:243], a[96:99], v[132:135]
    ds_read_b64_tr_b16 a[240:241], v8 offset:26624
    v_mfma_f32_16x16x32_bf16 v[160:163], a[224:227], a[96:99], v[160:163]
    ds_read_b64_tr_b16 a[242:243], v8 offset:32768
    v_mfma_f32_16x16x32_bf16 v[160:163], a[228:231], a[112:115], v[160:163]
    ds_read_b64_tr_b16 a[244:245], v8 offset:38912
    v_mfma_f32_16x16x32_bf16 v[168:171], a[228:231], a[116:119], v[168:171]
    buffer_load_dwordx4 a[144:147], v14, s[20:23], s46 offen sc1
    v_mfma_f32_16x16x32_bf16 v[168:171], a[224:227], a[100:103], v[168:171]
    ds_read_b64_tr_b16 a[246:247], v8 offset:45056
    v_mfma_f32_16x16x32_bf16 v[176:179], a[224:227], a[104:107], v[176:179]
    v_add_u32 v8, 49152, v8
    v_mfma_f32_16x16x32_bf16 v[176:179], a[228:231], a[120:123], v[176:179]
    s_waitcnt lgkmcnt(4)
    v_mfma_f32_16x16x32_bf16 v[184:187], a[228:231], a[124:127], v[184:187]
    v_mfma_f32_16x16x32_bf16 v[184:187], a[224:227], a[108:111], v[184:187]
    ds_read_b64_tr_b16 a[224:225], v9 offset:26624
    v_mfma_f32_16x16x32_bf16 v[188:191], a[232:235], a[108:111], v[188:191]
    buffer_load_dwordx4 a[148:151], v14, s[20:23], s77 offen sc1
    v_mfma_f32_16x16x32_bf16 v[188:191], a[236:239], a[124:127], v[188:191]
    ds_read_b64_tr_b16 a[226:227], v9 offset:32768
    v_mfma_f32_16x16x32_bf16 v[180:183], a[236:239], a[120:123], v[180:183]
    ds_read_b64_tr_b16 a[228:229], v9 offset:38912
    v_mfma_f32_16x16x32_bf16 v[180:183], a[232:235], a[104:107], v[180:183]
    ds_read_b64_tr_b16 a[230:231], v9 offset:45056
    v_mfma_f32_16x16x32_bf16 v[172:175], a[232:235], a[100:103], v[172:175]
    v_add_u32 v9, 49152, v9
    v_mfma_f32_16x16x32_bf16 v[172:175], a[236:239], a[116:119], v[172:175]
    s_waitcnt lgkmcnt(4)
    v_mfma_f32_16x16x32_bf16 v[164:167], a[236:239], a[112:115], v[164:167]
    buffer_load_dwordx4 a[152:155], v15, s[20:23], s46 offen sc1
    v_mfma_f32_16x16x32_bf16 v[164:167], a[232:235], a[96:99], v[164:167]
    ds_read_b64_tr_b16 a[232:233], v10 offset:26624
    v_mfma_f32_16x16x32_bf16 v[192:195], a[240:243], a[96:99], v[192:195]
    ds_read_b64_tr_b16 a[234:235], v10 offset:32768
    v_mfma_f32_16x16x32_bf16 v[192:195], a[244:247], a[112:115], v[192:195]
    ds_read_b64_tr_b16 a[236:237], v10 offset:38912
    v_mfma_f32_16x16x32_bf16 v[200:203], a[244:247], a[116:119], v[200:203]
pg_1:
    s_cbranch_execz pg_3
    ds_read_b64_tr_b16 a[238:239], v10 offset:45056
    v_mfma_f32_16x16x32_bf16 v[200:203], a[240:243], a[100:103], v[200:203]
    v_add_u32 v10, 49152, v10
    v_mfma_f32_16x16x32_bf16 v[208:211], a[240:243], a[104:107], v[208:211]
    buffer_load_dwordx4 a[156:159], v15, s[20:23], s77 offen sc1
    v_mfma_f32_16x16x32_bf16 v[208:211], a[244:247], a[120:123], v[208:211]
    s_waitcnt lgkmcnt(4)
    s_addk_i32 m0, 19712
    v_mfma_f32_16x16x32_bf16 v[216:219], a[244:247], a[124:127], v[216:219]
    v_mfma_f32_16x16x32_bf16 v[216:219], a[240:243], a[108:111], v[216:219]
    ds_read_b64_tr_b16 a[240:241], v11 offset:26624
    ds_read_b64_tr_b16 a[242:243], v11 offset:32768
    ds_read_b64_tr_b16 a[244:245], v11 offset:38912
    v_mfma_f32_16x16x32_bf16 v[220:223], a[224:227], a[108:111], v[220:223]
    ds_read_b64_tr_b16 a[246:247], v11 offset:45056
    v_mfma_f32_16x16x32_bf16 v[220:223], a[228:231], a[124:127], v[220:223]
    v_add_u32 v11, 49152, v11
    v_mfma_f32_16x16x32_bf16 v[212:215], a[228:231], a[120:123], v[212:215]
    buffer_load_dwordx4 v2, s[8:11], s36 offen offset:0 lds
    v_mfma_f32_16x16x32_bf16 v[212:215], a[224:227], a[104:107], v[212:215]
    s_addk_i32 m0, 896
    v_mfma_f32_16x16x32_bf16 v[204:207], a[224:227], a[100:103], v[204:207]
    v_mfma_f32_16x16x32_bf16 v[204:207], a[228:231], a[116:119], v[204:207]
    s_waitcnt lgkmcnt(4)
    v_mfma_f32_16x16x32_bf16 v[196:199], a[228:231], a[112:115], v[196:199]
    s_waitcnt lgkmcnt(0)
    s_barrier
    v_mfma_f32_16x16x32_bf16 v[196:199], a[224:227], a[96:99], v[196:199]
    ds_read_b64_tr_b16 a[224:225], v8 offset:0
    v_mfma_f32_16x16x32_bf16 v[224:227], a[232:235], a[96:99], v[224:227]
    buffer_load_dwordx4 v2, s[8:11], s36 offen offset:128 lds
    v_mfma_f32_16x16x32_bf16 v[224:227], a[236:239], a[112:115], v[224:227]
    s_addk_i32 m0, 896
    ds_read_b64_tr_b16 a[226:227], v8 offset:6144
    v_mfma_f32_16x16x32_bf16 v[232:235], a[236:239], a[116:119], v[232:235]
    ds_read_b64_tr_b16 a[228:229], v8 offset:12288
    v_mfma_f32_16x16x32_bf16 v[232:235], a[232:235], a[100:103], v[232:235]
    ds_read_b64_tr_b16 a[230:231], v8 offset:18432
    v_mfma_f32_16x16x32_bf16 v[240:243], a[232:235], a[104:107], v[240:243]
    v_mfma_f32_16x16x32_bf16 v[240:243], a[236:239], a[120:123], v[240:243]
    v_mfma_f32_16x16x32_bf16 v[248:251], a[236:239], a[124:127], v[248:251]
    buffer_load_dwordx4 v2, s[8:11], s36 offen offset:256 lds
    v_mfma_f32_16x16x32_bf16 v[248:251], a[232:235], a[108:111], v[248:251]
    s_addk_i32 m0, 1280
    ds_read_b64_tr_b16 a[232:233], v9 offset:0
    v_mfma_f32_16x16x32_bf16 v[252:255], a[240:243], a[108:111], v[252:255]
    ds_read_b64_tr_b16 a[234:235], v9 offset:6144
    v_mfma_f32_16x16x32_bf16 v[252:255], a[244:247], a[124:127], v[252:255]
    ds_read_b64_tr_b16 a[236:237], v9 offset:12288
    v_mfma_f32_16x16x32_bf16 v[244:247], a[244:247], a[120:123], v[244:247]
    ds_read_b64_tr_b16 a[238:239], v9 offset:18432
    v_mfma_f32_16x16x32_bf16 v[244:247], a[240:243], a[104:107], v[244:247]
    v_mfma_f32_16x16x32_bf16 v[236:239], a[240:243], a[100:103], v[236:239]
    buffer_load_dwordx4 v3, s[8:11], s36 offen offset:0 lds
    v_mfma_f32_16x16x32_bf16 v[236:239], a[244:247], a[116:119], v[236:239]
    s_waitcnt vmcnt(11) lgkmcnt(4)
    s_addk_i32 m0, 896
    v_mfma_f32_16x16x32_bf16 v[228:231], a[244:247], a[112:115], v[228:231]
    s_waitcnt vmcnt(7)
    v_and_b32 v22, 1, v1
    v_mfma_f32_16x16x32_bf16 v[228:231], a[240:243], a[96:99], v[228:231]
    s_waitcnt vmcnt(6)
    ds_read_b64_tr_b16 a[240:241], v10 offset:0
    s_sub_u32 s56, s5, s4
    v_mfma_f32_16x16x32_bf16 v[64:67], a[224:227], a[128:131], v[64:67]
    s_sub_u32 s56, s56, 128
    ds_read_b64_tr_b16 a[242:243], v10 offset:6144
    v_mul_lo_u32 v22, v22, s56
    v_mfma_f32_16x16x32_bf16 v[64:67], a[228:231], a[144:147], v[64:67]
    buffer_load_dword a252, v22, s[24:27], s4 offen offset:128 sc1
    v_mfma_f32_16x16x32_bf16 v[72:75], a[228:231], a[148:151], v[72:75]
    buffer_load_dwordx4 v3, s[8:11], s36 offen offset:128 lds
    v_mfma_f32_16x16x32_bf16 v[72:75], a[224:227], a[132:135], v[72:75]
    s_waitcnt vmcnt(6)
    ds_read_b64_tr_b16 a[244:245], v10 offset:12288
    s_addk_i32 m0, 896
    v_mfma_f32_16x16x32_bf16 v[80:83], a[224:227], a[136:139], v[80:83]
    ds_read_b64_tr_b16 a[246:247], v10 offset:18432
    v_mfma_f32_16x16x32_bf16 v[80:83], a[228:231], a[152:155], v[80:83]
    s_waitcnt lgkmcnt(4)
    v_mfma_f32_16x16x32_bf16 v[88:91], a[228:231], a[156:159], v[88:91]
    v_mfma_f32_16x16x32_bf16 v[88:91], a[224:227], a[140:143], v[88:91]
    ds_read_b64_tr_b16 a[224:225], v11 offset:0
    v_mfma_f32_16x16x32_bf16 v[92:95], a[232:235], a[140:143], v[92:95]
    buffer_load_dwordx4 v3, s[8:11], s36 offen offset:256 lds
    v_mfma_f32_16x16x32_bf16 v[92:95], a[236:239], a[156:159], v[92:95]
    s_add_u32 s36, s36, s37
    ds_read_b64_tr_b16 a[226:227], v11 offset:6144
    s_sub_u32 s55, s36, 7864320
    v_mfma_f32_16x16x32_bf16 v[84:87], a[236:239], a[152:155], v[84:87]
    s_min_u32 s36, s36, s55
    ds_read_b64_tr_b16 a[228:229], v11 offset:12288
    s_add_u32 s46, s45, 24576
    v_mfma_f32_16x16x32_bf16 v[84:87], a[232:235], a[136:139], v[84:87]
    s_sub_u32 s77, s46, 81920
    ds_read_b64_tr_b16 a[230:231], v11 offset:18432
    s_min_u32 s46, s46, s77
    v_mfma_f32_16x16x32_bf16 v[76:79], a[232:235], a[132:135], v[76:79]
    s_xor_b32 s77, s46, 1024
    v_mfma_f32_16x16x32_bf16 v[76:79], a[236:239], a[148:151], v[76:79]
    s_waitcnt lgkmcnt(4)
    v_mfma_f32_16x16x32_bf16 v[68:71], a[236:239], a[144:147], v[68:71]
    buffer_load_dwordx4 a[192:195], v14, s[20:23], s46 offen sc1
    v_mfma_f32_16x16x32_bf16 v[68:71], a[232:235], a[128:131], v[68:71]
    ds_read_b64_tr_b16 a[232:233], v8 offset:1024
    v_mfma_f32_16x16x32_bf16 v[96:99], a[240:243], a[128:131], v[96:99]
    ds_read_b64_tr_b16 a[234:235], v8 offset:7168
    v_mfma_f32_16x16x32_bf16 v[96:99], a[244:247], a[144:147], v[96:99]
    ds_read_b64_tr_b16 a[236:237], v8 offset:13312
    v_mfma_f32_16x16x32_bf16 v[104:107], a[244:247], a[148:151], v[104:107]
    ds_read_b64_tr_b16 a[238:239], v8 offset:19456
    v_mfma_f32_16x16x32_bf16 v[104:107], a[240:243], a[132:135], v[104:107]
    v_mfma_f32_16x16x32_bf16 v[112:115], a[240:243], a[136:139], v[112:115]
    buffer_load_dwordx4 a[196:199], v14, s[20:23], s77 offen sc1
    v_mfma_f32_16x16x32_bf16 v[112:115], a[244:247], a[152:155], v[112:115]
    s_waitcnt lgkmcnt(4)
    v_mfma_f32_16x16x32_bf16 v[120:123], a[244:247], a[156:159], v[120:123]
    v_mfma_f32_16x16x32_bf16 v[120:123], a[240:243], a[140:143], v[120:123]
    ds_read_b64_tr_b16 a[240:241], v9 offset:1024
    v_mfma_f32_16x16x32_bf16 v[124:127], a[224:227], a[140:143], v[124:127]
    ds_read_b64_tr_b16 a[242:243], v9 offset:7168
    v_mfma_f32_16x16x32_bf16 v[124:127], a[228:231], a[156:159], v[124:127]
    ds_read_b64_tr_b16 a[244:245], v9 offset:13312
    v_mfma_f32_16x16x32_bf16 v[116:119], a[228:231], a[152:155], v[116:119]
    buffer_load_dwordx4 a[200:203], v15, s[20:23], s46 offen sc1
    v_mfma_f32_16x16x32_bf16 v[116:119], a[224:227], a[136:139], v[116:119]
    ds_read_b64_tr_b16 a[246:247], v9 offset:19456
    v_mfma_f32_16x16x32_bf16 v[108:111], a[224:227], a[132:135], v[108:111]
    v_mfma_f32_16x16x32_bf16 v[108:111], a[228:231], a[148:151], v[108:111]
    s_waitcnt lgkmcnt(4)
    v_mfma_f32_16x16x32_bf16 v[100:103], a[228:231], a[144:147], v[100:103]
    v_mfma_f32_16x16x32_bf16 v[100:103], a[224:227], a[128:131], v[100:103]
    ds_read_b64_tr_b16 a[224:225], v10 offset:1024
    v_mfma_f32_16x16x32_bf16 v[128:131], a[232:235], a[128:131], v[128:131]
    buffer_load_dwordx4 a[204:207], v15, s[20:23], s77 offen sc1
    v_mfma_f32_16x16x32_bf16 v[128:131], a[236:239], a[144:147], v[128:131]
    s_add_u32 s46, s45, 28672
    ds_read_b64_tr_b16 a[226:227], v10 offset:7168
    s_sub_u32 s77, s46, 81920
    v_mfma_f32_16x16x32_bf16 v[136:139], a[236:239], a[148:151], v[136:139]
    s_min_u32 s46, s46, s77
    ds_read_b64_tr_b16 a[228:229], v10 offset:13312
    s_xor_b32 s77, s46, 1024
    v_mfma_f32_16x16x32_bf16 v[136:139], a[232:235], a[132:135], v[136:139]
    ds_read_b64_tr_b16 a[230:231], v10 offset:19456
    v_mfma_f32_16x16x32_bf16 v[144:147], a[232:235], a[136:139], v[144:147]
    v_mfma_f32_16x16x32_bf16 v[144:147], a[236:239], a[152:155], v[144:147]
    s_waitcnt lgkmcnt(4)
    v_mfma_f32_16x16x32_bf16 v[152:155], a[236:239], a[156:159], v[152:155]
    buffer_load_dwordx4 v[32:35], v17, s[24:27], s47 offen offset:0 sc1
    v_mfma_f32_16x16x32_bf16 v[152:155], a[232:235], a[140:143], v[152:155]
    buffer_load_dwordx4 a[208:211], v14, s[20:23], s46 offen sc1
    v_mfma_f32_16x16x32_bf16 v[156:159], a[240:243], a[140:143], v[156:159]
    ds_read_b64_tr_b16 a[232:233], v11 offset:1024
    v_mfma_f32_16x16x32_bf16 v[156:159], a[244:247], a[156:159], v[156:159]
    ds_read_b64_tr_b16 a[234:235], v11 offset:7168
    v_mfma_f32_16x16x32_bf16 v[148:151], a[244:247], a[152:155], v[148:151]
    ds_read_b64_tr_b16 a[236:237], v11 offset:13312
    v_mfma_f32_16x16x32_bf16 v[148:151], a[240:243], a[136:139], v[148:151]
    ds_read_b64_tr_b16 a[238:239], v11 offset:19456
    v_mfma_f32_16x16x32_bf16 v[140:143], a[240:243], a[132:135], v[140:143]
    buffer_load_dwordx4 a[212:215], v14, s[20:23], s77 offen sc1
    v_mfma_f32_16x16x32_bf16 v[140:143], a[244:247], a[148:151], v[140:143]
    s_waitcnt lgkmcnt(4)
    v_mfma_f32_16x16x32_bf16 v[132:135], a[244:247], a[144:147], v[132:135]
    v_mfma_f32_16x16x32_bf16 v[132:135], a[240:243], a[128:131], v[132:135]
    ds_read_b64_tr_b16 a[240:241], v8 offset:2048
    v_mfma_f32_16x16x32_bf16 v[160:163], a[224:227], a[128:131], v[160:163]
    ds_read_b64_tr_b16 a[242:243], v8 offset:8192
    v_mfma_f32_16x16x32_bf16 v[160:163], a[228:231], a[144:147], v[160:163]
    ds_read_b64_tr_b16 a[244:245], v8 offset:14336
    v_mfma_f32_16x16x32_bf16 v[168:171], a[228:231], a[148:151], v[168:171]
    buffer_load_dwordx4 a[216:219], v15, s[20:23], s46 offen sc1
    v_mfma_f32_16x16x32_bf16 v[168:171], a[224:227], a[132:135], v[168:171]
    ds_read_b64_tr_b16 a[246:247], v8 offset:20480
    v_mfma_f32_16x16x32_bf16 v[176:179], a[224:227], a[136:139], v[176:179]
    buffer_load_dwordx4 v[36:39], v17, s[24:27], s47 offen offset:1024 sc1
    v_mfma_f32_16x16x32_bf16 v[176:179], a[228:231], a[152:155], v[176:179]
    s_waitcnt lgkmcnt(4)
    v_mfma_f32_16x16x32_bf16 v[184:187], a[228:231], a[156:159], v[184:187]
    v_mfma_f32_16x16x32_bf16 v[184:187], a[224:227], a[140:143], v[184:187]
    ds_read_b64_tr_b16 a[224:225], v9 offset:2048
    v_mfma_f32_16x16x32_bf16 v[188:191], a[232:235], a[140:143], v[188:191]
    buffer_load_dwordx4 a[220:223], v15, s[20:23], s77 offen sc1
    v_mfma_f32_16x16x32_bf16 v[188:191], a[236:239], a[156:159], v[188:191]
    s_addk_i32 m0, 19712
    ds_read_b64_tr_b16 a[226:227], v9 offset:8192
    v_mfma_f32_16x16x32_bf16 v[180:183], a[236:239], a[152:155], v[180:183]
    ds_read_b64_tr_b16 a[228:229], v9 offset:14336
    v_mfma_f32_16x16x32_bf16 v[180:183], a[232:235], a[136:139], v[180:183]
    ds_read_b64_tr_b16 a[230:231], v9 offset:20480
    v_mfma_f32_16x16x32_bf16 v[172:175], a[232:235], a[132:135], v[172:175]
    v_mfma_f32_16x16x32_bf16 v[172:175], a[236:239], a[148:151], v[172:175]
    s_waitcnt lgkmcnt(4)
    v_mfma_f32_16x16x32_bf16 v[164:167], a[236:239], a[144:147], v[164:167]
    buffer_load_dwordx4 v2, s[8:11], s36 offen offset:0 lds
    v_mfma_f32_16x16x32_bf16 v[164:167], a[232:235], a[128:131], v[164:167]
    s_addk_i32 m0, 896
    ds_read_b64_tr_b16 a[232:233], v10 offset:2048
    v_mfma_f32_16x16x32_bf16 v[192:195], a[240:243], a[128:131], v[192:195]
    ds_read_b64_tr_b16 a[234:235], v10 offset:8192
    v_mfma_f32_16x16x32_bf16 v[192:195], a[244:247], a[144:147], v[192:195]
    ds_read_b64_tr_b16 a[236:237], v10 offset:14336
    v_mfma_f32_16x16x32_bf16 v[200:203], a[244:247], a[148:151], v[200:203]
    buffer_load_dwordx4 v[40:43], v17, s[24:27], s47 offen offset:2048 sc1
    v_mfma_f32_16x16x32_bf16 v[200:203], a[240:243], a[132:135], v[200:203]
    ds_read_b64_tr_b16 a[238:239], v10 offset:20480
    v_mfma_f32_16x16x32_bf16 v[208:211], a[240:243], a[136:139], v[208:211]
    buffer_load_dwordx4 v2, s[8:11], s36 offen offset:128 lds
    v_mfma_f32_16x16x32_bf16 v[208:211], a[244:247], a[152:155], v[208:211]
    s_waitcnt lgkmcnt(4)
    s_addk_i32 m0, 896
    v_mfma_f32_16x16x32_bf16 v[216:219], a[244:247], a[156:159], v[216:219]
    v_mfma_f32_16x16x32_bf16 v[216:219], a[240:243], a[140:143], v[216:219]
    ds_read_b64_tr_b16 a[240:241], v11 offset:2048
    ds_read_b64_tr_b16 a[242:243], v11 offset:8192
    ds_read_b64_tr_b16 a[244:245], v11 offset:14336
    v_mfma_f32_16x16x32_bf16 v[220:223], a[224:227], a[140:143], v[220:223]
    ds_read_b64_tr_b16 a[246:247], v11 offset:20480
    v_mfma_f32_16x16x32_bf16 v[220:223], a[228:231], a[156:159], v[220:223]
    v_mfma_f32_16x16x32_bf16 v[212:215], a[228:231], a[152:155], v[212:215]
    buffer_load_dwordx4 v2, s[8:11], s36 offen offset:256 lds
    v_mfma_f32_16x16x32_bf16 v[212:215], a[224:227], a[136:139], v[212:215]
    s_addk_i32 m0, 1280
    v_mfma_f32_16x16x32_bf16 v[204:207], a[224:227], a[132:135], v[204:207]
    v_mfma_f32_16x16x32_bf16 v[204:207], a[228:231], a[148:151], v[204:207]
    s_waitcnt lgkmcnt(4)
    v_mfma_f32_16x16x32_bf16 v[196:199], a[228:231], a[144:147], v[196:199]
    s_waitcnt lgkmcnt(0)
    s_barrier
    v_mfma_f32_16x16x32_bf16 v[196:199], a[224:227], a[128:131], v[196:199]
    ds_read_b64_tr_b16 a[224:225], v8 offset:24576
    v_mfma_f32_16x16x32_bf16 v[224:227], a[232:235], a[128:131], v[224:227]
    buffer_load_dwordx4 v[44:47], v17, s[24:27], s47 offen offset:3072 sc1
    v_mfma_f32_16x16x32_bf16 v[224:227], a[236:239], a[144:147], v[224:227]
    buffer_load_dwordx4 v3, s[8:11], s36 offen offset:0 lds
    v_mfma_f32_16x16x32_bf16 v[232:235], a[236:239], a[148:151], v[232:235]
    s_addk_i32 m0, 896
    ds_read_b64_tr_b16 a[226:227], v8 offset:30720
    v_mfma_f32_16x16x32_bf16 v[232:235], a[232:235], a[132:135], v[232:235]
    ds_read_b64_tr_b16 a[228:229], v8 offset:36864
    v_mfma_f32_16x16x32_bf16 v[240:243], a[232:235], a[136:139], v[240:243]
    ds_read_b64_tr_b16 a[230:231], v8 offset:43008
    v_mfma_f32_16x16x32_bf16 v[240:243], a[236:239], a[152:155], v[240:243]
    v_mfma_f32_16x16x32_bf16 v[248:251], a[236:239], a[156:159], v[248:251]
    buffer_load_dwordx4 v3, s[8:11], s36 offen offset:128 lds
    v_mfma_f32_16x16x32_bf16 v[248:251], a[232:235], a[140:143], v[248:251]
    s_addk_i32 m0, 896
    ds_read_b64_tr_b16 a[232:233], v9 offset:24576
    v_mfma_f32_16x16x32_bf16 v[252:255], a[240:243], a[140:143], v[252:255]
    ds_read_b64_tr_b16 a[234:235], v9 offset:30720
    v_mfma_f32_16x16x32_bf16 v[252:255], a[244:247], a[156:159], v[252:255]
    ds_read_b64_tr_b16 a[236:237], v9 offset:36864
    v_mfma_f32_16x16x32_bf16 v[244:247], a[244:247], a[152:155], v[244:247]
    ds_read_b64_tr_b16 a[238:239], v9 offset:43008
    v_mfma_f32_16x16x32_bf16 v[244:247], a[240:243], a[136:139], v[244:247]
    v_mfma_f32_16x16x32_bf16 v[236:239], a[240:243], a[132:135], v[236:239]
    buffer_load_dwordx4 v3, s[8:11], s36 offen offset:256 lds
    v_mfma_f32_16x16x32_bf16 v[236:239], a[244:247], a[148:151], v[236:239]
    s_waitcnt vmcnt(17) lgkmcnt(4)
    s_add_u32 s36, s36, s37
    s_sub_u32 s55, s36, 7864320
    v_mfma_f32_16x16x32_bf16 v[228:231], a[244:247], a[144:147], v[228:231]
    s_waitcnt vmcnt(12)
    s_min_u32 s36, s36, s55
    s_add_u32 s46, s45, 32768
    v_mfma_f32_16x16x32_bf16 v[228:231], a[240:243], a[128:131], v[228:231]
    s_waitcnt vmcnt(11)
    ds_read_b64_tr_b16 a[240:241], v10 offset:24576
    s_sub_u32 s77, s46, 81920
    v_mfma_f32_16x16x32_bf16 v[64:67], a[224:227], a[192:195], v[64:67]
    s_min_u32 s46, s46, s77
    ds_read_b64_tr_b16 a[242:243], v10 offset:30720
    s_xor_b32 s77, s46, 1024
    v_mfma_f32_16x16x32_bf16 v[64:67], a[228:231], a[208:211], v[64:67]
    ds_read_b64_tr_b16 a[244:245], v10 offset:36864
    v_mfma_f32_16x16x32_bf16 v[72:75], a[228:231], a[212:215], v[72:75]
    buffer_load_dwordx4 a[0:3], v14, s[20:23], s46 offen sc1
    v_mfma_f32_16x16x32_bf16 v[72:75], a[224:227], a[196:199], v[72:75]
    s_waitcnt vmcnt(9)
    ds_read_b64_tr_b16 a[246:247], v10 offset:43008
    v_mfma_f32_16x16x32_bf16 v[80:83], a[224:227], a[200:203], v[80:83]
    v_mfma_f32_16x16x32_bf16 v[80:83], a[228:231], a[216:219], v[80:83]
    s_waitcnt lgkmcnt(4)
    v_mfma_f32_16x16x32_bf16 v[88:91], a[228:231], a[220:223], v[88:91]
    v_mfma_f32_16x16x32_bf16 v[88:91], a[224:227], a[204:207], v[88:91]
    ds_read_b64_tr_b16 a[224:225], v11 offset:24576
    v_mfma_f32_16x16x32_bf16 v[92:95], a[232:235], a[204:207], v[92:95]
    buffer_load_dwordx4 a[4:7], v14, s[20:23], s77 offen sc1
    v_mfma_f32_16x16x32_bf16 v[92:95], a[236:239], a[220:223], v[92:95]
    ds_read_b64_tr_b16 a[226:227], v11 offset:30720
    v_mfma_f32_16x16x32_bf16 v[84:87], a[236:239], a[216:219], v[84:87]
    ds_read_b64_tr_b16 a[228:229], v11 offset:36864
    v_mfma_f32_16x16x32_bf16 v[84:87], a[232:235], a[200:203], v[84:87]
    ds_read_b64_tr_b16 a[230:231], v11 offset:43008
    v_mfma_f32_16x16x32_bf16 v[76:79], a[232:235], a[196:199], v[76:79]
    v_mfma_f32_16x16x32_bf16 v[76:79], a[236:239], a[212:215], v[76:79]
    s_waitcnt lgkmcnt(4)
    v_mfma_f32_16x16x32_bf16 v[68:71], a[236:239], a[208:211], v[68:71]
    buffer_load_dwordx4 a[8:11], v15, s[20:23], s46 offen sc1
    v_mfma_f32_16x16x32_bf16 v[68:71], a[232:235], a[192:195], v[68:71]
    ds_read_b64_tr_b16 a[232:233], v8 offset:25600
    v_mfma_f32_16x16x32_bf16 v[96:99], a[240:243], a[192:195], v[96:99]
    ds_read_b64_tr_b16 a[234:235], v8 offset:31744
    v_mfma_f32_16x16x32_bf16 v[96:99], a[244:247], a[208:211], v[96:99]
    ds_read_b64_tr_b16 a[236:237], v8 offset:37888
    v_mfma_f32_16x16x32_bf16 v[104:107], a[244:247], a[212:215], v[104:107]
    ds_read_b64_tr_b16 a[238:239], v8 offset:44032
    v_mfma_f32_16x16x32_bf16 v[104:107], a[240:243], a[196:199], v[104:107]
    v_mfma_f32_16x16x32_bf16 v[112:115], a[240:243], a[200:203], v[112:115]
    buffer_load_dwordx4 a[12:15], v15, s[20:23], s77 offen sc1
    v_mfma_f32_16x16x32_bf16 v[112:115], a[244:247], a[216:219], v[112:115]
    s_waitcnt lgkmcnt(4)
    s_add_u32 s46, s45, 36864
    s_sub_u32 s77, s46, 81920
    v_mfma_f32_16x16x32_bf16 v[120:123], a[244:247], a[220:223], v[120:123]
    s_min_u32 s46, s46, s77
    s_xor_b32 s77, s46, 1024
    v_mfma_f32_16x16x32_bf16 v[120:123], a[240:243], a[204:207], v[120:123]
    ds_read_b64_tr_b16 a[240:241], v9 offset:25600
    v_mfma_f32_16x16x32_bf16 v[124:127], a[224:227], a[204:207], v[124:127]
    ds_read_b64_tr_b16 a[242:243], v9 offset:31744
    v_mfma_f32_16x16x32_bf16 v[124:127], a[228:231], a[220:223], v[124:127]
    ds_read_b64_tr_b16 a[244:245], v9 offset:37888
    v_mfma_f32_16x16x32_bf16 v[116:119], a[228:231], a[216:219], v[116:119]
    buffer_load_dwordx4 a[16:19], v14, s[20:23], s46 offen sc1
    v_mfma_f32_16x16x32_bf16 v[116:119], a[224:227], a[200:203], v[116:119]
    ds_read_b64_tr_b16 a[246:247], v9 offset:44032
    v_mfma_f32_16x16x32_bf16 v[108:111], a[224:227], a[196:199], v[108:111]
    v_mfma_f32_16x16x32_bf16 v[108:111], a[228:231], a[212:215], v[108:111]
    s_waitcnt lgkmcnt(4)
    v_mfma_f32_16x16x32_bf16 v[100:103], a[228:231], a[208:211], v[100:103]
    v_mfma_f32_16x16x32_bf16 v[100:103], a[224:227], a[192:195], v[100:103]
    ds_read_b64_tr_b16 a[224:225], v10 offset:25600
    v_mfma_f32_16x16x32_bf16 v[128:131], a[232:235], a[192:195], v[128:131]
    buffer_load_dwordx4 a[20:23], v14, s[20:23], s77 offen sc1
    v_mfma_f32_16x16x32_bf16 v[128:131], a[236:239], a[208:211], v[128:131]
    ds_read_b64_tr_b16 a[226:227], v10 offset:31744
    v_mfma_f32_16x16x32_bf16 v[136:139], a[236:239], a[212:215], v[136:139]
    ds_read_b64_tr_b16 a[228:229], v10 offset:37888
    v_mfma_f32_16x16x32_bf16 v[136:139], a[232:235], a[196:199], v[136:139]
    ds_read_b64_tr_b16 a[230:231], v10 offset:44032
    v_mfma_f32_16x16x32_bf16 v[144:147], a[232:235], a[200:203], v[144:147]
    v_mfma_f32_16x16x32_bf16 v[144:147], a[236:239], a[216:219], v[144:147]
    s_waitcnt lgkmcnt(4)
    v_mfma_f32_16x16x32_bf16 v[152:155], a[236:239], a[220:223], v[152:155]
    buffer_load_dwordx4 a[24:27], v15, s[20:23], s46 offen sc1
    v_mfma_f32_16x16x32_bf16 v[152:155], a[232:235], a[204:207], v[152:155]
    ds_read_b64_tr_b16 a[232:233], v11 offset:25600
    v_mfma_f32_16x16x32_bf16 v[156:159], a[240:243], a[204:207], v[156:159]
    ds_read_b64_tr_b16 a[234:235], v11 offset:31744
    v_mfma_f32_16x16x32_bf16 v[156:159], a[244:247], a[220:223], v[156:159]
    ds_read_b64_tr_b16 a[236:237], v11 offset:37888
    v_mfma_f32_16x16x32_bf16 v[148:151], a[244:247], a[216:219], v[148:151]
    ds_read_b64_tr_b16 a[238:239], v11 offset:44032
    v_mfma_f32_16x16x32_bf16 v[148:151], a[240:243], a[200:203], v[148:151]
    v_mfma_f32_16x16x32_bf16 v[140:143], a[240:243], a[196:199], v[140:143]
    buffer_load_dwordx4 a[28:31], v15, s[20:23], s77 offen sc1
    v_mfma_f32_16x16x32_bf16 v[140:143], a[244:247], a[212:215], v[140:143]
    s_waitcnt lgkmcnt(4)
    s_addk_i32 m0, 19712
    v_mfma_f32_16x16x32_bf16 v[132:135], a[244:247], a[208:211], v[132:135]
    v_mfma_f32_16x16x32_bf16 v[132:135], a[240:243], a[192:195], v[132:135]
    ds_read_b64_tr_b16 a[240:241], v8 offset:26624
    v_mfma_f32_16x16x32_bf16 v[160:163], a[224:227], a[192:195], v[160:163]
    ds_read_b64_tr_b16 a[242:243], v8 offset:32768
    v_mfma_f32_16x16x32_bf16 v[160:163], a[228:231], a[208:211], v[160:163]
    ds_read_b64_tr_b16 a[244:245], v8 offset:38912
    v_mfma_f32_16x16x32_bf16 v[168:171], a[228:231], a[212:215], v[168:171]
    buffer_load_dwordx4 v2, s[8:11], s36 offen offset:0 lds
    v_mfma_f32_16x16x32_bf16 v[168:171], a[224:227], a[196:199], v[168:171]
    s_addk_i32 m0, 896
    ds_read_b64_tr_b16 a[246:247], v8 offset:45056
    v_mfma_f32_16x16x32_bf16 v[176:179], a[224:227], a[200:203], v[176:179]
    v_subrev_u32 v8, 98304, v8
    v_mfma_f32_16x16x32_bf16 v[176:179], a[228:231], a[216:219], v[176:179]
    s_waitcnt lgkmcnt(4)
    v_mfma_f32_16x16x32_bf16 v[184:187], a[228:231], a[220:223], v[184:187]
    v_mfma_f32_16x16x32_bf16 v[184:187], a[224:227], a[204:207], v[184:187]
    ds_read_b64_tr_b16 a[224:225], v9 offset:26624
    v_mfma_f32_16x16x32_bf16 v[188:191], a[232:235], a[204:207], v[188:191]
    buffer_load_dwordx4 v2, s[8:11], s36 offen offset:128 lds
    v_mfma_f32_16x16x32_bf16 v[188:191], a[236:239], a[220:223], v[188:191]
    s_addk_i32 m0, 896
    ds_read_b64_tr_b16 a[226:227], v9 offset:32768
    v_mfma_f32_16x16x32_bf16 v[180:183], a[236:239], a[216:219], v[180:183]
    ds_read_b64_tr_b16 a[228:229], v9 offset:38912
    v_mfma_f32_16x16x32_bf16 v[180:183], a[232:235], a[200:203], v[180:183]
    ds_read_b64_tr_b16 a[230:231], v9 offset:45056
    v_mfma_f32_16x16x32_bf16 v[172:175], a[232:235], a[196:199], v[172:175]
    v_subrev_u32 v9, 98304, v9
    v_mfma_f32_16x16x32_bf16 v[172:175], a[236:239], a[212:215], v[172:175]
    s_waitcnt lgkmcnt(4)
    v_mfma_f32_16x16x32_bf16 v[164:167], a[236:239], a[208:211], v[164:167]
    buffer_load_dwordx4 v2, s[8:11], s36 offen offset:256 lds
    v_mfma_f32_16x16x32_bf16 v[164:167], a[232:235], a[192:195], v[164:167]
    s_addk_i32 m0, 1280
    ds_read_b64_tr_b16 a[232:233], v10 offset:26624
    v_xor_b32 v34, s7, v34
    v_mfma_f32_16x16x32_bf16 v[192:195], a[240:243], a[192:195], v[192:195]
    s_waitcnt vmcnt(17)
    ds_read_b64_tr_b16 a[234:235], v10 offset:32768
    v_xor_b32 v38, s7, v38
    v_mfma_f32_16x16x32_bf16 v[192:195], a[244:247], a[208:211], v[192:195]
    s_waitcnt vmcnt(14)
    ds_read_b64_tr_b16 a[236:237], v10 offset:38912
    v_xor_b32 v42, s7, v42
    v_mfma_f32_16x16x32_bf16 v[200:203], a[244:247], a[212:215], v[200:203]
    s_lshl_b32 s56, s3, 3
    ds_read_b64_tr_b16 a[238:239], v10 offset:45056
    v_xor_b32 v46, s7, v46
    v_mfma_f32_16x16x32_bf16 v[200:203], a[240:243], a[196:199], v[200:203]
    s_add_u32 s56, s56, 147456
    v_or3_b32 v34, v34, v38, v42
    v_or_b32 v34, v34, v46
    v_mfma_f32_16x16x32_bf16 v[208:211], a[240:243], a[200:203], v[208:211]
    buffer_load_dwordx4 v3, s[8:11], s36 offen offset:0 lds
    v_mfma_f32_16x16x32_bf16 v[208:211], a[244:247], a[216:219], v[208:211]
    s_waitcnt lgkmcnt(4)
    v_cmp_ne_u32 vcc, 0, v34
    s_addk_i32 m0, 896
    v_mfma_f32_16x16x32_bf16 v[216:219], a[244:247], a[220:223], v[216:219]
    s_cbranch_vccnz spin_rec
spin_rec_ret:
    v_max_u32 v20, v32, v33
    v_mfma_f32_16x16x32_bf16 v[216:219], a[240:243], a[204:207], v[216:219]
    ds_read_b64_tr_b16 a[240:241], v11 offset:26624
    v_min_u32 v21, v32, v33
    ds_read_b64_tr_b16 a[242:243], v11 offset:32768
    v_mfma_f32_16x16x32_bf16 v[220:223], a[224:227], a[204:207], v[220:223]
    ds_read_b64_tr_b16 a[244:245], v11 offset:38912
    v_med3_u32 v21, v20, v21, v36
    ds_read_b64_tr_b16 a[246:247], v11 offset:45056
    v_mfma_f32_16x16x32_bf16 v[220:223], a[228:231], a[220:223], v[220:223]
    v_max_u32 v20, v20, v36
    v_med3_u32 v21, v20, v21, v37
    v_mfma_f32_16x16x32_bf16 v[212:215], a[228:231], a[216:219], v[212:215]
    buffer_load_dwordx4 v3, s[8:11], s36 offen offset:128 lds
    v_mfma_f32_16x16x32_bf16 v[212:215], a[224:227], a[200:203], v[212:215]
    s_addk_i32 m0, 896
    v_max_u32 v20, v20, v37
    v_med3_u32 v21, v20, v21, v40
    v_mfma_f32_16x16x32_bf16 v[204:207], a[224:227], a[196:199], v[204:207]
    v_max_u32 v20, v20, v40
    v_med3_u32 v21, v20, v21, v41
    v_mfma_f32_16x16x32_bf16 v[204:207], a[228:231], a[212:215], v[204:207]
    s_waitcnt lgkmcnt(4)
    v_max_u32 v20, v20, v41
    v_med3_u32 v21, v20, v21, v44
    v_mfma_f32_16x16x32_bf16 v[196:199], a[228:231], a[208:211], v[196:199]
    s_waitcnt lgkmcnt(0)
    s_barrier
    v_mfma_f32_16x16x32_bf16 v[196:199], a[224:227], a[192:195], v[196:199]
    ds_read_b64_tr_b16 a[224:225], v8 offset:0
    v_max_u32 v20, v20, v44
    v_mfma_f32_16x16x32_bf16 v[224:227], a[232:235], a[192:195], v[224:227]
    buffer_load_dwordx4 v3, s[8:11], s36 offen offset:256 lds
    v_mfma_f32_16x16x32_bf16 v[224:227], a[236:239], a[208:211], v[224:227]
    s_add_u32 s36, s36, s37
    ds_read_b64_tr_b16 a[226:227], v8 offset:6144
    v_med3_u32 v21, v20, v21, v45
    v_mfma_f32_16x16x32_bf16 v[232:235], a[236:239], a[212:215], v[232:235]
    s_sub_u32 s55, s36, 7864320
    ds_read_b64_tr_b16 a[228:229], v8 offset:12288
    v_max_u32 v20, v20, v45
    v_mfma_f32_16x16x32_bf16 v[232:235], a[232:235], a[196:199], v[232:235]
    s_min_u32 s36, s36, s55
    ds_read_b64_tr_b16 a[230:231], v8 offset:18432
    v_mov_b32_dpp v22, v20 row_ror:8 row_mask:0xf bank_mask:0xf
    v_mfma_f32_16x16x32_bf16 v[240:243], a[232:235], a[200:203], v[240:243]
    s_add_u32 s46, s45, 40960
    v_mov_b32_dpp v23, v21 row_ror:8 row_mask:0xf bank_mask:0xf
    v_min_u32 v24, v20, v22
    v_mfma_f32_16x16x32_bf16 v[240:243], a[236:239], a[216:219], v[240:243]
    s_sub_u32 s77, s46, 81920
    v_max_u32 v20, v20, v22
    v_max3_u32 v21, v24, v21, v23
    v_mfma_f32_16x16x32_bf16 v[248:251], a[236:239], a[220:223], v[248:251]
    s_min_u32 s46, s46, s77
    v_mov_b32_dpp v22, v20 row_ror:4 row_mask:0xf bank_mask:0xf
    v_mov_b32_dpp v23, v21 row_ror:4 row_mask:0xf bank_mask:0xf
    v_mfma_f32_16x16x32_bf16 v[248:251], a[232:235], a[204:207], v[248:251]
    buffer_load_dwordx4 a[32:35], v14, s[20:23], s46 offen sc1
    v_mfma_f32_16x16x32_bf16 v[252:255], a[240:243], a[204:207], v[252:255]
    s_xor_b32 s77, s46, 1024
    ds_read_b64_tr_b16 a[232:233], v9 offset:0
    v_min_u32 v24, v20, v22
    v_mfma_f32_16x16x32_bf16 v[252:255], a[244:247], a[220:223], v[252:255]
    ds_read_b64_tr_b16 a[234:235], v9 offset:6144
    v_max_u32 v20, v20, v22
    v_mfma_f32_16x16x32_bf16 v[244:247], a[244:247], a[216:219], v[244:247]
    ds_read_b64_tr_b16 a[236:237], v9 offset:12288
    v_max3_u32 v21, v24, v21, v23
    v_mfma_f32_16x16x32_bf16 v[244:247], a[240:243], a[200:203], v[244:247]
    ds_read_b64_tr_b16 a[238:239], v9 offset:18432
    v_mov_b32_dpp v22, v20 row_ror:2 row_mask:0xf bank_mask:0xf
    v_mfma_f32_16x16x32_bf16 v[236:239], a[240:243], a[196:199], v[236:239]
    buffer_load_dwordx4 a[36:39], v14, s[20:23], s77 offen sc1
    v_mfma_f32_16x16x32_bf16 v[236:239], a[244:247], a[212:215], v[236:239]
    s_waitcnt vmcnt(15) lgkmcnt(4)
    v_mov_b32_dpp v23, v21 row_ror:2 row_mask:0xf bank_mask:0xf
    v_min_u32 v24, v20, v22
    v_mfma_f32_16x16x32_bf16 v[228:231], a[244:247], a[208:211], v[228:231]
    s_waitcnt vmcnt(11)
    v_max_u32 v20, v20, v22
    v_max3_u32 v21, v24, v21, v23
    v_mfma_f32_16x16x32_bf16 v[228:231], a[240:243], a[192:195], v[228:231]
    s_waitcnt vmcnt(10)
    v_mov_b32_dpp v22, v20 row_ror:1 row_mask:0xf bank_mask:0xf
    v_mov_b32_dpp v23, v21 row_ror:1 row_mask:0xf bank_mask:0xf
    v_mfma_f32_16x16x32_bf16 v[64:67], a[224:227], a[0:3], v[64:67]
    v_min_u32 v24, v20, v22
    v_max_u32 v20, v20, v22
    v_mfma_f32_16x16x32_bf16 v[64:67], a[228:231], a[16:19], v[64:67]
    v_max3_u32 v21, v24, v21, v23
    v_mov_b32 v22, v20
    v_mfma_f32_16x16x32_bf16 v[72:75], a[228:231], a[20:23], v[72:75]
    buffer_load_dwordx4 a[40:43], v15, s[20:23], s46 offen sc1
    v_mfma_f32_16x16x32_bf16 v[72:75], a[224:227], a[4:7], v[72:75]
    s_waitcnt vmcnt(9)
    v_permlane16_swap_b32 v20, v22
    v_mfma_f32_16x16x32_bf16 v[80:83], a[224:227], a[8:11], v[80:83]
    v_mov_b32 v23, v21
    v_min_u32 v24, v20, v22
    v_mfma_f32_16x16x32_bf16 v[80:83], a[228:231], a[24:27], v[80:83]
    s_waitcnt lgkmcnt(0)
    v_permlane16_swap_b32 v21, v23
    v_mfma_f32_16x16x32_bf16 v[88:91], a[228:231], a[28:31], v[88:91]
    v_max_u32 v20, v20, v22
    v_max3_u32 v21, v24, v21, v23
    v_subrev_u32 v10, 98304, v10
    v_mfma_f32_16x16x32_bf16 v[88:91], a[224:227], a[12:15], v[88:91]
    ds_read_b64_tr_b16 a[240:241], v10 offset:0
    v_mov_b32 v22, v20
    v_mfma_f32_16x16x32_bf16 v[92:95], a[232:235], a[12:15], v[92:95]
    s_add_u32 s46, s45, 45056
    ds_read_b64_tr_b16 a[242:243], v10 offset:6144
    v_mov_b32 v23, v21
    v_mfma_f32_16x16x32_bf16 v[92:95], a[236:239], a[28:31], v[92:95]
    ds_read_b64_tr_b16 a[244:245], v10 offset:12288
    v_subrev_u32 v11, 98304, v11
    v_mfma_f32_16x16x32_bf16 v[84:87], a[236:239], a[24:27], v[84:87]
    ds_read_b64_tr_b16 a[246:247], v10 offset:18432
    v_mfma_f32_16x16x32_bf16 v[84:87], a[232:235], a[8:11], v[84:87]
    buffer_load_dwordx4 a[44:47], v15, s[20:23], s77 offen sc1
    v_mfma_f32_16x16x32_bf16 v[76:79], a[232:235], a[4:7], v[76:79]
    s_sub_u32 s77, s46, 81920
    ds_read_b64_tr_b16 a[224:225], v11 offset:0
    s_min_u32 s46, s46, s77
    v_mfma_f32_16x16x32_bf16 v[76:79], a[236:239], a[20:23], v[76:79]
    s_xor_b32 s77, s46, 1024
    ds_read_b64_tr_b16 a[226:227], v11 offset:6144
    v_mfma_f32_16x16x32_bf16 v[68:71], a[236:239], a[16:19], v[68:71]
    buffer_load_dwordx4 a[48:51], v14, s[20:23], s46 offen sc1
    v_mfma_f32_16x16x32_bf16 v[68:71], a[232:235], a[0:3], v[68:71]
    s_waitcnt lgkmcnt(4)
    ds_read_b64_tr_b16 a[228:229], v11 offset:12288
    v_mfma_f32_16x16x32_bf16 v[96:99], a[240:243], a[0:3], v[96:99]
    s_waitcnt lgkmcnt(3)
    ds_read_b64_tr_b16 a[230:231], v11 offset:18432
    v_mfma_f32_16x16x32_bf16 v[96:99], a[244:247], a[16:19], v[96:99]
    ds_read_b64_tr_b16 a[232:233], v8 offset:1024
    v_mfma_f32_16x16x32_bf16 v[104:107], a[244:247], a[20:23], v[104:107]
    ds_read_b64_tr_b16 a[234:235], v8 offset:7168
    v_mfma_f32_16x16x32_bf16 v[104:107], a[240:243], a[4:7], v[104:107]
    ds_read_b64_tr_b16 a[236:237], v8 offset:13312
    v_mfma_f32_16x16x32_bf16 v[112:115], a[240:243], a[8:11], v[112:115]
pg_2:
    s_cbranch_execz pg_4
    buffer_load_dwordx4 a[52:55], v14, s[20:23], s77 offen sc1
    v_mfma_f32_16x16x32_bf16 v[112:115], a[244:247], a[24:27], v[112:115]
    s_waitcnt lgkmcnt(5)
    ds_read_b64_tr_b16 a[238:239], v8 offset:19456
    v_mfma_f32_16x16x32_bf16 v[120:123], a[244:247], a[28:31], v[120:123]
    v_permlane32_swap_b32 v20, v22
    v_mfma_f32_16x16x32_bf16 v[120:123], a[240:243], a[12:15], v[120:123]
    s_waitcnt lgkmcnt(4)
    ds_read_b64_tr_b16 a[240:241], v9 offset:1024
    v_min_u32 v24, v20, v22
    v_mfma_f32_16x16x32_bf16 v[124:127], a[224:227], a[12:15], v[124:127]
    ds_read_b64_tr_b16 a[242:243], v9 offset:7168
    v_max_u32 v20, v20, v22
    v_mfma_f32_16x16x32_bf16 v[124:127], a[228:231], a[28:31], v[124:127]
    ds_read_b64_tr_b16 a[244:245], v9 offset:13312
    v_mov_b32 v22, s56
    v_mfma_f32_16x16x32_bf16 v[116:119], a[228:231], a[24:27], v[116:119]
    buffer_load_dwordx4 a[56:59], v15, s[20:23], s46 offen sc1
    v_mfma_f32_16x16x32_bf16 v[116:119], a[224:227], a[8:11], v[116:119]
    ds_read_b64_tr_b16 a[246:247], v9 offset:19456
    v_mfma_f32_16x16x32_bf16 v[108:111], a[224:227], a[4:7], v[108:111]
    v_permlane32_swap_b32 v21, v23
    v_mfma_f32_16x16x32_bf16 v[108:111], a[228:231], a[20:23], v[108:111]
    s_waitcnt lgkmcnt(4)
    v_max3_u32 v21, v24, v21, v23
    v_mov_b32 v23, 147456
    v_mfma_f32_16x16x32_bf16 v[100:103], a[228:231], a[16:19], v[100:103]
    ds_write_b64 v22, v[20:21]
    v_mfma_f32_16x16x32_bf16 v[100:103], a[224:227], a[0:3], v[100:103]
    ds_read_b64_tr_b16 a[224:225], v10 offset:1024
    v_mfma_f32_16x16x32_bf16 v[128:131], a[232:235], a[0:3], v[128:131]
    buffer_load_dwordx4 a[60:63], v15, s[20:23], s77 offen sc1
    v_mfma_f32_16x16x32_bf16 v[128:131], a[236:239], a[16:19], v[128:131]
    s_addk_i32 m0, 19712
    ds_read_b64_tr_b16 a[226:227], v10 offset:7168
    v_mfma_f32_16x16x32_bf16 v[136:139], a[236:239], a[20:23], v[136:139]
    ds_read_b64_tr_b16 a[228:229], v10 offset:13312
    v_mfma_f32_16x16x32_bf16 v[136:139], a[232:235], a[4:7], v[136:139]
    ds_read_b64_tr_b16 a[230:231], v10 offset:19456
    v_mfma_f32_16x16x32_bf16 v[144:147], a[232:235], a[8:11], v[144:147]
    v_mfma_f32_16x16x32_bf16 v[144:147], a[236:239], a[24:27], v[144:147]
    s_waitcnt lgkmcnt(4)
    v_mfma_f32_16x16x32_bf16 v[152:155], a[236:239], a[28:31], v[152:155]
    buffer_load_dwordx4 v2, s[8:11], s36 offen offset:0 lds
    v_mfma_f32_16x16x32_bf16 v[152:155], a[232:235], a[12:15], v[152:155]
    s_addk_i32 m0, 896
    ds_read_b64_tr_b16 a[232:233], v11 offset:1024
    v_mfma_f32_16x16x32_bf16 v[156:159], a[240:243], a[12:15], v[156:159]
    ds_read_b64_tr_b16 a[234:235], v11 offset:7168
    v_mfma_f32_16x16x32_bf16 v[156:159], a[244:247], a[28:31], v[156:159]
    ds_read_b64_tr_b16 a[236:237], v11 offset:13312
    v_mfma_f32_16x16x32_bf16 v[148:151], a[244:247], a[24:27], v[148:151]
    ds_read_b64_tr_b16 a[238:239], v11 offset:19456
    v_mfma_f32_16x16x32_bf16 v[148:151], a[240:243], a[8:11], v[148:151]
    v_mfma_f32_16x16x32_bf16 v[140:143], a[240:243], a[4:7], v[140:143]
    buffer_load_dwordx4 v2, s[8:11], s36 offen offset:128 lds
    v_mfma_f32_16x16x32_bf16 v[140:143], a[244:247], a[20:23], v[140:143]
    s_waitcnt lgkmcnt(4)
    s_addk_i32 m0, 896
    v_mfma_f32_16x16x32_bf16 v[132:135], a[244:247], a[16:19], v[132:135]
    v_mfma_f32_16x16x32_bf16 v[132:135], a[240:243], a[0:3], v[132:135]
    ds_read_b64_tr_b16 a[240:241], v8 offset:2048
    v_mfma_f32_16x16x32_bf16 v[160:163], a[224:227], a[0:3], v[160:163]
    ds_read_b64_tr_b16 a[242:243], v8 offset:8192
    v_mfma_f32_16x16x32_bf16 v[160:163], a[228:231], a[16:19], v[160:163]
    ds_read_b64_tr_b16 a[244:245], v8 offset:14336
    v_mfma_f32_16x16x32_bf16 v[168:171], a[228:231], a[20:23], v[168:171]
    buffer_load_dwordx4 v2, s[8:11], s36 offen offset:256 lds
    v_mfma_f32_16x16x32_bf16 v[168:171], a[224:227], a[4:7], v[168:171]
    s_addk_i32 m0, 1280
    ds_read_b64_tr_b16 a[246:247], v8 offset:20480
    v_mfma_f32_16x16x32_bf16 v[176:179], a[224:227], a[8:11], v[176:179]
    v_mfma_f32_16x16x32_bf16 v[176:179], a[228:231], a[24:27], v[176:179]
    s_waitcnt lgkmcnt(4)
    v_mfma_f32_16x16x32_bf16 v[184:187], a[228:231], a[28:31], v[184:187]
    v_mfma_f32_16x16x32_bf16 v[184:187], a[224:227], a[12:15], v[184:187]
    ds_read_b64_tr_b16 a[224:225], v9 offset:2048
    v_mfma_f32_16x16x32_bf16 v[188:191], a[232:235], a[12:15], v[188:191]
    buffer_load_dwordx4 v3, s[8:11], s36 offen offset:0 lds
    v_mfma_f32_16x16x32_bf16 v[188:191], a[236:239], a[28:31], v[188:191]
    s_addk_i32 m0, 896
    ds_read_b64_tr_b16 a[226:227], v9 offset:8192
    v_mfma_f32_16x16x32_bf16 v[180:183], a[236:239], a[24:27], v[180:183]
    ds_read_b64_tr_b16 a[228:229], v9 offset:14336
    v_mfma_f32_16x16x32_bf16 v[180:183], a[232:235], a[8:11], v[180:183]
    ds_read_b64_tr_b16 a[230:231], v9 offset:20480
    v_mfma_f32_16x16x32_bf16 v[172:175], a[232:235], a[4:7], v[172:175]
    v_mfma_f32_16x16x32_bf16 v[172:175], a[236:239], a[20:23], v[172:175]
    s_waitcnt lgkmcnt(4)
    v_mfma_f32_16x16x32_bf16 v[164:167], a[236:239], a[16:19], v[164:167]
    buffer_load_dwordx4 v3, s[8:11], s36 offen offset:128 lds
    v_mfma_f32_16x16x32_bf16 v[164:167], a[232:235], a[0:3], v[164:167]
    s_addk_i32 m0, 896
    ds_read_b64_tr_b16 a[232:233], v10 offset:2048
    v_mfma_f32_16x16x32_bf16 v[192:195], a[240:243], a[0:3], v[192:195]
    ds_read_b64_tr_b16 a[234:235], v10 offset:8192
    v_mfma_f32_16x16x32_bf16 v[192:195], a[244:247], a[16:19], v[192:195]
    ds_read_b64_tr_b16 a[236:237], v10 offset:14336
    v_mfma_f32_16x16x32_bf16 v[200:203], a[244:247], a[20:23], v[200:203]
    ds_read_b64_tr_b16 a[238:239], v10 offset:20480
    v_mfma_f32_16x16x32_bf16 v[200:203], a[240:243], a[4:7], v[200:203]
    v_mfma_f32_16x16x32_bf16 v[208:211], a[240:243], a[8:11], v[208:211]
    buffer_load_dwordx4 v3, s[8:11], s36 offen offset:256 lds
    v_mfma_f32_16x16x32_bf16 v[208:211], a[244:247], a[24:27], v[208:211]
    s_waitcnt lgkmcnt(4)
    s_add_u32 s36, s36, s37
    s_sub_u32 s55, s36, 7864320
    v_mfma_f32_16x16x32_bf16 v[216:219], a[244:247], a[28:31], v[216:219]
    s_min_u32 s36, s36, s55
    s_add_u32 s46, s45, 49152
    s_sub_u32 s77, s46, 81920
    v_mfma_f32_16x16x32_bf16 v[216:219], a[240:243], a[12:15], v[216:219]
    s_min_u32 s46, s46, s77
    ds_read_b64_tr_b16 a[240:241], v11 offset:2048
    s_xor_b32 s77, s46, 1024
    ds_read_b64_tr_b16 a[242:243], v11 offset:8192
    v_mfma_f32_16x16x32_bf16 v[220:223], a[224:227], a[12:15], v[220:223]
    ds_read_b64_tr_b16 a[244:245], v11 offset:14336
    ds_read_b64_tr_b16 a[246:247], v11 offset:20480
    v_mfma_f32_16x16x32_bf16 v[220:223], a[228:231], a[28:31], v[220:223]
    v_mfma_f32_16x16x32_bf16 v[212:215], a[228:231], a[24:27], v[212:215]
    buffer_load_dwordx4 a[64:67], v14, s[20:23], s46 offen sc1
    v_mfma_f32_16x16x32_bf16 v[212:215], a[224:227], a[8:11], v[212:215]
    v_mfma_f32_16x16x32_bf16 v[204:207], a[224:227], a[4:7], v[204:207]
    v_mfma_f32_16x16x32_bf16 v[204:207], a[228:231], a[20:23], v[204:207]
    s_waitcnt lgkmcnt(4)
    v_mfma_f32_16x16x32_bf16 v[196:199], a[228:231], a[16:19], v[196:199]
    s_waitcnt lgkmcnt(0)
    s_barrier
    v_mfma_f32_16x16x32_bf16 v[196:199], a[224:227], a[0:3], v[196:199]
    ds_read_b128 v[32:35], v23 offset:0
    v_mfma_f32_16x16x32_bf16 v[224:227], a[232:235], a[0:3], v[224:227]
    buffer_load_dwordx4 a[68:71], v14, s[20:23], s77 offen sc1
    v_mfma_f32_16x16x32_bf16 v[224:227], a[236:239], a[16:19], v[224:227]
    ds_read_b128 v[36:39], v23 offset:16
    v_and_b32 v22, 1, v1
    v_mfma_f32_16x16x32_bf16 v[232:235], a[236:239], a[20:23], v[232:235]
    ds_read_b64_tr_b16 a[224:225], v8 offset:24576
    v_cmp_eq_u32 vcc, 1, v22
    v_mfma_f32_16x16x32_bf16 v[232:235], a[232:235], a[4:7], v[232:235]
    ds_read_b64_tr_b16 a[226:227], v8 offset:30720
    v_lshrrev_b32 v24, 4, v1
    v_mfma_f32_16x16x32_bf16 v[240:243], a[232:235], a[8:11], v[240:243]
    ds_read_b64_tr_b16 a[228:229], v8 offset:36864
    v_bfe_u32 v26, v1, 2, 3
    v_mfma_f32_16x16x32_bf16 v[240:243], a[236:239], a[24:27], v[240:243]
    ds_read_b64_tr_b16 a[230:231], v8 offset:43008
    v_lshlrev_b32 v25, 7, v26
    v_mfma_f32_16x16x32_bf16 v[248:251], a[236:239], a[28:31], v[248:251]
    buffer_load_dwordx4 a[72:75], v15, s[20:23], s46 offen sc1
    v_mfma_f32_16x16x32_bf16 v[248:251], a[232:235], a[12:15], v[248:251]
    s_waitcnt lgkmcnt(5)
    ds_read_b64_tr_b16 a[232:233], v9 offset:24576
    v_max_u32 v20, v32, v33
    v_mfma_f32_16x16x32_bf16 v[252:255], a[240:243], a[12:15], v[252:255]
    ds_read_b64_tr_b16 a[234:235], v9 offset:30720
    v_min_u32 v21, v32, v33
    v_mfma_f32_16x16x32_bf16 v[252:255], a[244:247], a[28:31], v[252:255]
    ds_read_b64_tr_b16 a[236:237], v9 offset:36864
    v_med3_u32 v21, v20, v21, v34
    v_mfma_f32_16x16x32_bf16 v[244:247], a[244:247], a[24:27], v[244:247]
    ds_read_b64_tr_b16 a[238:239], v9 offset:43008
    v_max_u32 v20, v20, v34
    v_mfma_f32_16x16x32_bf16 v[244:247], a[240:243], a[8:11], v[244:247]
    v_med3_u32 v21, v20, v21, v35
    v_max_u32 v20, v20, v35
    v_mfma_f32_16x16x32_bf16 v[236:239], a[240:243], a[4:7], v[236:239]
    buffer_load_dwordx4 a[76:79], v15, s[20:23], s77 offen sc1
    v_mfma_f32_16x16x32_bf16 v[236:239], a[244:247], a[20:23], v[236:239]
    s_waitcnt vmcnt(17) lgkmcnt(4)
    v_med3_u32 v21, v20, v21, v36
    v_max_u32 v20, v20, v36
    v_mfma_f32_16x16x32_bf16 v[228:231], a[244:247], a[16:19], v[228:231]
    s_waitcnt vmcnt(13)
    v_med3_u32 v21, v20, v21, v37
    v_max_u32 v20, v20, v37
    v_mfma_f32_16x16x32_bf16 v[228:231], a[240:243], a[0:3], v[228:231]
    s_waitcnt vmcnt(12)
    ds_read_b64_tr_b16 a[240:241], v10 offset:24576
    v_med3_u32 v21, v20, v21, v38
    v_mfma_f32_16x16x32_bf16 v[64:67], a[224:227], a[32:35], v[64:67]
    s_add_u32 s46, s45, 53248
    ds_read_b64_tr_b16 a[242:243], v10 offset:30720
    v_max_u32 v20, v20, v38
    v_mfma_f32_16x16x32_bf16 v[64:67], a[228:231], a[48:51], v[64:67]
    s_sub_u32 s77, s46, 81920
    ds_read_b64_tr_b16 a[244:245], v10 offset:36864
    v_med3_u32 v21, v20, v21, v39
    v_mfma_f32_16x16x32_bf16 v[72:75], a[228:231], a[52:55], v[72:75]
    s_waitcnt vmcnt(11)
    ds_read_b64_tr_b16 a[246:247], v10 offset:43008
    v_max_u32 v20, v20, v39
    v_mfma_f32_16x16x32_bf16 v[72:75], a[224:227], a[36:39], v[72:75]
    s_waitcnt vmcnt(10)
    v_readfirstlane_b32 s70, v20
    v_readfirstlane_b32 s71, v21
    v_mfma_f32_16x16x32_bf16 v[80:83], a[224:227], a[40:43], v[80:83]
    s_min_u32 s46, s46, s77
    v_cndmask_b32 v22, v20, v21, vcc
    v_and_b32 v22, 0x7ff, v22
    v_mfma_f32_16x16x32_bf16 v[80:83], a[228:231], a[56:59], v[80:83]
    buffer_load_dwordx4 a[80:83], v14, s[20:23], s46 offen sc1
    v_mfma_f32_16x16x32_bf16 v[88:91], a[228:231], a[60:63], v[88:91]
    s_waitcnt lgkmcnt(3)
    v_sub_u32 v22, 2047, v22
    v_mul_u32_u24 v23, 1280, v22
    v_mfma_f32_16x16x32_bf16 v[88:91], a[224:227], a[44:47], v[88:91]
    s_xor_b32 s77, s46, 1024
    ds_read_b64_tr_b16 a[224:225], v11 offset:24576
    v_lshl_add_u32 v23, v24, 4, v23
    v_mfma_f32_16x16x32_bf16 v[92:95], a[232:235], a[44:47], v[92:95]
    buffer_load_dwordx4 a[84:87], v14, s[20:23], s77 offen sc1
    v_mfma_f32_16x16x32_bf16 v[92:95], a[236:239], a[60:63], v[92:95]
    ds_read_b64_tr_b16 a[226:227], v11 offset:30720
    v_add_u32 v23, s61, v23
    v_mfma_f32_16x16x32_bf16 v[84:87], a[236:239], a[56:59], v[84:87]
    ds_read_b64_tr_b16 a[228:229], v11 offset:36864
    v_lshlrev_b32 v24, 3, v22
    v_mfma_f32_16x16x32_bf16 v[84:87], a[232:235], a[40:43], v[84:87]
    ds_read_b64_tr_b16 a[230:231], v11 offset:43008
    v_add_u32 v24, 3211264, v24
    v_mfma_f32_16x16x32_bf16 v[76:79], a[232:235], a[36:39], v[76:79]
    v_lshrrev_b32 v26, 1, v26
    v_xor_b32 v26, s3, v26
    v_mfma_f32_16x16x32_bf16 v[76:79], a[236:239], a[52:55], v[76:79]
    s_waitcnt lgkmcnt(4)
    v_lshl_add_u32 v25, v26, 5, v25
    v_and_b32 v26, 3, v1
    v_mfma_f32_16x16x32_bf16 v[68:71], a[236:239], a[48:51], v[68:71]
    buffer_load_dwordx4 a[88:91], v15, s[20:23], s46 offen sc1
    v_mfma_f32_16x16x32_bf16 v[68:71], a[232:235], a[32:35], v[68:71]
    ds_read_b64_tr_b16 a[232:233], v8 offset:25600
    v_lshl_add_u32 v25, v26, 3, v25
    v_mfma_f32_16x16x32_bf16 v[96:99], a[240:243], a[32:35], v[96:99]
    ds_read_b64_tr_b16 a[234:235], v8 offset:31744
    v_lshrrev_b32 v26, 5, v1
    v_mfma_f32_16x16x32_bf16 v[96:99], a[244:247], a[48:51], v[96:99]
    ds_read_b64_tr_b16 a[236:237], v8 offset:37888
    v_mul_u32_u24 v26, 2048, v26
    v_mfma_f32_16x16x32_bf16 v[104:107], a[244:247], a[52:55], v[104:107]
    ds_read_b64_tr_b16 a[238:239], v8 offset:44032
    v_add_u32 v25, v25, v26
    v_mfma_f32_16x16x32_bf16 v[104:107], a[240:243], a[36:39], v[104:107]
    v_add_u32 v25, 147456, v25
    v_lshlrev_b32 v26, 4, v1
    v_mfma_f32_16x16x32_bf16 v[112:115], a[240:243], a[40:43], v[112:115]
    buffer_load_dwordx4 a[92:95], v15, s[20:23], s77 offen sc1
    v_mfma_f32_16x16x32_bf16 v[112:115], a[244:247], a[56:59], v[112:115]
    s_waitcnt lgkmcnt(4)
    v_cmp_gt_u32 vcc, 16, v1
    v_mov_b32 v27, 0x7ffffff0
    v_mfma_f32_16x16x32_bf16 v[120:123], a[244:247], a[60:63], v[120:123]
    s_addk_i32 m0, 19712
    v_cndmask_b32 v26, v27, v26, vcc
    v_mfma_f32_16x16x32_bf16 v[120:123], a[240:243], a[44:47], v[120:123]
    ds_read_b64_tr_b16 a[240:241], v9 offset:25600
    v_mfma_f32_16x16x32_bf16 v[124:127], a[224:227], a[44:47], v[124:127]
    ds_read_b64_tr_b16 a[242:243], v9 offset:31744
    v_mfma_f32_16x16x32_bf16 v[124:127], a[228:231], a[60:63], v[124:127]
    ds_read_b64_tr_b16 a[244:245], v9 offset:37888
    v_mfma_f32_16x16x32_bf16 v[116:119], a[228:231], a[56:59], v[116:119]
    buffer_load_dwordx4 v2, s[8:11], s36 offen offset:0 lds
    v_mfma_f32_16x16x32_bf16 v[116:119], a[224:227], a[40:43], v[116:119]
    s_addk_i32 m0, 896
    ds_read_b64_tr_b16 a[246:247], v9 offset:44032
    v_mfma_f32_16x16x32_bf16 v[108:111], a[224:227], a[36:39], v[108:111]
    v_min_u32 v27, 1, v1
    v_mfma_f32_16x16x32_bf16 v[108:111], a[228:231], a[52:55], v[108:111]
    s_waitcnt lgkmcnt(4)
    v_lshlrev_b32 v27, 30, v27
    v_mfma_f32_16x16x32_bf16 v[100:103], a[228:231], a[48:51], v[100:103]
    v_mfma_f32_16x16x32_bf16 v[100:103], a[224:227], a[32:35], v[100:103]
    ds_read_b64_tr_b16 a[224:225], v10 offset:25600
    v_mfma_f32_16x16x32_bf16 v[128:131], a[232:235], a[32:35], v[128:131]
    buffer_load_dwordx4 v2, s[8:11], s36 offen offset:128 lds
    v_mfma_f32_16x16x32_bf16 v[128:131], a[236:239], a[48:51], v[128:131]
    s_addk_i32 m0, 896
    ds_read_b64_tr_b16 a[226:227], v10 offset:31744
    v_mfma_f32_16x16x32_bf16 v[136:139], a[236:239], a[52:55], v[136:139]
    ds_read_b64_tr_b16 a[228:229], v10 offset:37888
    v_mfma_f32_16x16x32_bf16 v[136:139], a[232:235], a[36:39], v[136:139]
    ds_read_b64_tr_b16 a[230:231], v10 offset:44032
    v_mfma_f32_16x16x32_bf16 v[144:147], a[232:235], a[40:43], v[144:147]
    v_mfma_f32_16x16x32_bf16 v[144:147], a[236:239], a[56:59], v[144:147]
    s_waitcnt lgkmcnt(4)
    v_mfma_f32_16x16x32_bf16 v[152:155], a[236:239], a[60:63], v[152:155]
    buffer_load_dwordx4 v2, s[8:11], s36 offen offset:256 lds
    v_mfma_f32_16x16x32_bf16 v[152:155], a[232:235], a[44:47], v[152:155]
    s_addk_i32 m0, 1280
    ds_read_b64_tr_b16 a[232:233], v11 offset:25600
    v_mfma_f32_16x16x32_bf16 v[156:159], a[240:243], a[44:47], v[156:159]
    ds_read_b64_tr_b16 a[234:235], v11 offset:31744
    v_mfma_f32_16x16x32_bf16 v[156:159], a[244:247], a[60:63], v[156:159]
    ds_read_b64_tr_b16 a[236:237], v11 offset:37888
    v_mfma_f32_16x16x32_bf16 v[148:151], a[244:247], a[56:59], v[148:151]
    ds_read_b64_tr_b16 a[238:239], v11 offset:44032
    v_mfma_f32_16x16x32_bf16 v[148:151], a[240:243], a[40:43], v[148:151]
    v_mfma_f32_16x16x32_bf16 v[140:143], a[240:243], a[36:39], v[140:143]
    buffer_load_dwordx4 v3, s[8:11], s36 offen offset:0 lds
    v_mfma_f32_16x16x32_bf16 v[140:143], a[244:247], a[52:55], v[140:143]
    s_waitcnt lgkmcnt(4)
    s_addk_i32 m0, 896
    v_mfma_f32_16x16x32_bf16 v[132:135], a[244:247], a[48:51], v[132:135]
    v_mfma_f32_16x16x32_bf16 v[132:135], a[240:243], a[32:35], v[132:135]
    ds_read_b64_tr_b16 a[240:241], v8 offset:26624
    v_mfma_f32_16x16x32_bf16 v[160:163], a[224:227], a[32:35], v[160:163]
    ds_read_b64_tr_b16 a[242:243], v8 offset:32768
    v_mfma_f32_16x16x32_bf16 v[160:163], a[228:231], a[48:51], v[160:163]
    ds_read_b64_tr_b16 a[244:245], v8 offset:38912
    v_mfma_f32_16x16x32_bf16 v[168:171], a[228:231], a[52:55], v[168:171]
    global_load_dwordx4 v[48:51], v23, s[64:65]
    v_mfma_f32_16x16x32_bf16 v[168:171], a[224:227], a[36:39], v[168:171]
    global_load_dwordx4 v[52:55], v23, s[64:65] offset:64
    v_mfma_f32_16x16x32_bf16 v[176:179], a[224:227], a[40:43], v[176:179]
    buffer_load_dwordx2 v[40:41], v24, s[24:27], 0 offen sc1
    v_mfma_f32_16x16x32_bf16 v[176:179], a[228:231], a[56:59], v[176:179]
    buffer_load_dwordx4 v3, s[8:11], s36 offen offset:128 lds
    v_mfma_f32_16x16x32_bf16 v[184:187], a[228:231], a[60:63], v[184:187]
    s_waitcnt lgkmcnt(2)
    ds_read_b64_tr_b16 a[246:247], v8 offset:45056
    s_addk_i32 m0, 896
    v_mfma_f32_16x16x32_bf16 v[184:187], a[224:227], a[44:47], v[184:187]
    ds_read_b64_tr_b16 a[224:225], v9 offset:26624
    v_mfma_f32_16x16x32_bf16 v[188:191], a[232:235], a[44:47], v[188:191]
    buffer_load_dwordx4 v3, s[8:11], s36 offen offset:256 lds
    v_mfma_f32_16x16x32_bf16 v[188:191], a[236:239], a[60:63], v[188:191]
    s_add_u32 s36, s36, s37
    ds_read_b64_tr_b16 a[226:227], v9 offset:32768
    s_sub_u32 s55, s36, 7864320
    v_mfma_f32_16x16x32_bf16 v[180:183], a[236:239], a[56:59], v[180:183]
    s_min_u32 s36, s36, s55
    ds_read_b64_tr_b16 a[228:229], v9 offset:38912
    s_add_u32 s46, s45, 57344
    v_mfma_f32_16x16x32_bf16 v[180:183], a[232:235], a[40:43], v[180:183]
    s_sub_u32 s77, s46, 81920
    ds_read_b64_tr_b16 a[230:231], v9 offset:45056
    s_min_u32 s46, s46, s77
    v_mfma_f32_16x16x32_bf16 v[172:175], a[232:235], a[36:39], v[172:175]
    s_xor_b32 s77, s46, 1024
    v_add_u32 v8, 49152, v8
    v_mfma_f32_16x16x32_bf16 v[172:175], a[236:239], a[52:55], v[172:175]
    s_waitcnt lgkmcnt(4)
    v_add_u32 v9, 49152, v9
    v_mfma_f32_16x16x32_bf16 v[164:167], a[236:239], a[48:51], v[164:167]
    buffer_load_dwordx4 a[160:163], v14, s[20:23], s46 offen sc1
    v_mfma_f32_16x16x32_bf16 v[164:167], a[232:235], a[32:35], v[164:167]
    ds_read_b64_tr_b16 a[232:233], v10 offset:26624
    v_mfma_f32_16x16x32_bf16 v[192:195], a[240:243], a[32:35], v[192:195]
    ds_read_b64_tr_b16 a[234:235], v10 offset:32768
    v_mfma_f32_16x16x32_bf16 v[192:195], a[244:247], a[48:51], v[192:195]
    ds_read_b64_tr_b16 a[236:237], v10 offset:38912
    v_mfma_f32_16x16x32_bf16 v[200:203], a[244:247], a[52:55], v[200:203]
    ds_read_b64_tr_b16 a[238:239], v10 offset:45056
    v_mfma_f32_16x16x32_bf16 v[200:203], a[240:243], a[36:39], v[200:203]
    v_add_u32 v10, 49152, v10
    v_mfma_f32_16x16x32_bf16 v[208:211], a[240:243], a[40:43], v[208:211]
    buffer_load_dwordx4 a[164:167], v14, s[20:23], s77 offen sc1
    v_mfma_f32_16x16x32_bf16 v[208:211], a[244:247], a[56:59], v[208:211]
    s_waitcnt lgkmcnt(4)
    v_mfma_f32_16x16x32_bf16 v[216:219], a[244:247], a[60:63], v[216:219]
    v_mfma_f32_16x16x32_bf16 v[216:219], a[240:243], a[44:47], v[216:219]
    ds_read_b64_tr_b16 a[240:241], v11 offset:26624
    ds_read_b64_tr_b16 a[242:243], v11 offset:32768
    ds_read_b64_tr_b16 a[244:245], v11 offset:38912
    v_mfma_f32_16x16x32_bf16 v[220:223], a[224:227], a[44:47], v[220:223]
    ds_read_b64_tr_b16 a[246:247], v11 offset:45056
    v_mfma_f32_16x16x32_bf16 v[220:223], a[228:231], a[60:63], v[220:223]
    v_add_u32 v11, 49152, v11
    v_mfma_f32_16x16x32_bf16 v[212:215], a[228:231], a[56:59], v[212:215]
    buffer_load_dwordx4 a[168:171], v15, s[20:23], s46 offen sc1
    v_mfma_f32_16x16x32_bf16 v[212:215], a[224:227], a[40:43], v[212:215]
    v_mfma_f32_16x16x32_bf16 v[204:207], a[224:227], a[36:39], v[204:207]
    v_mfma_f32_16x16x32_bf16 v[204:207], a[228:231], a[52:55], v[204:207]
    s_waitcnt lgkmcnt(4)
    v_mfma_f32_16x16x32_bf16 v[196:199], a[228:231], a[48:51], v[196:199]
    s_waitcnt lgkmcnt(0)
    s_barrier
    v_mfma_f32_16x16x32_bf16 v[196:199], a[224:227], a[32:35], v[196:199]
    ds_read_b64_tr_b16 a[224:225], v8 offset:0
    v_mfma_f32_16x16x32_bf16 v[224:227], a[232:235], a[32:35], v[224:227]
    buffer_load_dwordx4 a[172:175], v15, s[20:23], s77 offen sc1
    v_mfma_f32_16x16x32_bf16 v[224:227], a[236:239], a[48:51], v[224:227]
    s_add_u32 m0, s44, 147456
    ds_read_b64_tr_b16 a[226:227], v8 offset:6144
    v_mfma_f32_16x16x32_bf16 v[232:235], a[236:239], a[52:55], v[232:235]
    ds_read_b64_tr_b16 a[228:229], v8 offset:12288
    v_mfma_f32_16x16x32_bf16 v[232:235], a[232:235], a[36:39], v[232:235]
    ds_read_b64_tr_b16 a[230:231], v8 offset:18432
    v_mfma_f32_16x16x32_bf16 v[240:243], a[232:235], a[40:43], v[240:243]
    v_mfma_f32_16x16x32_bf16 v[240:243], a[236:239], a[56:59], v[240:243]
    v_mfma_f32_16x16x32_bf16 v[248:251], a[236:239], a[60:63], v[248:251]
    buffer_load_dwordx4 v56, s[28:31], s60 offen lds
    v_mfma_f32_16x16x32_bf16 v[248:251], a[232:235], a[44:47], v[248:251]
    s_addk_i32 m0, 1024
    ds_read_b64_tr_b16 a[232:233], v9 offset:0
    v_mfma_f32_16x16x32_bf16 v[252:255], a[240:243], a[44:47], v[252:255]
    ds_read_b64_tr_b16 a[234:235], v9 offset:6144
    v_mfma_f32_16x16x32_bf16 v[252:255], a[244:247], a[60:63], v[252:255]
    ds_read_b64_tr_b16 a[236:237], v9 offset:12288
    v_mfma_f32_16x16x32_bf16 v[244:247], a[244:247], a[56:59], v[244:247]
    ds_read_b64_tr_b16 a[238:239], v9 offset:18432
    v_mfma_f32_16x16x32_bf16 v[244:247], a[240:243], a[40:43], v[244:247]
    v_mfma_f32_16x16x32_bf16 v[236:239], a[240:243], a[36:39], v[236:239]
    buffer_load_dwordx4 v56, s[32:35], s60 offen lds
    v_mfma_f32_16x16x32_bf16 v[236:239], a[244:247], a[52:55], v[236:239]
    s_waitcnt vmcnt(22) lgkmcnt(4)
    s_addk_i32 m0, 1024
    v_mfma_f32_16x16x32_bf16 v[228:231], a[244:247], a[48:51], v[228:231]
    s_waitcnt vmcnt(18)
    v_mfma_f32_16x16x32_bf16 v[228:231], a[240:243], a[32:35], v[228:231]
    s_waitcnt vmcnt(17)
    ds_read_b64_tr_b16 a[240:241], v10 offset:0
    v_mfma_f32_16x16x32_bf16 v[64:67], a[224:227], a[64:67], v[64:67]
    ds_read_b64_tr_b16 a[242:243], v10 offset:6144
    v_mfma_f32_16x16x32_bf16 v[64:67], a[228:231], a[80:83], v[64:67]
    ds_read_b64_tr_b16 a[244:245], v10 offset:12288
    v_mfma_f32_16x16x32_bf16 v[72:75], a[228:231], a[84:87], v[72:75]
    buffer_load_dwordx4 v57, s[28:31], s60 offen lds
    v_mfma_f32_16x16x32_bf16 v[72:75], a[224:227], a[68:71], v[72:75]
    s_waitcnt vmcnt(16)
    ds_read_b64_tr_b16 a[246:247], v10 offset:18432
    s_addk_i32 m0, 1024
    v_mfma_f32_16x16x32_bf16 v[80:83], a[224:227], a[72:75], v[80:83]
    v_mfma_f32_16x16x32_bf16 v[80:83], a[228:231], a[88:91], v[80:83]
    s_waitcnt lgkmcnt(4)
    v_mfma_f32_16x16x32_bf16 v[88:91], a[228:231], a[92:95], v[88:91]
    v_mfma_f32_16x16x32_bf16 v[88:91], a[224:227], a[76:79], v[88:91]
    ds_read_b64_tr_b16 a[224:225], v11 offset:0
    v_mfma_f32_16x16x32_bf16 v[92:95], a[232:235], a[76:79], v[92:95]
    buffer_load_dwordx4 v57, s[32:35], s60 offen lds
    v_mfma_f32_16x16x32_bf16 v[92:95], a[236:239], a[92:95], v[92:95]
    s_add_u32 s46, s45, 61440
    ds_read_b64_tr_b16 a[226:227], v11 offset:6144
    s_sub_u32 s77, s46, 81920
    v_mfma_f32_16x16x32_bf16 v[84:87], a[236:239], a[88:91], v[84:87]
    s_min_u32 s46, s46, s77
    ds_read_b64_tr_b16 a[228:229], v11 offset:12288
    s_xor_b32 s77, s46, 1024
    v_mfma_f32_16x16x32_bf16 v[84:87], a[232:235], a[72:75], v[84:87]
    ds_read_b64_tr_b16 a[230:231], v11 offset:18432
    v_mfma_f32_16x16x32_bf16 v[76:79], a[232:235], a[68:71], v[76:79]
    v_mfma_f32_16x16x32_bf16 v[76:79], a[236:239], a[84:87], v[76:79]
    s_waitcnt lgkmcnt(4)
    v_mfma_f32_16x16x32_bf16 v[68:71], a[236:239], a[80:83], v[68:71]
    buffer_load_dwordx4 a[176:179], v14, s[20:23], s46 offen sc1
    v_mfma_f32_16x16x32_bf16 v[68:71], a[232:235], a[64:67], v[68:71]
    ds_read_b64_tr_b16 a[232:233], v8 offset:1024
    v_mfma_f32_16x16x32_bf16 v[96:99], a[240:243], a[64:67], v[96:99]
    ds_read_b64_tr_b16 a[234:235], v8 offset:7168
    v_mfma_f32_16x16x32_bf16 v[96:99], a[244:247], a[80:83], v[96:99]
    ds_read_b64_tr_b16 a[236:237], v8 offset:13312
    v_mfma_f32_16x16x32_bf16 v[104:107], a[244:247], a[84:87], v[104:107]
    ds_read_b64_tr_b16 a[238:239], v8 offset:19456
    v_mfma_f32_16x16x32_bf16 v[104:107], a[240:243], a[68:71], v[104:107]
    v_mfma_f32_16x16x32_bf16 v[112:115], a[240:243], a[72:75], v[112:115]
    buffer_load_dwordx4 a[180:183], v14, s[20:23], s77 offen sc1
    v_mfma_f32_16x16x32_bf16 v[112:115], a[244:247], a[88:91], v[112:115]
    s_waitcnt lgkmcnt(4)
    v_mfma_f32_16x16x32_bf16 v[120:123], a[244:247], a[92:95], v[120:123]
    s_add_u32 s88, s88, 32768
    s_addc_u32 s89, s89, 0
    v_mfma_f32_16x16x32_bf16 v[120:123], a[240:243], a[76:79], v[120:123]
    ds_read_b64_tr_b16 a[240:241], v9 offset:1024
    v_mfma_f32_16x16x32_bf16 v[124:127], a[224:227], a[76:79], v[124:127]
    global_load_dword a252, v18, s[88:89]
    v_mfma_f32_16x16x32_bf16 v[124:127], a[228:231], a[92:95], v[124:127]
    ds_read_b64_tr_b16 a[242:243], v9 offset:7168
    v_mfma_f32_16x16x32_bf16 v[116:119], a[228:231], a[88:91], v[116:119]
    buffer_load_dwordx4 a[184:187], v15, s[20:23], s46 offen sc1
    v_mfma_f32_16x16x32_bf16 v[116:119], a[224:227], a[72:75], v[116:119]
    ds_read_b64_tr_b16 a[244:245], v9 offset:13312
    v_mfma_f32_16x16x32_bf16 v[108:111], a[224:227], a[68:71], v[108:111]
    ds_read_b64_tr_b16 a[246:247], v9 offset:19456
    v_mfma_f32_16x16x32_bf16 v[108:111], a[228:231], a[84:87], v[108:111]
    s_waitcnt lgkmcnt(4)
    v_mfma_f32_16x16x32_bf16 v[100:103], a[228:231], a[80:83], v[100:103]
    v_mfma_f32_16x16x32_bf16 v[100:103], a[224:227], a[64:67], v[100:103]
    ds_read_b64_tr_b16 a[224:225], v10 offset:1024
    v_mfma_f32_16x16x32_bf16 v[128:131], a[232:235], a[64:67], v[128:131]
    buffer_load_dwordx4 a[188:191], v15, s[20:23], s77 offen sc1
    v_mfma_f32_16x16x32_bf16 v[128:131], a[236:239], a[80:83], v[128:131]
    s_add_u32 s46, s45, 65536
    ds_read_b64_tr_b16 a[226:227], v10 offset:7168
    s_sub_u32 s77, s46, 81920
    v_mfma_f32_16x16x32_bf16 v[136:139], a[236:239], a[84:87], v[136:139]
    s_min_u32 s46, s46, s77
    ds_read_b64_tr_b16 a[228:229], v10 offset:13312
    s_xor_b32 s77, s46, 1024
    v_mfma_f32_16x16x32_bf16 v[136:139], a[232:235], a[68:71], v[136:139]
    ds_read_b64_tr_b16 a[230:231], v10 offset:19456
    v_mfma_f32_16x16x32_bf16 v[144:147], a[232:235], a[72:75], v[144:147]
    v_mfma_f32_16x16x32_bf16 v[144:147], a[236:239], a[88:91], v[144:147]
    s_waitcnt lgkmcnt(4)
    v_mfma_f32_16x16x32_bf16 v[152:155], a[236:239], a[92:95], v[152:155]
    buffer_load_dwordx4 a[96:99], v14, s[20:23], s46 offen sc1
    v_mfma_f32_16x16x32_bf16 v[152:155], a[232:235], a[76:79], v[152:155]
    ds_read_b64_tr_b16 a[232:233], v11 offset:1024
    v_mfma_f32_16x16x32_bf16 v[156:159], a[240:243], a[76:79], v[156:159]
    ds_read_b64_tr_b16 a[234:235], v11 offset:7168
    v_mfma_f32_16x16x32_bf16 v[156:159], a[244:247], a[92:95], v[156:159]
    ds_read_b64_tr_b16 a[236:237], v11 offset:13312
    v_mfma_f32_16x16x32_bf16 v[148:151], a[244:247], a[88:91], v[148:151]
    ds_read_b64_tr_b16 a[238:239], v11 offset:19456
    v_mfma_f32_16x16x32_bf16 v[148:151], a[240:243], a[72:75], v[148:151]
    v_mfma_f32_16x16x32_bf16 v[140:143], a[240:243], a[68:71], v[140:143]
    buffer_load_dwordx4 a[100:103], v14, s[20:23], s77 offen sc1
    v_mfma_f32_16x16x32_bf16 v[140:143], a[244:247], a[84:87], v[140:143]
    s_waitcnt lgkmcnt(4)
    v_mfma_f32_16x16x32_bf16 v[132:135], a[244:247], a[80:83], v[132:135]
    v_mfma_f32_16x16x32_bf16 v[132:135], a[240:243], a[64:67], v[132:135]
    ds_read_b64_tr_b16 a[240:241], v8 offset:2048
    v_mfma_f32_16x16x32_bf16 v[160:163], a[224:227], a[64:67], v[160:163]
    ds_read_b64_tr_b16 a[242:243], v8 offset:8192
    v_mfma_f32_16x16x32_bf16 v[160:163], a[228:231], a[80:83], v[160:163]
    ds_read_b64_tr_b16 a[244:245], v8 offset:14336
    v_mfma_f32_16x16x32_bf16 v[168:171], a[228:231], a[84:87], v[168:171]
    buffer_load_dwordx4 a[104:107], v15, s[20:23], s46 offen sc1
    v_mfma_f32_16x16x32_bf16 v[168:171], a[224:227], a[68:71], v[168:171]
    ds_read_b64_tr_b16 a[246:247], v8 offset:20480
    v_mfma_f32_16x16x32_bf16 v[176:179], a[224:227], a[72:75], v[176:179]
    v_mfma_f32_16x16x32_bf16 v[176:179], a[228:231], a[88:91], v[176:179]
    s_waitcnt lgkmcnt(4)
    v_mfma_f32_16x16x32_bf16 v[184:187], a[228:231], a[92:95], v[184:187]
    s_waitcnt vmcnt(20)
    v_lshlrev_b32 v42, 16, v48
    v_and_b32 v43, 0xffff0000, v48
    v_mfma_f32_16x16x32_bf16 v[184:187], a[224:227], a[76:79], v[184:187]
    ds_read_b64_tr_b16 a[224:225], v9 offset:2048
    v_mfma_f32_16x16x32_bf16 v[188:191], a[232:235], a[76:79], v[188:191]
    buffer_load_dwordx4 a[108:111], v15, s[20:23], s77 offen sc1
    v_mfma_f32_16x16x32_bf16 v[188:191], a[236:239], a[92:95], v[188:191]
    s_add_u32 s46, s45, 69632
    ds_read_b64_tr_b16 a[226:227], v9 offset:8192
    s_sub_u32 s77, s46, 81920
    v_mfma_f32_16x16x32_bf16 v[180:183], a[236:239], a[88:91], v[180:183]
    s_min_u32 s46, s46, s77
    ds_read_b64_tr_b16 a[228:229], v9 offset:14336
    s_xor_b32 s77, s46, 1024
    v_mfma_f32_16x16x32_bf16 v[180:183], a[232:235], a[72:75], v[180:183]
    s_waitcnt vmcnt(19)
    ds_read_b64_tr_b16 a[230:231], v9 offset:20480
    v_sub_f32 v42, v42, v40
    v_mfma_f32_16x16x32_bf16 v[172:175], a[232:235], a[68:71], v[172:175]
    v_sub_f32 v43, v43, v40
    v_cvt_pk_bf16_f32 v42, 0, v42
    v_mfma_f32_16x16x32_bf16 v[172:175], a[236:239], a[84:87], v[172:175]
    s_waitcnt lgkmcnt(4)
    v_cvt_pk_bf16_f32 v43, 0, v43
    v_mul_f32 v42, v42, v41
    v_mfma_f32_16x16x32_bf16 v[164:167], a[236:239], a[80:83], v[164:167]
    buffer_load_dwordx4 a[112:115], v14, s[20:23], s46 offen sc1
    v_mfma_f32_16x16x32_bf16 v[164:167], a[232:235], a[64:67], v[164:167]
    ds_read_b64_tr_b16 a[232:233], v10 offset:2048
    v_mul_f32 v43, v43, v41
    v_mfma_f32_16x16x32_bf16 v[192:195], a[240:243], a[64:67], v[192:195]
    ds_read_b64_tr_b16 a[234:235], v10 offset:8192
    v_cvt_pk_bf16_f32 v48, v42, v43
    v_mfma_f32_16x16x32_bf16 v[192:195], a[244:247], a[80:83], v[192:195]
    ds_read_b64_tr_b16 a[236:237], v10 offset:14336
    v_lshlrev_b32 v42, 16, v49
    v_mfma_f32_16x16x32_bf16 v[200:203], a[244:247], a[84:87], v[200:203]
    ds_read_b64_tr_b16 a[238:239], v10 offset:20480
    v_and_b32 v43, 0xffff0000, v49
    v_mfma_f32_16x16x32_bf16 v[200:203], a[240:243], a[68:71], v[200:203]
    v_sub_f32 v42, v42, v40
    v_sub_f32 v43, v43, v40
    v_mfma_f32_16x16x32_bf16 v[208:211], a[240:243], a[72:75], v[208:211]
pg_3:
    s_cbranch_execz pg_5
    buffer_load_dwordx4 a[116:119], v14, s[20:23], s77 offen sc1
    v_mfma_f32_16x16x32_bf16 v[208:211], a[244:247], a[88:91], v[208:211]
    s_waitcnt lgkmcnt(4)
    v_cvt_pk_bf16_f32 v42, 0, v42
    v_cvt_pk_bf16_f32 v43, 0, v43
    v_mfma_f32_16x16x32_bf16 v[216:219], a[244:247], a[92:95], v[216:219]
    v_mul_f32 v42, v42, v41
    v_mul_f32 v43, v43, v41
    v_mfma_f32_16x16x32_bf16 v[216:219], a[240:243], a[76:79], v[216:219]
    ds_read_b64_tr_b16 a[240:241], v11 offset:2048
    v_cvt_pk_bf16_f32 v49, v42, v43
    ds_read_b64_tr_b16 a[242:243], v11 offset:8192
    v_mfma_f32_16x16x32_bf16 v[220:223], a[224:227], a[76:79], v[220:223]
    ds_read_b64_tr_b16 a[244:245], v11 offset:14336
    v_lshlrev_b32 v42, 16, v50
    ds_read_b64_tr_b16 a[246:247], v11 offset:20480
    v_mfma_f32_16x16x32_bf16 v[220:223], a[228:231], a[92:95], v[220:223]
    v_and_b32 v43, 0xffff0000, v50
    v_sub_f32 v42, v42, v40
    v_mfma_f32_16x16x32_bf16 v[212:215], a[228:231], a[88:91], v[212:215]
    buffer_load_dwordx4 a[120:123], v15, s[20:23], s46 offen sc1
    v_mfma_f32_16x16x32_bf16 v[212:215], a[224:227], a[72:75], v[212:215]
    v_sub_f32 v43, v43, v40
    v_cvt_pk_bf16_f32 v42, 0, v42
    v_mfma_f32_16x16x32_bf16 v[204:207], a[224:227], a[68:71], v[204:207]
    v_cvt_pk_bf16_f32 v43, 0, v43
    v_mul_f32 v42, v42, v41
    v_mfma_f32_16x16x32_bf16 v[204:207], a[228:231], a[84:87], v[204:207]
    s_waitcnt lgkmcnt(4)
    v_mul_f32 v43, v43, v41
    v_cvt_pk_bf16_f32 v50, v42, v43
    v_mfma_f32_16x16x32_bf16 v[196:199], a[228:231], a[80:83], v[196:199]
    s_waitcnt vmcnt(12) lgkmcnt(0)
    s_barrier
    v_mfma_f32_16x16x32_bf16 v[196:199], a[224:227], a[64:67], v[196:199]
    ds_read_b64_tr_b16 a[224:225], v8 offset:24576
    v_lshlrev_b32 v42, 16, v51
    v_mfma_f32_16x16x32_bf16 v[224:227], a[232:235], a[64:67], v[224:227]
    buffer_load_dwordx4 a[124:127], v15, s[20:23], s77 offen sc1
    v_mfma_f32_16x16x32_bf16 v[224:227], a[236:239], a[80:83], v[224:227]
    s_add_u32 s46, s45, 73728
    ds_read_b64_tr_b16 a[226:227], v8 offset:30720
    v_and_b32 v43, 0xffff0000, v51
    v_mfma_f32_16x16x32_bf16 v[232:235], a[236:239], a[84:87], v[232:235]
    s_sub_u32 s77, s46, 81920
    ds_read_b64_tr_b16 a[228:229], v8 offset:36864
    v_sub_f32 v42, v42, v40
    v_mfma_f32_16x16x32_bf16 v[232:235], a[232:235], a[68:71], v[232:235]
    s_min_u32 s46, s46, s77
    ds_read_b64_tr_b16 a[230:231], v8 offset:43008
    v_sub_f32 v43, v43, v40
    v_mfma_f32_16x16x32_bf16 v[240:243], a[232:235], a[72:75], v[240:243]
    s_xor_b32 s77, s46, 1024
    v_cvt_pk_bf16_f32 v42, 0, v42
    v_cvt_pk_bf16_f32 v43, 0, v43
    v_mfma_f32_16x16x32_bf16 v[240:243], a[236:239], a[88:91], v[240:243]
    v_mul_f32 v42, v42, v41
    v_mul_f32 v43, v43, v41
    v_mfma_f32_16x16x32_bf16 v[248:251], a[236:239], a[92:95], v[248:251]
    buffer_load_dwordx4 a[128:131], v14, s[20:23], s46 offen sc1
    v_mfma_f32_16x16x32_bf16 v[248:251], a[232:235], a[76:79], v[248:251]
    ds_read_b64_tr_b16 a[232:233], v9 offset:24576
    v_cvt_pk_bf16_f32 v51, v42, v43
    v_mfma_f32_16x16x32_bf16 v[252:255], a[240:243], a[76:79], v[252:255]
    ds_read_b64_tr_b16 a[234:235], v9 offset:30720
    v_lshlrev_b32 v42, 16, v52
    v_mfma_f32_16x16x32_bf16 v[252:255], a[244:247], a[92:95], v[252:255]
    ds_read_b64_tr_b16 a[236:237], v9 offset:36864
    v_and_b32 v43, 0xffff0000, v52
    v_mfma_f32_16x16x32_bf16 v[244:247], a[244:247], a[88:91], v[244:247]
    ds_read_b64_tr_b16 a[238:239], v9 offset:43008
    v_sub_f32 v42, v42, v40
    v_mfma_f32_16x16x32_bf16 v[244:247], a[240:243], a[72:75], v[244:247]
    v_sub_f32 v43, v43, v40
    v_cvt_pk_bf16_f32 v42, 0, v42
    v_mfma_f32_16x16x32_bf16 v[236:239], a[240:243], a[68:71], v[236:239]
    buffer_load_dwordx4 a[132:135], v14, s[20:23], s77 offen sc1
    v_mfma_f32_16x16x32_bf16 v[236:239], a[244:247], a[84:87], v[236:239]
    s_waitcnt lgkmcnt(4)
    v_cvt_pk_bf16_f32 v43, 0, v43
    v_mul_f32 v42, v42, v41
    v_mfma_f32_16x16x32_bf16 v[228:231], a[244:247], a[80:83], v[228:231]
    s_waitcnt vmcnt(14)
    v_mul_f32 v43, v43, v41
    v_cvt_pk_bf16_f32 v52, v42, v43
    v_mfma_f32_16x16x32_bf16 v[228:231], a[240:243], a[64:67], v[228:231]
    s_waitcnt vmcnt(13)
    ds_read_b64_tr_b16 a[240:241], v10 offset:24576
    v_lshlrev_b32 v42, 16, v53
    v_mfma_f32_16x16x32_bf16 v[64:67], a[224:227], a[160:163], v[64:67]
    ds_read_b64_tr_b16 a[242:243], v10 offset:30720
    v_and_b32 v43, 0xffff0000, v53
    v_mfma_f32_16x16x32_bf16 v[64:67], a[228:231], a[176:179], v[64:67]
    ds_read_b64_tr_b16 a[244:245], v10 offset:36864
    v_sub_f32 v42, v42, v40
    v_mfma_f32_16x16x32_bf16 v[72:75], a[228:231], a[180:183], v[72:75]
    buffer_load_dwordx4 a[136:139], v15, s[20:23], s46 offen sc1
    v_mfma_f32_16x16x32_bf16 v[72:75], a[224:227], a[164:167], v[72:75]
    s_waitcnt vmcnt(11)
    ds_read_b64_tr_b16 a[246:247], v10 offset:43008
    v_sub_f32 v43, v43, v40
    v_mfma_f32_16x16x32_bf16 v[80:83], a[224:227], a[168:171], v[80:83]
    v_cvt_pk_bf16_f32 v42, 0, v42
    v_cvt_pk_bf16_f32 v43, 0, v43
    v_mfma_f32_16x16x32_bf16 v[80:83], a[228:231], a[184:187], v[80:83]
    s_waitcnt lgkmcnt(4)
    v_mul_f32 v42, v42, v41
    v_mul_f32 v43, v43, v41
    v_mfma_f32_16x16x32_bf16 v[88:91], a[228:231], a[188:191], v[88:91]
    v_cvt_pk_bf16_f32 v53, v42, v43
    v_lshlrev_b32 v42, 16, v54
    v_mfma_f32_16x16x32_bf16 v[88:91], a[224:227], a[172:175], v[88:91]
    ds_read_b64_tr_b16 a[224:225], v11 offset:24576
    v_and_b32 v43, 0xffff0000, v54
    v_mfma_f32_16x16x32_bf16 v[92:95], a[232:235], a[172:175], v[92:95]
    buffer_load_dwordx4 a[140:143], v15, s[20:23], s77 offen sc1
    v_mfma_f32_16x16x32_bf16 v[92:95], a[236:239], a[188:191], v[92:95]
    s_add_u32 s46, s45, 77824
    ds_read_b64_tr_b16 a[226:227], v11 offset:30720
    v_sub_f32 v42, v42, v40
    v_mfma_f32_16x16x32_bf16 v[84:87], a[236:239], a[184:187], v[84:87]
    s_sub_u32 s77, s46, 81920
    ds_read_b64_tr_b16 a[228:229], v11 offset:36864
    v_sub_f32 v43, v43, v40
    v_mfma_f32_16x16x32_bf16 v[84:87], a[232:235], a[168:171], v[84:87]
    s_min_u32 s46, s46, s77
    ds_read_b64_tr_b16 a[230:231], v11 offset:43008
    v_cvt_pk_bf16_f32 v42, 0, v42
    v_mfma_f32_16x16x32_bf16 v[76:79], a[232:235], a[164:167], v[76:79]
    s_xor_b32 s77, s46, 1024
    v_cvt_pk_bf16_f32 v43, 0, v43
    v_mul_f32 v42, v42, v41
    v_mfma_f32_16x16x32_bf16 v[76:79], a[236:239], a[180:183], v[76:79]
    s_waitcnt lgkmcnt(4)
    v_mul_f32 v43, v43, v41
    v_cvt_pk_bf16_f32 v54, v42, v43
    v_mfma_f32_16x16x32_bf16 v[68:71], a[236:239], a[176:179], v[68:71]
    buffer_load_dwordx4 a[144:147], v14, s[20:23], s46 offen sc1
    v_mfma_f32_16x16x32_bf16 v[68:71], a[232:235], a[160:163], v[68:71]
    ds_read_b64_tr_b16 a[232:233], v8 offset:25600
    v_lshlrev_b32 v42, 16, v55
    v_mfma_f32_16x16x32_bf16 v[96:99], a[240:243], a[160:163], v[96:99]
    ds_read_b64_tr_b16 a[234:235], v8 offset:31744
    v_and_b32 v43, 0xffff0000, v55
    v_mfma_f32_16x16x32_bf16 v[96:99], a[244:247], a[176:179], v[96:99]
    ds_read_b64_tr_b16 a[236:237], v8 offset:37888
    v_sub_f32 v42, v42, v40
    v_mfma_f32_16x16x32_bf16 v[104:107], a[244:247], a[180:183], v[104:107]
    ds_read_b64_tr_b16 a[238:239], v8 offset:44032
    v_sub_f32 v43, v43, v40
    v_mfma_f32_16x16x32_bf16 v[104:107], a[240:243], a[164:167], v[104:107]
    v_cvt_pk_bf16_f32 v42, 0, v42
    v_cvt_pk_bf16_f32 v43, 0, v43
    v_mfma_f32_16x16x32_bf16 v[112:115], a[240:243], a[168:171], v[112:115]
    buffer_load_dwordx4 a[148:151], v14, s[20:23], s77 offen sc1
    v_mfma_f32_16x16x32_bf16 v[112:115], a[244:247], a[184:187], v[112:115]
    s_waitcnt lgkmcnt(4)
    v_mul_f32 v42, v42, v41
    v_mul_f32 v43, v43, v41
    v_mfma_f32_16x16x32_bf16 v[120:123], a[244:247], a[188:191], v[120:123]
    v_cvt_pk_bf16_f32 v55, v42, v43
    v_mfma_f32_16x16x32_bf16 v[120:123], a[240:243], a[172:175], v[120:123]
    ds_read_b64_tr_b16 a[240:241], v9 offset:25600
    v_mfma_f32_16x16x32_bf16 v[124:127], a[224:227], a[172:175], v[124:127]
    ds_read_b64_tr_b16 a[242:243], v9 offset:31744
    v_mfma_f32_16x16x32_bf16 v[124:127], a[228:231], a[188:191], v[124:127]
    ds_read_b64_tr_b16 a[244:245], v9 offset:37888
    v_mfma_f32_16x16x32_bf16 v[116:119], a[228:231], a[184:187], v[116:119]
    buffer_load_dwordx4 a[152:155], v15, s[20:23], s46 offen sc1
    v_mfma_f32_16x16x32_bf16 v[116:119], a[224:227], a[168:171], v[116:119]
    ds_read_b64_tr_b16 a[246:247], v9 offset:44032
    v_mfma_f32_16x16x32_bf16 v[108:111], a[224:227], a[164:167], v[108:111]
    v_mfma_f32_16x16x32_bf16 v[108:111], a[228:231], a[180:183], v[108:111]
    s_waitcnt lgkmcnt(4)
    v_mfma_f32_16x16x32_bf16 v[100:103], a[228:231], a[176:179], v[100:103]
    v_mfma_f32_16x16x32_bf16 v[100:103], a[224:227], a[160:163], v[100:103]
    ds_read_b64_tr_b16 a[224:225], v10 offset:25600
    v_mfma_f32_16x16x32_bf16 v[128:131], a[232:235], a[160:163], v[128:131]
    buffer_load_dwordx4 a[156:159], v15, s[20:23], s77 offen sc1
    v_mfma_f32_16x16x32_bf16 v[128:131], a[236:239], a[176:179], v[128:131]
    s_add_u32 m0, s49, 0
    ds_read_b64_tr_b16 a[226:227], v10 offset:31744
    v_mfma_f32_16x16x32_bf16 v[136:139], a[236:239], a[180:183], v[136:139]
    ds_read_b64_tr_b16 a[228:229], v10 offset:37888
    v_mfma_f32_16x16x32_bf16 v[136:139], a[232:235], a[164:167], v[136:139]
    ds_read_b64_tr_b16 a[230:231], v10 offset:44032
    v_mfma_f32_16x16x32_bf16 v[144:147], a[232:235], a[168:171], v[144:147]
    v_mfma_f32_16x16x32_bf16 v[144:147], a[236:239], a[184:187], v[144:147]
    s_waitcnt lgkmcnt(4)
    v_mfma_f32_16x16x32_bf16 v[152:155], a[236:239], a[188:191], v[152:155]
    buffer_load_dwordx4 v4, s[12:15], s38 offen offset:0 lds
    v_mfma_f32_16x16x32_bf16 v[152:155], a[232:235], a[172:175], v[152:155]
    s_addk_i32 m0, 896
    ds_read_b64_tr_b16 a[232:233], v11 offset:25600
    v_mfma_f32_16x16x32_bf16 v[156:159], a[240:243], a[172:175], v[156:159]
    ds_read_b64_tr_b16 a[234:235], v11 offset:31744
    v_mfma_f32_16x16x32_bf16 v[156:159], a[244:247], a[188:191], v[156:159]
    ds_read_b64_tr_b16 a[236:237], v11 offset:37888
    v_mfma_f32_16x16x32_bf16 v[148:151], a[244:247], a[184:187], v[148:151]
    ds_read_b64_tr_b16 a[238:239], v11 offset:44032
    v_mfma_f32_16x16x32_bf16 v[148:151], a[240:243], a[168:171], v[148:151]
    v_mfma_f32_16x16x32_bf16 v[140:143], a[240:243], a[164:167], v[140:143]
    buffer_load_dwordx4 v4, s[12:15], s38 offen offset:128 lds
    v_mfma_f32_16x16x32_bf16 v[140:143], a[244:247], a[180:183], v[140:143]
    s_waitcnt lgkmcnt(4)
    s_addk_i32 m0, 896
    v_mfma_f32_16x16x32_bf16 v[132:135], a[244:247], a[176:179], v[132:135]
    v_mfma_f32_16x16x32_bf16 v[132:135], a[240:243], a[160:163], v[132:135]
    ds_read_b64_tr_b16 a[240:241], v8 offset:26624
    v_mfma_f32_16x16x32_bf16 v[160:163], a[224:227], a[160:163], v[160:163]
    ds_read_b64_tr_b16 a[242:243], v8 offset:32768
    v_mfma_f32_16x16x32_bf16 v[160:163], a[228:231], a[176:179], v[160:163]
    ds_read_b64_tr_b16 a[244:245], v8 offset:38912
    v_mfma_f32_16x16x32_bf16 v[168:171], a[228:231], a[180:183], v[168:171]
    buffer_load_dwordx4 v4, s[12:15], s38 offen offset:256 lds
    v_mfma_f32_16x16x32_bf16 v[168:171], a[224:227], a[164:167], v[168:171]
    s_addk_i32 m0, 1280
    ds_read_b64_tr_b16 a[246:247], v8 offset:45056
    v_mfma_f32_16x16x32_bf16 v[176:179], a[224:227], a[168:171], v[176:179]
    ds_read_b64_tr_b16 v[32:33], v25 offset:0
    v_mfma_f32_16x16x32_bf16 v[176:179], a[228:231], a[184:187], v[176:179]
    s_waitcnt lgkmcnt(5)
    ds_read_b64_tr_b16 v[34:35], v25 offset:4096
    v_mfma_f32_16x16x32_bf16 v[184:187], a[228:231], a[188:191], v[184:187]
    ds_read_b64_tr_b16 v[36:37], v25 offset:1024
    v_mfma_f32_16x16x32_bf16 v[184:187], a[224:227], a[172:175], v[184:187]
    ds_read_b64_tr_b16 v[38:39], v25 offset:5120
    v_mfma_f32_16x16x32_bf16 v[188:191], a[232:235], a[172:175], v[188:191]
    buffer_load_dwordx4 v5, s[12:15], s38 offen offset:0 lds
    v_mfma_f32_16x16x32_bf16 v[188:191], a[236:239], a[188:191], v[188:191]
    s_addk_i32 m0, 896
    ds_read_b64_tr_b16 v[40:41], v25 offset:8192
    v_mfma_f32_16x16x32_bf16 v[180:183], a[236:239], a[184:187], v[180:183]
    ds_read_b64_tr_b16 v[42:43], v25 offset:12288
    v_mfma_f32_16x16x32_bf16 v[180:183], a[232:235], a[168:171], v[180:183]
    ds_read_b64_tr_b16 v[44:45], v25 offset:9216
    v_mfma_f32_16x16x32_bf16 v[172:175], a[232:235], a[164:167], v[172:175]
    s_waitcnt lgkmcnt(5)
    ds_read_b64_tr_b16 v[46:47], v25 offset:13312
    ds_read_b64_tr_b16 a[224:225], v9 offset:26624
    v_mfma_f32_16x16x32_bf16 v[172:175], a[236:239], a[180:183], v[172:175]
    ds_read_b64_tr_b16 a[226:227], v9 offset:32768
    v_mfma_f32_16x16x32_bf16 v[164:167], a[236:239], a[176:179], v[164:167]
    ds_read_b64_tr_b16 a[228:229], v9 offset:38912
    v_mfma_f32_16x16x32_bf16 v[164:167], a[232:235], a[160:163], v[164:167]
    ds_read_b64_tr_b16 a[230:231], v9 offset:45056
    v_mfma_f32_16x16x32_bf16 v[192:195], a[240:243], a[160:163], v[192:195]
    ds_read_b64_tr_b16 a[232:233], v10 offset:26624
    v_mfma_f32_16x16x32_bf16 v[192:195], a[244:247], a[176:179], v[192:195]
    s_waitcnt lgkmcnt(7)
    ds_read_b64_tr_b16 a[234:235], v10 offset:32768
    v_mfma_f32_16x16x32_bf16 v[200:203], a[244:247], a[180:183], v[200:203]
    ds_read_b64_tr_b16 a[236:237], v10 offset:38912
    v_mfma_f32_16x16x32_bf16 v[200:203], a[240:243], a[164:167], v[200:203]
    ds_read_b64_tr_b16 a[238:239], v10 offset:45056
    v_mfma_f32_16x16x32_bf16 v[208:211], a[240:243], a[168:171], v[208:211]
    buffer_load_dwordx4 v5, s[12:15], s38 offen offset:128 lds
    v_mfma_f32_16x16x32_bf16 v[208:211], a[244:247], a[184:187], v[208:211]
    s_waitcnt lgkmcnt(5)
    v_add_u32 v8, 49152, v8
    s_addk_i32 m0, 896
    v_mfma_f32_16x16x32_bf16 v[216:219], a[244:247], a[188:191], v[216:219]
    buffer_load_dwordx4 v5, s[12:15], s38 offen offset:256 lds
    v_mfma_f32_16x16x32_bf16 v[216:219], a[240:243], a[172:175], v[216:219]
    s_waitcnt lgkmcnt(3)
    ds_read_b64_tr_b16 a[240:241], v11 offset:26624
    s_add_u32 s38, s38, 24576
    ds_read_b64_tr_b16 a[242:243], v11 offset:32768
    v_mfma_f32_16x16x32_bf16 v[220:223], a[224:227], a[172:175], v[220:223]
    s_addk_i32 m0, 19712
    ds_read_b64_tr_b16 a[244:245], v11 offset:38912
    ds_read_b64_tr_b16 a[246:247], v11 offset:45056
    v_mfma_f32_16x16x32_bf16 v[220:223], a[228:231], a[188:191], v[220:223]
    v_add_u32 v9, 49152, v9
    v_mfma_f32_16x16x32_bf16 v[212:215], a[228:231], a[184:187], v[212:215]
    buffer_load_dwordx4 v4, s[12:15], s38 offen offset:0 lds
    v_mfma_f32_16x16x32_bf16 v[212:215], a[224:227], a[168:171], v[212:215]
    s_addk_i32 m0, 896
    v_add_u32 v10, 49152, v10
    v_mfma_f32_16x16x32_bf16 v[204:207], a[224:227], a[164:167], v[204:207]
    v_add_u32 v11, 49152, v11
    v_mfma_f32_16x16x32_bf16 v[204:207], a[228:231], a[180:183], v[204:207]
    s_waitcnt lgkmcnt(4)
    v_mfma_f32_16x16x32_bf16 v[196:199], a[228:231], a[176:179], v[196:199]
    s_waitcnt lgkmcnt(0)
    s_barrier
    v_mfma_f32_16x16x32_bf16 v[196:199], a[224:227], a[160:163], v[196:199]
    ds_read_b64_tr_b16 a[224:225], v8 offset:0
    v_mfma_f32_16x16x32_bf16 v[224:227], a[232:235], a[160:163], v[224:227]
    buffer_load_dwordx4 v4, s[12:15], s38 offen offset:128 lds
    v_mfma_f32_16x16x32_bf16 v[224:227], a[236:239], a[176:179], v[224:227]
    s_addk_i32 m0, 896
    ds_read_b64_tr_b16 a[226:227], v8 offset:6144
    v_mfma_f32_16x16x32_bf16 v[232:235], a[236:239], a[180:183], v[232:235]
    ds_read_b64_tr_b16 a[228:229], v8 offset:12288
    v_mfma_f32_16x16x32_bf16 v[232:235], a[232:235], a[164:167], v[232:235]
    ds_read_b64_tr_b16 a[230:231], v8 offset:18432
    v_mfma_f32_16x16x32_bf16 v[240:243], a[232:235], a[168:171], v[240:243]
    v_mfma_f32_16x16x32_bf16 v[240:243], a[236:239], a[184:187], v[240:243]
    v_mfma_f32_16x16x32_bf16 v[248:251], a[236:239], a[188:191], v[248:251]
    buffer_load_dwordx4 v4, s[12:15], s38 offen offset:256 lds
    v_mfma_f32_16x16x32_bf16 v[248:251], a[232:235], a[172:175], v[248:251]
    s_addk_i32 m0, 1280
    ds_read_b64_tr_b16 a[232:233], v8 offset:24576
    v_mfma_f32_16x16x32_bf16 v[20:23], v[48:51], v[32:35], 0
    ds_read_b64_tr_b16 a[234:235], v8 offset:30720
    v_mfma_f32_16x16x32_bf16 v[58:61], v[48:51], v[36:39], 0
    ds_read_b64_tr_b16 a[236:237], v8 offset:36864
    v_mfma_f32_16x16x32_bf16 v[20:23], v[52:55], v[40:43], v[20:23]
    ds_read_b64_tr_b16 a[238:239], v8 offset:43008
    v_mfma_f32_16x16x32_bf16 v[58:61], v[52:55], v[44:47], v[58:61]
    v_mfma_f32_16x16x32_bf16 v[252:255], a[240:243], a[172:175], v[252:255]
    buffer_load_dwordx4 v5, s[12:15], s38 offen offset:0 lds
    v_mfma_f32_16x16x32_bf16 v[252:255], a[244:247], a[188:191], v[252:255]
    s_addk_i32 m0, 896
    v_lshlrev_b32 v14, 4, v1
    v_min_u32 v15, 1, v1
    v_mfma_f32_16x16x32_bf16 v[244:247], a[244:247], a[184:187], v[244:247]
    s_mul_i32 s56, s53, 983040
    v_mov_b32 v22, v58
    v_mov_b32 v23, v59
    v_mfma_f32_16x16x32_bf16 v[244:247], a[240:243], a[168:171], v[244:247]
    buffer_store_dwordx4 v[20:23], v26, s[24:27], s62 offen sc1
    v_mov_b32 v26, s7
    v_mfma_f32_16x16x32_bf16 v[236:239], a[240:243], a[164:167], v[236:239]
    s_mul_i32 s57, s51, 320
    v_lshrrev_b32 v21, 3, v1
    v_mul_u32_u24 v21, 1280, v21
    v_mfma_f32_16x16x32_bf16 v[236:239], a[244:247], a[180:183], v[236:239]
    s_waitcnt vmcnt(26) lgkmcnt(0)
    v_and_b32 v22, 16, v1
    v_lshlrev_b32 v22, 1, v22
    v_mfma_f32_16x16x32_bf16 v[228:231], a[244:247], a[176:179], v[228:231]
    buffer_load_dwordx4 v5, s[12:15], s38 offen offset:128 lds
    v_mfma_f32_16x16x32_bf16 v[228:231], a[240:243], a[160:163], v[228:231]
    s_waitcnt vmcnt(22)
    ds_read_b64_tr_b16 a[240:241], v9 offset:0
    v_lshlrev_b32 v15, 30, v15
    v_mfma_f32_16x16x32_bf16 v[64:67], a[224:227], a[96:99], v[64:67]
    s_addk_i32 m0, 896
    ds_read_b64_tr_b16 a[242:243], v9 offset:6144
    v_and_b32 v20, 1, v1
    v_mfma_f32_16x16x32_bf16 v[64:67], a[228:231], a[112:115], v[64:67]
    s_add_u32 s56, s56, s57
    ds_read_b64_tr_b16 a[244:245], v9 offset:12288
    v_mul_u32_u24 v20, 0xaaaa, v20
    v_mfma_f32_16x16x32_bf16 v[72:75], a[228:231], a[116:119], v[72:75]
    s_waitcnt vmcnt(21)
    ds_read_b64_tr_b16 a[246:247], v9 offset:18432
    v_add_u32 v20, 0x4444, v20
    v_mfma_f32_16x16x32_bf16 v[72:75], a[224:227], a[100:103], v[72:75]
    s_waitcnt vmcnt(20)
    s_add_u32 s39, s40, 0
    s_sub_u32 s57, 7864320, s56
    v_mfma_f32_16x16x32_bf16 v[80:83], a[224:227], a[104:107], v[80:83]
    buffer_load_dwordx4 v5, s[12:15], s38 offen offset:256 lds
    v_mfma_f32_16x16x32_bf16 v[80:83], a[228:231], a[120:123], v[80:83]
    s_waitcnt vmcnt(17)
    s_add_u32 s38, s38, 24576
    s_add_u32 m0, s63, 73728
    v_mfma_f32_16x16x32_bf16 v[88:91], a[228:231], a[124:127], v[88:91]
    s_waitcnt vmcnt(13)
    s_mov_b32 s10, s57
    s_mov_b32 s11, 0x00020000
    v_mfma_f32_16x16x32_bf16 v[88:91], a[224:227], a[108:111], v[88:91]
    s_add_u32 s8, s72, s56
    s_addc_u32 s9, s73, 0
    s_and_b32 s9, s9, 0xffff
    v_mfma_f32_16x16x32_bf16 v[88:91], a[232:235], a[140:143], v[88:91]
    s_mul_i32 s56, s53, 983040
    ds_read_b64_tr_b16 a[224:225], v9 offset:24576
    s_mov_b32 s34, 983040
    v_mfma_f32_16x16x32_bf16 v[88:91], a[236:239], a[156:159], v[88:91]
    s_add_u32 s32, s72, s56
    s_addc_u32 s33, s73, 0
    s_and_b32 s33, s33, 0xffff
    v_mfma_f32_16x16x32_bf16 v[80:83], a[236:239], a[152:155], v[80:83]
    buffer_load_dwordx4 v6, s[16:19], s39 offen lds
    v_mfma_f32_16x16x32_bf16 v[80:83], a[232:235], a[136:139], v[80:83]
    s_add_u32 s39, s40, 12288
    ds_read_b64_tr_b16 a[226:227], v9 offset:30720
    v_cvt_pk_bf16_f32 v88, v88, v89
    v_mfma_f32_16x16x32_bf16 v[72:75], a[232:235], a[132:135], v[72:75]
    s_addk_i32 m0, 4096
    ds_read_b64_tr_b16 a[228:229], v9 offset:36864
    v_cvt_pk_bf16_f32 v89, v90, v91
    v_mfma_f32_16x16x32_bf16 v[72:75], a[236:239], a[148:151], v[72:75]
    s_waitcnt lgkmcnt(3)
    ds_read_b64_tr_b16 a[230:231], v9 offset:43008
    v_cvt_pk_bf16_f32 v80, v80, v81
    v_mfma_f32_16x16x32_bf16 v[64:67], a[236:239], a[144:147], v[64:67]
    s_mov_b32 s35, 0x00020000
    v_cvt_pk_bf16_f32 v81, v82, v83
    s_mul_i32 s56, s53, 3145728
    v_mfma_f32_16x16x32_bf16 v[64:67], a[232:235], a[128:131], v[64:67]
    s_add_u32 s56, s56, 16777216
    ds_read_b64_tr_b16 a[232:233], v10 offset:0
    v_cvt_pk_bf16_f32 v72, v72, v73
    v_mfma_f32_16x16x32_bf16 v[68:71], a[240:243], a[96:99], v[68:71]
    buffer_load_dwordx4 v6, s[16:19], s39 offen lds
    v_mfma_f32_16x16x32_bf16 v[68:71], a[244:247], a[112:115], v[68:71]
    s_add_u32 s39, s40, 24576
    ds_read_b64_tr_b16 a[234:235], v10 offset:6144
    v_cvt_pk_bf16_f32 v64, v64, v65
    v_mfma_f32_16x16x32_bf16 v[76:79], a[244:247], a[116:119], v[76:79]
    s_addk_i32 m0, 4096
    ds_read_b64_tr_b16 a[236:237], v10 offset:12288
    v_cvt_pk_bf16_f32 v65, v66, v67
    v_mfma_f32_16x16x32_bf16 v[76:79], a[240:243], a[100:103], v[76:79]
    s_add_u32 s20, s86, s56
    s_addc_u32 s21, s87, 0
    v_cvt_pk_bf16_f32 v73, v74, v75
    v_mfma_f32_16x16x32_bf16 v[84:87], a[240:243], a[104:107], v[84:87]
    s_and_b32 s21, s21, 0xffff
    ds_read_b64_tr_b16 a[238:239], v10 offset:18432
    s_mov_b32 s22, 3145728
    v_mfma_f32_16x16x32_bf16 v[84:87], a[244:247], a[120:123], v[84:87]
    s_waitcnt lgkmcnt(4)
    s_mov_b32 s23, 0x00020000
    s_lshl_b32 s55, s51, 5
    v_mfma_f32_16x16x32_bf16 v[92:95], a[244:247], a[124:127], v[92:95]
    buffer_load_dwordx4 v6, s[16:19], s39 offen lds
    v_mfma_f32_16x16x32_bf16 v[92:95], a[240:243], a[108:111], v[92:95]
    s_add_u32 s39, s40, 36864
    ds_read_b64_tr_b16 a[240:241], v10 offset:24576
    s_addk_i32 m0, 4096
    v_mfma_f32_16x16x32_bf16 v[92:95], a[224:227], a[140:143], v[92:95]
    s_add_u32 s55, s55, s54
    ds_read_b64_tr_b16 a[242:243], v10 offset:30720
    s_mul_i32 s55, s55, 24576
    v_mfma_f32_16x16x32_bf16 v[92:95], a[228:231], a[156:159], v[92:95]
    s_lshr_b32 s50, s53, 1
    ds_read_b64_tr_b16 a[244:245], v10 offset:36864
    s_xor_b32 s67, s50, 3
    v_mfma_f32_16x16x32_bf16 v[84:87], a[228:231], a[152:155], v[84:87]
    s_lshl_b32 s67, s67, 10
    ds_read_b64_tr_b16 a[246:247], v10 offset:43008
    s_add_u32 s56, s51, 0
    v_mfma_f32_16x16x32_bf16 v[84:87], a[224:227], a[136:139], v[84:87]
    s_and_b32 s56, s56, 3
    v_cvt_pk_bf16_f32 v90, v92, v93
    v_cvt_pk_bf16_f32 v91, v94, v95
    v_mfma_f32_16x16x32_bf16 v[76:79], a[224:227], a[132:135], v[76:79]
    buffer_load_dwordx4 v6, s[16:19], s39 offen lds
    v_mfma_f32_16x16x32_bf16 v[76:79], a[228:231], a[148:151], v[76:79]
    s_waitcnt lgkmcnt(4)
    v_permlane16_swap_b32 v88, v90
    v_mfma_f32_16x16x32_bf16 v[68:71], a[228:231], a[144:147], v[68:71]
    s_mul_i32 s44, s56, 245760
    v_permlane16_swap_b32 v89, v91
    v_mfma_f32_16x16x32_bf16 v[68:71], a[224:227], a[128:131], v[68:71]
    s_add_u32 s56, s51, 1
    ds_read_b64_tr_b16 a[224:225], v11 offset:0
    v_cvt_pk_bf16_f32 v74, v76, v77
    v_mfma_f32_16x16x32_bf16 v[96:99], a[232:235], a[96:99], v[96:99]
    s_and_b32 s56, s56, 3
    ds_read_b64_tr_b16 a[226:227], v11 offset:6144
    v_cvt_pk_bf16_f32 v75, v78, v79
    v_mfma_f32_16x16x32_bf16 v[96:99], a[236:239], a[112:115], v[96:99]
    s_mul_i32 s45, s56, 245760
    ds_read_b64_tr_b16 a[228:229], v11 offset:12288
    v_cvt_pk_bf16_f32 v66, v68, v69
    v_mfma_f32_16x16x32_bf16 v[104:107], a[236:239], a[116:119], v[104:107]
    s_lshl_b32 s56, s56, 5
    ds_read_b64_tr_b16 a[230:231], v11 offset:18432
    v_cvt_pk_bf16_f32 v67, v70, v71
    v_mfma_f32_16x16x32_bf16 v[104:107], a[232:235], a[100:103], v[104:107]
    s_add_u32 s56, s56, s54
    v_permlane16_swap_b32 v64, v66
    v_mfma_f32_16x16x32_bf16 v[112:115], a[232:235], a[104:107], v[112:115]
    s_mul_i32 s59, s56, 24576
    v_permlane16_swap_b32 v65, v67
    v_mfma_f32_16x16x32_bf16 v[112:115], a[236:239], a[120:123], v[112:115]
    s_waitcnt lgkmcnt(4)
    v_permlane16_swap_b32 v72, v74
    v_mfma_f32_16x16x32_bf16 v[120:123], a[236:239], a[124:127], v[120:123]
    s_add_u32 s56, s51, 2
    v_permlane16_swap_b32 v73, v75
    v_mfma_f32_16x16x32_bf16 v[120:123], a[232:235], a[108:111], v[120:123]
    s_and_b32 s56, s56, 3
    ds_read_b64_tr_b16 a[232:233], v11 offset:24576
    v_cvt_pk_bf16_f32 v82, v84, v85
    v_mfma_f32_16x16x32_bf16 v[120:123], a[240:243], a[140:143], v[120:123]
    s_mul_i32 s46, s56, 245760
    ds_read_b64_tr_b16 a[234:235], v11 offset:30720
    v_cvt_pk_bf16_f32 v83, v86, v87
    v_mfma_f32_16x16x32_bf16 v[120:123], a[244:247], a[156:159], v[120:123]
    s_lshl_b32 s56, s56, 5
    ds_read_b64_tr_b16 a[236:237], v11 offset:36864
    v_accvgpr_write_b32 a0, v64
    v_mfma_f32_16x16x32_bf16 v[112:115], a[244:247], a[152:155], v[112:115]
    s_add_u32 s56, s56, s54
    ds_read_b64_tr_b16 a[238:239], v11 offset:43008
    v_accvgpr_write_b32 a1, v65
    v_mfma_f32_16x16x32_bf16 v[112:115], a[240:243], a[136:139], v[112:115]
    s_mul_i32 s60, s56, 24576
    v_permlane16_swap_b32 v80, v82
    v_mfma_f32_16x16x32_bf16 v[104:107], a[240:243], a[132:135], v[104:107]
    s_add_u32 s56, s51, 3
    v_permlane16_swap_b32 v81, v83
    v_mfma_f32_16x16x32_bf16 v[104:107], a[244:247], a[148:151], v[104:107]
    s_waitcnt lgkmcnt(4)
    v_accvgpr_write_b32 a2, v66
    v_accvgpr_write_b32 a3, v67
    v_mfma_f32_16x16x32_bf16 v[96:99], a[244:247], a[144:147], v[96:99]
    s_and_b32 s56, s56, 3
    v_accvgpr_write_b32 a4, v72
    v_accvgpr_write_b32 a5, v73
    v_mfma_f32_16x16x32_bf16 v[96:99], a[240:243], a[128:131], v[96:99]
    s_mul_i32 s47, s56, 245760
    ds_read_b64_tr_b16 a[240:241], v8 offset:1024
    v_accvgpr_write_b32 a6, v74
    v_mfma_f32_16x16x32_bf16 v[100:103], a[224:227], a[96:99], v[100:103]
    s_lshl_b32 s56, s56, 5
    ds_read_b64_tr_b16 a[242:243], v8 offset:7168
    v_accvgpr_write_b32 a7, v75
    v_mfma_f32_16x16x32_bf16 v[100:103], a[228:231], a[112:115], v[100:103]
    s_add_u32 s56, s56, s54
    ds_read_b64_tr_b16 a[244:245], v8 offset:13312
    v_accvgpr_write_b32 a8, v80
    v_mfma_f32_16x16x32_bf16 v[108:111], a[228:231], a[116:119], v[108:111]
    s_mul_i32 s61, s56, 24576
    ds_read_b64_tr_b16 a[246:247], v8 offset:19456
    v_accvgpr_write_b32 a9, v81
    v_mfma_f32_16x16x32_bf16 v[108:111], a[224:227], a[100:103], v[108:111]
    s_mov_b32 s72, s7
    v_accvgpr_write_b32 a10, v82
    v_accvgpr_write_b32 a11, v83
    v_mfma_f32_16x16x32_bf16 v[116:119], a[224:227], a[104:107], v[116:119]
    s_mov_b32 s73, s7
    v_accvgpr_write_b32 a12, v88
    v_accvgpr_write_b32 a13, v89
    v_mfma_f32_16x16x32_bf16 v[116:119], a[228:231], a[120:123], v[116:119]
    s_waitcnt lgkmcnt(4)
    v_accvgpr_write_b32 a14, v90
    v_accvgpr_write_b32 a15, v91
    v_mfma_f32_16x16x32_bf16 v[124:127], a[228:231], a[124:127], v[124:127]
    s_mov_b32 s74, s7
    v_cvt_pk_bf16_f32 v96, v96, v97
    v_cvt_pk_bf16_f32 v97, v98, v99
    v_mfma_f32_16x16x32_bf16 v[124:127], a[224:227], a[108:111], v[124:127]
    s_mov_b32 s75, s7
    ds_read_b64_tr_b16 a[224:225], v8 offset:25600
    v_cvt_pk_bf16_f32 v104, v104, v105
    v_mfma_f32_16x16x32_bf16 v[124:127], a[232:235], a[140:143], v[124:127]
    s_lshl_b32 s56, s50, 6
    ds_read_b64_tr_b16 a[226:227], v8 offset:31744
    v_cvt_pk_bf16_f32 v105, v106, v107
    v_mfma_f32_16x16x32_bf16 v[124:127], a[236:239], a[156:159], v[124:127]
    s_xor_b32 s56, s56, 192
    ds_read_b64_tr_b16 a[228:229], v8 offset:37888
    v_xor_b32 v2, s56, v7
    v_mfma_f32_16x16x32_bf16 v[116:119], a[236:239], a[152:155], v[116:119]
    s_and_b32 s56, s51, 1
    ds_read_b64_tr_b16 a[230:231], v8 offset:44032
    v_xor_b32 v3, 128, v2
    v_mfma_f32_16x16x32_bf16 v[116:119], a[232:235], a[136:139], v[116:119]
    s_lshl_b32 s56, s56, 6
    v_cvt_pk_bf16_f32 v112, v112, v113
    v_cvt_pk_bf16_f32 v113, v114, v115
    v_mfma_f32_16x16x32_bf16 v[108:111], a[232:235], a[132:135], v[108:111]
    s_mul_i32 s57, s3, 10240
    v_cvt_pk_bf16_f32 v120, v120, v121
    v_cvt_pk_bf16_f32 v121, v122, v123
    v_mfma_f32_16x16x32_bf16 v[108:111], a[236:239], a[148:151], v[108:111]
    s_waitcnt lgkmcnt(4)
    v_cvt_pk_bf16_f32 v114, v116, v117
    v_cvt_pk_bf16_f32 v115, v118, v119
    v_mfma_f32_16x16x32_bf16 v[100:103], a[236:239], a[144:147], v[100:103]
    s_add_u32 s56, s56, s57
    v_permlane16_swap_b32 v112, v114
    v_mfma_f32_16x16x32_bf16 v[100:103], a[232:235], a[128:131], v[100:103]
    s_and_b32 s57, s3, 1
    ds_read_b64_tr_b16 a[232:233], v9 offset:1024
    v_add_u32 v21, s56, v21
    v_mfma_f32_16x16x32_bf16 v[128:131], a[240:243], a[96:99], v[128:131]
    s_and_b32 s56, s51, 1
    ds_read_b64_tr_b16 a[234:235], v9 offset:7168
    v_add_u32 v2, v2, v21
    v_mfma_f32_16x16x32_bf16 v[128:131], a[244:247], a[112:115], v[128:131]
    s_xor_b32 s56, s56, 1
    ds_read_b64_tr_b16 a[236:237], v9 offset:13312
    v_add_u32 v3, v3, v21
    v_mfma_f32_16x16x32_bf16 v[136:139], a[244:247], a[116:119], v[136:139]
pg_4:
    s_cbranch_execz pg_6
    s_lshl_b32 s56, s56, 8
    ds_read_b64_tr_b16 a[238:239], v9 offset:19456
    v_and_b32 v21, 3, v1
    v_mfma_f32_16x16x32_bf16 v[136:139], a[240:243], a[100:103], v[136:139]
    s_mul_i32 s57, s57, 20480
    v_lshlrev_b32 v21, 4, v21
    v_xor_b32 v21, v21, v22
    v_mfma_f32_16x16x32_bf16 v[144:147], a[240:243], a[104:107], v[144:147]
    s_add_u32 s56, s56, s57
    v_lshrrev_b32 v22, 2, v1
    v_mul_u32_u24 v22, 1280, v22
    v_mfma_f32_16x16x32_bf16 v[144:147], a[244:247], a[120:123], v[144:147]
    s_waitcnt lgkmcnt(4)
    v_add_u32 v21, v21, v22
    v_add_u32 v7, s56, v21
    v_mfma_f32_16x16x32_bf16 v[152:155], a[244:247], a[124:127], v[152:155]
    s_lshr_b32 s42, s2, 3
    v_mov_b32 v21, 0x3f803f80
    v_accvgpr_write_b32 a248, v21
    v_mfma_f32_16x16x32_bf16 v[152:155], a[240:243], a[108:111], v[152:155]
    s_lshl_b32 s42, s42, 2
    ds_read_b64_tr_b16 a[240:241], v9 offset:25600
    v_accvgpr_write_b32 a249, v21
    v_mfma_f32_16x16x32_bf16 v[152:155], a[224:227], a[140:143], v[152:155]
    s_add_u32 s42, s42, s3
    ds_read_b64_tr_b16 a[242:243], v9 offset:31744
    v_accvgpr_write_b32 a250, v21
    v_mfma_f32_16x16x32_bf16 v[152:155], a[228:231], a[156:159], v[152:155]
    s_mul_i32 s42, s42, 7680
    ds_read_b64_tr_b16 a[244:245], v9 offset:37888
    v_accvgpr_write_b32 a251, v21
    v_mfma_f32_16x16x32_bf16 v[144:147], a[228:231], a[152:155], v[144:147]
    ds_read_b64_tr_b16 a[246:247], v9 offset:44032
    v_min_u32 v22, 11, v1
    v_mfma_f32_16x16x32_bf16 v[144:147], a[224:227], a[136:139], v[144:147]
    v_lshlrev_b32 v22, 7, v22
    v_cvt_pk_bf16_f32 v98, v100, v101
    v_mfma_f32_16x16x32_bf16 v[136:139], a[224:227], a[132:135], v[136:139]
    v_permlane16_swap_b32 v113, v115
    v_mfma_f32_16x16x32_bf16 v[136:139], a[228:231], a[148:151], v[136:139]
    s_waitcnt lgkmcnt(4)
    v_permlane16_swap_b32 v96, v98
    v_mfma_f32_16x16x32_bf16 v[128:131], a[228:231], a[144:147], v[128:131]
    v_cvt_pk_bf16_f32 v99, v102, v103
    v_cvt_pk_bf16_f32 v106, v108, v109
    v_mfma_f32_16x16x32_bf16 v[128:131], a[224:227], a[128:131], v[128:131]
    ds_read_b64_tr_b16 a[224:225], v10 offset:1024
    v_cvt_pk_bf16_f32 v107, v110, v111
    v_mfma_f32_16x16x32_bf16 v[132:135], a[232:235], a[96:99], v[132:135]
    ds_read_b64_tr_b16 a[226:227], v10 offset:7168
    v_accvgpr_write_b32 a16, v96
    v_mfma_f32_16x16x32_bf16 v[132:135], a[236:239], a[112:115], v[132:135]
    ds_read_b64_tr_b16 a[228:229], v10 offset:13312
    v_accvgpr_write_b32 a18, v98
    v_mfma_f32_16x16x32_bf16 v[140:143], a[236:239], a[116:119], v[140:143]
    ds_read_b64_tr_b16 a[230:231], v10 offset:19456
    v_cvt_pk_bf16_f32 v122, v124, v125
    v_mfma_f32_16x16x32_bf16 v[140:143], a[232:235], a[100:103], v[140:143]
    v_permlane16_swap_b32 v97, v99
    v_mfma_f32_16x16x32_bf16 v[148:151], a[232:235], a[104:107], v[148:151]
    v_permlane16_swap_b32 v104, v106
    v_mfma_f32_16x16x32_bf16 v[148:151], a[236:239], a[120:123], v[148:151]
    s_waitcnt lgkmcnt(4)
    v_permlane16_swap_b32 v105, v107
    v_mfma_f32_16x16x32_bf16 v[156:159], a[236:239], a[124:127], v[156:159]
    s_waitcnt vmcnt(6)
    v_permlane16_swap_b32 v120, v122
    v_mfma_f32_16x16x32_bf16 v[156:159], a[232:235], a[108:111], v[156:159]
    buffer_store_dword v26, v27, s[24:27], s4 offen offset:144 sc1
    v_mfma_f32_16x16x32_bf16 v[156:159], a[240:243], a[140:143], v[156:159]
    ds_read_b64_tr_b16 a[232:233], v10 offset:25600
    v_accvgpr_write_b32 a17, v97
    v_mfma_f32_16x16x32_bf16 v[156:159], a[244:247], a[156:159], v[156:159]
    ds_read_b64_tr_b16 a[234:235], v10 offset:31744
    v_accvgpr_write_b32 a19, v99
    v_mfma_f32_16x16x32_bf16 v[148:151], a[244:247], a[152:155], v[148:151]
    ds_read_b64_tr_b16 a[236:237], v10 offset:37888
    v_cvt_pk_bf16_f32 v123, v126, v127
    v_mfma_f32_16x16x32_bf16 v[148:151], a[240:243], a[136:139], v[148:151]
    ds_read_b64_tr_b16 a[238:239], v10 offset:44032
    v_accvgpr_write_b32 a20, v104
    v_mfma_f32_16x16x32_bf16 v[140:143], a[240:243], a[132:135], v[140:143]
    v_permlane16_swap_b32 v121, v123
    v_mfma_f32_16x16x32_bf16 v[140:143], a[244:247], a[148:151], v[140:143]
    s_waitcnt lgkmcnt(4)
    v_accvgpr_write_b32 a21, v105
    v_accvgpr_write_b32 a22, v106
    v_mfma_f32_16x16x32_bf16 v[132:135], a[244:247], a[144:147], v[132:135]
    v_accvgpr_write_b32 a23, v107
    v_accvgpr_write_b32 a24, v112
    v_mfma_f32_16x16x32_bf16 v[132:135], a[240:243], a[128:131], v[132:135]
    ds_read_b64_tr_b16 a[240:241], v11 offset:1024
    v_accvgpr_write_b32 a25, v113
    v_mfma_f32_16x16x32_bf16 v[160:163], a[224:227], a[96:99], v[160:163]
    ds_read_b64_tr_b16 a[242:243], v11 offset:7168
    v_accvgpr_write_b32 a26, v114
    v_mfma_f32_16x16x32_bf16 v[160:163], a[228:231], a[112:115], v[160:163]
    ds_read_b64_tr_b16 a[244:245], v11 offset:13312
    v_accvgpr_write_b32 a27, v115
    v_mfma_f32_16x16x32_bf16 v[168:171], a[228:231], a[116:119], v[168:171]
    ds_read_b64_tr_b16 a[246:247], v11 offset:19456
    v_accvgpr_write_b32 a28, v120
    v_mfma_f32_16x16x32_bf16 v[168:171], a[224:227], a[100:103], v[168:171]
    v_accvgpr_write_b32 a29, v121
    v_accvgpr_write_b32 a30, v122
    v_mfma_f32_16x16x32_bf16 v[176:179], a[224:227], a[104:107], v[176:179]
    v_accvgpr_write_b32 a31, v123
    v_cvt_pk_bf16_f32 v128, v128, v129
    v_mfma_f32_16x16x32_bf16 v[176:179], a[228:231], a[120:123], v[176:179]
    s_waitcnt lgkmcnt(4)
    v_cvt_pk_bf16_f32 v129, v130, v131
    v_cvt_pk_bf16_f32 v130, v132, v133
    v_mfma_f32_16x16x32_bf16 v[184:187], a[228:231], a[124:127], v[184:187]
    v_cvt_pk_bf16_f32 v131, v134, v135
    v_cvt_pk_bf16_f32 v136, v136, v137
    v_mfma_f32_16x16x32_bf16 v[184:187], a[224:227], a[108:111], v[184:187]
    ds_read_b64_tr_b16 a[224:225], v11 offset:25600
    v_cvt_pk_bf16_f32 v137, v138, v139
    v_mfma_f32_16x16x32_bf16 v[184:187], a[232:235], a[140:143], v[184:187]
    ds_read_b64_tr_b16 a[226:227], v11 offset:31744
    v_cvt_pk_bf16_f32 v138, v140, v141
    v_mfma_f32_16x16x32_bf16 v[184:187], a[236:239], a[156:159], v[184:187]
    ds_read_b64_tr_b16 a[228:229], v11 offset:37888
    v_cvt_pk_bf16_f32 v139, v142, v143
    v_mfma_f32_16x16x32_bf16 v[176:179], a[236:239], a[152:155], v[176:179]
    ds_read_b64_tr_b16 a[230:231], v11 offset:44032
    v_cvt_pk_bf16_f32 v144, v144, v145
    v_mfma_f32_16x16x32_bf16 v[176:179], a[232:235], a[136:139], v[176:179]
    v_permlane16_swap_b32 v128, v130
    v_mfma_f32_16x16x32_bf16 v[168:171], a[232:235], a[132:135], v[168:171]
    v_permlane16_swap_b32 v129, v131
    v_mfma_f32_16x16x32_bf16 v[168:171], a[236:239], a[148:151], v[168:171]
    s_waitcnt lgkmcnt(4)
    v_permlane16_swap_b32 v136, v138
    v_mfma_f32_16x16x32_bf16 v[160:163], a[236:239], a[144:147], v[160:163]
    v_permlane16_swap_b32 v137, v139
    v_mfma_f32_16x16x32_bf16 v[160:163], a[232:235], a[128:131], v[160:163]
    ds_read_b64_tr_b16 a[232:233], v8 offset:2048
    v_cvt_pk_bf16_f32 v145, v146, v147
    v_mfma_f32_16x16x32_bf16 v[164:167], a[240:243], a[96:99], v[164:167]
    ds_read_b64_tr_b16 a[234:235], v8 offset:8192
    v_cvt_pk_bf16_f32 v146, v148, v149
    v_mfma_f32_16x16x32_bf16 v[164:167], a[244:247], a[112:115], v[164:167]
    ds_read_b64_tr_b16 a[236:237], v8 offset:14336
    v_cvt_pk_bf16_f32 v147, v150, v151
    v_mfma_f32_16x16x32_bf16 v[172:175], a[244:247], a[116:119], v[172:175]
    ds_read_b64_tr_b16 a[238:239], v8 offset:20480
    v_accvgpr_write_b32 a32, v128
    v_mfma_f32_16x16x32_bf16 v[172:175], a[240:243], a[100:103], v[172:175]
    v_permlane16_swap_b32 v144, v146
    v_mfma_f32_16x16x32_bf16 v[180:183], a[240:243], a[104:107], v[180:183]
    v_permlane16_swap_b32 v145, v147
    v_mfma_f32_16x16x32_bf16 v[180:183], a[244:247], a[120:123], v[180:183]
    s_waitcnt lgkmcnt(4)
    v_accvgpr_write_b32 a33, v129
    v_accvgpr_write_b32 a34, v130
    v_mfma_f32_16x16x32_bf16 v[188:191], a[244:247], a[124:127], v[188:191]
    v_accvgpr_write_b32 a35, v131
    v_cvt_pk_bf16_f32 v152, v152, v153
    v_mfma_f32_16x16x32_bf16 v[188:191], a[240:243], a[108:111], v[188:191]
    ds_read_b64_tr_b16 a[240:241], v8 offset:26624
    v_cvt_pk_bf16_f32 v153, v154, v155
    v_mfma_f32_16x16x32_bf16 v[188:191], a[224:227], a[140:143], v[188:191]
    ds_read_b64_tr_b16 a[242:243], v8 offset:32768
    v_cvt_pk_bf16_f32 v154, v156, v157
    v_mfma_f32_16x16x32_bf16 v[188:191], a[228:231], a[156:159], v[188:191]
    ds_read_b64_tr_b16 a[244:245], v8 offset:38912
    v_cvt_pk_bf16_f32 v155, v158, v159
    v_mfma_f32_16x16x32_bf16 v[180:183], a[228:231], a[152:155], v[180:183]
    ds_read_b64_tr_b16 a[246:247], v8 offset:45056
    v_accvgpr_write_b32 a36, v136
    v_mfma_f32_16x16x32_bf16 v[180:183], a[224:227], a[136:139], v[180:183]
    v_permlane16_swap_b32 v152, v154
    v_mfma_f32_16x16x32_bf16 v[172:175], a[224:227], a[132:135], v[172:175]
    s_add_u32 s88, s88, code_end-code0-65536
    s_addc_u32 s89, s89, 0
    v_accvgpr_write_b32 a37, v137
    v_mfma_f32_16x16x32_bf16 v[172:175], a[228:231], a[148:151], v[172:175]
    s_waitcnt lgkmcnt(4)
    v_permlane16_swap_b32 v153, v155
    v_mfma_f32_16x16x32_bf16 v[164:167], a[228:231], a[144:147], v[164:167]
    v_accvgpr_write_b32 a38, v138
    v_accvgpr_write_b32 a39, v139
    v_mfma_f32_16x16x32_bf16 v[164:167], a[224:227], a[128:131], v[164:167]
    ds_read_b64_tr_b16 a[224:225], v9 offset:2048
    v_accvgpr_write_b32 a40, v144
    v_mfma_f32_16x16x32_bf16 v[192:195], a[232:235], a[96:99], v[192:195]
    global_load_dword a252, v18, s[88:89]
    v_mfma_f32_16x16x32_bf16 v[192:195], a[236:239], a[112:115], v[192:195]
    ds_read_b64_tr_b16 a[226:227], v9 offset:8192
    v_accvgpr_write_b32 a41, v145
    v_mfma_f32_16x16x32_bf16 v[200:203], a[236:239], a[116:119], v[200:203]
    ds_read_b64_tr_b16 a[228:229], v9 offset:14336
    v_accvgpr_write_b32 a42, v146
    v_mfma_f32_16x16x32_bf16 v[200:203], a[232:235], a[100:103], v[200:203]
    ds_read_b64_tr_b16 a[230:231], v9 offset:20480
    v_accvgpr_write_b32 a43, v147
    v_mfma_f32_16x16x32_bf16 v[208:211], a[232:235], a[104:107], v[208:211]
    v_accvgpr_write_b32 a44, v152
    v_accvgpr_write_b32 a45, v153
    v_mfma_f32_16x16x32_bf16 v[208:211], a[236:239], a[120:123], v[208:211]
    s_waitcnt lgkmcnt(4)
    v_accvgpr_write_b32 a46, v154
    v_accvgpr_write_b32 a47, v155
    v_mfma_f32_16x16x32_bf16 v[216:219], a[236:239], a[124:127], v[216:219]
    v_cvt_pk_bf16_f32 v160, v160, v161
    v_cvt_pk_bf16_f32 v161, v162, v163
    v_mfma_f32_16x16x32_bf16 v[216:219], a[232:235], a[108:111], v[216:219]
    ds_read_b64_tr_b16 a[232:233], v9 offset:26624
    v_cvt_pk_bf16_f32 v162, v164, v165
    v_mfma_f32_16x16x32_bf16 v[216:219], a[240:243], a[140:143], v[216:219]
    ds_read_b64_tr_b16 a[234:235], v9 offset:32768
    v_cvt_pk_bf16_f32 v163, v166, v167
    v_mfma_f32_16x16x32_bf16 v[216:219], a[244:247], a[156:159], v[216:219]
    ds_read_b64_tr_b16 a[236:237], v9 offset:38912
    v_cvt_pk_bf16_f32 v168, v168, v169
    v_mfma_f32_16x16x32_bf16 v[208:211], a[244:247], a[152:155], v[208:211]
    ds_read_b64_tr_b16 a[238:239], v9 offset:45056
    v_cvt_pk_bf16_f32 v169, v170, v171
    v_mfma_f32_16x16x32_bf16 v[208:211], a[240:243], a[136:139], v[208:211]
    v_permlane16_swap_b32 v160, v162
    v_mfma_f32_16x16x32_bf16 v[200:203], a[240:243], a[132:135], v[200:203]
    v_permlane16_swap_b32 v161, v163
    v_mfma_f32_16x16x32_bf16 v[200:203], a[244:247], a[148:151], v[200:203]
    s_waitcnt lgkmcnt(4)
    v_cvt_pk_bf16_f32 v170, v172, v173
    v_cvt_pk_bf16_f32 v171, v174, v175
    v_mfma_f32_16x16x32_bf16 v[192:195], a[244:247], a[144:147], v[192:195]
    v_permlane16_swap_b32 v168, v170
    v_mfma_f32_16x16x32_bf16 v[192:195], a[240:243], a[128:131], v[192:195]
    ds_read_b64_tr_b16 a[240:241], v10 offset:2048
    v_cvt_pk_bf16_f32 v176, v176, v177
    v_mfma_f32_16x16x32_bf16 v[196:199], a[224:227], a[96:99], v[196:199]
    ds_read_b64_tr_b16 a[242:243], v10 offset:8192
    v_cvt_pk_bf16_f32 v177, v178, v179
    v_mfma_f32_16x16x32_bf16 v[196:199], a[228:231], a[112:115], v[196:199]
    ds_read_b64_tr_b16 a[244:245], v10 offset:14336
    v_cvt_pk_bf16_f32 v178, v180, v181
    v_mfma_f32_16x16x32_bf16 v[204:207], a[228:231], a[116:119], v[204:207]
    ds_read_b64_tr_b16 a[246:247], v10 offset:20480
    v_cvt_pk_bf16_f32 v179, v182, v183
    v_mfma_f32_16x16x32_bf16 v[204:207], a[224:227], a[100:103], v[204:207]
    v_permlane16_swap_b32 v169, v171
    v_mfma_f32_16x16x32_bf16 v[212:215], a[224:227], a[104:107], v[212:215]
    v_permlane16_swap_b32 v176, v178
    v_mfma_f32_16x16x32_bf16 v[212:215], a[228:231], a[120:123], v[212:215]
    s_waitcnt lgkmcnt(4)
    v_permlane16_swap_b32 v177, v179
    v_mfma_f32_16x16x32_bf16 v[220:223], a[228:231], a[124:127], v[220:223]
    v_accvgpr_write_b32 a48, v160
    v_accvgpr_write_b32 a49, v161
    v_mfma_f32_16x16x32_bf16 v[220:223], a[224:227], a[108:111], v[220:223]
    ds_read_b64_tr_b16 a[224:225], v10 offset:26624
    v_accvgpr_write_b32 a50, v162
    v_mfma_f32_16x16x32_bf16 v[220:223], a[232:235], a[140:143], v[220:223]
    ds_read_b64_tr_b16 a[226:227], v10 offset:32768
    v_accvgpr_write_b32 a51, v163
    v_mfma_f32_16x16x32_bf16 v[220:223], a[236:239], a[156:159], v[220:223]
    ds_read_b64_tr_b16 a[228:229], v10 offset:38912
    v_cvt_pk_bf16_f32 v184, v184, v185
    v_mfma_f32_16x16x32_bf16 v[212:215], a[236:239], a[152:155], v[212:215]
    ds_read_b64_tr_b16 a[230:231], v10 offset:45056
    v_cvt_pk_bf16_f32 v185, v186, v187
    v_mfma_f32_16x16x32_bf16 v[212:215], a[232:235], a[136:139], v[212:215]
    v_cvt_pk_bf16_f32 v186, v188, v189
    v_cvt_pk_bf16_f32 v187, v190, v191
    v_mfma_f32_16x16x32_bf16 v[204:207], a[232:235], a[132:135], v[204:207]
    v_permlane16_swap_b32 v184, v186
    v_mfma_f32_16x16x32_bf16 v[204:207], a[236:239], a[148:151], v[204:207]
    s_waitcnt lgkmcnt(4)
    v_permlane16_swap_b32 v185, v187
    v_mfma_f32_16x16x32_bf16 v[196:199], a[236:239], a[144:147], v[196:199]
    v_accvgpr_write_b32 a52, v168
    v_accvgpr_write_b32 a53, v169
    v_mfma_f32_16x16x32_bf16 v[196:199], a[232:235], a[128:131], v[196:199]
    ds_read_b64_tr_b16 a[232:233], v11 offset:2048
    v_accvgpr_write_b32 a54, v170
    ds_read_b64_tr_b16 a[234:235], v11 offset:8192
    v_mfma_f32_16x16x32_bf16 v[224:227], a[240:243], a[96:99], v[224:227]
    ds_read_b64_tr_b16 a[236:237], v11 offset:14336
    v_accvgpr_write_b32 a55, v171
    ds_read_b64_tr_b16 a[238:239], v11 offset:20480
    v_mfma_f32_16x16x32_bf16 v[224:227], a[244:247], a[112:115], v[224:227]
    v_accvgpr_write_b32 a56, v176
    v_accvgpr_write_b32 a57, v177
    v_mfma_f32_16x16x32_bf16 v[232:235], a[244:247], a[116:119], v[232:235]
    v_accvgpr_write_b32 a58, v178
    v_accvgpr_write_b32 a59, v179
    v_mfma_f32_16x16x32_bf16 v[232:235], a[240:243], a[100:103], v[232:235]
    v_accvgpr_write_b32 a60, v184
    v_accvgpr_write_b32 a61, v185
    v_mfma_f32_16x16x32_bf16 v[240:243], a[240:243], a[104:107], v[240:243]
    v_accvgpr_write_b32 a62, v186
    v_accvgpr_write_b32 a63, v187
    v_mfma_f32_16x16x32_bf16 v[240:243], a[244:247], a[120:123], v[240:243]
    s_waitcnt lgkmcnt(4)
    v_cvt_pk_bf16_f32 v192, v192, v193
    v_cvt_pk_bf16_f32 v193, v194, v195
    v_mfma_f32_16x16x32_bf16 v[248:251], a[244:247], a[124:127], v[248:251]
    s_waitcnt lgkmcnt(0)
    s_barrier
    v_mfma_f32_16x16x32_bf16 v[248:251], a[240:243], a[108:111], v[248:251]
    s_add_u32 m0, s49, 49152
    ds_read_b128 a[184:187], v12 offset:0
    v_cvt_pk_bf16_f32 v194, v196, v197
    v_mfma_f32_16x16x32_bf16 v[248:251], a[224:227], a[140:143], v[248:251]
    ds_read_b128 a[188:191], v13 offset:0
    v_cvt_pk_bf16_f32 v195, v198, v199
    v_mfma_f32_16x16x32_bf16 v[248:251], a[228:231], a[156:159], v[248:251]
    ds_read_b128 a[192:195], v12 offset:1024
    v_cvt_pk_bf16_f32 v200, v200, v201
    v_mfma_f32_16x16x32_bf16 v[240:243], a[228:231], a[152:155], v[240:243]
    ds_read_b128 a[196:199], v13 offset:1024
    v_cvt_pk_bf16_f32 v201, v202, v203
    v_mfma_f32_16x16x32_bf16 v[240:243], a[224:227], a[136:139], v[240:243]
    ds_read_b128 a[200:203], v12 offset:2048
    v_cvt_pk_bf16_f32 v202, v204, v205
    v_mfma_f32_16x16x32_bf16 v[232:235], a[224:227], a[132:135], v[232:235]
    buffer_load_dwordx4 v4, s[12:15], s38 offen offset:0 lds
    v_mfma_f32_16x16x32_bf16 v[232:235], a[228:231], a[148:151], v[232:235]
    ds_read_b64_tr_b16 a[240:241], v11 offset:26624
    v_cvt_pk_bf16_f32 v203, v206, v207
    v_mfma_f32_16x16x32_bf16 v[224:227], a[228:231], a[144:147], v[224:227]
    ds_read_b64_tr_b16 a[242:243], v11 offset:32768
    v_cvt_pk_bf16_f32 v208, v208, v209
    v_mfma_f32_16x16x32_bf16 v[224:227], a[224:227], a[128:131], v[224:227]
    ds_read_b64_tr_b16 a[244:245], v11 offset:38912
    v_cvt_pk_bf16_f32 v209, v210, v211
    v_mfma_f32_16x16x32_bf16 v[228:231], a[232:235], a[96:99], v[228:231]
    ds_read_b64_tr_b16 a[246:247], v11 offset:45056
    v_cvt_pk_bf16_f32 v210, v212, v213
    v_mfma_f32_16x16x32_bf16 v[228:231], a[236:239], a[112:115], v[228:231]
    v_permlane16_swap_b32 v192, v194
    v_mfma_f32_16x16x32_bf16 v[236:239], a[236:239], a[116:119], v[236:239]
    s_addk_i32 m0, 896
    v_permlane16_swap_b32 v193, v195
    v_mfma_f32_16x16x32_bf16 v[236:239], a[232:235], a[100:103], v[236:239]
    v_permlane16_swap_b32 v200, v202
    v_mfma_f32_16x16x32_bf16 v[244:247], a[232:235], a[104:107], v[244:247]
    v_permlane16_swap_b32 v201, v203
    v_mfma_f32_16x16x32_bf16 v[244:247], a[236:239], a[120:123], v[244:247]
    s_waitcnt lgkmcnt(2)
    v_permlane16_swap_b32 v208, v210
    v_mfma_f32_16x16x32_bf16 v[252:255], a[236:239], a[124:127], v[252:255]
    ds_read_b128 a[204:207], v13 offset:2048
    v_cvt_pk_bf16_f32 v211, v214, v215
    v_mfma_f32_16x16x32_bf16 v[252:255], a[232:235], a[108:111], v[252:255]
    s_waitcnt lgkmcnt(1)
    v_permlane16_swap_b32 v209, v211
    v_mfma_f32_16x16x32_bf16 v[252:255], a[240:243], a[140:143], v[252:255]
    buffer_load_dwordx4 v4, s[12:15], s38 offen offset:128 lds
    v_mfma_f32_16x16x32_bf16 v[252:255], a[244:247], a[156:159], v[252:255]
    v_accvgpr_write_b32 a64, v192
    v_accvgpr_write_b32 a65, v193
    v_mfma_f32_16x16x32_bf16 v[244:247], a[244:247], a[152:155], v[244:247]
    ds_read_b128 a[208:211], v12 offset:6144
    v_accvgpr_write_b32 a66, v194
    v_mfma_f32_16x16x32_bf16 v[244:247], a[240:243], a[136:139], v[244:247]
    ds_read_b128 a[212:215], v13 offset:6144
    v_accvgpr_write_b32 a67, v195
    v_mfma_f32_16x16x32_bf16 v[236:239], a[240:243], a[132:135], v[236:239]
    ds_read_b128 a[216:219], v12 offset:7168
    v_cvt_pk_bf16_f32 v216, v216, v217
    v_mfma_f32_16x16x32_bf16 v[236:239], a[244:247], a[148:151], v[236:239]
    ds_read_b128 a[220:223], v13 offset:7168
    v_cvt_pk_bf16_f32 v217, v218, v219
    v_mfma_f32_16x16x32_bf16 v[228:231], a[244:247], a[144:147], v[228:231]
    s_addk_i32 m0, 896
    ds_read_b128 a[224:227], v12 offset:8192
    v_cvt_pk_bf16_f32 v218, v220, v221
    v_mfma_f32_16x16x32_bf16 v[228:231], a[240:243], a[128:131], v[228:231]
    ds_read_b128 a[228:231], v13 offset:8192
    v_cvt_pk_bf16_f32 v219, v222, v223
    v_mfma_f32_16x16x32_bf16 v[64:67], a[184:187], a[0:3], 0
    v_permlane16_swap_b32 v216, v218
    v_mfma_f32_16x16x32_bf16 v[64:67], a[188:191], a[16:19], v[64:67]
    v_permlane16_swap_b32 v217, v219
    v_mfma_f32_16x16x32_bf16 v[64:67], a[192:195], a[32:35], v[64:67]
    v_accvgpr_write_b32 a68, v200
    v_accvgpr_write_b32 a69, v201
    v_mfma_f32_16x16x32_bf16 v[64:67], a[196:199], a[48:51], v[64:67]
    v_accvgpr_write_b32 a70, v202
    v_accvgpr_write_b32 a71, v203
    v_mfma_f32_16x16x32_bf16 v[64:67], a[200:203], a[64:67], v[64:67]
    buffer_load_dwordx4 v4, s[12:15], s38 offen offset:256 lds
    v_mfma_f32_16x16x32_bf16 v[72:75], a[200:203], a[68:71], 0
    v_accvgpr_write_b32 a72, v208
    v_accvgpr_write_b32 a73, v209
    v_mfma_f32_16x16x32_bf16 v[72:75], a[196:199], a[52:55], v[72:75]
    v_accvgpr_write_b32 a74, v210
    v_accvgpr_write_b32 a75, v211
    v_mfma_f32_16x16x32_bf16 v[72:75], a[192:195], a[36:39], v[72:75]
    v_accvgpr_write_b32 a76, v216
    v_accvgpr_write_b32 a77, v217
    v_mfma_f32_16x16x32_bf16 v[72:75], a[188:191], a[20:23], v[72:75]
    v_accvgpr_write_b32 a78, v218
    v_accvgpr_write_b32 a79, v219
    v_mfma_f32_16x16x32_bf16 v[72:75], a[184:187], a[4:7], v[72:75]
    v_cvt_pk_bf16_f32 v224, v224, v225
    v_cvt_pk_bf16_f32 v225, v226, v227
    v_mfma_f32_16x16x32_bf16 v[80:83], a[184:187], a[8:11], 0
    s_addk_i32 m0, 1280
    v_cvt_pk_bf16_f32 v226, v228, v229
    v_cvt_pk_bf16_f32 v227, v230, v231
    v_mfma_f32_16x16x32_bf16 v[80:83], a[188:191], a[24:27], v[80:83]
    v_permlane16_swap_b32 v224, v226
    v_mfma_f32_16x16x32_bf16 v[80:83], a[192:195], a[40:43], v[80:83]
    v_permlane16_swap_b32 v225, v227
    v_mfma_f32_16x16x32_bf16 v[80:83], a[196:199], a[56:59], v[80:83]
    v_cvt_pk_bf16_f32 v232, v232, v233
    v_cvt_pk_bf16_f32 v233, v234, v235
    v_mfma_f32_16x16x32_bf16 v[80:83], a[200:203], a[72:75], v[80:83]
    v_cvt_pk_bf16_f32 v234, v236, v237
    v_cvt_pk_bf16_f32 v235, v238, v239
    v_mfma_f32_16x16x32_bf16 v[88:91], a[200:203], a[76:79], 0
    v_permlane16_swap_b32 v232, v234
    v_mfma_f32_16x16x32_bf16 v[88:91], a[196:199], a[60:63], v[88:91]
    buffer_load_dwordx4 v5, s[12:15], s38 offen offset:0 lds
    v_mfma_f32_16x16x32_bf16 v[88:91], a[192:195], a[44:47], v[88:91]
    s_waitcnt lgkmcnt(0)
    v_permlane16_swap_b32 v233, v235
    v_mfma_f32_16x16x32_bf16 v[88:91], a[188:191], a[28:31], v[88:91]
    v_cvt_pk_bf16_f32 v240, v240, v241
    v_cvt_pk_bf16_f32 v241, v242, v243
    v_mfma_f32_16x16x32_bf16 v[88:91], a[184:187], a[12:15], v[88:91]
    ds_read_b128 a[184:187], v12 offset:12288
    v_cvt_pk_bf16_f32 v242, v244, v245
    v_mfma_f32_16x16x32_bf16 v[64:67], a[204:207], v[224:227], v[64:67]
    ds_read_b128 a[188:191], v13 offset:12288
    v_cvt_pk_bf16_f32 v243, v246, v247
    v_cvt_pk_bf16_f32 v248, v248, v249
    v_cvt_pk_bf16_f32 v249, v250, v251
    v_mfma_f32_16x16x32_bf16 v[72:75], a[204:207], v[232:235], v[72:75]
    ds_read_b128 a[192:195], v12 offset:13312
    v_cvt_pk_bf16_f32 v250, v252, v253
    v_permlane16_swap_b32 v240, v242
    v_permlane16_swap_b32 v241, v243
    s_nop 1
    v_mfma_f32_16x16x32_bf16 v[80:83], a[204:207], v[240:243], v[80:83]
    s_addk_i32 m0, 896
    ds_read_b128 a[196:199], v13 offset:13312
    v_cvt_pk_bf16_f32 v251, v254, v255
    v_permlane16_swap_b32 v248, v250
    v_accvgpr_write_b32 a80, v224
    v_permlane16_swap_b32 v249, v251
    s_nop 1
    v_mfma_f32_16x16x32_bf16 v[88:91], a[204:207], v[248:251], v[88:91]
    ds_read_b128 a[200:203], v12 offset:14336
    v_accvgpr_write_b32 a81, v225
    v_mfma_f32_16x16x32_bf16 v[24:27], a[208:211], a[0:3], 0
    ds_read_b128 a[204:207], v13 offset:14336
    v_accvgpr_write_b32 a82, v226
    v_mfma_f32_16x16x32_bf16 v[24:27], a[212:215], a[16:19], v[24:27]
    v_exp_f32 v64, v64
    v_mfma_f32_16x16x32_bf16 v[24:27], a[216:219], a[32:35], v[24:27]
    v_exp_f32 v65, v65
    v_mfma_f32_16x16x32_bf16 v[24:27], a[220:223], a[48:51], v[24:27]
    v_exp_f32 v66, v66
    v_mfma_f32_16x16x32_bf16 v[24:27], a[224:227], a[64:67], v[24:27]
    buffer_load_dwordx4 v5, s[12:15], s38 offen offset:128 lds
    v_accvgpr_write_b32 a83, v227
    s_nop 1
    v_mfma_f32_16x16x32_bf16 v[24:27], a[228:231], a[80:83], v[24:27]
    v_exp_f32 v67, v67
    v_accvgpr_write_b32 a84, v232
    v_accvgpr_write_b32 a85, v233
    v_accvgpr_write_b32 a86, v234
    v_accvgpr_write_b32 a87, v235
    s_nop 1
    v_mfma_f32_16x16x32_bf16 v[28:31], a[228:231], a[84:87], 0
    v_exp_f32 v72, v72
    v_mfma_f32_16x16x32_bf16 v[28:31], a[224:227], a[68:71], v[28:31]
    v_exp_f32 v73, v73
    v_mfma_f32_16x16x32_bf16 v[28:31], a[220:223], a[52:55], v[28:31]
    v_exp_f32 v74, v74
    v_mfma_f32_16x16x32_bf16 v[28:31], a[216:219], a[36:39], v[28:31]
    v_exp_f32 v75, v75
    v_mfma_f32_16x16x32_bf16 v[28:31], a[212:215], a[20:23], v[28:31]
    s_addk_i32 m0, 896
    v_exp_f32 v80, v80
    v_mfma_f32_16x16x32_bf16 v[28:31], a[208:211], a[4:7], v[28:31]
    v_exp_f32 v81, v81
    v_mfma_f32_16x16x32_bf16 v[32:35], a[208:211], a[8:11], 0
    v_exp_f32 v82, v82
    v_mfma_f32_16x16x32_bf16 v[32:35], a[212:215], a[24:27], v[32:35]
    v_exp_f32 v83, v83
    v_mfma_f32_16x16x32_bf16 v[32:35], a[216:219], a[40:43], v[32:35]
    v_exp_f32 v88, v88
    v_mfma_f32_16x16x32_bf16 v[32:35], a[220:223], a[56:59], v[32:35]
    v_exp_f32 v89, v89
    v_mfma_f32_16x16x32_bf16 v[32:35], a[224:227], a[72:75], v[32:35]
    buffer_load_dwordx4 v5, s[12:15], s38 offen offset:256 lds
    v_accvgpr_write_b32 a88, v240
    v_accvgpr_write_b32 a89, v241
    v_accvgpr_write_b32 a90, v242
    v_accvgpr_write_b32 a91, v243
    s_nop 1
    v_mfma_f32_16x16x32_bf16 v[32:35], a[228:231], a[88:91], v[32:35]
    s_add_u32 s38, s38, 24576
    v_exp_f32 v90, v90
    v_accvgpr_write_b32 a92, v248
    v_accvgpr_write_b32 a93, v249
    v_accvgpr_write_b32 a94, v250
    v_accvgpr_write_b32 a95, v251
    s_nop 1
    v_mfma_f32_16x16x32_bf16 v[36:39], a[228:231], a[92:95], 0
    v_exp_f32 v91, v91
    v_mfma_f32_16x16x32_bf16 v[36:39], a[224:227], a[76:79], v[36:39]
    v_cvt_pk_bf16_f32 v64, v64, v65
    v_cvt_pk_bf16_f32 v65, v66, v67
    v_mfma_f32_16x16x32_bf16 v[36:39], a[220:223], a[60:63], v[36:39]
    s_add_u32 s39, s40, 49152
    v_exp_f32 v24, v24
    v_mfma_f32_16x16x32_bf16 v[36:39], a[216:219], a[44:47], v[36:39]
    s_waitcnt lgkmcnt(0)
    v_exp_f32 v25, v25
    v_mfma_f32_16x16x32_bf16 v[36:39], a[212:215], a[28:31], v[36:39]
    s_add_u32 m0, s63, 90112
    ds_read_b128 a[212:215], v13 offset:18432
    v_cvt_pk_bf16_f32 v72, v72, v73
    v_mfma_f32_16x16x32_bf16 v[36:39], a[208:211], a[12:15], v[36:39]
    ds_read_b128 a[220:223], v13 offset:19456
    v_cvt_pk_bf16_f32 v73, v74, v75
    v_mfma_f32_16x16x32_bf16 v[68:71], a[184:187], a[0:3], 0
    ds_read_b128 a[208:211], v12 offset:18432
    v_cvt_pk_bf16_f32 v80, v80, v81
    v_mfma_f32_16x16x32_bf16 v[68:71], a[188:191], a[16:19], v[68:71]
    ds_read_b128 a[216:219], v12 offset:19456
    v_cvt_pk_bf16_f32 v81, v82, v83
    v_mfma_f32_16x16x32_bf16 v[68:71], a[192:195], a[32:35], v[68:71]
    ds_read_b128 a[224:227], v12 offset:20480
    v_cvt_pk_bf16_f32 v88, v88, v89
    v_mfma_f32_16x16x32_bf16 v[68:71], a[196:199], a[48:51], v[68:71]
    ds_read_b128 a[228:231], v13 offset:20480
    v_cvt_pk_bf16_f32 v89, v90, v91
    v_mfma_f32_16x16x32_bf16 v[68:71], a[200:203], a[64:67], v[68:71]
    buffer_load_dwordx4 v6, s[16:19], s39 offen lds
    v_mfma_f32_16x16x32_bf16 v[68:71], a[204:207], a[80:83], v[68:71]
    v_exp_f32 v26, v26
    v_mfma_f32_16x16x32_bf16 v[76:79], a[204:207], a[84:87], 0
    v_exp_f32 v27, v27
    v_mfma_f32_16x16x32_bf16 v[76:79], a[200:203], a[68:71], v[76:79]
    v_exp_f32 v28, v28
    v_mfma_f32_16x16x32_bf16 v[76:79], a[196:199], a[52:55], v[76:79]
    s_add_u32 s39, s40, 61440
    v_exp_f32 v29, v29
    v_mfma_f32_16x16x32_bf16 v[76:79], a[192:195], a[36:39], v[76:79]
    v_exp_f32 v30, v30
    v_mfma_f32_16x16x32_bf16 v[76:79], a[188:191], a[20:23], v[76:79]
    s_addk_i32 m0, 4096
    v_exp_f32 v31, v31
    v_mfma_f32_16x16x32_bf16 v[76:79], a[184:187], a[4:7], v[76:79]
    v_cvt_pk_bf16_f32 v66, v24, v25
    v_cvt_pk_bf16_f32 v67, v26, v27
    v_mfma_f32_16x16x32_bf16 v[84:87], a[184:187], a[8:11], 0
    v_exp_f32 v32, v32
    v_mfma_f32_16x16x32_bf16 v[84:87], a[188:191], a[24:27], v[84:87]
    v_exp_f32 v33, v33
    v_mfma_f32_16x16x32_bf16 v[84:87], a[192:195], a[40:43], v[84:87]
    v_exp_f32 v34, v34
    v_mfma_f32_16x16x32_bf16 v[84:87], a[196:199], a[56:59], v[84:87]
    v_exp_f32 v35, v35
    v_mfma_f32_16x16x32_bf16 v[84:87], a[200:203], a[72:75], v[84:87]
    buffer_load_dwordx4 v6, s[16:19], s39 offen lds
    v_mfma_f32_16x16x32_bf16 v[84:87], a[204:207], a[88:91], v[84:87]
    v_cvt_pk_bf16_f32 v74, v28, v29
    v_cvt_pk_bf16_f32 v75, v30, v31
    v_mfma_f32_16x16x32_bf16 v[92:95], a[204:207], a[92:95], 0
pg_5:
    s_cbranch_execz pg_7
    v_exp_f32 v36, v36
    v_mfma_f32_16x16x32_bf16 v[92:95], a[200:203], a[76:79], v[92:95]
    v_exp_f32 v37, v37
    v_mfma_f32_16x16x32_bf16 v[92:95], a[196:199], a[60:63], v[92:95]
    v_exp_f32 v38, v38
    v_mfma_f32_16x16x32_bf16 v[92:95], a[192:195], a[44:47], v[92:95]
    s_waitcnt lgkmcnt(0)
    v_exp_f32 v39, v39
    v_mfma_f32_16x16x32_bf16 v[92:95], a[188:191], a[28:31], v[92:95]
    s_add_u32 m0, s49, 0
    v_add_u32 v8, v19, v8
    v_add_u32 v9, v19, v9
    v_mfma_f32_16x16x32_bf16 v[92:95], a[184:187], a[12:15], v[92:95]
    v_add_u32 v10, v19, v10
    v_add_u32 v11, v19, v11
    v_mfma_f32_16x16x32_bf16 v[40:43], a[208:211], a[0:3], 0
    s_waitcnt vmcnt(13)
    v_cvt_pk_bf16_f32 v82, v32, v33
    v_cvt_pk_bf16_f32 v83, v34, v35
    v_mfma_f32_16x16x32_bf16 v[40:43], a[212:215], a[16:19], v[40:43]
    s_barrier
    v_mfma_f32_16x16x32_bf16 v[40:43], a[216:219], a[32:35], v[40:43]
    ds_read_b128 a[184:187], v12 offset:24576
    v_cvt_pk_bf16_f32 v90, v36, v37
    v_mfma_f32_16x16x32_bf16 v[40:43], a[220:223], a[48:51], v[40:43]
    ds_read_b128 a[188:191], v13 offset:24576
    v_cvt_pk_bf16_f32 v91, v38, v39
    v_mfma_f32_16x16x32_bf16 v[40:43], a[224:227], a[64:67], v[40:43]
    buffer_load_dwordx4 v4, s[12:15], s38 offen offset:0 lds
    v_mfma_f32_16x16x32_bf16 v[40:43], a[228:231], a[80:83], v[40:43]
    v_exp_f32 v68, v68
    v_mfma_f32_16x16x32_bf16 v[44:47], a[228:231], a[84:87], 0
    v_exp_f32 v69, v69
    v_mfma_f32_16x16x32_bf16 v[44:47], a[224:227], a[68:71], v[44:47]
    ds_read_b128 a[192:195], v12 offset:25600
    v_cvt_pk_bf16_f32 v68, v68, v69
    v_mfma_f32_16x16x32_bf16 v[44:47], a[220:223], a[52:55], v[44:47]
    v_exp_f32 v70, v70
    v_mfma_f32_16x16x32_bf16 v[44:47], a[216:219], a[36:39], v[44:47]
    v_exp_f32 v71, v71
    v_mfma_f32_16x16x32_bf16 v[44:47], a[212:215], a[20:23], v[44:47]
    s_addk_i32 m0, 896
    ds_read_b128 a[196:199], v13 offset:25600
    v_cvt_pk_bf16_f32 v69, v70, v71
    v_mfma_f32_16x16x32_bf16 v[44:47], a[208:211], a[4:7], v[44:47]
    v_exp_f32 v76, v76
    v_mfma_f32_16x16x32_bf16 v[48:51], a[208:211], a[8:11], 0
    buffer_load_dword a252, v22, s[32:35], s42 offen offset:0
    v_mfma_f32_16x16x32_bf16 v[48:51], a[212:215], a[24:27], v[48:51]
    v_exp_f32 v77, v77
    v_mfma_f32_16x16x32_bf16 v[48:51], a[216:219], a[40:43], v[48:51]
    ds_read_b128 a[200:203], v12 offset:26624
    v_cvt_pk_bf16_f32 v76, v76, v77
    v_mfma_f32_16x16x32_bf16 v[48:51], a[220:223], a[56:59], v[48:51]
    v_exp_f32 v78, v78
    v_mfma_f32_16x16x32_bf16 v[48:51], a[224:227], a[72:75], v[48:51]
    buffer_load_dwordx4 v4, s[12:15], s38 offen offset:128 lds
    v_mfma_f32_16x16x32_bf16 v[48:51], a[228:231], a[88:91], v[48:51]
    v_exp_f32 v79, v79
    v_mfma_f32_16x16x32_bf16 v[52:55], a[228:231], a[92:95], 0
    ds_read_b128 a[204:207], v13 offset:26624
    v_cvt_pk_bf16_f32 v77, v78, v79
    v_mfma_f32_16x16x32_bf16 v[52:55], a[224:227], a[76:79], v[52:55]
    v_exp_f32 v84, v84
    v_mfma_f32_16x16x32_bf16 v[52:55], a[220:223], a[60:63], v[52:55]
    v_exp_f32 v85, v85
    v_mfma_f32_16x16x32_bf16 v[52:55], a[216:219], a[44:47], v[52:55]
    s_waitcnt lgkmcnt(1)
    v_exp_f32 v86, v86
    v_mfma_f32_16x16x32_bf16 v[52:55], a[212:215], a[28:31], v[52:55]
    s_addk_i32 m0, 896
    ds_read_b128 a[212:215], v13 offset:30720
    v_cvt_pk_bf16_f32 v84, v84, v85
    v_mfma_f32_16x16x32_bf16 v[52:55], a[208:211], a[12:15], v[52:55]
    v_exp_f32 v87, v87
    v_mfma_f32_16x16x32_bf16 v[96:99], a[184:187], a[0:3], 0
    ds_read_b128 a[220:223], v13 offset:31744
    v_cvt_pk_bf16_f32 v85, v86, v87
    v_mfma_f32_16x16x32_bf16 v[96:99], a[188:191], a[16:19], v[96:99]
    v_exp_f32 v92, v92
    v_mfma_f32_16x16x32_bf16 v[96:99], a[192:195], a[32:35], v[96:99]
    s_waitcnt lgkmcnt(2)
    v_exp_f32 v93, v93
    v_mfma_f32_16x16x32_bf16 v[96:99], a[196:199], a[48:51], v[96:99]
    ds_read_b128 a[208:211], v12 offset:30720
    v_cvt_pk_bf16_f32 v92, v92, v93
    v_mfma_f32_16x16x32_bf16 v[96:99], a[200:203], a[64:67], v[96:99]
    buffer_load_dwordx4 v4, s[12:15], s38 offen offset:256 lds
    v_mfma_f32_16x16x32_bf16 v[96:99], a[204:207], a[80:83], v[96:99]
    v_exp_f32 v94, v94
    v_mfma_f32_16x16x32_bf16 v[104:107], a[204:207], a[84:87], 0
    v_exp_f32 v95, v95
    v_mfma_f32_16x16x32_bf16 v[104:107], a[200:203], a[68:71], v[104:107]
    ds_read_b128 a[216:219], v12 offset:31744
    v_cvt_pk_bf16_f32 v93, v94, v95
    v_mfma_f32_16x16x32_bf16 v[104:107], a[196:199], a[52:55], v[104:107]
    v_exp_f32 v40, v40
    v_mfma_f32_16x16x32_bf16 v[104:107], a[192:195], a[36:39], v[104:107]
    v_exp_f32 v41, v41
    v_mfma_f32_16x16x32_bf16 v[104:107], a[188:191], a[20:23], v[104:107]
    s_addk_i32 m0, 1280
    ds_read_b128 a[224:227], v12 offset:32768
    v_cvt_pk_bf16_f32 v70, v40, v41
    v_mfma_f32_16x16x32_bf16 v[104:107], a[184:187], a[4:7], v[104:107]
    v_exp_f32 v42, v42
    v_mfma_f32_16x16x32_bf16 v[112:115], a[184:187], a[8:11], 0
    v_exp_f32 v43, v43
    v_mfma_f32_16x16x32_bf16 v[112:115], a[188:191], a[24:27], v[112:115]
    ds_read_b128 a[228:231], v13 offset:32768
    v_cvt_pk_bf16_f32 v71, v42, v43
    v_mfma_f32_16x16x32_bf16 v[112:115], a[192:195], a[40:43], v[112:115]
    v_exp_f32 v44, v44
    v_mfma_f32_16x16x32_bf16 v[112:115], a[196:199], a[56:59], v[112:115]
    v_exp_f32 v45, v45
    v_mfma_f32_16x16x32_bf16 v[112:115], a[200:203], a[72:75], v[112:115]
    buffer_load_dwordx4 v5, s[12:15], s38 offen offset:0 lds
    v_mfma_f32_16x16x32_bf16 v[112:115], a[204:207], a[88:91], v[112:115]
    v_exp_f32 v46, v46
    v_mfma_f32_16x16x32_bf16 v[120:123], a[204:207], a[92:95], 0
    ds_read_b64_tr_b16 a[232:233], v8 offset:0
    v_cvt_pk_bf16_f32 v78, v44, v45
    v_mfma_f32_16x16x32_bf16 v[120:123], a[200:203], a[76:79], v[120:123]
    v_exp_f32 v47, v47
    v_mfma_f32_16x16x32_bf16 v[120:123], a[196:199], a[60:63], v[120:123]
    ds_read_b64_tr_b16 a[234:235], v8 offset:2048
    v_cvt_pk_bf16_f32 v79, v46, v47
    v_mfma_f32_16x16x32_bf16 v[120:123], a[192:195], a[44:47], v[120:123]
    s_waitcnt lgkmcnt(2)
    v_exp_f32 v48, v48
    v_mfma_f32_16x16x32_bf16 v[120:123], a[188:191], a[28:31], v[120:123]
    s_addk_i32 m0, 896
    v_exp_f32 v49, v49
    v_mfma_f32_16x16x32_bf16 v[120:123], a[184:187], a[12:15], v[120:123]
    ds_read_b64_tr_b16 a[236:237], v9 offset:0
    v_cvt_pk_bf16_f32 v86, v48, v49
    v_mfma_f32_16x16x32_bf16 v[24:27], a[208:211], a[0:3], 0
    v_exp_f32 v50, v50
    v_mfma_f32_16x16x32_bf16 v[24:27], a[212:215], a[16:19], v[24:27]
    v_exp_f32 v51, v51
    v_mfma_f32_16x16x32_bf16 v[24:27], a[216:219], a[32:35], v[24:27]
    ds_read_b64_tr_b16 a[238:239], v9 offset:2048
    v_cvt_pk_bf16_f32 v87, v50, v51
    v_mfma_f32_16x16x32_bf16 v[24:27], a[220:223], a[48:51], v[24:27]
    v_exp_f32 v52, v52
    v_mfma_f32_16x16x32_bf16 v[24:27], a[224:227], a[64:67], v[24:27]
    buffer_load_dwordx4 v5, s[12:15], s38 offen offset:128 lds
    v_mfma_f32_16x16x32_bf16 v[24:27], a[228:231], a[80:83], v[24:27]
    v_exp_f32 v53, v53
    v_mfma_f32_16x16x32_bf16 v[28:31], a[228:231], a[84:87], 0
    ds_read_b128 a[184:187], v12 offset:36864
    v_cvt_pk_bf16_f32 v94, v52, v53
    v_mfma_f32_16x16x32_bf16 v[28:31], a[224:227], a[68:71], v[28:31]
    v_exp_f32 v54, v54
    v_mfma_f32_16x16x32_bf16 v[28:31], a[220:223], a[52:55], v[28:31]
    v_exp_f32 v55, v55
    v_mfma_f32_16x16x32_bf16 v[28:31], a[216:219], a[36:39], v[28:31]
    ds_read_b128 a[188:191], v13 offset:36864
    v_cvt_pk_bf16_f32 v95, v54, v55
    v_mfma_f32_16x16x32_bf16 v[28:31], a[212:215], a[20:23], v[28:31]
    s_addk_i32 m0, 896
    v_exp_f32 v96, v96
    v_mfma_f32_16x16x32_bf16 v[28:31], a[208:211], a[4:7], v[28:31]
    v_exp_f32 v97, v97
    v_mfma_f32_16x16x32_bf16 v[32:35], a[208:211], a[8:11], 0
    ds_read_b128 a[192:195], v12 offset:37888
    v_cvt_pk_bf16_f32 v96, v96, v97
    v_mfma_f32_16x16x32_bf16 v[32:35], a[212:215], a[24:27], v[32:35]
    v_exp_f32 v98, v98
    v_mfma_f32_16x16x32_bf16 v[32:35], a[216:219], a[40:43], v[32:35]
    v_exp_f32 v99, v99
    v_mfma_f32_16x16x32_bf16 v[32:35], a[220:223], a[56:59], v[32:35]
    ds_read_b128 a[196:199], v13 offset:37888
    v_cvt_pk_bf16_f32 v97, v98, v99
    v_mfma_f32_16x16x32_bf16 v[32:35], a[224:227], a[72:75], v[32:35]
    buffer_load_dwordx4 v5, s[12:15], s38 offen offset:256 lds
    v_mfma_f32_16x16x32_bf16 v[32:35], a[228:231], a[88:91], v[32:35]
    s_add_u32 s38, s38, 24576
    v_exp_f32 v104, v104
    v_mfma_f32_16x16x32_bf16 v[36:39], a[228:231], a[92:95], 0
    v_exp_f32 v105, v105
    v_mfma_f32_16x16x32_bf16 v[36:39], a[224:227], a[76:79], v[36:39]
    ds_read_b128 a[200:203], v12 offset:38912
    v_cvt_pk_bf16_f32 v104, v104, v105
    v_mfma_f32_16x16x32_bf16 v[36:39], a[220:223], a[60:63], v[36:39]
    s_add_u32 s39, s40, 73728
    v_exp_f32 v106, v106
    v_mfma_f32_16x16x32_bf16 v[36:39], a[216:219], a[44:47], v[36:39]
    s_waitcnt lgkmcnt(2)
    v_exp_f32 v107, v107
    v_mfma_f32_16x16x32_bf16 v[36:39], a[212:215], a[28:31], v[36:39]
    s_add_u32 m0, s63, 98304
    ds_read_b128 a[204:207], v13 offset:38912
    v_cvt_pk_bf16_f32 v105, v106, v107
    v_mfma_f32_16x16x32_bf16 v[36:39], a[208:211], a[12:15], v[36:39]
    v_exp_f32 v112, v112
    v_mfma_f32_16x16x32_bf16 a[152:155], a[232:235], v[64:67], 0
    v_exp_f32 v113, v113
    v_mfma_f32_16x16x32_bf16 a[168:171], a[236:239], v[64:67], 0
    v_exp_f32 v114, v114
    v_mfma_f32_16x16x32_bf16 a[172:175], a[236:239], v[72:75], 0
    ds_read_b128 a[208:211], v12 offset:43008
    v_cvt_pk_bf16_f32 v112, v112, v113
    v_mfma_f32_16x16x32_bf16 a[156:159], a[232:235], v[72:75], 0
    v_exp_f32 v115, v115
    v_mfma_f32_16x16x32_bf16 a[160:163], a[232:235], v[80:83], 0
    buffer_load_dwordx4 v6, s[16:19], s39 offen lds
    v_mfma_f32_16x16x32_bf16 a[176:179], a[236:239], v[80:83], 0
    ds_read_b128 a[212:215], v13 offset:43008
    v_cvt_pk_bf16_f32 v113, v114, v115
    v_mfma_f32_16x16x32_bf16 a[180:183], a[236:239], v[88:91], 0
    v_exp_f32 v120, v120
    v_mfma_f32_16x16x32_bf16 a[164:167], a[232:235], v[88:91], 0
    v_exp_f32 v121, v121
    v_mfma_f32_16x16x32_bf16 v[100:103], a[184:187], a[0:3], 0
    s_waitcnt lgkmcnt(2)
    ds_read_b128 a[216:219], v12 offset:44032
    v_cvt_pk_bf16_f32 v120, v120, v121
    v_mfma_f32_16x16x32_bf16 v[100:103], a[188:191], a[16:19], v[100:103]
    s_add_u32 s39, s40, 86016
    v_exp_f32 v122, v122
    v_mfma_f32_16x16x32_bf16 v[100:103], a[192:195], a[32:35], v[100:103]
    s_addk_i32 m0, 4096
    v_exp_f32 v123, v123
    v_mfma_f32_16x16x32_bf16 v[100:103], a[196:199], a[48:51], v[100:103]
    ds_read_b128 a[220:223], v13 offset:44032
    v_cvt_pk_bf16_f32 v121, v122, v123
    v_mfma_f32_16x16x32_bf16 v[100:103], a[200:203], a[64:67], v[100:103]
    v_exp_f32 v24, v24
    v_mfma_f32_16x16x32_bf16 v[100:103], a[204:207], a[80:83], v[100:103]
    v_exp_f32 v25, v25
    v_mfma_f32_16x16x32_bf16 v[108:111], a[204:207], a[84:87], 0
    ds_read_b128 a[224:227], v12 offset:45056
    v_cvt_pk_bf16_f32 v98, v24, v25
    v_mfma_f32_16x16x32_bf16 v[108:111], a[200:203], a[68:71], v[108:111]
    v_exp_f32 v26, v26
    v_mfma_f32_16x16x32_bf16 v[108:111], a[196:199], a[52:55], v[108:111]
    buffer_load_dwordx4 v6, s[16:19], s39 offen lds
    v_mfma_f32_16x16x32_bf16 v[108:111], a[192:195], a[36:39], v[108:111]
    v_exp_f32 v27, v27
    v_mfma_f32_16x16x32_bf16 v[108:111], a[188:191], a[20:23], v[108:111]
    ds_read_b128 a[228:231], v13 offset:45056
    v_cvt_pk_bf16_f32 v99, v26, v27
    v_mfma_f32_16x16x32_bf16 v[108:111], a[184:187], a[4:7], v[108:111]
    v_exp_f32 v28, v28
    v_mfma_f32_16x16x32_bf16 v[116:119], a[184:187], a[8:11], 0
    v_exp_f32 v29, v29
    v_mfma_f32_16x16x32_bf16 v[116:119], a[188:191], a[24:27], v[116:119]
    v_exp_f32 v30, v30
    v_mfma_f32_16x16x32_bf16 v[116:119], a[192:195], a[40:43], v[116:119]
    v_exp_f32 v31, v31
    v_mfma_f32_16x16x32_bf16 v[116:119], a[196:199], a[56:59], v[116:119]
    v_exp_f32 v32, v32
    v_mfma_f32_16x16x32_bf16 v[116:119], a[200:203], a[72:75], v[116:119]
    v_exp_f32 v33, v33
    v_mfma_f32_16x16x32_bf16 v[116:119], a[204:207], a[88:91], v[116:119]
    v_exp_f32 v34, v34
    v_mfma_f32_16x16x32_bf16 v[124:127], a[204:207], a[92:95], 0
    v_exp_f32 v35, v35
    v_mfma_f32_16x16x32_bf16 v[124:127], a[200:203], a[76:79], v[124:127]
    v_cvt_pk_bf16_f32 v106, v28, v29
    v_cvt_pk_bf16_f32 v107, v30, v31
    v_mfma_f32_16x16x32_bf16 v[124:127], a[196:199], a[60:63], v[124:127]
    s_add_u32 m0, s49, 24576
    v_exp_f32 v36, v36
    v_mfma_f32_16x16x32_bf16 v[124:127], a[192:195], a[44:47], v[124:127]
    s_waitcnt lgkmcnt(0)
    v_exp_f32 v37, v37
    v_mfma_f32_16x16x32_bf16 v[124:127], a[188:191], a[28:31], v[124:127]
    v_exp_f32 v38, v38
    v_mfma_f32_16x16x32_bf16 v[124:127], a[184:187], a[12:15], v[124:127]
    v_exp_f32 v39, v39
    v_mfma_f32_16x16x32_bf16 v[40:43], a[208:211], a[0:3], 0
    s_waitcnt vmcnt(11)
    v_cvt_pk_bf16_f32 v114, v32, v33
    v_cvt_pk_bf16_f32 v115, v34, v35
    v_mfma_f32_16x16x32_bf16 v[40:43], a[212:215], a[16:19], v[40:43]
    s_barrier
    v_mfma_f32_16x16x32_bf16 v[40:43], a[216:219], a[32:35], v[40:43]
    buffer_load_dwordx4 v4, s[12:15], s38 offen offset:0 lds
    v_mfma_f32_16x16x32_bf16 v[40:43], a[220:223], a[48:51], v[40:43]
    ds_read_b64_tr_b16 a[240:241], v8 offset:4096
    v_cvt_pk_bf16_f32 v122, v36, v37
    v_mfma_f32_16x16x32_bf16 v[40:43], a[224:227], a[64:67], v[40:43]
    ds_read_b64_tr_b16 a[242:243], v8 offset:6144
    v_cvt_pk_bf16_f32 v123, v38, v39
    v_mfma_f32_16x16x32_bf16 v[40:43], a[228:231], a[80:83], v[40:43]
    v_exp_f32 v100, v100
    v_mfma_f32_16x16x32_bf16 v[44:47], a[228:231], a[84:87], 0
    v_exp_f32 v101, v101
    v_mfma_f32_16x16x32_bf16 v[44:47], a[224:227], a[68:71], v[44:47]
    ds_read_b64_tr_b16 a[244:245], v9 offset:4096
    v_cvt_pk_bf16_f32 v100, v100, v101
    v_mfma_f32_16x16x32_bf16 v[44:47], a[220:223], a[52:55], v[44:47]
    s_addk_i32 m0, 896
    v_exp_f32 v102, v102
    v_mfma_f32_16x16x32_bf16 v[44:47], a[216:219], a[36:39], v[44:47]
    v_exp_f32 v103, v103
    v_mfma_f32_16x16x32_bf16 v[44:47], a[212:215], a[20:23], v[44:47]
    ds_read_b64_tr_b16 a[246:247], v9 offset:6144
    v_cvt_pk_bf16_f32 v101, v102, v103
    v_mfma_f32_16x16x32_bf16 v[44:47], a[208:211], a[4:7], v[44:47]
    v_exp_f32 v108, v108
    v_mfma_f32_16x16x32_bf16 v[48:51], a[208:211], a[8:11], 0
    buffer_load_dword a252, v22, s[32:35], s42 offen offset:1536
    s_add_u32 s42, s42, 3072
    v_mfma_f32_16x16x32_bf16 v[48:51], a[212:215], a[24:27], v[48:51]
    v_exp_f32 v109, v109
    v_mfma_f32_16x16x32_bf16 v[48:51], a[216:219], a[40:43], v[48:51]
    buffer_load_dwordx4 v4, s[12:15], s38 offen offset:128 lds
    v_mfma_f32_16x16x32_bf16 v[48:51], a[220:223], a[56:59], v[48:51]
    ds_read_b128 a[184:187], v12 offset:49152
    v_cvt_pk_bf16_f32 v108, v108, v109
    v_mfma_f32_16x16x32_bf16 v[48:51], a[224:227], a[72:75], v[48:51]
    v_exp_f32 v110, v110
    v_mfma_f32_16x16x32_bf16 v[48:51], a[228:231], a[88:91], v[48:51]
    v_exp_f32 v111, v111
    v_mfma_f32_16x16x32_bf16 v[52:55], a[228:231], a[92:95], 0
    ds_read_b128 a[188:191], v13 offset:49152
    v_cvt_pk_bf16_f32 v109, v110, v111
    v_mfma_f32_16x16x32_bf16 v[52:55], a[224:227], a[76:79], v[52:55]
    v_exp_f32 v116, v116
    v_mfma_f32_16x16x32_bf16 v[52:55], a[220:223], a[60:63], v[52:55]
    s_addk_i32 m0, 896
    ds_read_b128 a[192:195], v12 offset:50176
    v_accvgpr_write_b32 a96, v64
    v_mfma_f32_16x16x32_bf16 v[52:55], a[216:219], a[44:47], v[52:55]
    s_waitcnt lgkmcnt(3)
    v_exp_f32 v117, v117
    v_mfma_f32_16x16x32_bf16 v[52:55], a[212:215], a[28:31], v[52:55]
    ds_read_b128 a[196:199], v13 offset:50176
    v_cvt_pk_bf16_f32 v116, v116, v117
    v_mfma_f32_16x16x32_bf16 v[52:55], a[208:211], a[12:15], v[52:55]
    v_exp_f32 v118, v118
    v_mfma_f32_16x16x32_bf16 a[164:167], a[240:243], v[92:95], a[164:167]
    v_exp_f32 v119, v119
    v_mfma_f32_16x16x32_bf16 a[180:183], a[244:247], v[92:95], a[180:183]
    ds_read_b128 a[200:203], v12 offset:51200
    v_cvt_pk_bf16_f32 v117, v118, v119
    v_mfma_f32_16x16x32_bf16 a[176:179], a[244:247], v[84:87], a[176:179]
    buffer_load_dwordx4 v4, s[12:15], s38 offen offset:256 lds
    v_mfma_f32_16x16x32_bf16 a[160:163], a[240:243], v[84:87], a[160:163]
    ds_read_b128 a[204:207], v13 offset:51200
    v_accvgpr_write_b32 a97, v65
    v_mfma_f32_16x16x32_bf16 a[156:159], a[240:243], v[76:79], a[156:159]
    v_exp_f32 v124, v124
    v_mfma_f32_16x16x32_bf16 a[172:175], a[244:247], v[76:79], a[172:175]
    s_waitcnt lgkmcnt(2)
    v_exp_f32 v125, v125
    v_mfma_f32_16x16x32_bf16 a[168:171], a[244:247], v[68:71], a[168:171]
    ds_read_b128 a[208:211], v12 offset:55296
    v_cvt_pk_bf16_f32 v124, v124, v125
    v_mfma_f32_16x16x32_bf16 a[152:155], a[240:243], v[68:71], a[152:155]
    v_exp_f32 v126, v126
    v_mfma_f32_16x16x32_bf16 v[128:131], a[184:187], a[0:3], 0
    s_addk_i32 m0, 1280
    v_exp_f32 v127, v127
    v_mfma_f32_16x16x32_bf16 v[128:131], a[188:191], a[16:19], v[128:131]
    s_waitcnt lgkmcnt(2)
    ds_read_b128 a[212:215], v13 offset:55296
    v_cvt_pk_bf16_f32 v125, v126, v127
    v_mfma_f32_16x16x32_bf16 v[128:131], a[192:195], a[32:35], v[128:131]
    s_waitcnt lgkmcnt(2)
    v_exp_f32 v40, v40
    v_mfma_f32_16x16x32_bf16 v[128:131], a[196:199], a[48:51], v[128:131]
    ds_read_b128 a[216:219], v12 offset:56320
    v_accvgpr_write_b32 a98, v66
    v_mfma_f32_16x16x32_bf16 v[128:131], a[200:203], a[64:67], v[128:131]
    v_exp_f32 v41, v41
    v_mfma_f32_16x16x32_bf16 v[128:131], a[204:207], a[80:83], v[128:131]
    ds_read_b128 a[220:223], v13 offset:56320
    v_cvt_pk_bf16_f32 v102, v40, v41
    v_mfma_f32_16x16x32_bf16 v[136:139], a[204:207], a[84:87], 0
    buffer_load_dwordx4 v5, s[12:15], s38 offen offset:0 lds
    v_mfma_f32_16x16x32_bf16 v[136:139], a[200:203], a[68:71], v[136:139]
    v_exp_f32 v42, v42
    v_mfma_f32_16x16x32_bf16 v[136:139], a[196:199], a[52:55], v[136:139]
    v_exp_f32 v43, v43
    v_mfma_f32_16x16x32_bf16 v[136:139], a[192:195], a[36:39], v[136:139]
    ds_read_b128 a[224:227], v12 offset:57344
    v_cvt_pk_bf16_f32 v103, v42, v43
    v_mfma_f32_16x16x32_bf16 v[136:139], a[188:191], a[20:23], v[136:139]
    v_exp_f32 v44, v44
    v_mfma_f32_16x16x32_bf16 v[136:139], a[184:187], a[4:7], v[136:139]
    ds_read_b128 a[228:231], v13 offset:57344
    v_accvgpr_write_b32 a99, v67
    v_mfma_f32_16x16x32_bf16 v[144:147], a[184:187], a[8:11], 0
    s_addk_i32 m0, 896
    v_exp_f32 v45, v45
    v_mfma_f32_16x16x32_bf16 v[144:147], a[188:191], a[24:27], v[144:147]
    v_exp_f32 v46, v46
    v_mfma_f32_16x16x32_bf16 v[144:147], a[192:195], a[40:43], v[144:147]
    v_exp_f32 v47, v47
    v_mfma_f32_16x16x32_bf16 v[144:147], a[196:199], a[56:59], v[144:147]
    v_exp_f32 v48, v48
    v_mfma_f32_16x16x32_bf16 v[144:147], a[200:203], a[72:75], v[144:147]
    v_exp_f32 v49, v49
    v_mfma_f32_16x16x32_bf16 v[144:147], a[204:207], a[88:91], v[144:147]
    v_exp_f32 v50, v50
    v_mfma_f32_16x16x32_bf16 v[152:155], a[204:207], a[92:95], 0
    buffer_load_dwordx4 v5, s[12:15], s38 offen offset:128 lds
    v_mfma_f32_16x16x32_bf16 v[152:155], a[200:203], a[76:79], v[152:155]
    ds_read_b64_tr_b16 a[232:233], v8 offset:8192
    v_cvt_pk_bf16_f32 v110, v44, v45
    v_mfma_f32_16x16x32_bf16 v[152:155], a[196:199], a[60:63], v[152:155]
    ds_read_b64_tr_b16 a[234:235], v8 offset:10240
    v_cvt_pk_bf16_f32 v111, v46, v47
    v_mfma_f32_16x16x32_bf16 v[152:155], a[192:195], a[44:47], v[152:155]
    s_waitcnt lgkmcnt(2)
    ds_read_b64_tr_b16 a[236:237], v9 offset:8192
    v_cvt_pk_bf16_f32 v118, v48, v49
    v_mfma_f32_16x16x32_bf16 v[152:155], a[188:191], a[28:31], v[152:155]
    ds_read_b64_tr_b16 a[238:239], v9 offset:10240
    v_accvgpr_write_b32 a100, v68
    v_mfma_f32_16x16x32_bf16 v[152:155], a[184:187], a[12:15], v[152:155]
    v_exp_f32 v51, v51
    v_mfma_f32_16x16x32_bf16 v[24:27], a[208:211], a[0:3], 0
    s_addk_i32 m0, 896
    v_exp_f32 v52, v52
    v_mfma_f32_16x16x32_bf16 v[24:27], a[212:215], a[16:19], v[24:27]
    v_exp_f32 v53, v53
    v_mfma_f32_16x16x32_bf16 v[24:27], a[216:219], a[32:35], v[24:27]
    ds_read_b128 a[184:187], v12 offset:61440
    v_cvt_pk_bf16_f32 v119, v50, v51
    v_mfma_f32_16x16x32_bf16 v[24:27], a[220:223], a[48:51], v[24:27]
    ds_read_b128 a[188:191], v13 offset:61440
    v_cvt_pk_bf16_f32 v126, v52, v53
    v_mfma_f32_16x16x32_bf16 v[24:27], a[224:227], a[64:67], v[24:27]
    ds_read_b128 a[192:195], v12 offset:62464
    v_accvgpr_write_b32 a101, v69
    v_mfma_f32_16x16x32_bf16 v[24:27], a[228:231], a[80:83], v[24:27]
    v_exp_f32 v54, v54
    v_mfma_f32_16x16x32_bf16 v[28:31], a[228:231], a[84:87], 0
    buffer_load_dwordx4 v5, s[12:15], s38 offen offset:256 lds
    v_mfma_f32_16x16x32_bf16 v[28:31], a[224:227], a[68:71], v[28:31]
    s_add_u32 s38, s38, 24576
    v_exp_f32 v55, v55
    v_mfma_f32_16x16x32_bf16 v[28:31], a[220:223], a[52:55], v[28:31]
    ds_read_b128 a[196:199], v13 offset:62464
    v_cvt_pk_bf16_f32 v127, v54, v55
    v_mfma_f32_16x16x32_bf16 v[28:31], a[216:219], a[36:39], v[28:31]
    v_exp_f32 v128, v128
    v_mfma_f32_16x16x32_bf16 v[28:31], a[212:215], a[20:23], v[28:31]
    s_add_u32 s39, s40, 98304
    ds_read_b128 a[200:203], v12 offset:63488
    v_add_u32 v12, 67584, v12
    v_mfma_f32_16x16x32_bf16 v[28:31], a[208:211], a[4:7], v[28:31]
    ds_read_b128 a[204:207], v13 offset:63488
    v_add_u32 v13, 67584, v13
    v_mfma_f32_16x16x32_bf16 v[32:35], a[208:211], a[8:11], 0
    s_add_u32 m0, s63, 106496
    v_exp_f32 v129, v129
    v_mfma_f32_16x16x32_bf16 v[32:35], a[212:215], a[24:27], v[32:35]
    v_exp_f32 v130, v130
    v_mfma_f32_16x16x32_bf16 v[32:35], a[216:219], a[40:43], v[32:35]
    v_exp_f32 v131, v131
    v_mfma_f32_16x16x32_bf16 v[32:35], a[220:223], a[56:59], v[32:35]
    v_exp_f32 v136, v136
    v_mfma_f32_16x16x32_bf16 v[32:35], a[224:227], a[72:75], v[32:35]
    v_exp_f32 v137, v137
    v_mfma_f32_16x16x32_bf16 v[32:35], a[228:231], a[88:91], v[32:35]
    v_exp_f32 v138, v138
    v_mfma_f32_16x16x32_bf16 v[36:39], a[228:231], a[92:95], 0
    buffer_load_dwordx4 v6, s[16:19], s39 offen lds
    v_mfma_f32_16x16x32_bf16 v[36:39], a[224:227], a[76:79], v[36:39]
    v_exp_f32 v139, v139
    v_mfma_f32_16x16x32_bf16 v[36:39], a[220:223], a[60:63], v[36:39]
    v_cvt_pk_bf16_f32 v128, v128, v129
    v_cvt_pk_bf16_f32 v129, v130, v131
    v_mfma_f32_16x16x32_bf16 v[36:39], a[216:219], a[44:47], v[36:39]
    s_waitcnt lgkmcnt(0)
    v_exp_f32 v144, v144
    v_mfma_f32_16x16x32_bf16 v[36:39], a[212:215], a[28:31], v[36:39]
    s_add_u32 s39, s40, 110592
    v_exp_f32 v145, v145
    v_mfma_f32_16x16x32_bf16 v[36:39], a[208:211], a[12:15], v[36:39]
    v_exp_f32 v146, v146
    v_mfma_f32_16x16x32_bf16 a[152:155], a[232:235], v[96:99], a[152:155]
    s_addk_i32 m0, 4096
    v_exp_f32 v147, v147
    v_mfma_f32_16x16x32_bf16 a[168:171], a[236:239], v[96:99], a[168:171]
    v_cvt_pk_bf16_f32 v136, v136, v137
    v_cvt_pk_bf16_f32 v137, v138, v139
    v_mfma_f32_16x16x32_bf16 a[172:175], a[236:239], v[104:107], a[172:175]
    ds_read_b128 a[208:211], v12 offset:0
    v_cvt_pk_bf16_f32 v144, v144, v145
    v_mfma_f32_16x16x32_bf16 a[156:159], a[232:235], v[104:107], a[156:159]
    ds_read_b128 a[212:215], v13 offset:0
    v_cvt_pk_bf16_f32 v145, v146, v147
    v_mfma_f32_16x16x32_bf16 a[160:163], a[232:235], v[112:115], a[160:163]
    ds_read_b128 a[216:219], v12 offset:1024
    v_accvgpr_write_b32 a102, v70
    v_mfma_f32_16x16x32_bf16 a[176:179], a[236:239], v[112:115], a[176:179]
    ds_read_b128 a[220:223], v13 offset:1024
    v_accvgpr_write_b32 a103, v71
    v_mfma_f32_16x16x32_bf16 a[180:183], a[236:239], v[120:123], a[180:183]
    buffer_load_dwordx4 v6, s[16:19], s39 offen lds
    v_mfma_f32_16x16x32_bf16 a[164:167], a[232:235], v[120:123], a[164:167]
    ds_read_b128 a[224:227], v12 offset:2048
    v_accvgpr_write_b32 a104, v72
    v_mfma_f32_16x16x32_bf16 v[132:135], a[184:187], a[0:3], 0
    ds_read_b128 a[228:231], v13 offset:2048
    v_subrev_u32 v12, 67584, v12
    v_mfma_f32_16x16x32_bf16 v[132:135], a[188:191], a[16:19], v[132:135]
    v_exp_f32 v152, v152
    v_mfma_f32_16x16x32_bf16 v[132:135], a[192:195], a[32:35], v[132:135]
    v_exp_f32 v153, v153
    v_mfma_f32_16x16x32_bf16 v[132:135], a[196:199], a[48:51], v[132:135]
    v_exp_f32 v154, v154
    v_mfma_f32_16x16x32_bf16 v[132:135], a[200:203], a[64:67], v[132:135]
    v_exp_f32 v155, v155
    v_mfma_f32_16x16x32_bf16 v[132:135], a[204:207], a[80:83], v[132:135]
    v_exp_f32 v24, v24
    v_mfma_f32_16x16x32_bf16 v[140:143], a[204:207], a[84:87], 0
    v_exp_f32 v25, v25
    v_mfma_f32_16x16x32_bf16 v[140:143], a[200:203], a[68:71], v[140:143]
    v_exp_f32 v26, v26
    v_mfma_f32_16x16x32_bf16 v[140:143], a[196:199], a[52:55], v[140:143]
    v_exp_f32 v27, v27
    v_mfma_f32_16x16x32_bf16 v[140:143], a[192:195], a[36:39], v[140:143]
    v_cvt_pk_bf16_f32 v152, v152, v153
    v_cvt_pk_bf16_f32 v153, v154, v155
    v_mfma_f32_16x16x32_bf16 v[140:143], a[188:191], a[20:23], v[140:143]
    v_exp_f32 v28, v28
    v_mfma_f32_16x16x32_bf16 v[140:143], a[184:187], a[4:7], v[140:143]
    v_exp_f32 v29, v29
    v_mfma_f32_16x16x32_bf16 v[148:151], a[184:187], a[8:11], 0
    v_exp_f32 v30, v30
    v_mfma_f32_16x16x32_bf16 v[148:151], a[188:191], a[24:27], v[148:151]
    v_exp_f32 v31, v31
    v_mfma_f32_16x16x32_bf16 v[148:151], a[192:195], a[40:43], v[148:151]
    v_cvt_pk_bf16_f32 v130, v24, v25
    v_cvt_pk_bf16_f32 v131, v26, v27
    v_mfma_f32_16x16x32_bf16 v[148:151], a[196:199], a[56:59], v[148:151]
    v_exp_f32 v32, v32
    v_mfma_f32_16x16x32_bf16 v[148:151], a[200:203], a[72:75], v[148:151]
    v_exp_f32 v33, v33
    v_mfma_f32_16x16x32_bf16 v[148:151], a[204:207], a[88:91], v[148:151]
    v_exp_f32 v34, v34
    v_mfma_f32_16x16x32_bf16 v[156:159], a[204:207], a[92:95], 0
    v_exp_f32 v35, v35
    v_mfma_f32_16x16x32_bf16 v[156:159], a[200:203], a[76:79], v[156:159]
    v_cvt_pk_bf16_f32 v138, v28, v29
    v_cvt_pk_bf16_f32 v139, v30, v31
    v_mfma_f32_16x16x32_bf16 v[156:159], a[196:199], a[60:63], v[156:159]
    s_add_u32 m0, s49, 49152
    v_exp_f32 v36, v36
    v_mfma_f32_16x16x32_bf16 v[156:159], a[192:195], a[44:47], v[156:159]
    s_waitcnt lgkmcnt(0)
    v_exp_f32 v37, v37
    v_mfma_f32_16x16x32_bf16 v[156:159], a[188:191], a[28:31], v[156:159]
    v_exp_f32 v38, v38
    v_mfma_f32_16x16x32_bf16 v[156:159], a[184:187], a[12:15], v[156:159]
    v_exp_f32 v39, v39
    v_mfma_f32_16x16x32_bf16 v[40:43], a[208:211], a[0:3], 0
    s_waitcnt vmcnt(11)
    v_cvt_pk_bf16_f32 v146, v32, v33
    v_cvt_pk_bf16_f32 v147, v34, v35
    v_mfma_f32_16x16x32_bf16 v[40:43], a[212:215], a[16:19], v[40:43]
    s_barrier
    v_mfma_f32_16x16x32_bf16 v[40:43], a[216:219], a[32:35], v[40:43]
    buffer_load_dwordx4 v4, s[12:15], s38 offen offset:0 lds
    v_mfma_f32_16x16x32_bf16 v[40:43], a[220:223], a[48:51], v[40:43]
    ds_read_b64_tr_b16 a[240:241], v8 offset:12288
    v_cvt_pk_bf16_f32 v154, v36, v37
    v_mfma_f32_16x16x32_bf16 v[40:43], a[224:227], a[64:67], v[40:43]
    ds_read_b64_tr_b16 a[242:243], v8 offset:14336
    v_cvt_pk_bf16_f32 v155, v38, v39
    v_mfma_f32_16x16x32_bf16 v[40:43], a[228:231], a[80:83], v[40:43]
    ds_read_b64_tr_b16 a[244:245], v9 offset:12288
    v_accvgpr_write_b32 a105, v73
    v_mfma_f32_16x16x32_bf16 v[44:47], a[228:231], a[84:87], 0
    ds_read_b64_tr_b16 a[246:247], v9 offset:14336
    v_subrev_u32 v13, 67584, v13
    v_mfma_f32_16x16x32_bf16 v[44:47], a[224:227], a[68:71], v[44:47]
    ds_read_b128 a[184:187], v12 offset:0
    v_accvgpr_write_b32 a106, v74
    v_mfma_f32_16x16x32_bf16 v[44:47], a[220:223], a[52:55], v[44:47]
    s_addk_i32 m0, 896
    ds_read_b128 a[188:191], v13 offset:0
    v_accvgpr_write_b32 a107, v75
    v_mfma_f32_16x16x32_bf16 v[44:47], a[216:219], a[36:39], v[44:47]
    ds_read_b128 a[192:195], v12 offset:1024
    v_accvgpr_write_b32 a108, v76
    v_mfma_f32_16x16x32_bf16 v[44:47], a[212:215], a[20:23], v[44:47]
    ds_read_b128 a[196:199], v13 offset:1024
    v_accvgpr_write_b32 a109, v77
    v_mfma_f32_16x16x32_bf16 v[44:47], a[208:211], a[4:7], v[44:47]
    v_exp_f32 v132, v132
    v_mfma_f32_16x16x32_bf16 v[48:51], a[208:211], a[8:11], 0
    buffer_load_dword a252, v22, s[32:35], s42 offen offset:0
    v_mfma_f32_16x16x32_bf16 v[48:51], a[212:215], a[24:27], v[48:51]
    v_exp_f32 v133, v133
    v_mfma_f32_16x16x32_bf16 v[48:51], a[216:219], a[40:43], v[48:51]
    buffer_load_dwordx4 v4, s[12:15], s38 offen offset:128 lds
    v_mfma_f32_16x16x32_bf16 v[48:51], a[220:223], a[56:59], v[48:51]
    ds_read_b128 a[200:203], v12 offset:2048
    v_cvt_pk_bf16_f32 v132, v132, v133
    v_mfma_f32_16x16x32_bf16 v[48:51], a[224:227], a[72:75], v[48:51]
pg_6:
    s_cbranch_execz pg_8
    v_exp_f32 v134, v134
    v_mfma_f32_16x16x32_bf16 v[48:51], a[228:231], a[88:91], v[48:51]
    ds_read_b128 a[204:207], v13 offset:2048
    v_accvgpr_write_b32 a110, v78
    v_mfma_f32_16x16x32_bf16 v[52:55], a[228:231], a[92:95], 0
    v_exp_f32 v135, v135
    v_mfma_f32_16x16x32_bf16 v[52:55], a[224:227], a[76:79], v[52:55]
    v_exp_f32 v140, v140
    v_mfma_f32_16x16x32_bf16 v[52:55], a[220:223], a[60:63], v[52:55]
    s_addk_i32 m0, 896
    v_exp_f32 v141, v141
    v_mfma_f32_16x16x32_bf16 v[52:55], a[216:219], a[44:47], v[52:55]
    s_waitcnt lgkmcnt(2)
    v_exp_f32 v142, v142
    v_mfma_f32_16x16x32_bf16 v[52:55], a[212:215], a[28:31], v[52:55]
    v_exp_f32 v143, v143
    v_mfma_f32_16x16x32_bf16 v[52:55], a[208:211], a[12:15], v[52:55]
    v_exp_f32 v148, v148
    v_mfma_f32_16x16x32_bf16 a[164:167], a[240:243], v[124:127], a[164:167]
    v_exp_f32 v149, v149
    v_mfma_f32_16x16x32_bf16 a[180:183], a[244:247], v[124:127], a[180:183]
    v_cvt_pk_bf16_f32 v133, v134, v135
    v_cvt_pk_bf16_f32 v140, v140, v141
    v_mfma_f32_16x16x32_bf16 a[176:179], a[244:247], v[116:119], a[176:179]
    buffer_load_dwordx4 v4, s[12:15], s38 offen offset:256 lds
    v_mfma_f32_16x16x32_bf16 a[160:163], a[240:243], v[116:119], a[160:163]
    ds_read_b128 a[208:211], v12 offset:6144
    v_cvt_pk_bf16_f32 v141, v142, v143
    v_mfma_f32_16x16x32_bf16 a[156:159], a[240:243], v[108:111], a[156:159]
    ds_read_b128 a[212:215], v13 offset:6144
    v_cvt_pk_bf16_f32 v148, v148, v149
    v_mfma_f32_16x16x32_bf16 a[172:175], a[244:247], v[108:111], a[172:175]
    ds_read_b128 a[216:219], v12 offset:7168
    v_accvgpr_write_b32 a111, v79
    v_mfma_f32_16x16x32_bf16 a[168:171], a[244:247], v[100:103], a[168:171]
    v_exp_f32 v150, v150
    v_mfma_f32_16x16x32_bf16 a[152:155], a[240:243], v[100:103], a[152:155]
    v_exp_f32 v151, v151
    v_mfma_f32_16x16x32_bf16 v[160:163], a[184:187], a[0:3], 0
    s_addk_i32 m0, 1280
    ds_read_b128 a[220:223], v13 offset:7168
    v_cvt_pk_bf16_f32 v149, v150, v151
    v_mfma_f32_16x16x32_bf16 v[160:163], a[188:191], a[16:19], v[160:163]
    s_waitcnt lgkmcnt(4)
    ds_read_b128 a[224:227], v12 offset:8192
    v_accvgpr_write_b32 a112, v80
    v_mfma_f32_16x16x32_bf16 v[160:163], a[192:195], a[32:35], v[160:163]
    v_exp_f32 v156, v156
    v_mfma_f32_16x16x32_bf16 v[160:163], a[196:199], a[48:51], v[160:163]
    v_exp_f32 v157, v157
    v_mfma_f32_16x16x32_bf16 v[160:163], a[200:203], a[64:67], v[160:163]
    ds_read_b128 a[228:231], v13 offset:8192
    v_cvt_pk_bf16_f32 v156, v156, v157
    v_mfma_f32_16x16x32_bf16 v[160:163], a[204:207], a[80:83], v[160:163]
    v_exp_f32 v158, v158
    v_mfma_f32_16x16x32_bf16 v[168:171], a[204:207], a[84:87], 0
    buffer_load_dwordx4 v5, s[12:15], s38 offen offset:0 lds
    v_mfma_f32_16x16x32_bf16 v[168:171], a[200:203], a[68:71], v[168:171]
    v_exp_f32 v159, v159
    v_mfma_f32_16x16x32_bf16 v[168:171], a[196:199], a[52:55], v[168:171]
    v_exp_f32 v40, v40
    v_mfma_f32_16x16x32_bf16 v[168:171], a[192:195], a[36:39], v[168:171]
    v_exp_f32 v41, v41
    v_mfma_f32_16x16x32_bf16 v[168:171], a[188:191], a[20:23], v[168:171]
    v_exp_f32 v42, v42
    v_mfma_f32_16x16x32_bf16 v[168:171], a[184:187], a[4:7], v[168:171]
    v_exp_f32 v43, v43
    v_mfma_f32_16x16x32_bf16 v[176:179], a[184:187], a[8:11], 0
    s_addk_i32 m0, 896
    v_cvt_pk_bf16_f32 v157, v158, v159
    v_cvt_pk_bf16_f32 v134, v40, v41
    v_mfma_f32_16x16x32_bf16 v[176:179], a[188:191], a[24:27], v[176:179]
    v_exp_f32 v44, v44
    v_mfma_f32_16x16x32_bf16 v[176:179], a[192:195], a[40:43], v[176:179]
    v_exp_f32 v45, v45
    v_mfma_f32_16x16x32_bf16 v[176:179], a[196:199], a[56:59], v[176:179]
    v_exp_f32 v46, v46
    v_mfma_f32_16x16x32_bf16 v[176:179], a[200:203], a[72:75], v[176:179]
    v_exp_f32 v47, v47
    v_mfma_f32_16x16x32_bf16 v[176:179], a[204:207], a[88:91], v[176:179]
    v_cvt_pk_bf16_f32 v135, v42, v43
    v_cvt_pk_bf16_f32 v142, v44, v45
    v_mfma_f32_16x16x32_bf16 v[184:187], a[204:207], a[92:95], 0
    buffer_load_dwordx4 v5, s[12:15], s38 offen offset:128 lds
    v_mfma_f32_16x16x32_bf16 v[184:187], a[200:203], a[76:79], v[184:187]
    ds_read_b64_tr_b16 a[232:233], v8 offset:16384
    v_cvt_pk_bf16_f32 v143, v46, v47
    v_mfma_f32_16x16x32_bf16 v[184:187], a[196:199], a[60:63], v[184:187]
    ds_read_b64_tr_b16 a[234:235], v8 offset:18432
    v_accvgpr_write_b32 a113, v81
    v_mfma_f32_16x16x32_bf16 v[184:187], a[192:195], a[44:47], v[184:187]
    s_waitcnt lgkmcnt(2)
    ds_read_b64_tr_b16 a[236:237], v9 offset:16384
    v_accvgpr_write_b32 a114, v82
    v_mfma_f32_16x16x32_bf16 v[184:187], a[188:191], a[28:31], v[184:187]
    v_exp_f32 v48, v48
    v_mfma_f32_16x16x32_bf16 v[184:187], a[184:187], a[12:15], v[184:187]
    v_exp_f32 v49, v49
    v_mfma_f32_16x16x32_bf16 v[24:27], a[208:211], a[0:3], 0
    s_addk_i32 m0, 896
    ds_read_b64_tr_b16 a[238:239], v9 offset:18432
    v_cvt_pk_bf16_f32 v150, v48, v49
    v_mfma_f32_16x16x32_bf16 v[24:27], a[212:215], a[16:19], v[24:27]
    v_exp_f32 v50, v50
    v_mfma_f32_16x16x32_bf16 v[24:27], a[216:219], a[32:35], v[24:27]
    ds_read_b128 a[184:187], v12 offset:12288
    v_accvgpr_write_b32 a115, v83
    v_mfma_f32_16x16x32_bf16 v[24:27], a[220:223], a[48:51], v[24:27]
    v_exp_f32 v51, v51
    v_mfma_f32_16x16x32_bf16 v[24:27], a[224:227], a[64:67], v[24:27]
    ds_read_b128 a[188:191], v13 offset:12288
    v_cvt_pk_bf16_f32 v151, v50, v51
    v_mfma_f32_16x16x32_bf16 v[24:27], a[228:231], a[80:83], v[24:27]
    v_exp_f32 v52, v52
    v_mfma_f32_16x16x32_bf16 v[28:31], a[228:231], a[84:87], 0
    buffer_load_dwordx4 v5, s[12:15], s38 offen offset:256 lds
    v_mfma_f32_16x16x32_bf16 v[28:31], a[224:227], a[68:71], v[28:31]
    s_add_u32 s38, s38, 24576
    v_exp_f32 v53, v53
    v_mfma_f32_16x16x32_bf16 v[28:31], a[220:223], a[52:55], v[28:31]
    ds_read_b128 a[192:195], v12 offset:13312
    v_cvt_pk_bf16_f32 v158, v52, v53
    v_mfma_f32_16x16x32_bf16 v[28:31], a[216:219], a[36:39], v[28:31]
    ds_read_b128 a[196:199], v13 offset:13312
    v_accvgpr_write_b32 a116, v84
    v_mfma_f32_16x16x32_bf16 v[28:31], a[212:215], a[20:23], v[28:31]
    s_add_u32 s39, s40, 122880
    v_exp_f32 v54, v54
    v_mfma_f32_16x16x32_bf16 v[28:31], a[208:211], a[4:7], v[28:31]
    v_exp_f32 v55, v55
    v_mfma_f32_16x16x32_bf16 v[32:35], a[208:211], a[8:11], 0
    s_add_u32 m0, s63, 114688
    ds_read_b128 a[200:203], v12 offset:14336
    v_cvt_pk_bf16_f32 v159, v54, v55
    v_mfma_f32_16x16x32_bf16 v[32:35], a[212:215], a[24:27], v[32:35]
    v_exp_f32 v160, v160
    v_mfma_f32_16x16x32_bf16 v[32:35], a[216:219], a[40:43], v[32:35]
    v_exp_f32 v161, v161
    v_mfma_f32_16x16x32_bf16 v[32:35], a[220:223], a[56:59], v[32:35]
    ds_read_b128 a[204:207], v13 offset:14336
    v_cvt_pk_bf16_f32 v160, v160, v161
    v_mfma_f32_16x16x32_bf16 v[32:35], a[224:227], a[72:75], v[32:35]
    v_exp_f32 v162, v162
    v_mfma_f32_16x16x32_bf16 v[32:35], a[228:231], a[88:91], v[32:35]
    v_exp_f32 v163, v163
    v_mfma_f32_16x16x32_bf16 v[36:39], a[228:231], a[92:95], 0
    buffer_load_dwordx4 v6, s[16:19], s39 offen lds
    v_mfma_f32_16x16x32_bf16 v[36:39], a[224:227], a[76:79], v[36:39]
    v_exp_f32 v168, v168
    v_mfma_f32_16x16x32_bf16 v[36:39], a[220:223], a[60:63], v[36:39]
    v_exp_f32 v169, v169
    v_mfma_f32_16x16x32_bf16 v[36:39], a[216:219], a[44:47], v[36:39]
    s_waitcnt lgkmcnt(1)
    v_exp_f32 v170, v170
    v_mfma_f32_16x16x32_bf16 v[36:39], a[212:215], a[28:31], v[36:39]
    s_add_u32 s39, s40, 135168
    v_exp_f32 v171, v171
    v_mfma_f32_16x16x32_bf16 v[36:39], a[208:211], a[12:15], v[36:39]
    v_exp_f32 v176, v176
    v_mfma_f32_16x16x32_bf16 a[152:155], a[232:235], v[128:131], a[152:155]
    s_addk_i32 m0, 4096
    v_cvt_pk_bf16_f32 v161, v162, v163
    v_cvt_pk_bf16_f32 v168, v168, v169
    v_mfma_f32_16x16x32_bf16 a[168:171], a[236:239], v[128:131], a[168:171]
    v_exp_f32 v177, v177
    v_mfma_f32_16x16x32_bf16 a[172:175], a[236:239], v[136:139], a[172:175]
    ds_read_b128 a[208:211], v12 offset:18432
    v_cvt_pk_bf16_f32 v169, v170, v171
    v_mfma_f32_16x16x32_bf16 a[156:159], a[232:235], v[136:139], a[156:159]
    ds_read_b128 a[212:215], v13 offset:18432
    v_cvt_pk_bf16_f32 v176, v176, v177
    v_mfma_f32_16x16x32_bf16 a[160:163], a[232:235], v[144:147], a[160:163]
    ds_read_b128 a[216:219], v12 offset:19456
    v_accvgpr_write_b32 a117, v85
    v_mfma_f32_16x16x32_bf16 a[176:179], a[236:239], v[144:147], a[176:179]
    ds_read_b128 a[220:223], v13 offset:19456
    v_accvgpr_write_b32 a118, v86
    v_mfma_f32_16x16x32_bf16 a[180:183], a[236:239], v[152:155], a[180:183]
    buffer_load_dwordx4 v6, s[16:19], s39 offen lds
    v_mfma_f32_16x16x32_bf16 a[164:167], a[232:235], v[152:155], a[164:167]
    ds_read_b128 a[224:227], v12 offset:20480
    v_accvgpr_write_b32 a119, v87
    v_mfma_f32_16x16x32_bf16 v[164:167], a[184:187], a[0:3], 0
    v_exp_f32 v178, v178
    v_mfma_f32_16x16x32_bf16 v[164:167], a[188:191], a[16:19], v[164:167]
    v_exp_f32 v179, v179
    v_mfma_f32_16x16x32_bf16 v[164:167], a[192:195], a[32:35], v[164:167]
    s_waitcnt lgkmcnt(3)
    ds_read_b128 a[228:231], v13 offset:20480
    v_cvt_pk_bf16_f32 v177, v178, v179
    v_mfma_f32_16x16x32_bf16 v[164:167], a[196:199], a[48:51], v[164:167]
    v_exp_f32 v184, v184
    v_mfma_f32_16x16x32_bf16 v[164:167], a[200:203], a[64:67], v[164:167]
    v_exp_f32 v185, v185
    v_mfma_f32_16x16x32_bf16 v[164:167], a[204:207], a[80:83], v[164:167]
    v_exp_f32 v186, v186
    v_mfma_f32_16x16x32_bf16 v[172:175], a[204:207], a[84:87], 0
    v_exp_f32 v187, v187
    v_mfma_f32_16x16x32_bf16 v[172:175], a[200:203], a[68:71], v[172:175]
    v_exp_f32 v24, v24
    v_mfma_f32_16x16x32_bf16 v[172:175], a[196:199], a[52:55], v[172:175]
    v_exp_f32 v25, v25
    v_mfma_f32_16x16x32_bf16 v[172:175], a[192:195], a[36:39], v[172:175]
    v_exp_f32 v26, v26
    v_mfma_f32_16x16x32_bf16 v[172:175], a[188:191], a[20:23], v[172:175]
    v_exp_f32 v27, v27
    v_mfma_f32_16x16x32_bf16 v[172:175], a[184:187], a[4:7], v[172:175]
    v_cvt_pk_bf16_f32 v184, v184, v185
    v_cvt_pk_bf16_f32 v185, v186, v187
    v_mfma_f32_16x16x32_bf16 v[180:183], a[184:187], a[8:11], 0
    v_exp_f32 v28, v28
    v_mfma_f32_16x16x32_bf16 v[180:183], a[188:191], a[24:27], v[180:183]
    v_exp_f32 v29, v29
    v_mfma_f32_16x16x32_bf16 v[180:183], a[192:195], a[40:43], v[180:183]
    v_exp_f32 v30, v30
    v_mfma_f32_16x16x32_bf16 v[180:183], a[196:199], a[56:59], v[180:183]
    v_exp_f32 v31, v31
    v_mfma_f32_16x16x32_bf16 v[180:183], a[200:203], a[72:75], v[180:183]
    v_cvt_pk_bf16_f32 v162, v24, v25
    v_cvt_pk_bf16_f32 v163, v26, v27
    v_mfma_f32_16x16x32_bf16 v[180:183], a[204:207], a[88:91], v[180:183]
    v_exp_f32 v32, v32
    v_mfma_f32_16x16x32_bf16 v[188:191], a[204:207], a[92:95], 0
    v_exp_f32 v33, v33
    v_mfma_f32_16x16x32_bf16 v[188:191], a[200:203], a[76:79], v[188:191]
    v_exp_f32 v34, v34
    v_mfma_f32_16x16x32_bf16 v[188:191], a[196:199], a[60:63], v[188:191]
    s_add_u32 m0, s49, 0
    v_exp_f32 v35, v35
    v_mfma_f32_16x16x32_bf16 v[188:191], a[192:195], a[44:47], v[188:191]
    v_cvt_pk_bf16_f32 v170, v28, v29
    v_cvt_pk_bf16_f32 v171, v30, v31
    v_mfma_f32_16x16x32_bf16 v[188:191], a[188:191], a[28:31], v[188:191]
    v_exp_f32 v36, v36
    v_mfma_f32_16x16x32_bf16 v[188:191], a[184:187], a[12:15], v[188:191]
    s_waitcnt lgkmcnt(0)
    v_exp_f32 v37, v37
    v_mfma_f32_16x16x32_bf16 v[40:43], a[208:211], a[0:3], 0
    s_waitcnt vmcnt(11)
    v_exp_f32 v38, v38
    v_mfma_f32_16x16x32_bf16 v[40:43], a[212:215], a[16:19], v[40:43]
    s_barrier
    v_mfma_f32_16x16x32_bf16 v[40:43], a[216:219], a[32:35], v[40:43]
    buffer_load_dwordx4 v4, s[12:15], s38 offen offset:0 lds
    v_mfma_f32_16x16x32_bf16 v[40:43], a[220:223], a[48:51], v[40:43]
    ds_read_b64_tr_b16 a[240:241], v8 offset:20480
    v_cvt_pk_bf16_f32 v178, v32, v33
    v_mfma_f32_16x16x32_bf16 v[40:43], a[224:227], a[64:67], v[40:43]
    ds_read_b64_tr_b16 a[242:243], v8 offset:22528
    v_cvt_pk_bf16_f32 v179, v34, v35
    v_mfma_f32_16x16x32_bf16 v[40:43], a[228:231], a[80:83], v[40:43]
    ds_read_b64_tr_b16 a[244:245], v9 offset:20480
    v_cvt_pk_bf16_f32 v186, v36, v37
    v_mfma_f32_16x16x32_bf16 v[44:47], a[228:231], a[84:87], 0
    ds_read_b64_tr_b16 a[246:247], v9 offset:22528
    v_accvgpr_write_b32 a120, v88
    v_mfma_f32_16x16x32_bf16 v[44:47], a[224:227], a[68:71], v[44:47]
    ds_read_b128 a[184:187], v12 offset:24576
    v_accvgpr_write_b32 a121, v89
    v_mfma_f32_16x16x32_bf16 v[44:47], a[220:223], a[52:55], v[44:47]
    s_addk_i32 m0, 896
    ds_read_b128 a[188:191], v13 offset:24576
    v_accvgpr_write_b32 a122, v90
    v_mfma_f32_16x16x32_bf16 v[44:47], a[216:219], a[36:39], v[44:47]
    ds_read_b128 a[192:195], v12 offset:25600
    v_accvgpr_write_b32 a123, v91
    v_mfma_f32_16x16x32_bf16 v[44:47], a[212:215], a[20:23], v[44:47]
    v_exp_f32 v39, v39
    v_mfma_f32_16x16x32_bf16 v[44:47], a[208:211], a[4:7], v[44:47]
    ds_read_b128 a[196:199], v13 offset:25600
    v_cvt_pk_bf16_f32 v187, v38, v39
    v_mfma_f32_16x16x32_bf16 v[48:51], a[208:211], a[8:11], 0
    buffer_load_dword a252, v22, s[32:35], s42 offen offset:1536
    s_add_u32 s42, s42, 3072
    v_mfma_f32_16x16x32_bf16 v[48:51], a[212:215], a[24:27], v[48:51]
    v_exp_f32 v164, v164
    v_mfma_f32_16x16x32_bf16 v[48:51], a[216:219], a[40:43], v[48:51]
    buffer_load_dwordx4 v4, s[12:15], s38 offen offset:128 lds
    v_mfma_f32_16x16x32_bf16 v[48:51], a[220:223], a[56:59], v[48:51]
    ds_read_b128 a[200:203], v12 offset:26624
    v_accvgpr_write_b32 a124, v92
    v_mfma_f32_16x16x32_bf16 v[48:51], a[224:227], a[72:75], v[48:51]
    v_exp_f32 v165, v165
    v_mfma_f32_16x16x32_bf16 v[48:51], a[228:231], a[88:91], v[48:51]
    ds_read_b128 a[204:207], v13 offset:26624
    v_cvt_pk_bf16_f32 v164, v164, v165
    v_mfma_f32_16x16x32_bf16 v[52:55], a[228:231], a[92:95], 0
    v_exp_f32 v166, v166
    v_mfma_f32_16x16x32_bf16 v[52:55], a[224:227], a[76:79], v[52:55]
    v_exp_f32 v167, v167
    v_mfma_f32_16x16x32_bf16 v[52:55], a[220:223], a[60:63], v[52:55]
    s_addk_i32 m0, 896
    v_exp_f32 v172, v172
    v_mfma_f32_16x16x32_bf16 v[52:55], a[216:219], a[44:47], v[52:55]
    s_waitcnt lgkmcnt(2)
    v_exp_f32 v173, v173
    v_mfma_f32_16x16x32_bf16 v[52:55], a[212:215], a[28:31], v[52:55]
    v_exp_f32 v174, v174
    v_mfma_f32_16x16x32_bf16 v[52:55], a[208:211], a[12:15], v[52:55]
    v_exp_f32 v175, v175
    v_mfma_f32_16x16x32_bf16 a[164:167], a[240:243], v[156:159], a[164:167]
    v_exp_f32 v180, v180
    v_mfma_f32_16x16x32_bf16 a[180:183], a[244:247], v[156:159], a[180:183]
    v_exp_f32 v181, v181
    v_mfma_f32_16x16x32_bf16 a[176:179], a[244:247], v[148:151], a[176:179]
    buffer_load_dwordx4 v4, s[12:15], s38 offen offset:256 lds
    v_mfma_f32_16x16x32_bf16 a[160:163], a[240:243], v[148:151], a[160:163]
    ds_read_b128 a[208:211], v12 offset:30720
    v_cvt_pk_bf16_f32 v165, v166, v167
    v_mfma_f32_16x16x32_bf16 a[156:159], a[240:243], v[140:143], a[156:159]
    ds_read_b128 a[212:215], v13 offset:30720
    v_cvt_pk_bf16_f32 v172, v172, v173
    v_mfma_f32_16x16x32_bf16 a[172:175], a[244:247], v[140:143], a[172:175]
    ds_read_b128 a[216:219], v12 offset:31744
    v_cvt_pk_bf16_f32 v173, v174, v175
    v_mfma_f32_16x16x32_bf16 a[168:171], a[244:247], v[132:135], a[168:171]
    ds_read_b128 a[220:223], v13 offset:31744
    v_cvt_pk_bf16_f32 v180, v180, v181
    v_mfma_f32_16x16x32_bf16 a[152:155], a[240:243], v[132:135], a[152:155]
    ds_read_b128 a[224:227], v12 offset:32768
    v_accvgpr_write_b32 a125, v93
    v_mfma_f32_16x16x32_bf16 v[192:195], a[184:187], a[0:3], 0
    s_addk_i32 m0, 1280
    ds_read_b128 a[228:231], v13 offset:32768
    v_accvgpr_write_b32 a126, v94
    v_mfma_f32_16x16x32_bf16 v[192:195], a[188:191], a[16:19], v[192:195]
    s_waitcnt lgkmcnt(6)
    v_exp_f32 v182, v182
    v_mfma_f32_16x16x32_bf16 v[192:195], a[192:195], a[32:35], v[192:195]
    v_exp_f32 v183, v183
    v_mfma_f32_16x16x32_bf16 v[192:195], a[196:199], a[48:51], v[192:195]
    v_exp_f32 v188, v188
    v_mfma_f32_16x16x32_bf16 v[192:195], a[200:203], a[64:67], v[192:195]
    v_exp_f32 v189, v189
    v_mfma_f32_16x16x32_bf16 v[192:195], a[204:207], a[80:83], v[192:195]
    v_exp_f32 v190, v190
    v_mfma_f32_16x16x32_bf16 v[200:203], a[204:207], a[84:87], 0
    buffer_load_dwordx4 v5, s[12:15], s38 offen offset:0 lds
    v_mfma_f32_16x16x32_bf16 v[200:203], a[200:203], a[68:71], v[200:203]
    v_exp_f32 v191, v191
    v_mfma_f32_16x16x32_bf16 v[200:203], a[196:199], a[52:55], v[200:203]
    v_exp_f32 v40, v40
    v_mfma_f32_16x16x32_bf16 v[200:203], a[192:195], a[36:39], v[200:203]
    v_exp_f32 v41, v41
    v_mfma_f32_16x16x32_bf16 v[200:203], a[188:191], a[20:23], v[200:203]
    v_cvt_pk_bf16_f32 v181, v182, v183
    v_cvt_pk_bf16_f32 v188, v188, v189
    v_mfma_f32_16x16x32_bf16 v[200:203], a[184:187], a[4:7], v[200:203]
    v_exp_f32 v42, v42
    v_mfma_f32_16x16x32_bf16 v[208:211], a[184:187], a[8:11], 0
    s_addk_i32 m0, 896
    v_exp_f32 v43, v43
    v_mfma_f32_16x16x32_bf16 v[208:211], a[188:191], a[24:27], v[208:211]
    v_cvt_pk_bf16_f32 v189, v190, v191
    v_cvt_pk_bf16_f32 v166, v40, v41
    v_mfma_f32_16x16x32_bf16 v[208:211], a[192:195], a[40:43], v[208:211]
    v_exp_f32 v44, v44
    v_mfma_f32_16x16x32_bf16 v[208:211], a[196:199], a[56:59], v[208:211]
    v_exp_f32 v45, v45
    v_mfma_f32_16x16x32_bf16 v[208:211], a[200:203], a[72:75], v[208:211]
    v_exp_f32 v46, v46
    v_mfma_f32_16x16x32_bf16 v[208:211], a[204:207], a[88:91], v[208:211]
    v_exp_f32 v47, v47
    v_mfma_f32_16x16x32_bf16 v[216:219], a[204:207], a[92:95], 0
    buffer_load_dwordx4 v5, s[12:15], s38 offen offset:128 lds
    v_mfma_f32_16x16x32_bf16 v[216:219], a[200:203], a[76:79], v[216:219]
    ds_read_b64_tr_b16 a[232:233], v8 offset:24576
    v_cvt_pk_bf16_f32 v167, v42, v43
    v_mfma_f32_16x16x32_bf16 v[216:219], a[196:199], a[60:63], v[216:219]
    ds_read_b64_tr_b16 a[234:235], v8 offset:26624
    v_cvt_pk_bf16_f32 v174, v44, v45
    v_mfma_f32_16x16x32_bf16 v[216:219], a[192:195], a[44:47], v[216:219]
    s_waitcnt lgkmcnt(2)
    ds_read_b64_tr_b16 a[236:237], v9 offset:24576
    v_cvt_pk_bf16_f32 v175, v46, v47
    v_mfma_f32_16x16x32_bf16 v[216:219], a[188:191], a[28:31], v[216:219]
    ds_read_b64_tr_b16 a[238:239], v9 offset:26624
    v_accvgpr_write_b32 a127, v95
    v_mfma_f32_16x16x32_bf16 v[216:219], a[184:187], a[12:15], v[216:219]
    v_exp_f32 v48, v48
    v_mfma_f32_16x16x32_bf16 v[24:27], a[208:211], a[0:3], 0
    s_addk_i32 m0, 896
    v_exp_f32 v49, v49
    v_mfma_f32_16x16x32_bf16 v[24:27], a[212:215], a[16:19], v[24:27]
    v_exp_f32 v50, v50
    v_mfma_f32_16x16x32_bf16 v[24:27], a[216:219], a[32:35], v[24:27]
    ds_read_b128 a[184:187], v12 offset:36864
    v_cvt_pk_bf16_f32 v182, v48, v49
    v_mfma_f32_16x16x32_bf16 v[24:27], a[220:223], a[48:51], v[24:27]
    ds_read_b128 a[188:191], v13 offset:36864
    v_accvgpr_write_b32 a128, v96
    v_mfma_f32_16x16x32_bf16 v[24:27], a[224:227], a[64:67], v[24:27]
    ds_read_b128 a[192:195], v12 offset:37888
    v_accvgpr_write_b32 a129, v97
    v_mfma_f32_16x16x32_bf16 v[24:27], a[228:231], a[80:83], v[24:27]
    ds_read_b128 a[196:199], v13 offset:37888
    v_accvgpr_write_b32 a130, v98
    v_mfma_f32_16x16x32_bf16 v[28:31], a[228:231], a[84:87], 0
    buffer_load_dwordx4 v5, s[12:15], s38 offen offset:256 lds
    v_mfma_f32_16x16x32_bf16 v[28:31], a[224:227], a[68:71], v[28:31]
    s_add_u32 s38, s38, 24576
    v_exp_f32 v51, v51
    v_mfma_f32_16x16x32_bf16 v[28:31], a[220:223], a[52:55], v[28:31]
    ds_read_b128 a[200:203], v12 offset:38912
    v_cvt_pk_bf16_f32 v183, v50, v51
    v_mfma_f32_16x16x32_bf16 v[28:31], a[216:219], a[36:39], v[28:31]
    v_exp_f32 v52, v52
    v_mfma_f32_16x16x32_bf16 v[28:31], a[212:215], a[20:23], v[28:31]
    s_add_u32 s39, s40, 147456
    v_exp_f32 v53, v53
    v_mfma_f32_16x16x32_bf16 v[28:31], a[208:211], a[4:7], v[28:31]
    ds_read_b128 a[204:207], v13 offset:38912
    v_cvt_pk_bf16_f32 v190, v52, v53
    v_mfma_f32_16x16x32_bf16 v[32:35], a[208:211], a[8:11], 0
    s_add_u32 m0, s63, 122880
    v_exp_f32 v54, v54
    v_mfma_f32_16x16x32_bf16 v[32:35], a[212:215], a[24:27], v[32:35]
    v_exp_f32 v55, v55
    v_mfma_f32_16x16x32_bf16 v[32:35], a[216:219], a[40:43], v[32:35]
    v_exp_f32 v192, v192
    v_mfma_f32_16x16x32_bf16 v[32:35], a[220:223], a[56:59], v[32:35]
    v_exp_f32 v193, v193
    v_mfma_f32_16x16x32_bf16 v[32:35], a[224:227], a[72:75], v[32:35]
    v_exp_f32 v194, v194
    v_mfma_f32_16x16x32_bf16 v[32:35], a[228:231], a[88:91], v[32:35]
    v_exp_f32 v195, v195
    v_mfma_f32_16x16x32_bf16 v[36:39], a[228:231], a[92:95], 0
    buffer_load_dwordx4 v6, s[16:19], s39 offen lds
    v_mfma_f32_16x16x32_bf16 v[36:39], a[224:227], a[76:79], v[36:39]
    v_exp_f32 v200, v200
    v_mfma_f32_16x16x32_bf16 v[36:39], a[220:223], a[60:63], v[36:39]
    v_exp_f32 v201, v201
    v_mfma_f32_16x16x32_bf16 v[36:39], a[216:219], a[44:47], v[36:39]
    s_waitcnt lgkmcnt(0)
    v_cvt_pk_bf16_f32 v191, v54, v55
    v_cvt_pk_bf16_f32 v192, v192, v193
    v_mfma_f32_16x16x32_bf16 v[36:39], a[212:215], a[28:31], v[36:39]
    s_add_u32 s39, s40, 159744
    v_exp_f32 v202, v202
    v_mfma_f32_16x16x32_bf16 v[36:39], a[208:211], a[12:15], v[36:39]
    v_exp_f32 v203, v203
    v_mfma_f32_16x16x32_bf16 a[152:155], a[232:235], v[160:163], a[152:155]
    s_addk_i32 m0, 4096
    v_cvt_pk_bf16_f32 v193, v194, v195
    v_cvt_pk_bf16_f32 v200, v200, v201
    v_mfma_f32_16x16x32_bf16 a[168:171], a[236:239], v[160:163], a[168:171]
    v_exp_f32 v208, v208
    v_mfma_f32_16x16x32_bf16 a[172:175], a[236:239], v[168:171], a[172:175]
    ds_read_b128 a[208:211], v12 offset:43008
    v_cvt_pk_bf16_f32 v201, v202, v203
    v_mfma_f32_16x16x32_bf16 a[156:159], a[232:235], v[168:171], a[156:159]
    ds_read_b128 a[212:215], v13 offset:43008
    v_accvgpr_write_b32 a131, v99
    v_mfma_f32_16x16x32_bf16 a[160:163], a[232:235], v[176:179], a[160:163]
    ds_read_b128 a[216:219], v12 offset:44032
    v_accvgpr_write_b32 a132, v100
    v_mfma_f32_16x16x32_bf16 a[176:179], a[236:239], v[176:179], a[176:179]
    ds_read_b128 a[220:223], v13 offset:44032
    v_accvgpr_write_b32 a133, v101
    v_mfma_f32_16x16x32_bf16 a[180:183], a[236:239], v[184:187], a[180:183]
    buffer_load_dwordx4 v6, s[16:19], s39 offen lds
    v_mfma_f32_16x16x32_bf16 a[164:167], a[232:235], v[184:187], a[164:167]
    v_exp_f32 v209, v209
    v_mfma_f32_16x16x32_bf16 v[196:199], a[184:187], a[0:3], 0
    ds_read_b128 a[224:227], v12 offset:45056
    v_cvt_pk_bf16_f32 v208, v208, v209
    v_mfma_f32_16x16x32_bf16 v[196:199], a[188:191], a[16:19], v[196:199]
    v_exp_f32 v210, v210
    v_mfma_f32_16x16x32_bf16 v[196:199], a[192:195], a[32:35], v[196:199]
    v_exp_f32 v211, v211
    v_mfma_f32_16x16x32_bf16 v[196:199], a[196:199], a[48:51], v[196:199]
    ds_read_b128 a[228:231], v13 offset:45056
    v_cvt_pk_bf16_f32 v209, v210, v211
    v_mfma_f32_16x16x32_bf16 v[196:199], a[200:203], a[64:67], v[196:199]
    v_exp_f32 v216, v216
    v_mfma_f32_16x16x32_bf16 v[196:199], a[204:207], a[80:83], v[196:199]
    v_exp_f32 v217, v217
    v_mfma_f32_16x16x32_bf16 v[204:207], a[204:207], a[84:87], 0
    v_exp_f32 v218, v218
    v_mfma_f32_16x16x32_bf16 v[204:207], a[200:203], a[68:71], v[204:207]
    v_exp_f32 v219, v219
    v_mfma_f32_16x16x32_bf16 v[204:207], a[196:199], a[52:55], v[204:207]
    v_exp_f32 v24, v24
    v_mfma_f32_16x16x32_bf16 v[204:207], a[192:195], a[36:39], v[204:207]
    v_exp_f32 v25, v25
    v_mfma_f32_16x16x32_bf16 v[204:207], a[188:191], a[20:23], v[204:207]
    v_exp_f32 v26, v26
    v_mfma_f32_16x16x32_bf16 v[204:207], a[184:187], a[4:7], v[204:207]
    v_exp_f32 v27, v27
    v_mfma_f32_16x16x32_bf16 v[212:215], a[184:187], a[8:11], 0
    v_cvt_pk_bf16_f32 v216, v216, v217
    v_cvt_pk_bf16_f32 v217, v218, v219
    v_mfma_f32_16x16x32_bf16 v[212:215], a[188:191], a[24:27], v[212:215]
    v_exp_f32 v28, v28
    v_mfma_f32_16x16x32_bf16 v[212:215], a[192:195], a[40:43], v[212:215]
    v_exp_f32 v29, v29
    v_mfma_f32_16x16x32_bf16 v[212:215], a[196:199], a[56:59], v[212:215]
    v_exp_f32 v30, v30
    v_mfma_f32_16x16x32_bf16 v[212:215], a[200:203], a[72:75], v[212:215]
    v_exp_f32 v31, v31
    v_mfma_f32_16x16x32_bf16 v[212:215], a[204:207], a[88:91], v[212:215]
    v_cvt_pk_bf16_f32 v194, v24, v25
    v_cvt_pk_bf16_f32 v195, v26, v27
    v_mfma_f32_16x16x32_bf16 v[220:223], a[204:207], a[92:95], 0
    v_exp_f32 v32, v32
    v_mfma_f32_16x16x32_bf16 v[220:223], a[200:203], a[76:79], v[220:223]
    v_exp_f32 v33, v33
    v_mfma_f32_16x16x32_bf16 v[220:223], a[196:199], a[60:63], v[220:223]
    s_add_u32 m0, s49, 24576
    v_exp_f32 v34, v34
    v_mfma_f32_16x16x32_bf16 v[220:223], a[192:195], a[44:47], v[220:223]
    s_waitcnt lgkmcnt(0)
    v_exp_f32 v35, v35
    v_mfma_f32_16x16x32_bf16 v[220:223], a[188:191], a[28:31], v[220:223]
    v_cvt_pk_bf16_f32 v202, v28, v29
    v_cvt_pk_bf16_f32 v203, v30, v31
    v_mfma_f32_16x16x32_bf16 v[220:223], a[184:187], a[12:15], v[220:223]
    v_exp_f32 v36, v36
    v_mfma_f32_16x16x32_bf16 v[40:43], a[208:211], a[0:3], 0
    s_waitcnt vmcnt(11)
    v_exp_f32 v37, v37
    v_mfma_f32_16x16x32_bf16 v[40:43], a[212:215], a[16:19], v[40:43]
    s_barrier
    v_mfma_f32_16x16x32_bf16 v[40:43], a[216:219], a[32:35], v[40:43]
    buffer_load_dwordx4 v4, s[12:15], s38 offen offset:0 lds
    v_mfma_f32_16x16x32_bf16 v[40:43], a[220:223], a[48:51], v[40:43]
    ds_read_b64_tr_b16 a[240:241], v8 offset:28672
    v_cvt_pk_bf16_f32 v210, v32, v33
    v_mfma_f32_16x16x32_bf16 v[40:43], a[224:227], a[64:67], v[40:43]
    ds_read_b64_tr_b16 a[242:243], v8 offset:30720
    v_cvt_pk_bf16_f32 v211, v34, v35
    v_mfma_f32_16x16x32_bf16 v[40:43], a[228:231], a[80:83], v[40:43]
    ds_read_b64_tr_b16 a[244:245], v9 offset:28672
    v_cvt_pk_bf16_f32 v218, v36, v37
    v_mfma_f32_16x16x32_bf16 v[44:47], a[228:231], a[84:87], 0
    ds_read_b64_tr_b16 a[246:247], v9 offset:30720
    v_accvgpr_write_b32 a134, v102
    v_mfma_f32_16x16x32_bf16 v[44:47], a[224:227], a[68:71], v[44:47]
    ds_read_b128 a[184:187], v12 offset:49152
    v_accvgpr_write_b32 a135, v103
    v_mfma_f32_16x16x32_bf16 v[44:47], a[220:223], a[52:55], v[44:47]
    s_addk_i32 m0, 896
    ds_read_b128 a[188:191], v13 offset:49152
    v_accvgpr_write_b32 a136, v104
    v_mfma_f32_16x16x32_bf16 v[44:47], a[216:219], a[36:39], v[44:47]
    ds_read_b128 a[192:195], v12 offset:50176
    v_accvgpr_write_b32 a137, v105
    v_mfma_f32_16x16x32_bf16 v[44:47], a[212:215], a[20:23], v[44:47]
    v_exp_f32 v38, v38
    v_mfma_f32_16x16x32_bf16 v[44:47], a[208:211], a[4:7], v[44:47]
    v_exp_f32 v39, v39
    v_mfma_f32_16x16x32_bf16 v[48:51], a[208:211], a[8:11], 0
    buffer_load_dword a252, v22, s[32:35], s42 offen offset:0
    v_mfma_f32_16x16x32_bf16 v[48:51], a[212:215], a[24:27], v[48:51]
    ds_read_b128 a[196:199], v13 offset:50176
    v_cvt_pk_bf16_f32 v219, v38, v39
    v_mfma_f32_16x16x32_bf16 v[48:51], a[216:219], a[40:43], v[48:51]
    buffer_load_dwordx4 v4, s[12:15], s38 offen offset:128 lds
    v_mfma_f32_16x16x32_bf16 v[48:51], a[220:223], a[56:59], v[48:51]
    ds_read_b128 a[200:203], v12 offset:51200
    v_accvgpr_write_b32 a138, v106
    v_mfma_f32_16x16x32_bf16 v[48:51], a[224:227], a[72:75], v[48:51]
    v_exp_f32 v196, v196
    v_mfma_f32_16x16x32_bf16 v[48:51], a[228:231], a[88:91], v[48:51]
    v_exp_f32 v197, v197
    v_mfma_f32_16x16x32_bf16 v[52:55], a[228:231], a[92:95], 0
    ds_read_b128 a[204:207], v13 offset:51200
    v_cvt_pk_bf16_f32 v196, v196, v197
    v_mfma_f32_16x16x32_bf16 v[52:55], a[224:227], a[76:79], v[52:55]
    v_exp_f32 v198, v198
    v_mfma_f32_16x16x32_bf16 v[52:55], a[220:223], a[60:63], v[52:55]
    s_addk_i32 m0, 896
    v_exp_f32 v199, v199
    v_mfma_f32_16x16x32_bf16 v[52:55], a[216:219], a[44:47], v[52:55]
    s_waitcnt lgkmcnt(2)
    v_exp_f32 v204, v204
    v_mfma_f32_16x16x32_bf16 v[52:55], a[212:215], a[28:31], v[52:55]
    v_exp_f32 v205, v205
    v_mfma_f32_16x16x32_bf16 v[52:55], a[208:211], a[12:15], v[52:55]
    v_exp_f32 v206, v206
    v_mfma_f32_16x16x32_bf16 a[164:167], a[240:243], v[188:191], a[164:167]
    v_exp_f32 v207, v207
    v_mfma_f32_16x16x32_bf16 a[180:183], a[244:247], v[188:191], a[180:183]
    v_exp_f32 v212, v212
    v_mfma_f32_16x16x32_bf16 a[176:179], a[244:247], v[180:183], a[176:179]
    buffer_load_dwordx4 v4, s[12:15], s38 offen offset:256 lds
    v_mfma_f32_16x16x32_bf16 a[160:163], a[240:243], v[180:183], a[160:163]
    ds_read_b128 a[208:211], v12 offset:55296
    v_cvt_pk_bf16_f32 v197, v198, v199
    v_mfma_f32_16x16x32_bf16 a[156:159], a[240:243], v[172:175], a[156:159]
    ds_read_b128 a[212:215], v13 offset:55296
    v_cvt_pk_bf16_f32 v204, v204, v205
    v_mfma_f32_16x16x32_bf16 a[172:175], a[244:247], v[172:175], a[172:175]
pg_7:
    s_cbranch_execz pg_9
    ds_read_b128 a[216:219], v12 offset:56320
    v_cvt_pk_bf16_f32 v205, v206, v207
    v_mfma_f32_16x16x32_bf16 a[168:171], a[244:247], v[164:167], a[168:171]
    ds_read_b128 a[220:223], v13 offset:56320
    v_accvgpr_write_b32 a139, v107
    v_mfma_f32_16x16x32_bf16 a[152:155], a[240:243], v[164:167], a[152:155]
    ds_read_b128 a[224:227], v12 offset:57344
    v_accvgpr_write_b32 a140, v108
    v_mfma_f32_16x16x32_bf16 v[224:227], a[184:187], a[0:3], 0
    s_addk_i32 m0, 1280
    v_exp_f32 v213, v213
    v_mfma_f32_16x16x32_bf16 v[224:227], a[188:191], a[16:19], v[224:227]
    s_waitcnt lgkmcnt(5)
    ds_read_b128 a[228:231], v13 offset:57344
    v_cvt_pk_bf16_f32 v212, v212, v213
    v_mfma_f32_16x16x32_bf16 v[224:227], a[192:195], a[32:35], v[224:227]
    v_exp_f32 v214, v214
    v_mfma_f32_16x16x32_bf16 v[224:227], a[196:199], a[48:51], v[224:227]
    v_exp_f32 v215, v215
    v_mfma_f32_16x16x32_bf16 v[224:227], a[200:203], a[64:67], v[224:227]
    v_exp_f32 v220, v220
    v_mfma_f32_16x16x32_bf16 v[224:227], a[204:207], a[80:83], v[224:227]
    v_exp_f32 v221, v221
    v_mfma_f32_16x16x32_bf16 v[232:235], a[204:207], a[84:87], 0
    buffer_load_dwordx4 v5, s[12:15], s38 offen offset:0 lds
    v_mfma_f32_16x16x32_bf16 v[232:235], a[200:203], a[68:71], v[232:235]
    v_exp_f32 v222, v222
    v_mfma_f32_16x16x32_bf16 v[232:235], a[196:199], a[52:55], v[232:235]
    v_exp_f32 v223, v223
    v_mfma_f32_16x16x32_bf16 v[232:235], a[192:195], a[36:39], v[232:235]
    v_exp_f32 v40, v40
    v_mfma_f32_16x16x32_bf16 v[232:235], a[188:191], a[20:23], v[232:235]
    v_exp_f32 v41, v41
    v_mfma_f32_16x16x32_bf16 v[232:235], a[184:187], a[4:7], v[232:235]
    v_cvt_pk_bf16_f32 v213, v214, v215
    v_cvt_pk_bf16_f32 v220, v220, v221
    v_mfma_f32_16x16x32_bf16 v[240:243], a[184:187], a[8:11], 0
    s_addk_i32 m0, 896
    v_exp_f32 v42, v42
    v_mfma_f32_16x16x32_bf16 v[240:243], a[188:191], a[24:27], v[240:243]
    v_exp_f32 v43, v43
    v_mfma_f32_16x16x32_bf16 v[240:243], a[192:195], a[40:43], v[240:243]
    v_cvt_pk_bf16_f32 v221, v222, v223
    v_cvt_pk_bf16_f32 v198, v40, v41
    v_mfma_f32_16x16x32_bf16 v[240:243], a[196:199], a[56:59], v[240:243]
    v_exp_f32 v44, v44
    v_mfma_f32_16x16x32_bf16 v[240:243], a[200:203], a[72:75], v[240:243]
    v_exp_f32 v45, v45
    v_mfma_f32_16x16x32_bf16 v[240:243], a[204:207], a[88:91], v[240:243]
    v_exp_f32 v46, v46
    v_mfma_f32_16x16x32_bf16 v[248:251], a[204:207], a[92:95], 0
    buffer_load_dwordx4 v5, s[12:15], s38 offen offset:128 lds
    v_mfma_f32_16x16x32_bf16 v[248:251], a[200:203], a[76:79], v[248:251]
    ds_read_b64_tr_b16 a[232:233], v8 offset:32768
    v_cvt_pk_bf16_f32 v199, v42, v43
    v_mfma_f32_16x16x32_bf16 v[248:251], a[196:199], a[60:63], v[248:251]
    ds_read_b64_tr_b16 a[234:235], v8 offset:34816
    v_cvt_pk_bf16_f32 v206, v44, v45
    v_mfma_f32_16x16x32_bf16 v[248:251], a[192:195], a[44:47], v[248:251]
    s_waitcnt lgkmcnt(2)
    ds_read_b64_tr_b16 a[236:237], v9 offset:32768
    v_accvgpr_write_b32 a141, v109
    v_mfma_f32_16x16x32_bf16 v[248:251], a[188:191], a[28:31], v[248:251]
    ds_read_b64_tr_b16 a[238:239], v9 offset:34816
    v_accvgpr_write_b32 a142, v110
    v_mfma_f32_16x16x32_bf16 v[248:251], a[184:187], a[12:15], v[248:251]
    v_exp_f32 v47, v47
    v_mfma_f32_16x16x32_bf16 v[24:27], a[208:211], a[0:3], 0
    s_addk_i32 m0, 896
    v_exp_f32 v48, v48
    v_mfma_f32_16x16x32_bf16 v[24:27], a[212:215], a[16:19], v[24:27]
    v_exp_f32 v49, v49
    v_mfma_f32_16x16x32_bf16 v[24:27], a[216:219], a[32:35], v[24:27]
    ds_read_b128 a[184:187], v12 offset:61440
    v_cvt_pk_bf16_f32 v207, v46, v47
    v_mfma_f32_16x16x32_bf16 v[24:27], a[220:223], a[48:51], v[24:27]
    ds_read_b128 a[188:191], v13 offset:61440
    v_cvt_pk_bf16_f32 v214, v48, v49
    v_mfma_f32_16x16x32_bf16 v[24:27], a[224:227], a[64:67], v[24:27]
    ds_read_b128 a[192:195], v12 offset:62464
    v_accvgpr_write_b32 a143, v111
    v_mfma_f32_16x16x32_bf16 v[24:27], a[228:231], a[80:83], v[24:27]
    ds_read_b128 a[196:199], v13 offset:62464
    v_accvgpr_write_b32 a144, v112
    v_mfma_f32_16x16x32_bf16 v[28:31], a[228:231], a[84:87], 0
    buffer_load_dwordx4 v5, s[12:15], s38 offen offset:256 lds
    v_mfma_f32_16x16x32_bf16 v[28:31], a[224:227], a[68:71], v[28:31]
    s_add_u32 s38, s38, 24576
    v_exp_f32 v50, v50
    v_mfma_f32_16x16x32_bf16 v[28:31], a[220:223], a[52:55], v[28:31]
    v_exp_f32 v51, v51
    v_mfma_f32_16x16x32_bf16 v[28:31], a[216:219], a[36:39], v[28:31]
    ds_read_b128 a[200:203], v12 offset:63488
    v_cvt_pk_bf16_f32 v215, v50, v51
    v_mfma_f32_16x16x32_bf16 v[28:31], a[212:215], a[20:23], v[28:31]
    s_add_u32 s39, s40, 172032
    ds_read_b128 a[204:207], v13 offset:63488
    v_add_u32 v12, 67584, v12
    v_mfma_f32_16x16x32_bf16 v[28:31], a[208:211], a[4:7], v[28:31]
    v_exp_f32 v52, v52
    v_mfma_f32_16x16x32_bf16 v[32:35], a[208:211], a[8:11], 0
    s_add_u32 m0, s63, 131072
    v_exp_f32 v53, v53
    v_mfma_f32_16x16x32_bf16 v[32:35], a[212:215], a[24:27], v[32:35]
    v_exp_f32 v54, v54
    v_mfma_f32_16x16x32_bf16 v[32:35], a[216:219], a[40:43], v[32:35]
    v_exp_f32 v55, v55
    v_mfma_f32_16x16x32_bf16 v[32:35], a[220:223], a[56:59], v[32:35]
    v_cvt_pk_bf16_f32 v222, v52, v53
    v_cvt_pk_bf16_f32 v223, v54, v55
    v_mfma_f32_16x16x32_bf16 v[32:35], a[224:227], a[72:75], v[32:35]
    v_exp_f32 v224, v224
    v_mfma_f32_16x16x32_bf16 v[32:35], a[228:231], a[88:91], v[32:35]
    v_exp_f32 v225, v225
    v_mfma_f32_16x16x32_bf16 v[36:39], a[228:231], a[92:95], 0
    buffer_load_dwordx4 v6, s[16:19], s39 offen lds
    v_mfma_f32_16x16x32_bf16 v[36:39], a[224:227], a[76:79], v[36:39]
    v_exp_f32 v226, v226
    v_mfma_f32_16x16x32_bf16 v[36:39], a[220:223], a[60:63], v[36:39]
    v_exp_f32 v227, v227
    v_mfma_f32_16x16x32_bf16 v[36:39], a[216:219], a[44:47], v[36:39]
    s_waitcnt lgkmcnt(0)
    v_exp_f32 v232, v232
    v_mfma_f32_16x16x32_bf16 v[36:39], a[212:215], a[28:31], v[36:39]
    s_add_u32 s39, s40, 184320
    v_exp_f32 v233, v233
    v_mfma_f32_16x16x32_bf16 v[36:39], a[208:211], a[12:15], v[36:39]
    v_exp_f32 v234, v234
    v_mfma_f32_16x16x32_bf16 a[152:155], a[232:235], v[192:195], a[152:155]
    s_addk_i32 m0, 4096
    v_exp_f32 v235, v235
    v_mfma_f32_16x16x32_bf16 a[168:171], a[236:239], v[192:195], a[168:171]
    v_cvt_pk_bf16_f32 v224, v224, v225
    v_cvt_pk_bf16_f32 v225, v226, v227
    v_mfma_f32_16x16x32_bf16 a[172:175], a[236:239], v[200:203], a[172:175]
    ds_read_b128 a[208:211], v12 offset:0
    v_cvt_pk_bf16_f32 v232, v232, v233
    v_mfma_f32_16x16x32_bf16 a[156:159], a[232:235], v[200:203], a[156:159]
    v_exp_f32 v240, v240
    v_mfma_f32_16x16x32_bf16 a[160:163], a[232:235], v[208:211], a[160:163]
    v_exp_f32 v241, v241
    v_mfma_f32_16x16x32_bf16 a[176:179], a[236:239], v[208:211], a[176:179]
    v_exp_f32 v242, v242
    v_mfma_f32_16x16x32_bf16 a[180:183], a[236:239], v[216:219], a[180:183]
    buffer_load_dwordx4 v6, s[16:19], s39 offen lds
    v_mfma_f32_16x16x32_bf16 a[164:167], a[232:235], v[216:219], a[164:167]
    v_exp_f32 v243, v243
    v_mfma_f32_16x16x32_bf16 v[228:231], a[184:187], a[0:3], 0
    v_cvt_pk_bf16_f32 v233, v234, v235
    v_cvt_pk_bf16_f32 v240, v240, v241
    v_mfma_f32_16x16x32_bf16 v[228:231], a[188:191], a[16:19], v[228:231]
    v_exp_f32 v248, v248
    v_mfma_f32_16x16x32_bf16 v[228:231], a[192:195], a[32:35], v[228:231]
    v_exp_f32 v249, v249
    v_mfma_f32_16x16x32_bf16 v[228:231], a[196:199], a[48:51], v[228:231]
    v_exp_f32 v250, v250
    v_mfma_f32_16x16x32_bf16 v[228:231], a[200:203], a[64:67], v[228:231]
    v_exp_f32 v251, v251
    v_mfma_f32_16x16x32_bf16 v[228:231], a[204:207], a[80:83], v[228:231]
    v_cvt_pk_bf16_f32 v241, v242, v243
    v_cvt_pk_bf16_f32 v248, v248, v249
    v_mfma_f32_16x16x32_bf16 v[236:239], a[204:207], a[84:87], 0
    v_exp_f32 v24, v24
    v_mfma_f32_16x16x32_bf16 v[236:239], a[200:203], a[68:71], v[236:239]
    v_exp_f32 v25, v25
    v_mfma_f32_16x16x32_bf16 v[236:239], a[196:199], a[52:55], v[236:239]
    v_exp_f32 v26, v26
    v_mfma_f32_16x16x32_bf16 v[236:239], a[192:195], a[36:39], v[236:239]
    v_exp_f32 v27, v27
    v_mfma_f32_16x16x32_bf16 v[236:239], a[188:191], a[20:23], v[236:239]
    v_cvt_pk_bf16_f32 v249, v250, v251
    v_cvt_pk_bf16_f32 v226, v24, v25
    v_mfma_f32_16x16x32_bf16 v[236:239], a[184:187], a[4:7], v[236:239]
    v_exp_f32 v28, v28
    v_mfma_f32_16x16x32_bf16 v[244:247], a[184:187], a[8:11], 0
    v_exp_f32 v29, v29
    v_mfma_f32_16x16x32_bf16 v[244:247], a[188:191], a[24:27], v[244:247]
    v_exp_f32 v30, v30
    v_add_u32 v13, 67584, v13
    v_mfma_f32_16x16x32_bf16 v[244:247], a[192:195], a[40:43], v[244:247]
    ds_read_b128 a[212:215], v13 offset:0
    v_cvt_pk_bf16_f32 v227, v26, v27
    v_mfma_f32_16x16x32_bf16 v[244:247], a[196:199], a[56:59], v[244:247]
    ds_read_b128 a[216:219], v12 offset:1024
    v_cvt_pk_bf16_f32 v234, v28, v29
    v_mfma_f32_16x16x32_bf16 v[244:247], a[200:203], a[72:75], v[244:247]
    ds_read_b128 a[220:223], v13 offset:1024
    v_accvgpr_write_b32 a145, v113
    v_mfma_f32_16x16x32_bf16 v[244:247], a[204:207], a[88:91], v[244:247]
    ds_read_b128 a[224:227], v12 offset:2048
    v_accvgpr_write_b32 a146, v114
    v_mfma_f32_16x16x32_bf16 v[252:255], a[204:207], a[92:95], 0
    s_add_u32 s39, s40, 128
    ds_read_b128 a[228:231], v13 offset:2048
    v_accvgpr_write_b32 a147, v115
    v_mfma_f32_16x16x32_bf16 v[252:255], a[200:203], a[76:79], v[252:255]
    v_exp_f32 v31, v31
    v_mfma_f32_16x16x32_bf16 v[252:255], a[196:199], a[60:63], v[252:255]
    s_add_u32 m0, s63, 49152
    v_exp_f32 v32, v32
    v_mfma_f32_16x16x32_bf16 v[252:255], a[192:195], a[44:47], v[252:255]
    s_waitcnt lgkmcnt(4)
    v_exp_f32 v33, v33
    v_mfma_f32_16x16x32_bf16 v[252:255], a[188:191], a[28:31], v[252:255]
    v_exp_f32 v34, v34
    v_mfma_f32_16x16x32_bf16 v[252:255], a[184:187], a[12:15], v[252:255]
    s_waitcnt lgkmcnt(2)
    v_exp_f32 v35, v35
    v_mfma_f32_16x16x32_bf16 v[40:43], a[208:211], a[0:3], 0
    s_waitcnt vmcnt(11) lgkmcnt(0)
    v_cvt_pk_bf16_f32 v235, v30, v31
    v_cvt_pk_bf16_f32 v242, v32, v33
    v_mfma_f32_16x16x32_bf16 v[40:43], a[212:215], a[16:19], v[40:43]
    s_barrier
    v_mfma_f32_16x16x32_bf16 v[40:43], a[216:219], a[32:35], v[40:43]
    buffer_load_dwordx4 v6, s[16:19], s39 offen lds
    v_mfma_f32_16x16x32_bf16 v[40:43], a[220:223], a[48:51], v[40:43]
    ds_read_b64_tr_b16 a[240:241], v8 offset:36864
    v_cvt_pk_bf16_f32 v243, v34, v35
    v_mfma_f32_16x16x32_bf16 v[40:43], a[224:227], a[64:67], v[40:43]
    ds_read_b64_tr_b16 a[242:243], v8 offset:38912
    v_subrev_u32 v12, 67584, v12
    v_mfma_f32_16x16x32_bf16 v[40:43], a[228:231], a[80:83], v[40:43]
    ds_read_b64_tr_b16 a[244:245], v9 offset:36864
    v_accvgpr_write_b32 a148, v116
    v_mfma_f32_16x16x32_bf16 v[44:47], a[228:231], a[84:87], 0
    s_add_u32 s39, s40, 12416
    ds_read_b64_tr_b16 a[246:247], v9 offset:38912
    v_subrev_u32 v13, 67584, v13
    v_mfma_f32_16x16x32_bf16 v[44:47], a[224:227], a[68:71], v[44:47]
    ds_read_b128 a[184:187], v12 offset:0
    v_accvgpr_write_b32 a149, v117
    v_mfma_f32_16x16x32_bf16 v[44:47], a[220:223], a[52:55], v[44:47]
    s_addk_i32 m0, 4096
    ds_read_b128 a[188:191], v13 offset:0
    v_accvgpr_write_b32 a150, v118
    v_mfma_f32_16x16x32_bf16 v[44:47], a[216:219], a[36:39], v[44:47]
    ds_read_b128 a[192:195], v12 offset:1024
    v_accvgpr_write_b32 a151, v119
    v_mfma_f32_16x16x32_bf16 v[44:47], a[212:215], a[20:23], v[44:47]
    v_exp_f32 v36, v36
    v_mfma_f32_16x16x32_bf16 v[44:47], a[208:211], a[4:7], v[44:47]
    v_exp_f32 v37, v37
    v_mfma_f32_16x16x32_bf16 v[48:51], a[208:211], a[8:11], 0
    s_lshl_b32 s42, s54, 4
    ds_read_b128 a[196:199], v13 offset:1024
    v_cvt_pk_bf16_f32 v250, v36, v37
    v_mfma_f32_16x16x32_bf16 v[48:51], a[212:215], a[24:27], v[48:51]
    s_mul_i32 s42, s42, 384
    ds_read_b128 a[200:203], v12 offset:2048
    v_and_b32 v22, 15, v1
    v_mfma_f32_16x16x32_bf16 v[48:51], a[216:219], a[40:43], v[48:51]
    buffer_load_dwordx4 v6, s[16:19], s39 offen lds
    v_mfma_f32_16x16x32_bf16 v[48:51], a[220:223], a[56:59], v[48:51]
    ds_read_b128 a[204:207], v13 offset:2048
    v_mul_u32_u24 v22, 384, v22
    v_mfma_f32_16x16x32_bf16 v[48:51], a[224:227], a[72:75], v[48:51]
    buffer_load_dword a252, v22, s[16:19], s42 offen offset:256
    v_mfma_f32_16x16x32_bf16 v[48:51], a[228:231], a[88:91], v[48:51]
    v_exp_f32 v38, v38
    v_mfma_f32_16x16x32_bf16 v[52:55], a[228:231], a[92:95], 0
    s_add_u32 s39, s40, 24704
    v_exp_f32 v39, v39
    v_mfma_f32_16x16x32_bf16 v[52:55], a[224:227], a[76:79], v[52:55]
    v_exp_f32 v228, v228
    v_mfma_f32_16x16x32_bf16 v[52:55], a[220:223], a[60:63], v[52:55]
    s_addk_i32 m0, 4096
    v_exp_f32 v229, v229
    v_mfma_f32_16x16x32_bf16 v[52:55], a[216:219], a[44:47], v[52:55]
    s_waitcnt lgkmcnt(1)
    v_exp_f32 v230, v230
    v_mfma_f32_16x16x32_bf16 v[52:55], a[212:215], a[28:31], v[52:55]
    v_exp_f32 v231, v231
    v_mfma_f32_16x16x32_bf16 v[52:55], a[208:211], a[12:15], v[52:55]
    v_exp_f32 v236, v236
    v_mfma_f32_16x16x32_bf16 a[164:167], a[240:243], v[220:223], a[164:167]
    v_exp_f32 v237, v237
    v_mfma_f32_16x16x32_bf16 a[180:183], a[244:247], v[220:223], a[180:183]
    v_exp_f32 v238, v238
    v_mfma_f32_16x16x32_bf16 a[176:179], a[244:247], v[212:215], a[176:179]
    buffer_load_dwordx4 v6, s[16:19], s39 offen lds
    v_mfma_f32_16x16x32_bf16 a[160:163], a[240:243], v[212:215], a[160:163]
    ds_read_b128 a[208:211], v12 offset:6144
    v_cvt_pk_bf16_f32 v251, v38, v39
    v_mfma_f32_16x16x32_bf16 a[156:159], a[240:243], v[204:207], a[156:159]
    ds_read_b128 a[212:215], v13 offset:6144
    v_cvt_pk_bf16_f32 v228, v228, v229
    v_mfma_f32_16x16x32_bf16 a[172:175], a[244:247], v[204:207], a[172:175]
    ds_read_b128 a[216:219], v12 offset:7168
    v_cvt_pk_bf16_f32 v229, v230, v231
    v_mfma_f32_16x16x32_bf16 a[168:171], a[244:247], v[196:199], a[168:171]
    s_add_u32 s39, s40, 36992
    ds_read_b128 a[220:223], v13 offset:7168
    v_cvt_pk_bf16_f32 v236, v236, v237
    v_mfma_f32_16x16x32_bf16 a[152:155], a[240:243], v[196:199], a[152:155]
    v_exp_f32 v239, v239
    v_mfma_f32_16x16x32_bf16 v[56:59], a[184:187], a[0:3], 0
    s_addk_i32 m0, 4096
    ds_read_b128 a[224:227], v12 offset:8192
    v_cvt_pk_bf16_f32 v237, v238, v239
    v_mfma_f32_16x16x32_bf16 v[56:59], a[188:191], a[16:19], v[56:59]
    v_exp_f32 v244, v244
    v_mfma_f32_16x16x32_bf16 v[56:59], a[192:195], a[32:35], v[56:59]
    s_waitcnt lgkmcnt(4)
    v_exp_f32 v245, v245
    v_mfma_f32_16x16x32_bf16 v[56:59], a[196:199], a[48:51], v[56:59]
    ds_read_b128 a[228:231], v13 offset:8192
    v_cvt_pk_bf16_f32 v244, v244, v245
    v_mfma_f32_16x16x32_bf16 v[56:59], a[200:203], a[64:67], v[56:59]
    v_exp_f32 v246, v246
    v_mfma_f32_16x16x32_bf16 v[56:59], a[204:207], a[80:83], v[56:59]
    v_exp_f32 v247, v247
    v_mfma_f32_16x16x32_bf16 v[64:67], a[204:207], a[84:87], 0
    buffer_load_dwordx4 v6, s[16:19], s39 offen lds
    v_mfma_f32_16x16x32_bf16 v[64:67], a[200:203], a[68:71], v[64:67]
    v_exp_f32 v252, v252
    v_mfma_f32_16x16x32_bf16 v[64:67], a[196:199], a[52:55], v[64:67]
    v_exp_f32 v253, v253
    v_mfma_f32_16x16x32_bf16 v[64:67], a[192:195], a[36:39], v[64:67]
    v_exp_f32 v254, v254
    v_mfma_f32_16x16x32_bf16 v[64:67], a[188:191], a[20:23], v[64:67]
    v_exp_f32 v255, v255
    v_mfma_f32_16x16x32_bf16 v[64:67], a[184:187], a[4:7], v[64:67]
    v_exp_f32 v40, v40
    v_mfma_f32_16x16x32_bf16 v[72:75], a[184:187], a[8:11], 0
    v_exp_f32 v41, v41
    v_mfma_f32_16x16x32_bf16 v[72:75], a[188:191], a[24:27], v[72:75]
    v_exp_f32 v42, v42
    v_mfma_f32_16x16x32_bf16 v[72:75], a[192:195], a[40:43], v[72:75]
    v_exp_f32 v43, v43
    v_mfma_f32_16x16x32_bf16 v[72:75], a[196:199], a[56:59], v[72:75]
    v_cvt_pk_bf16_f32 v245, v246, v247
    v_cvt_pk_bf16_f32 v252, v252, v253
    v_mfma_f32_16x16x32_bf16 v[72:75], a[200:203], a[72:75], v[72:75]
    v_exp_f32 v44, v44
    v_mfma_f32_16x16x32_bf16 v[72:75], a[204:207], a[88:91], v[72:75]
    v_exp_f32 v45, v45
    v_mfma_f32_16x16x32_bf16 v[80:83], a[204:207], a[92:95], 0
    ds_read_b64_tr_b16 a[232:233], v8 offset:40960
    v_cvt_pk_bf16_f32 v253, v254, v255
    v_mfma_f32_16x16x32_bf16 v[80:83], a[200:203], a[76:79], v[80:83]
    ds_read_b64_tr_b16 a[234:235], v8 offset:43008
    v_cvt_pk_bf16_f32 v230, v40, v41
    v_mfma_f32_16x16x32_bf16 v[80:83], a[196:199], a[60:63], v[80:83]
    ds_read_b64_tr_b16 a[236:237], v9 offset:40960
    v_cvt_pk_bf16_f32 v231, v42, v43
    v_mfma_f32_16x16x32_bf16 v[80:83], a[192:195], a[44:47], v[80:83]
    ds_read_b64_tr_b16 a[238:239], v9 offset:43008
    v_cvt_pk_bf16_f32 v238, v44, v45
    v_mfma_f32_16x16x32_bf16 v[80:83], a[188:191], a[28:31], v[80:83]
    s_waitcnt lgkmcnt(4)
    v_exp_f32 v46, v46
    v_mfma_f32_16x16x32_bf16 v[80:83], a[184:187], a[12:15], v[80:83]
    v_exp_f32 v47, v47
    v_mfma_f32_16x16x32_bf16 v[24:27], a[208:211], a[0:3], 0
    v_exp_f32 v48, v48
    v_mfma_f32_16x16x32_bf16 v[24:27], a[212:215], a[16:19], v[24:27]
    v_exp_f32 v49, v49
    v_mfma_f32_16x16x32_bf16 v[24:27], a[216:219], a[32:35], v[24:27]
    ds_read_b128 a[184:187], v12 offset:12288
    v_cvt_pk_bf16_f32 v239, v46, v47
    v_mfma_f32_16x16x32_bf16 v[24:27], a[220:223], a[48:51], v[24:27]
    ds_read_b128 a[188:191], v13 offset:12288
    v_cvt_pk_bf16_f32 v246, v48, v49
    v_mfma_f32_16x16x32_bf16 v[24:27], a[224:227], a[64:67], v[24:27]
    v_exp_f32 v50, v50
    v_mfma_f32_16x16x32_bf16 v[24:27], a[228:231], a[80:83], v[24:27]
    v_exp_f32 v51, v51
    v_mfma_f32_16x16x32_bf16 v[28:31], a[228:231], a[84:87], 0
    ds_read_b128 a[192:195], v12 offset:13312
    v_cvt_pk_bf16_f32 v247, v50, v51
    v_mfma_f32_16x16x32_bf16 v[28:31], a[224:227], a[68:71], v[28:31]
    v_exp_f32 v52, v52
    v_mfma_f32_16x16x32_bf16 v[28:31], a[220:223], a[52:55], v[28:31]
    v_exp_f32 v53, v53
    v_mfma_f32_16x16x32_bf16 v[28:31], a[216:219], a[36:39], v[28:31]
    ds_read_b128 a[196:199], v13 offset:13312
    v_cvt_pk_bf16_f32 v254, v52, v53
    v_mfma_f32_16x16x32_bf16 v[28:31], a[212:215], a[20:23], v[28:31]
    v_exp_f32 v54, v54
    v_mfma_f32_16x16x32_bf16 v[28:31], a[208:211], a[4:7], v[28:31]
    v_exp_f32 v55, v55
    v_mfma_f32_16x16x32_bf16 v[32:35], a[208:211], a[8:11], 0
    ds_read_b128 a[200:203], v12 offset:14336
    v_cvt_pk_bf16_f32 v255, v54, v55
    v_mfma_f32_16x16x32_bf16 v[32:35], a[212:215], a[24:27], v[32:35]
    v_exp_f32 v56, v56
    v_mfma_f32_16x16x32_bf16 v[32:35], a[216:219], a[40:43], v[32:35]
    v_exp_f32 v57, v57
    v_mfma_f32_16x16x32_bf16 v[32:35], a[220:223], a[56:59], v[32:35]
    ds_read_b128 a[204:207], v13 offset:14336
    v_cvt_pk_bf16_f32 v56, v56, v57
    v_mfma_f32_16x16x32_bf16 v[32:35], a[224:227], a[72:75], v[32:35]
    v_exp_f32 v58, v58
    v_mfma_f32_16x16x32_bf16 v[32:35], a[228:231], a[88:91], v[32:35]
    v_exp_f32 v59, v59
    v_mfma_f32_16x16x32_bf16 v[36:39], a[228:231], a[92:95], 0
    v_exp_f32 v64, v64
    v_mfma_f32_16x16x32_bf16 v[36:39], a[224:227], a[76:79], v[36:39]
    v_exp_f32 v65, v65
    v_mfma_f32_16x16x32_bf16 v[36:39], a[220:223], a[60:63], v[36:39]
    v_exp_f32 v66, v66
    v_mfma_f32_16x16x32_bf16 v[36:39], a[216:219], a[44:47], v[36:39]
    s_waitcnt lgkmcnt(1)
    v_exp_f32 v67, v67
    v_mfma_f32_16x16x32_bf16 v[36:39], a[212:215], a[28:31], v[36:39]
    v_exp_f32 v72, v72
    v_mfma_f32_16x16x32_bf16 v[36:39], a[208:211], a[12:15], v[36:39]
    v_exp_f32 v73, v73
    v_mfma_f32_16x16x32_bf16 a[152:155], a[232:235], v[224:227], a[152:155]
    v_exp_f32 v74, v74
    v_mfma_f32_16x16x32_bf16 a[168:171], a[236:239], v[224:227], a[168:171]
    v_exp_f32 v75, v75
    v_mfma_f32_16x16x32_bf16 a[172:175], a[236:239], v[232:235], a[172:175]
    ds_read_b128 a[208:211], v12 offset:18432
    v_cvt_pk_bf16_f32 v57, v58, v59
    v_mfma_f32_16x16x32_bf16 a[156:159], a[232:235], v[232:235], a[156:159]
    ds_read_b128 a[212:215], v13 offset:18432
    v_cvt_pk_bf16_f32 v64, v64, v65
    v_mfma_f32_16x16x32_bf16 a[160:163], a[232:235], v[240:243], a[160:163]
    ds_read_b128 a[216:219], v12 offset:19456
    v_cvt_pk_bf16_f32 v65, v66, v67
    v_mfma_f32_16x16x32_bf16 a[176:179], a[236:239], v[240:243], a[176:179]
    ds_read_b128 a[220:223], v13 offset:19456
    v_cvt_pk_bf16_f32 v72, v72, v73
    v_mfma_f32_16x16x32_bf16 a[180:183], a[236:239], v[248:251], a[180:183]
    ds_read_b128 a[224:227], v12 offset:20480
    v_cvt_pk_bf16_f32 v73, v74, v75
    v_mfma_f32_16x16x32_bf16 a[164:167], a[232:235], v[248:251], a[164:167]
    v_exp_f32 v80, v80
    v_mfma_f32_16x16x32_bf16 v[60:63], a[184:187], a[0:3], 0
    v_exp_f32 v81, v81
    v_mfma_f32_16x16x32_bf16 v[60:63], a[188:191], a[16:19], v[60:63]
    ds_read_b128 a[228:231], v13 offset:20480
    v_cvt_pk_bf16_f32 v80, v80, v81
    v_mfma_f32_16x16x32_bf16 v[60:63], a[192:195], a[32:35], v[60:63]
    s_waitcnt lgkmcnt(4)
    v_exp_f32 v82, v82
    v_mfma_f32_16x16x32_bf16 v[60:63], a[196:199], a[48:51], v[60:63]
    v_exp_f32 v83, v83
    v_mfma_f32_16x16x32_bf16 v[60:63], a[200:203], a[64:67], v[60:63]
    v_exp_f32 v24, v24
    v_mfma_f32_16x16x32_bf16 v[60:63], a[204:207], a[80:83], v[60:63]
    v_exp_f32 v25, v25
    v_mfma_f32_16x16x32_bf16 v[68:71], a[204:207], a[84:87], 0
    v_exp_f32 v26, v26
    v_mfma_f32_16x16x32_bf16 v[68:71], a[200:203], a[68:71], v[68:71]
    v_exp_f32 v27, v27
    v_mfma_f32_16x16x32_bf16 v[68:71], a[196:199], a[52:55], v[68:71]
    v_exp_f32 v28, v28
    v_mfma_f32_16x16x32_bf16 v[68:71], a[192:195], a[36:39], v[68:71]
    v_exp_f32 v29, v29
    v_mfma_f32_16x16x32_bf16 v[68:71], a[188:191], a[20:23], v[68:71]
    v_cvt_pk_bf16_f32 v81, v82, v83
    v_cvt_pk_bf16_f32 v58, v24, v25
    v_mfma_f32_16x16x32_bf16 v[68:71], a[184:187], a[4:7], v[68:71]
    v_exp_f32 v30, v30
    v_mfma_f32_16x16x32_bf16 v[76:79], a[184:187], a[8:11], 0
    v_exp_f32 v31, v31
    v_mfma_f32_16x16x32_bf16 v[76:79], a[188:191], a[24:27], v[76:79]
    v_exp_f32 v32, v32
    v_mfma_f32_16x16x32_bf16 v[76:79], a[192:195], a[40:43], v[76:79]
    v_exp_f32 v33, v33
    v_mfma_f32_16x16x32_bf16 v[76:79], a[196:199], a[56:59], v[76:79]
    v_cvt_pk_bf16_f32 v59, v26, v27
    v_cvt_pk_bf16_f32 v66, v28, v29
    v_mfma_f32_16x16x32_bf16 v[76:79], a[200:203], a[72:75], v[76:79]
    v_exp_f32 v34, v34
    v_mfma_f32_16x16x32_bf16 v[76:79], a[204:207], a[88:91], v[76:79]
    v_exp_f32 v35, v35
    v_mfma_f32_16x16x32_bf16 v[84:87], a[204:207], a[92:95], 0
    s_add_u32 s39, s40, 49280
    v_exp_f32 v36, v36
    v_mfma_f32_16x16x32_bf16 v[84:87], a[200:203], a[76:79], v[84:87]
    v_exp_f32 v37, v37
    v_mfma_f32_16x16x32_bf16 v[84:87], a[196:199], a[60:63], v[84:87]
    s_add_u32 m0, s63, 0
    v_cvt_pk_bf16_f32 v67, v30, v31
    v_cvt_pk_bf16_f32 v74, v32, v33
    v_mfma_f32_16x16x32_bf16 v[84:87], a[192:195], a[44:47], v[84:87]
    v_exp_f32 v38, v38
    v_mfma_f32_16x16x32_bf16 v[84:87], a[188:191], a[28:31], v[84:87]
    v_exp_f32 v39, v39
    v_mfma_f32_16x16x32_bf16 v[84:87], a[184:187], a[12:15], v[84:87]
    s_waitcnt lgkmcnt(0)
    v_exp_f32 v60, v60
    v_mfma_f32_16x16x32_bf16 v[40:43], a[208:211], a[0:3], 0
    s_waitcnt vmcnt(7)
    v_exp_f32 v61, v61
    v_mfma_f32_16x16x32_bf16 v[40:43], a[212:215], a[16:19], v[40:43]
    s_barrier
    v_mfma_f32_16x16x32_bf16 v[40:43], a[216:219], a[32:35], v[40:43]
    buffer_load_dwordx4 v6, s[16:19], s39 offen lds
    v_mfma_f32_16x16x32_bf16 v[40:43], a[220:223], a[48:51], v[40:43]
    ds_read_b64_tr_b16 a[240:241], v8 offset:45056
    v_cvt_pk_bf16_f32 v75, v34, v35
    v_mfma_f32_16x16x32_bf16 v[40:43], a[224:227], a[64:67], v[40:43]
    ds_read_b64_tr_b16 a[242:243], v8 offset:47104
    v_cvt_pk_bf16_f32 v82, v36, v37
    v_mfma_f32_16x16x32_bf16 v[40:43], a[228:231], a[80:83], v[40:43]
    ds_read_b64_tr_b16 a[244:245], v9 offset:45056
    v_cvt_pk_bf16_f32 v83, v38, v39
    v_mfma_f32_16x16x32_bf16 v[44:47], a[228:231], a[84:87], 0
    s_add_u32 s39, s40, 61568
    ds_read_b64_tr_b16 a[246:247], v9 offset:47104
    v_cvt_pk_bf16_f32 v60, v60, v61
    v_mfma_f32_16x16x32_bf16 v[44:47], a[224:227], a[68:71], v[44:47]
    v_exp_f32 v62, v62
    v_mfma_f32_16x16x32_bf16 v[44:47], a[220:223], a[52:55], v[44:47]
    s_addk_i32 m0, 4096
    v_exp_f32 v63, v63
    v_mfma_f32_16x16x32_bf16 v[44:47], a[216:219], a[36:39], v[44:47]
    ds_read_b128 a[184:187], v12 offset:24576
    v_cvt_pk_bf16_f32 v61, v62, v63
    v_mfma_f32_16x16x32_bf16 v[44:47], a[212:215], a[20:23], v[44:47]
    v_exp_f32 v68, v68
    v_mfma_f32_16x16x32_bf16 v[44:47], a[208:211], a[4:7], v[44:47]
    v_exp_f32 v69, v69
    v_mfma_f32_16x16x32_bf16 v[48:51], a[208:211], a[8:11], 0
    s_mov_b32 s28, s82
    ds_read_b128 a[188:191], v13 offset:24576
    v_cvt_pk_bf16_f32 v68, v68, v69
    v_mfma_f32_16x16x32_bf16 v[48:51], a[212:215], a[24:27], v[48:51]
    s_and_b32 s29, s83, 0xffff
    ds_read_b128 a[192:195], v12 offset:25600
    v_and_b32 v22, 15, v1
    v_mfma_f32_16x16x32_bf16 v[48:51], a[216:219], a[40:43], v[48:51]
    buffer_load_dwordx4 v6, s[16:19], s39 offen lds
    v_mfma_f32_16x16x32_bf16 v[48:51], a[220:223], a[56:59], v[48:51]
    s_mov_b32 s30, 1966080
    ds_read_b128 a[196:199], v13 offset:25600
    v_mul_u32_u24 v22, 1280, v22
    v_mfma_f32_16x16x32_bf16 v[48:51], a[224:227], a[72:75], v[48:51]
    s_mov_b32 s31, 0x00020000
    v_exp_f32 v70, v70
    v_mfma_f32_16x16x32_bf16 v[48:51], a[228:231], a[88:91], v[48:51]
    s_mul_hi_u32 s48, s58, 429496730
    v_exp_f32 v71, v71
    v_mfma_f32_16x16x32_bf16 v[52:55], a[228:231], a[92:95], 0
    s_add_u32 s39, s40, 73856
    ds_read_b128 a[200:203], v12 offset:26624
    v_cvt_pk_bf16_f32 v69, v70, v71
    v_mfma_f32_16x16x32_bf16 v[52:55], a[224:227], a[76:79], v[52:55]
    s_mul_i32 s42, s48, 80640
    v_exp_f32 v76, v76
    v_mfma_f32_16x16x32_bf16 v[52:55], a[220:223], a[60:63], v[52:55]
    s_addk_i32 m0, 4096
    v_exp_f32 v77, v77
    v_mfma_f32_16x16x32_bf16 v[52:55], a[216:219], a[44:47], v[52:55]
    s_waitcnt lgkmcnt(2)
    ds_read_b128 a[204:207], v13 offset:26624
    v_cvt_pk_bf16_f32 v76, v76, v77
    v_mfma_f32_16x16x32_bf16 v[52:55], a[212:215], a[28:31], v[52:55]
    s_lshl_b32 s56, s58, 7
    v_exp_f32 v78, v78
    v_mfma_f32_16x16x32_bf16 v[52:55], a[208:211], a[12:15], v[52:55]
    s_add_u32 s42, s42, s56
    v_exp_f32 v79, v79
    v_mfma_f32_16x16x32_bf16 a[164:167], a[240:243], v[252:255], a[164:167]
    s_mul_i32 s56, s3, 20480
    v_exp_f32 v84, v84
    v_mfma_f32_16x16x32_bf16 a[180:183], a[244:247], v[252:255], a[180:183]
    s_add_u32 s42, s42, s56
    v_exp_f32 v85, v85
    v_mfma_f32_16x16x32_bf16 a[176:179], a[244:247], v[244:247], a[176:179]
    buffer_load_dword a252, v22, s[28:31], s42 offen
    v_mfma_f32_16x16x32_bf16 a[160:163], a[240:243], v[244:247], a[160:163]
    buffer_load_dwordx4 v6, s[16:19], s39 offen lds
    v_mfma_f32_16x16x32_bf16 a[156:159], a[240:243], v[236:239], a[156:159]
    s_add_u32 s56, s7, 1
    ds_read_b128 a[208:211], v12 offset:30720
    v_cvt_pk_bf16_f32 v77, v78, v79
    v_mfma_f32_16x16x32_bf16 a[172:175], a[244:247], v[236:239], a[172:175]
    ds_read_b128 a[212:215], v13 offset:30720
    v_cvt_pk_bf16_f32 v84, v84, v85
    v_mfma_f32_16x16x32_bf16 a[168:171], a[244:247], v[228:231], a[168:171]
    s_add_u32 s39, s40, 86144
    ds_read_b128 a[216:219], v12 offset:31744
    v_mov_b32 v4, s56
    v_mfma_f32_16x16x32_bf16 a[152:155], a[240:243], v[228:231], a[152:155]
    s_add_u32 s56, s7, 2
    v_exp_f32 v86, v86
    v_mfma_f32_16x16x32_bf16 v[88:91], a[184:187], a[0:3], 0
    s_waitcnt lgkmcnt(3)
    v_exp_f32 v87, v87
    v_mfma_f32_16x16x32_bf16 v[88:91], a[188:191], a[16:19], v[88:91]
    s_addk_i32 m0, 4096
    ds_read_b128 a[220:223], v13 offset:31744
    v_cvt_pk_bf16_f32 v85, v86, v87
    v_mfma_f32_16x16x32_bf16 v[88:91], a[192:195], a[32:35], v[88:91]
    v_exp_f32 v40, v40
    v_mfma_f32_16x16x32_bf16 v[88:91], a[196:199], a[48:51], v[88:91]
    v_exp_f32 v41, v41
    v_mfma_f32_16x16x32_bf16 v[88:91], a[200:203], a[64:67], v[88:91]
    ds_read_b128 a[224:227], v12 offset:32768
    v_cvt_pk_bf16_f32 v62, v40, v41
    v_mfma_f32_16x16x32_bf16 v[88:91], a[204:207], a[80:83], v[88:91]
    v_exp_f32 v42, v42
    v_mfma_f32_16x16x32_bf16 v[96:99], a[204:207], a[84:87], 0
    buffer_load_dwordx4 v6, s[16:19], s39 offen lds
    v_mfma_f32_16x16x32_bf16 v[96:99], a[200:203], a[68:71], v[96:99]
pg_8:
    s_cbranch_execz pg_10
    v_exp_f32 v43, v43
    v_mfma_f32_16x16x32_bf16 v[96:99], a[196:199], a[52:55], v[96:99]
    ds_read_b128 a[228:231], v13 offset:32768
    v_cvt_pk_bf16_f32 v63, v42, v43
    v_mfma_f32_16x16x32_bf16 v[96:99], a[192:195], a[36:39], v[96:99]
    v_exp_f32 v44, v44
    v_mfma_f32_16x16x32_bf16 v[96:99], a[188:191], a[20:23], v[96:99]
    s_add_u32 s39, s40, 98432
    v_exp_f32 v45, v45
    v_mfma_f32_16x16x32_bf16 v[96:99], a[184:187], a[4:7], v[96:99]
    v_exp_f32 v46, v46
    v_mfma_f32_16x16x32_bf16 v[104:107], a[184:187], a[8:11], 0
    s_addk_i32 m0, 4096
    v_exp_f32 v47, v47
    v_mfma_f32_16x16x32_bf16 v[104:107], a[188:191], a[24:27], v[104:107]
    v_exp_f32 v48, v48
    v_mfma_f32_16x16x32_bf16 v[104:107], a[192:195], a[40:43], v[104:107]
    v_exp_f32 v49, v49
    v_mfma_f32_16x16x32_bf16 v[104:107], a[196:199], a[56:59], v[104:107]
    v_exp_f32 v50, v50
    v_mfma_f32_16x16x32_bf16 v[104:107], a[200:203], a[72:75], v[104:107]
    v_exp_f32 v51, v51
    v_mfma_f32_16x16x32_bf16 v[104:107], a[204:207], a[88:91], v[104:107]
    v_cvt_pk_bf16_f32 v70, v44, v45
    v_cvt_pk_bf16_f32 v71, v46, v47
    v_mfma_f32_16x16x32_bf16 v[112:115], a[204:207], a[92:95], 0
    buffer_load_dwordx4 v6, s[16:19], s39 offen lds
    v_mfma_f32_16x16x32_bf16 v[112:115], a[200:203], a[76:79], v[112:115]
    ds_read_b64_tr_b16 a[232:233], v8 offset:49152
    v_cvt_pk_bf16_f32 v78, v48, v49
    v_mfma_f32_16x16x32_bf16 v[112:115], a[196:199], a[60:63], v[112:115]
    ds_read_b64_tr_b16 a[234:235], v8 offset:51200
    v_cvt_pk_bf16_f32 v79, v50, v51
    v_mfma_f32_16x16x32_bf16 v[112:115], a[192:195], a[44:47], v[112:115]
    s_waitcnt lgkmcnt(2)
    v_exp_f32 v52, v52
    v_mfma_f32_16x16x32_bf16 v[112:115], a[188:191], a[28:31], v[112:115]
    s_add_u32 s39, s40, 110720
    v_exp_f32 v53, v53
    v_mfma_f32_16x16x32_bf16 v[112:115], a[184:187], a[12:15], v[112:115]
    ds_read_b64_tr_b16 a[236:237], v9 offset:49152
    v_cvt_pk_bf16_f32 v86, v52, v53
    v_mfma_f32_16x16x32_bf16 v[24:27], a[208:211], a[0:3], 0
    s_addk_i32 m0, 4096
    v_exp_f32 v54, v54
    v_mfma_f32_16x16x32_bf16 v[24:27], a[212:215], a[16:19], v[24:27]
    v_exp_f32 v55, v55
    v_mfma_f32_16x16x32_bf16 v[24:27], a[216:219], a[32:35], v[24:27]
    ds_read_b64_tr_b16 a[238:239], v9 offset:51200
    v_cvt_pk_bf16_f32 v87, v54, v55
    v_mfma_f32_16x16x32_bf16 v[24:27], a[220:223], a[48:51], v[24:27]
    v_exp_f32 v88, v88
    v_mfma_f32_16x16x32_bf16 v[24:27], a[224:227], a[64:67], v[24:27]
    v_exp_f32 v89, v89
    v_mfma_f32_16x16x32_bf16 v[24:27], a[228:231], a[80:83], v[24:27]
    ds_read_b128 a[184:187], v12 offset:36864
    v_cvt_pk_bf16_f32 v88, v88, v89
    v_mfma_f32_16x16x32_bf16 v[28:31], a[228:231], a[84:87], 0
    buffer_load_dwordx4 v6, s[16:19], s39 offen lds
    v_mfma_f32_16x16x32_bf16 v[28:31], a[224:227], a[68:71], v[28:31]
    v_exp_f32 v90, v90
    v_mfma_f32_16x16x32_bf16 v[28:31], a[220:223], a[52:55], v[28:31]
    v_exp_f32 v91, v91
    v_mfma_f32_16x16x32_bf16 v[28:31], a[216:219], a[36:39], v[28:31]
    ds_read_b128 a[188:191], v13 offset:36864
    v_cvt_pk_bf16_f32 v89, v90, v91
    v_mfma_f32_16x16x32_bf16 v[28:31], a[212:215], a[20:23], v[28:31]
    v_exp_f32 v96, v96
    v_mfma_f32_16x16x32_bf16 v[28:31], a[208:211], a[4:7], v[28:31]
    v_exp_f32 v97, v97
    v_mfma_f32_16x16x32_bf16 v[32:35], a[208:211], a[8:11], 0
    ds_read_b128 a[192:195], v12 offset:37888
    v_cvt_pk_bf16_f32 v96, v96, v97
    v_mfma_f32_16x16x32_bf16 v[32:35], a[212:215], a[24:27], v[32:35]
    v_exp_f32 v98, v98
    v_mfma_f32_16x16x32_bf16 v[32:35], a[216:219], a[40:43], v[32:35]
    v_exp_f32 v99, v99
    v_mfma_f32_16x16x32_bf16 v[32:35], a[220:223], a[56:59], v[32:35]
    ds_read_b128 a[196:199], v13 offset:37888
    v_cvt_pk_bf16_f32 v97, v98, v99
    v_mfma_f32_16x16x32_bf16 v[32:35], a[224:227], a[72:75], v[32:35]
    v_exp_f32 v104, v104
    v_mfma_f32_16x16x32_bf16 v[32:35], a[228:231], a[88:91], v[32:35]
    v_exp_f32 v105, v105
    v_mfma_f32_16x16x32_bf16 v[36:39], a[228:231], a[92:95], 0
    ds_read_b128 a[200:203], v12 offset:38912
    v_cvt_pk_bf16_f32 v104, v104, v105
    v_mfma_f32_16x16x32_bf16 v[36:39], a[224:227], a[76:79], v[36:39]
    v_exp_f32 v106, v106
    v_mfma_f32_16x16x32_bf16 v[36:39], a[220:223], a[60:63], v[36:39]
    v_exp_f32 v107, v107
    v_mfma_f32_16x16x32_bf16 v[36:39], a[216:219], a[44:47], v[36:39]
    s_waitcnt lgkmcnt(2)
    ds_read_b128 a[204:207], v13 offset:38912
    v_cvt_pk_bf16_f32 v105, v106, v107
    v_mfma_f32_16x16x32_bf16 v[36:39], a[212:215], a[28:31], v[36:39]
    v_exp_f32 v112, v112
    v_mfma_f32_16x16x32_bf16 v[36:39], a[208:211], a[12:15], v[36:39]
    v_exp_f32 v113, v113
    v_mfma_f32_16x16x32_bf16 a[152:155], a[232:235], v[56:59], a[152:155]
    v_exp_f32 v114, v114
    v_mfma_f32_16x16x32_bf16 a[168:171], a[236:239], v[56:59], a[168:171]
    v_exp_f32 v115, v115
    v_mfma_f32_16x16x32_bf16 a[172:175], a[236:239], v[64:67], a[172:175]
    ds_read_b128 a[208:211], v12 offset:43008
    v_cvt_pk_bf16_f32 v112, v112, v113
    v_mfma_f32_16x16x32_bf16 a[156:159], a[232:235], v[64:67], a[156:159]
    ds_read_b128 a[212:215], v13 offset:43008
    v_cvt_pk_bf16_f32 v113, v114, v115
    v_mfma_f32_16x16x32_bf16 a[160:163], a[232:235], v[72:75], a[160:163]
    v_exp_f32 v24, v24
    v_mfma_f32_16x16x32_bf16 a[176:179], a[236:239], v[72:75], a[176:179]
    v_exp_f32 v25, v25
    v_mfma_f32_16x16x32_bf16 a[180:183], a[236:239], v[80:83], a[180:183]
    ds_read_b128 a[216:219], v12 offset:44032
    v_cvt_pk_bf16_f32 v90, v24, v25
    v_mfma_f32_16x16x32_bf16 a[164:167], a[232:235], v[80:83], a[164:167]
    ds_read_b128 a[220:223], v13 offset:44032
    v_mov_b32 v24, 0
    v_mfma_f32_16x16x32_bf16 v[92:95], a[184:187], a[0:3], 0
    s_waitcnt lgkmcnt(4)
    ds_read_b128 a[224:227], v12 offset:45056
    v_mov_b32 v25, 0
    v_mfma_f32_16x16x32_bf16 v[92:95], a[188:191], a[16:19], v[92:95]
    v_exp_f32 v26, v26
    v_mfma_f32_16x16x32_bf16 v[92:95], a[192:195], a[32:35], v[92:95]
    v_exp_f32 v27, v27
    v_mfma_f32_16x16x32_bf16 v[92:95], a[196:199], a[48:51], v[92:95]
    ds_read_b128 a[228:231], v13 offset:45056
    v_cvt_pk_bf16_f32 v91, v26, v27
    v_mfma_f32_16x16x32_bf16 v[92:95], a[200:203], a[64:67], v[92:95]
    v_exp_f32 v28, v28
    v_mfma_f32_16x16x32_bf16 v[92:95], a[204:207], a[80:83], v[92:95]
    v_exp_f32 v29, v29
    v_mfma_f32_16x16x32_bf16 v[100:103], a[204:207], a[84:87], 0
    v_exp_f32 v30, v30
    v_mfma_f32_16x16x32_bf16 v[100:103], a[200:203], a[68:71], v[100:103]
    v_exp_f32 v31, v31
    v_mfma_f32_16x16x32_bf16 v[100:103], a[196:199], a[52:55], v[100:103]
    v_exp_f32 v32, v32
    v_mfma_f32_16x16x32_bf16 v[100:103], a[192:195], a[36:39], v[100:103]
    v_exp_f32 v33, v33
    v_mfma_f32_16x16x32_bf16 v[100:103], a[188:191], a[20:23], v[100:103]
    v_exp_f32 v34, v34
    v_mfma_f32_16x16x32_bf16 v[100:103], a[184:187], a[4:7], v[100:103]
    v_exp_f32 v35, v35
    v_mfma_f32_16x16x32_bf16 v[108:111], a[184:187], a[8:11], 0
    v_cvt_pk_bf16_f32 v98, v28, v29
    v_cvt_pk_bf16_f32 v99, v30, v31
    v_mfma_f32_16x16x32_bf16 v[108:111], a[188:191], a[24:27], v[108:111]
    v_exp_f32 v36, v36
    v_mfma_f32_16x16x32_bf16 v[108:111], a[192:195], a[40:43], v[108:111]
    v_exp_f32 v37, v37
    v_mfma_f32_16x16x32_bf16 v[108:111], a[196:199], a[56:59], v[108:111]
    v_exp_f32 v38, v38
    v_mfma_f32_16x16x32_bf16 v[108:111], a[200:203], a[72:75], v[108:111]
    v_exp_f32 v39, v39
    v_mfma_f32_16x16x32_bf16 v[108:111], a[204:207], a[88:91], v[108:111]
    v_cvt_pk_bf16_f32 v106, v32, v33
    v_cvt_pk_bf16_f32 v107, v34, v35
    v_mfma_f32_16x16x32_bf16 v[116:119], a[204:207], a[92:95], 0
    s_add_u32 s39, s40, 123008
    v_cvt_pk_bf16_f32 v114, v36, v37
    v_cvt_pk_bf16_f32 v115, v38, v39
    v_mfma_f32_16x16x32_bf16 v[116:119], a[200:203], a[76:79], v[116:119]
    v_exp_f32 v92, v92
    v_mfma_f32_16x16x32_bf16 v[116:119], a[196:199], a[60:63], v[116:119]
    s_addk_i32 m0, 4096
    v_exp_f32 v93, v93
    v_mfma_f32_16x16x32_bf16 v[116:119], a[192:195], a[44:47], v[116:119]
    s_waitcnt lgkmcnt(0)
    v_exp_f32 v94, v94
    v_mfma_f32_16x16x32_bf16 v[116:119], a[188:191], a[28:31], v[116:119]
    v_exp_f32 v95, v95
    v_mfma_f32_16x16x32_bf16 v[116:119], a[184:187], a[12:15], v[116:119]
    v_exp_f32 v100, v100
    v_mfma_f32_16x16x32_bf16 v[40:43], a[208:211], a[0:3], 0
    s_waitcnt vmcnt(12)
    v_exp_f32 v101, v101
    v_mfma_f32_16x16x32_bf16 v[40:43], a[212:215], a[16:19], v[40:43]
    s_barrier
    v_mfma_f32_16x16x32_bf16 v[40:43], a[216:219], a[32:35], v[40:43]
    buffer_load_dwordx4 v6, s[16:19], s39 offen lds
    v_mfma_f32_16x16x32_bf16 v[40:43], a[220:223], a[48:51], v[40:43]
    s_add_u32 s39, s40, 135296
    ds_read_b64_tr_b16 a[240:241], v8 offset:53248
    v_cvt_pk_bf16_f32 v92, v92, v93
    v_mfma_f32_16x16x32_bf16 v[40:43], a[224:227], a[64:67], v[40:43]
    s_addk_i32 m0, 4096
    ds_read_b64_tr_b16 a[242:243], v8 offset:55296
    v_cvt_pk_bf16_f32 v93, v94, v95
    v_mfma_f32_16x16x32_bf16 v[40:43], a[228:231], a[80:83], v[40:43]
    ds_read_b64_tr_b16 a[244:245], v9 offset:53248
    v_cvt_pk_bf16_f32 v100, v100, v101
    v_mfma_f32_16x16x32_bf16 v[44:47], a[228:231], a[84:87], 0
    ds_read_b64_tr_b16 a[246:247], v9 offset:55296
    v_mov_b32 v28, 0
    v_mfma_f32_16x16x32_bf16 v[44:47], a[224:227], a[68:71], v[44:47]
    v_exp_f32 v102, v102
    v_mfma_f32_16x16x32_bf16 v[44:47], a[220:223], a[52:55], v[44:47]
    v_exp_f32 v103, v103
    v_mfma_f32_16x16x32_bf16 v[44:47], a[216:219], a[36:39], v[44:47]
    v_exp_f32 v108, v108
    v_mfma_f32_16x16x32_bf16 v[44:47], a[212:215], a[20:23], v[44:47]
    buffer_load_dwordx4 v6, s[16:19], s39 offen lds
    v_mfma_f32_16x16x32_bf16 v[44:47], a[208:211], a[4:7], v[44:47]
    s_add_u32 s39, s40, 147584
    v_exp_f32 v109, v109
    v_mfma_f32_16x16x32_bf16 v[48:51], a[208:211], a[8:11], 0
    s_addk_i32 m0, 4096
    v_exp_f32 v110, v110
    v_mfma_f32_16x16x32_bf16 v[48:51], a[212:215], a[24:27], v[48:51]
    v_exp_f32 v111, v111
    v_mfma_f32_16x16x32_bf16 v[48:51], a[216:219], a[40:43], v[48:51]
    v_cvt_pk_bf16_f32 v101, v102, v103
    v_cvt_pk_bf16_f32 v108, v108, v109
    v_mfma_f32_16x16x32_bf16 v[48:51], a[220:223], a[56:59], v[48:51]
    v_exp_f32 v116, v116
    v_mfma_f32_16x16x32_bf16 v[48:51], a[224:227], a[72:75], v[48:51]
    v_exp_f32 v117, v117
    v_mfma_f32_16x16x32_bf16 v[48:51], a[228:231], a[88:91], v[48:51]
    v_exp_f32 v118, v118
    v_mfma_f32_16x16x32_bf16 v[52:55], a[228:231], a[92:95], 0
    buffer_load_dwordx4 v6, s[16:19], s39 offen lds
    v_mfma_f32_16x16x32_bf16 v[52:55], a[224:227], a[76:79], v[52:55]
    s_add_u32 s39, s40, 159872
    v_exp_f32 v119, v119
    v_mfma_f32_16x16x32_bf16 v[52:55], a[220:223], a[60:63], v[52:55]
    s_addk_i32 m0, 4096
    v_cvt_pk_bf16_f32 v109, v110, v111
    v_cvt_pk_bf16_f32 v116, v116, v117
    v_mfma_f32_16x16x32_bf16 v[52:55], a[216:219], a[44:47], v[52:55]
    s_waitcnt lgkmcnt(0)
    v_exp_f32 v40, v40
    v_mfma_f32_16x16x32_bf16 v[52:55], a[212:215], a[28:31], v[52:55]
    v_exp_f32 v41, v41
    v_mfma_f32_16x16x32_bf16 v[52:55], a[208:211], a[12:15], v[52:55]
    v_exp_f32 v42, v42
    v_mfma_f32_16x16x32_bf16 a[164:167], a[240:243], v[84:87], a[164:167]
    v_exp_f32 v43, v43
    v_mfma_f32_16x16x32_bf16 a[180:183], a[244:247], v[84:87], a[180:183]
    v_cvt_pk_bf16_f32 v117, v118, v119
    v_cvt_pk_bf16_f32 v94, v40, v41
    v_mfma_f32_16x16x32_bf16 a[176:179], a[244:247], v[76:79], a[176:179]
    buffer_load_dwordx4 v6, s[16:19], s39 offen lds
    v_mfma_f32_16x16x32_bf16 a[160:163], a[240:243], v[76:79], a[160:163]
    s_add_u32 s39, s40, 172160
    v_exp_f32 v44, v44
    v_mfma_f32_16x16x32_bf16 a[156:159], a[240:243], v[68:71], a[156:159]
    s_addk_i32 m0, 4096
    v_exp_f32 v45, v45
    v_mfma_f32_16x16x32_bf16 a[172:175], a[244:247], v[68:71], a[172:175]
    v_exp_f32 v46, v46
    v_mfma_f32_16x16x32_bf16 a[168:171], a[244:247], v[60:63], a[168:171]
    v_exp_f32 v47, v47
    v_mfma_f32_16x16x32_bf16 a[152:155], a[240:243], v[60:63], a[152:155]
    v_cvt_pk_bf16_f32 v95, v42, v43
    v_cvt_pk_bf16_f32 v102, v44, v45
    v_smfmac_f32_16x16x64_bf16 v[24:27], a[248:251], a[96:103], v20
    v_cvt_pk_bf16_f32 v103, v46, v47
    v_mov_b32 v29, 0
    s_nop 1
    v_smfmac_f32_16x16x64_bf16 v[28:31], a[248:251], a[104:111], v20
    v_mov_b32 v32, 0
    v_mov_b32 v33, 0
    s_nop 1
    v_smfmac_f32_16x16x64_bf16 v[32:35], a[248:251], a[112:119], v20
    buffer_load_dwordx4 v6, s[16:19], s39 offen lds
    v_mov_b32 v36, 0
    v_mov_b32 v37, 0
    s_nop 1
    v_smfmac_f32_16x16x64_bf16 v[36:39], a[248:251], a[120:127], v20
    s_add_u32 s39, s40, 184448
    ds_read_b64_tr_b16 a[232:233], v8 offset:57344
    v_smfmac_f32_16x16x64_bf16 v[24:27], a[248:251], a[128:135], v20
    s_addk_i32 m0, 4096
    ds_read_b64_tr_b16 a[234:235], v8 offset:59392
    v_smfmac_f32_16x16x64_bf16 v[28:31], a[248:251], a[136:143], v20
    ds_read_b64_tr_b16 a[236:237], v9 offset:57344
    v_smfmac_f32_16x16x64_bf16 v[32:35], a[248:251], a[144:151], v20
    ds_read_b64_tr_b16 a[238:239], v9 offset:59392
    v_smfmac_f32_16x16x64_bf16 v[36:39], a[248:251], v[120:127], v20
    v_smfmac_f32_16x16x64_bf16 v[24:27], a[248:251], v[128:135], v20
    v_smfmac_f32_16x16x64_bf16 v[28:31], a[248:251], v[136:143], v20
    v_smfmac_f32_16x16x64_bf16 v[32:35], a[248:251], v[144:151], v20
    buffer_load_dwordx4 v6, s[16:19], s39 offen lds
    v_smfmac_f32_16x16x64_bf16 v[36:39], a[248:251], v[152:159], v20
    s_add_u32 s38, s44, 0
    ds_read_b64_tr_b16 a[240:241], v8 offset:61440
    s_add_u32 s36, s44, 40960
    v_smfmac_f32_16x16x64_bf16 v[24:27], a[248:251], v[160:167], v20
    s_cmp_lt_u32 s3, 2
    s_cselect_b32 s38, s38, s36
    s_add_u32 m0, s63, 155648
    v_smfmac_f32_16x16x64_bf16 v[28:31], a[248:251], v[168:175], v20
    ds_read_b64_tr_b16 a[242:243], v8 offset:63488
    v_smfmac_f32_16x16x64_bf16 v[32:35], a[248:251], v[176:183], v20
    ds_read_b64_tr_b16 a[244:245], v9 offset:61440
    v_smfmac_f32_16x16x64_bf16 v[36:39], a[248:251], v[184:191], v20
    ds_read_b64_tr_b16 a[246:247], v9 offset:63488
    v_smfmac_f32_16x16x64_bf16 v[24:27], a[248:251], v[192:199], v20
    v_smfmac_f32_16x16x64_bf16 v[28:31], a[248:251], v[200:207], v20
    v_smfmac_f32_16x16x64_bf16 v[32:35], a[248:251], v[208:215], v20
    buffer_load_dwordx4 v7, s[8:11], s38 offen lds
    v_smfmac_f32_16x16x64_bf16 v[36:39], a[248:251], v[216:223], v20
    s_add_u32 s38, s44, 0
    ds_read_b64_tr_b16 a[184:185], v10 offset:0
    v_smfmac_f32_16x16x64_bf16 v[24:27], a[248:251], v[224:231], v20
    s_addk_i32 m0, -16384
    ds_read_b64_tr_b16 a[186:187], v10 offset:2048
    v_smfmac_f32_16x16x64_bf16 v[28:31], a[248:251], v[232:239], v20
    ds_read_b64_tr_b16 a[188:189], v10 offset:4096
    v_smfmac_f32_16x16x64_bf16 v[32:35], a[248:251], v[240:247], v20
    s_waitcnt lgkmcnt(3)
    ds_read_b64_tr_b16 a[190:191], v10 offset:6144
    v_smfmac_f32_16x16x64_bf16 v[36:39], a[248:251], v[248:255], v20
    v_smfmac_f32_16x16x64_bf16 v[24:27], a[248:251], v[56:63], v20
    v_smfmac_f32_16x16x64_bf16 v[28:31], a[248:251], v[64:71], v20
    v_smfmac_f32_16x16x64_bf16 v[32:35], a[248:251], v[72:79], v20
    buffer_load_dwordx4 v2, s[8:11], s38 offen lds
    v_smfmac_f32_16x16x64_bf16 v[36:39], a[248:251], v[80:87], v20
    s_add_u32 s38, s44, 0
    ds_read_b64_tr_b16 a[192:193], v10 offset:8192
    v_smfmac_f32_16x16x64_bf16 v[24:27], a[248:251], v[88:95], v20
    s_addk_i32 m0, 4096
    ds_read_b64_tr_b16 a[194:195], v10 offset:10240
    v_smfmac_f32_16x16x64_bf16 v[28:31], a[248:251], v[96:103], v20
    ds_read_b64_tr_b16 a[196:197], v10 offset:12288
    v_exp_f32 v48, v48
    v_exp_f32 v49, v49
    v_exp_f32 v50, v50
    v_exp_f32 v51, v51
    v_cvt_pk_bf16_f32 v110, v48, v49
    v_cvt_pk_bf16_f32 v111, v50, v51
    s_nop 1
    v_smfmac_f32_16x16x64_bf16 v[32:35], a[248:251], v[104:111], v20
    ds_read_b64_tr_b16 a[198:199], v10 offset:14336
    v_add_f32 v24, v24, v25
    v_exp_f32 v52, v52
    v_exp_f32 v53, v53
    v_exp_f32 v54, v54
    v_exp_f32 v55, v55
    v_cvt_pk_bf16_f32 v118, v52, v53
    v_cvt_pk_bf16_f32 v119, v54, v55
    s_nop 1
    v_smfmac_f32_16x16x64_bf16 v[36:39], a[248:251], v[112:119], v20
    v_add_f32 v28, v28, v29
    v_mfma_f32_16x16x32_bf16 a[152:155], a[232:235], v[88:91], a[152:155]
    v_rcp_f32 v16, v24
    v_mfma_f32_16x16x32_bf16 a[168:171], a[236:239], v[88:91], a[168:171]
    v_rcp_f32 v17, v28
    v_mfma_f32_16x16x32_bf16 a[172:175], a[236:239], v[96:99], a[172:175]
    buffer_load_dwordx4 v3, s[8:11], s38 offen lds
    v_mfma_f32_16x16x32_bf16 a[156:159], a[232:235], v[96:99], a[156:159]
    s_add_u32 s38, s44, 40960
    ds_read_b64_tr_b16 a[200:201], v10 offset:16384
    v_add_f32 v32, v32, v33
    v_mfma_f32_16x16x32_bf16 a[160:163], a[232:235], v[104:107], a[160:163]
    s_addk_i32 m0, 4096
    ds_read_b64_tr_b16 a[202:203], v10 offset:18432
    v_add_f32 v36, v36, v37
    v_mfma_f32_16x16x32_bf16 a[176:179], a[236:239], v[104:107], a[176:179]
    ds_read_b64_tr_b16 a[204:205], v10 offset:20480
    v_max3_f32 v21, v24, v28, v32
    v_mfma_f32_16x16x32_bf16 a[180:183], a[236:239], v[112:115], a[180:183]
    s_waitcnt lgkmcnt(3)
    ds_read_b64_tr_b16 a[206:207], v10 offset:22528
    v_max3_f32 v21, v21, v36, v16
    v_mfma_f32_16x16x32_bf16 a[164:167], a[232:235], v[112:115], a[164:167]
    v_rcp_f32 v18, v32
    v_mfma_f32_16x16x32_bf16 a[164:167], a[240:243], v[116:119], a[164:167]
    v_rcp_f32 v19, v36
    v_mfma_f32_16x16x32_bf16 a[180:183], a[244:247], v[116:119], a[180:183]
    v_max3_f32 v21, v21, v17, v18
    v_max_f32 v21, v21, v19
    v_mfma_f32_16x16x32_bf16 a[176:179], a[244:247], v[108:111], a[176:179]
    buffer_load_dwordx4 v2, s[8:11], s38 offen lds
    v_mfma_f32_16x16x32_bf16 a[160:163], a[240:243], v[108:111], a[160:163]
    s_add_u32 s38, s44, 40960
    ds_read_b64_tr_b16 a[208:209], v10 offset:24576
    v_cmp_nge_f32 vcc, 0x5f800000, v21
    v_mfma_f32_16x16x32_bf16 a[156:159], a[240:243], v[100:103], a[156:159]
    s_addk_i32 m0, 4096
    ds_read_b64_tr_b16 a[210:211], v10 offset:26624
    v_mfma_f32_16x16x32_bf16 a[172:175], a[244:247], v[100:103], a[172:175]
    ds_read_b64_tr_b16 a[212:213], v10 offset:28672
    v_mfma_f32_16x16x32_bf16 a[168:171], a[244:247], v[92:95], a[168:171]
    ds_read_b64_tr_b16 a[214:215], v10 offset:30720
    v_mfma_f32_16x16x32_bf16 a[152:155], a[240:243], v[92:95], a[152:155]
    s_cbranch_vccnz rare
rare_ret:
    v_mfma_f32_16x16x32_bf16 v[40:43], a[184:187], a[96:99], 0
    v_subrev_u32 v8, 73728, v8
    v_subrev_u32 v9, 73728, v9
    v_mfma_f32_16x16x32_bf16 v[40:43], a[188:191], a[100:103], v[40:43]
    v_mfma_f32_16x16x32_bf16 v[44:47], a[188:191], a[108:111], 0
    s_barrier
    v_mfma_f32_16x16x32_bf16 v[44:47], a[184:187], a[104:107], v[44:47]
    buffer_load_dwordx4 v3, s[8:11], s38 offen lds
    v_mfma_f32_16x16x32_bf16 v[48:51], a[184:187], a[112:115], 0
    v_accvgpr_read_b32 v21, a152
    v_accvgpr_read_b32 v22, a153
    v_mfma_f32_16x16x32_bf16 v[48:51], a[188:191], a[116:119], v[48:51]
    v_accvgpr_read_b32 v23, a154
    v_accvgpr_read_b32 v5, a155
    v_mfma_f32_16x16x32_bf16 v[52:55], a[188:191], a[124:127], 0
    v_mul_f32 v21, v16, v21
    v_mul_f32 v22, v16, v22
    v_mfma_f32_16x16x32_bf16 v[52:55], a[184:187], a[120:123], v[52:55]
    ds_read_b64_tr_b16 a[184:185], v10 offset:32768
    v_mul_f32 v23, v16, v23
    v_mfma_f32_16x16x32_bf16 v[52:55], a[192:195], v[120:123], v[52:55]
    ds_read_b64_tr_b16 a[186:187], v10 offset:34816
    v_mul_f32 v5, v16, v5
    v_mfma_f32_16x16x32_bf16 v[52:55], a[196:199], v[124:127], v[52:55]
    ds_read_b64_tr_b16 a[188:189], v10 offset:36864
    v_cvt_pk_bf16_f32 v21, v21, v22
    v_mfma_f32_16x16x32_bf16 v[48:51], a[196:199], a[148:151], v[48:51]
    s_waitcnt lgkmcnt(3)
    ds_read_b64_tr_b16 a[190:191], v10 offset:38912
    v_cvt_pk_bf16_f32 v22, v23, v5
    v_mfma_f32_16x16x32_bf16 v[48:51], a[192:195], a[144:147], v[48:51]
    v_accvgpr_write_b32 a0, v21
    v_accvgpr_write_b32 a1, v22
    v_mfma_f32_16x16x32_bf16 v[44:47], a[192:195], a[136:139], v[44:47]
    v_accvgpr_read_b32 v21, a168
    v_accvgpr_read_b32 v22, a169
    v_mfma_f32_16x16x32_bf16 v[44:47], a[196:199], a[140:143], v[44:47]
    v_accvgpr_read_b32 v23, a170
    v_accvgpr_read_b32 v5, a171
    v_mfma_f32_16x16x32_bf16 v[40:43], a[196:199], a[132:135], v[40:43]
    v_mul_f32 v21, v16, v21
    v_mul_f32 v22, v16, v22
    v_mfma_f32_16x16x32_bf16 v[40:43], a[192:195], a[128:131], v[40:43]
    ds_read_b64_tr_b16 a[192:193], v10 offset:40960
    v_mul_f32 v23, v16, v23
    v_mfma_f32_16x16x32_bf16 v[40:43], a[200:203], v[128:131], v[40:43]
    ds_read_b64_tr_b16 a[194:195], v10 offset:43008
    v_mul_f32 v5, v16, v5
    v_mfma_f32_16x16x32_bf16 v[40:43], a[204:207], v[132:135], v[40:43]
    ds_read_b64_tr_b16 a[196:197], v10 offset:45056
    v_cvt_pk_bf16_f32 v21, v21, v22
    v_mfma_f32_16x16x32_bf16 v[44:47], a[204:207], v[140:143], v[44:47]
    ds_read_b64_tr_b16 a[198:199], v10 offset:47104
    v_cvt_pk_bf16_f32 v22, v23, v5
    v_mfma_f32_16x16x32_bf16 v[44:47], a[200:203], v[136:139], v[44:47]
    v_accvgpr_write_b32 a2, v21
    v_accvgpr_write_b32 a3, v22
    v_mfma_f32_16x16x32_bf16 v[48:51], a[200:203], v[144:147], v[48:51]
    buffer_store_dwordx4 a[0:3], v14, s[20:23], s55 offen offset:0 sc1
    v_accvgpr_read_b32 v21, a156
    v_mfma_f32_16x16x32_bf16 v[48:51], a[204:207], v[148:151], v[48:51]
    v_accvgpr_read_b32 v22, a157
    v_accvgpr_read_b32 v23, a158
    v_mfma_f32_16x16x32_bf16 v[52:55], a[204:207], v[156:159], v[52:55]
    v_accvgpr_read_b32 v5, a159
    v_mul_f32 v21, v17, v21
    v_mfma_f32_16x16x32_bf16 v[52:55], a[200:203], v[152:155], v[52:55]
    ds_read_b64_tr_b16 a[200:201], v10 offset:49152
    v_mul_f32 v22, v17, v22
    v_mfma_f32_16x16x32_bf16 v[52:55], a[208:211], v[184:187], v[52:55]
    ds_read_b64_tr_b16 a[202:203], v10 offset:51200
    v_mul_f32 v23, v17, v23
    v_mfma_f32_16x16x32_bf16 v[52:55], a[212:215], v[188:191], v[52:55]
    ds_read_b64_tr_b16 a[204:205], v10 offset:53248
    v_mul_f32 v5, v17, v5
    v_mfma_f32_16x16x32_bf16 v[48:51], a[212:215], v[180:183], v[48:51]
    s_waitcnt lgkmcnt(3)
    ds_read_b64_tr_b16 a[206:207], v10 offset:55296
    v_cvt_pk_bf16_f32 v21, v21, v22
    v_mfma_f32_16x16x32_bf16 v[48:51], a[208:211], v[176:179], v[48:51]
    v_cvt_pk_bf16_f32 v22, v23, v5
    v_accvgpr_write_b32 a4, v21
    v_mfma_f32_16x16x32_bf16 v[44:47], a[208:211], v[168:171], v[44:47]
    v_accvgpr_write_b32 a5, v22
    v_accvgpr_read_b32 v21, a172
    v_mfma_f32_16x16x32_bf16 v[44:47], a[212:215], v[172:175], v[44:47]
    v_accvgpr_read_b32 v22, a173
    v_accvgpr_read_b32 v23, a174
    v_mfma_f32_16x16x32_bf16 v[40:43], a[212:215], v[164:167], v[40:43]
    v_accvgpr_read_b32 v5, a175
    v_mul_f32 v21, v17, v21
    v_mfma_f32_16x16x32_bf16 v[40:43], a[208:211], v[160:163], v[40:43]
    ds_read_b64_tr_b16 a[208:209], v10 offset:57344
    v_mul_f32 v22, v17, v22
    v_mfma_f32_16x16x32_bf16 v[40:43], a[184:187], v[192:195], v[40:43]
    ds_read_b64_tr_b16 a[210:211], v10 offset:59392
    v_mul_f32 v23, v17, v23
    v_mfma_f32_16x16x32_bf16 v[40:43], a[188:191], v[196:199], v[40:43]
    ds_read_b64_tr_b16 a[212:213], v10 offset:61440
    v_mul_f32 v5, v17, v5
    v_mfma_f32_16x16x32_bf16 v[44:47], a[188:191], v[204:207], v[44:47]
    ds_read_b64_tr_b16 a[214:215], v10 offset:63488
    v_subrev_u32 v10, 73728, v10
    v_mfma_f32_16x16x32_bf16 v[44:47], a[184:187], v[200:203], v[44:47]
    v_cvt_pk_bf16_f32 v21, v21, v22
    v_cvt_pk_bf16_f32 v22, v23, v5
    v_mfma_f32_16x16x32_bf16 v[48:51], a[184:187], v[208:211], v[48:51]
    v_accvgpr_write_b32 a6, v21
    v_accvgpr_write_b32 a7, v22
    v_mfma_f32_16x16x32_bf16 v[48:51], a[188:191], v[212:215], v[48:51]
    buffer_store_dwordx4 a[4:7], v14, s[20:23], s55 offen offset:1024 sc1
    v_accvgpr_read_b32 v21, a160
    v_mfma_f32_16x16x32_bf16 v[52:55], a[188:191], v[220:223], v[52:55]
    v_accvgpr_read_b32 v22, a161
    v_accvgpr_read_b32 v23, a162
    v_mfma_f32_16x16x32_bf16 v[52:55], a[184:187], v[216:219], v[52:55]
    ds_read_b64_tr_b16 a[184:185], v11 offset:0
    v_accvgpr_read_b32 v5, a163
    v_mfma_f32_16x16x32_bf16 v[52:55], a[192:195], v[248:251], v[52:55]
    ds_read_b64_tr_b16 a[186:187], v11 offset:2048
    v_mul_f32 v21, v18, v21
    v_mfma_f32_16x16x32_bf16 v[52:55], a[196:199], v[252:255], v[52:55]
    ds_read_b64_tr_b16 a[188:189], v11 offset:4096
    v_mul_f32 v22, v18, v22
    v_mfma_f32_16x16x32_bf16 v[48:51], a[196:199], v[244:247], v[48:51]
    s_waitcnt lgkmcnt(3)
    ds_read_b64_tr_b16 a[190:191], v11 offset:6144
    v_mul_f32 v23, v18, v23
    v_mfma_f32_16x16x32_bf16 v[48:51], a[192:195], v[240:243], v[48:51]
    v_mul_f32 v5, v18, v5
    v_cvt_pk_bf16_f32 v21, v21, v22
    v_mfma_f32_16x16x32_bf16 v[44:47], a[192:195], v[232:235], v[44:47]
    v_cvt_pk_bf16_f32 v22, v23, v5
    v_accvgpr_write_b32 a8, v21
    v_mfma_f32_16x16x32_bf16 v[44:47], a[196:199], v[236:239], v[44:47]
    v_accvgpr_write_b32 a9, v22
    v_accvgpr_read_b32 v21, a176
    v_mfma_f32_16x16x32_bf16 v[40:43], a[196:199], v[228:231], v[40:43]
    v_accvgpr_read_b32 v22, a177
    v_accvgpr_read_b32 v23, a178
    v_mfma_f32_16x16x32_bf16 v[40:43], a[192:195], v[224:227], v[40:43]
    ds_read_b64_tr_b16 a[192:193], v11 offset:8192
    v_accvgpr_read_b32 v5, a179
    v_mfma_f32_16x16x32_bf16 v[40:43], a[200:203], v[56:59], v[40:43]
    ds_read_b64_tr_b16 a[194:195], v11 offset:10240
    v_mul_f32 v21, v18, v21
    v_mfma_f32_16x16x32_bf16 v[40:43], a[204:207], v[60:63], v[40:43]
    ds_read_b64_tr_b16 a[196:197], v11 offset:12288
    v_mul_f32 v22, v18, v22
    v_mfma_f32_16x16x32_bf16 v[44:47], a[204:207], v[68:71], v[44:47]
    ds_read_b64_tr_b16 a[198:199], v11 offset:14336
    v_mul_f32 v23, v18, v23
    v_mfma_f32_16x16x32_bf16 v[44:47], a[200:203], v[64:67], v[44:47]
    v_mul_f32 v5, v18, v5
    v_cvt_pk_bf16_f32 v21, v21, v22
    v_mfma_f32_16x16x32_bf16 v[48:51], a[200:203], v[72:75], v[48:51]
    v_cvt_pk_bf16_f32 v22, v23, v5
    v_accvgpr_write_b32 a10, v21
    v_mfma_f32_16x16x32_bf16 v[48:51], a[204:207], v[76:79], v[48:51]
    v_accvgpr_write_b32 a11, v22
    v_accvgpr_read_b32 v21, a164
    v_mfma_f32_16x16x32_bf16 v[52:55], a[204:207], v[84:87], v[52:55]
    buffer_store_dwordx4 a[8:11], v14, s[20:23], s55 offen offset:2048 sc1
    v_accvgpr_read_b32 v22, a165
    v_mfma_f32_16x16x32_bf16 v[52:55], a[200:203], v[80:83], v[52:55]
    ds_read_b64_tr_b16 a[200:201], v11 offset:16384
    v_accvgpr_read_b32 v23, a166
    v_mfma_f32_16x16x32_bf16 v[52:55], a[208:211], v[112:115], v[52:55]
    ds_read_b64_tr_b16 a[202:203], v11 offset:18432
    v_accvgpr_read_b32 v5, a167
    v_mfma_f32_16x16x32_bf16 v[52:55], a[212:215], v[116:119], v[52:55]
    ds_read_b64_tr_b16 a[204:205], v11 offset:20480
    v_mul_f32 v21, v19, v21
    v_mfma_f32_16x16x32_bf16 v[48:51], a[212:215], v[108:111], v[48:51]
    s_waitcnt lgkmcnt(3)
    ds_read_b64_tr_b16 a[206:207], v11 offset:22528
    v_mul_f32 v22, v19, v22
    v_mfma_f32_16x16x32_bf16 v[48:51], a[208:211], v[104:107], v[48:51]
    v_mul_f32 v23, v19, v23
    v_mul_f32 v5, v19, v5
    v_mfma_f32_16x16x32_bf16 v[44:47], a[208:211], v[96:99], v[44:47]
    v_cvt_pk_bf16_f32 v21, v21, v22
    v_cvt_pk_bf16_f32 v22, v23, v5
    v_mfma_f32_16x16x32_bf16 v[44:47], a[212:215], v[100:103], v[44:47]
    v_accvgpr_write_b32 a12, v21
    v_accvgpr_write_b32 a13, v22
    v_mfma_f32_16x16x32_bf16 v[40:43], a[212:215], v[92:95], v[40:43]
    v_accvgpr_read_b32 v21, a180
    v_accvgpr_read_b32 v22, a181
    v_mfma_f32_16x16x32_bf16 v[40:43], a[208:211], v[88:91], v[40:43]
    ds_read_b64_tr_b16 a[208:209], v11 offset:24576
    v_accvgpr_read_b32 v23, a182
    v_mfma_f32_16x16x32_bf16 v[24:27], a[184:187], a[96:99], 0
    ds_read_b64_tr_b16 a[210:211], v11 offset:26624
    v_accvgpr_read_b32 v5, a183
    v_mfma_f32_16x16x32_bf16 v[24:27], a[188:191], a[100:103], v[24:27]
    ds_read_b64_tr_b16 a[212:213], v11 offset:28672
    v_mul_f32 v21, v19, v21
    v_mfma_f32_16x16x32_bf16 v[28:31], a[188:191], a[108:111], 0
    ds_read_b64_tr_b16 a[214:215], v11 offset:30720
    v_mul_f32 v22, v19, v22
    v_mfma_f32_16x16x32_bf16 v[28:31], a[184:187], a[104:107], v[28:31]
pg_9:
    s_cbranch_execz pg_11
    v_mul_f32 v23, v19, v23
    v_mul_f32 v5, v19, v5
    v_mfma_f32_16x16x32_bf16 v[32:35], a[184:187], a[112:115], 0
    v_cvt_pk_bf16_f32 v21, v21, v22
    v_cvt_pk_bf16_f32 v22, v23, v5
    v_mfma_f32_16x16x32_bf16 v[32:35], a[188:191], a[116:119], v[32:35]
    v_accvgpr_write_b32 a14, v21
    v_accvgpr_write_b32 a15, v22
    v_mfma_f32_16x16x32_bf16 v[36:39], a[188:191], a[124:127], 0
    buffer_store_dwordx4 a[12:15], v14, s[20:23], s55 offen offset:3072 sc1
    v_mul_f32 v40, v16, v40
    v_mfma_f32_16x16x32_bf16 v[36:39], a[184:187], a[120:123], v[36:39]
    s_add_u32 s55, s55, 4096
    ds_read_b64_tr_b16 a[184:185], v11 offset:32768
    v_mul_f32 v41, v16, v41
    v_mfma_f32_16x16x32_bf16 v[36:39], a[192:195], v[120:123], v[36:39]
    ds_read_b64_tr_b16 a[186:187], v11 offset:34816
    v_mul_f32 v42, v16, v42
    v_mfma_f32_16x16x32_bf16 v[36:39], a[196:199], v[124:127], v[36:39]
    ds_read_b64_tr_b16 a[188:189], v11 offset:36864
    v_mul_f32 v43, v16, v43
    v_mfma_f32_16x16x32_bf16 v[32:35], a[196:199], a[148:151], v[32:35]
    s_waitcnt lgkmcnt(3)
    ds_read_b64_tr_b16 a[190:191], v11 offset:38912
    v_cvt_pk_bf16_f32 v40, v40, v41
    v_mfma_f32_16x16x32_bf16 v[32:35], a[192:195], a[144:147], v[32:35]
    v_cvt_pk_bf16_f32 v41, v42, v43
    v_accvgpr_write_b32 a16, v40
    v_mfma_f32_16x16x32_bf16 v[28:31], a[192:195], a[136:139], v[28:31]
    v_accvgpr_write_b32 a17, v41
    v_mul_f32 v44, v17, v44
    v_mfma_f32_16x16x32_bf16 v[28:31], a[196:199], a[140:143], v[28:31]
    v_mul_f32 v45, v17, v45
    v_mul_f32 v46, v17, v46
    v_mfma_f32_16x16x32_bf16 v[24:27], a[196:199], a[132:135], v[24:27]
    v_mul_f32 v47, v17, v47
    v_cvt_pk_bf16_f32 v44, v44, v45
    v_mfma_f32_16x16x32_bf16 v[24:27], a[192:195], a[128:131], v[24:27]
    ds_read_b64_tr_b16 a[192:193], v11 offset:40960
    v_cvt_pk_bf16_f32 v45, v46, v47
    v_mfma_f32_16x16x32_bf16 v[24:27], a[200:203], v[128:131], v[24:27]
    ds_read_b64_tr_b16 a[194:195], v11 offset:43008
    v_accvgpr_write_b32 a20, v44
    v_mfma_f32_16x16x32_bf16 v[24:27], a[204:207], v[132:135], v[24:27]
    ds_read_b64_tr_b16 a[196:197], v11 offset:45056
    v_accvgpr_write_b32 a21, v45
    v_mfma_f32_16x16x32_bf16 v[28:31], a[204:207], v[140:143], v[28:31]
    ds_read_b64_tr_b16 a[198:199], v11 offset:47104
    v_mul_f32 v48, v18, v48
    v_mfma_f32_16x16x32_bf16 v[28:31], a[200:203], v[136:139], v[28:31]
    v_mul_f32 v49, v18, v49
    v_mul_f32 v50, v18, v50
    v_mfma_f32_16x16x32_bf16 v[32:35], a[200:203], v[144:147], v[32:35]
    v_mul_f32 v51, v18, v51
    v_cvt_pk_bf16_f32 v48, v48, v49
    v_mfma_f32_16x16x32_bf16 v[32:35], a[204:207], v[148:151], v[32:35]
    v_cvt_pk_bf16_f32 v49, v50, v51
    v_accvgpr_write_b32 a24, v48
    v_mfma_f32_16x16x32_bf16 v[36:39], a[204:207], v[156:159], v[36:39]
    v_accvgpr_write_b32 a25, v49
    v_mul_f32 v52, v19, v52
    v_mfma_f32_16x16x32_bf16 v[36:39], a[200:203], v[152:155], v[36:39]
    ds_read_b64_tr_b16 a[200:201], v11 offset:49152
    v_mul_f32 v53, v19, v53
    v_mfma_f32_16x16x32_bf16 v[36:39], a[208:211], v[184:187], v[36:39]
    ds_read_b64_tr_b16 a[202:203], v11 offset:51200
    v_mul_f32 v54, v19, v54
    v_mfma_f32_16x16x32_bf16 v[36:39], a[212:215], v[188:191], v[36:39]
    ds_read_b64_tr_b16 a[204:205], v11 offset:53248
    v_mul_f32 v55, v19, v55
    v_mfma_f32_16x16x32_bf16 v[32:35], a[212:215], v[180:183], v[32:35]
    s_waitcnt lgkmcnt(3)
    ds_read_b64_tr_b16 a[206:207], v11 offset:55296
    v_cvt_pk_bf16_f32 v52, v52, v53
    v_mfma_f32_16x16x32_bf16 v[32:35], a[208:211], v[176:179], v[32:35]
    v_cvt_pk_bf16_f32 v53, v54, v55
    v_accvgpr_write_b32 a28, v52
    v_mfma_f32_16x16x32_bf16 v[28:31], a[208:211], v[168:171], v[28:31]
    v_accvgpr_write_b32 a29, v53
    v_mfma_f32_16x16x32_bf16 v[28:31], a[212:215], v[172:175], v[28:31]
    v_mfma_f32_16x16x32_bf16 v[24:27], a[212:215], v[164:167], v[24:27]
    v_mfma_f32_16x16x32_bf16 v[24:27], a[208:211], v[160:163], v[24:27]
    ds_read_b64_tr_b16 a[208:209], v11 offset:57344
    v_mfma_f32_16x16x32_bf16 v[24:27], a[184:187], v[192:195], v[24:27]
    ds_read_b64_tr_b16 a[210:211], v11 offset:59392
    v_mfma_f32_16x16x32_bf16 v[24:27], a[188:191], v[196:199], v[24:27]
    ds_read_b64_tr_b16 a[212:213], v11 offset:61440
    v_mfma_f32_16x16x32_bf16 v[28:31], a[188:191], v[204:207], v[28:31]
    ds_read_b64_tr_b16 a[214:215], v11 offset:63488
    v_subrev_u32 v11, 73728, v11
    v_mfma_f32_16x16x32_bf16 v[28:31], a[184:187], v[200:203], v[28:31]
    s_add_u32 s39, s40, 256
    v_mfma_f32_16x16x32_bf16 v[32:35], a[184:187], v[208:211], v[32:35]
    v_mfma_f32_16x16x32_bf16 v[32:35], a[188:191], v[212:215], v[32:35]
    s_add_u32 m0, s63, 73728
    v_mfma_f32_16x16x32_bf16 v[36:39], a[188:191], v[220:223], v[36:39]
    v_mfma_f32_16x16x32_bf16 v[36:39], a[184:187], v[216:219], v[36:39]
    v_mfma_f32_16x16x32_bf16 v[36:39], a[192:195], v[248:251], v[36:39]
    v_mfma_f32_16x16x32_bf16 v[36:39], a[196:199], v[252:255], v[36:39]
    s_waitcnt vmcnt(17) lgkmcnt(0)
    v_mfma_f32_16x16x32_bf16 v[32:35], a[196:199], v[244:247], v[32:35]
    s_barrier
    v_mfma_f32_16x16x32_bf16 v[32:35], a[192:195], v[240:243], v[32:35]
    buffer_load_dwordx4 v6, s[16:19], s39 offen lds
    v_mfma_f32_16x16x32_bf16 v[28:31], a[192:195], v[232:235], v[28:31]
    s_add_u32 s39, s40, 12544
    ds_read_b64_tr_b16 a[184:185], v8 offset:49152
    v_mfma_f32_16x16x32_bf16 v[28:31], a[196:199], v[236:239], v[28:31]
    ds_read_b64_tr_b16 a[186:187], v8 offset:51200
    v_mfma_f32_16x16x32_bf16 v[24:27], a[196:199], v[228:231], v[24:27]
    s_addk_i32 m0, 4096
    ds_read_b64_tr_b16 a[188:189], v8 offset:53248
    v_mfma_f32_16x16x32_bf16 v[24:27], a[192:195], v[224:227], v[24:27]
    ds_read_b64_tr_b16 a[190:191], v8 offset:55296
    v_mfma_f32_16x16x32_bf16 v[24:27], a[200:203], v[56:59], v[24:27]
    ds_read_b64_tr_b16 a[192:193], v8 offset:57344
    v_mfma_f32_16x16x32_bf16 v[24:27], a[204:207], v[60:63], v[24:27]
    ds_read_b64_tr_b16 a[194:195], v8 offset:59392
    v_mfma_f32_16x16x32_bf16 v[28:31], a[204:207], v[68:71], v[28:31]
    ds_read_b64_tr_b16 a[196:197], v8 offset:61440
    v_mfma_f32_16x16x32_bf16 v[28:31], a[200:203], v[64:67], v[28:31]
    ds_read_b64_tr_b16 a[198:199], v8 offset:63488
    v_mfma_f32_16x16x32_bf16 v[32:35], a[200:203], v[72:75], v[32:35]
    buffer_load_dwordx4 v6, s[16:19], s39 offen lds
    v_mfma_f32_16x16x32_bf16 v[32:35], a[204:207], v[76:79], v[32:35]
    s_add_u32 s39, s40, 24832
    v_mfma_f32_16x16x32_bf16 v[36:39], a[204:207], v[84:87], v[36:39]
    v_mfma_f32_16x16x32_bf16 v[36:39], a[200:203], v[80:83], v[36:39]
    s_addk_i32 m0, 4096
    ds_read_b64_tr_b16 a[200:201], v8 offset:0
    v_mfma_f32_16x16x32_bf16 v[36:39], a[208:211], v[112:115], v[36:39]
    ds_read_b64_tr_b16 a[202:203], v8 offset:2048
    v_mfma_f32_16x16x32_bf16 v[36:39], a[212:215], v[116:119], v[36:39]
    ds_read_b64_tr_b16 a[204:205], v8 offset:4096
    v_mfma_f32_16x16x32_bf16 v[32:35], a[212:215], v[108:111], v[32:35]
    s_waitcnt lgkmcnt(3)
    ds_read_b64_tr_b16 a[206:207], v8 offset:6144
    v_mfma_f32_16x16x32_bf16 v[32:35], a[208:211], v[104:107], v[32:35]
    v_mfma_f32_16x16x32_bf16 v[28:31], a[208:211], v[96:99], v[28:31]
    v_mfma_f32_16x16x32_bf16 v[28:31], a[212:215], v[100:103], v[28:31]
    buffer_load_dwordx4 v6, s[16:19], s39 offen lds
    v_mfma_f32_16x16x32_bf16 v[24:27], a[212:215], v[92:95], v[24:27]
    s_add_u32 s39, s40, 37120
    v_mul_f32 v36, v19, v36
    v_mfma_f32_16x16x32_bf16 v[24:27], a[208:211], v[88:91], v[24:27]
    ds_read_b64_tr_b16 a[208:209], v8 offset:8192
    v_mul_f32 v32, v18, v32
    v_mfma_f32_16x16x32_bf16 v[40:43], a[184:187], a[96:99], 0
    s_addk_i32 m0, 4096
    ds_read_b64_tr_b16 a[210:211], v8 offset:10240
    v_mul_f32 v28, v17, v28
    v_mfma_f32_16x16x32_bf16 v[40:43], a[188:191], a[100:103], v[40:43]
    ds_read_b64_tr_b16 a[212:213], v8 offset:12288
    v_mul_f32 v24, v16, v24
    v_mfma_f32_16x16x32_bf16 v[44:47], a[188:191], a[108:111], 0
    s_waitcnt vmcnt(3)
    ds_read_b64_tr_b16 a[214:215], v8 offset:14336
    v_mul_f32 v25, v16, v25
    v_mfma_f32_16x16x32_bf16 v[44:47], a[184:187], a[104:107], v[44:47]
    buffer_store_dword v4, v15, s[24:27], s76 offen sc1
    v_mfma_f32_16x16x32_bf16 v[48:51], a[184:187], a[112:115], 0
    v_mov_b32 v4, s56
    v_mul_f32 v26, v16, v26
    v_mfma_f32_16x16x32_bf16 v[48:51], a[188:191], a[116:119], v[48:51]
    s_add_u32 s56, s7, 3
    v_mul_f32 v27, v16, v27
    v_cvt_pk_bf16_f32 v24, v24, v25
    v_mfma_f32_16x16x32_bf16 v[52:55], a[188:191], a[124:127], 0
    buffer_load_dwordx4 v6, s[16:19], s39 offen lds
    v_mfma_f32_16x16x32_bf16 v[52:55], a[184:187], a[120:123], v[52:55]
    s_add_u32 s39, s40, 49408
    v_cvt_pk_bf16_f32 v25, v26, v27
    v_accvgpr_write_b32 a18, v24
    v_mfma_f32_16x16x32_bf16 v[52:55], a[192:195], v[120:123], v[52:55]
    v_accvgpr_write_b32 a19, v25
    v_mul_f32 v29, v17, v29
    v_mfma_f32_16x16x32_bf16 v[52:55], a[196:199], v[124:127], v[52:55]
    buffer_store_dwordx4 a[16:19], v14, s[20:23], s55 offen offset:0 sc1
    v_mul_f32 v30, v17, v30
    v_mfma_f32_16x16x32_bf16 v[48:51], a[196:199], a[148:151], v[48:51]
    s_addk_i32 m0, 4096
    v_mul_f32 v31, v17, v31
    v_cvt_pk_bf16_f32 v28, v28, v29
    v_mfma_f32_16x16x32_bf16 v[48:51], a[192:195], a[144:147], v[48:51]
    v_cvt_pk_bf16_f32 v29, v30, v31
    v_accvgpr_write_b32 a22, v28
    v_mfma_f32_16x16x32_bf16 v[44:47], a[192:195], a[136:139], v[44:47]
    v_accvgpr_write_b32 a23, v29
    v_mfma_f32_16x16x32_bf16 v[44:47], a[196:199], a[140:143], v[44:47]
    buffer_store_dwordx4 a[20:23], v14, s[20:23], s55 offen offset:1024 sc1
    v_mul_f32 v33, v18, v33
    v_mfma_f32_16x16x32_bf16 v[40:43], a[196:199], a[132:135], v[40:43]
    s_waitcnt lgkmcnt(0)
    v_mul_f32 v34, v18, v34
    v_mul_f32 v35, v18, v35
    v_mfma_f32_16x16x32_bf16 v[40:43], a[192:195], a[128:131], v[40:43]
    buffer_load_dwordx4 v6, s[16:19], s39 offen lds
    v_mfma_f32_16x16x32_bf16 v[40:43], a[200:203], v[128:131], v[40:43]
    s_add_u32 s39, s40, 61696
    v_cvt_pk_bf16_f32 v32, v32, v33
    v_cvt_pk_bf16_f32 v33, v34, v35
    v_mfma_f32_16x16x32_bf16 v[40:43], a[204:207], v[132:135], v[40:43]
    v_accvgpr_write_b32 a26, v32
    v_accvgpr_write_b32 a27, v33
    v_mfma_f32_16x16x32_bf16 v[44:47], a[204:207], v[140:143], v[44:47]
    buffer_store_dwordx4 a[24:27], v14, s[20:23], s55 offen offset:2048 sc1
    v_mul_f32 v37, v19, v37
    v_mfma_f32_16x16x32_bf16 v[44:47], a[200:203], v[136:139], v[44:47]
    s_addk_i32 m0, 4096
    v_mul_f32 v38, v19, v38
    v_mfma_f32_16x16x32_bf16 v[48:51], a[200:203], v[144:147], v[48:51]
    s_barrier
    v_mfma_f32_16x16x32_bf16 v[48:51], a[204:207], v[148:151], v[48:51]
    ds_read_b64_tr_b16 a[184:185], v8 offset:16384
    v_mul_f32 v39, v19, v39
    v_mfma_f32_16x16x32_bf16 v[52:55], a[204:207], v[156:159], v[52:55]
    ds_read_b64_tr_b16 a[186:187], v8 offset:18432
    v_cvt_pk_bf16_f32 v36, v36, v37
    v_mfma_f32_16x16x32_bf16 v[52:55], a[200:203], v[152:155], v[52:55]
    ds_read_b64_tr_b16 a[188:189], v8 offset:20480
    v_cvt_pk_bf16_f32 v37, v38, v39
    v_mfma_f32_16x16x32_bf16 v[52:55], a[208:211], v[184:187], v[52:55]
    buffer_load_dwordx4 v6, s[16:19], s39 offen lds
    v_mfma_f32_16x16x32_bf16 v[52:55], a[212:215], v[188:191], v[52:55]
    s_add_u32 s39, s40, 73984
    ds_read_b64_tr_b16 a[190:191], v8 offset:22528
    v_accvgpr_write_b32 a30, v36
    v_mfma_f32_16x16x32_bf16 v[48:51], a[212:215], v[180:183], v[48:51]
    ds_read_b64_tr_b16 a[192:193], v8 offset:24576
    v_accvgpr_write_b32 a31, v37
    v_mfma_f32_16x16x32_bf16 v[48:51], a[208:211], v[176:179], v[48:51]
    buffer_store_dwordx4 a[28:31], v14, s[20:23], s55 offen offset:3072 sc1
    v_mfma_f32_16x16x32_bf16 v[44:47], a[208:211], v[168:171], v[44:47]
    s_addk_i32 m0, 4096
    ds_read_b64_tr_b16 a[194:195], v8 offset:26624
    s_add_u32 s55, s55, 4096
    v_mfma_f32_16x16x32_bf16 v[44:47], a[212:215], v[172:175], v[44:47]
    s_waitcnt lgkmcnt(4)
    ds_read_b64_tr_b16 a[196:197], v8 offset:28672
    v_mfma_f32_16x16x32_bf16 v[40:43], a[212:215], v[164:167], v[40:43]
    ds_read_b64_tr_b16 a[198:199], v8 offset:30720
    v_mfma_f32_16x16x32_bf16 v[40:43], a[208:211], v[160:163], v[40:43]
    ds_read_b64_tr_b16 a[200:201], v8 offset:32768
    v_mfma_f32_16x16x32_bf16 v[40:43], a[184:187], v[192:195], v[40:43]
    s_waitcnt lgkmcnt(5)
    ds_read_b64_tr_b16 a[202:203], v8 offset:34816
    v_mfma_f32_16x16x32_bf16 v[40:43], a[188:191], v[196:199], v[40:43]
    buffer_load_dwordx4 v6, s[16:19], s39 offen lds
    v_mfma_f32_16x16x32_bf16 v[44:47], a[188:191], v[204:207], v[44:47]
    s_add_u32 s39, s40, 86272
    ds_read_b64_tr_b16 a[204:205], v8 offset:36864
    v_mfma_f32_16x16x32_bf16 v[44:47], a[184:187], v[200:203], v[44:47]
    ds_read_b64_tr_b16 a[206:207], v8 offset:38912
    v_mfma_f32_16x16x32_bf16 v[48:51], a[184:187], v[208:211], v[48:51]
    s_addk_i32 m0, 4096
    ds_read_b64_tr_b16 a[208:209], v8 offset:40960
    v_mfma_f32_16x16x32_bf16 v[48:51], a[188:191], v[212:215], v[48:51]
    s_waitcnt lgkmcnt(5)
    ds_read_b64_tr_b16 a[210:211], v8 offset:43008
    v_mfma_f32_16x16x32_bf16 v[52:55], a[188:191], v[220:223], v[52:55]
    ds_read_b64_tr_b16 a[212:213], v8 offset:45056
    v_mfma_f32_16x16x32_bf16 v[52:55], a[184:187], v[216:219], v[52:55]
    ds_read_b64_tr_b16 a[214:215], v8 offset:47104
    v_add_u32 v8, 73728, v8
    v_mfma_f32_16x16x32_bf16 v[52:55], a[192:195], v[248:251], v[52:55]
    ds_read_b64_tr_b16 a[184:185], v9 offset:49152
    v_mfma_f32_16x16x32_bf16 v[52:55], a[196:199], v[252:255], v[52:55]
    ds_read_b64_tr_b16 a[186:187], v9 offset:51200
    v_mfma_f32_16x16x32_bf16 v[48:51], a[196:199], v[244:247], v[48:51]
    buffer_load_dwordx4 v6, s[16:19], s39 offen lds
    v_mfma_f32_16x16x32_bf16 v[48:51], a[192:195], v[240:243], v[48:51]
    s_add_u32 s39, s40, 98560
    ds_read_b64_tr_b16 a[188:189], v9 offset:53248
    v_mfma_f32_16x16x32_bf16 v[44:47], a[192:195], v[232:235], v[44:47]
    s_waitcnt lgkmcnt(5)
    ds_read_b64_tr_b16 a[190:191], v9 offset:55296
    v_mfma_f32_16x16x32_bf16 v[44:47], a[196:199], v[236:239], v[44:47]
    s_addk_i32 m0, 4096
    v_mfma_f32_16x16x32_bf16 v[40:43], a[196:199], v[228:231], v[40:43]
    v_mfma_f32_16x16x32_bf16 v[40:43], a[192:195], v[224:227], v[40:43]
    ds_read_b64_tr_b16 a[192:193], v9 offset:57344
    v_mfma_f32_16x16x32_bf16 v[40:43], a[200:203], v[56:59], v[40:43]
    ds_read_b64_tr_b16 a[194:195], v9 offset:59392
    v_mfma_f32_16x16x32_bf16 v[40:43], a[204:207], v[60:63], v[40:43]
    ds_read_b64_tr_b16 a[196:197], v9 offset:61440
    v_mfma_f32_16x16x32_bf16 v[44:47], a[204:207], v[68:71], v[44:47]
    ds_read_b64_tr_b16 a[198:199], v9 offset:63488
    v_mfma_f32_16x16x32_bf16 v[44:47], a[200:203], v[64:67], v[44:47]
    buffer_load_dwordx4 v6, s[16:19], s39 offen lds
    v_mfma_f32_16x16x32_bf16 v[48:51], a[200:203], v[72:75], v[48:51]
    s_add_u32 s39, s40, 110848
    v_mfma_f32_16x16x32_bf16 v[48:51], a[204:207], v[76:79], v[48:51]
    v_mfma_f32_16x16x32_bf16 v[52:55], a[204:207], v[84:87], v[52:55]
    s_waitcnt lgkmcnt(3)
    s_addk_i32 m0, 4096
    v_mfma_f32_16x16x32_bf16 v[52:55], a[200:203], v[80:83], v[52:55]
    ds_read_b64_tr_b16 a[200:201], v9 offset:0
    v_mfma_f32_16x16x32_bf16 v[52:55], a[208:211], v[112:115], v[52:55]
    ds_read_b64_tr_b16 a[202:203], v9 offset:2048
    v_mfma_f32_16x16x32_bf16 v[52:55], a[212:215], v[116:119], v[52:55]
    ds_read_b64_tr_b16 a[204:205], v9 offset:4096
    v_mfma_f32_16x16x32_bf16 v[48:51], a[212:215], v[108:111], v[48:51]
    ds_read_b64_tr_b16 a[206:207], v9 offset:6144
    v_mfma_f32_16x16x32_bf16 v[48:51], a[208:211], v[104:107], v[48:51]
    v_mfma_f32_16x16x32_bf16 v[44:47], a[208:211], v[96:99], v[44:47]
    buffer_load_dwordx4 v6, s[16:19], s39 offen lds
    v_mfma_f32_16x16x32_bf16 v[44:47], a[212:215], v[100:103], v[44:47]
    s_add_u32 s39, s40, 123136
    v_mul_f32 v52, v19, v52
    v_mfma_f32_16x16x32_bf16 v[40:43], a[212:215], v[92:95], v[40:43]
    v_mul_f32 v53, v19, v53
    v_mfma_f32_16x16x32_bf16 v[40:43], a[208:211], v[88:91], v[40:43]
    s_addk_i32 m0, 4096
    ds_read_b64_tr_b16 a[208:209], v9 offset:8192
    v_mul_f32 v48, v18, v48
    v_mfma_f32_16x16x32_bf16 v[24:27], a[184:187], a[96:99], 0
    ds_read_b64_tr_b16 a[210:211], v9 offset:10240
    v_mul_f32 v44, v17, v44
    v_mfma_f32_16x16x32_bf16 v[24:27], a[188:191], a[100:103], v[24:27]
    ds_read_b64_tr_b16 a[212:213], v9 offset:12288
    v_mul_f32 v40, v16, v40
    v_mfma_f32_16x16x32_bf16 v[28:31], a[188:191], a[108:111], 0
    ds_read_b64_tr_b16 a[214:215], v9 offset:14336
    v_mul_f32 v41, v16, v41
    v_mfma_f32_16x16x32_bf16 v[28:31], a[184:187], a[104:107], v[28:31]
    s_waitcnt lgkmcnt(4)
    v_mul_f32 v42, v16, v42
    v_mul_f32 v43, v16, v43
    v_mfma_f32_16x16x32_bf16 v[32:35], a[184:187], a[112:115], 0
    v_cvt_pk_bf16_f32 v40, v40, v41
    v_cvt_pk_bf16_f32 v41, v42, v43
    v_mfma_f32_16x16x32_bf16 v[32:35], a[188:191], a[116:119], v[32:35]
    buffer_load_dwordx4 v6, s[16:19], s39 offen lds
    v_mfma_f32_16x16x32_bf16 v[36:39], a[188:191], a[124:127], 0
    s_add_u32 s39, s40, 135424
    v_accvgpr_write_b32 a32, v40
    v_accvgpr_write_b32 a33, v41
    v_mfma_f32_16x16x32_bf16 v[36:39], a[184:187], a[120:123], v[36:39]
    ds_read_b64_tr_b16 a[184:185], v9 offset:16384
    v_mul_f32 v45, v17, v45
    v_mfma_f32_16x16x32_bf16 v[36:39], a[192:195], v[120:123], v[36:39]
    s_addk_i32 m0, 4096
    ds_read_b64_tr_b16 a[186:187], v9 offset:18432
    v_mul_f32 v46, v17, v46
    v_mfma_f32_16x16x32_bf16 v[36:39], a[196:199], v[124:127], v[36:39]
    ds_read_b64_tr_b16 a[188:189], v9 offset:20480
    v_mul_f32 v47, v17, v47
    v_mfma_f32_16x16x32_bf16 v[32:35], a[196:199], a[148:151], v[32:35]
    ds_read_b64_tr_b16 a[190:191], v9 offset:22528
    v_cvt_pk_bf16_f32 v44, v44, v45
    v_mfma_f32_16x16x32_bf16 v[32:35], a[192:195], a[144:147], v[32:35]
    v_cvt_pk_bf16_f32 v45, v46, v47
    v_accvgpr_write_b32 a36, v44
    v_mfma_f32_16x16x32_bf16 v[28:31], a[192:195], a[136:139], v[28:31]
    v_accvgpr_write_b32 a37, v45
    v_mfma_f32_16x16x32_bf16 v[28:31], a[196:199], a[140:143], v[28:31]
    v_mul_f32 v49, v18, v49
    v_mfma_f32_16x16x32_bf16 v[24:27], a[196:199], a[132:135], v[24:27]
    buffer_load_dwordx4 v6, s[16:19], s39 offen lds
    v_mfma_f32_16x16x32_bf16 v[24:27], a[192:195], a[128:131], v[24:27]
    s_add_u32 s39, s40, 147712
    ds_read_b64_tr_b16 a[192:193], v9 offset:24576
    v_mul_f32 v50, v18, v50
    v_mfma_f32_16x16x32_bf16 v[24:27], a[200:203], v[128:131], v[24:27]
    ds_read_b64_tr_b16 a[194:195], v9 offset:26624
    v_mul_f32 v51, v18, v51
    v_mfma_f32_16x16x32_bf16 v[24:27], a[204:207], v[132:135], v[24:27]
    s_addk_i32 m0, 4096
    ds_read_b64_tr_b16 a[196:197], v9 offset:28672
    v_cvt_pk_bf16_f32 v48, v48, v49
    v_mfma_f32_16x16x32_bf16 v[28:31], a[204:207], v[140:143], v[28:31]
    s_waitcnt lgkmcnt(3)
    ds_read_b64_tr_b16 a[198:199], v9 offset:30720
    v_cvt_pk_bf16_f32 v49, v50, v51
    v_mfma_f32_16x16x32_bf16 v[28:31], a[200:203], v[136:139], v[28:31]
    v_accvgpr_write_b32 a40, v48
    v_accvgpr_write_b32 a41, v49
    v_mfma_f32_16x16x32_bf16 v[32:35], a[200:203], v[144:147], v[32:35]
    v_mul_f32 v54, v19, v54
    v_mul_f32 v55, v19, v55
    v_mfma_f32_16x16x32_bf16 v[32:35], a[204:207], v[148:151], v[32:35]
    v_cvt_pk_bf16_f32 v52, v52, v53
    v_cvt_pk_bf16_f32 v53, v54, v55
    v_mfma_f32_16x16x32_bf16 v[36:39], a[204:207], v[156:159], v[36:39]
    v_accvgpr_write_b32 a44, v52
    v_accvgpr_write_b32 a45, v53
    v_mfma_f32_16x16x32_bf16 v[36:39], a[200:203], v[152:155], v[36:39]
    buffer_load_dwordx4 v6, s[16:19], s39 offen lds
    v_mfma_f32_16x16x32_bf16 v[36:39], a[208:211], v[184:187], v[36:39]
    s_add_u32 s39, s40, 160000
    ds_read_b64_tr_b16 a[200:201], v9 offset:32768
    v_mfma_f32_16x16x32_bf16 v[36:39], a[212:215], v[188:191], v[36:39]
    s_waitcnt vmcnt(7)
    ds_read_b64_tr_b16 a[202:203], v9 offset:34816
    v_mfma_f32_16x16x32_bf16 v[32:35], a[212:215], v[180:183], v[32:35]
    buffer_store_dword v4, v15, s[24:27], s76 offen sc1
    v_mfma_f32_16x16x32_bf16 v[32:35], a[208:211], v[176:179], v[32:35]
    s_addk_i32 m0, 4096
    ds_read_b64_tr_b16 a[204:205], v9 offset:36864
    v_mfma_f32_16x16x32_bf16 v[28:31], a[208:211], v[168:171], v[28:31]
    ds_read_b64_tr_b16 a[206:207], v9 offset:38912
    v_mfma_f32_16x16x32_bf16 v[28:31], a[212:215], v[172:175], v[28:31]
    v_mov_b32 v4, s56
    v_mfma_f32_16x16x32_bf16 v[24:27], a[212:215], v[164:167], v[24:27]
    s_add_u32 s56, s7, 4
    v_mfma_f32_16x16x32_bf16 v[24:27], a[208:211], v[160:163], v[24:27]
    ds_read_b64_tr_b16 a[208:209], v9 offset:40960
    v_mfma_f32_16x16x32_bf16 v[24:27], a[184:187], v[192:195], v[24:27]
    buffer_load_dwordx4 v6, s[16:19], s39 offen lds
    v_mfma_f32_16x16x32_bf16 v[24:27], a[188:191], v[196:199], v[24:27]
    s_load_dwordx4 s[72:75], s[86:87], s5 glc
    ds_read_b64_tr_b16 a[210:211], v9 offset:43008
    s_add_u32 s39, s40, 172288
    v_mfma_f32_16x16x32_bf16 v[28:31], a[188:191], v[204:207], v[28:31]
    ds_read_b64_tr_b16 a[212:213], v9 offset:45056
    v_mfma_f32_16x16x32_bf16 v[28:31], a[184:187], v[200:203], v[28:31]
    s_waitcnt lgkmcnt(5)
    ds_read_b64_tr_b16 a[214:215], v9 offset:47104
    v_add_u32 v9, 73728, v9
    v_mfma_f32_16x16x32_bf16 v[32:35], a[184:187], v[208:211], v[32:35]
    s_add_u32 m0, s63, 131072
    v_mfma_f32_16x16x32_bf16 v[32:35], a[188:191], v[212:215], v[32:35]
    v_mfma_f32_16x16x32_bf16 v[36:39], a[188:191], v[220:223], v[36:39]
    v_mfma_f32_16x16x32_bf16 v[36:39], a[184:187], v[216:219], v[36:39]
    ds_read_b64_tr_b16 a[184:185], v10 offset:49152
    v_mfma_f32_16x16x32_bf16 v[36:39], a[192:195], v[248:251], v[36:39]
    ds_read_b64_tr_b16 a[186:187], v10 offset:51200
    v_mfma_f32_16x16x32_bf16 v[36:39], a[196:199], v[252:255], v[36:39]
    buffer_load_dwordx4 v6, s[16:19], s39 offen lds
    v_mfma_f32_16x16x32_bf16 v[32:35], a[196:199], v[244:247], v[32:35]
    s_add_u32 s39, s40, 184576
    ds_read_b64_tr_b16 a[188:189], v10 offset:53248
    v_mfma_f32_16x16x32_bf16 v[32:35], a[192:195], v[240:243], v[32:35]
    ds_read_b64_tr_b16 a[190:191], v10 offset:55296
    v_mfma_f32_16x16x32_bf16 v[28:31], a[192:195], v[232:235], v[28:31]
    s_addk_i32 m0, 4096
    v_mfma_f32_16x16x32_bf16 v[28:31], a[196:199], v[236:239], v[28:31]
    v_mfma_f32_16x16x32_bf16 v[24:27], a[196:199], v[228:231], v[24:27]
    s_waitcnt lgkmcnt(5)
    v_mfma_f32_16x16x32_bf16 v[24:27], a[192:195], v[224:227], v[24:27]
    ds_read_b64_tr_b16 a[192:193], v10 offset:57344
    v_mfma_f32_16x16x32_bf16 v[24:27], a[200:203], v[56:59], v[24:27]
    ds_read_b64_tr_b16 a[194:195], v10 offset:59392
    v_mfma_f32_16x16x32_bf16 v[24:27], a[204:207], v[60:63], v[24:27]
    ds_read_b64_tr_b16 a[196:197], v10 offset:61440
    v_mfma_f32_16x16x32_bf16 v[28:31], a[204:207], v[68:71], v[28:31]
    buffer_load_dwordx4 v6, s[16:19], s39 offen lds
    v_mfma_f32_16x16x32_bf16 v[28:31], a[200:203], v[64:67], v[28:31]
    ds_read_b64_tr_b16 a[198:199], v10 offset:63488
    v_mfma_f32_16x16x32_bf16 v[32:35], a[200:203], v[72:75], v[32:35]
    v_mov_b32 v6, s7
    v_mfma_f32_16x16x32_bf16 v[32:35], a[204:207], v[76:79], v[32:35]
    v_mfma_f32_16x16x32_bf16 v[36:39], a[204:207], v[84:87], v[36:39]
    s_waitcnt lgkmcnt(5)
    v_mfma_f32_16x16x32_bf16 v[36:39], a[200:203], v[80:83], v[36:39]
    ds_read_b64_tr_b16 a[200:201], v10 offset:0
    v_mfma_f32_16x16x32_bf16 v[36:39], a[208:211], v[112:115], v[36:39]
    ds_read_b64_tr_b16 a[202:203], v10 offset:2048
    v_mfma_f32_16x16x32_bf16 v[36:39], a[212:215], v[116:119], v[36:39]
    ds_read_b64_tr_b16 a[204:205], v10 offset:4096
    v_mfma_f32_16x16x32_bf16 v[32:35], a[212:215], v[108:111], v[32:35]
    s_add_u32 s77, s7, 1
    ds_read_b64_tr_b16 a[206:207], v10 offset:6144
    v_mfma_f32_16x16x32_bf16 v[32:35], a[208:211], v[104:107], v[32:35]
    v_mfma_f32_16x16x32_bf16 v[28:31], a[208:211], v[96:99], v[28:31]
    v_mfma_f32_16x16x32_bf16 v[28:31], a[212:215], v[100:103], v[28:31]
    v_mfma_f32_16x16x32_bf16 v[24:27], a[212:215], v[92:95], v[24:27]
    s_waitcnt lgkmcnt(5)
    v_mul_f32 v36, v19, v36
    v_mfma_f32_16x16x32_bf16 v[24:27], a[208:211], v[88:91], v[24:27]
    ds_read_b64_tr_b16 a[208:209], v10 offset:8192
    v_mfma_f32_16x16x32_bf16 v[40:43], a[184:187], a[96:99], 0
    s_lshl_b32 s42, s48, 8
    ds_read_b64_tr_b16 a[210:211], v10 offset:10240
    v_lshrrev_b32 v22, 2, v1
    v_mfma_f32_16x16x32_bf16 v[40:43], a[188:191], a[100:103], v[40:43]
    s_add_u32 s42, s42, 3932304
    ds_read_b64_tr_b16 a[212:213], v10 offset:12288
    v_min_u32 v22, 9, v22
    v_mfma_f32_16x16x32_bf16 v[44:47], a[188:191], a[108:111], 0
    ds_read_b64_tr_b16 a[214:215], v10 offset:14336
    v_mul_u32_u24 v22, 6144, v22
    v_mfma_f32_16x16x32_bf16 v[44:47], a[184:187], a[104:107], v[44:47]
    v_and_b32 v23, 3, v1
    v_lshl_add_u32 v22, v23, 2, v22
    v_mfma_f32_16x16x32_bf16 v[48:51], a[184:187], a[112:115], 0
    buffer_load_dword v23, v22, s[24:27], s42 offen sc1
    v_mfma_f32_16x16x32_bf16 v[48:51], a[188:191], a[116:119], v[48:51]
    v_mul_f32 v24, v16, v24
    v_mul_f32 v25, v16, v25
    v_mfma_f32_16x16x32_bf16 v[52:55], a[188:191], a[124:127], 0
    s_waitcnt lgkmcnt(5)
    v_mul_f32 v26, v16, v26
    v_mul_f32 v27, v16, v27
    v_mfma_f32_16x16x32_bf16 v[52:55], a[184:187], a[120:123], v[52:55]
    ds_read_b64_tr_b16 a[184:185], v10 offset:16384
    v_cvt_pk_bf16_f32 v24, v24, v25
    v_mfma_f32_16x16x32_bf16 v[52:55], a[192:195], v[120:123], v[52:55]
    ds_read_b64_tr_b16 a[186:187], v10 offset:18432
    v_cvt_pk_bf16_f32 v25, v26, v27
    v_mfma_f32_16x16x32_bf16 v[52:55], a[196:199], v[124:127], v[52:55]
    ds_read_b64_tr_b16 a[188:189], v10 offset:20480
    v_accvgpr_write_b32 a34, v24
    v_mfma_f32_16x16x32_bf16 v[48:51], a[196:199], a[148:151], v[48:51]
    ds_read_b64_tr_b16 a[190:191], v10 offset:22528
    v_accvgpr_write_b32 a35, v25
    v_mfma_f32_16x16x32_bf16 v[48:51], a[192:195], a[144:147], v[48:51]
    buffer_store_dwordx4 a[32:35], v14, s[20:23], s55 offen offset:0 sc1
    v_mul_f32 v28, v17, v28
    v_mfma_f32_16x16x32_bf16 v[44:47], a[192:195], a[136:139], v[44:47]
    v_mul_f32 v29, v17, v29
    v_mul_f32 v30, v17, v30
    v_mfma_f32_16x16x32_bf16 v[44:47], a[196:199], a[140:143], v[44:47]
    v_mul_f32 v31, v17, v31
    v_cvt_pk_bf16_f32 v28, v28, v29
    v_mfma_f32_16x16x32_bf16 v[40:43], a[196:199], a[132:135], v[40:43]
    s_waitcnt lgkmcnt(5)
    v_cvt_pk_bf16_f32 v29, v30, v31
    v_accvgpr_write_b32 a38, v28
    v_mfma_f32_16x16x32_bf16 v[40:43], a[192:195], a[128:131], v[40:43]
    s_sub_u32 s78, s72, s77
    ds_read_b64_tr_b16 a[192:193], v10 offset:24576
    v_accvgpr_write_b32 a39, v29
    v_mfma_f32_16x16x32_bf16 v[40:43], a[200:203], v[128:131], v[40:43]
    buffer_store_dwordx4 a[36:39], v14, s[20:23], s55 offen offset:1024 sc1
    v_mul_f32 v32, v18, v32
    v_mfma_f32_16x16x32_bf16 v[40:43], a[204:207], v[132:135], v[40:43]
    s_sub_u32 s79, s73, s77
    ds_read_b64_tr_b16 a[194:195], v10 offset:26624
    v_mul_f32 v33, v18, v33
    v_mfma_f32_16x16x32_bf16 v[44:47], a[204:207], v[140:143], v[44:47]
    s_max_u32 s78, s78, s79
    ds_read_b64_tr_b16 a[196:197], v10 offset:28672
    v_mul_f32 v34, v18, v34
    v_mfma_f32_16x16x32_bf16 v[44:47], a[200:203], v[136:139], v[44:47]
    s_sub_u32 s79, s74, s77
    ds_read_b64_tr_b16 a[198:199], v10 offset:30720
    v_mul_f32 v35, v18, v35
    v_mfma_f32_16x16x32_bf16 v[48:51], a[200:203], v[144:147], v[48:51]
    s_max_u32 s78, s78, s79
    v_cvt_pk_bf16_f32 v32, v32, v33
    v_cvt_pk_bf16_f32 v33, v34, v35
    v_mfma_f32_16x16x32_bf16 v[48:51], a[204:207], v[148:151], v[48:51]
    s_sub_u32 s79, s75, s77
    v_accvgpr_write_b32 a42, v32
    v_accvgpr_write_b32 a43, v33
    v_mfma_f32_16x16x32_bf16 v[52:55], a[204:207], v[156:159], v[52:55]
    buffer_store_dwordx4 a[40:43], v14, s[20:23], s55 offen offset:2048 sc1
    v_mul_f32 v37, v19, v37
    v_mfma_f32_16x16x32_bf16 v[52:55], a[200:203], v[152:155], v[52:55]
    s_waitcnt lgkmcnt(3)
    ds_read_b64_tr_b16 a[200:201], v10 offset:32768
    v_mul_f32 v38, v19, v38
    v_mfma_f32_16x16x32_bf16 v[52:55], a[208:211], v[184:187], v[52:55]
    s_max_u32 s78, s78, s79
    ds_read_b64_tr_b16 a[202:203], v10 offset:34816
    v_mul_f32 v39, v19, v39
    v_mfma_f32_16x16x32_bf16 v[52:55], a[212:215], v[188:191], v[52:55]
    s_cmp_gt_u32 s78, 5
    s_cbranch_scc1 spin_o0
spin_o0_ret:
    v_cvt_pk_bf16_f32 v36, v36, v37
    v_mfma_f32_16x16x32_bf16 v[48:51], a[212:215], v[180:183], v[48:51]
    s_add_u32 s37, s59, 0
    ds_read_b64_tr_b16 a[204:205], v10 offset:36864
    v_cvt_pk_bf16_f32 v37, v38, v39
    v_mfma_f32_16x16x32_bf16 v[48:51], a[208:211], v[176:179], v[48:51]
    buffer_load_dwordx4 a[216:219], v14, s[20:23], s37 offen offset:0 sc1
    v_mfma_f32_16x16x32_bf16 v[44:47], a[208:211], v[168:171], v[44:47]
    ds_read_b64_tr_b16 a[206:207], v10 offset:38912
    v_accvgpr_write_b32 a46, v36
    v_mfma_f32_16x16x32_bf16 v[44:47], a[212:215], v[172:175], v[44:47]
    v_accvgpr_write_b32 a47, v37
    v_mfma_f32_16x16x32_bf16 v[40:43], a[212:215], v[164:167], v[40:43]
pg_10:
    s_cbranch_execz pg_12
    buffer_store_dwordx4 a[44:47], v14, s[20:23], s55 offen offset:3072 sc1
    v_mfma_f32_16x16x32_bf16 v[40:43], a[208:211], v[160:163], v[40:43]
    s_add_u32 s55, s55, 4096
    ds_read_b64_tr_b16 a[208:209], v10 offset:40960
    v_mfma_f32_16x16x32_bf16 v[40:43], a[184:187], v[192:195], v[40:43]
    ds_read_b64_tr_b16 a[210:211], v10 offset:43008
    v_mfma_f32_16x16x32_bf16 v[40:43], a[188:191], v[196:199], v[40:43]
    buffer_load_dwordx4 a[220:223], v14, s[20:23], s37 offen offset:1024 sc1
    v_mfma_f32_16x16x32_bf16 v[44:47], a[188:191], v[204:207], v[44:47]
    ds_read_b64_tr_b16 a[212:213], v10 offset:45056
    v_mfma_f32_16x16x32_bf16 v[44:47], a[184:187], v[200:203], v[44:47]
    ds_read_b64_tr_b16 a[214:215], v10 offset:47104
    v_add_u32 v10, 73728, v10
    v_mfma_f32_16x16x32_bf16 v[48:51], a[184:187], v[208:211], v[48:51]
    s_waitcnt lgkmcnt(4)
    v_mfma_f32_16x16x32_bf16 v[48:51], a[188:191], v[212:215], v[48:51]
    v_mfma_f32_16x16x32_bf16 v[52:55], a[188:191], v[220:223], v[52:55]
    v_mfma_f32_16x16x32_bf16 v[52:55], a[184:187], v[216:219], v[52:55]
    ds_read_b64_tr_b16 a[184:185], v11 offset:49152
    v_mfma_f32_16x16x32_bf16 v[52:55], a[192:195], v[248:251], v[52:55]
    ds_read_b64_tr_b16 a[186:187], v11 offset:51200
    v_mfma_f32_16x16x32_bf16 v[52:55], a[196:199], v[252:255], v[52:55]
    ds_read_b64_tr_b16 a[188:189], v11 offset:53248
    v_mfma_f32_16x16x32_bf16 v[48:51], a[196:199], v[244:247], v[48:51]
    buffer_load_dwordx4 a[224:227], v14, s[20:23], s37 offen offset:2048 sc1
    v_mfma_f32_16x16x32_bf16 v[48:51], a[192:195], v[240:243], v[48:51]
    ds_read_b64_tr_b16 a[190:191], v11 offset:55296
    v_mfma_f32_16x16x32_bf16 v[44:47], a[192:195], v[232:235], v[44:47]
    v_mfma_f32_16x16x32_bf16 v[44:47], a[196:199], v[236:239], v[44:47]
    v_mfma_f32_16x16x32_bf16 v[40:43], a[196:199], v[228:231], v[40:43]
    v_mfma_f32_16x16x32_bf16 v[40:43], a[192:195], v[224:227], v[40:43]
    ds_read_b64_tr_b16 a[192:193], v11 offset:57344
    v_mfma_f32_16x16x32_bf16 v[40:43], a[200:203], v[56:59], v[40:43]
    ds_read_b64_tr_b16 a[194:195], v11 offset:59392
    v_mfma_f32_16x16x32_bf16 v[40:43], a[204:207], v[60:63], v[40:43]
    ds_read_b64_tr_b16 a[196:197], v11 offset:61440
    v_mfma_f32_16x16x32_bf16 v[44:47], a[204:207], v[68:71], v[44:47]
    s_waitcnt lgkmcnt(3)
    ds_read_b64_tr_b16 a[198:199], v11 offset:63488
    v_mfma_f32_16x16x32_bf16 v[44:47], a[200:203], v[64:67], v[44:47]
    buffer_load_dwordx4 a[228:231], v14, s[20:23], s37 offen offset:3072 sc1
    v_mfma_f32_16x16x32_bf16 v[48:51], a[200:203], v[72:75], v[48:51]
    v_mfma_f32_16x16x32_bf16 v[48:51], a[204:207], v[76:79], v[48:51]
    v_mfma_f32_16x16x32_bf16 v[52:55], a[204:207], v[84:87], v[52:55]
    v_mfma_f32_16x16x32_bf16 v[52:55], a[200:203], v[80:83], v[52:55]
    ds_read_b64_tr_b16 a[200:201], v11 offset:0
    v_mfma_f32_16x16x32_bf16 v[52:55], a[208:211], v[112:115], v[52:55]
    ds_read_b64_tr_b16 a[202:203], v11 offset:2048
    v_mfma_f32_16x16x32_bf16 v[52:55], a[212:215], v[116:119], v[52:55]
    ds_read_b64_tr_b16 a[204:205], v11 offset:4096
    v_mfma_f32_16x16x32_bf16 v[48:51], a[212:215], v[108:111], v[48:51]
    ds_read_b64_tr_b16 a[206:207], v11 offset:6144
    v_mfma_f32_16x16x32_bf16 v[48:51], a[208:211], v[104:107], v[48:51]
    v_mfma_f32_16x16x32_bf16 v[44:47], a[208:211], v[96:99], v[44:47]
    v_mfma_f32_16x16x32_bf16 v[44:47], a[212:215], v[100:103], v[44:47]
    v_mfma_f32_16x16x32_bf16 v[40:43], a[212:215], v[92:95], v[40:43]
    s_add_u32 s37, s60, 0
    v_mul_f32 v52, v19, v52
    v_mfma_f32_16x16x32_bf16 v[40:43], a[208:211], v[88:91], v[40:43]
    ds_read_b64_tr_b16 a[208:209], v11 offset:8192
    v_mfma_f32_16x16x32_bf16 v[24:27], a[184:187], a[96:99], 0
    s_waitcnt vmcnt(8)
    ds_read_b64_tr_b16 a[210:211], v11 offset:10240
    v_cmp_ne_u32 vcc, s7, v23
    v_mfma_f32_16x16x32_bf16 v[24:27], a[188:191], a[100:103], v[24:27]
    s_cbranch_vccnz spin_gu
spin_gu_ret:
    v_mul_f32 v44, v17, v44
    v_mfma_f32_16x16x32_bf16 v[28:31], a[188:191], a[108:111], 0
    ds_read_b64_tr_b16 a[212:213], v11 offset:12288
    v_mul_f32 v40, v16, v40
    v_mfma_f32_16x16x32_bf16 v[28:31], a[184:187], a[104:107], v[28:31]
    s_waitcnt lgkmcnt(3)
    ds_read_b64_tr_b16 a[214:215], v11 offset:14336
    v_mul_f32 v41, v16, v41
    v_mfma_f32_16x16x32_bf16 v[32:35], a[184:187], a[112:115], 0
    buffer_load_dwordx4 a[232:235], v14, s[20:23], s37 offen offset:0 sc1
    v_mfma_f32_16x16x32_bf16 v[32:35], a[188:191], a[116:119], v[32:35]
    v_mul_f32 v42, v16, v42
    v_mul_f32 v43, v16, v43
    v_mfma_f32_16x16x32_bf16 v[36:39], a[188:191], a[124:127], 0
    v_cvt_pk_bf16_f32 v40, v40, v41
    v_cvt_pk_bf16_f32 v41, v42, v43
    v_mfma_f32_16x16x32_bf16 v[36:39], a[184:187], a[120:123], v[36:39]
    ds_read_b64_tr_b16 a[184:185], v11 offset:16384
    v_accvgpr_write_b32 a48, v40
    v_mfma_f32_16x16x32_bf16 v[36:39], a[192:195], v[120:123], v[36:39]
    ds_read_b64_tr_b16 a[186:187], v11 offset:18432
    v_accvgpr_write_b32 a49, v41
    v_mfma_f32_16x16x32_bf16 v[36:39], a[196:199], v[124:127], v[36:39]
    ds_read_b64_tr_b16 a[188:189], v11 offset:20480
    v_mul_f32 v45, v17, v45
    v_mfma_f32_16x16x32_bf16 v[32:35], a[196:199], a[148:151], v[32:35]
    ds_read_b64_tr_b16 a[190:191], v11 offset:22528
    v_mul_f32 v46, v17, v46
    v_mfma_f32_16x16x32_bf16 v[32:35], a[192:195], a[144:147], v[32:35]
    v_mul_f32 v47, v17, v47
    v_cvt_pk_bf16_f32 v44, v44, v45
    v_mfma_f32_16x16x32_bf16 v[28:31], a[192:195], a[136:139], v[28:31]
    v_cvt_pk_bf16_f32 v45, v46, v47
    v_accvgpr_write_b32 a52, v44
    v_mfma_f32_16x16x32_bf16 v[28:31], a[196:199], a[140:143], v[28:31]
    buffer_load_dwordx4 a[236:239], v14, s[20:23], s37 offen offset:1024 sc1
    v_mfma_f32_16x16x32_bf16 v[24:27], a[196:199], a[132:135], v[24:27]
    v_accvgpr_write_b32 a53, v45
    v_mul_f32 v48, v18, v48
    v_mfma_f32_16x16x32_bf16 v[24:27], a[192:195], a[128:131], v[24:27]
    ds_read_b64_tr_b16 a[192:193], v11 offset:24576
    v_mul_f32 v49, v18, v49
    v_mfma_f32_16x16x32_bf16 v[24:27], a[200:203], v[128:131], v[24:27]
    ds_read_b64_tr_b16 a[194:195], v11 offset:26624
    v_mul_f32 v50, v18, v50
    v_mfma_f32_16x16x32_bf16 v[24:27], a[204:207], v[132:135], v[24:27]
    ds_read_b64_tr_b16 a[196:197], v11 offset:28672
    v_mul_f32 v51, v18, v51
    v_mfma_f32_16x16x32_bf16 v[28:31], a[204:207], v[140:143], v[28:31]
    s_waitcnt lgkmcnt(3)
    ds_read_b64_tr_b16 a[198:199], v11 offset:30720
    v_cvt_pk_bf16_f32 v48, v48, v49
    v_mfma_f32_16x16x32_bf16 v[28:31], a[200:203], v[136:139], v[28:31]
    v_cvt_pk_bf16_f32 v49, v50, v51
    v_accvgpr_write_b32 a56, v48
    v_mfma_f32_16x16x32_bf16 v[32:35], a[200:203], v[144:147], v[32:35]
    v_accvgpr_write_b32 a57, v49
    v_mul_f32 v53, v19, v53
    v_mfma_f32_16x16x32_bf16 v[32:35], a[204:207], v[148:151], v[32:35]
    v_mul_f32 v54, v19, v54
    v_mul_f32 v55, v19, v55
    v_mfma_f32_16x16x32_bf16 v[36:39], a[204:207], v[156:159], v[36:39]
    buffer_load_dwordx4 a[240:243], v14, s[20:23], s37 offen offset:2048 sc1
    v_mfma_f32_16x16x32_bf16 v[36:39], a[200:203], v[152:155], v[36:39]
    ds_read_b64_tr_b16 a[200:201], v11 offset:32768
    v_cvt_pk_bf16_f32 v52, v52, v53
    v_mfma_f32_16x16x32_bf16 v[36:39], a[208:211], v[184:187], v[36:39]
    ds_read_b64_tr_b16 a[202:203], v11 offset:34816
    v_cvt_pk_bf16_f32 v53, v54, v55
    v_mfma_f32_16x16x32_bf16 v[36:39], a[212:215], v[188:191], v[36:39]
    ds_read_b64_tr_b16 a[204:205], v11 offset:36864
    v_accvgpr_write_b32 a60, v52
    v_mfma_f32_16x16x32_bf16 v[32:35], a[212:215], v[180:183], v[32:35]
    s_waitcnt vmcnt(6)
    ds_read_b64_tr_b16 a[206:207], v11 offset:38912
    v_accvgpr_write_b32 a61, v53
    v_mfma_f32_16x16x32_bf16 v[32:35], a[208:211], v[176:179], v[32:35]
    buffer_store_dword v4, v15, s[24:27], s76 offen sc1
    v_mfma_f32_16x16x32_bf16 v[28:31], a[208:211], v[168:171], v[28:31]
    v_mov_b32 v4, s56
    v_mfma_f32_16x16x32_bf16 v[28:31], a[212:215], v[172:175], v[28:31]
    v_cmp_gt_u32 vcc, 16, v1
    v_mfma_f32_16x16x32_bf16 v[24:27], a[212:215], v[164:167], v[24:27]
    v_mfma_f32_16x16x32_bf16 v[24:27], a[208:211], v[160:163], v[24:27]
    buffer_load_dwordx4 a[244:247], v14, s[20:23], s37 offen offset:3072 sc1
    v_mfma_f32_16x16x32_bf16 v[24:27], a[184:187], v[192:195], v[24:27]
    ds_read_b64_tr_b16 a[208:209], v11 offset:40960
    v_mfma_f32_16x16x32_bf16 v[24:27], a[188:191], v[196:199], v[24:27]
    ds_read_b64_tr_b16 a[210:211], v11 offset:43008
    v_mfma_f32_16x16x32_bf16 v[28:31], a[188:191], v[204:207], v[28:31]
    s_add_u32 s37, s61, 0
    ds_read_b64_tr_b16 a[212:213], v11 offset:45056
    v_mfma_f32_16x16x32_bf16 v[28:31], a[184:187], v[200:203], v[28:31]
    s_waitcnt lgkmcnt(3)
    ds_read_b64_tr_b16 a[214:215], v11 offset:47104
    v_add_u32 v11, 73728, v11
    v_mfma_f32_16x16x32_bf16 v[32:35], a[184:187], v[208:211], v[32:35]
    s_add_u32 s38, s44, 81920
    s_add_u32 s36, s44, 122880
    v_mfma_f32_16x16x32_bf16 v[32:35], a[188:191], v[212:215], v[32:35]
    s_cmp_lt_u32 s3, 2
    s_cselect_b32 s38, s38, s36
    s_add_u32 m0, s63, 16384
    v_mfma_f32_16x16x32_bf16 v[36:39], a[188:191], v[220:223], v[36:39]
    v_mfma_f32_16x16x32_bf16 v[36:39], a[184:187], v[216:219], v[36:39]
    v_mfma_f32_16x16x32_bf16 v[36:39], a[192:195], v[248:251], v[36:39]
    buffer_load_dwordx4 a[152:155], v14, s[20:23], s37 offen offset:0 sc1
    v_mfma_f32_16x16x32_bf16 v[36:39], a[196:199], v[252:255], v[36:39]
    s_waitcnt lgkmcnt(0)
    v_mfma_f32_16x16x32_bf16 v[32:35], a[196:199], v[244:247], v[32:35]
    s_barrier
    v_mfma_f32_16x16x32_bf16 v[32:35], a[192:195], v[240:243], v[32:35]
    buffer_load_dwordx4 v7, s[8:11], s38 offen lds
    v_mfma_f32_16x16x32_bf16 v[28:31], a[192:195], v[232:235], v[28:31]
    ds_read_b64_tr_b16 a[184:185], v8 offset:0
    v_mfma_f32_16x16x32_bf16 v[28:31], a[196:199], v[236:239], v[28:31]
    ds_read_b64_tr_b16 a[186:187], v8 offset:2048
    v_mfma_f32_16x16x32_bf16 v[24:27], a[196:199], v[228:231], v[24:27]
    ds_read_b64_tr_b16 a[188:189], v8 offset:4096
    v_mfma_f32_16x16x32_bf16 v[24:27], a[192:195], v[224:227], v[24:27]
    s_add_u32 s38, s44, 81920
    ds_read_b64_tr_b16 a[190:191], v8 offset:6144
    v_mfma_f32_16x16x32_bf16 v[24:27], a[200:203], v[56:59], v[24:27]
    ds_read_b64_tr_b16 a[192:193], v8 offset:8192
    v_mfma_f32_16x16x32_bf16 v[24:27], a[204:207], v[60:63], v[24:27]
    buffer_load_dwordx4 a[156:159], v14, s[20:23], s37 offen offset:1024 sc1
    v_mfma_f32_16x16x32_bf16 v[28:31], a[204:207], v[68:71], v[28:31]
    s_addk_i32 m0, -16384
    ds_read_b64_tr_b16 a[194:195], v8 offset:10240
    v_mfma_f32_16x16x32_bf16 v[28:31], a[200:203], v[64:67], v[28:31]
    ds_read_b64_tr_b16 a[196:197], v8 offset:12288
    v_mfma_f32_16x16x32_bf16 v[32:35], a[200:203], v[72:75], v[32:35]
    ds_read_b64_tr_b16 a[198:199], v8 offset:14336
    v_mfma_f32_16x16x32_bf16 v[32:35], a[204:207], v[76:79], v[32:35]
    v_mfma_f32_16x16x32_bf16 v[36:39], a[204:207], v[84:87], v[36:39]
    v_mfma_f32_16x16x32_bf16 v[36:39], a[200:203], v[80:83], v[36:39]
    buffer_load_dwordx4 v2, s[8:11], s38 offen lds
    v_mfma_f32_16x16x32_bf16 v[36:39], a[208:211], v[112:115], v[36:39]
    ds_read_b64_tr_b16 a[200:201], v8 offset:16384
    v_mfma_f32_16x16x32_bf16 v[36:39], a[212:215], v[116:119], v[36:39]
    ds_read_b64_tr_b16 a[202:203], v8 offset:18432
    v_mfma_f32_16x16x32_bf16 v[32:35], a[212:215], v[108:111], v[32:35]
    buffer_load_dwordx4 a[160:163], v14, s[20:23], s37 offen offset:2048 sc1
    v_mfma_f32_16x16x32_bf16 v[32:35], a[208:211], v[104:107], v[32:35]
    s_load_dwordx4 s[72:75], s[86:87], s5 glc
    ds_read_b64_tr_b16 a[204:205], v8 offset:20480
    s_add_u32 s38, s44, 81920
    v_mfma_f32_16x16x32_bf16 v[28:31], a[208:211], v[96:99], v[28:31]
    s_waitcnt lgkmcnt(5)
    ds_read_b64_tr_b16 a[206:207], v8 offset:22528
    v_mfma_f32_16x16x32_bf16 v[28:31], a[212:215], v[100:103], v[28:31]
    s_add_u32 m0, s63, 4096
    v_mul_f32 v32, v18, v32
    v_mul_f32 v33, v18, v33
    v_mfma_f32_16x16x32_bf16 v[24:27], a[212:215], v[92:95], v[24:27]
    v_mul_f32 v34, v18, v34
    v_mfma_f32_16x16x32_bf16 v[24:27], a[208:211], v[88:91], v[24:27]
    ds_read_b64_tr_b16 a[208:209], v8 offset:24576
    v_mfma_f32_16x16x32_bf16 v[40:43], a[184:187], a[96:99], 0
    ds_read_b64_tr_b16 a[210:211], v8 offset:26624
    v_mul_f32 v28, v17, v28
    v_mfma_f32_16x16x32_bf16 v[40:43], a[188:191], a[100:103], v[40:43]
    ds_read_b64_tr_b16 a[212:213], v8 offset:28672
    v_mul_f32 v29, v17, v29
    v_mfma_f32_16x16x32_bf16 v[44:47], a[188:191], a[108:111], 0
    ds_read_b64_tr_b16 a[214:215], v8 offset:30720
    v_mul_f32 v24, v16, v24
    v_mfma_f32_16x16x32_bf16 v[44:47], a[184:187], a[104:107], v[44:47]
    buffer_load_dwordx4 a[164:167], v14, s[20:23], s37 offen offset:3072 sc1
    v_mfma_f32_16x16x32_bf16 v[48:51], a[184:187], a[112:115], 0
    buffer_load_dwordx4 v3, s[8:11], s38 offen lds
    v_mfma_f32_16x16x32_bf16 v[48:51], a[188:191], a[116:119], v[48:51]
    v_mul_f32 v25, v16, v25
    v_mul_f32 v26, v16, v26
    v_mfma_f32_16x16x32_bf16 v[52:55], a[188:191], a[124:127], 0
    s_waitcnt lgkmcnt(5)
    v_mul_f32 v27, v16, v27
    v_cvt_pk_bf16_f32 v24, v24, v25
    v_mfma_f32_16x16x32_bf16 v[52:55], a[184:187], a[120:123], v[52:55]
    s_add_u32 s38, s44, 122880
    ds_read_b64_tr_b16 a[184:185], v8 offset:32768
    v_cvt_pk_bf16_f32 v25, v26, v27
    v_mfma_f32_16x16x32_bf16 v[52:55], a[192:195], v[120:123], v[52:55]
    ds_read_b64_tr_b16 a[186:187], v8 offset:34816
    v_accvgpr_write_b32 a50, v24
    v_mfma_f32_16x16x32_bf16 v[52:55], a[196:199], v[124:127], v[52:55]
    s_addk_i32 m0, 4096
    ds_read_b64_tr_b16 a[188:189], v8 offset:36864
    v_accvgpr_write_b32 a51, v25
    v_mfma_f32_16x16x32_bf16 v[48:51], a[196:199], a[148:151], v[48:51]
    buffer_store_dwordx4 a[48:51], v14, s[20:23], s55 offen offset:0 sc1
    v_mul_f32 v30, v17, v30
    v_mfma_f32_16x16x32_bf16 v[48:51], a[192:195], a[144:147], v[48:51]
    ds_read_b64_tr_b16 a[190:191], v8 offset:38912
    v_mul_f32 v31, v17, v31
    v_mfma_f32_16x16x32_bf16 v[44:47], a[192:195], a[136:139], v[44:47]
    v_cvt_pk_bf16_f32 v28, v28, v29
    v_cvt_pk_bf16_f32 v29, v30, v31
    v_mfma_f32_16x16x32_bf16 v[44:47], a[196:199], a[140:143], v[44:47]
    v_accvgpr_write_b32 a54, v28
    v_accvgpr_write_b32 a55, v29
    v_mfma_f32_16x16x32_bf16 v[40:43], a[196:199], a[132:135], v[40:43]
    buffer_store_dwordx4 a[52:55], v14, s[20:23], s55 offen offset:1024 sc1
    v_mul_f32 v35, v18, v35
    v_mfma_f32_16x16x32_bf16 v[40:43], a[192:195], a[128:131], v[40:43]
    buffer_load_dwordx4 v2, s[8:11], s38 offen lds
    v_mfma_f32_16x16x32_bf16 v[40:43], a[200:203], v[128:131], v[40:43]
    s_waitcnt lgkmcnt(3)
    ds_read_b64_tr_b16 a[192:193], v8 offset:40960
    v_cvt_pk_bf16_f32 v32, v32, v33
    v_mfma_f32_16x16x32_bf16 v[40:43], a[204:207], v[132:135], v[40:43]
    ds_read_b64_tr_b16 a[194:195], v8 offset:43008
    v_cvt_pk_bf16_f32 v33, v34, v35
    v_mfma_f32_16x16x32_bf16 v[44:47], a[204:207], v[140:143], v[44:47]
    ds_read_b64_tr_b16 a[196:197], v8 offset:45056
    v_accvgpr_write_b32 a58, v32
    v_mfma_f32_16x16x32_bf16 v[44:47], a[200:203], v[136:139], v[44:47]
    s_add_u32 s38, s44, 122880
    ds_read_b64_tr_b16 a[198:199], v8 offset:47104
    v_accvgpr_write_b32 a59, v33
    v_mfma_f32_16x16x32_bf16 v[48:51], a[200:203], v[144:147], v[48:51]
    buffer_store_dwordx4 a[56:59], v14, s[20:23], s55 offen offset:2048 sc1
    v_mul_f32 v36, v19, v36
    v_mfma_f32_16x16x32_bf16 v[48:51], a[204:207], v[148:151], v[48:51]
    s_addk_i32 m0, 4096
    v_mul_f32 v37, v19, v37
    v_mul_f32 v38, v19, v38
    v_mfma_f32_16x16x32_bf16 v[52:55], a[204:207], v[156:159], v[52:55]
    v_mul_f32 v39, v19, v39
    v_cvt_pk_bf16_f32 v36, v36, v37
    v_mfma_f32_16x16x32_bf16 v[52:55], a[200:203], v[152:155], v[52:55]
    ds_read_b64_tr_b16 a[200:201], v8 offset:49152
    v_cvt_pk_bf16_f32 v37, v38, v39
    v_mfma_f32_16x16x32_bf16 v[52:55], a[208:211], v[184:187], v[52:55]
    ds_read_b64_tr_b16 a[202:203], v8 offset:51200
    v_accvgpr_write_b32 a62, v36
    v_mfma_f32_16x16x32_bf16 v[52:55], a[212:215], v[188:191], v[52:55]
    ds_read_b64_tr_b16 a[204:205], v8 offset:53248
    v_accvgpr_write_b32 a63, v37
    v_mfma_f32_16x16x32_bf16 v[48:51], a[212:215], v[180:183], v[48:51]
    buffer_store_dwordx4 a[60:63], v14, s[20:23], s55 offen offset:3072 sc1
    v_mfma_f32_16x16x32_bf16 v[48:51], a[208:211], v[176:179], v[48:51]
    buffer_load_dwordx4 v3, s[8:11], s38 offen lds
    v_mfma_f32_16x16x32_bf16 v[44:47], a[208:211], v[168:171], v[44:47]
    s_add_u32 s55, s55, 4096
    ds_read_b64_tr_b16 a[206:207], v8 offset:55296
    v_mfma_f32_16x16x32_bf16 v[44:47], a[212:215], v[172:175], v[44:47]
    s_waitcnt lgkmcnt(6)
    v_mfma_f32_16x16x32_bf16 v[40:43], a[212:215], v[164:167], v[40:43]
    s_add_u32 s77, s7, 2
    v_mfma_f32_16x16x32_bf16 v[40:43], a[208:211], v[160:163], v[40:43]
    s_add_u32 s38, s44, 163840
    ds_read_b64_tr_b16 a[208:209], v8 offset:57344
    s_add_u32 s36, s45, 0
    v_mfma_f32_16x16x32_bf16 v[40:43], a[184:187], v[192:195], v[40:43]
    s_cmp_lt_u32 s3, 2
    s_cselect_b32 s38, s38, s36
    v_mfma_f32_16x16x32_bf16 v[40:43], a[188:191], v[196:199], v[40:43]
    s_addk_i32 m0, 24576
    ds_read_b64_tr_b16 a[210:211], v8 offset:59392
    v_mfma_f32_16x16x32_bf16 v[44:47], a[188:191], v[204:207], v[44:47]
    ds_read_b64_tr_b16 a[212:213], v8 offset:61440
    v_mfma_f32_16x16x32_bf16 v[44:47], a[184:187], v[200:203], v[44:47]
    ds_read_b64_tr_b16 a[214:215], v8 offset:63488
    v_add_u32 v8, 65536, v8
    v_mfma_f32_16x16x32_bf16 v[48:51], a[184:187], v[208:211], v[48:51]
    v_mfma_f32_16x16x32_bf16 v[48:51], a[188:191], v[212:215], v[48:51]
    v_mfma_f32_16x16x32_bf16 v[52:55], a[188:191], v[220:223], v[52:55]
    s_waitcnt lgkmcnt(5)
    v_mfma_f32_16x16x32_bf16 v[52:55], a[184:187], v[216:219], v[52:55]
    buffer_load_dwordx4 v7, s[8:11], s38 offen lds
    v_mfma_f32_16x16x32_bf16 v[52:55], a[192:195], v[248:251], v[52:55]
    ds_read_b64_tr_b16 a[184:185], v9 offset:0
    v_mfma_f32_16x16x32_bf16 v[52:55], a[196:199], v[252:255], v[52:55]
    ds_read_b64_tr_b16 a[186:187], v9 offset:2048
    v_mfma_f32_16x16x32_bf16 v[48:51], a[196:199], v[244:247], v[48:51]
    ds_read_b64_tr_b16 a[188:189], v9 offset:4096
    v_mfma_f32_16x16x32_bf16 v[48:51], a[192:195], v[240:243], v[48:51]
    s_add_u32 s38, s44, 163840
    ds_read_b64_tr_b16 a[190:191], v9 offset:6144
    v_mfma_f32_16x16x32_bf16 v[44:47], a[192:195], v[232:235], v[44:47]
    v_mfma_f32_16x16x32_bf16 v[44:47], a[196:199], v[236:239], v[44:47]
    s_addk_i32 m0, -16384
    v_mfma_f32_16x16x32_bf16 v[40:43], a[196:199], v[228:231], v[40:43]
    s_waitcnt lgkmcnt(4)
    s_sub_u32 s78, s72, s77
    s_sub_u32 s79, s73, s77
    v_mfma_f32_16x16x32_bf16 v[40:43], a[192:195], v[224:227], v[40:43]
    s_max_u32 s78, s78, s79
    ds_read_b64_tr_b16 a[192:193], v9 offset:8192
    s_sub_u32 s79, s74, s77
    v_mfma_f32_16x16x32_bf16 v[40:43], a[200:203], v[56:59], v[40:43]
    s_max_u32 s78, s78, s79
    ds_read_b64_tr_b16 a[194:195], v9 offset:10240
    s_sub_u32 s79, s75, s77
    v_mfma_f32_16x16x32_bf16 v[40:43], a[204:207], v[60:63], v[40:43]
    s_max_u32 s78, s78, s79
    ds_read_b64_tr_b16 a[196:197], v9 offset:12288
    v_mfma_f32_16x16x32_bf16 v[44:47], a[204:207], v[68:71], v[44:47]
    s_cmp_gt_u32 s78, 4
    s_cbranch_scc1 spin_o1
spin_o1_ret:
    s_add_u32 s37, s59, 4096
    v_mfma_f32_16x16x32_bf16 v[44:47], a[200:203], v[64:67], v[44:47]
    buffer_load_dwordx4 v2, s[8:11], s38 offen lds
    v_mfma_f32_16x16x32_bf16 v[48:51], a[200:203], v[72:75], v[48:51]
    ds_read_b64_tr_b16 a[198:199], v9 offset:14336
    v_mfma_f32_16x16x32_bf16 v[48:51], a[204:207], v[76:79], v[48:51]
    v_mfma_f32_16x16x32_bf16 v[52:55], a[204:207], v[84:87], v[52:55]
    v_mfma_f32_16x16x32_bf16 v[52:55], a[200:203], v[80:83], v[52:55]
    s_add_u32 s38, s44, 163840
    ds_read_b64_tr_b16 a[200:201], v9 offset:16384
    v_mfma_f32_16x16x32_bf16 v[52:55], a[208:211], v[112:115], v[52:55]
    buffer_load_dwordx4 a[168:171], v14, s[20:23], s37 offen offset:0 sc1
    v_mfma_f32_16x16x32_bf16 v[52:55], a[212:215], v[116:119], v[52:55]
    s_addk_i32 m0, 4096
    ds_read_b64_tr_b16 a[202:203], v9 offset:18432
    v_mfma_f32_16x16x32_bf16 v[48:51], a[212:215], v[108:111], v[48:51]
    ds_read_b64_tr_b16 a[204:205], v9 offset:20480
    v_mfma_f32_16x16x32_bf16 v[48:51], a[208:211], v[104:107], v[48:51]
    s_waitcnt lgkmcnt(3)
    ds_read_b64_tr_b16 a[206:207], v9 offset:22528
    v_mfma_f32_16x16x32_bf16 v[44:47], a[208:211], v[96:99], v[44:47]
    v_mul_f32 v52, v19, v52
    v_mfma_f32_16x16x32_bf16 v[44:47], a[212:215], v[100:103], v[44:47]
    v_mul_f32 v53, v19, v53
    v_mfma_f32_16x16x32_bf16 v[40:43], a[212:215], v[92:95], v[40:43]
    v_mul_f32 v54, v19, v54
    v_mfma_f32_16x16x32_bf16 v[40:43], a[208:211], v[88:91], v[40:43]
    buffer_load_dwordx4 v3, s[8:11], s38 offen lds
    v_mfma_f32_16x16x32_bf16 v[24:27], a[184:187], a[96:99], 0
    ds_read_b64_tr_b16 a[208:209], v9 offset:24576
    v_mfma_f32_16x16x32_bf16 v[24:27], a[188:191], a[100:103], v[24:27]
    buffer_load_dwordx4 a[172:175], v14, s[20:23], s37 offen offset:1024 sc1
    v_mfma_f32_16x16x32_bf16 v[28:31], a[188:191], a[108:111], 0
    ds_read_b64_tr_b16 a[210:211], v9 offset:26624
    v_mul_f32 v44, v17, v44
    v_mfma_f32_16x16x32_bf16 v[28:31], a[184:187], a[104:107], v[28:31]
    s_add_u32 s38, s45, 0
    ds_read_b64_tr_b16 a[212:213], v9 offset:28672
    v_mul_f32 v40, v16, v40
    v_mfma_f32_16x16x32_bf16 v[32:35], a[184:187], a[112:115], 0
    ds_read_b64_tr_b16 a[214:215], v9 offset:30720
    v_mul_f32 v41, v16, v41
    v_mfma_f32_16x16x32_bf16 v[32:35], a[188:191], a[116:119], v[32:35]
    s_addk_i32 m0, 4096
    v_mul_f32 v42, v16, v42
    v_mul_f32 v43, v16, v43
    v_mfma_f32_16x16x32_bf16 v[36:39], a[188:191], a[124:127], 0
    v_cvt_pk_bf16_f32 v40, v40, v41
    v_cvt_pk_bf16_f32 v41, v42, v43
    v_mfma_f32_16x16x32_bf16 v[36:39], a[184:187], a[120:123], v[36:39]
    ds_read_b64_tr_b16 a[184:185], v9 offset:32768
    v_accvgpr_write_b32 a64, v40
    v_mfma_f32_16x16x32_bf16 v[36:39], a[192:195], v[120:123], v[36:39]
    ds_read_b64_tr_b16 a[186:187], v9 offset:34816
    v_accvgpr_write_b32 a65, v41
    v_mfma_f32_16x16x32_bf16 v[36:39], a[196:199], v[124:127], v[36:39]
    ds_read_b64_tr_b16 a[188:189], v9 offset:36864
    v_mul_f32 v45, v17, v45
    v_mfma_f32_16x16x32_bf16 v[32:35], a[196:199], a[148:151], v[32:35]
    s_waitcnt lgkmcnt(4)
    ds_read_b64_tr_b16 a[190:191], v9 offset:38912
    v_mul_f32 v46, v17, v46
    v_mfma_f32_16x16x32_bf16 v[32:35], a[192:195], a[144:147], v[32:35]
    buffer_load_dwordx4 a[176:179], v14, s[20:23], s37 offen offset:2048 sc1
    v_mfma_f32_16x16x32_bf16 v[28:31], a[192:195], a[136:139], v[28:31]
    buffer_load_dwordx4 v2, s[8:11], s38 offen lds
    v_mfma_f32_16x16x32_bf16 v[28:31], a[196:199], a[140:143], v[28:31]
    s_mov_b32 s12, s64
    v_mul_f32 v47, v17, v47
    v_cvt_pk_bf16_f32 v44, v44, v45
    v_mfma_f32_16x16x32_bf16 v[24:27], a[196:199], a[132:135], v[24:27]
    s_and_b32 s13, s65, 0xffff
    v_cvt_pk_bf16_f32 v45, v46, v47
    v_accvgpr_write_b32 a68, v44
    v_mfma_f32_16x16x32_bf16 v[24:27], a[192:195], a[128:131], v[24:27]
    s_add_u32 s38, s45, 0
    ds_read_b64_tr_b16 a[192:193], v9 offset:40960
    v_accvgpr_write_b32 a69, v45
    v_mfma_f32_16x16x32_bf16 v[24:27], a[200:203], v[128:131], v[24:27]
    s_mov_b32 s14, 2621440
    ds_read_b64_tr_b16 a[194:195], v9 offset:43008
    v_mul_f32 v48, v18, v48
    v_mfma_f32_16x16x32_bf16 v[24:27], a[204:207], v[132:135], v[24:27]
    s_addk_i32 m0, 4096
    ds_read_b64_tr_b16 a[196:197], v9 offset:45056
    v_mul_f32 v49, v18, v49
    v_mfma_f32_16x16x32_bf16 v[28:31], a[204:207], v[140:143], v[28:31]
    s_mov_b32 s15, 0x00020000
    ds_read_b64_tr_b16 a[198:199], v9 offset:47104
    v_mul_f32 v50, v18, v50
    v_mfma_f32_16x16x32_bf16 v[28:31], a[200:203], v[136:139], v[28:31]
    buffer_load_dwordx4 a[180:183], v14, s[20:23], s37 offen offset:3072 sc1
    v_mfma_f32_16x16x32_bf16 v[32:35], a[200:203], v[144:147], v[32:35]
    s_lshl_b32 s56, s54, 1
    v_mul_f32 v51, v18, v51
    v_cvt_pk_bf16_f32 v48, v48, v49
    v_mfma_f32_16x16x32_bf16 v[32:35], a[204:207], v[148:151], v[32:35]
    s_and_b32 s57, s53, 1
    v_cvt_pk_bf16_f32 v49, v50, v51
    v_accvgpr_write_b32 a72, v48
    v_mfma_f32_16x16x32_bf16 v[36:39], a[204:207], v[156:159], v[36:39]
    s_waitcnt lgkmcnt(3)
    v_accvgpr_write_b32 a73, v49
    v_mul_f32 v55, v19, v55
    v_mfma_f32_16x16x32_bf16 v[36:39], a[200:203], v[152:155], v[36:39]
    buffer_load_dwordx4 v3, s[8:11], s38 offen lds
    v_mfma_f32_16x16x32_bf16 v[36:39], a[208:211], v[184:187], v[36:39]
    s_waitcnt vmcnt(10)
    ds_read_b64_tr_b16 a[200:201], v9 offset:49152
    v_cvt_pk_bf16_f32 v52, v52, v53
    v_mfma_f32_16x16x32_bf16 v[36:39], a[212:215], v[188:191], v[36:39]
    buffer_store_dword v4, v15, s[24:27], s76 offen sc1
    v_mfma_f32_16x16x32_bf16 v[32:35], a[212:215], v[180:183], v[32:35]
    s_add_u32 s56, s56, s57
    ds_read_b64_tr_b16 a[202:203], v9 offset:51200
    v_cvt_pk_bf16_f32 v53, v54, v55
    v_mfma_f32_16x16x32_bf16 v[32:35], a[208:211], v[176:179], v[32:35]
    s_add_u32 s38, s46, 0
    ds_read_b64_tr_b16 a[204:205], v9 offset:53248
    v_accvgpr_write_b32 a76, v52
    v_mfma_f32_16x16x32_bf16 v[28:31], a[208:211], v[168:171], v[28:31]
    s_add_u32 s36, s47, 0
    ds_read_b64_tr_b16 a[206:207], v9 offset:55296
    v_accvgpr_write_b32 a77, v53
    v_mfma_f32_16x16x32_bf16 v[28:31], a[212:215], v[172:175], v[28:31]
    s_cmp_lt_u32 s3, 2
    s_cselect_b32 s38, s38, s36
    s_addk_i32 m0, 24576
    v_mfma_f32_16x16x32_bf16 v[24:27], a[212:215], v[164:167], v[24:27]
    s_lshl_b32 s6, s56, 5
    s_andn2_b32 s56, 2, s53
    s_lshl3_add_u32 s6, s56, s6
    v_mfma_f32_16x16x32_bf16 v[24:27], a[208:211], v[160:163], v[24:27]
    s_mul_i32 s56, s51, 320
    ds_read_b64_tr_b16 a[208:209], v9 offset:57344
    s_and_b32 s57, s51, 1
    v_mfma_f32_16x16x32_bf16 v[24:27], a[184:187], v[192:195], v[24:27]
    s_add_u32 s64, s57, s50
    ds_read_b64_tr_b16 a[210:211], v9 offset:59392
    s_lshl_b32 s64, s64, 6
    v_mfma_f32_16x16x32_bf16 v[24:27], a[188:191], v[196:199], v[24:27]
    s_add_u32 s64, s64, s56
    ds_read_b64_tr_b16 a[212:213], v9 offset:61440
    s_xor_b32 s57, s57, 1
    v_mfma_f32_16x16x32_bf16 v[28:31], a[188:191], v[204:207], v[28:31]
    s_lshl_b32 s57, s57, 8
    ds_read_b64_tr_b16 a[214:215], v9 offset:63488
    v_add_u32 v9, 65536, v9
    v_mfma_f32_16x16x32_bf16 v[28:31], a[184:187], v[200:203], v[28:31]
    s_waitcnt lgkmcnt(4)
    s_add_u32 s68, s56, s57
    v_mfma_f32_16x16x32_bf16 v[32:35], a[184:187], v[208:211], v[32:35]
    buffer_load_dwordx4 v7, s[8:11], s38 offen lds
    v_mfma_f32_16x16x32_bf16 v[32:35], a[188:191], v[212:215], v[32:35]
    s_add_u32 s56, s7, 5
    v_mov_b32 v4, s56
    v_mfma_f32_16x16x32_bf16 v[36:39], a[188:191], v[220:223], v[36:39]
    v_mfma_f32_16x16x32_bf16 v[36:39], a[184:187], v[216:219], v[36:39]
    s_add_u32 s38, s46, 0
    ds_read_b64_tr_b16 a[184:185], v10 offset:0
    v_mfma_f32_16x16x32_bf16 v[36:39], a[192:195], v[248:251], v[36:39]
    ds_read_b64_tr_b16 a[186:187], v10 offset:2048
    v_mfma_f32_16x16x32_bf16 v[36:39], a[196:199], v[252:255], v[36:39]
    s_addk_i32 m0, -16384
    ds_read_b64_tr_b16 a[188:189], v10 offset:4096
    v_mfma_f32_16x16x32_bf16 v[32:35], a[196:199], v[244:247], v[32:35]
    ds_read_b64_tr_b16 a[190:191], v10 offset:6144
    v_mfma_f32_16x16x32_bf16 v[32:35], a[192:195], v[240:243], v[32:35]
    v_mfma_f32_16x16x32_bf16 v[28:31], a[192:195], v[232:235], v[28:31]
    v_mfma_f32_16x16x32_bf16 v[28:31], a[196:199], v[236:239], v[28:31]
    v_mfma_f32_16x16x32_bf16 v[24:27], a[196:199], v[228:231], v[24:27]
    v_mfma_f32_16x16x32_bf16 v[24:27], a[192:195], v[224:227], v[24:27]
    buffer_load_dwordx4 v2, s[8:11], s38 offen lds
    v_mfma_f32_16x16x32_bf16 v[24:27], a[200:203], v[56:59], v[24:27]
    ds_read_b64_tr_b16 a[192:193], v10 offset:8192
    v_mfma_f32_16x16x32_bf16 v[24:27], a[204:207], v[60:63], v[24:27]
    ds_read_b64_tr_b16 a[194:195], v10 offset:10240
    v_mfma_f32_16x16x32_bf16 v[28:31], a[204:207], v[68:71], v[28:31]
    ds_read_b64_tr_b16 a[196:197], v10 offset:12288
    v_mfma_f32_16x16x32_bf16 v[28:31], a[200:203], v[64:67], v[28:31]
    s_waitcnt lgkmcnt(3)
    ds_read_b64_tr_b16 a[198:199], v10 offset:14336
    s_add_u32 s38, s46, 0
    v_mfma_f32_16x16x32_bf16 v[32:35], a[200:203], v[72:75], v[32:35]
    v_mfma_f32_16x16x32_bf16 v[32:35], a[204:207], v[76:79], v[32:35]
    s_addk_i32 m0, 4096
    v_mfma_f32_16x16x32_bf16 v[36:39], a[204:207], v[84:87], v[36:39]
    v_mfma_f32_16x16x32_bf16 v[36:39], a[200:203], v[80:83], v[36:39]
    ds_read_b64_tr_b16 a[200:201], v10 offset:16384
    v_mfma_f32_16x16x32_bf16 v[36:39], a[208:211], v[112:115], v[36:39]
    ds_read_b64_tr_b16 a[202:203], v10 offset:18432
    v_mfma_f32_16x16x32_bf16 v[36:39], a[212:215], v[116:119], v[36:39]
    ds_read_b64_tr_b16 a[204:205], v10 offset:20480
    v_mfma_f32_16x16x32_bf16 v[32:35], a[212:215], v[108:111], v[32:35]
    ds_read_b64_tr_b16 a[206:207], v10 offset:22528
    v_mfma_f32_16x16x32_bf16 v[32:35], a[208:211], v[104:107], v[32:35]
    buffer_load_dwordx4 v3, s[8:11], s38 offen lds
    v_mfma_f32_16x16x32_bf16 v[28:31], a[208:211], v[96:99], v[28:31]
    v_mfma_f32_16x16x32_bf16 v[28:31], a[212:215], v[100:103], v[28:31]
    v_mfma_f32_16x16x32_bf16 v[24:27], a[212:215], v[92:95], v[24:27]
    v_mul_f32 v36, v19, v36
    v_mfma_f32_16x16x32_bf16 v[24:27], a[208:211], v[88:91], v[24:27]
    s_add_u32 s38, s47, 0
    ds_read_b64_tr_b16 a[208:209], v10 offset:24576
    v_mul_f32 v32, v18, v32
    v_mfma_f32_16x16x32_bf16 v[40:43], a[184:187], a[96:99], 0
    s_mul_i32 s57, s48, 10
    ds_read_b64_tr_b16 a[210:211], v10 offset:26624
    v_lshrrev_b32 v5, 5, v1
    v_mfma_f32_16x16x32_bf16 v[40:43], a[188:191], a[100:103], v[40:43]
pg_11:
    s_cbranch_execz pg_13
    s_addk_i32 m0, 4096
    ds_read_b64_tr_b16 a[212:213], v10 offset:28672
    v_lshlrev_b32 v5, 3, v5
    v_mfma_f32_16x16x32_bf16 v[44:47], a[188:191], a[108:111], 0
    s_waitcnt lgkmcnt(3)
    ds_read_b64_tr_b16 a[214:215], v10 offset:30720
    v_bfe_u32 v22, v1, 3, 2
    v_mfma_f32_16x16x32_bf16 v[44:47], a[184:187], a[104:107], v[44:47]
    s_sub_u32 s57, s58, s57
    v_add_u32 v22, v22, v5
    v_mul_u32_u24 v22, 1280, v22
    v_mfma_f32_16x16x32_bf16 v[48:51], a[184:187], a[112:115], 0
    s_mul_i32 s62, s48, 1280
    v_lshrrev_b32 v5, 4, v1
    v_lshlrev_b32 v5, 1, v5
    v_mfma_f32_16x16x32_bf16 v[48:51], a[188:191], a[116:119], v[48:51]
    s_lshl_b32 s56, s57, 6
    v_and_b32 v23, 7, v1
    v_xor_b32 v23, v23, v5
    v_mfma_f32_16x16x32_bf16 v[52:55], a[188:191], a[124:127], 0
    s_add_u32 s62, s62, s56
    v_lshlrev_b32 v23, 4, v23
    v_add_u32 v22, v22, v23
    v_mfma_f32_16x16x32_bf16 v[52:55], a[184:187], a[120:123], v[52:55]
    buffer_load_dwordx4 v2, s[8:11], s38 offen lds
    v_mfma_f32_16x16x32_bf16 v[52:55], a[192:195], v[120:123], v[52:55]
    s_lshl_b32 s56, s3, 4
    ds_read_b64_tr_b16 a[184:185], v10 offset:32768
    v_add_u32 v23, 20480, v22
    v_mfma_f32_16x16x32_bf16 v[52:55], a[196:199], v[124:127], v[52:55]
    s_add_u32 s62, s62, s56
    ds_read_b64_tr_b16 a[186:187], v10 offset:34816
    v_mul_f32 v24, v16, v24
    v_mfma_f32_16x16x32_bf16 v[48:51], a[196:199], a[148:151], v[48:51]
    s_lshl_b32 s62, s62, 2
    ds_read_b64_tr_b16 a[188:189], v10 offset:36864
    v_mul_f32 v25, v16, v25
    v_mfma_f32_16x16x32_bf16 v[48:51], a[192:195], a[144:147], v[48:51]
    s_add_u32 s38, s47, 0
    ds_read_b64_tr_b16 a[190:191], v10 offset:38912
    v_mul_f32 v26, v16, v26
    v_mfma_f32_16x16x32_bf16 v[44:47], a[192:195], a[136:139], v[44:47]
    s_add_u32 s62, s62, 3670016
    v_mul_f32 v27, v16, v27
    v_cvt_pk_bf16_f32 v24, v24, v25
    v_mfma_f32_16x16x32_bf16 v[44:47], a[196:199], a[140:143], v[44:47]
    s_addk_i32 m0, 4096
    v_cvt_pk_bf16_f32 v25, v26, v27
    v_accvgpr_write_b32 a66, v24
    v_mfma_f32_16x16x32_bf16 v[40:43], a[196:199], a[132:135], v[40:43]
    s_lshl_b32 s41, s48, 6
    v_accvgpr_write_b32 a67, v25
    v_mul_f32 v28, v17, v28
    v_mfma_f32_16x16x32_bf16 v[40:43], a[192:195], a[128:131], v[40:43]
    buffer_store_dwordx4 a[64:67], v14, s[20:23], s55 offen offset:0 sc1
    v_mul_f32 v29, v17, v29
    v_mfma_f32_16x16x32_bf16 v[40:43], a[200:203], v[128:131], v[40:43]
    s_lshr_b32 s56, s3, 1
    ds_read_b64_tr_b16 a[192:193], v10 offset:40960
    v_mul_f32 v30, v17, v30
    v_mfma_f32_16x16x32_bf16 v[40:43], a[204:207], v[132:135], v[40:43]
    s_lshl_b32 s56, s56, 5
    ds_read_b64_tr_b16 a[194:195], v10 offset:43008
    v_mul_f32 v31, v17, v31
    v_mfma_f32_16x16x32_bf16 v[44:47], a[204:207], v[140:143], v[44:47]
    s_add_u32 s41, s41, s56
    ds_read_b64_tr_b16 a[196:197], v10 offset:45056
    v_cvt_pk_bf16_f32 v28, v28, v29
    v_mfma_f32_16x16x32_bf16 v[44:47], a[200:203], v[136:139], v[44:47]
    s_waitcnt lgkmcnt(3)
    ds_read_b64_tr_b16 a[198:199], v10 offset:47104
    v_cvt_pk_bf16_f32 v29, v30, v31
    v_mfma_f32_16x16x32_bf16 v[48:51], a[200:203], v[144:147], v[48:51]
    buffer_load_dwordx4 v3, s[8:11], s38 offen lds
    v_mfma_f32_16x16x32_bf16 v[48:51], a[204:207], v[148:151], v[48:51]
    s_and_b32 s56, s3, 1
    v_accvgpr_write_b32 a70, v28
    v_accvgpr_write_b32 a71, v29
    v_mfma_f32_16x16x32_bf16 v[52:55], a[204:207], v[156:159], v[52:55]
    buffer_store_dwordx4 a[68:71], v14, s[20:23], s55 offen offset:1024 sc1
    v_mul_f32 v33, v18, v33
    v_mfma_f32_16x16x32_bf16 v[52:55], a[200:203], v[152:155], v[52:55]
    s_lshl_b32 s56, s56, 2
    ds_read_b64_tr_b16 a[200:201], v10 offset:49152
    v_mul_f32 v34, v18, v34
    v_mfma_f32_16x16x32_bf16 v[52:55], a[208:211], v[184:187], v[52:55]
    s_add_u32 s41, s41, s56
    ds_read_b64_tr_b16 a[202:203], v10 offset:51200
    v_mul_f32 v35, v18, v35
    v_mfma_f32_16x16x32_bf16 v[52:55], a[212:215], v[188:191], v[52:55]
    s_add_u32 s56, s3, 0
    ds_read_b64_tr_b16 a[204:205], v10 offset:53248
    v_cvt_pk_bf16_f32 v32, v32, v33
    v_mfma_f32_16x16x32_bf16 v[48:51], a[212:215], v[180:183], v[48:51]
    s_min_u32 s56, s56, 9
    ds_read_b64_tr_b16 a[206:207], v10 offset:55296
    v_cvt_pk_bf16_f32 v33, v34, v35
    v_mfma_f32_16x16x32_bf16 v[48:51], a[208:211], v[176:179], v[48:51]
    s_mul_i32 s38, s56, 24576
    v_accvgpr_write_b32 a74, v32
    v_accvgpr_write_b32 a75, v33
    v_mfma_f32_16x16x32_bf16 v[44:47], a[208:211], v[168:171], v[44:47]
    buffer_store_dwordx4 a[72:75], v14, s[20:23], s55 offen offset:2048 sc1
    v_mul_f32 v37, v19, v37
    v_mfma_f32_16x16x32_bf16 v[44:47], a[212:215], v[172:175], v[44:47]
    s_lshl_b32 s56, s56, 10
    v_mul_f32 v38, v19, v38
    v_mul_f32 v39, v19, v39
    v_mfma_f32_16x16x32_bf16 v[40:43], a[212:215], v[164:167], v[40:43]
    s_add_u32 m0, s56, 61440
    v_cvt_pk_bf16_f32 v36, v36, v37
    v_cvt_pk_bf16_f32 v37, v38, v39
    v_mfma_f32_16x16x32_bf16 v[40:43], a[208:211], v[160:163], v[40:43]
    s_mul_i32 s41, s41, 1280
    ds_read_b64_tr_b16 a[208:209], v10 offset:57344
    v_accvgpr_write_b32 a78, v36
    v_mfma_f32_16x16x32_bf16 v[40:43], a[184:187], v[192:195], v[40:43]
    s_lshl_b32 s57, s57, 7
    ds_read_b64_tr_b16 a[210:211], v10 offset:59392
    v_accvgpr_write_b32 a79, v37
    v_mfma_f32_16x16x32_bf16 v[40:43], a[188:191], v[196:199], v[40:43]
    buffer_store_dwordx4 a[76:79], v14, s[20:23], s55 offen offset:3072 sc1
    v_mfma_f32_16x16x32_bf16 v[44:47], a[188:191], v[204:207], v[44:47]
    s_add_u32 s56, s3, 4
    ds_read_b64_tr_b16 a[212:213], v10 offset:61440
    s_min_u32 s56, s56, 9
    v_mfma_f32_16x16x32_bf16 v[44:47], a[184:187], v[200:203], v[44:47]
    s_waitcnt lgkmcnt(3)
    ds_read_b64_tr_b16 a[214:215], v10 offset:63488
    v_add_u32 v10, 65536, v10
    v_mfma_f32_16x16x32_bf16 v[48:51], a[184:187], v[208:211], v[48:51]
    s_add_u32 s55, s55, 4096
    s_add_u32 s41, s41, s57
    s_lshl_b32 s57, s48, 10
    v_mfma_f32_16x16x32_bf16 v[48:51], a[188:191], v[212:215], v[48:51]
    s_add_u32 s38, s38, s57
    s_add_u32 s38, s38, 3276800
    s_lshl_b32 s57, s48, 10
    v_mfma_f32_16x16x32_bf16 v[52:55], a[188:191], v[220:223], v[52:55]
    buffer_load_dwordx4 v14, s[24:27], s38 offen sc1 lds
    v_mfma_f32_16x16x32_bf16 v[52:55], a[184:187], v[216:219], v[52:55]
    s_mul_i32 s38, s56, 24576
    ds_read_b64_tr_b16 a[184:185], v11 offset:0
    s_add_u32 s38, s38, s57
    v_mfma_f32_16x16x32_bf16 v[52:55], a[192:195], v[248:251], v[52:55]
    s_add_u32 s38, s38, 3276800
    ds_read_b64_tr_b16 a[186:187], v11 offset:2048
    s_lshl_b32 s56, s56, 10
    v_mfma_f32_16x16x32_bf16 v[52:55], a[196:199], v[252:255], v[52:55]
    s_add_u32 m0, s56, 61440
    ds_read_b64_tr_b16 a[188:189], v11 offset:4096
    s_lshl_b32 s43, s3, 11
    v_mfma_f32_16x16x32_bf16 v[48:51], a[196:199], v[244:247], v[48:51]
    buffer_load_dwordx4 v14, s[24:27], s38 offen sc1 lds
    v_mfma_f32_16x16x32_bf16 v[48:51], a[192:195], v[240:243], v[48:51]
    s_add_u32 s56, s3, 8
    ds_read_b64_tr_b16 a[190:191], v11 offset:6144
    s_min_u32 s56, s56, 9
    v_mfma_f32_16x16x32_bf16 v[44:47], a[192:195], v[232:235], v[44:47]
    s_mul_i32 s38, s56, 24576
    s_lshl_b32 s57, s48, 10
    s_add_u32 s38, s38, s57
    v_mfma_f32_16x16x32_bf16 v[44:47], a[196:199], v[236:239], v[44:47]
    s_add_u32 s38, s38, 3276800
    s_lshl_b32 s56, s56, 10
    s_add_u32 m0, s56, 61440
    v_mfma_f32_16x16x32_bf16 v[40:43], a[196:199], v[228:231], v[40:43]
    s_add_u32 s56, s7, 6
    v_lshrrev_b32 v12, 2, v1
    v_mfma_f32_16x16x32_bf16 v[40:43], a[192:195], v[224:227], v[40:43]
    ds_read_b64_tr_b16 a[192:193], v11 offset:8192
    v_mfma_f32_16x16x32_bf16 v[40:43], a[200:203], v[56:59], v[40:43]
    s_load_dwordx4 s[72:75], s[86:87], s5 glc
    ds_read_b64_tr_b16 a[194:195], v11 offset:10240
    v_mfma_f32_16x16x32_bf16 v[40:43], a[204:207], v[60:63], v[40:43]
    ds_read_b64_tr_b16 a[196:197], v11 offset:12288
    v_mfma_f32_16x16x32_bf16 v[44:47], a[204:207], v[68:71], v[44:47]
    s_waitcnt lgkmcnt(5)
    ds_read_b64_tr_b16 a[198:199], v11 offset:14336
    v_mfma_f32_16x16x32_bf16 v[44:47], a[200:203], v[64:67], v[44:47]
    buffer_load_dwordx4 v14, s[24:27], s38 offen sc1 lds
    v_mfma_f32_16x16x32_bf16 v[48:51], a[200:203], v[72:75], v[48:51]
    v_lshlrev_b32 v12, 6, v12
    v_mfma_f32_16x16x32_bf16 v[48:51], a[204:207], v[76:79], v[48:51]
    v_and_b32 v21, 3, v1
    v_mfma_f32_16x16x32_bf16 v[52:55], a[204:207], v[84:87], v[52:55]
    v_lshl_add_u32 v12, v21, 3, v12
    v_mfma_f32_16x16x32_bf16 v[52:55], a[200:203], v[80:83], v[52:55]
    ds_read_b64_tr_b16 a[200:201], v11 offset:16384
    v_mfma_f32_16x16x32_bf16 v[52:55], a[208:211], v[112:115], v[52:55]
    ds_read_b64_tr_b16 a[202:203], v11 offset:18432
    v_mfma_f32_16x16x32_bf16 v[52:55], a[212:215], v[116:119], v[52:55]
    ds_read_b64_tr_b16 a[204:205], v11 offset:20480
    v_mfma_f32_16x16x32_bf16 v[48:51], a[212:215], v[108:111], v[48:51]
    ds_read_b64_tr_b16 a[206:207], v11 offset:22528
    v_mfma_f32_16x16x32_bf16 v[48:51], a[208:211], v[104:107], v[48:51]
    v_and_b32 v21, 16, v1
    v_mfma_f32_16x16x32_bf16 v[44:47], a[208:211], v[96:99], v[44:47]
    v_lshl_add_u32 v12, v21, 1, v12
    v_mfma_f32_16x16x32_bf16 v[44:47], a[212:215], v[100:103], v[44:47]
    v_mul_f32 v52, v19, v52
    v_mfma_f32_16x16x32_bf16 v[40:43], a[212:215], v[92:95], v[40:43]
    s_waitcnt lgkmcnt(5)
    v_mul_f32 v53, v19, v53
    v_mul_f32 v48, v18, v48
    v_mfma_f32_16x16x32_bf16 v[40:43], a[208:211], v[88:91], v[40:43]
    s_add_u32 s37, s60, 4096
    ds_read_b64_tr_b16 a[208:209], v11 offset:24576
    v_mul_f32 v44, v17, v44
    v_mfma_f32_16x16x32_bf16 v[24:27], a[184:187], a[96:99], 0
    ds_read_b64_tr_b16 a[210:211], v11 offset:26624
    v_mul_f32 v45, v17, v45
    v_mfma_f32_16x16x32_bf16 v[24:27], a[188:191], a[100:103], v[24:27]
    ds_read_b64_tr_b16 a[212:213], v11 offset:28672
    v_mul_f32 v40, v16, v40
    v_mfma_f32_16x16x32_bf16 v[28:31], a[188:191], a[108:111], 0
    ds_read_b64_tr_b16 a[214:215], v11 offset:30720
    v_mul_f32 v41, v16, v41
    v_mfma_f32_16x16x32_bf16 v[28:31], a[184:187], a[104:107], v[28:31]
    v_mul_f32 v42, v16, v42
    v_mul_f32 v43, v16, v43
    v_mfma_f32_16x16x32_bf16 v[32:35], a[184:187], a[112:115], 0
    buffer_load_dwordx4 a[96:99], v14, s[20:23], s37 offen offset:0 sc1
    v_mfma_f32_16x16x32_bf16 v[32:35], a[188:191], a[116:119], v[32:35]
    v_cvt_pk_bf16_f32 v40, v40, v41
    v_cvt_pk_bf16_f32 v41, v42, v43
    v_mfma_f32_16x16x32_bf16 v[36:39], a[188:191], a[124:127], 0
    s_waitcnt lgkmcnt(5)
    v_accvgpr_write_b32 a80, v40
    v_accvgpr_write_b32 a81, v41
    v_mfma_f32_16x16x32_bf16 v[36:39], a[184:187], a[120:123], v[36:39]
    ds_read_b64_tr_b16 a[184:185], v11 offset:32768
    v_mul_f32 v46, v17, v46
    v_mfma_f32_16x16x32_bf16 v[36:39], a[192:195], v[120:123], v[36:39]
    ds_read_b64_tr_b16 a[186:187], v11 offset:34816
    v_mul_f32 v47, v17, v47
    v_mfma_f32_16x16x32_bf16 v[36:39], a[196:199], v[124:127], v[36:39]
    ds_read_b64_tr_b16 a[188:189], v11 offset:36864
    v_cvt_pk_bf16_f32 v44, v44, v45
    v_mfma_f32_16x16x32_bf16 v[32:35], a[196:199], a[148:151], v[32:35]
    ds_read_b64_tr_b16 a[190:191], v11 offset:38912
    v_cvt_pk_bf16_f32 v45, v46, v47
    v_mfma_f32_16x16x32_bf16 v[32:35], a[192:195], a[144:147], v[32:35]
    v_accvgpr_write_b32 a84, v44
    v_accvgpr_write_b32 a85, v45
    v_mfma_f32_16x16x32_bf16 v[28:31], a[192:195], a[136:139], v[28:31]
    v_mul_f32 v49, v18, v49
    v_mul_f32 v50, v18, v50
    v_mfma_f32_16x16x32_bf16 v[28:31], a[196:199], a[140:143], v[28:31]
    v_mul_f32 v51, v18, v51
    v_cvt_pk_bf16_f32 v48, v48, v49
    v_mfma_f32_16x16x32_bf16 v[24:27], a[196:199], a[132:135], v[24:27]
    buffer_load_dwordx4 a[100:103], v14, s[20:23], s37 offen offset:1024 sc1
    v_mfma_f32_16x16x32_bf16 v[24:27], a[192:195], a[128:131], v[24:27]
    s_waitcnt lgkmcnt(4)
    ds_read_b64_tr_b16 a[192:193], v11 offset:40960
    v_cvt_pk_bf16_f32 v49, v50, v51
    v_mfma_f32_16x16x32_bf16 v[24:27], a[200:203], v[128:131], v[24:27]
    ds_read_b64_tr_b16 a[194:195], v11 offset:43008
    v_accvgpr_write_b32 a88, v48
    v_mfma_f32_16x16x32_bf16 v[24:27], a[204:207], v[132:135], v[24:27]
    ds_read_b64_tr_b16 a[196:197], v11 offset:45056
    v_accvgpr_write_b32 a89, v49
    v_mfma_f32_16x16x32_bf16 v[28:31], a[204:207], v[140:143], v[28:31]
    ds_read_b64_tr_b16 a[198:199], v11 offset:47104
    v_mfma_f32_16x16x32_bf16 v[28:31], a[200:203], v[136:139], v[28:31]
    v_mul_f32 v54, v19, v54
    v_mfma_f32_16x16x32_bf16 v[32:35], a[200:203], v[144:147], v[32:35]
    v_mul_f32 v55, v19, v55
    v_cvt_pk_bf16_f32 v52, v52, v53
    v_mfma_f32_16x16x32_bf16 v[32:35], a[204:207], v[148:151], v[32:35]
    v_cvt_pk_bf16_f32 v53, v54, v55
    v_accvgpr_write_b32 a92, v52
    v_mfma_f32_16x16x32_bf16 v[36:39], a[204:207], v[156:159], v[36:39]
    v_accvgpr_write_b32 a93, v53
    v_mfma_f32_16x16x32_bf16 v[36:39], a[200:203], v[152:155], v[36:39]
    ds_read_b64_tr_b16 a[200:201], v11 offset:49152
    v_mfma_f32_16x16x32_bf16 v[36:39], a[208:211], v[184:187], v[36:39]
    buffer_load_dwordx4 a[104:107], v14, s[20:23], s37 offen offset:2048 sc1
    v_mfma_f32_16x16x32_bf16 v[36:39], a[212:215], v[188:191], v[36:39]
    ds_read_b64_tr_b16 a[202:203], v11 offset:51200
    v_mfma_f32_16x16x32_bf16 v[32:35], a[212:215], v[180:183], v[32:35]
    ds_read_b64_tr_b16 a[204:205], v11 offset:53248
    v_mfma_f32_16x16x32_bf16 v[32:35], a[208:211], v[176:179], v[32:35]
    s_waitcnt lgkmcnt(5)
    ds_read_b64_tr_b16 a[206:207], v11 offset:55296
    v_mfma_f32_16x16x32_bf16 v[28:31], a[208:211], v[168:171], v[28:31]
    v_add_u32 v12, 98304, v12
    v_mfma_f32_16x16x32_bf16 v[28:31], a[212:215], v[172:175], v[28:31]
    s_waitcnt vmcnt(6)
    v_lshrrev_b32 v13, 2, v1
    v_mfma_f32_16x16x32_bf16 v[24:27], a[212:215], v[164:167], v[24:27]
    buffer_store_dword v4, v15, s[24:27], s76 offen sc1
    v_mfma_f32_16x16x32_bf16 v[24:27], a[208:211], v[160:163], v[24:27]
    ds_read_b64_tr_b16 a[208:209], v11 offset:57344
    v_mfma_f32_16x16x32_bf16 v[24:27], a[184:187], v[192:195], v[24:27]
    ds_read_b64_tr_b16 a[210:211], v11 offset:59392
    v_mfma_f32_16x16x32_bf16 v[24:27], a[188:191], v[196:199], v[24:27]
    ds_read_b64_tr_b16 a[212:213], v11 offset:61440
    v_mfma_f32_16x16x32_bf16 v[28:31], a[188:191], v[204:207], v[28:31]
    buffer_load_dwordx4 a[108:111], v14, s[20:23], s37 offen offset:3072 sc1
    v_mfma_f32_16x16x32_bf16 v[28:31], a[184:187], v[200:203], v[28:31]
    ds_read_b64_tr_b16 a[214:215], v11 offset:63488
    v_add_u32 v11, 65536, v11
    v_mfma_f32_16x16x32_bf16 v[32:35], a[184:187], v[208:211], v[32:35]
    v_lshlrev_b32 v13, 6, v13
    v_mfma_f32_16x16x32_bf16 v[32:35], a[188:191], v[212:215], v[32:35]
    v_and_b32 v21, 3, v1
    v_mfma_f32_16x16x32_bf16 v[36:39], a[188:191], v[220:223], v[36:39]
    s_waitcnt lgkmcnt(3)
    v_lshl_add_u32 v13, v21, 3, v13
    s_add_u32 s37, s61, 4096
    v_mfma_f32_16x16x32_bf16 v[36:39], a[184:187], v[216:219], v[36:39]
    v_and_b32 v21, 16, v1
    v_mfma_f32_16x16x32_bf16 v[36:39], a[192:195], v[248:251], v[36:39]
    v_lshl_add_u32 v13, v21, 1, v13
    v_mfma_f32_16x16x32_bf16 v[36:39], a[196:199], v[252:255], v[36:39]
    s_waitcnt lgkmcnt(0)
    v_xor_b32 v13, 32, v13
    v_mfma_f32_16x16x32_bf16 v[32:35], a[196:199], v[244:247], v[32:35]
    s_barrier
    v_mfma_f32_16x16x32_bf16 v[32:35], a[192:195], v[240:243], v[32:35]
    ds_read_b64_tr_b16 a[184:185], v12 offset:57344
    v_mfma_f32_16x16x32_bf16 v[28:31], a[192:195], v[232:235], v[28:31]
    buffer_load_dwordx4 a[112:115], v14, s[20:23], s37 offen offset:0 sc1
    v_mfma_f32_16x16x32_bf16 v[28:31], a[196:199], v[236:239], v[28:31]
    ds_read_b64_tr_b16 a[186:187], v12 offset:58368
    v_mfma_f32_16x16x32_bf16 v[24:27], a[196:199], v[228:231], v[24:27]
    ds_read_b64_tr_b16 a[188:189], v12 offset:59392
    v_add_u32 v13, 98304, v13
    v_mfma_f32_16x16x32_bf16 v[24:27], a[192:195], v[224:227], v[24:27]
    ds_read_b64_tr_b16 a[190:191], v12 offset:60416
    v_subrev_u32 v12, 81920, v12
    v_mfma_f32_16x16x32_bf16 v[24:27], a[200:203], v[56:59], v[24:27]
    ds_read_b64_tr_b16 a[192:193], v13 offset:57344
    v_mfma_f32_16x16x32_bf16 v[24:27], a[204:207], v[60:63], v[24:27]
    ds_read_b64_tr_b16 a[194:195], v13 offset:58368
    v_mfma_f32_16x16x32_bf16 v[28:31], a[204:207], v[68:71], v[28:31]
    ds_read_b64_tr_b16 a[196:197], v13 offset:59392
    v_mfma_f32_16x16x32_bf16 v[28:31], a[200:203], v[64:67], v[28:31]
    ds_read_b64_tr_b16 a[198:199], v13 offset:60416
    v_subrev_u32 v13, 81920, v13
    v_mfma_f32_16x16x32_bf16 v[32:35], a[200:203], v[72:75], v[32:35]
    v_mov_b32 v55, s56
    v_mfma_f32_16x16x32_bf16 v[32:35], a[204:207], v[76:79], v[32:35]
    s_lshl_b32 s56, s3, 8
    v_mfma_f32_16x16x32_bf16 v[36:39], a[204:207], v[84:87], v[36:39]
    buffer_load_dwordx4 a[116:119], v14, s[20:23], s37 offen offset:1024 sc1
    v_mfma_f32_16x16x32_bf16 v[36:39], a[200:203], v[80:83], v[36:39]
    s_add_u32 s77, s7, 3
    ds_read_b64_tr_b16 a[200:201], v8 offset:0
    v_mfma_f32_16x16x32_bf16 v[36:39], a[208:211], v[112:115], v[36:39]
    s_add_u32 s56, s56, 71680
    ds_read_b64_tr_b16 a[202:203], v8 offset:2048
    v_mfma_f32_16x16x32_bf16 v[36:39], a[212:215], v[116:119], v[36:39]
    ds_read_b64_tr_b16 a[204:205], v8 offset:8192
    v_mfma_f32_16x16x32_bf16 v[32:35], a[212:215], v[108:111], v[32:35]
    s_waitcnt lgkmcnt(3)
    ds_read_b64_tr_b16 a[206:207], v8 offset:10240
    v_mfma_f32_16x16x32_bf16 v[32:35], a[208:211], v[104:107], v[32:35]
    v_mfma_f32_16x16x32_bf16 v[28:31], a[208:211], v[96:99], v[28:31]
    v_mfma_f32_16x16x32_bf16 v[28:31], a[212:215], v[100:103], v[28:31]
    v_mfma_f32_16x16x32_bf16 v[24:27], a[212:215], v[92:95], v[24:27]
    v_mul_f32 v36, v19, v36
    v_mfma_f32_16x16x32_bf16 v[24:27], a[208:211], v[88:91], v[24:27]
    ds_read_b64_tr_b16 a[208:209], v9 offset:0
    v_mfma_f32_16x16x32_bf16 v[96:99], a[184:187], a[0:3], 0
    buffer_load_dwordx4 a[120:123], v14, s[20:23], s37 offen offset:2048 sc1
    v_mfma_f32_16x16x32_bf16 v[96:99], a[188:191], a[16:19], v[96:99]
    ds_read_b64_tr_b16 a[210:211], v9 offset:2048
    v_mul_f32 v28, v17, v28
    v_mfma_f32_16x16x32_bf16 v[104:107], a[188:191], a[20:23], 0
    ds_read_b64_tr_b16 a[212:213], v9 offset:8192
    v_mul_f32 v24, v16, v24
    v_mfma_f32_16x16x32_bf16 v[104:107], a[184:187], a[4:7], v[104:107]
    ds_read_b64_tr_b16 a[214:215], v9 offset:10240
    v_mul_f32 v25, v16, v25
    v_mfma_f32_16x16x32_bf16 v[112:115], a[184:187], a[8:11], 0
    v_mul_f32 v26, v16, v26
    v_mul_f32 v27, v16, v27
    v_mfma_f32_16x16x32_bf16 v[112:115], a[188:191], a[24:27], v[112:115]
    v_cvt_pk_bf16_f32 v24, v24, v25
    v_cvt_pk_bf16_f32 v25, v26, v27
    v_mfma_f32_16x16x32_bf16 v[120:123], a[188:191], a[28:31], 0
    v_accvgpr_write_b32 a82, v24
    v_accvgpr_write_b32 a83, v25
    v_mfma_f32_16x16x32_bf16 v[120:123], a[184:187], a[12:15], v[120:123]
    buffer_store_dwordx4 a[80:83], v14, s[20:23], s55 offen offset:0 sc1
    v_mul_f32 v29, v17, v29
    v_mfma_f32_16x16x32_bf16 v[124:127], a[192:195], a[12:15], 0
    ds_read_b64_tr_b16 a[184:185], v10 offset:0
    v_mul_f32 v30, v17, v30
    v_mfma_f32_16x16x32_bf16 v[124:127], a[196:199], a[28:31], v[124:127]
    ds_read_b64_tr_b16 a[186:187], v10 offset:2048
    v_mul_f32 v31, v17, v31
    v_mfma_f32_16x16x32_bf16 v[116:119], a[196:199], a[24:27], 0
    buffer_load_dwordx4 a[124:127], v14, s[20:23], s37 offen offset:3072 sc1
    v_mfma_f32_16x16x32_bf16 v[116:119], a[192:195], a[8:11], v[116:119]
    s_sub_u32 s78, s72, s77
    ds_read_b64_tr_b16 a[188:189], v10 offset:8192
    v_cvt_pk_bf16_f32 v28, v28, v29
    v_mfma_f32_16x16x32_bf16 v[108:111], a[192:195], a[4:7], 0
    s_waitcnt lgkmcnt(3)
    ds_read_b64_tr_b16 a[190:191], v10 offset:10240
    v_cvt_pk_bf16_f32 v29, v30, v31
    v_mfma_f32_16x16x32_bf16 v[108:111], a[196:199], a[20:23], v[108:111]
    s_sub_u32 s79, s73, s77
    v_accvgpr_write_b32 a86, v28
    v_accvgpr_write_b32 a87, v29
    v_mfma_f32_16x16x32_bf16 v[100:103], a[196:199], a[16:19], 0
    buffer_store_dwordx4 a[84:87], v14, s[20:23], s55 offen offset:1024 sc1
    v_mul_f32 v32, v18, v32
    v_mfma_f32_16x16x32_bf16 v[100:103], a[192:195], a[0:3], v[100:103]
    s_max_u32 s78, s78, s79
    ds_read_b64_tr_b16 a[192:193], v11 offset:0
    v_mul_f32 v33, v18, v33
    v_mfma_f32_16x16x32_bf16 v[128:131], a[200:203], a[0:3], 0
    s_sub_u32 s79, s74, s77
    ds_read_b64_tr_b16 a[194:195], v11 offset:2048
    v_mul_f32 v34, v18, v34
    v_mfma_f32_16x16x32_bf16 v[128:131], a[204:207], a[16:19], v[128:131]
    s_max_u32 s78, s78, s79
    ds_read_b64_tr_b16 a[196:197], v11 offset:8192
    v_mul_f32 v35, v18, v35
    v_mfma_f32_16x16x32_bf16 v[136:139], a[204:207], a[20:23], 0
    s_sub_u32 s79, s75, s77
    ds_read_b64_tr_b16 a[198:199], v11 offset:10240
    v_cvt_pk_bf16_f32 v32, v32, v33
    v_mfma_f32_16x16x32_bf16 v[136:139], a[200:203], a[4:7], v[136:139]
    s_max_u32 s78, s78, s79
    v_cvt_pk_bf16_f32 v33, v34, v35
    v_accvgpr_write_b32 a90, v32
    v_mfma_f32_16x16x32_bf16 v[144:147], a[200:203], a[8:11], 0
    s_cmp_gt_u32 s78, 3
    s_cbranch_scc1 spin_o2
spin_o2_ret:
    v_accvgpr_write_b32 a91, v33
    v_mfma_f32_16x16x32_bf16 v[144:147], a[204:207], a[24:27], v[144:147]
    buffer_store_dwordx4 a[88:91], v14, s[20:23], s55 offen offset:2048 sc1
    v_mul_f32 v37, v19, v37
    v_mfma_f32_16x16x32_bf16 v[152:155], a[204:207], a[28:31], 0
    s_add_u32 s37, s59, 8192
    v_mul_f32 v38, v19, v38
    v_mul_f32 v39, v19, v39
    v_mfma_f32_16x16x32_bf16 v[152:155], a[200:203], a[12:15], v[152:155]
    buffer_load_dwordx4 a[128:131], v14, s[20:23], s37 offen offset:0 sc1
    v_mfma_f32_16x16x32_bf16 v[156:159], a[208:211], a[12:15], 0
    ds_read_b64_tr_b16 a[200:201], v8 offset:4096
    v_cvt_pk_bf16_f32 v36, v36, v37
    v_mfma_f32_16x16x32_bf16 v[156:159], a[212:215], a[28:31], v[156:159]
    ds_read_b64_tr_b16 a[202:203], v8 offset:6144
    v_cvt_pk_bf16_f32 v37, v38, v39
    v_mfma_f32_16x16x32_bf16 v[148:151], a[212:215], a[24:27], 0
    ds_read_b64_tr_b16 a[204:205], v8 offset:12288
    v_accvgpr_write_b32 a94, v36
    v_mfma_f32_16x16x32_bf16 v[148:151], a[208:211], a[8:11], v[148:151]
    s_waitcnt lgkmcnt(3)
    ds_read_b64_tr_b16 a[206:207], v8 offset:14336
    v_subrev_u32 v8, 139264, v8
    v_mfma_f32_16x16x32_bf16 v[140:143], a[208:211], a[4:7], 0
    v_accvgpr_write_b32 a95, v37
    v_mfma_f32_16x16x32_bf16 v[140:143], a[212:215], a[20:23], v[140:143]
    buffer_store_dwordx4 a[92:95], v14, s[20:23], s55 offen offset:3072 sc1
    v_mfma_f32_16x16x32_bf16 v[132:135], a[212:215], a[16:19], 0
    buffer_load_dwordx4 a[132:135], v14, s[20:23], s37 offen offset:1024 sc1
    v_mfma_f32_16x16x32_bf16 v[132:135], a[208:211], a[0:3], v[132:135]
    s_add_u32 s55, s55, 4096
    ds_read_b64_tr_b16 a[208:209], v9 offset:4096
    v_mfma_f32_16x16x32_bf16 v[160:163], a[184:187], a[0:3], 0
    ds_read_b64_tr_b16 a[210:211], v9 offset:6144
    v_mfma_f32_16x16x32_bf16 v[160:163], a[188:191], a[16:19], v[160:163]
    ds_read_b64_tr_b16 a[212:213], v9 offset:12288
    v_mfma_f32_16x16x32_bf16 v[168:171], a[188:191], a[20:23], 0
    ds_read_b64_tr_b16 a[214:215], v9 offset:14336
    v_subrev_u32 v9, 139264, v9
    v_mfma_f32_16x16x32_bf16 v[168:171], a[184:187], a[4:7], v[168:171]
    v_mfma_f32_16x16x32_bf16 v[176:179], a[184:187], a[8:11], 0
    v_mfma_f32_16x16x32_bf16 v[176:179], a[188:191], a[24:27], v[176:179]
    v_mfma_f32_16x16x32_bf16 v[184:187], a[188:191], a[28:31], 0
    v_mfma_f32_16x16x32_bf16 v[184:187], a[184:187], a[12:15], v[184:187]
    ds_read_b64_tr_b16 a[184:185], v10 offset:4096
    v_mfma_f32_16x16x32_bf16 v[188:191], a[192:195], a[12:15], 0
    buffer_load_dwordx4 a[136:139], v14, s[20:23], s37 offen offset:2048 sc1
    v_mfma_f32_16x16x32_bf16 v[188:191], a[196:199], a[28:31], v[188:191]
    ds_read_b64_tr_b16 a[186:187], v10 offset:6144
    v_mfma_f32_16x16x32_bf16 v[180:183], a[196:199], a[24:27], 0
    ds_read_b64_tr_b16 a[188:189], v10 offset:12288
    v_mfma_f32_16x16x32_bf16 v[180:183], a[192:195], a[8:11], v[180:183]
    s_waitcnt lgkmcnt(3)
    ds_read_b64_tr_b16 a[190:191], v10 offset:14336
    v_subrev_u32 v10, 139264, v10
    v_mfma_f32_16x16x32_bf16 v[172:175], a[192:195], a[4:7], 0
    s_add_u32 m0, s43, 114688
    v_mfma_f32_16x16x32_bf16 v[172:175], a[196:199], a[20:23], v[172:175]
    v_mfma_f32_16x16x32_bf16 v[164:167], a[196:199], a[16:19], 0
    v_mfma_f32_16x16x32_bf16 v[164:167], a[192:195], a[0:3], v[164:167]
    ds_read_b64_tr_b16 a[192:193], v11 offset:4096
    v_mfma_f32_16x16x32_bf16 v[192:195], a[200:203], a[0:3], 0
    ds_read_b64_tr_b16 a[194:195], v11 offset:6144
    v_mfma_f32_16x16x32_bf16 v[192:195], a[204:207], a[16:19], v[192:195]
    ds_read_b64_tr_b16 a[196:197], v11 offset:12288
    v_mfma_f32_16x16x32_bf16 v[200:203], a[204:207], a[20:23], 0
    buffer_load_dwordx4 a[140:143], v14, s[20:23], s37 offen offset:3072 sc1
    v_mfma_f32_16x16x32_bf16 v[200:203], a[200:203], a[4:7], v[200:203]
    ds_read_b64_tr_b16 a[198:199], v11 offset:14336
    v_subrev_u32 v11, 139264, v11
    v_mfma_f32_16x16x32_bf16 v[208:211], a[200:203], a[8:11], 0
    buffer_load_dwordx4 v22, s[28:31], s41 offen lds
    v_mfma_f32_16x16x32_bf16 v[208:211], a[204:207], a[24:27], v[208:211]
    v_mfma_f32_16x16x32_bf16 v[216:219], a[204:207], a[28:31], 0
    v_add_u32 v21, 61440, v14
    v_mfma_f32_16x16x32_bf16 v[216:219], a[200:203], a[12:15], v[216:219]
    v_mfma_f32_16x16x32_bf16 v[220:223], a[208:211], a[12:15], 0
    s_addk_i32 m0, 1024
    v_mfma_f32_16x16x32_bf16 v[220:223], a[212:215], a[28:31], v[220:223]
    s_waitcnt vmcnt(18) lgkmcnt(0)
    v_mfma_f32_16x16x32_bf16 v[212:215], a[212:215], a[24:27], 0
    s_barrier
    v_mfma_f32_16x16x32_bf16 v[212:215], a[208:211], a[8:11], v[212:215]
    ds_read_b64_tr_b16 a[200:201], v12 offset:0
    v_mfma_f32_16x16x32_bf16 v[204:207], a[208:211], a[4:7], 0
    ds_read_b64_tr_b16 a[202:203], v12 offset:1024
    v_mfma_f32_16x16x32_bf16 v[204:207], a[212:215], a[20:23], v[204:207]
    ds_read_b64_tr_b16 a[204:205], v12 offset:2048
    v_mfma_f32_16x16x32_bf16 v[196:199], a[212:215], a[16:19], 0
    buffer_load_dwordx4 v23, s[28:31], s41 offen lds
    v_mfma_f32_16x16x32_bf16 v[196:199], a[208:211], a[0:3], v[196:199]
    s_mov_b64 s[28:29], 0
    ds_read_b64_tr_b16 a[206:207], v12 offset:3072
    v_mfma_f32_16x16x32_bf16 v[224:227], a[184:187], a[0:3], 0
    s_mov_b64 s[30:31], 0
    ds_read_b64_tr_b16 a[208:209], v13 offset:0
    v_mfma_f32_16x16x32_bf16 v[224:227], a[188:191], a[16:19], v[224:227]
    s_mov_b64 s[32:33], 0
    ds_read_b64_tr_b16 a[210:211], v13 offset:1024
    v_mfma_f32_16x16x32_bf16 v[232:235], a[188:191], a[20:23], 0
    s_add_u32 s38, s45, 40960
    ds_read_b64_tr_b16 a[212:213], v13 offset:2048
    s_add_u32 s36, s44, 204800
    v_mfma_f32_16x16x32_bf16 v[232:235], a[184:187], a[4:7], v[232:235]
    s_cmp_lt_u32 s3, 2
    s_cselect_b32 s38, s38, s36
    v_mfma_f32_16x16x32_bf16 v[240:243], a[184:187], a[8:11], 0
    s_add_u32 m0, s63, 90112
    ds_read_b64_tr_b16 a[214:215], v13 offset:3072
    v_mfma_f32_16x16x32_bf16 v[240:243], a[188:191], a[24:27], v[240:243]
    s_mov_b64 s[34:35], 0
    ds_read_b128 v[56:59], v21 offset:0
    v_mfma_f32_16x16x32_bf16 v[248:251], a[188:191], a[28:31], 0
    ds_read_b128 v[60:63], v21 offset:1024
    v_mfma_f32_16x16x32_bf16 v[248:251], a[184:187], a[12:15], v[248:251]
    ds_read_b128 v[64:67], v21 offset:2048
    v_mfma_f32_16x16x32_bf16 v[252:255], a[192:195], a[12:15], 0
    s_waitcnt lgkmcnt(5)
    ds_read_b64_tr_b16 a[184:185], v8 offset:0
    s_load_dwordx4 s[72:75], s[86:87], s5 glc
    v_mfma_f32_16x16x32_bf16 v[252:255], a[196:199], a[28:31], v[252:255]
    ds_read_b64_tr_b16 a[186:187], v8 offset:2048
    v_mfma_f32_16x16x32_bf16 v[244:247], a[196:199], a[24:27], 0
    buffer_load_dwordx4 v7, s[8:11], s38 offen lds
    v_mfma_f32_16x16x32_bf16 v[244:247], a[192:195], a[8:11], v[244:247]
    s_add_u32 s37, s60, 8192
    ds_read_b64_tr_b16 a[188:189], v8 offset:8192
    v_mfma_f32_16x16x32_bf16 v[236:239], a[192:195], a[4:7], 0
    ds_read_b64_tr_b16 a[190:191], v8 offset:10240
    v_mfma_f32_16x16x32_bf16 v[236:239], a[196:199], a[20:23], v[236:239]
    s_waitcnt lgkmcnt(5)
    ds_read_b128 v[68:71], v21 offset:3072
    v_add_f32 v56, v56, v60
    v_mfma_f32_16x16x32_bf16 v[228:231], a[196:199], a[16:19], 0
    s_add_u32 s38, s45, 40960
    ds_read_b128 v[72:75], v21 offset:4096
    v_add_f32 v57, v57, v61
    v_mfma_f32_16x16x32_bf16 v[228:231], a[192:195], a[0:3], v[228:231]
    s_waitcnt lgkmcnt(6)
    ds_read_b128 v[76:79], v21 offset:5120
    v_add_f32 v58, v58, v62
    v_mfma_f32_16x16x32_bf16 v[96:99], a[200:203], a[32:35], v[96:99]
    buffer_load_dwordx4 a[0:3], v14, s[20:23], s37 offen offset:0 sc1
    v_mfma_f32_16x16x32_bf16 v[96:99], a[204:207], a[48:51], v[96:99]
    s_add_u32 m0, s63, 73728
    ds_read_b64_tr_b16 a[192:193], v9 offset:0
    v_add_f32 v59, v59, v63
    v_mfma_f32_16x16x32_bf16 v[104:107], a[204:207], a[52:55], v[104:107]
pg_12:
    s_cbranch_execz pg_14
    ds_read_b64_tr_b16 a[194:195], v9 offset:2048
    v_add_f32 v56, v56, v64
    v_mfma_f32_16x16x32_bf16 v[104:107], a[200:203], a[36:39], v[104:107]
    ds_read_b64_tr_b16 a[196:197], v9 offset:8192
    v_add_f32 v57, v57, v65
    v_mfma_f32_16x16x32_bf16 v[112:115], a[200:203], a[40:43], v[112:115]
    s_waitcnt lgkmcnt(5)
    ds_read_b64_tr_b16 a[198:199], v9 offset:10240
    v_add_f32 v58, v58, v66
    v_mfma_f32_16x16x32_bf16 v[112:115], a[204:207], a[56:59], v[112:115]
    ds_read_b128 v[80:83], v21 offset:6144
    v_add_f32 v59, v59, v67
    v_mfma_f32_16x16x32_bf16 v[120:123], a[204:207], a[60:63], v[120:123]
    buffer_load_dwordx4 v2, s[8:11], s38 offen lds
    v_mfma_f32_16x16x32_bf16 v[120:123], a[200:203], a[44:47], v[120:123]
    ds_read_b128 v[84:87], v21 offset:7168
    v_add_f32 v56, v56, v68
    v_mfma_f32_16x16x32_bf16 v[124:127], a[208:211], a[44:47], v[124:127]
    s_waitcnt lgkmcnt(7)
    ds_read_b64_tr_b16 a[200:201], v10 offset:0
    v_add_f32 v57, v57, v69
    v_mfma_f32_16x16x32_bf16 v[124:127], a[212:215], a[60:63], v[124:127]
    s_waitcnt vmcnt(8)
    ds_read_b64_tr_b16 a[202:203], v10 offset:2048
    v_add_f32 v58, v58, v70
    v_mfma_f32_16x16x32_bf16 v[116:119], a[212:215], a[56:59], v[116:119]
    buffer_store_dword v55, v15, s[24:27], s76 offen sc1
    v_mfma_f32_16x16x32_bf16 v[116:119], a[208:211], a[40:43], v[116:119]
    buffer_load_dwordx4 a[4:7], v14, s[20:23], s37 offen offset:1024 sc1
    v_mfma_f32_16x16x32_bf16 v[108:111], a[208:211], a[36:39], v[108:111]
    s_add_u32 s38, s45, 40960
    ds_read_b64_tr_b16 a[204:205], v10 offset:8192
    v_add_f32 v59, v59, v71
    v_mfma_f32_16x16x32_bf16 v[108:111], a[212:215], a[52:55], v[108:111]
    s_addk_i32 m0, 4096
    ds_read_b64_tr_b16 a[206:207], v10 offset:10240
    v_add_f32 v56, v56, v72
    v_mfma_f32_16x16x32_bf16 v[100:103], a[212:215], a[48:51], v[100:103]
    s_waitcnt lgkmcnt(6)
    ds_read_b128 v[88:91], v21 offset:8192
    v_add_f32 v57, v57, v73
    v_mfma_f32_16x16x32_bf16 v[100:103], a[208:211], a[32:35], v[100:103]
    ds_read_b128 v[92:95], v21 offset:9216
    v_add_f32 v58, v58, v74
    v_mfma_f32_16x16x32_bf16 v[128:131], a[184:187], a[32:35], v[128:131]
    ds_read_b64_tr_b16 a[208:209], v11 offset:0
    v_add_f32 v59, v59, v75
    v_mfma_f32_16x16x32_bf16 v[128:131], a[188:191], a[48:51], v[128:131]
    ds_read_b64_tr_b16 a[210:211], v11 offset:2048
    v_add_f32 v56, v56, v76
    v_mfma_f32_16x16x32_bf16 v[136:139], a[188:191], a[52:55], v[136:139]
    buffer_load_dwordx4 v3, s[8:11], s38 offen lds
    v_mfma_f32_16x16x32_bf16 v[136:139], a[184:187], a[36:39], v[136:139]
    s_waitcnt lgkmcnt(7)
    ds_read_b64_tr_b16 a[212:213], v11 offset:8192
    v_add_f32 v57, v57, v77
    v_mfma_f32_16x16x32_bf16 v[144:147], a[184:187], a[40:43], v[144:147]
    buffer_load_dwordx4 a[8:11], v14, s[20:23], s37 offen offset:2048 sc1
    v_mfma_f32_16x16x32_bf16 v[144:147], a[188:191], a[56:59], v[144:147]
    ds_read_b64_tr_b16 a[214:215], v11 offset:10240
    v_add_f32 v58, v58, v78
    v_mfma_f32_16x16x32_bf16 v[152:155], a[188:191], a[60:63], v[152:155]
    s_add_u32 s38, s44, 204800
    v_add_f32 v59, v59, v79
    v_add_f32 v56, v56, v80
    v_mfma_f32_16x16x32_bf16 v[152:155], a[184:187], a[44:47], v[152:155]
    ds_read_b64_tr_b16 a[184:185], v8 offset:4096
    v_add_f32 v57, v57, v81
    v_mfma_f32_16x16x32_bf16 v[156:159], a[192:195], a[44:47], v[156:159]
    s_addk_i32 m0, 4096
    ds_read_b64_tr_b16 a[186:187], v8 offset:6144
    v_add_f32 v58, v58, v82
    v_mfma_f32_16x16x32_bf16 v[156:159], a[196:199], a[60:63], v[156:159]
    s_waitcnt lgkmcnt(6)
    ds_read_b64_tr_b16 a[188:189], v8 offset:12288
    v_add_f32 v59, v59, v83
    v_mfma_f32_16x16x32_bf16 v[148:151], a[196:199], a[56:59], v[148:151]
    ds_read_b64_tr_b16 a[190:191], v8 offset:14336
    v_add_f32 v56, v56, v84
    v_mfma_f32_16x16x32_bf16 v[148:151], a[192:195], a[40:43], v[148:151]
    v_add_f32 v57, v57, v85
    v_add_f32 v58, v58, v86
    v_mfma_f32_16x16x32_bf16 v[140:143], a[192:195], a[36:39], v[140:143]
    v_add_f32 v59, v59, v87
    v_add_f32 v56, v56, v88
    v_mfma_f32_16x16x32_bf16 v[140:143], a[196:199], a[52:55], v[140:143]
    v_add_f32 v57, v57, v89
    v_add_f32 v58, v58, v90
    v_mfma_f32_16x16x32_bf16 v[132:135], a[196:199], a[48:51], v[132:135]
    buffer_load_dwordx4 a[12:15], v14, s[20:23], s37 offen offset:3072 sc1
    v_mfma_f32_16x16x32_bf16 v[132:135], a[192:195], a[32:35], v[132:135]
    buffer_load_dwordx4 v2, s[8:11], s38 offen lds
    v_mfma_f32_16x16x32_bf16 v[160:163], a[200:203], a[32:35], v[160:163]
    ds_read_b64_tr_b16 a[192:193], v9 offset:4096
    v_add_f32 v59, v59, v91
    v_mfma_f32_16x16x32_bf16 v[160:163], a[204:207], a[48:51], v[160:163]
    ds_read_b64_tr_b16 a[194:195], v9 offset:6144
    v_add_f32 v56, v56, v92
    v_mfma_f32_16x16x32_bf16 v[168:171], a[204:207], a[52:55], v[168:171]
    s_add_u32 s37, s61, 8192
    ds_read_b64_tr_b16 a[196:197], v9 offset:12288
    v_add_f32 v57, v57, v93
    v_mfma_f32_16x16x32_bf16 v[168:171], a[200:203], a[36:39], v[168:171]
    s_waitcnt lgkmcnt(5)
    ds_read_b64_tr_b16 a[198:199], v9 offset:14336
    v_add_f32 v58, v58, v94
    v_mfma_f32_16x16x32_bf16 v[176:179], a[200:203], a[40:43], v[176:179]
    s_add_u32 s38, s44, 204800
    v_add_f32 v59, v59, v95
    v_cvt_pk_bf16_f32 v56, 0, v56
    v_mfma_f32_16x16x32_bf16 v[176:179], a[204:207], a[56:59], v[176:179]
    s_addk_i32 m0, 4096
    v_cvt_pk_bf16_f32 v57, 0, v57
    v_cvt_pk_bf16_f32 v58, 0, v58
    v_mfma_f32_16x16x32_bf16 v[184:187], a[204:207], a[60:63], v[184:187]
    v_cvt_pk_bf16_f32 v59, 0, v59
    v_mul_f32 v60, s92, v56
    v_mfma_f32_16x16x32_bf16 v[184:187], a[200:203], a[44:47], v[184:187]
    ds_read_b64_tr_b16 a[200:201], v10 offset:4096
    v_mul_f32 v61, s92, v57
    v_mfma_f32_16x16x32_bf16 v[188:191], a[208:211], a[44:47], v[188:191]
    buffer_load_dwordx4 a[16:19], v14, s[20:23], s37 offen offset:0 sc1
    v_mfma_f32_16x16x32_bf16 v[188:191], a[212:215], a[60:63], v[188:191]
    ds_read_b64_tr_b16 a[202:203], v10 offset:6144
    v_lshlrev_b32 v64, 1, v1
    v_mfma_f32_16x16x32_bf16 v[180:183], a[212:215], a[56:59], v[180:183]
    buffer_load_dwordx4 v3, s[8:11], s38 offen lds
    v_mfma_f32_16x16x32_bf16 v[180:183], a[208:211], a[40:43], v[180:183]
    ds_read_b64_tr_b16 a[204:205], v10 offset:12288
    v_add_u32 v64, s56, v64
    v_mfma_f32_16x16x32_bf16 v[172:175], a[208:211], a[36:39], v[172:175]
    ds_read_b64_tr_b16 a[206:207], v10 offset:14336
    v_and_b32 v65, 1, v1
    v_mfma_f32_16x16x32_bf16 v[172:175], a[212:215], a[52:55], v[172:175]
    v_exp_f32 v60, v60
    v_mfma_f32_16x16x32_bf16 v[164:167], a[212:215], a[48:51], v[164:167]
    s_waitcnt lgkmcnt(3)
    v_exp_f32 v61, v61
    v_mfma_f32_16x16x32_bf16 v[164:167], a[208:211], a[32:35], v[164:167]
    s_add_u32 s38, s46, 40960
    ds_read_b64_tr_b16 a[208:209], v11 offset:4096
    v_add_f32 v60, 1.0, v60
    v_mfma_f32_16x16x32_bf16 v[192:195], a[184:187], a[32:35], v[192:195]
    s_add_u32 s36, s47, 40960
    ds_read_b64_tr_b16 a[210:211], v11 offset:6144
    v_add_f32 v61, 1.0, v61
    v_mfma_f32_16x16x32_bf16 v[192:195], a[188:191], a[48:51], v[192:195]
    s_cmp_lt_u32 s3, 2
    s_cselect_b32 s38, s38, s36
    v_lshlrev_b32 v65, 7, v65
    v_mfma_f32_16x16x32_bf16 v[200:203], a[188:191], a[52:55], v[200:203]
    s_addk_i32 m0, 24576
    ds_read_b64_tr_b16 a[212:213], v11 offset:12288
    v_lshrrev_b32 v67, 4, v1
    v_mfma_f32_16x16x32_bf16 v[200:203], a[184:187], a[36:39], v[200:203]
    s_add_u32 s77, s7, 4
    ds_read_b64_tr_b16 a[214:215], v11 offset:14336
    v_lshl_add_u32 v65, v67, 4, v65
    v_mfma_f32_16x16x32_bf16 v[208:211], a[184:187], a[40:43], v[208:211]
    buffer_load_dwordx4 a[20:23], v14, s[20:23], s37 offen offset:1024 sc1
    v_mfma_f32_16x16x32_bf16 v[208:211], a[188:191], a[56:59], v[208:211]
    v_rcp_f32 v60, v60
    v_mfma_f32_16x16x32_bf16 v[216:219], a[188:191], a[60:63], v[216:219]
    buffer_load_dwordx4 v7, s[8:11], s38 offen lds
    v_mfma_f32_16x16x32_bf16 v[216:219], a[184:187], a[44:47], v[216:219]
    v_rcp_f32 v61, v61
    v_mfma_f32_16x16x32_bf16 v[220:223], a[192:195], a[44:47], v[220:223]
    v_mul_f32 v56, v56, v60
    v_cvt_pk_bf16_f32 v56, 0, v56
    v_mfma_f32_16x16x32_bf16 v[220:223], a[196:199], a[60:63], v[220:223]
    s_waitcnt lgkmcnt(0)
    v_mul_f32 v56, v56, v58
    v_mul_f32 v57, v57, v61
    v_mfma_f32_16x16x32_bf16 v[212:215], a[196:199], a[56:59], v[212:215]
    s_barrier
    v_mfma_f32_16x16x32_bf16 v[212:215], a[192:195], a[40:43], v[212:215]
    s_add_u32 s38, s46, 40960
    ds_read_b64_tr_b16 a[184:185], v12 offset:20480
    v_cvt_pk_bf16_f32 v57, 0, v57
    v_mfma_f32_16x16x32_bf16 v[204:207], a[192:195], a[36:39], v[204:207]
    buffer_load_dwordx4 a[24:27], v14, s[20:23], s37 offen offset:2048 sc1
    v_mfma_f32_16x16x32_bf16 v[204:207], a[196:199], a[52:55], v[204:207]
    s_addk_i32 m0, -16384
    ds_read_b64_tr_b16 a[186:187], v12 offset:21504
    v_mul_f32 v57, v57, v59
    v_mfma_f32_16x16x32_bf16 v[196:199], a[196:199], a[48:51], v[196:199]
    ds_read_b64_tr_b16 a[188:189], v12 offset:22528
    v_cvt_pk_bf16_f32 v56, v56, v57
    v_mfma_f32_16x16x32_bf16 v[196:199], a[192:195], a[32:35], v[196:199]
    ds_write_b16 v64, v56
    v_mfma_f32_16x16x32_bf16 v[224:227], a[200:203], a[32:35], v[224:227]
    ds_write_b16_d16_hi v64, v56 offset:128
    v_mfma_f32_16x16x32_bf16 v[224:227], a[204:207], a[48:51], v[224:227]
    ds_read_b64_tr_b16 a[190:191], v12 offset:23552
    v_add_u32 v65, s56, v65
    v_mfma_f32_16x16x32_bf16 v[232:235], a[204:207], a[52:55], v[232:235]
    buffer_load_dwordx4 v2, s[8:11], s38 offen lds
    v_mfma_f32_16x16x32_bf16 v[232:235], a[200:203], a[36:39], v[232:235]
    ds_read_b128 v[68:71], v65
    v_bfe_u32 v67, v1, 2, 3
    v_mfma_f32_16x16x32_bf16 v[240:243], a[200:203], a[40:43], v[240:243]
    ds_read_b128 v[72:75], v65 offset:64
    v_lshlrev_b32 v66, 7, v67
    v_mfma_f32_16x16x32_bf16 v[240:243], a[204:207], a[56:59], v[240:243]
    ds_read_b64_tr_b16 a[192:193], v13 offset:20480
    v_lshrrev_b32 v67, 1, v67
    v_mfma_f32_16x16x32_bf16 v[248:251], a[204:207], a[60:63], v[248:251]
    buffer_load_dwordx4 a[28:31], v14, s[20:23], s37 offen offset:3072 sc1
    v_mfma_f32_16x16x32_bf16 v[248:251], a[200:203], a[44:47], v[248:251]
    s_add_u32 s38, s46, 40960
    ds_read_b64_tr_b16 a[194:195], v13 offset:21504
    v_xor_b32 v67, s3, v67
    v_mfma_f32_16x16x32_bf16 v[252:255], a[208:211], a[44:47], v[252:255]
    s_addk_i32 m0, 4096
    ds_read_b64_tr_b16 a[196:197], v13 offset:22528
    v_lshl_add_u32 v66, v67, 5, v66
    v_mfma_f32_16x16x32_bf16 v[252:255], a[212:215], a[60:63], v[252:255]
    s_waitcnt lgkmcnt(5)
    ds_read_b64_tr_b16 a[198:199], v13 offset:23552
    v_and_b32 v67, 3, v1
    v_mfma_f32_16x16x32_bf16 v[244:247], a[212:215], a[56:59], v[244:247]
    s_sub_u32 s78, s72, s77
    ds_read_b64_tr_b16 a[200:201], v8 offset:20480
    v_lshl_add_u32 v66, v67, 3, v66
    v_mfma_f32_16x16x32_bf16 v[244:247], a[208:211], a[40:43], v[244:247]
    s_sub_u32 s79, s73, s77
    ds_read_b64_tr_b16 a[202:203], v8 offset:22528
    v_lshrrev_b32 v67, 5, v1
    v_mfma_f32_16x16x32_bf16 v[236:239], a[208:211], a[36:39], v[236:239]
    s_max_u32 s78, s78, s79
    ds_read_b64_tr_b16 a[204:205], v8 offset:28672
    v_mul_u32_u24 v67, 1024, v67
    v_mfma_f32_16x16x32_bf16 v[236:239], a[212:215], a[52:55], v[236:239]
    s_sub_u32 s79, s74, s77
    ds_read_b64_tr_b16 a[206:207], v8 offset:30720
    v_add_u32 v66, v66, v67
    v_mfma_f32_16x16x32_bf16 v[228:231], a[212:215], a[48:51], v[228:231]
    buffer_load_dwordx4 v3, s[8:11], s38 offen lds
    v_mfma_f32_16x16x32_bf16 v[228:231], a[208:211], a[32:35], v[228:231]
    s_max_u32 s78, s78, s79
    ds_read_b64_tr_b16 a[208:209], v9 offset:20480
    v_add_u32 v66, 114688, v66
    v_mfma_f32_16x16x32_bf16 v[96:99], a[184:187], a[64:67], v[96:99]
    s_waitcnt lgkmcnt(5)
    ds_read_b64_tr_b16 a[210:211], v9 offset:22528
    v_lshlrev_b32 v62, 2, v1
    v_mfma_f32_16x16x32_bf16 v[96:99], a[188:191], a[216:219], v[96:99]
    s_sub_u32 s79, s75, s77
    ds_read_b64_tr_b16 a[212:213], v9 offset:28672
    v_mov_b32 v67, 0x7ffffff0
    v_mfma_f32_16x16x32_bf16 v[104:107], a[188:191], a[220:223], v[104:107]
    s_max_u32 s78, s78, s79
    ds_read_b64_tr_b16 a[214:215], v9 offset:30720
    v_cndmask_b32 v62, v67, v62, vcc
    v_mfma_f32_16x16x32_bf16 v[104:107], a[184:187], a[68:71], v[104:107]
    s_cmp_gt_u32 s78, 2
    s_cbranch_scc1 spin_o3
spin_o3_ret:
    s_load_dwordx4 s[72:75], s[86:87], s5 glc
    v_mfma_f32_16x16x32_bf16 v[112:115], a[184:187], a[72:75], v[112:115]
    s_add_u32 s37, s59, 12288
    s_add_u32 s38, s47, 40960
    s_add_u32 m0, s63, 102400
    v_mfma_f32_16x16x32_bf16 v[112:115], a[188:191], a[224:227], v[112:115]
    buffer_load_dwordx4 a[32:35], v14, s[20:23], s37 offen offset:0 sc1
    v_mfma_f32_16x16x32_bf16 v[120:123], a[188:191], a[228:231], v[120:123]
    v_mfma_f32_16x16x32_bf16 v[120:123], a[184:187], a[76:79], v[120:123]
    ds_read_b64_tr_b16 a[184:185], v10 offset:20480
    v_mfma_f32_16x16x32_bf16 v[124:127], a[192:195], a[76:79], v[124:127]
    ds_read_b64_tr_b16 a[186:187], v10 offset:22528
    v_mfma_f32_16x16x32_bf16 v[124:127], a[196:199], a[228:231], v[124:127]
    ds_read_b64_tr_b16 a[188:189], v10 offset:28672
    v_mfma_f32_16x16x32_bf16 v[116:119], a[196:199], a[224:227], v[116:119]
    s_waitcnt lgkmcnt(5)
    ds_read_b64_tr_b16 a[190:191], v10 offset:30720
    v_mfma_f32_16x16x32_bf16 v[116:119], a[192:195], a[72:75], v[116:119]
    buffer_load_dwordx4 a[36:39], v14, s[20:23], s37 offen offset:1024 sc1
    v_mfma_f32_16x16x32_bf16 v[108:111], a[192:195], a[68:71], v[108:111]
    buffer_load_dwordx4 v2, s[8:11], s38 offen lds
    v_mfma_f32_16x16x32_bf16 v[108:111], a[196:199], a[220:223], v[108:111]
    v_mfma_f32_16x16x32_bf16 v[100:103], a[196:199], a[216:219], v[100:103]
    s_add_u32 s38, s47, 40960
    v_mfma_f32_16x16x32_bf16 v[100:103], a[192:195], a[64:67], v[100:103]
    ds_read_b64_tr_b16 a[192:193], v11 offset:20480
    v_mfma_f32_16x16x32_bf16 v[128:131], a[200:203], a[64:67], v[128:131]
    s_addk_i32 m0, 4096
    ds_read_b64_tr_b16 a[194:195], v11 offset:22528
    v_mfma_f32_16x16x32_bf16 v[128:131], a[204:207], a[216:219], v[128:131]
    ds_read_b64_tr_b16 a[196:197], v11 offset:28672
    v_mfma_f32_16x16x32_bf16 v[136:139], a[204:207], a[220:223], v[136:139]
    ds_read_b64_tr_b16 a[198:199], v11 offset:30720
    v_mfma_f32_16x16x32_bf16 v[136:139], a[200:203], a[68:71], v[136:139]
    v_mfma_f32_16x16x32_bf16 v[144:147], a[200:203], a[72:75], v[144:147]
    buffer_load_dwordx4 a[40:43], v14, s[20:23], s37 offen offset:2048 sc1
    v_mfma_f32_16x16x32_bf16 v[144:147], a[204:207], a[224:227], v[144:147]
    v_mfma_f32_16x16x32_bf16 v[152:155], a[204:207], a[228:231], v[152:155]
    buffer_load_dwordx4 v3, s[8:11], s38 offen lds
    v_mfma_f32_16x16x32_bf16 v[152:155], a[200:203], a[76:79], v[152:155]
    s_waitcnt lgkmcnt(4)
    ds_read_b64_tr_b16 a[200:201], v8 offset:24576
    v_mfma_f32_16x16x32_bf16 v[156:159], a[208:211], a[76:79], v[156:159]
    ds_read_b64_tr_b16 a[202:203], v8 offset:26624
    v_mfma_f32_16x16x32_bf16 v[156:159], a[212:215], a[228:231], v[156:159]
    ds_read_b64_tr_b16 a[204:205], v8 offset:32768
    v_mfma_f32_16x16x32_bf16 v[148:151], a[212:215], a[224:227], v[148:151]
    s_add_u32 s38, s45, 81920
    ds_read_b64_tr_b16 a[206:207], v8 offset:34816
    s_add_u32 s36, s46, 81920
    v_mfma_f32_16x16x32_bf16 v[148:151], a[208:211], a[72:75], v[148:151]
    s_cmp_lt_u32 s3, 2
    s_cselect_b32 s38, s38, s36
    v_mfma_f32_16x16x32_bf16 v[140:143], a[208:211], a[68:71], v[140:143]
    s_add_u32 m0, s63, 139264
    v_mfma_f32_16x16x32_bf16 v[140:143], a[212:215], a[220:223], v[140:143]
    v_mfma_f32_16x16x32_bf16 v[132:135], a[212:215], a[216:219], v[132:135]
    buffer_load_dwordx4 a[44:47], v14, s[20:23], s37 offen offset:3072 sc1
    v_mfma_f32_16x16x32_bf16 v[132:135], a[208:211], a[64:67], v[132:135]
    ds_read_b64_tr_b16 a[208:209], v9 offset:24576
    v_mfma_f32_16x16x32_bf16 v[160:163], a[184:187], a[64:67], v[160:163]
    ds_read_b64_tr_b16 a[210:211], v9 offset:26624
    v_mfma_f32_16x16x32_bf16 v[160:163], a[188:191], a[216:219], v[160:163]
    ds_read_b64_tr_b16 a[212:213], v9 offset:32768
    v_mfma_f32_16x16x32_bf16 v[168:171], a[188:191], a[220:223], v[168:171]
    s_waitcnt lgkmcnt(5)
    ds_read_b64_tr_b16 a[214:215], v9 offset:34816
    s_add_u32 s37, s60, 12288
    v_mfma_f32_16x16x32_bf16 v[168:171], a[184:187], a[68:71], v[168:171]
    buffer_load_dwordx4 v7, s[8:11], s38 offen lds
    v_mfma_f32_16x16x32_bf16 v[176:179], a[184:187], a[72:75], v[176:179]
    v_mfma_f32_16x16x32_bf16 v[176:179], a[188:191], a[224:227], v[176:179]
    v_mfma_f32_16x16x32_bf16 v[184:187], a[188:191], a[228:231], v[184:187]
    v_mfma_f32_16x16x32_bf16 v[184:187], a[184:187], a[76:79], v[184:187]
    ds_read_b64_tr_b16 a[184:185], v10 offset:24576
    v_mfma_f32_16x16x32_bf16 v[188:191], a[192:195], a[76:79], v[188:191]
    buffer_load_dwordx4 a[48:51], v14, s[20:23], s37 offen offset:0 sc1
    v_mfma_f32_16x16x32_bf16 v[188:191], a[196:199], a[228:231], v[188:191]
    s_mov_b32 s16, s84
    ds_read_b64_tr_b16 a[186:187], v10 offset:26624
    v_and_b32 v5, 15, v1
    v_mfma_f32_16x16x32_bf16 v[180:183], a[196:199], a[224:227], v[180:183]
    s_and_b32 s17, s85, 0xffff
    ds_read_b64_tr_b16 a[188:189], v10 offset:32768
    v_add_u32 v5, s6, v5
    v_mfma_f32_16x16x32_bf16 v[180:183], a[192:195], a[72:75], v[180:183]
    s_mov_b32 s18, 2621440
    ds_read_b64_tr_b16 a[190:191], v10 offset:34816
    v_bfe_u32 v50, v1, 4, 1
    v_mfma_f32_16x16x32_bf16 v[172:175], a[192:195], a[68:71], v[172:175]
    s_mov_b32 s19, 0x00020000
    v_bfe_u32 v51, v1, 5, 1
    v_lshl_add_u32 v50, v50, 1, v51
    v_mfma_f32_16x16x32_bf16 v[172:175], a[196:199], a[220:223], v[172:175]
    s_and_b32 s56, s53, 4
    v_mul_u32_u24 v4, 1280, v5
    v_lshl_add_u32 v4, v50, 4, v4
    v_mfma_f32_16x16x32_bf16 v[164:167], a[196:199], a[216:219], v[164:167]
    s_waitcnt lgkmcnt(5)
    v_xor_b32 v51, 16, v5
    v_mul_u32_u24 v35, 1280, v51
    v_mfma_f32_16x16x32_bf16 v[164:167], a[192:195], a[64:67], v[164:167]
    s_add_u32 s38, s47, 81920
    ds_read_b64_tr_b16 a[192:193], v11 offset:24576
    v_lshl_add_u32 v34, v50, 4, v35
    v_mfma_f32_16x16x32_bf16 v[192:195], a[200:203], a[64:67], v[192:195]
    s_add_u32 s36, s45, 122880
    ds_read_b64_tr_b16 a[194:195], v11 offset:26624
    v_and_b32 v51, 0xfffffff7, v51
    v_mfma_f32_16x16x32_bf16 v[192:195], a[204:207], a[216:219], v[192:195]
    s_cmp_lt_u32 s3, 2
    s_cselect_b32 s38, s38, s36
    v_lshrrev_b32 v50, 4, v1
    v_mfma_f32_16x16x32_bf16 v[200:203], a[204:207], a[220:223], v[200:203]
    s_addk_i32 m0, 4096
    ds_read_b64_tr_b16 a[196:197], v11 offset:32768
    s_lshl_b32 s56, s56, 1
    v_mfma_f32_16x16x32_bf16 v[200:203], a[200:203], a[68:71], v[200:203]
    ds_read_b64_tr_b16 a[198:199], v11 offset:34816
    v_or_b32 v37, s56, v51
    v_mfma_f32_16x16x32_bf16 v[208:211], a[200:203], a[72:75], v[208:211]
    buffer_load_dwordx4 a[52:55], v14, s[20:23], s37 offen offset:1024 sc1
    v_mfma_f32_16x16x32_bf16 v[208:211], a[204:207], a[224:227], v[208:211]
    s_xor_b32 s56, s56, 8
    v_mul_u32_u24 v35, 1280, v37
    v_lshl_add_u32 v35, v50, 3, v35
    v_mfma_f32_16x16x32_bf16 v[216:219], a[204:207], a[228:231], v[216:219]
    buffer_load_dwordx4 v7, s[8:11], s38 offen lds
    v_mfma_f32_16x16x32_bf16 v[216:219], a[200:203], a[76:79], v[216:219]
    s_waitcnt lgkmcnt(2)
    v_xor_b32 v50, s56, v1
    v_and_b32 v50, 8, v50
    v_mfma_f32_16x16x32_bf16 v[220:223], a[208:211], a[76:79], v[220:223]
    v_lshl_add_u32 v35, v50, 2, v35
    v_lshlrev_b32 v52, 3, v37
    v_mfma_f32_16x16x32_bf16 v[220:223], a[212:215], a[228:231], v[220:223]
    s_waitcnt vmcnt(27) lgkmcnt(0)
    v_add_u32 v52, 3211264, v52
    v_lshlrev_b32 v50, 3, v5
    v_mfma_f32_16x16x32_bf16 v[212:215], a[212:215], a[224:227], v[212:215]
    s_barrier
    v_mfma_f32_16x16x32_bf16 v[212:215], a[208:211], a[72:75], v[212:215]
    ds_read_b64_tr_b16 a[200:201], v12 offset:40960
    v_add_u32 v50, 3211264, v50
    v_mfma_f32_16x16x32_bf16 v[204:207], a[208:211], a[68:71], v[204:207]
    buffer_load_dwordx4 a[56:59], v14, s[20:23], s37 offen offset:2048 sc1
    v_mfma_f32_16x16x32_bf16 v[204:207], a[212:215], a[220:223], v[204:207]
    ds_read_b64_tr_b16 a[202:203], v12 offset:41984
    v_xor_b32 v51, 128, v50
    v_mfma_f32_16x16x32_bf16 v[196:199], a[212:215], a[216:219], v[196:199]
    ds_read_b64_tr_b16 a[204:205], v12 offset:43008
    v_mfma_f32_16x16x32_bf16 v[196:199], a[208:211], a[64:67], v[196:199]
    ds_read_b64_tr_b16 a[206:207], v12 offset:44032
    v_add_u32 v12, 73728, v12
    v_mfma_f32_16x16x32_bf16 v[224:227], a[184:187], a[64:67], v[224:227]
    ds_read_b64_tr_b16 a[208:209], v13 offset:40960
    v_mfma_f32_16x16x32_bf16 v[224:227], a[188:191], a[216:219], v[224:227]
    ds_read_b64_tr_b16 a[210:211], v13 offset:41984
    v_mfma_f32_16x16x32_bf16 v[232:235], a[188:191], a[220:223], v[232:235]
    s_add_u32 s38, s46, 122880
    ds_read_b64_tr_b16 a[212:213], v13 offset:43008
    s_add_u32 s36, s47, 122880
    v_mfma_f32_16x16x32_bf16 v[232:235], a[184:187], a[68:71], v[232:235]
    s_cmp_lt_u32 s3, 2
    s_cselect_b32 s38, s38, s36
    v_mfma_f32_16x16x32_bf16 v[240:243], a[184:187], a[72:75], v[240:243]
    s_addk_i32 m0, 4096
    ds_read_b64_tr_b16 a[214:215], v13 offset:44032
    v_add_u32 v13, 73728, v13
    v_mfma_f32_16x16x32_bf16 v[240:243], a[188:191], a[224:227], v[240:243]
    v_mfma_f32_16x16x32_bf16 v[248:251], a[188:191], a[228:231], v[248:251]
    buffer_load_dwordx4 a[60:63], v14, s[20:23], s37 offen offset:3072 sc1
    v_mfma_f32_16x16x32_bf16 v[248:251], a[184:187], a[76:79], v[248:251]
    ds_read_b64_tr_b16 a[184:185], v8 offset:40960
    v_mfma_f32_16x16x32_bf16 v[252:255], a[192:195], a[76:79], v[252:255]
    ds_read_b64_tr_b16 a[186:187], v8 offset:43008
    v_mfma_f32_16x16x32_bf16 v[252:255], a[196:199], a[228:231], v[252:255]
    ds_read_b64_tr_b16 a[188:189], v8 offset:49152
    v_mfma_f32_16x16x32_bf16 v[244:247], a[196:199], a[224:227], v[244:247]
    s_waitcnt lgkmcnt(4)
    ds_read_b64_tr_b16 a[190:191], v8 offset:51200
    s_add_u32 s37, s61, 12288
    v_mfma_f32_16x16x32_bf16 v[244:247], a[192:195], a[72:75], v[244:247]
    buffer_load_dwordx4 v7, s[8:11], s38 offen lds
    v_mfma_f32_16x16x32_bf16 v[236:239], a[192:195], a[68:71], v[236:239]
    v_mfma_f32_16x16x32_bf16 v[236:239], a[196:199], a[220:223], v[236:239]
    v_mfma_f32_16x16x32_bf16 v[228:231], a[196:199], a[216:219], v[228:231]
    v_mfma_f32_16x16x32_bf16 v[228:231], a[192:195], a[64:67], v[228:231]
    ds_read_b64_tr_b16 a[192:193], v9 offset:40960
    v_mfma_f32_16x16x32_bf16 v[96:99], a[200:203], a[232:235], v[96:99]
    buffer_load_dwordx4 a[64:67], v14, s[20:23], s37 offen offset:0 sc1
    v_mfma_f32_16x16x32_bf16 v[96:99], a[204:207], a[152:155], v[96:99]
    buffer_load_dwordx2 v[16:17], v50, s[24:27], 0 offen sc1
    v_mfma_f32_16x16x32_bf16 v[104:107], a[204:207], a[156:159], v[104:107]
    ds_read_b64_tr_b16 a[194:195], v9 offset:43008
    v_mfma_f32_16x16x32_bf16 v[104:107], a[200:203], a[236:239], v[104:107]
    ds_read_b64_tr_b16 a[196:197], v9 offset:49152
    v_mfma_f32_16x16x32_bf16 v[112:115], a[200:203], a[240:243], v[112:115]
    ds_read_b64_tr_b16 a[198:199], v9 offset:51200
    v_mfma_f32_16x16x32_bf16 v[112:115], a[204:207], a[160:163], v[112:115]
    ds_read_b64_tr_b16 v[76:77], v66 offset:0
    v_mfma_f32_16x16x32_bf16 v[120:123], a[204:207], a[164:167], v[120:123]
    s_waitcnt lgkmcnt(4)
    ds_read_b64_tr_b16 v[78:79], v66 offset:2048
    s_add_u32 s38, s45, 163840
    v_mfma_f32_16x16x32_bf16 v[120:123], a[200:203], a[244:247], v[120:123]
    s_add_u32 s36, s46, 163840
    ds_read_b64_tr_b16 v[80:81], v66 offset:4096
    v_mfma_f32_16x16x32_bf16 v[124:127], a[208:211], a[244:247], v[124:127]
    s_cmp_lt_u32 s3, 2
    s_cselect_b32 s38, s38, s36
    s_addk_i32 m0, 4096
    v_mfma_f32_16x16x32_bf16 v[124:127], a[212:215], a[164:167], v[124:127]
    ds_read_b64_tr_b16 v[82:83], v66 offset:6144
    v_mfma_f32_16x16x32_bf16 v[116:119], a[212:215], a[160:163], v[116:119]
    buffer_load_dwordx4 a[68:71], v14, s[20:23], s37 offen offset:1024 sc1
    v_mfma_f32_16x16x32_bf16 v[116:119], a[208:211], a[240:243], v[116:119]
    s_add_u32 s77, s7, 5
    ds_read_b64_tr_b16 a[200:201], v10 offset:40960
    v_mfma_f32_16x16x32_bf16 v[108:111], a[208:211], a[236:239], v[108:111]
    ds_read_b64_tr_b16 a[202:203], v10 offset:43008
    v_mfma_f32_16x16x32_bf16 v[108:111], a[212:215], a[156:159], v[108:111]
    ds_read_b64_tr_b16 a[204:205], v10 offset:49152
    v_mfma_f32_16x16x32_bf16 v[100:103], a[212:215], a[152:155], v[100:103]
    buffer_load_dwordx4 v7, s[8:11], s38 offen lds
    v_mfma_f32_16x16x32_bf16 v[100:103], a[208:211], a[232:235], v[100:103]
    buffer_load_dwordx2 v[18:19], v51, s[24:27], 0 offen sc1
    v_mfma_f32_16x16x32_bf16 v[128:131], a[184:187], a[232:235], v[128:131]
    ds_read_b64_tr_b16 a[206:207], v10 offset:51200
    v_mfma_f32_16x16x32_bf16 v[128:131], a[188:191], a[152:155], v[128:131]
    s_waitcnt lgkmcnt(4)
    ds_read_b64_tr_b16 a[208:209], v11 offset:40960
    v_mfma_f32_16x16x32_bf16 v[136:139], a[188:191], a[156:159], v[136:139]
    ds_read_b64_tr_b16 a[210:211], v11 offset:43008
    v_mfma_f32_16x16x32_bf16 v[136:139], a[184:187], a[236:239], v[136:139]
    ds_read_b64_tr_b16 a[212:213], v11 offset:49152
    v_mfma_f32_16x16x32_bf16 v[144:147], a[184:187], a[240:243], v[144:147]
    buffer_load_dwordx4 a[72:75], v14, s[20:23], s37 offen offset:2048 sc1
    v_mfma_f32_16x16x32_bf16 v[144:147], a[188:191], a[160:163], v[144:147]
    ds_read_b64_tr_b16 a[214:215], v11 offset:51200
    v_mfma_f32_16x16x32_bf16 v[152:155], a[188:191], a[164:167], v[152:155]
    v_mfma_f32_16x16x32_bf16 v[152:155], a[184:187], a[244:247], v[152:155]
    ds_read_b64_tr_b16 a[184:185], v8 offset:45056
    v_mfma_f32_16x16x32_bf16 v[156:159], a[192:195], a[244:247], v[156:159]
    ds_read_b64_tr_b16 a[186:187], v8 offset:47104
    v_mfma_f32_16x16x32_bf16 v[156:159], a[196:199], a[164:167], v[156:159]
    ds_read_b64_tr_b16 a[188:189], v8 offset:53248
    v_mfma_f32_16x16x32_bf16 v[148:151], a[196:199], a[160:163], v[148:151]
    s_waitcnt lgkmcnt(4)
    ds_read_b64_tr_b16 a[190:191], v8 offset:55296
    v_add_u32 v8, 73728, v8
    v_mfma_f32_16x16x32_bf16 v[148:151], a[192:195], a[240:243], v[148:151]
    s_add_u32 s38, s47, 163840
    s_add_u32 s36, s45, 204800
    v_mfma_f32_16x16x32_bf16 v[140:143], a[192:195], a[236:239], v[140:143]
    buffer_load_dwordx2 v[38:39], v52, s[24:27], 0 offen sc1
    v_mfma_f32_16x16x32_bf16 v[140:143], a[196:199], a[156:159], v[140:143]
    s_cmp_lt_u32 s3, 2
    s_cselect_b32 s38, s38, s36
    s_addk_i32 m0, 4096
    v_mfma_f32_16x16x32_bf16 v[132:135], a[196:199], a[152:155], v[132:135]
    buffer_load_dwordx4 a[76:79], v14, s[20:23], s37 offen offset:3072 sc1
    v_mfma_f32_16x16x32_bf16 v[132:135], a[192:195], a[232:235], v[132:135]
    s_sub_u32 s78, s72, s77
    ds_read_b64_tr_b16 a[192:193], v9 offset:45056
    s_sub_u32 s79, s73, s77
    v_mfma_f32_16x16x32_bf16 v[84:87], v[68:71], v[76:79], 0
    s_max_u32 s78, s78, s79
    ds_read_b64_tr_b16 a[194:195], v9 offset:47104
    s_sub_u32 s79, s74, s77
    v_mfma_f32_16x16x32_bf16 v[84:87], v[72:75], v[80:83], v[84:87]
    s_max_u32 s78, s78, s79
    ds_read_b64_tr_b16 a[196:197], v9 offset:53248
    s_sub_u32 s79, s75, s77
    v_mfma_f32_16x16x32_bf16 v[160:163], a[200:203], a[232:235], v[160:163]
    buffer_load_dwordx4 v7, s[8:11], s38 offen lds
    v_mfma_f32_16x16x32_bf16 v[160:163], a[204:207], a[152:155], v[160:163]
    s_max_u32 s78, s78, s79
    ds_read_b64_tr_b16 a[198:199], v9 offset:55296
    v_add_u32 v9, 73728, v9
    v_mfma_f32_16x16x32_bf16 v[168:171], a[204:207], a[156:159], v[168:171]
    buffer_store_dword v84, v62, s[24:27], s62 offen sc1
    v_mfma_f32_16x16x32_bf16 v[168:171], a[200:203], a[236:239], v[168:171]
    buffer_store_dword v85, v62, s[24:27], s62 offen offset:2560 sc1
    v_mfma_f32_16x16x32_bf16 v[176:179], a[200:203], a[240:243], v[176:179]
    s_cmp_gt_u32 s78, 1
    s_cbranch_scc1 spin_o4
spin_o4_ret:
    s_add_u32 s37, s59, 16384
    v_mfma_f32_16x16x32_bf16 v[176:179], a[204:207], a[160:163], v[176:179]
    v_mfma_f32_16x16x32_bf16 v[184:187], a[204:207], a[164:167], v[184:187]
    buffer_load_dwordx4 a[216:219], v14, s[20:23], s37 offen offset:0 sc1
    v_mfma_f32_16x16x32_bf16 v[184:187], a[200:203], a[244:247], v[184:187]
    s_waitcnt lgkmcnt(1)
    ds_read_b64_tr_b16 a[200:201], v10 offset:45056
    v_mfma_f32_16x16x32_bf16 v[188:191], a[208:211], a[244:247], v[188:191]
    buffer_load_dwordx2 v[32:33], v35, s[12:15], s68 offen
    v_mfma_f32_16x16x32_bf16 v[188:191], a[212:215], a[164:167], v[188:191]
    ds_read_b64_tr_b16 a[202:203], v10 offset:47104
    v_mfma_f32_16x16x32_bf16 v[180:183], a[212:215], a[160:163], v[180:183]
    ds_read_b64_tr_b16 a[204:205], v10 offset:53248
    v_mfma_f32_16x16x32_bf16 v[180:183], a[208:211], a[240:243], v[180:183]
    ds_read_b64_tr_b16 a[206:207], v10 offset:55296
    v_add_u32 v10, 73728, v10
    v_mfma_f32_16x16x32_bf16 v[172:175], a[208:211], a[236:239], v[172:175]
    s_add_u32 s38, s46, 204800
    s_add_u32 s36, s47, 204800
    v_mfma_f32_16x16x32_bf16 v[172:175], a[212:215], a[156:159], v[172:175]
    s_cmp_lt_u32 s3, 2
    s_cselect_b32 s38, s38, s36
    v_mfma_f32_16x16x32_bf16 v[164:167], a[212:215], a[152:155], v[164:167]
    s_addk_i32 m0, 4096
    v_mfma_f32_16x16x32_bf16 v[164:167], a[208:211], a[232:235], v[164:167]
    ds_read_b64_tr_b16 a[208:209], v11 offset:45056
    v_mfma_f32_16x16x32_bf16 v[192:195], a[184:187], a[232:235], v[192:195]
    buffer_load_dwordx4 a[220:223], v14, s[20:23], s37 offen offset:1024 sc1
    v_mfma_f32_16x16x32_bf16 v[192:195], a[188:191], a[152:155], v[192:195]
    ds_read_b64_tr_b16 a[210:211], v11 offset:47104
    v_mfma_f32_16x16x32_bf16 v[200:203], a[188:191], a[156:159], v[200:203]
    ds_read_b64_tr_b16 a[212:213], v11 offset:53248
    v_mfma_f32_16x16x32_bf16 v[200:203], a[184:187], a[236:239], v[200:203]
    ds_read_b64_tr_b16 a[214:215], v11 offset:55296
    v_add_u32 v11, 73728, v11
    v_mfma_f32_16x16x32_bf16 v[208:211], a[184:187], a[240:243], v[208:211]
pg_13:
    s_cbranch_execz pg_15
    buffer_load_dwordx4 v7, s[8:11], s38 offen lds
    v_mfma_f32_16x16x32_bf16 v[208:211], a[188:191], a[160:163], v[208:211]
    v_mfma_f32_16x16x32_bf16 v[216:219], a[188:191], a[164:167], v[216:219]
    buffer_load_dwordx4 v[24:27], v4, s[12:15], s64 offen
    v_mfma_f32_16x16x32_bf16 v[216:219], a[184:187], a[244:247], v[216:219]
    s_waitcnt lgkmcnt(3)
    v_mfma_f32_16x16x32_bf16 v[220:223], a[192:195], a[244:247], v[220:223]
    v_mfma_f32_16x16x32_bf16 v[220:223], a[196:199], a[164:167], v[220:223]
    s_waitcnt vmcnt(35) lgkmcnt(1)
    v_mfma_f32_16x16x32_bf16 v[212:215], a[196:199], a[160:163], v[212:215]
    s_barrier
    v_mfma_f32_16x16x32_bf16 v[212:215], a[192:195], a[240:243], v[212:215]
    buffer_load_dwordx4 a[224:227], v14, s[20:23], s37 offen offset:2048 sc1
    v_mfma_f32_16x16x32_bf16 v[204:207], a[192:195], a[236:239], v[204:207]
    ds_read_b64_tr_b16 a[184:185], v12 offset:0
    v_mfma_f32_16x16x32_bf16 v[204:207], a[196:199], a[156:159], v[204:207]
    ds_read_b64_tr_b16 a[186:187], v12 offset:1024
    v_mfma_f32_16x16x32_bf16 v[196:199], a[196:199], a[152:155], v[196:199]
    ds_read_b64_tr_b16 a[188:189], v12 offset:2048
    v_mfma_f32_16x16x32_bf16 v[196:199], a[192:195], a[232:235], v[196:199]
    ds_read_b64_tr_b16 a[190:191], v12 offset:3072
    v_mfma_f32_16x16x32_bf16 v[224:227], a[200:203], a[232:235], v[224:227]
    s_add_u32 s38, s45, 81920
    ds_read_b64_tr_b16 a[192:193], v13 offset:0
    v_mfma_f32_16x16x32_bf16 v[224:227], a[204:207], a[152:155], v[224:227]
    ds_read_b64_tr_b16 a[194:195], v13 offset:1024
    v_mfma_f32_16x16x32_bf16 v[232:235], a[204:207], a[156:159], v[232:235]
    s_add_u32 m0, s63, 0
    ds_read_b64_tr_b16 a[196:197], v13 offset:2048
    v_mfma_f32_16x16x32_bf16 v[232:235], a[200:203], a[236:239], v[232:235]
    ds_read_b64_tr_b16 a[198:199], v13 offset:3072
    v_mfma_f32_16x16x32_bf16 v[240:243], a[200:203], a[240:243], v[240:243]
    buffer_load_dwordx4 a[228:231], v14, s[20:23], s37 offen offset:3072 sc1
    v_mfma_f32_16x16x32_bf16 v[240:243], a[204:207], a[160:163], v[240:243]
    buffer_load_dwordx4 v[28:31], v34, s[12:15], s64 offen
    v_mfma_f32_16x16x32_bf16 v[248:251], a[204:207], a[164:167], v[248:251]
    s_waitcnt lgkmcnt(4)
    v_mfma_f32_16x16x32_bf16 v[248:251], a[200:203], a[244:247], v[248:251]
    ds_read_b64_tr_b16 a[200:201], v8 offset:0
    v_mfma_f32_16x16x32_bf16 v[252:255], a[208:211], a[244:247], v[252:255]
    buffer_load_dwordx4 v2, s[8:11], s38 offen lds
    v_mfma_f32_16x16x32_bf16 v[252:255], a[212:215], a[164:167], v[252:255]
    ds_read_b64_tr_b16 a[202:203], v8 offset:2048
    v_mfma_f32_16x16x32_bf16 v[244:247], a[212:215], a[160:163], v[244:247]
    s_add_u32 s37, s60, 16384
    ds_read_b64_tr_b16 a[204:205], v8 offset:8192
    v_mfma_f32_16x16x32_bf16 v[244:247], a[208:211], a[240:243], v[244:247]
    ds_read_b64_tr_b16 a[206:207], v8 offset:10240
    v_mfma_f32_16x16x32_bf16 v[236:239], a[208:211], a[236:239], v[236:239]
    v_mfma_f32_16x16x32_bf16 v[236:239], a[212:215], a[156:159], v[236:239]
    v_mfma_f32_16x16x32_bf16 v[228:231], a[212:215], a[152:155], v[228:231]
    s_add_u32 s38, s46, 81920
    v_mfma_f32_16x16x32_bf16 v[228:231], a[208:211], a[232:235], v[228:231]
    ds_read_b64_tr_b16 a[208:209], v9 offset:0
    v_mfma_f32_16x16x32_bf16 v[96:99], a[184:187], a[168:171], v[96:99]
    buffer_load_dwordx4 a[232:235], v14, s[20:23], s37 offen offset:0 sc1
    v_mfma_f32_16x16x32_bf16 v[96:99], a[188:191], a[80:83], v[96:99]
    s_addk_i32 m0, 4096
    ds_read_b64_tr_b16 a[210:211], v9 offset:2048
    v_mfma_f32_16x16x32_bf16 v[104:107], a[188:191], a[84:87], v[104:107]
    ds_read_b64_tr_b16 a[212:213], v9 offset:8192
    v_mfma_f32_16x16x32_bf16 v[104:107], a[184:187], a[172:175], v[104:107]
    s_waitcnt lgkmcnt(3)
    ds_read_b64_tr_b16 a[214:215], v9 offset:10240
    v_mfma_f32_16x16x32_bf16 v[112:115], a[184:187], a[176:179], v[112:115]
    v_mfma_f32_16x16x32_bf16 v[112:115], a[188:191], a[88:91], v[112:115]
    v_mfma_f32_16x16x32_bf16 v[120:123], a[188:191], a[92:95], v[120:123]
    buffer_load_dwordx4 v2, s[8:11], s38 offen lds
    v_mfma_f32_16x16x32_bf16 v[120:123], a[184:187], a[180:183], v[120:123]
    ds_read_b64_tr_b16 a[184:185], v10 offset:0
    v_mfma_f32_16x16x32_bf16 v[124:127], a[192:195], a[180:183], v[124:127]
    ds_read_b64_tr_b16 a[186:187], v10 offset:2048
    v_mfma_f32_16x16x32_bf16 v[124:127], a[196:199], a[92:95], v[124:127]
    ds_read_b64_tr_b16 a[188:189], v10 offset:8192
    v_mfma_f32_16x16x32_bf16 v[116:119], a[196:199], a[88:91], v[116:119]
    buffer_load_dwordx4 a[236:239], v14, s[20:23], s37 offen offset:1024 sc1
    v_mfma_f32_16x16x32_bf16 v[116:119], a[192:195], a[176:179], v[116:119]
    ds_read_b64_tr_b16 a[190:191], v10 offset:10240
    v_mfma_f32_16x16x32_bf16 v[108:111], a[192:195], a[172:175], v[108:111]
    s_add_u32 s38, s47, 81920
    v_mfma_f32_16x16x32_bf16 v[108:111], a[196:199], a[84:87], v[108:111]
    v_mfma_f32_16x16x32_bf16 v[100:103], a[196:199], a[80:83], v[100:103]
    s_addk_i32 m0, 4096
    v_mfma_f32_16x16x32_bf16 v[100:103], a[192:195], a[168:171], v[100:103]
    ds_read_b64_tr_b16 a[192:193], v11 offset:0
    v_mfma_f32_16x16x32_bf16 v[128:131], a[200:203], a[168:171], v[128:131]
    ds_read_b64_tr_b16 a[194:195], v11 offset:2048
    v_mfma_f32_16x16x32_bf16 v[128:131], a[204:207], a[80:83], v[128:131]
    ds_read_b64_tr_b16 a[196:197], v11 offset:8192
    v_mfma_f32_16x16x32_bf16 v[136:139], a[204:207], a[84:87], v[136:139]
    s_waitcnt lgkmcnt(3)
    ds_read_b64_tr_b16 a[198:199], v11 offset:10240
    v_lshrrev_b32 v65, 1, v1
    v_mfma_f32_16x16x32_bf16 v[136:139], a[200:203], a[172:175], v[136:139]
    s_and_b32 s39, s70, 0x7ff
    v_min_u32 v65, 23, v65
    v_mul_u32_u24 v65, 2560, v65
    v_mfma_f32_16x16x32_bf16 v[144:147], a[200:203], a[176:179], v[144:147]
    buffer_load_dwordx4 a[240:243], v14, s[20:23], s37 offen offset:2048 sc1
    v_mfma_f32_16x16x32_bf16 v[144:147], a[204:207], a[88:91], v[144:147]
    buffer_load_dwordx4 v2, s[8:11], s38 offen lds
    v_mfma_f32_16x16x32_bf16 v[152:155], a[204:207], a[92:95], v[152:155]
    s_sub_u32 s39, 2047, s39
    v_and_b32 v56, 1, v1
    v_lshl_add_u32 v65, v56, 2, v65
    v_mfma_f32_16x16x32_bf16 v[152:155], a[200:203], a[180:183], v[152:155]
    s_and_b32 s40, s71, 0x7ff
    ds_read_b64_tr_b16 a[200:201], v8 offset:4096
    v_cmp_lt_u32 vcc, 31, v1
    v_mfma_f32_16x16x32_bf16 v[156:159], a[208:211], a[180:183], v[156:159]
    s_load_dwordx4 s[72:75], s[86:87], s5 glc
    ds_read_b64_tr_b16 a[202:203], v8 offset:6144
    v_mov_b32 v54, s70
    v_mfma_f32_16x16x32_bf16 v[156:159], a[212:215], a[92:95], v[156:159]
    s_sub_u32 s40, 2047, s40
    ds_read_b64_tr_b16 a[204:205], v8 offset:12288
    v_mov_b32 v64, s71
    v_mfma_f32_16x16x32_bf16 v[148:151], a[212:215], a[88:91], v[148:151]
    s_add_u32 s38, s45, 122880
    ds_read_b64_tr_b16 a[206:207], v8 offset:14336
    v_cndmask_b32 v54, v54, v64, vcc
    v_mfma_f32_16x16x32_bf16 v[148:151], a[208:211], a[176:179], v[148:151]
    s_xor_b32 s56, s39, s6
    v_bfe_i32 v56, v1, 3, 1
    v_and_b32 v57, 7, v1
    v_mfma_f32_16x16x32_bf16 v[140:143], a[208:211], a[172:175], v[140:143]
    s_add_u32 m0, s63, 12288
    s_xor_b32 s57, s40, s6
    s_min_u32 s56, s56, s57
    v_mfma_f32_16x16x32_bf16 v[140:143], a[212:215], a[84:87], v[140:143]
    s_cmp_lt_u32 s56, 32
    s_cselect_b32 s43, 0, 0x70000000
    s_cselect_b32 s58, s7, 0
    v_mfma_f32_16x16x32_bf16 v[132:135], a[212:215], a[80:83], v[132:135]
    buffer_load_dwordx4 a[244:247], v14, s[20:23], s37 offen offset:3072 sc1
    v_mfma_f32_16x16x32_bf16 v[132:135], a[208:211], a[168:171], v[132:135]
    s_lshr_b32 s41, s64, 7
    ds_read_b64_tr_b16 a[208:209], v9 offset:4096
    v_or_b32 v65, s43, v65
    v_mfma_f32_16x16x32_bf16 v[160:163], a[184:187], a[168:171], v[160:163]
    s_lshl_b32 s41, s41, 8
    ds_read_b64_tr_b16 a[210:211], v9 offset:6144
    s_bfe_u32 s56, s64, 0x10006
    v_mfma_f32_16x16x32_bf16 v[160:163], a[188:191], a[80:83], v[160:163]
    s_lshl3_add_u32 s41, s56, s41
    ds_read_b64_tr_b16 a[212:213], v9 offset:12288
    s_add_u32 s41, s41, 3932320
    v_mfma_f32_16x16x32_bf16 v[168:171], a[188:191], a[84:87], v[168:171]
    s_waitcnt lgkmcnt(5)
    ds_read_b64_tr_b16 a[214:215], v9 offset:14336
    s_add_u32 s37, s61, 16384
    v_mfma_f32_16x16x32_bf16 v[168:171], a[184:187], a[172:175], v[168:171]
    buffer_load_dwordx4 v2, s[8:11], s38 offen lds
    v_mfma_f32_16x16x32_bf16 v[176:179], a[184:187], a[176:179], v[176:179]
    s_waitcnt vmcnt(16)
    s_lshr_b32 s42, s68, 7
    s_lshl_b32 s42, s42, 8
    v_mfma_f32_16x16x32_bf16 v[176:179], a[188:191], a[88:91], v[176:179]
    buffer_store_dword v6, v15, s[24:27], s4 offen offset:160 sc1
    v_mfma_f32_16x16x32_bf16 v[184:187], a[188:191], a[92:95], v[184:187]
    s_bfe_u32 s56, s68, 0x10006
    s_lshl3_add_u32 s42, s56, s42
    s_add_u32 s42, s42, 3932320
    v_mfma_f32_16x16x32_bf16 v[184:187], a[184:187], a[180:183], v[184:187]
    s_sub_u32 s56, s68, s64
    ds_read_b64_tr_b16 a[184:185], v10 offset:4096
    v_and_b32 v56, s56, v56
    v_mfma_f32_16x16x32_bf16 v[188:191], a[192:195], a[180:183], v[188:191]
    buffer_load_dwordx4 a[152:155], v14, s[20:23], s37 offen offset:0 sc1
    v_mfma_f32_16x16x32_bf16 v[188:191], a[196:199], a[92:95], v[188:191]
    s_add_u32 s38, s46, 122880
    ds_read_b64_tr_b16 a[186:187], v10 offset:6144
    v_lshl_add_u32 v64, v57, 3, v56
    v_mfma_f32_16x16x32_bf16 v[180:183], a[196:199], a[88:91], v[180:183]
    s_addk_i32 m0, 4096
    ds_read_b64_tr_b16 a[188:189], v10 offset:12288
    v_add_u32 v55, s64, v64
    v_mfma_f32_16x16x32_bf16 v[180:183], a[192:195], a[176:179], v[180:183]
    s_or_b32 s57, s64, s43
    ds_read_b64_tr_b16 a[190:191], v10 offset:14336
    v_add_u32 v64, s57, v64
    v_mfma_f32_16x16x32_bf16 v[172:175], a[192:195], a[172:175], v[172:175]
    s_add_u32 s55, s43, 3670016
    v_lshrrev_b32 v56, 5, v1
    v_bfe_u32 v57, v1, 4, 1
    v_mfma_f32_16x16x32_bf16 v[172:175], a[196:199], a[84:87], v[172:175]
    s_add_u32 s56, s43, 3211264
    v_lshl_add_u32 v56, v57, 1, v56
    v_mul_u32_u24 v56, 2560, v56
    v_mfma_f32_16x16x32_bf16 v[164:167], a[196:199], a[80:83], v[164:167]
    s_waitcnt lgkmcnt(5)
    v_lshl_add_u32 v55, v55, 1, v56
    v_and_b32 v56, 0x7ff, v54
    v_mfma_f32_16x16x32_bf16 v[164:167], a[192:195], a[168:171], v[164:167]
    ds_read_b64_tr_b16 a[192:193], v11 offset:4096
    v_sub_u32 v56, 2047, v56
    v_mfma_f32_16x16x32_bf16 v[192:195], a[200:203], a[168:171], v[192:195]
    buffer_load_dwordx4 v2, s[8:11], s38 offen lds
    v_mfma_f32_16x16x32_bf16 v[192:195], a[204:207], a[80:83], v[192:195]
    ds_read_b64_tr_b16 a[194:195], v11 offset:6144
    v_mul_u32_u24 v57, 1280, v56
    v_mfma_f32_16x16x32_bf16 v[200:203], a[204:207], a[84:87], v[200:203]
    buffer_load_dwordx4 a[156:159], v14, s[20:23], s37 offen offset:1024 sc1
    v_mfma_f32_16x16x32_bf16 v[200:203], a[200:203], a[172:175], v[200:203]
    s_add_u32 s77, s7, 6
    ds_read_b64_tr_b16 a[196:197], v11 offset:12288
    v_add_u32 v57, v57, v64
    v_mfma_f32_16x16x32_bf16 v[208:211], a[200:203], a[176:179], v[208:211]
    buffer_load_dwordx2 v[66:67], v57, s[12:15], 0 offen
    v_mfma_f32_16x16x32_bf16 v[208:211], a[204:207], a[88:91], v[208:211]
    ds_read_b64_tr_b16 a[198:199], v11 offset:14336
    v_lshlrev_b32 v56, 3, v56
    v_mfma_f32_16x16x32_bf16 v[216:219], a[204:207], a[92:95], v[216:219]
    buffer_load_dwordx2 v[68:69], v56, s[24:27], s56 offen sc1
    v_mfma_f32_16x16x32_bf16 v[216:219], a[200:203], a[180:183], v[216:219]
    s_waitcnt lgkmcnt(5)
    v_and_b32 v54, 0xffff0000, v54
    v_ashrrev_i32 v56, 31, v54
    v_mfma_f32_16x16x32_bf16 v[220:223], a[208:211], a[180:183], v[220:223]
    s_add_u32 s38, s47, 122880
    v_not_b32 v56, v56
    v_or_b32 v56, 0x80000000, v56
    v_mfma_f32_16x16x32_bf16 v[220:223], a[212:215], a[92:95], v[220:223]
    s_addk_i32 m0, 4096
    v_xor_b32 v54, v54, v56
    v_and_b32 v54, 0xffff0000, v54
    v_mfma_f32_16x16x32_bf16 v[212:215], a[212:215], a[88:91], v[212:215]
    s_barrier
    v_mfma_f32_16x16x32_bf16 v[212:215], a[208:211], a[176:179], v[212:215]
    ds_read_b64_tr_b16 a[200:201], v12 offset:20480
    v_mul_f32 v54, s92, v54
    v_mfma_f32_16x16x32_bf16 v[204:207], a[208:211], a[172:175], v[204:207]
    buffer_load_dwordx4 a[160:163], v14, s[20:23], s37 offen offset:2048 sc1
    v_mfma_f32_16x16x32_bf16 v[204:207], a[212:215], a[84:87], v[204:207]
    ds_read_b64_tr_b16 a[202:203], v12 offset:21504
    v_mfma_f32_16x16x32_bf16 v[196:199], a[212:215], a[80:83], v[196:199]
    buffer_load_dwordx4 v2, s[8:11], s38 offen lds
    v_mfma_f32_16x16x32_bf16 v[196:199], a[208:211], a[168:171], v[196:199]
    s_waitcnt lgkmcnt(4)
    ds_read_b64_tr_b16 a[204:205], v13 offset:20480
    v_mfma_f32_16x16x32_bf16 v[224:227], a[184:187], a[168:171], v[224:227]
    ds_read_b64_tr_b16 a[206:207], v13 offset:21504
    v_mfma_f32_16x16x32_bf16 v[224:227], a[188:191], a[80:83], v[224:227]
    ds_read_b64_tr_b16 a[208:209], v8 offset:20480
    v_mfma_f32_16x16x32_bf16 v[232:235], a[188:191], a[84:87], v[232:235]
    ds_read_b64_tr_b16 a[210:211], v8 offset:22528
    v_mfma_f32_16x16x32_bf16 v[232:235], a[184:187], a[172:175], v[232:235]
    ds_read_b64_tr_b16 a[212:213], v9 offset:20480
    v_mfma_f32_16x16x32_bf16 v[240:243], a[184:187], a[176:179], v[240:243]
    s_add_u32 s38, s45, 163840
    ds_read_b64_tr_b16 a[214:215], v9 offset:22528
    v_mfma_f32_16x16x32_bf16 v[240:243], a[188:191], a[88:91], v[240:243]
    v_exp_f32 v54, v54
    v_mfma_f32_16x16x32_bf16 v[248:251], a[188:191], a[92:95], v[248:251]
    buffer_load_dwordx4 a[164:167], v14, s[20:23], s37 offen offset:3072 sc1
    v_mfma_f32_16x16x32_bf16 v[248:251], a[184:187], a[180:183], v[248:251]
    s_waitcnt lgkmcnt(6)
    ds_read_b64_tr_b16 a[188:189], v11 offset:20480
    v_add_f32 v54, 1.0, v54
    v_mfma_f32_16x16x32_bf16 v[252:255], a[192:195], a[180:183], v[252:255]
    s_addk_i32 m0, 4096
    ds_read_b64_tr_b16 a[190:191], v11 offset:22528
    s_sub_u32 s78, s72, s77
    v_mfma_f32_16x16x32_bf16 v[252:255], a[196:199], a[92:95], v[252:255]
    s_sub_u32 s79, s73, s77
    ds_read_b64_tr_b16 a[184:185], v10 offset:20480
    s_max_u32 s78, s78, s79
    v_mfma_f32_16x16x32_bf16 v[244:247], a[196:199], a[88:91], v[244:247]
    s_sub_u32 s79, s74, s77
    ds_read_b64_tr_b16 a[186:187], v10 offset:22528
    s_max_u32 s78, s78, s79
    v_mfma_f32_16x16x32_bf16 v[244:247], a[192:195], a[176:179], v[244:247]
    s_sub_u32 s79, s75, s77
    v_rcp_f32 v54, v54
    v_mfma_f32_16x16x32_bf16 v[236:239], a[192:195], a[172:175], v[236:239]
    buffer_load_dwordx4 v2, s[8:11], s38 offen lds
    v_mfma_f32_16x16x32_bf16 v[236:239], a[196:199], a[84:87], v[236:239]
    s_max_u32 s78, s78, s79
    v_cvt_pk_bf16_f32 v54, 0, v54
    s_add_u32 s37, s59, 20480
    v_mfma_f32_16x16x32_bf16 v[228:231], a[196:199], a[80:83], v[228:231]
    s_waitcnt lgkmcnt(3)
    v_mfma_f32_16x16x32_bf16 v[228:231], a[192:195], a[168:171], v[228:231]
    s_waitcnt vmcnt(24)
    ds_read_b64_tr_b16 a[192:193], v8 offset:24576
    v_lshlrev_b32 v20, 16, v32
    v_mfma_f32_16x16x32_bf16 v[96:99], a[200:203], a[96:99], v[96:99]
    s_cmp_gt_u32 s78, 0
    s_cbranch_scc1 spin_o5
spin_o5_ret:
    v_and_b32 v21, 0xffff0000, v32
    v_mfma_f32_16x16x32_bf16 v[100:103], a[204:207], a[96:99], v[100:103]
    buffer_load_dwordx4 a[168:171], v14, s[20:23], s37 offen offset:0 sc1
    v_mfma_f32_16x16x32_bf16 v[108:111], a[204:207], a[100:103], v[108:111]
    s_xor_b32 s77, s50, 2
    ds_read_b64_tr_b16 a[194:195], v8 offset:26624
    v_sub_f32 v20, v20, v38
    v_mfma_f32_16x16x32_bf16 v[104:107], a[200:203], a[100:103], v[104:107]
    s_lshl_b32 s77, s77, 10
    ds_read_b64_tr_b16 a[196:197], v9 offset:24576
    v_sub_f32 v21, v21, v38
    v_mfma_f32_16x16x32_bf16 v[112:115], a[200:203], a[104:107], v[112:115]
    s_add_u32 s38, s46, 163840
    ds_read_b64_tr_b16 a[198:199], v9 offset:26624
    v_cvt_pk_bf16_f32 v20, 0, v20
    v_mfma_f32_16x16x32_bf16 v[116:119], a[204:207], a[104:107], v[116:119]
    s_addk_i32 m0, 4096
    v_cvt_pk_bf16_f32 v21, 0, v21
    v_mul_f32 v20, v20, v39
    v_mfma_f32_16x16x32_bf16 v[124:127], a[204:207], a[108:111], v[124:127]
    s_waitcnt vmcnt(22)
    ds_read_b64_tr_b16 a[204:205], v11 offset:24576
    v_mul_f32 v21, v21, v39
    v_mfma_f32_16x16x32_bf16 v[120:123], a[200:203], a[108:111], v[120:123]
    s_lshr_b32 s56, s2, 3
    ds_read_b64_tr_b16 a[206:207], v11 offset:26624
    v_cvt_pk_bf16_f32 v20, 0, v20
    v_mfma_f32_16x16x32_bf16 v[152:155], a[208:211], a[108:111], v[152:155]
    s_lshl2_add_u32 s56, s56, s3
    ds_read_b64_tr_b16 a[200:201], v10 offset:24576
    v_cvt_pk_bf16_f32 v21, 0, v21
    v_mfma_f32_16x16x32_bf16 v[156:159], a[212:215], a[108:111], v[156:159]
    s_lshl_b32 s56, s56, 7
    ds_read_b64_tr_b16 a[202:203], v10 offset:26624
    v_mul_f32 v23, s92, v20
    v_mfma_f32_16x16x32_bf16 v[148:151], a[212:215], a[104:107], v[148:151]
    s_waitcnt lgkmcnt(5)
    v_exp_f32 v23, v23
    v_mfma_f32_16x16x32_bf16 v[144:147], a[208:211], a[104:107], v[144:147]
    buffer_load_dwordx4 a[172:175], v14, s[20:23], s37 offen offset:1024 sc1
    v_mfma_f32_16x16x32_bf16 v[136:139], a[208:211], a[100:103], v[136:139]
    buffer_load_dwordx4 v2, s[8:11], s38 offen lds
    v_mfma_f32_16x16x32_bf16 v[140:143], a[212:215], a[100:103], v[140:143]
    s_add_u32 s56, s56, rare-code_end+16384
    v_permlane16_swap_b32 v24, v26
    v_mfma_f32_16x16x32_bf16 v[132:135], a[212:215], a[96:99], v[132:135]
    ds_read_b64_tr_b16 a[212:213], v13 offset:22528
    v_mul_f32 v36, s92, v21
    v_mfma_f32_16x16x32_bf16 v[128:131], a[208:211], a[96:99], v[128:131]
    ds_read_b64_tr_b16 a[214:215], v13 offset:23552
    v_add_f32 v23, 1.0, v23
    v_mfma_f32_16x16x32_bf16 v[160:163], a[184:187], a[96:99], v[160:163]
    s_add_u32 s38, s47, 163840
    ds_read_b64_tr_b16 a[208:209], v12 offset:22528
    v_mov_b32 v70, s56
    v_mfma_f32_16x16x32_bf16 v[164:167], a[188:191], a[96:99], v[164:167]
    global_load_dword a252, v70, s[88:89]
    v_mfma_f32_16x16x32_bf16 v[172:175], a[188:191], a[100:103], v[172:175]
    s_addk_i32 m0, 4096
    ds_read_b64_tr_b16 a[210:211], v12 offset:23552
    v_mfma_f32_16x16x32_bf16 v[168:171], a[184:187], a[100:103], v[168:171]
    s_waitcnt vmcnt(22)
    v_exp_f32 v36, v36
    v_mfma_f32_16x16x32_bf16 v[176:179], a[184:187], a[104:107], v[176:179]
    buffer_load_dwordx4 a[176:179], v14, s[20:23], s37 offen offset:2048 sc1
    v_mfma_f32_16x16x32_bf16 v[180:183], a[188:191], a[104:107], v[180:183]
    v_rcp_f32 v23, v23
    v_mfma_f32_16x16x32_bf16 v[188:191], a[188:191], a[108:111], v[188:191]
    s_waitcnt lgkmcnt(2)
    v_permlane16_swap_b32 v25, v27
    v_mfma_f32_16x16x32_bf16 v[184:187], a[184:187], a[108:111], v[184:187]
    ds_read_b64_tr_b16 a[184:185], v8 offset:28672
    v_add_f32 v36, 1.0, v36
    v_mfma_f32_16x16x32_bf16 v[216:219], a[192:195], a[108:111], v[216:219]
    buffer_load_dwordx4 v2, s[8:11], s38 offen lds
    v_mfma_f32_16x16x32_bf16 v[220:223], a[196:199], a[108:111], v[220:223]
    ds_read_b64_tr_b16 a[186:187], v8 offset:30720
    v_mul_f32 v20, v20, v23
    v_mfma_f32_16x16x32_bf16 v[212:215], a[196:199], a[104:107], v[212:215]
    ds_read_b64_tr_b16 a[188:189], v9 offset:28672
    v_mfma_f32_16x16x32_bf16 v[208:211], a[192:195], a[104:107], v[208:211]
    ds_read_b64_tr_b16 a[190:191], v9 offset:30720
    v_mfma_f32_16x16x32_bf16 v[200:203], a[192:195], a[100:103], v[200:203]
    v_rcp_f32 v36, v36
    v_mfma_f32_16x16x32_bf16 v[204:207], a[196:199], a[100:103], v[204:207]
    v_permlane16_swap_b32 v28, v30
    v_mfma_f32_16x16x32_bf16 v[196:199], a[196:199], a[96:99], v[196:199]
    buffer_load_dwordx4 a[180:183], v14, s[20:23], s37 offen offset:3072 sc1
    v_mfma_f32_16x16x32_bf16 v[192:195], a[192:195], a[96:99], v[192:195]
    s_add_u32 s38, s45, 204800
    ds_read_b64_tr_b16 a[196:197], v11 offset:28672
    v_mul_f32 v21, v21, v36
    v_mfma_f32_16x16x32_bf16 v[224:227], a[200:203], a[96:99], v[224:227]
    s_addk_i32 m0, 4096
    ds_read_b64_tr_b16 a[198:199], v11 offset:30720
    v_cvt_pk_bf16_f32 v48, v20, v21
    v_mfma_f32_16x16x32_bf16 v[228:231], a[204:207], a[96:99], v[228:231]
    ds_read_b64_tr_b16 a[192:193], v10 offset:28672
    v_lshlrev_b32 v20, 16, v33
    v_mfma_f32_16x16x32_bf16 v[236:239], a[204:207], a[100:103], v[236:239]
    s_add_u32 s37, s60, 20480
    ds_read_b64_tr_b16 a[194:195], v10 offset:30720
    v_and_b32 v21, 0xffff0000, v33
    v_mfma_f32_16x16x32_bf16 v[232:235], a[200:203], a[100:103], v[232:235]
    v_permlane16_swap_b32 v29, v31
    v_mfma_f32_16x16x32_bf16 v[240:243], a[200:203], a[104:107], v[240:243]
    v_sub_f32 v20, v20, v38
    v_sub_f32 v21, v21, v38
    v_mfma_f32_16x16x32_bf16 v[244:247], a[204:207], a[104:107], v[244:247]
    s_waitcnt lgkmcnt(4)
    v_cvt_pk_bf16_f32 v20, 0, v20
    v_cvt_pk_bf16_f32 v21, 0, v21
    v_mfma_f32_16x16x32_bf16 v[252:255], a[204:207], a[108:111], v[252:255]
    buffer_load_dwordx4 v2, s[8:11], s38 offen lds
    v_mfma_f32_16x16x32_bf16 v[248:251], a[200:203], a[108:111], v[248:251]
    ds_read_b64_tr_b16 a[200:201], v8 offset:32768
    v_mul_f32 v20, v20, v39
    v_mfma_f32_16x16x32_bf16 v[120:123], a[208:211], a[124:127], v[120:123]
    buffer_load_dwordx4 a[80:83], v14, s[20:23], s37 offen offset:0 sc1
    v_mfma_f32_16x16x32_bf16 v[124:127], a[212:215], a[124:127], v[124:127]
    ds_read_b64_tr_b16 a[202:203], v8 offset:34816
    v_subrev_u32 v8, 73728, v8
    v_mfma_f32_16x16x32_bf16 v[116:119], a[212:215], a[120:123], v[116:119]
    ds_read_b64_tr_b16 a[204:205], v9 offset:32768
    v_mul_f32 v21, v21, v39
    v_mfma_f32_16x16x32_bf16 v[112:115], a[208:211], a[120:123], v[112:115]
    ds_read_b64_tr_b16 a[206:207], v9 offset:34816
    v_subrev_u32 v9, 73728, v9
    v_mfma_f32_16x16x32_bf16 v[104:107], a[208:211], a[116:119], v[104:107]
    s_add_u32 s38, s46, 204800
    v_cvt_pk_bf16_f32 v20, 0, v20
    v_cvt_pk_bf16_f32 v21, 0, v21
    v_mfma_f32_16x16x32_bf16 v[108:111], a[212:215], a[116:119], v[108:111]
    v_mul_f32 v23, s92, v20
    v_mul_f32 v36, s92, v21
    v_mfma_f32_16x16x32_bf16 v[100:103], a[212:215], a[112:115], v[100:103]
    s_addk_i32 m0, 4096
    ds_read_b64_tr_b16 a[212:213], v11 offset:32768
    v_mfma_f32_16x16x32_bf16 v[96:99], a[208:211], a[112:115], v[96:99]
    ds_read_b64_tr_b16 a[214:215], v11 offset:34816
    v_subrev_u32 v11, 73728, v11
    v_mfma_f32_16x16x32_bf16 v[128:131], a[184:187], a[112:115], v[128:131]
    ds_read_b64_tr_b16 a[208:209], v10 offset:32768
    v_mfma_f32_16x16x32_bf16 v[132:135], a[188:191], a[112:115], v[132:135]
    s_waitcnt lgkmcnt(4)
    ds_read_b64_tr_b16 a[210:211], v10 offset:34816
    v_subrev_u32 v10, 73728, v10
    v_mfma_f32_16x16x32_bf16 v[140:143], a[188:191], a[116:119], v[140:143]
    buffer_load_dwordx4 a[84:87], v14, s[20:23], s37 offen offset:1024 sc1
    v_mfma_f32_16x16x32_bf16 v[136:139], a[184:187], a[116:119], v[136:139]
    v_exp_f32 v23, v23
    v_mfma_f32_16x16x32_bf16 v[144:147], a[184:187], a[120:123], v[144:147]
    buffer_load_dwordx4 v2, s[8:11], s38 offen lds
    v_mfma_f32_16x16x32_bf16 v[148:151], a[188:191], a[120:123], v[148:151]
    v_exp_f32 v36, v36
    v_mfma_f32_16x16x32_bf16 v[156:159], a[188:191], a[124:127], v[156:159]
    v_add_f32 v23, 1.0, v23
    v_add_f32 v36, 1.0, v36
    v_mfma_f32_16x16x32_bf16 v[152:155], a[184:187], a[124:127], v[152:155]
    v_rcp_f32 v23, v23
    v_mfma_f32_16x16x32_bf16 v[184:187], a[192:195], a[124:127], v[184:187]
    v_rcp_f32 v36, v36
    v_mfma_f32_16x16x32_bf16 v[188:191], a[196:199], a[124:127], v[188:191]
    s_waitcnt lgkmcnt(0)
    v_mul_f32 v20, v20, v23
    v_mul_f32 v21, v21, v36
    v_mfma_f32_16x16x32_bf16 v[180:183], a[196:199], a[120:123], v[180:183]
    s_barrier
    v_mfma_f32_16x16x32_bf16 v[176:179], a[192:195], a[120:123], v[176:179]
    s_add_u32 s38, s47, 204800
    ds_read_b64_tr_b16 a[184:185], v12 offset:49152
    v_cvt_pk_bf16_f32 v49, v20, v21
    v_mfma_f32_16x16x32_bf16 v[168:171], a[192:195], a[116:119], v[168:171]
    buffer_load_dwordx4 a[88:91], v14, s[20:23], s37 offen offset:2048 sc1
    v_mfma_f32_16x16x32_bf16 v[172:175], a[196:199], a[116:119], v[172:175]
    s_addk_i32 m0, 4096
    ds_read_b64_tr_b16 a[186:187], v12 offset:50176
    v_lshlrev_b32 v20, 16, v24
    v_mfma_f32_16x16x32_bf16 v[164:167], a[196:199], a[112:115], v[164:167]
    s_waitcnt vmcnt(17)
    ds_read_b64_tr_b16 a[188:189], v12 offset:51200
    v_and_b32 v21, 0xffff0000, v24
    v_mfma_f32_16x16x32_bf16 v[160:163], a[192:195], a[112:115], v[160:163]
    ds_read_b64_tr_b16 a[190:191], v12 offset:52224
    v_sub_f32 v20, v20, v16
    v_mfma_f32_16x16x32_bf16 v[192:195], a[200:203], a[112:115], v[192:195]
    ds_read_b64_tr_b16 a[192:193], v13 offset:49152
    v_sub_f32 v21, v21, v16
    v_mfma_f32_16x16x32_bf16 v[196:199], a[204:207], a[112:115], v[196:199]
    ds_read_b64_tr_b16 a[194:195], v13 offset:50176
    v_cvt_pk_bf16_f32 v20, 0, v20
    v_mfma_f32_16x16x32_bf16 v[204:207], a[204:207], a[116:119], v[204:207]
    buffer_load_dwordx4 v2, s[8:11], s38 offen lds
    v_mfma_f32_16x16x32_bf16 v[200:203], a[200:203], a[116:119], v[200:203]
    ds_read_b64_tr_b16 a[196:197], v13 offset:51200
    v_cvt_pk_bf16_f32 v21, 0, v21
    v_mfma_f32_16x16x32_bf16 v[208:211], a[200:203], a[120:123], v[208:211]
    ds_read_b64_tr_b16 a[198:199], v13 offset:52224
    v_mul_f32 v20, v20, v17
    v_mfma_f32_16x16x32_bf16 v[212:215], a[204:207], a[120:123], v[212:215]
    v_mul_f32 v21, v21, v17
    v_cvt_pk_bf16_f32 v20, 0, v20
    v_mfma_f32_16x16x32_bf16 v[220:223], a[204:207], a[124:127], v[220:223]
    buffer_load_dwordx4 a[92:95], v14, s[20:23], s37 offen offset:3072 sc1
    v_mfma_f32_16x16x32_bf16 v[216:219], a[200:203], a[124:127], v[216:219]
    ds_read_b64_tr_b16 a[200:201], v12 offset:53248
    v_cvt_pk_bf16_f32 v21, 0, v21
    v_mfma_f32_16x16x32_bf16 v[248:251], a[208:211], a[124:127], v[248:251]
    ds_read_b64_tr_b16 a[202:203], v12 offset:54272
    v_mul_f32 v23, s92, v20
    v_mfma_f32_16x16x32_bf16 v[252:255], a[212:215], a[124:127], v[252:255]
    ds_read_b64_tr_b16 a[204:205], v12 offset:55296
    v_mul_f32 v36, s92, v21
    v_mfma_f32_16x16x32_bf16 v[244:247], a[212:215], a[120:123], v[244:247]
    s_waitcnt lgkmcnt(4)
    ds_read_b64_tr_b16 a[206:207], v12 offset:56320
    v_lshlrev_b32 v50, 16, v66
    v_mfma_f32_16x16x32_bf16 v[240:243], a[208:211], a[120:123], v[240:243]
    s_add_u32 s37, s61, 20480
    v_exp_f32 v23, v23
    v_mfma_f32_16x16x32_bf16 v[232:235], a[208:211], a[116:119], v[232:235]
    s_waitcnt vmcnt(18)
    v_exp_f32 v36, v36
    v_mfma_f32_16x16x32_bf16 v[236:239], a[212:215], a[116:119], v[236:239]
    v_and_b32 v51, 0xffff0000, v66
    v_lshlrev_b32 v52, 16, v67
    v_mfma_f32_16x16x32_bf16 v[228:231], a[212:215], a[112:115], v[228:231]
    v_and_b32 v53, 0xffff0000, v67
    v_sub_f32 v50, v50, v68
    v_mfma_f32_16x16x32_bf16 v[224:227], a[208:211], a[112:115], v[224:227]
    ds_read_b64_tr_b16 a[208:209], v13 offset:53248
    v_sub_f32 v51, v51, v68
    v_mfma_f32_16x16x32_bf16 v[96:99], a[184:187], a[128:131], v[96:99]
    buffer_load_dwordx4 a[96:99], v14, s[20:23], s37 offen offset:0 sc1
    v_mfma_f32_16x16x32_bf16 v[96:99], a[188:191], a[0:3], v[96:99]
    ds_read_b64_tr_b16 a[210:211], v13 offset:54272
    v_sub_f32 v52, v52, v68
    v_mfma_f32_16x16x32_bf16 v[104:107], a[188:191], a[4:7], v[104:107]
    ds_read_b64_tr_b16 a[212:213], v13 offset:55296
    v_sub_f32 v53, v53, v68
    v_mfma_f32_16x16x32_bf16 v[104:107], a[184:187], a[132:135], v[104:107]
    ds_read_b64_tr_b16 a[214:215], v13 offset:56320
    v_cvt_pk_bf16_f32 v50, 0, v50
    v_mfma_f32_16x16x32_bf16 v[112:115], a[184:187], a[136:139], v[112:115]
    v_cvt_pk_bf16_f32 v51, 0, v51
    v_cvt_pk_bf16_f32 v52, 0, v52
    v_mfma_f32_16x16x32_bf16 v[112:115], a[188:191], a[8:11], v[112:115]
    v_cvt_pk_bf16_f32 v53, 0, v53
    v_mul_f32 v50, v50, v69
    v_mfma_f32_16x16x32_bf16 v[120:123], a[188:191], a[12:15], v[120:123]
    s_waitcnt lgkmcnt(3)
    v_mul_f32 v51, v51, v69
    v_mul_f32 v52, v52, v69
    v_mfma_f32_16x16x32_bf16 v[120:123], a[184:187], a[140:143], v[120:123]
    ds_read_b64_tr_b16 a[184:185], v12 offset:57344
    v_mul_f32 v53, v53, v69
    v_mfma_f32_16x16x32_bf16 v[124:127], a[192:195], a[140:143], v[124:127]
    ds_read_b64_tr_b16 a[186:187], v12 offset:58368
    v_cvt_pk_bf16_f32 v50, 0, v50
    v_mfma_f32_16x16x32_bf16 v[124:127], a[196:199], a[12:15], v[124:127]
    ds_read_b64_tr_b16 a[188:189], v12 offset:59392
    v_cvt_pk_bf16_f32 v51, 0, v51
    v_mfma_f32_16x16x32_bf16 v[116:119], a[196:199], a[8:11], v[116:119]
    buffer_load_dwordx4 a[100:103], v14, s[20:23], s37 offen offset:1024 sc1
    v_mfma_f32_16x16x32_bf16 v[116:119], a[192:195], a[136:139], v[116:119]
    s_lshl2_add_u32 s60, s54, s51
    ds_read_b64_tr_b16 a[190:191], v12 offset:60416
    v_lshrrev_b32 v70, 1, v1
    v_mfma_f32_16x16x32_bf16 v[108:111], a[192:195], a[132:135], v[108:111]
    s_mul_i32 s60, s60, 163840
    v_min_u32 v70, 1, v70
    v_and_b32 v39, 7, v1
    v_mfma_f32_16x16x32_bf16 v[108:111], a[196:199], a[4:7], v[108:111]
    s_add_u32 s60, s60, 50331648
    v_cvt_pk_bf16_f32 v52, 0, v52
    v_cvt_pk_bf16_f32 v53, 0, v53
    v_mfma_f32_16x16x32_bf16 v[100:103], a[196:199], a[0:3], v[100:103]
    s_mul_i32 s56, s53, 2560
    v_add_f32 v23, 1.0, v23
    v_add_f32 v36, 1.0, v36
    v_mfma_f32_16x16x32_bf16 v[100:103], a[192:195], a[128:131], v[100:103]
    s_add_u32 s59, s60, s56
    ds_read_b64_tr_b16 a[192:193], v13 offset:57344
    s_mul_i32 s56, s53, 20480
    v_mfma_f32_16x16x32_bf16 v[96:99], a[200:203], a[16:19], v[96:99]
    s_add_u32 s60, s60, s56
    ds_read_b64_tr_b16 a[194:195], v13 offset:58368
    s_andn2_b32 s61, s2, 7
    v_mfma_f32_16x16x32_bf16 v[96:99], a[204:207], a[32:35], v[96:99]
    s_lshl_b32 s61, s61, 2
    ds_read_b64_tr_b16 a[196:197], v13 offset:59392
    s_add_u32 s61, s61, s3
    v_mfma_f32_16x16x32_bf16 v[104:107], a[204:207], a[36:39], v[104:107]
    s_lshl_b32 s61, s61, 7
    ds_read_b64_tr_b16 a[198:199], v13 offset:60416
    s_add_u32 s61, s61, 4194304
    v_mfma_f32_16x16x32_bf16 v[104:107], a[200:203], a[20:23], v[104:107]
    s_waitcnt lgkmcnt(4)
    v_rcp_f32 v23, v23
    v_mfma_f32_16x16x32_bf16 v[112:115], a[200:203], a[24:27], v[112:115]
    buffer_load_dwordx4 a[104:107], v14, s[20:23], s37 offen offset:2048 sc1
    v_mfma_f32_16x16x32_bf16 v[112:115], a[204:207], a[40:43], v[112:115]
pg_14:
    s_cbranch_execz pg_back
    s_and_b32 s56, s53, 1
    v_xor_b32 v7, s56, v1
    v_add_u32 v2, 1, v7
    v_mfma_f32_16x16x32_bf16 v[120:123], a[204:207], a[44:47], v[120:123]
    s_andn2_b32 s56, 4, s53
    v_lshlrev_b32 v7, 2, v7
    v_lshl_add_u32 v7, v1, 9, v7
    v_mfma_f32_16x16x32_bf16 v[120:123], a[200:203], a[28:31], v[120:123]
    s_lshl_b32 s56, s56, 1
    ds_read_b64_tr_b16 a[200:201], v12 offset:61440
    v_lshl_or_b32 v7, v70, 30, v7
    v_mfma_f32_16x16x32_bf16 v[124:127], a[208:211], a[28:31], v[124:127]
    s_add_u32 s67, s61, s67
    ds_read_b64_tr_b16 a[202:203], v12 offset:62464
    v_lshrrev_b32 v70, 4, v1
    v_mfma_f32_16x16x32_bf16 v[124:127], a[212:215], a[44:47], v[124:127]
    s_add_u32 s77, s61, s77
    ds_read_b64_tr_b16 a[204:205], v12 offset:63488
    v_lshl_add_u32 v39, v70, 3, v39
    v_mfma_f32_16x16x32_bf16 v[116:119], a[212:215], a[40:43], v[116:119]
    s_add_u32 s38, s45, 81920
    ds_read_b64_tr_b16 a[206:207], v12 offset:64512
    v_add_u32 v12, 65536, v12
    v_mfma_f32_16x16x32_bf16 v[116:119], a[208:211], a[24:27], v[116:119]
    s_add_u32 m0, s63, 135168
    v_lshlrev_b32 v39, 4, v39
    v_and_b32 v70, 8, v1
    v_mfma_f32_16x16x32_bf16 v[108:111], a[208:211], a[20:23], v[108:111]
    buffer_load_dwordx4 v3, s[8:11], s38 offen lds
    v_mfma_f32_16x16x32_bf16 v[108:111], a[212:215], a[36:39], v[108:111]
    s_add_u32 s38, s46, 81920
    v_mul_u32_u24 v38, 1280, v70
    v_add_u32 v38, v38, v39
    v_mfma_f32_16x16x32_bf16 v[100:103], a[212:215], a[32:35], v[100:103]
    buffer_load_dwordx4 a[108:111], v14, s[20:23], s37 offen offset:3072 sc1
    v_mfma_f32_16x16x32_bf16 v[100:103], a[208:211], a[16:19], v[100:103]
    s_addk_i32 m0, -4096
    ds_read_b64_tr_b16 a[208:209], v13 offset:61440
    v_xor_b32 v70, s56, v70
    v_mfma_f32_16x16x32_bf16 v[96:99], a[184:187], a[48:51], v[96:99]
    buffer_load_dwordx4 v3, s[8:11], s38 offen lds
    v_mfma_f32_16x16x32_bf16 v[96:99], a[188:191], a[64:67], v[96:99]
    ds_read_b64_tr_b16 a[210:211], v13 offset:62464
    v_add_u32 v39, v39, v70
    v_mfma_f32_16x16x32_bf16 v[104:107], a[188:191], a[68:71], v[104:107]
    s_add_u32 s38, s47, 81920
    ds_read_b64_tr_b16 a[212:213], v13 offset:63488
    v_cmp_ne_u32 s[74:75], 0, v70
    v_mfma_f32_16x16x32_bf16 v[104:107], a[184:187], a[52:55], v[104:107]
    s_waitcnt lgkmcnt(3)
    ds_read_b64_tr_b16 a[214:215], v13 offset:64512
    v_add_u32 v13, 65536, v13
    v_mfma_f32_16x16x32_bf16 v[112:115], a[184:187], a[56:59], v[112:115]
    s_add_u32 m0, s63, 126976
    v_rcp_f32 v36, v36
    v_mfma_f32_16x16x32_bf16 v[112:115], a[188:191], a[72:75], v[112:115]
    v_mul_f32 v20, v20, v23
    v_mul_f32 v21, v21, v36
    v_mfma_f32_16x16x32_bf16 v[120:123], a[188:191], a[76:79], v[120:123]
    v_cvt_pk_bf16_f32 v40, v20, v21
    v_lshlrev_b32 v20, 16, v25
    v_mfma_f32_16x16x32_bf16 v[120:123], a[184:187], a[60:63], v[120:123]
    ds_read_b64_tr_b16 a[184:185], v12 offset:0
    v_and_b32 v21, 0xffff0000, v25
    v_mfma_f32_16x16x32_bf16 v[124:127], a[192:195], a[60:63], v[124:127]
    ds_read_b64_tr_b16 a[186:187], v12 offset:1024
    v_sub_f32 v20, v20, v16
    v_mfma_f32_16x16x32_bf16 v[124:127], a[196:199], a[76:79], v[124:127]
    ds_read_b64_tr_b16 a[188:189], v12 offset:2048
    v_sub_f32 v21, v21, v16
    v_mfma_f32_16x16x32_bf16 v[116:119], a[196:199], a[72:75], v[116:119]
    buffer_load_dwordx4 v3, s[8:11], s38 offen lds
    v_mfma_f32_16x16x32_bf16 v[116:119], a[192:195], a[56:59], v[116:119]
    ds_read_b64_tr_b16 a[190:191], v12 offset:3072
    v_cvt_pk_bf16_f32 v20, 0, v20
    v_mfma_f32_16x16x32_bf16 v[108:111], a[192:195], a[52:55], v[108:111]
    v_cvt_pk_bf16_f32 v21, 0, v21
    v_mul_f32 v20, v20, v17
    v_mfma_f32_16x16x32_bf16 v[108:111], a[196:199], a[68:71], v[108:111]
    v_mul_f32 v21, v21, v17
    v_cvt_pk_bf16_f32 v20, 0, v20
    v_mfma_f32_16x16x32_bf16 v[100:103], a[196:199], a[64:67], v[100:103]
    s_add_u32 s38, s45, 122880
    v_cvt_pk_bf16_f32 v21, 0, v21
    v_mul_f32 v23, s92, v20
    v_mfma_f32_16x16x32_bf16 v[100:103], a[192:195], a[48:51], v[100:103]
    ds_read_b64_tr_b16 a[192:193], v13 offset:0
    v_mul_f32 v36, s92, v21
    v_mfma_f32_16x16x32_bf16 v[96:99], a[200:203], a[216:219], v[96:99]
    s_addk_i32 m0, -4096
    ds_read_b64_tr_b16 a[194:195], v13 offset:1024
    v_mfma_f32_16x16x32_bf16 v[96:99], a[204:207], a[232:235], v[96:99]
    ds_read_b64_tr_b16 a[196:197], v13 offset:2048
    v_mfma_f32_16x16x32_bf16 v[104:107], a[204:207], a[236:239], v[104:107]
    s_waitcnt lgkmcnt(3)
    ds_read_b64_tr_b16 a[198:199], v13 offset:3072
    v_mfma_f32_16x16x32_bf16 v[104:107], a[200:203], a[220:223], v[104:107]
    v_exp_f32 v23, v23
    v_mfma_f32_16x16x32_bf16 v[112:115], a[200:203], a[224:227], v[112:115]
    v_exp_f32 v36, v36
    v_mfma_f32_16x16x32_bf16 v[112:115], a[204:207], a[240:243], v[112:115]
    v_add_f32 v23, 1.0, v23
    v_add_f32 v36, 1.0, v36
    v_mfma_f32_16x16x32_bf16 v[120:123], a[204:207], a[244:247], v[120:123]
    buffer_load_dwordx4 v3, s[8:11], s38 offen lds
    v_mfma_f32_16x16x32_bf16 v[120:123], a[200:203], a[228:231], v[120:123]
    ds_read_b64_tr_b16 a[200:201], v12 offset:4096
    v_mfma_f32_16x16x32_bf16 v[124:127], a[208:211], a[228:231], v[124:127]
    ds_read_b64_tr_b16 a[202:203], v12 offset:5120
    v_mfma_f32_16x16x32_bf16 v[124:127], a[212:215], a[244:247], v[124:127]
    ds_read_b64_tr_b16 a[204:205], v12 offset:6144
    v_mfma_f32_16x16x32_bf16 v[116:119], a[212:215], a[240:243], v[116:119]
    buffer_load_dword v58, v65, s[24:27], s41 offen sc1
    v_mfma_f32_16x16x32_bf16 v[116:119], a[208:211], a[224:227], v[116:119]
    buffer_load_dword v59, v65, s[24:27], s42 offen sc1
    v_mfma_f32_16x16x32_bf16 v[108:111], a[208:211], a[220:223], v[108:111]
    s_add_u32 s38, s46, 122880
    ds_read_b64_tr_b16 a[206:207], v12 offset:7168
    s_addk_i32 m0, -4096
    v_mfma_f32_16x16x32_bf16 v[108:111], a[212:215], a[236:239], v[108:111]
    v_rcp_f32 v23, v23
    v_mfma_f32_16x16x32_bf16 v[100:103], a[212:215], a[232:235], v[100:103]
    s_waitcnt vmcnt(23)
    v_rcp_f32 v36, v36
    v_mfma_f32_16x16x32_bf16 v[100:103], a[208:211], a[216:219], v[100:103]
    s_waitcnt vmcnt(22)
    ds_read_b64_tr_b16 a[208:209], v13 offset:4096
    v_mul_f32 v20, v20, v23
    v_mfma_f32_16x16x32_bf16 v[96:99], a[184:187], a[152:155], v[96:99]
    ds_read_b64_tr_b16 a[210:211], v13 offset:5120
    v_mul_f32 v21, v21, v36
    v_mfma_f32_16x16x32_bf16 v[96:99], a[188:191], a[168:171], v[96:99]
    ds_read_b64_tr_b16 a[212:213], v13 offset:6144
    v_cvt_pk_bf16_f32 v41, v20, v21
    v_mfma_f32_16x16x32_bf16 v[104:107], a[188:191], a[172:175], v[104:107]
    s_waitcnt vmcnt(19) lgkmcnt(4)
    ds_read_b64_tr_b16 a[214:215], v13 offset:7168
    v_lshlrev_b32 v20, 16, v26
    v_mfma_f32_16x16x32_bf16 v[104:107], a[184:187], a[156:159], v[104:107]
    buffer_load_dwordx4 v3, s[8:11], s38 offen lds
    v_mfma_f32_16x16x32_bf16 v[112:115], a[184:187], a[160:163], v[112:115]
    s_waitcnt vmcnt(18)
    v_and_b32 v21, 0xffff0000, v26
    v_sub_f32 v20, v20, v16
    v_mfma_f32_16x16x32_bf16 v[112:115], a[188:191], a[176:179], v[112:115]
    v_sub_f32 v21, v21, v16
    v_cvt_pk_bf16_f32 v20, 0, v20
    v_mfma_f32_16x16x32_bf16 v[120:123], a[188:191], a[180:183], v[120:123]
    s_add_u32 s38, s47, 122880
    v_cvt_pk_bf16_f32 v21, 0, v21
    v_mul_f32 v20, v20, v17
    v_mfma_f32_16x16x32_bf16 v[120:123], a[184:187], a[164:167], v[120:123]
    v_mul_f32 v21, v21, v17
    v_cvt_pk_bf16_f32 v20, 0, v20
    v_mfma_f32_16x16x32_bf16 v[124:127], a[192:195], a[164:167], v[124:127]
    s_addk_i32 m0, -4096
    v_cvt_pk_bf16_f32 v21, 0, v21
    v_mul_f32 v23, s92, v20
    v_mfma_f32_16x16x32_bf16 v[124:127], a[196:199], a[180:183], v[124:127]
    v_exp_f32 v23, v23
    v_mfma_f32_16x16x32_bf16 v[116:119], a[196:199], a[176:179], v[116:119]
    s_barrier
    v_mfma_f32_16x16x32_bf16 v[116:119], a[192:195], a[160:163], v[116:119]
    ds_read_b64_tr_b16 a[184:185], v8 offset:0
    v_mul_f32 v36, s92, v21
    v_mfma_f32_16x16x32_bf16 v[108:111], a[192:195], a[156:159], v[108:111]
    ds_read_b64_tr_b16 a[186:187], v8 offset:2048
    v_add_f32 v23, 1.0, v23
    v_mfma_f32_16x16x32_bf16 v[108:111], a[196:199], a[172:175], v[108:111]
    s_waitcnt vmcnt(16)
    ds_read_b64_tr_b16 a[188:189], v8 offset:4096
    v_mfma_f32_16x16x32_bf16 v[100:103], a[196:199], a[168:171], v[100:103]
    buffer_load_dwordx4 v3, s[8:11], s38 offen lds
    v_mfma_f32_16x16x32_bf16 v[100:103], a[192:195], a[152:155], v[100:103]
    s_waitcnt vmcnt(10) lgkmcnt(3)
    ds_read_b64_tr_b16 a[190:191], v8 offset:6144
    v_mfma_f32_16x16x32_bf16 v[96:99], a[200:203], a[80:83], v[96:99]
    ds_read_b64_tr_b16 a[192:193], v9 offset:0
    v_mfma_f32_16x16x32_bf16 v[96:99], a[204:207], a[96:99], v[96:99]
    ds_read_b64_tr_b16 a[194:195], v9 offset:2048
    v_mfma_f32_16x16x32_bf16 v[104:107], a[204:207], a[100:103], v[104:107]
    s_waitcnt vmcnt(9)
    ds_read_b64_tr_b16 a[196:197], v9 offset:4096
    s_add_u32 s38, s45, 163840
    v_mfma_f32_16x16x32_bf16 v[104:107], a[200:203], a[84:87], v[104:107]
    s_waitcnt vmcnt(7)
    ds_read_b64_tr_b16 a[198:199], v9 offset:6144
    v_cvt_pk_bf16_f32 v96, v96, v97
    v_mfma_f32_16x16x32_bf16 v[112:115], a[200:203], a[88:91], v[112:115]
    s_addk_i32 m0, -4096
    v_cvt_pk_bf16_f32 v97, v98, v99
    v_mfma_f32_16x16x32_bf16 v[112:115], a[204:207], a[104:107], v[112:115]
    s_xor_b32 s78, s53, 3
    v_cvt_pk_bf16_f32 v104, v104, v105
    v_cvt_pk_bf16_f32 v105, v106, v107
    v_mfma_f32_16x16x32_bf16 v[120:123], a[204:207], a[108:111], v[120:123]
    s_and_b32 s78, s78, 3
    v_exp_f32 v36, v36
    v_mfma_f32_16x16x32_bf16 v[120:123], a[200:203], a[92:95], v[120:123]
    s_mul_i32 s78, s78, 2560
    ds_read_b64_tr_b16 a[200:201], v8 offset:8192
    v_cvt_pk_bf16_f32 v112, v112, v113
    v_mfma_f32_16x16x32_bf16 v[124:127], a[208:211], a[92:95], v[124:127]
    s_add_u32 s78, s78, s60
    ds_read_b64_tr_b16 a[202:203], v8 offset:10240
    v_cvt_pk_bf16_f32 v113, v114, v115
    v_mfma_f32_16x16x32_bf16 v[124:127], a[212:215], a[108:111], v[124:127]
    s_xor_b32 s79, s53, 1
    ds_read_b64_tr_b16 a[204:205], v8 offset:12288
    v_add_f32 v36, 1.0, v36
    v_mfma_f32_16x16x32_bf16 v[116:119], a[212:215], a[104:107], v[116:119]
    s_waitcnt lgkmcnt(3)
    ds_read_b64_tr_b16 a[206:207], v8 offset:14336
    s_and_b32 s79, s79, 3
    v_mfma_f32_16x16x32_bf16 v[116:119], a[208:211], a[88:91], v[116:119]
    buffer_load_dwordx4 v3, s[8:11], s38 offen lds
    v_mfma_f32_16x16x32_bf16 v[108:111], a[208:211], a[84:87], v[108:111]
    s_mul_i32 s79, s79, 2560
    v_rcp_f32 v23, v23
    v_mfma_f32_16x16x32_bf16 v[108:111], a[212:215], a[100:103], v[108:111]
    s_add_u32 s79, s79, s60
    v_rcp_f32 v36, v36
    v_mfma_f32_16x16x32_bf16 v[100:103], a[212:215], a[96:99], v[100:103]
    s_add_u32 s38, s46, 163840
    v_cvt_pk_bf16_f32 v114, v116, v117
    v_cvt_pk_bf16_f32 v115, v118, v119
    v_mfma_f32_16x16x32_bf16 v[100:103], a[208:211], a[80:83], v[100:103]
    ds_read_b64_tr_b16 a[208:209], v9 offset:8192
    v_cvt_pk_bf16_f32 v106, v108, v109
    v_mfma_f32_16x16x32_bf16 v[128:131], a[184:187], a[128:131], v[128:131]
    s_addk_i32 m0, -4096
    ds_read_b64_tr_b16 a[210:211], v9 offset:10240
    v_cvt_pk_bf16_f32 v107, v110, v111
    v_mfma_f32_16x16x32_bf16 v[128:131], a[188:191], a[0:3], v[128:131]
    ds_read_b64_tr_b16 a[212:213], v9 offset:12288
    v_cvt_pk_bf16_f32 v98, v100, v101
    v_mfma_f32_16x16x32_bf16 v[136:139], a[188:191], a[4:7], v[136:139]
    ds_read_b64_tr_b16 a[214:215], v9 offset:14336
    v_cvt_pk_bf16_f32 v99, v102, v103
    v_mfma_f32_16x16x32_bf16 v[136:139], a[184:187], a[132:135], v[136:139]
    buffer_store_dwordx4 v[96:99], v38, s[24:27], s78 offen offset:2048 sc1
    v_mov_b32_dpp v116, v120 row_ror:8 row_mask:0xf bank_mask:0xf
    v_mfma_f32_16x16x32_bf16 v[144:147], a[184:187], a[136:139], v[144:147]
    s_xor_b32 s78, s53, 2
    v_mov_b32_dpp v117, v121 row_ror:8 row_mask:0xf bank_mask:0xf
    v_mov_b32_dpp v118, v122 row_ror:8 row_mask:0xf bank_mask:0xf
    v_mfma_f32_16x16x32_bf16 v[144:147], a[188:191], a[8:11], v[144:147]
    buffer_store_dwordx4 v[104:107], v38, s[24:27], s79 offen offset:2048 sc1
    v_mov_b32_dpp v119, v123 row_ror:8 row_mask:0xf bank_mask:0xf
    v_mfma_f32_16x16x32_bf16 v[152:155], a[188:191], a[12:15], v[152:155]
    buffer_load_dwordx4 v3, s[8:11], s38 offen lds
    v_mfma_f32_16x16x32_bf16 v[152:155], a[184:187], a[140:143], v[152:155]
    s_and_b32 s78, s78, 3
    ds_read_b64_tr_b16 a[184:185], v8 offset:16384
    v_cvt_pk_bf16_f32 v120, v120, v121
    v_mfma_f32_16x16x32_bf16 v[156:159], a[192:195], a[140:143], v[156:159]
    s_mul_i32 s78, s78, 2560
    ds_read_b64_tr_b16 a[186:187], v8 offset:18432
    v_cvt_pk_bf16_f32 v121, v122, v123
    v_mfma_f32_16x16x32_bf16 v[156:159], a[196:199], a[12:15], v[156:159]
    s_add_u32 s78, s78, s60
    ds_read_b64_tr_b16 a[188:189], v8 offset:20480
    v_cvt_pk_bf16_f32 v122, v124, v125
    v_mfma_f32_16x16x32_bf16 v[148:151], a[196:199], a[8:11], v[148:151]
    s_waitcnt lgkmcnt(3)
    ds_read_b64_tr_b16 a[190:191], v8 offset:22528
    v_cvt_pk_bf16_f32 v123, v126, v127
    v_mfma_f32_16x16x32_bf16 v[148:151], a[192:195], a[136:139], v[148:151]
    buffer_store_dwordx4 v[112:115], v38, s[24:27], s78 offen offset:2048 sc1
    v_mul_f32 v20, v20, v23
    v_mfma_f32_16x16x32_bf16 v[140:143], a[192:195], a[132:135], v[140:143]
    s_xor_b32 s79, s53, 0
    v_mul_f32 v21, v21, v36
    v_cvt_pk_bf16_f32 v42, v20, v21
    v_mfma_f32_16x16x32_bf16 v[140:143], a[196:199], a[4:7], v[140:143]
    s_and_b32 s79, s79, 3
    v_lshlrev_b32 v20, 16, v27
    v_and_b32 v21, 0xffff0000, v27
    v_mfma_f32_16x16x32_bf16 v[132:135], a[196:199], a[0:3], v[132:135]
    s_mul_i32 s79, s79, 2560
    v_sub_f32 v20, v20, v16
    v_sub_f32 v21, v21, v16
    v_mfma_f32_16x16x32_bf16 v[132:135], a[192:195], a[128:131], v[132:135]
    s_add_u32 s79, s79, s60
    ds_read_b64_tr_b16 a[192:193], v9 offset:16384
    v_lshlrev_b32 v16, 4, v2
    v_mfma_f32_16x16x32_bf16 v[128:131], a[200:203], a[16:19], v[128:131]
    s_add_u32 s38, s47, 163840
    ds_read_b64_tr_b16 a[194:195], v9 offset:18432
    v_cvt_pk_bf16_f32 v20, 0, v20
    v_mfma_f32_16x16x32_bf16 v[128:131], a[204:207], a[32:35], v[128:131]
    buffer_store_dwordx4 v[120:123], v38, s[24:27], s79 offen offset:2048 sc1
    v_cvt_pk_bf16_f32 v21, 0, v21
    v_mfma_f32_16x16x32_bf16 v[136:139], a[204:207], a[36:39], v[136:139]
    s_addk_i32 m0, -4096
    ds_read_b64_tr_b16 a[196:197], v9 offset:20480
    v_mul_f32 v20, v20, v17
    v_mfma_f32_16x16x32_bf16 v[136:139], a[200:203], a[20:23], v[136:139]
    buffer_load_dwordx4 v3, s[8:11], s38 offen lds
    v_mfma_f32_16x16x32_bf16 v[144:147], a[200:203], a[24:27], v[144:147]
    ds_read_b64_tr_b16 a[198:199], v9 offset:22528
    v_mul_f32 v21, v21, v17
    v_mfma_f32_16x16x32_bf16 v[144:147], a[204:207], a[40:43], v[144:147]
    v_lshlrev_b32 v17, 6, v2
    v_cvt_pk_bf16_f32 v20, 0, v20
    v_mfma_f32_16x16x32_bf16 v[152:155], a[204:207], a[44:47], v[152:155]
    s_add_u32 s38, s45, 204800
    v_cvt_pk_bf16_f32 v21, 0, v21
    v_mul_f32 v23, s92, v20
    v_mfma_f32_16x16x32_bf16 v[152:155], a[200:203], a[28:31], v[152:155]
    v_exp_f32 v23, v23
    v_mfma_f32_16x16x32_bf16 v[156:159], a[208:211], a[28:31], v[156:159]
    s_addk_i32 m0, -4096
    v_mul_f32 v36, s92, v21
    v_add_f32 v23, 1.0, v23
    v_mfma_f32_16x16x32_bf16 v[156:159], a[212:215], a[44:47], v[156:159]
    v_exp_f32 v36, v36
    v_mfma_f32_16x16x32_bf16 v[148:151], a[212:215], a[40:43], v[148:151]
    s_barrier
    v_mfma_f32_16x16x32_bf16 v[148:151], a[208:211], a[24:27], v[148:151]
    s_waitcnt vmcnt(10)
    ds_read_b64_tr_b16 a[200:201], v8 offset:24576
    v_xor_b32 v58, s58, v58
    v_mfma_f32_16x16x32_bf16 v[140:143], a[208:211], a[20:23], v[140:143]
    s_waitcnt vmcnt(9)
    ds_read_b64_tr_b16 a[202:203], v8 offset:26624
    v_xor_b32 v59, s58, v59
    v_mfma_f32_16x16x32_bf16 v[140:143], a[212:215], a[36:39], v[140:143]
    s_waitcnt lgkmcnt(2)
    ds_read_b64_tr_b16 a[204:205], v8 offset:28672
    v_or_b32 v58, v58, v59
    v_mfma_f32_16x16x32_bf16 v[132:135], a[212:215], a[32:35], v[132:135]
    buffer_load_dwordx4 v3, s[8:11], s38 offen lds
    v_mfma_f32_16x16x32_bf16 v[132:135], a[208:211], a[16:19], v[132:135]
    ds_read_b64_tr_b16 a[206:207], v8 offset:30720
    v_cmp_ne_u32 vcc, 0, v58
    v_mfma_f32_16x16x32_bf16 v[128:131], a[184:187], a[48:51], v[128:131]
    s_cbranch_vccnz spin_y
spin_y_ret:
    v_add_f32 v36, 1.0, v36
    v_mfma_f32_16x16x32_bf16 v[128:131], a[188:191], a[64:67], v[128:131]
    ds_read_b64_tr_b16 a[208:209], v9 offset:24576
    v_cndmask_b32 v124, v116, v124, s[74:75]
    v_mfma_f32_16x16x32_bf16 v[136:139], a[188:191], a[68:71], v[136:139]
    s_add_u32 s38, s46, 204800
    ds_read_b64_tr_b16 a[210:211], v9 offset:26624
    v_cndmask_b32 v125, v117, v125, s[74:75]
    v_mfma_f32_16x16x32_bf16 v[136:139], a[184:187], a[52:55], v[136:139]
    ds_read_b64_tr_b16 a[212:213], v9 offset:28672
    v_cndmask_b32 v126, v118, v126, s[74:75]
    v_mfma_f32_16x16x32_bf16 v[144:147], a[184:187], a[56:59], v[144:147]
    s_addk_i32 m0, -4096
    ds_read_b64_tr_b16 a[214:215], v9 offset:30720
    v_cndmask_b32 v127, v119, v127, s[74:75]
    v_mfma_f32_16x16x32_bf16 v[144:147], a[188:191], a[72:75], v[144:147]
    buffer_load_dwordx4 v[116:119], v55, s[24:27], s55 offen sc1
    v_mfma_f32_16x16x32_bf16 v[152:155], a[188:191], a[76:79], v[152:155]
    s_add_u32 s55, s55, 10240
    v_rcp_f32 v23, v23
    v_mfma_f32_16x16x32_bf16 v[152:155], a[184:187], a[60:63], v[152:155]
    buffer_load_dwordx4 v[120:123], v55, s[24:27], s55 offen sc1
    v_mfma_f32_16x16x32_bf16 v[156:159], a[192:195], a[60:63], v[156:159]
    s_add_u32 s55, s55, 10240
    ds_read_b64_tr_b16 a[184:185], v8 offset:32768
    v_mul_f32 v20, v20, v23
    v_mfma_f32_16x16x32_bf16 v[156:159], a[196:199], a[76:79], v[156:159]
    buffer_load_dwordx4 v[56:59], v55, s[24:27], s55 offen sc1
    v_mfma_f32_16x16x32_bf16 v[148:151], a[196:199], a[72:75], v[148:151]
    buffer_load_dwordx4 v3, s[8:11], s38 offen lds
    v_mfma_f32_16x16x32_bf16 v[148:151], a[192:195], a[56:59], v[148:151]
    s_add_u32 s55, s55, 10240
    ds_read_b64_tr_b16 a[186:187], v8 offset:34816
    v_mfma_f32_16x16x32_bf16 v[140:143], a[192:195], a[52:55], v[140:143]
    buffer_load_dwordx4 v[60:63], v55, s[24:27], s55 offen sc1
    v_mfma_f32_16x16x32_bf16 v[140:143], a[196:199], a[68:71], v[140:143]
    s_waitcnt lgkmcnt(2)
    ds_read_b64_tr_b16 a[188:189], v8 offset:36864
    s_add_u32 s55, s55, 10240
    v_mfma_f32_16x16x32_bf16 v[132:135], a[196:199], a[64:67], v[132:135]
    s_add_u32 s38, s47, 204800
    ds_read_b64_tr_b16 a[190:191], v8 offset:38912
    v_mfma_f32_16x16x32_bf16 v[132:135], a[192:195], a[48:51], v[132:135]
    ds_read_b64_tr_b16 a[192:193], v9 offset:32768
    v_mfma_f32_16x16x32_bf16 v[128:131], a[200:203], a[216:219], v[128:131]
    buffer_load_dwordx4 v[64:67], v55, s[24:27], s55 offen sc1
    v_mfma_f32_16x16x32_bf16 v[128:131], a[204:207], a[232:235], v[128:131]
    s_add_u32 s55, s55, 10240
    ds_read_b64_tr_b16 a[194:195], v9 offset:34816
    s_addk_i32 m0, -4096
    v_mfma_f32_16x16x32_bf16 v[136:139], a[204:207], a[236:239], v[136:139]
    ds_read_b64_tr_b16 a[196:197], v9 offset:36864
    v_mfma_f32_16x16x32_bf16 v[136:139], a[200:203], a[220:223], v[136:139]
    ds_read_b64_tr_b16 a[198:199], v9 offset:38912
    v_mfma_f32_16x16x32_bf16 v[144:147], a[200:203], a[224:227], v[144:147]
    buffer_load_dwordx4 v[68:71], v55, s[24:27], s55 offen sc1
    v_mfma_f32_16x16x32_bf16 v[144:147], a[204:207], a[240:243], v[144:147]
    s_add_u32 s55, s55, 10240
    v_rcp_f32 v36, v36
    v_mfma_f32_16x16x32_bf16 v[152:155], a[204:207], a[244:247], v[152:155]
    buffer_load_dwordx4 v3, s[8:11], s38 offen lds
    v_mfma_f32_16x16x32_bf16 v[152:155], a[200:203], a[228:231], v[152:155]
    ds_read_b64_tr_b16 a[200:201], v8 offset:40960
    v_mul_f32 v21, v21, v36
    v_mfma_f32_16x16x32_bf16 v[156:159], a[208:211], a[228:231], v[156:159]
    buffer_load_dwordx4 v[72:75], v55, s[24:27], s55 offen sc1
    v_mfma_f32_16x16x32_bf16 v[156:159], a[212:215], a[244:247], v[156:159]
    s_add_u32 s55, s55, 10240
    ds_read_b64_tr_b16 a[202:203], v8 offset:43008
    v_cvt_pk_bf16_f32 v43, v20, v21
    v_mfma_f32_16x16x32_bf16 v[148:151], a[212:215], a[240:243], v[148:151]
    ds_read_b64_tr_b16 a[204:205], v8 offset:45056
    v_lshlrev_b32 v20, 16, v28
    v_mfma_f32_16x16x32_bf16 v[148:151], a[208:211], a[224:227], v[148:151]
    s_waitcnt lgkmcnt(3)
    ds_read_b64_tr_b16 a[206:207], v8 offset:47104
    v_add_u32 v8, 90112, v8
    v_mfma_f32_16x16x32_bf16 v[140:143], a[208:211], a[220:223], v[140:143]
    buffer_load_dwordx4 v[76:79], v55, s[24:27], s55 offen sc1
    v_mfma_f32_16x16x32_bf16 v[140:143], a[212:215], a[236:239], v[140:143]
    s_add_u32 s55, s55, 10240
    v_and_b32 v21, 0xffff0000, v28
    v_sub_f32 v20, v20, v18
    v_mfma_f32_16x16x32_bf16 v[132:135], a[212:215], a[232:235], v[132:135]
    v_sub_f32 v21, v21, v18
    v_cvt_pk_bf16_f32 v20, 0, v20
    v_mfma_f32_16x16x32_bf16 v[132:135], a[208:211], a[216:219], v[132:135]
    ds_read_b64_tr_b16 a[208:209], v9 offset:40960
    v_cvt_pk_bf16_f32 v21, 0, v21
    v_mfma_f32_16x16x32_bf16 v[128:131], a[184:187], a[152:155], v[128:131]
    buffer_load_dwordx4 v[80:83], v55, s[24:27], s55 offen sc1
    v_mfma_f32_16x16x32_bf16 v[128:131], a[188:191], a[168:171], v[128:131]
    s_add_u32 s55, s55, 10240
    ds_read_b64_tr_b16 a[210:211], v9 offset:43008
    v_mul_f32 v20, v20, v19
    v_mfma_f32_16x16x32_bf16 v[136:139], a[188:191], a[172:175], v[136:139]
    ds_read_b64_tr_b16 a[212:213], v9 offset:45056
    v_mul_f32 v21, v21, v19
    v_mfma_f32_16x16x32_bf16 v[136:139], a[184:187], a[156:159], v[136:139]
    ds_read_b64_tr_b16 a[214:215], v9 offset:47104
    v_add_u32 v9, 90112, v9
    v_mfma_f32_16x16x32_bf16 v[144:147], a[184:187], a[160:163], v[144:147]
    buffer_load_dwordx4 v[84:87], v55, s[24:27], s55 offen sc1
    v_mfma_f32_16x16x32_bf16 v[144:147], a[188:191], a[176:179], v[144:147]
    s_add_u32 s55, s55, 10240
    v_cvt_pk_bf16_f32 v20, 0, v20
    v_cvt_pk_bf16_f32 v21, 0, v21
    v_mfma_f32_16x16x32_bf16 v[152:155], a[188:191], a[180:183], v[152:155]
    v_mul_f32 v23, s92, v20
    v_mul_f32 v36, s92, v21
    v_mfma_f32_16x16x32_bf16 v[152:155], a[184:187], a[164:167], v[152:155]
    ds_read_b64_tr_b16 a[184:185], v10 offset:0
    v_mfma_f32_16x16x32_bf16 v[156:159], a[192:195], a[164:167], v[156:159]
    buffer_load_dwordx4 v[88:91], v55, s[24:27], s55 offen sc1
    v_mfma_f32_16x16x32_bf16 v[156:159], a[196:199], a[180:183], v[156:159]
    s_add_u32 s55, s55, 10240
    ds_read_b64_tr_b16 a[186:187], v10 offset:2048
    v_mfma_f32_16x16x32_bf16 v[148:151], a[196:199], a[176:179], v[148:151]
    ds_read_b64_tr_b16 a[188:189], v10 offset:4096
    v_mfma_f32_16x16x32_bf16 v[148:151], a[192:195], a[160:163], v[148:151]
    s_waitcnt lgkmcnt(3)
    ds_read_b64_tr_b16 a[190:191], v10 offset:6144
    v_mfma_f32_16x16x32_bf16 v[140:143], a[192:195], a[156:159], v[140:143]
    buffer_load_dwordx4 v[92:95], v55, s[24:27], s55 offen sc1
    v_mfma_f32_16x16x32_bf16 v[140:143], a[196:199], a[172:175], v[140:143]
    v_exp_f32 v23, v23
    v_mfma_f32_16x16x32_bf16 v[132:135], a[196:199], a[168:171], v[132:135]
    v_exp_f32 v36, v36
    v_mfma_f32_16x16x32_bf16 v[132:135], a[192:195], a[152:155], v[132:135]
    ds_read_b64_tr_b16 a[192:193], v11 offset:0
    v_add_f32 v23, 1.0, v23
    v_mfma_f32_16x16x32_bf16 v[128:131], a[200:203], a[80:83], v[128:131]
    ds_read_b64_tr_b16 a[194:195], v11 offset:2048
    v_add_f32 v36, 1.0, v36
    v_mfma_f32_16x16x32_bf16 v[128:131], a[204:207], a[96:99], v[128:131]
    ds_read_b64_tr_b16 a[196:197], v11 offset:4096
    v_mfma_f32_16x16x32_bf16 v[136:139], a[204:207], a[100:103], v[136:139]
    s_load_dwordx8 s[28:35], s[86:87], s93 glc
    ds_read_b64_tr_b16 a[198:199], v11 offset:6144
    v_mfma_f32_16x16x32_bf16 v[136:139], a[200:203], a[84:87], v[136:139]
    v_rcp_f32 v23, v23
    v_mfma_f32_16x16x32_bf16 v[144:147], a[200:203], a[88:91], v[144:147]
    v_rcp_f32 v36, v36
    v_mfma_f32_16x16x32_bf16 v[144:147], a[204:207], a[104:107], v[144:147]
    s_xor_b32 s78, s53, 7
    v_cvt_pk_bf16_f32 v128, v128, v129
    v_cvt_pk_bf16_f32 v129, v130, v131
    v_mfma_f32_16x16x32_bf16 v[152:155], a[204:207], a[108:111], v[152:155]
    s_mul_i32 s78, s78, 2560
    v_cvt_pk_bf16_f32 v136, v136, v137
    v_cvt_pk_bf16_f32 v137, v138, v139
    v_mfma_f32_16x16x32_bf16 v[152:155], a[200:203], a[92:95], v[152:155]
    s_add_u32 s78, s78, s60
    ds_read_b64_tr_b16 a[200:201], v10 offset:8192
    v_cvt_pk_bf16_f32 v144, v144, v145
    v_mfma_f32_16x16x32_bf16 v[156:159], a[208:211], a[92:95], v[156:159]
    s_xor_b32 s79, s53, 6
    ds_read_b64_tr_b16 a[202:203], v10 offset:10240
    v_cvt_pk_bf16_f32 v145, v146, v147
    v_mfma_f32_16x16x32_bf16 v[156:159], a[212:215], a[108:111], v[156:159]
    s_mul_i32 s79, s79, 2560
    ds_read_b64_tr_b16 a[204:205], v10 offset:12288
    v_cvt_pk_bf16_f32 v152, v152, v153
    v_mfma_f32_16x16x32_bf16 v[148:151], a[212:215], a[104:107], v[148:151]
    s_waitcnt lgkmcnt(5)
    ds_read_b64_tr_b16 a[206:207], v10 offset:14336
    v_cvt_pk_bf16_f32 v153, v154, v155
    v_mfma_f32_16x16x32_bf16 v[148:151], a[208:211], a[88:91], v[148:151]
    s_add_u32 s79, s79, s60
    v_cvt_pk_bf16_f32 v154, v156, v157
    v_cvt_pk_bf16_f32 v155, v158, v159
    v_mfma_f32_16x16x32_bf16 v[140:143], a[208:211], a[84:87], v[140:143]
    s_lshl_b32 s56, s3, 9
    v_mul_f32 v20, v20, v23
    v_mul_f32 v21, v21, v36
    v_mfma_f32_16x16x32_bf16 v[140:143], a[212:215], a[100:103], v[140:143]
    s_add_u32 s56, s56, 61440
    v_cvt_pk_bf16_f32 v146, v148, v149
    v_cvt_pk_bf16_f32 v147, v150, v151
    v_mfma_f32_16x16x32_bf16 v[132:135], a[212:215], a[96:99], v[132:135]
    v_cvt_pk_bf16_f32 v44, v20, v21
    v_lshlrev_b32 v20, 16, v29
    v_mfma_f32_16x16x32_bf16 v[132:135], a[208:211], a[80:83], v[132:135]
    ds_read_b64_tr_b16 a[208:209], v11 offset:8192
    v_cvt_pk_bf16_f32 v138, v140, v141
    v_mfma_f32_16x16x32_bf16 v[160:163], a[184:187], a[128:131], v[160:163]
    ds_read_b64_tr_b16 a[210:211], v11 offset:10240
    v_cvt_pk_bf16_f32 v139, v142, v143
    v_mfma_f32_16x16x32_bf16 v[160:163], a[188:191], a[0:3], v[160:163]
    ds_read_b64_tr_b16 a[212:213], v11 offset:12288
    v_and_b32 v21, 0xffff0000, v29
    v_mfma_f32_16x16x32_bf16 v[168:171], a[188:191], a[4:7], v[168:171]
    ds_read_b64_tr_b16 a[214:215], v11 offset:14336
    v_cvt_pk_bf16_f32 v130, v132, v133
    v_mfma_f32_16x16x32_bf16 v[168:171], a[184:187], a[132:135], v[168:171]
    v_cvt_pk_bf16_f32 v131, v134, v135
    v_sub_f32 v20, v20, v18
    v_mfma_f32_16x16x32_bf16 v[176:179], a[184:187], a[136:139], v[176:179]
    buffer_store_dwordx4 v[128:131], v14, s[24:27], s78 offen offset:1024 sc1
    v_sub_f32 v21, v21, v18
    v_mfma_f32_16x16x32_bf16 v[176:179], a[188:191], a[8:11], v[176:179]
    buffer_store_dwordx4 v[136:139], v14, s[24:27], s78 offen offset:0 sc1
    v_cvt_pk_bf16_f32 v20, 0, v20
    v_mfma_f32_16x16x32_bf16 v[184:187], a[188:191], a[12:15], v[184:187]
    s_waitcnt lgkmcnt(5)
    v_cvt_pk_bf16_f32 v21, 0, v21
    v_mul_f32 v20, v20, v19
    v_mfma_f32_16x16x32_bf16 v[184:187], a[184:187], a[140:143], v[184:187]
    ds_read_b64_tr_b16 a[184:185], v10 offset:16384
    v_mul_f32 v21, v21, v19
    v_mfma_f32_16x16x32_bf16 v[188:191], a[192:195], a[140:143], v[188:191]
    ds_read_b64_tr_b16 a[186:187], v10 offset:18432
    v_cvt_pk_bf16_f32 v20, 0, v20
    v_mfma_f32_16x16x32_bf16 v[188:191], a[196:199], a[12:15], v[188:191]
    ds_read_b64_tr_b16 a[188:189], v10 offset:20480
    v_cvt_pk_bf16_f32 v21, 0, v21
    v_mfma_f32_16x16x32_bf16 v[180:183], a[196:199], a[8:11], v[180:183]
    ds_read_b64_tr_b16 a[190:191], v10 offset:22528
    v_mul_f32 v23, s92, v20
    v_mfma_f32_16x16x32_bf16 v[180:183], a[192:195], a[136:139], v[180:183]
    buffer_store_dwordx4 v[144:147], v14, s[24:27], s79 offen offset:1024 sc1
    v_mul_f32 v36, s92, v21
    v_mfma_f32_16x16x32_bf16 v[172:175], a[192:195], a[132:135], v[172:175]
    v_exp_f32 v23, v23
    v_mfma_f32_16x16x32_bf16 v[172:175], a[196:199], a[4:7], v[172:175]
    s_or_b64 s[88:89], s[28:29], s[30:31]
    v_exp_f32 v36, v36
    v_mfma_f32_16x16x32_bf16 v[164:167], a[196:199], a[0:3], v[164:167]
    s_waitcnt lgkmcnt(5)
    v_add_f32 v23, 1.0, v23
    v_add_f32 v36, 1.0, v36
    v_mfma_f32_16x16x32_bf16 v[164:167], a[192:195], a[128:131], v[164:167]
    s_or_b64 s[88:89], s[88:89], s[32:33]
    ds_read_b64_tr_b16 a[192:193], v11 offset:16384
    v_cmp_eq_u32 s[8:9], s39, v5
    v_mfma_f32_16x16x32_bf16 v[160:163], a[200:203], a[16:19], v[160:163]
    s_load_dwordx8 s[28:35], s[86:87], s93 glc
    ds_read_b64_tr_b16 a[194:195], v11 offset:18432
    v_cmp_eq_u32 s[20:21], s40, v5
    v_mfma_f32_16x16x32_bf16 v[160:163], a[204:207], a[32:35], v[160:163]
    buffer_store_dwordx4 v[152:155], v14, s[24:27], s79 offen offset:0 sc1
    v_lshl_add_u32 v12, v1, 3, s56
    v_mfma_f32_16x16x32_bf16 v[168:171], a[204:207], a[36:39], v[168:171]
    s_or_b64 s[88:89], s[88:89], s[34:35]
    ds_read_b64_tr_b16 a[196:197], v11 offset:20480
    s_or_b32 s66, s88, s89
    v_mfma_f32_16x16x32_bf16 v[168:171], a[200:203], a[20:23], v[168:171]
pg_15:
    s_cbranch_execz pg_back
    s_andn2_b32 s69, s66, s80
    s_cselect_b32 s65, s59, 0x70000000
    s_ff1_i32_b32 s69, s69
    v_mfma_f32_16x16x32_bf16 v[176:179], a[200:203], a[24:27], v[176:179]
    s_xor_b32 s81, s53, s69
    ds_read_b64_tr_b16 a[198:199], v11 offset:22528
    s_mul_i32 s81, s81, 20480
    v_mfma_f32_16x16x32_bf16 v[176:179], a[204:207], a[40:43], v[176:179]
    s_add_u32 s81, s81, s65
    v_rcp_f32 v23, v23
    v_mfma_f32_16x16x32_bf16 v[184:187], a[204:207], a[44:47], v[184:187]
    s_waitcnt lgkmcnt(7)
    v_rcp_f32 v36, v36
    v_mfma_f32_16x16x32_bf16 v[184:187], a[200:203], a[28:31], v[184:187]
    s_bitset1_b32 s80, s69
    ds_read_b64_tr_b16 a[200:201], v10 offset:24576
    v_mul_f32 v20, v20, v23
    v_mfma_f32_16x16x32_bf16 v[188:191], a[208:211], a[28:31], v[188:191]
    s_waitcnt vmcnt(16)
    ds_read_b64_tr_b16 a[202:203], v10 offset:26624
    v_mul_f32 v21, v21, v36
    v_mfma_f32_16x16x32_bf16 v[188:191], a[212:215], a[44:47], v[188:191]
    s_or_b64 s[8:9], s[8:9], s[20:21]
    ds_read_b64_tr_b16 a[204:205], v10 offset:28672
    v_cvt_pk_bf16_f32 v45, v20, v21
    v_mfma_f32_16x16x32_bf16 v[180:183], a[212:215], a[40:43], v[180:183]
    ds_read_b64_tr_b16 a[206:207], v10 offset:30720
    v_lshlrev_b32 v20, 16, v30
    v_mfma_f32_16x16x32_bf16 v[180:183], a[208:211], a[24:27], v[180:183]
    s_waitcnt lgkmcnt(8)
    v_and_b32 v21, 0xffff0000, v30
    v_sub_f32 v20, v20, v18
    v_mfma_f32_16x16x32_bf16 v[172:175], a[208:211], a[20:23], v[172:175]
    v_sub_f32 v21, v21, v18
    v_cvt_pk_bf16_f32 v20, 0, v20
    v_mfma_f32_16x16x32_bf16 v[172:175], a[212:215], a[36:39], v[172:175]
    v_cvt_pk_bf16_f32 v21, 0, v21
    v_mul_f32 v20, v20, v19
    v_mfma_f32_16x16x32_bf16 v[164:167], a[212:215], a[32:35], v[164:167]
    v_mul_f32 v21, v21, v19
    v_cvt_pk_bf16_f32 v20, 0, v20
    v_mfma_f32_16x16x32_bf16 v[164:167], a[208:211], a[16:19], v[164:167]
    buffer_load_dwordx4 v[98:101], v14, s[24:27], s81 offen sc1
    v_mfma_f32_16x16x32_bf16 v[160:163], a[184:187], a[48:51], v[160:163]
    ds_read_b64_tr_b16 a[208:209], v11 offset:24576
    v_cvt_pk_bf16_f32 v21, 0, v21
    v_mfma_f32_16x16x32_bf16 v[160:163], a[188:191], a[64:67], v[160:163]
    ds_read_b64_tr_b16 a[210:211], v11 offset:26624
    v_mul_f32 v23, s92, v20
    v_mfma_f32_16x16x32_bf16 v[168:171], a[188:191], a[68:71], v[168:171]
    buffer_load_dwordx4 v[102:105], v14, s[24:27], s81 offen offset:1024 sc1
    v_mfma_f32_16x16x32_bf16 v[168:171], a[184:187], a[52:55], v[168:171]
    ds_read_b64_tr_b16 a[212:213], v11 offset:28672
    v_mul_f32 v36, s92, v21
    v_mfma_f32_16x16x32_bf16 v[176:179], a[184:187], a[56:59], v[176:179]
    s_waitcnt lgkmcnt(7)
    ds_read_b64_tr_b16 a[214:215], v11 offset:30720
    v_add_f32 v116, v116, v120
    v_mfma_f32_16x16x32_bf16 v[176:179], a[188:191], a[72:75], v[176:179]
    buffer_load_dwordx2 v[96:97], v39, s[24:27], s81 offen offset:2048 sc1
    v_mfma_f32_16x16x32_bf16 v[184:187], a[188:191], a[76:79], v[184:187]
    s_waitcnt vmcnt(18)
    v_exp_f32 v23, v23
    v_mfma_f32_16x16x32_bf16 v[184:187], a[184:187], a[60:63], v[184:187]
    ds_read_b64_tr_b16 a[184:185], v10 offset:32768
    v_add_f32 v23, 1.0, v23
    v_mfma_f32_16x16x32_bf16 v[188:191], a[192:195], a[60:63], v[188:191]
    ds_read_b64_tr_b16 a[186:187], v10 offset:34816
    v_add_f32 v117, v117, v121
    v_mfma_f32_16x16x32_bf16 v[188:191], a[196:199], a[76:79], v[188:191]
    ds_read_b64_tr_b16 a[188:189], v10 offset:36864
    v_add_f32 v118, v118, v122
    v_mfma_f32_16x16x32_bf16 v[180:183], a[196:199], a[72:75], v[180:183]
    s_waitcnt lgkmcnt(6)
    ds_read_b64_tr_b16 a[190:191], v10 offset:38912
    v_add_f32 v119, v119, v123
    v_mfma_f32_16x16x32_bf16 v[180:183], a[192:195], a[56:59], v[180:183]
    v_exp_f32 v36, v36
    v_mfma_f32_16x16x32_bf16 v[172:175], a[192:195], a[52:55], v[172:175]
    v_rcp_f32 v23, v23
    v_mfma_f32_16x16x32_bf16 v[172:175], a[196:199], a[68:71], v[172:175]
    v_add_f32 v36, 1.0, v36
    v_mul_f32 v20, v20, v23
    v_mfma_f32_16x16x32_bf16 v[164:167], a[196:199], a[64:67], v[164:167]
    v_rcp_f32 v36, v36
    v_mfma_f32_16x16x32_bf16 v[164:167], a[192:195], a[48:51], v[164:167]
    ds_read_b64_tr_b16 a[192:193], v11 offset:32768
    v_mul_f32 v21, v21, v36
    v_mfma_f32_16x16x32_bf16 v[160:163], a[200:203], a[216:219], v[160:163]
    s_or_b64 s[88:89], s[28:29], s[30:31]
    ds_read_b64_tr_b16 a[194:195], v11 offset:34816
    v_cvt_pk_bf16_f32 v46, v20, v21
    v_mfma_f32_16x16x32_bf16 v[160:163], a[204:207], a[232:235], v[160:163]
    s_or_b64 s[88:89], s[88:89], s[32:33]
    ds_read_b64_tr_b16 a[196:197], v11 offset:36864
    v_lshlrev_b32 v20, 16, v31
    v_mfma_f32_16x16x32_bf16 v[168:171], a[204:207], a[236:239], v[168:171]
    s_or_b64 s[88:89], s[88:89], s[34:35]
    ds_read_b64_tr_b16 a[198:199], v11 offset:38912
    v_and_b32 v21, 0xffff0000, v31
    v_mfma_f32_16x16x32_bf16 v[168:171], a[200:203], a[220:223], v[168:171]
    s_waitcnt lgkmcnt(6)
    v_sub_f32 v20, v20, v18
    v_sub_f32 v21, v21, v18
    v_mfma_f32_16x16x32_bf16 v[176:179], a[200:203], a[224:227], v[176:179]
    s_or_b32 s66, s88, s89
    v_cvt_pk_bf16_f32 v20, 0, v20
    v_cvt_pk_bf16_f32 v21, 0, v21
    v_mfma_f32_16x16x32_bf16 v[176:179], a[204:207], a[240:243], v[176:179]
    v_mul_f32 v20, v20, v19
    v_mul_f32 v21, v21, v19
    v_mfma_f32_16x16x32_bf16 v[184:187], a[204:207], a[244:247], v[184:187]
    s_andn2_b32 s69, s66, s80
    s_cselect_b32 s65, s59, 0x70000000
    v_cvt_pk_bf16_f32 v20, 0, v20
    v_mfma_f32_16x16x32_bf16 v[184:187], a[200:203], a[228:231], v[184:187]
    s_ff1_i32_b32 s69, s69
    ds_read_b64_tr_b16 a[200:201], v10 offset:40960
    v_cvt_pk_bf16_f32 v21, 0, v21
    v_mfma_f32_16x16x32_bf16 v[188:191], a[208:211], a[228:231], v[188:191]
    s_xor_b32 s72, s53, s69
    ds_read_b64_tr_b16 a[202:203], v10 offset:43008
    v_mul_f32 v23, s92, v20
    v_mfma_f32_16x16x32_bf16 v[188:191], a[212:215], a[244:247], v[188:191]
    s_mul_i32 s72, s72, 20480
    ds_read_b64_tr_b16 a[204:205], v10 offset:45056
    v_mul_f32 v36, s92, v21
    v_mfma_f32_16x16x32_bf16 v[180:183], a[212:215], a[240:243], v[180:183]
    s_add_u32 s72, s72, s65
    ds_read_b64_tr_b16 a[206:207], v10 offset:47104
    v_add_u32 v10, 90112, v10
    v_mfma_f32_16x16x32_bf16 v[180:183], a[208:211], a[224:227], v[180:183]
    s_bitset1_b32 s80, s69
    v_exp_f32 v23, v23
    v_mfma_f32_16x16x32_bf16 v[172:175], a[208:211], a[220:223], v[172:175]
    v_exp_f32 v36, v36
    v_mfma_f32_16x16x32_bf16 v[172:175], a[212:215], a[236:239], v[172:175]
    v_add_f32 v23, 1.0, v23
    v_add_f32 v36, 1.0, v36
    v_mfma_f32_16x16x32_bf16 v[164:167], a[212:215], a[232:235], v[164:167]
    s_waitcnt lgkmcnt(5)
    v_rcp_f32 v23, v23
    v_mfma_f32_16x16x32_bf16 v[164:167], a[208:211], a[216:219], v[164:167]
    ds_read_b64_tr_b16 a[208:209], v11 offset:40960
    v_mul_f32 v20, v20, v23
    v_mfma_f32_16x16x32_bf16 v[160:163], a[184:187], a[152:155], v[160:163]
    ds_read_b64_tr_b16 a[210:211], v11 offset:43008
    v_add_f32 v116, v116, v56
    v_mfma_f32_16x16x32_bf16 v[160:163], a[188:191], a[168:171], v[160:163]
    s_waitcnt vmcnt(16)
    ds_read_b64_tr_b16 a[212:213], v11 offset:45056
    v_add_f32 v117, v117, v57
    v_mfma_f32_16x16x32_bf16 v[168:171], a[188:191], a[172:175], v[168:171]
    buffer_load_dwordx4 v[108:111], v14, s[24:27], s72 offen sc1
    v_mfma_f32_16x16x32_bf16 v[168:171], a[184:187], a[156:159], v[168:171]
    s_waitcnt vmcnt(4)
    ds_read_b64_tr_b16 a[214:215], v11 offset:47104
    v_add_u32 v11, 90112, v11
    v_mfma_f32_16x16x32_bf16 v[176:179], a[184:187], a[160:163], v[176:179]
    buffer_store_dword v17, v7, s[24:27], s67 offen offset:24 sc1
    v_mfma_f32_16x16x32_bf16 v[176:179], a[188:191], a[176:179], v[176:179]
    buffer_load_dwordx4 v[112:115], v14, s[24:27], s72 offen offset:1024 sc1
    v_mfma_f32_16x16x32_bf16 v[184:187], a[188:191], a[180:183], v[184:187]
    s_waitcnt lgkmcnt(3)
    v_lshlrev_b32 v17, 2, v2
    v_add_f32 v118, v118, v58
    v_mfma_f32_16x16x32_bf16 v[184:187], a[184:187], a[164:167], v[184:187]
    s_xor_b32 s67, s50, 1
    v_rcp_f32 v36, v36
    v_mfma_f32_16x16x32_bf16 v[188:191], a[192:195], a[164:167], v[188:191]
    buffer_load_dwordx2 v[106:107], v39, s[24:27], s72 offen offset:2048 sc1
    v_mfma_f32_16x16x32_bf16 v[188:191], a[196:199], a[180:183], v[188:191]
    s_lshl_b32 s67, s67, 10
    v_mul_f32 v21, v21, v36
    v_cvt_pk_bf16_f32 v47, v20, v21
    v_mfma_f32_16x16x32_bf16 v[180:183], a[196:199], a[176:179], v[180:183]
    s_barrier
    v_mfma_f32_16x16x32_bf16 v[180:183], a[192:195], a[160:163], v[180:183]
    s_add_u32 s67, s61, s67
    ds_read_b64_tr_b16 a[184:185], v8 offset:45056
    v_add_f32 v119, v119, v59
    v_mfma_f32_16x16x32_bf16 v[172:175], a[192:195], a[156:159], v[172:175]
    ds_read_b64_tr_b16 a[186:187], v8 offset:47104
    v_add_f32 v116, v116, v60
    v_mfma_f32_16x16x32_bf16 v[172:175], a[196:199], a[172:175], v[172:175]
    ds_read_b64_tr_b16 a[188:189], v8 offset:40960
    v_add_f32 v117, v117, v61
    v_mfma_f32_16x16x32_bf16 v[164:167], a[196:199], a[168:171], v[164:167]
    ds_read_b64_tr_b16 a[190:191], v8 offset:43008
    v_add_f32 v118, v118, v62
    v_mfma_f32_16x16x32_bf16 v[164:167], a[192:195], a[152:155], v[164:167]
    ds_read_b64_tr_b16 a[192:193], v9 offset:45056
    v_add_f32 v119, v119, v63
    v_mfma_f32_16x16x32_bf16 v[160:163], a[200:203], a[80:83], v[160:163]
    s_load_dwordx8 s[28:35], s[86:87], s93 glc
    ds_read_b64_tr_b16 a[194:195], v9 offset:47104
    v_add_f32 v116, v116, v64
    v_mfma_f32_16x16x32_bf16 v[160:163], a[204:207], a[96:99], v[160:163]
    ds_read_b64_tr_b16 a[196:197], v9 offset:40960
    v_add_f32 v117, v117, v65
    v_mfma_f32_16x16x32_bf16 v[168:171], a[204:207], a[100:103], v[168:171]
    ds_read_b64_tr_b16 a[198:199], v9 offset:43008
    v_add_f32 v118, v118, v66
    v_mfma_f32_16x16x32_bf16 v[168:171], a[200:203], a[84:87], v[168:171]
    s_waitcnt lgkmcnt(8)
    v_add_f32 v119, v119, v67
    v_cvt_pk_bf16_f32 v160, v160, v161
    v_mfma_f32_16x16x32_bf16 v[176:179], a[200:203], a[88:91], v[176:179]
    v_cvt_pk_bf16_f32 v161, v162, v163
    v_add_f32 v116, v116, v68
    v_mfma_f32_16x16x32_bf16 v[176:179], a[204:207], a[104:107], v[176:179]
    s_xor_b32 s78, s53, 5
    v_cvt_pk_bf16_f32 v168, v168, v169
    v_cvt_pk_bf16_f32 v169, v170, v171
    v_mfma_f32_16x16x32_bf16 v[184:187], a[204:207], a[108:111], v[184:187]
    s_mul_i32 s78, s78, 2560
    v_add_f32 v117, v117, v69
    v_add_f32 v118, v118, v70
    v_mfma_f32_16x16x32_bf16 v[184:187], a[200:203], a[92:95], v[184:187]
    s_add_u32 s78, s78, s60
    ds_read_b64_tr_b16 a[200:201], v8 offset:36864
    v_cvt_pk_bf16_f32 v176, v176, v177
    v_mfma_f32_16x16x32_bf16 v[188:191], a[208:211], a[92:95], v[188:191]
    s_xor_b32 s79, s53, 4
    ds_read_b64_tr_b16 a[202:203], v8 offset:38912
    v_cvt_pk_bf16_f32 v177, v178, v179
    v_mfma_f32_16x16x32_bf16 v[188:191], a[212:215], a[108:111], v[188:191]
    s_mul_i32 s79, s79, 2560
    ds_read_b64_tr_b16 a[204:205], v8 offset:32768
    v_cvt_pk_bf16_f32 v184, v184, v185
    v_mfma_f32_16x16x32_bf16 v[180:183], a[212:215], a[104:107], v[180:183]
    s_waitcnt lgkmcnt(5)
    ds_read_b64_tr_b16 a[206:207], v8 offset:34816
    v_cvt_pk_bf16_f32 v185, v186, v187
    v_mfma_f32_16x16x32_bf16 v[180:183], a[208:211], a[88:91], v[180:183]
    s_add_u32 s79, s79, s60
    v_cvt_pk_bf16_f32 v186, v188, v189
    v_cvt_pk_bf16_f32 v187, v190, v191
    v_mfma_f32_16x16x32_bf16 v[172:175], a[208:211], a[84:87], v[172:175]
    v_add_f32 v119, v119, v71
    v_add_f32 v116, v116, v72
    v_mfma_f32_16x16x32_bf16 v[172:175], a[212:215], a[100:103], v[172:175]
    v_add_f32 v117, v117, v73
    v_cvt_pk_bf16_f32 v178, v180, v181
    v_mfma_f32_16x16x32_bf16 v[164:167], a[212:215], a[96:99], v[164:167]
    v_cvt_pk_bf16_f32 v179, v182, v183
    v_add_f32 v118, v118, v74
    v_mfma_f32_16x16x32_bf16 v[164:167], a[208:211], a[80:83], v[164:167]
    ds_read_b64_tr_b16 a[208:209], v9 offset:36864
    v_add_f32 v119, v119, v75
    v_mfma_f32_16x16x32_bf16 v[192:195], a[184:187], a[128:131], v[192:195]
    ds_read_b64_tr_b16 a[210:211], v9 offset:38912
    v_cvt_pk_bf16_f32 v170, v172, v173
    v_mfma_f32_16x16x32_bf16 v[192:195], a[188:191], a[0:3], v[192:195]
    ds_read_b64_tr_b16 a[212:213], v9 offset:32768
    v_cvt_pk_bf16_f32 v171, v174, v175
    v_mfma_f32_16x16x32_bf16 v[200:203], a[188:191], a[4:7], v[200:203]
    ds_read_b64_tr_b16 a[214:215], v9 offset:34816
    v_cvt_pk_bf16_f32 v162, v164, v165
    v_mfma_f32_16x16x32_bf16 v[200:203], a[184:187], a[132:135], v[200:203]
    v_cvt_pk_bf16_f32 v163, v166, v167
    v_add_f32 v116, v116, v76
    v_mfma_f32_16x16x32_bf16 v[208:211], a[184:187], a[136:139], v[208:211]
    buffer_store_dwordx4 v[160:163], v14, s[24:27], s78 offen offset:0 sc1
    v_add_f32 v117, v117, v77
    v_mfma_f32_16x16x32_bf16 v[208:211], a[188:191], a[8:11], v[208:211]
    buffer_store_dwordx4 v[168:171], v14, s[24:27], s78 offen offset:1024 sc1
    v_add_f32 v118, v118, v78
    v_mfma_f32_16x16x32_bf16 v[216:219], a[188:191], a[12:15], v[216:219]
    s_waitcnt lgkmcnt(5)
    v_add_f32 v119, v119, v79
    v_add_f32 v116, v116, v80
    v_mfma_f32_16x16x32_bf16 v[216:219], a[184:187], a[140:143], v[216:219]
    ds_read_b64_tr_b16 a[184:185], v8 offset:28672
    v_add_f32 v117, v117, v81
    v_mfma_f32_16x16x32_bf16 v[220:223], a[192:195], a[140:143], v[220:223]
    ds_read_b64_tr_b16 a[186:187], v8 offset:30720
    v_add_f32 v118, v118, v82
    v_mfma_f32_16x16x32_bf16 v[220:223], a[196:199], a[12:15], v[220:223]
    ds_read_b64_tr_b16 a[188:189], v8 offset:24576
    v_add_f32 v119, v119, v83
    v_mfma_f32_16x16x32_bf16 v[212:215], a[196:199], a[8:11], v[212:215]
    ds_read_b64_tr_b16 a[190:191], v8 offset:26624
    v_add_f32 v116, v116, v84
    v_mfma_f32_16x16x32_bf16 v[212:215], a[192:195], a[136:139], v[212:215]
    buffer_store_dwordx4 v[176:179], v14, s[24:27], s79 offen offset:0 sc1
    v_add_f32 v117, v117, v85
    v_mfma_f32_16x16x32_bf16 v[204:207], a[192:195], a[132:135], v[204:207]
    s_or_b64 s[88:89], s[28:29], s[30:31]
    v_add_f32 v118, v118, v86
    v_add_f32 v119, v119, v87
    v_mfma_f32_16x16x32_bf16 v[204:207], a[196:199], a[4:7], v[204:207]
    s_or_b64 s[88:89], s[88:89], s[32:33]
    v_add_f32 v116, v116, v88
    v_add_f32 v117, v117, v89
    v_mfma_f32_16x16x32_bf16 v[196:199], a[196:199], a[0:3], v[196:199]
    s_waitcnt lgkmcnt(5)
    v_add_f32 v118, v118, v90
    v_add_f32 v119, v119, v91
    v_mfma_f32_16x16x32_bf16 v[196:199], a[192:195], a[128:131], v[196:199]
    s_load_dwordx8 s[28:35], s[86:87], s93 glc
    ds_read_b64_tr_b16 a[192:193], v9 offset:28672
    v_add_f32 v116, v116, v92
    v_mfma_f32_16x16x32_bf16 v[192:195], a[200:203], a[16:19], v[192:195]
    s_or_b64 s[88:89], s[88:89], s[34:35]
    ds_read_b64_tr_b16 a[194:195], v9 offset:30720
    v_add_f32 v117, v117, v93
    v_mfma_f32_16x16x32_bf16 v[192:195], a[204:207], a[32:35], v[192:195]
    buffer_store_dwordx4 v[184:187], v14, s[24:27], s79 offen offset:1024 sc1
    v_add_f32 v118, v118, v94
    v_mfma_f32_16x16x32_bf16 v[200:203], a[204:207], a[36:39], v[200:203]
    s_or_b32 s66, s88, s89
    ds_read_b64_tr_b16 a[196:197], v9 offset:24576
    v_add_f32 v119, v119, v95
    v_mfma_f32_16x16x32_bf16 v[200:203], a[200:203], a[20:23], v[200:203]
    s_andn2_b32 s69, s66, s80
    s_cselect_b32 s65, s59, 0x70000000
    v_mov_b32 v120, v116
    v_mfma_f32_16x16x32_bf16 v[208:211], a[200:203], a[24:27], v[208:211]
    s_ff1_i32_b32 s69, s69
    ds_read_b64_tr_b16 a[198:199], v9 offset:26624
    v_mov_b32 v121, v117
    v_mfma_f32_16x16x32_bf16 v[208:211], a[204:207], a[40:43], v[208:211]
    s_xor_b32 s73, s53, s69
    v_permlane16_swap_b32 v116, v120
    v_mfma_f32_16x16x32_bf16 v[216:219], a[204:207], a[44:47], v[216:219]
    s_waitcnt lgkmcnt(7)
    v_permlane16_swap_b32 v117, v121
    v_mfma_f32_16x16x32_bf16 v[216:219], a[200:203], a[28:31], v[216:219]
    s_mul_i32 s73, s73, 20480
    v_mov_b32 v122, v118
    v_mov_b32 v123, v119
    v_mfma_f32_16x16x32_bf16 v[220:223], a[208:211], a[28:31], v[220:223]
    s_add_u32 s73, s73, s65
    v_permlane16_swap_b32 v118, v122
    v_mfma_f32_16x16x32_bf16 v[220:223], a[212:215], a[44:47], v[220:223]
    s_bitset1_b32 s80, s69
    v_permlane16_swap_b32 v119, v123
    v_mfma_f32_16x16x32_bf16 v[212:215], a[212:215], a[40:43], v[212:215]
    s_barrier
    v_mfma_f32_16x16x32_bf16 v[212:215], a[208:211], a[24:27], v[212:215]
    ds_read_b64_tr_b16 a[200:201], v8 offset:20480
    v_add_f32 v116, v116, v120
    v_mfma_f32_16x16x32_bf16 v[204:207], a[208:211], a[20:23], v[204:207]
    ds_read_b64_tr_b16 a[202:203], v8 offset:22528
    v_add_f32 v117, v117, v121
    v_mfma_f32_16x16x32_bf16 v[204:207], a[212:215], a[36:39], v[204:207]
    s_waitcnt lgkmcnt(6)
    ds_read_b64_tr_b16 a[204:205], v8 offset:16384
    v_add_f32 v118, v118, v122
    v_mfma_f32_16x16x32_bf16 v[196:199], a[212:215], a[32:35], v[196:199]
    buffer_load_dwordx4 v[130:133], v14, s[24:27], s73 offen sc1
    v_mfma_f32_16x16x32_bf16 v[196:199], a[208:211], a[16:19], v[196:199]
    ds_read_b64_tr_b16 a[206:207], v8 offset:18432
    v_add_f32 v119, v119, v123
    v_mfma_f32_16x16x32_bf16 v[192:195], a[184:187], a[48:51], v[192:195]
    ds_read_b64_tr_b16 a[208:209], v9 offset:20480
    v_cvt_pk_bf16_f32 v116, 0, v116
    v_mfma_f32_16x16x32_bf16 v[192:195], a[188:191], a[64:67], v[192:195]
    buffer_load_dwordx4 v[134:137], v14, s[24:27], s73 offen offset:1024 sc1
    v_mfma_f32_16x16x32_bf16 v[200:203], a[188:191], a[68:71], v[200:203]
    ds_read_b64_tr_b16 a[210:211], v9 offset:22528
    v_cvt_pk_bf16_f32 v117, 0, v117
    v_mfma_f32_16x16x32_bf16 v[200:203], a[184:187], a[52:55], v[200:203]
    ds_read_b64_tr_b16 a[212:213], v9 offset:16384
    v_cvt_pk_bf16_f32 v118, 0, v118
    v_mfma_f32_16x16x32_bf16 v[208:211], a[184:187], a[56:59], v[208:211]
    s_waitcnt lgkmcnt(6)
    ds_read_b64_tr_b16 a[214:215], v9 offset:18432
    v_cvt_pk_bf16_f32 v119, 0, v119
    v_mfma_f32_16x16x32_bf16 v[208:211], a[188:191], a[72:75], v[208:211]
    buffer_load_dwordx2 v[128:129], v39, s[24:27], s73 offen offset:2048 sc1
    v_mfma_f32_16x16x32_bf16 v[216:219], a[188:191], a[76:79], v[216:219]
    v_mul_f32 v116, v116, v54
    v_mul_f32 v117, v117, v54
    v_mfma_f32_16x16x32_bf16 v[216:219], a[184:187], a[60:63], v[216:219]
    ds_read_b64_tr_b16 a[184:185], v8 offset:12288
    v_mul_f32 v118, v118, v54
    v_mfma_f32_16x16x32_bf16 v[220:223], a[192:195], a[60:63], v[220:223]
    ds_read_b64_tr_b16 a[186:187], v8 offset:14336
    v_mul_f32 v119, v119, v54
    v_mfma_f32_16x16x32_bf16 v[220:223], a[196:199], a[76:79], v[220:223]
    ds_read_b64_tr_b16 a[188:189], v8 offset:8192
    v_cvt_pk_bf16_f32 v116, 0, v116
    v_mfma_f32_16x16x32_bf16 v[212:215], a[196:199], a[72:75], v[212:215]
    ds_read_b64_tr_b16 a[190:191], v8 offset:10240
    v_cvt_pk_bf16_f32 v117, 0, v117
    v_mfma_f32_16x16x32_bf16 v[212:215], a[192:195], a[56:59], v[212:215]
    s_waitcnt lgkmcnt(6)
    v_cvt_pk_bf16_f32 v118, 0, v118
    v_cvt_pk_bf16_f32 v119, 0, v119
    v_mfma_f32_16x16x32_bf16 v[204:207], a[192:195], a[52:55], v[204:207]
    v_add_f32 v116, v116, v50
    v_add_f32 v117, v117, v51
    v_mfma_f32_16x16x32_bf16 v[204:207], a[196:199], a[68:71], v[204:207]
    v_add_f32 v118, v118, v52
    v_add_f32 v119, v119, v53
    v_mfma_f32_16x16x32_bf16 v[196:199], a[196:199], a[64:67], v[196:199]
    v_cvt_pk_bf16_f32 v116, 0, v116
    v_cvt_pk_bf16_f32 v117, 0, v117
    v_mfma_f32_16x16x32_bf16 v[196:199], a[192:195], a[48:51], v[196:199]
    s_or_b64 s[88:89], s[28:29], s[30:31]
    ds_read_b64_tr_b16 a[192:193], v9 offset:12288
    v_cvt_pk_bf16_f32 v118, 0, v118
    v_mfma_f32_16x16x32_bf16 v[192:195], a[200:203], a[216:219], v[192:195]
    s_or_b64 s[88:89], s[88:89], s[32:33]
    ds_read_b64_tr_b16 a[194:195], v9 offset:14336
    v_cvt_pk_bf16_f32 v119, 0, v119
    v_mfma_f32_16x16x32_bf16 v[192:195], a[204:207], a[232:235], v[192:195]
    s_or_b64 s[88:89], s[88:89], s[34:35]
    ds_read_b64_tr_b16 a[196:197], v9 offset:8192
    v_mul_f32 v120, s92, v116
    v_mfma_f32_16x16x32_bf16 v[200:203], a[204:207], a[236:239], v[200:203]
    s_or_b32 s66, s88, s89
    ds_read_b64_tr_b16 a[198:199], v9 offset:10240
    v_mul_f32 v121, s92, v117
    v_mfma_f32_16x16x32_bf16 v[200:203], a[200:203], a[220:223], v[200:203]
    v_exp_f32 v120, v120
    v_mfma_f32_16x16x32_bf16 v[208:211], a[200:203], a[224:227], v[208:211]
    v_exp_f32 v121, v121
    v_mfma_f32_16x16x32_bf16 v[208:211], a[204:207], a[240:243], v[208:211]
    s_andn2_b32 s69, s66, s80
    s_cselect_b32 s65, s59, 0x70000000
    v_mul_f32 v122, s92, v118
    v_mfma_f32_16x16x32_bf16 v[216:219], a[204:207], a[244:247], v[216:219]
    s_waitcnt lgkmcnt(5)
    v_exp_f32 v122, v122
    v_mfma_f32_16x16x32_bf16 v[216:219], a[200:203], a[228:231], v[216:219]
    s_ff1_i32_b32 s69, s69
    ds_read_b64_tr_b16 a[200:201], v8 offset:4096
    v_mul_f32 v123, s92, v119
    v_mfma_f32_16x16x32_bf16 v[220:223], a[208:211], a[228:231], v[220:223]
    s_xor_b32 s81, s53, s69
    ds_read_b64_tr_b16 a[202:203], v8 offset:6144
    v_add_f32 v120, 1.0, v120
    v_mfma_f32_16x16x32_bf16 v[220:223], a[212:215], a[244:247], v[220:223]
    s_mul_i32 s81, s81, 20480
    ds_read_b64_tr_b16 a[204:205], v8 offset:0
    v_add_f32 v121, 1.0, v121
    v_mfma_f32_16x16x32_bf16 v[212:215], a[212:215], a[240:243], v[212:215]
    s_add_u32 s81, s81, s65
    ds_read_b64_tr_b16 a[206:207], v8 offset:2048
    v_add_f32 v122, 1.0, v122
    v_mfma_f32_16x16x32_bf16 v[212:215], a[208:211], a[224:227], v[212:215]
    s_bitset1_b32 s80, s69
    v_exp_f32 v123, v123
    v_mfma_f32_16x16x32_bf16 v[204:207], a[208:211], a[220:223], v[204:207]
    v_rcp_f32 v120, v120
    v_mfma_f32_16x16x32_bf16 v[204:207], a[212:215], a[236:239], v[204:207]
    v_rcp_f32 v121, v121
    v_mfma_f32_16x16x32_bf16 v[196:199], a[212:215], a[232:235], v[196:199]
    s_waitcnt lgkmcnt(5)
    v_rcp_f32 v122, v122
    v_mfma_f32_16x16x32_bf16 v[196:199], a[208:211], a[216:219], v[196:199]
    ds_read_b64_tr_b16 a[208:209], v9 offset:4096
    v_add_f32 v123, 1.0, v123
    v_mfma_f32_16x16x32_bf16 v[192:195], a[184:187], a[152:155], v[192:195]
    ds_read_b64_tr_b16 a[210:211], v9 offset:6144
    v_mul_f32 v116, v116, v120
    v_mfma_f32_16x16x32_bf16 v[192:195], a[188:191], a[168:171], v[192:195]
    buffer_load_dwordx4 v[140:143], v14, s[24:27], s81 offen sc1
    v_mfma_f32_16x16x32_bf16 v[200:203], a[188:191], a[172:175], v[200:203]
    ds_read_b64_tr_b16 a[212:213], v9 offset:0
    v_mul_f32 v117, v117, v121
    v_mfma_f32_16x16x32_bf16 v[200:203], a[184:187], a[156:159], v[200:203]
    s_waitcnt vmcnt(4)
    ds_read_b64_tr_b16 a[214:215], v9 offset:2048
    v_mul_f32 v118, v118, v122
    v_mfma_f32_16x16x32_bf16 v[208:211], a[184:187], a[160:163], v[208:211]
    buffer_store_dword v16, v7, s[24:27], s77 offen offset:16 sc1
    v_mfma_f32_16x16x32_bf16 v[208:211], a[188:191], a[176:179], v[208:211]
    buffer_load_dwordx4 v[144:147], v14, s[24:27], s81 offen offset:1024 sc1
    v_mfma_f32_16x16x32_bf16 v[216:219], a[188:191], a[180:183], v[216:219]
    s_waitcnt lgkmcnt(3)
    v_lshlrev_b32 v16, 0, v2
    v_cvt_pk_bf16_f32 v116, v116, v117
    v_mfma_f32_16x16x32_bf16 v[216:219], a[184:187], a[164:167], v[216:219]
    buffer_load_dwordx2 v[138:139], v39, s[24:27], s81 offen offset:2048 sc1
    v_mfma_f32_16x16x32_bf16 v[220:223], a[192:195], a[164:167], v[220:223]
    s_xor_b32 s77, s50, 0
    ds_read_b64_tr_b16 a[184:185], v10 offset:45056
    v_xor_b32 v20, 16, v5
    v_mfma_f32_16x16x32_bf16 v[220:223], a[196:199], a[180:183], v[220:223]
    s_lshl_b32 s77, s77, 10
    ds_read_b64_tr_b16 a[186:187], v10 offset:47104
    v_cmp_eq_u32 s[10:11], s39, v20
    v_mfma_f32_16x16x32_bf16 v[212:215], a[196:199], a[176:179], v[212:215]
    s_add_u32 s77, s61, s77
    ds_read_b64_tr_b16 a[188:189], v10 offset:40960
    v_cmp_eq_u32 s[22:23], s40, v20
    v_mfma_f32_16x16x32_bf16 v[212:215], a[192:195], a[160:163], v[212:215]
    s_or_b64 s[10:11], s[10:11], s[22:23]
    ds_read_b64_tr_b16 a[190:191], v10 offset:43008
    v_lshrrev_b32 v21, 4, v1
    v_mfma_f32_16x16x32_bf16 v[204:207], a[192:195], a[156:159], v[204:207]
    v_rcp_f32 v123, v123
    v_mfma_f32_16x16x32_bf16 v[204:207], a[196:199], a[172:175], v[204:207]
    v_mul_f32 v119, v119, v123
    v_cvt_pk_bf16_f32 v117, v118, v119
    v_mfma_f32_16x16x32_bf16 v[196:199], a[196:199], a[168:171], v[196:199]
    ds_write_b64 v12, v[116:117]
    v_mfma_f32_16x16x32_bf16 v[196:199], a[192:195], a[152:155], v[196:199]
    ds_read_b64_tr_b16 a[192:193], v11 offset:45056
    v_lshl_add_u32 v21, v21, 3, s56
    v_mfma_f32_16x16x32_bf16 v[192:195], a[200:203], a[80:83], v[192:195]
    ds_read_b64_tr_b16 a[194:195], v11 offset:47104
    v_add_u32 v20, 256, v21
    v_mfma_f32_16x16x32_bf16 v[192:195], a[204:207], a[96:99], v[192:195]
    ds_read_b64_tr_b16 a[196:197], v11 offset:40960
    v_cndmask_b32 v22, v21, v20, s[20:21]
    v_mfma_f32_16x16x32_bf16 v[200:203], a[204:207], a[100:103], v[200:203]
    s_waitcnt lgkmcnt(4)
    s_mov_b64 exec, s[8:9]
    ds_read2_b64 v[40:43], v22 offset0:0 offset1:4
    s_mov_b64 exec, -1
    v_mfma_f32_16x16x32_bf16 v[200:203], a[200:203], a[84:87], v[200:203]
    ds_read_b64_tr_b16 a[198:199], v11 offset:43008
    v_cvt_pk_bf16_f32 v192, v192, v193
    v_mfma_f32_16x16x32_bf16 v[208:211], a[200:203], a[88:91], v[208:211]
    v_cvt_pk_bf16_f32 v193, v194, v195
    v_cndmask_b32 v23, v21, v20, s[22:23]
    v_mfma_f32_16x16x32_bf16 v[208:211], a[204:207], a[104:107], v[208:211]
    s_mov_b64 exec, s[10:11]
    ds_read2_b64 v[44:47], v23 offset0:0 offset1:4
    s_mov_b64 exec, -1
    v_mfma_f32_16x16x32_bf16 v[216:219], a[204:207], a[108:111], v[216:219]
    s_xor_b32 s78, s53, 3
    v_cvt_pk_bf16_f32 v200, v200, v201
    v_cvt_pk_bf16_f32 v201, v202, v203
    v_mfma_f32_16x16x32_bf16 v[216:219], a[200:203], a[92:95], v[216:219]
    s_mul_i32 s78, s78, 2560
    ds_read_b64_tr_b16 a[200:201], v10 offset:36864
    v_cvt_pk_bf16_f32 v208, v208, v209
    v_mfma_f32_16x16x32_bf16 v[220:223], a[208:211], a[92:95], v[220:223]
    s_add_u32 s78, s78, s60
    ds_read_b64_tr_b16 a[202:203], v10 offset:38912
    v_cvt_pk_bf16_f32 v209, v210, v211
    v_mfma_f32_16x16x32_bf16 v[220:223], a[212:215], a[108:111], v[220:223]
    s_xor_b32 s79, s53, 2
    ds_read_b64_tr_b16 a[204:205], v10 offset:32768
    v_cvt_pk_bf16_f32 v216, v216, v217
    v_mfma_f32_16x16x32_bf16 v[212:215], a[212:215], a[104:107], v[212:215]
    s_mul_i32 s79, s79, 2560
    ds_read_b64_tr_b16 a[206:207], v10 offset:34816
    v_cvt_pk_bf16_f32 v217, v218, v219
    v_mfma_f32_16x16x32_bf16 v[212:215], a[208:211], a[88:91], v[212:215]
    s_waitcnt lgkmcnt(5)
    v_cvt_pk_bf16_f32 v218, v220, v221
    v_cvt_pk_bf16_f32 v219, v222, v223
    v_mfma_f32_16x16x32_bf16 v[204:207], a[208:211], a[84:87], v[204:207]
    s_add_u32 s79, s79, s60
    v_cmp_eq_u32 s[20:21], s39, v37
    v_cmp_eq_u32 s[22:23], s40, v37
    v_mfma_f32_16x16x32_bf16 v[204:207], a[212:215], a[100:103], v[204:207]
    s_or_b64 s[20:21], s[20:21], s[22:23]
    v_cvt_pk_bf16_f32 v210, v212, v213
    v_cvt_pk_bf16_f32 v211, v214, v215
    v_mfma_f32_16x16x32_bf16 v[196:199], a[212:215], a[96:99], v[196:199]
    s_waitcnt lgkmcnt(3)
    v_cndmask_b32 v13, v21, v20, s[22:23]
    v_and_b32 v20, 8, v39
    v_mfma_f32_16x16x32_bf16 v[196:199], a[208:211], a[80:83], v[196:199]
    s_load_dwordx8 s[28:35], s[86:87], s93 glc
    ds_read_b64_tr_b16 a[208:209], v11 offset:36864
    v_cvt_pk_bf16_f32 v202, v204, v205
    v_mfma_f32_16x16x32_bf16 v[224:227], a[184:187], a[128:131], v[224:227]
    ds_read_b64_tr_b16 a[210:211], v11 offset:38912
    v_cvt_pk_bf16_f32 v203, v206, v207
    v_mfma_f32_16x16x32_bf16 v[224:227], a[188:191], a[0:3], v[224:227]
    ds_read_b64_tr_b16 a[212:213], v11 offset:32768
    v_cvt_pk_bf16_f32 v194, v196, v197
    v_mfma_f32_16x16x32_bf16 v[232:235], a[188:191], a[4:7], v[232:235]
    ds_read_b64_tr_b16 a[214:215], v11 offset:34816
    v_cvt_pk_bf16_f32 v195, v198, v199
    v_mfma_f32_16x16x32_bf16 v[232:235], a[184:187], a[132:135], v[232:235]
    buffer_store_dwordx4 v[192:195], v14, s[24:27], s78 offen offset:1024 sc1
    v_lshl_add_u32 v13, v20, 2, v13
    v_mfma_f32_16x16x32_bf16 v[236:239], a[192:195], a[132:135], v[236:239]
    s_mov_b64 exec, s[20:21]
    ds_read_b64 v[48:49], v13 offset:64
    s_mov_b64 exec, -1
    v_mfma_f32_16x16x32_bf16 v[236:239], a[196:199], a[4:7], v[236:239]
    s_waitcnt lgkmcnt(7)
    ds_read_b64_tr_b16 a[184:185], v10 offset:28672
    v_bfe_u32 v20, v1, 2, 2
    v_mfma_f32_16x16x32_bf16 v[228:231], a[196:199], a[0:3], v[228:231]
    s_waitcnt lgkmcnt(6)
    ds_read_b64_tr_b16 a[186:187], v10 offset:30720
    v_lshrrev_b32 v21, 4, v1
    v_mfma_f32_16x16x32_bf16 v[228:231], a[192:195], a[128:131], v[228:231]
    buffer_store_dwordx4 v[200:203], v14, s[24:27], s78 offen offset:0 sc1
    v_cmp_eq_u32 vcc, v20, v21
    v_mfma_f32_16x16x32_bf16 v[224:227], a[200:203], a[16:19], v[224:227]
    ds_read_b64_tr_b16 a[188:189], v10 offset:24576
    v_and_b32 v20, 1, v1
    v_mfma_f32_16x16x32_bf16 v[224:227], a[204:207], a[32:35], v[224:227]
    s_waitcnt lgkmcnt(6)
    ds_read_b64_tr_b16 a[190:191], v10 offset:26624
    v_lshlrev_b32 v20, 4, v20
    v_mfma_f32_16x16x32_bf16 v[232:235], a[204:207], a[36:39], v[232:235]
    s_waitcnt lgkmcnt(5)
    ds_read_b64_tr_b16 a[192:193], v11 offset:28672
    v_mov_b32 v21, 0x3f80
    v_mfma_f32_16x16x32_bf16 v[232:235], a[200:203], a[20:23], v[232:235]
    s_waitcnt lgkmcnt(5)
    ds_read_b64_tr_b16 a[194:195], v11 offset:30720
    v_lshlrev_b32 v20, v20, v21
    v_mfma_f32_16x16x32_bf16 v[236:239], a[208:211], a[20:23], v[236:239]
    ds_read_b64_tr_b16 a[196:197], v11 offset:24576
    v_cndmask_b32 v20, 0, v20, vcc
    v_mfma_f32_16x16x32_bf16 v[236:239], a[212:215], a[36:39], v[236:239]
    s_waitcnt lgkmcnt(5)
    ds_read_b64_tr_b16 a[198:199], v11 offset:26624
    v_and_b32 v21, 2, v1
    v_mfma_f32_16x16x32_bf16 v[228:231], a[212:215], a[32:35], v[228:231]
    ds_read_b64_tr_b16 a[200:201], v10 offset:20480
    v_cmp_eq_u32 vcc, 0, v21
    v_mfma_f32_16x16x32_bf16 v[228:231], a[208:211], a[16:19], v[228:231]
    buffer_store_dwordx4 v[208:211], v14, s[24:27], s79 offen offset:1024 sc1
    v_cndmask_b32 v184, 0, v20, vcc
    v_mfma_f32_16x16x32_bf16 v[224:227], a[184:187], a[48:51], v[224:227]
    s_waitcnt lgkmcnt(5)
    ds_read_b64_tr_b16 a[202:203], v10 offset:22528
    v_sub_u32 v185, v20, v184
    v_mfma_f32_16x16x32_bf16 v[224:227], a[188:191], a[64:67], v[224:227]
pg_last:
    s_cbranch_execz pg_back2
    ds_read_b64_tr_b16 a[204:205], v10 offset:16384
    v_mov_b32 v186, v184
    v_mfma_f32_16x16x32_bf16 v[232:235], a[188:191], a[68:71], v[232:235]
    s_waitcnt lgkmcnt(5)
    ds_read_b64_tr_b16 a[206:207], v10 offset:18432
    v_mov_b32 v187, v185
    v_mfma_f32_16x16x32_bf16 v[232:235], a[184:187], a[52:55], v[232:235]
    ds_read_b64_tr_b16 a[208:209], v11 offset:20480
    v_mov_b32 v188, 0
    v_mfma_f32_16x16x32_bf16 v[236:239], a[192:195], a[52:55], v[236:239]
    s_waitcnt lgkmcnt(5)
    ds_read_b64_tr_b16 a[210:211], v11 offset:22528
    v_mov_b32 v189, 0
    v_mfma_f32_16x16x32_bf16 v[236:239], a[196:199], a[68:71], v[236:239]
    ds_read_b64_tr_b16 a[212:213], v11 offset:16384
    v_mov_b32 v190, v184
    v_mfma_f32_16x16x32_bf16 v[228:231], a[196:199], a[64:67], v[228:231]
    ds_read_b64_tr_b16 a[214:215], v11 offset:18432
    v_mov_b32 v191, v185
    v_mfma_f32_16x16x32_bf16 v[228:231], a[192:195], a[48:51], v[228:231]
    s_waitcnt lgkmcnt(6)
    buffer_store_dwordx4 v[216:219], v14, s[24:27], s79 offen offset:0 sc1
    v_lshlrev_b32 v192, 16, v24
    v_mfma_f32_16x16x32_bf16 v[224:227], a[200:203], a[216:219], v[224:227]
    s_waitcnt lgkmcnt(4)
    ds_read_b64_tr_b16 a[184:185], v10 offset:12288
    v_and_b32 v193, 0xffff0000, v24
    v_mfma_f32_16x16x32_bf16 v[224:227], a[204:207], a[232:235], v[224:227]
    ds_read_b64_tr_b16 a[186:187], v10 offset:14336
    v_lshlrev_b32 v208, 16, v40
    ds_read_b64_tr_b16 a[188:189], v10 offset:8192
    v_mfma_f32_16x16x32_bf16 v[232:235], a[204:207], a[236:239], v[232:235]
    ds_read_b64_tr_b16 a[190:191], v10 offset:10240
    v_and_b32 v209, 0xffff0000, v40
    v_mfma_f32_16x16x32_bf16 v[232:235], a[200:203], a[220:223], v[232:235]
    s_waitcnt lgkmcnt(6)
    ds_read_b64_tr_b16 a[192:193], v11 offset:12288
    v_lshlrev_b32 v194, 16, v25
    v_mfma_f32_16x16x32_bf16 v[236:239], a[208:211], a[220:223], v[236:239]
    s_waitcnt lgkmcnt(5)
    ds_read_b64_tr_b16 a[194:195], v11 offset:14336
    v_and_b32 v195, 0xffff0000, v25
    v_mfma_f32_16x16x32_bf16 v[236:239], a[212:215], a[236:239], v[236:239]
    ds_read_b64_tr_b16 a[196:197], v11 offset:8192
    v_lshlrev_b32 v210, 16, v41
    v_mfma_f32_16x16x32_bf16 v[228:231], a[212:215], a[232:235], v[228:231]
    ds_read_b64_tr_b16 a[198:199], v11 offset:10240
    v_and_b32 v211, 0xffff0000, v41
    v_mfma_f32_16x16x32_bf16 v[228:231], a[208:211], a[216:219], v[228:231]
    s_waitcnt lgkmcnt(6)
    ds_read_b64_tr_b16 a[200:201], v10 offset:4096
    v_lshlrev_b32 v196, 16, v26
    v_mfma_f32_16x16x32_bf16 v[224:227], a[184:187], a[152:155], v[224:227]
    s_waitcnt lgkmcnt(5)
    ds_read_b64_tr_b16 a[202:203], v10 offset:6144
    v_and_b32 v197, 0xffff0000, v26
    v_mfma_f32_16x16x32_bf16 v[224:227], a[188:191], a[168:171], v[224:227]
    ds_read_b64_tr_b16 a[204:205], v10 offset:0
    v_lshlrev_b32 v212, 16, v42
    v_mfma_f32_16x16x32_bf16 v[232:235], a[188:191], a[172:175], v[232:235]
    ds_read_b64_tr_b16 a[206:207], v10 offset:2048
    v_and_b32 v213, 0xffff0000, v42
    v_mfma_f32_16x16x32_bf16 v[232:235], a[184:187], a[156:159], v[232:235]
    s_waitcnt lgkmcnt(6)
    ds_read_b64_tr_b16 a[208:209], v11 offset:4096
    v_lshlrev_b32 v198, 16, v27
    v_mfma_f32_16x16x32_bf16 v[236:239], a[192:195], a[156:159], v[236:239]
    s_waitcnt lgkmcnt(5)
    ds_read_b64_tr_b16 a[210:211], v11 offset:6144
    v_and_b32 v199, 0xffff0000, v27
    v_mfma_f32_16x16x32_bf16 v[236:239], a[196:199], a[172:175], v[236:239]
    s_xor_b32 s78, s53, 1
    ds_read_b64_tr_b16 a[212:213], v11 offset:0
    v_lshlrev_b32 v214, 16, v43
    v_mfma_f32_16x16x32_bf16 v[228:231], a[196:199], a[168:171], v[228:231]
    s_mul_i32 s78, s78, 2560
    ds_read_b64_tr_b16 a[214:215], v11 offset:2048
    v_and_b32 v215, 0xffff0000, v43
    v_mfma_f32_16x16x32_bf16 v[228:231], a[192:195], a[152:155], v[228:231]
    s_waitcnt lgkmcnt(6)
    ds_read_b64_tr_b16 a[184:185], v10 offset:45056
    v_lshlrev_b32 v200, 16, v28
    v_mfma_f32_16x16x32_bf16 v[224:227], a[200:203], a[80:83], v[224:227]
    s_waitcnt lgkmcnt(5)
    ds_read_b64_tr_b16 a[186:187], v10 offset:47104
    v_and_b32 v201, 0xffff0000, v28
    v_mfma_f32_16x16x32_bf16 v[224:227], a[204:207], a[96:99], v[224:227]
    s_add_u32 s78, s78, s60
    ds_read_b64_tr_b16 a[188:189], v10 offset:40960
    v_lshlrev_b32 v216, 16, v44
    v_mfma_f32_16x16x32_bf16 v[232:235], a[204:207], a[100:103], v[232:235]
    s_or_b64 s[88:89], s[28:29], s[30:31]
    ds_read_b64_tr_b16 a[190:191], v10 offset:43008
    v_and_b32 v217, 0xffff0000, v44
    v_mfma_f32_16x16x32_bf16 v[232:235], a[200:203], a[84:87], v[232:235]
    s_waitcnt lgkmcnt(6)
    ds_read_b64_tr_b16 a[192:193], v11 offset:45056
    v_cvt_pk_bf16_f32 v224, v224, v225
    v_mfma_f32_16x16x32_bf16 v[236:239], a[208:211], a[84:87], v[236:239]
    s_waitcnt lgkmcnt(5)
    ds_read_b64_tr_b16 a[194:195], v11 offset:47104
    v_cvt_pk_bf16_f32 v225, v226, v227
    v_mfma_f32_16x16x32_bf16 v[236:239], a[212:215], a[100:103], v[236:239]
    s_or_b64 s[88:89], s[88:89], s[32:33]
    ds_read_b64_tr_b16 a[196:197], v11 offset:40960
    v_cvt_pk_bf16_f32 v232, v232, v233
    v_mfma_f32_16x16x32_bf16 v[228:231], a[212:215], a[96:99], v[228:231]
    s_or_b64 s[88:89], s[88:89], s[34:35]
    ds_read_b64_tr_b16 a[198:199], v11 offset:43008
    v_cvt_pk_bf16_f32 v233, v234, v235
    v_mfma_f32_16x16x32_bf16 v[228:231], a[208:211], a[80:83], v[228:231]
    s_waitcnt lgkmcnt(6)
    ds_read_b64_tr_b16 a[200:201], v10 offset:36864
    v_cvt_pk_bf16_f32 v234, v236, v237
    v_mfma_f32_16x16x32_bf16 v[240:243], a[184:187], a[136:139], v[240:243]
    s_waitcnt lgkmcnt(5)
    ds_read_b64_tr_b16 a[202:203], v10 offset:38912
    v_cvt_pk_bf16_f32 v235, v238, v239
    v_mfma_f32_16x16x32_bf16 v[240:243], a[188:191], a[8:11], v[240:243]
    s_or_b32 s66, s88, s89
    ds_read_b64_tr_b16 a[204:205], v10 offset:32768
    v_cvt_pk_bf16_f32 v226, v228, v229
    v_mfma_f32_16x16x32_bf16 v[248:251], a[188:191], a[12:15], v[248:251]
    s_andn2_b32 s69, s66, s80
    s_cselect_b32 s65, s59, 0x70000000
    v_cvt_pk_bf16_f32 v227, v230, v231
    ds_read_b64_tr_b16 a[206:207], v10 offset:34816
    v_mfma_f32_16x16x32_bf16 v[248:251], a[184:187], a[140:143], v[248:251]
    s_waitcnt lgkmcnt(6)
    buffer_store_dwordx4 v[224:227], v14, s[24:27], s78 offen offset:0 sc1
    v_lshlrev_b32 v202, 16, v29
    v_mfma_f32_16x16x32_bf16 v[252:255], a[192:195], a[140:143], v[252:255]
    s_waitcnt lgkmcnt(4)
    buffer_store_dwordx4 v[232:235], v14, s[24:27], s78 offen offset:1024 sc1
    v_and_b32 v203, 0xffff0000, v29
    v_mfma_f32_16x16x32_bf16 v[252:255], a[196:199], a[12:15], v[252:255]
    s_ff1_i32_b32 s69, s69
    ds_read_b64_tr_b16 a[208:209], v11 offset:36864
    v_lshlrev_b32 v218, 16, v45
    ds_read_b64_tr_b16 a[210:211], v11 offset:38912
    v_mfma_f32_16x16x32_bf16 v[244:247], a[196:199], a[8:11], v[244:247]
    s_xor_b32 s72, s53, s69
    ds_read_b64_tr_b16 a[212:213], v11 offset:32768
    v_and_b32 v219, 0xffff0000, v45
    ds_read_b64_tr_b16 a[214:215], v11 offset:34816
    v_mfma_f32_16x16x32_bf16 v[244:247], a[192:195], a[136:139], v[244:247]
    s_waitcnt lgkmcnt(6)
    ds_read_b64_tr_b16 a[184:185], v10 offset:28672
    v_lshlrev_b32 v204, 16, v30
    v_mfma_f32_16x16x32_bf16 v[240:243], a[200:203], a[24:27], v[240:243]
    s_waitcnt lgkmcnt(5)
    ds_read_b64_tr_b16 a[186:187], v10 offset:30720
    v_and_b32 v205, 0xffff0000, v30
    v_mfma_f32_16x16x32_bf16 v[240:243], a[204:207], a[40:43], v[240:243]
    s_mul_i32 s72, s72, 20480
    ds_read_b64_tr_b16 a[188:189], v10 offset:24576
    v_lshlrev_b32 v220, 16, v46
    v_mfma_f32_16x16x32_bf16 v[248:251], a[204:207], a[44:47], v[248:251]
    s_add_u32 s72, s72, s65
    ds_read_b64_tr_b16 a[190:191], v10 offset:26624
    v_and_b32 v221, 0xffff0000, v46
    v_mfma_f32_16x16x32_bf16 v[248:251], a[200:203], a[28:31], v[248:251]
    s_waitcnt lgkmcnt(6)
    ds_read_b64_tr_b16 a[192:193], v11 offset:28672
    v_lshlrev_b32 v206, 16, v31
    v_mfma_f32_16x16x32_bf16 v[252:255], a[208:211], a[28:31], v[252:255]
    s_waitcnt lgkmcnt(5)
    ds_read_b64_tr_b16 a[194:195], v11 offset:30720
    v_and_b32 v207, 0xffff0000, v31
    v_mfma_f32_16x16x32_bf16 v[252:255], a[212:215], a[44:47], v[252:255]
    s_bitset1_b32 s80, s69
    ds_read_b64_tr_b16 a[196:197], v11 offset:24576
    v_lshlrev_b32 v222, 16, v47
    v_mfma_f32_16x16x32_bf16 v[244:247], a[212:215], a[40:43], v[244:247]
    s_andn2_b32 s69, s66, s80
    s_cselect_b32 s65, s59, 0x70000000
    v_and_b32 v223, 0xffff0000, v47
    ds_read_b64_tr_b16 a[198:199], v11 offset:26624
    v_mfma_f32_16x16x32_bf16 v[244:247], a[208:211], a[24:27], v[244:247]
    s_waitcnt lgkmcnt(6)
    ds_read_b64_tr_b16 a[200:201], v10 offset:20480
    v_lshlrev_b32 v50, 16, v32
    v_mfma_f32_16x16x32_bf16 v[240:243], a[184:187], a[56:59], v[240:243]
    s_waitcnt lgkmcnt(5)
    ds_read_b64_tr_b16 a[202:203], v10 offset:22528
    v_and_b32 v51, 0xffff0000, v32
    v_mfma_f32_16x16x32_bf16 v[240:243], a[188:191], a[72:75], v[240:243]
    buffer_load_dwordx4 v[58:61], v14, s[24:27], s72 offen sc1
    ds_read_b64_tr_b16 a[204:205], v10 offset:16384
    v_mfma_f32_16x16x32_bf16 v[248:251], a[188:191], a[76:79], v[248:251]
    s_ff1_i32_b32 s69, s69
    ds_read_b64_tr_b16 a[206:207], v10 offset:18432
    v_lshlrev_b32 v116, 16, v48
    v_mfma_f32_16x16x32_bf16 v[248:251], a[184:187], a[60:63], v[248:251]
    s_waitcnt lgkmcnt(6)
    ds_read_b64_tr_b16 a[208:209], v11 offset:20480
    v_and_b32 v117, 0xffff0000, v48
    v_mfma_f32_16x16x32_bf16 v[252:255], a[192:195], a[60:63], v[252:255]
    s_waitcnt lgkmcnt(5)
    buffer_load_dwordx4 v[62:65], v14, s[24:27], s72 offen offset:1024 sc1
    v_mfma_f32_16x16x32_bf16 v[252:255], a[196:199], a[76:79], v[252:255]
    s_xor_b32 s73, s53, s69
    ds_read_b64_tr_b16 a[210:211], v11 offset:22528
    v_lshlrev_b32 v52, 16, v33
    ds_read_b64_tr_b16 a[212:213], v11 offset:16384
    v_mfma_f32_16x16x32_bf16 v[244:247], a[196:199], a[72:75], v[244:247]
    s_mul_i32 s73, s73, 20480
    ds_read_b64_tr_b16 a[214:215], v11 offset:18432
    v_and_b32 v53, 0xffff0000, v33
    v_mfma_f32_16x16x32_bf16 v[244:247], a[192:195], a[56:59], v[244:247]
    s_waitcnt lgkmcnt(6)
    buffer_load_dwordx2 v[56:57], v39, s[24:27], s72 offen offset:2048 sc1
    v_mfma_f32_16x16x32_bf16 v[240:243], a[200:203], a[224:227], v[240:243]
    s_waitcnt lgkmcnt(4)
    ds_read_b64_tr_b16 a[184:185], v10 offset:12288
    v_lshlrev_b32 v118, 16, v49
    v_mfma_f32_16x16x32_bf16 v[240:243], a[204:207], a[240:243], v[240:243]
    s_waitcnt vmcnt(5)
    ds_read_b64_tr_b16 a[186:187], v10 offset:14336
    v_and_b32 v119, 0xffff0000, v49
    ds_read_b64_tr_b16 a[188:189], v10 offset:8192
    v_mfma_f32_16x16x32_bf16 v[248:251], a[204:207], a[244:247], v[248:251]
    buffer_store_dword v17, v7, s[24:27], s67 offen offset:8 sc1
    ds_read_b64_tr_b16 a[190:191], v10 offset:10240
    v_mfma_f32_16x16x32_bf16 v[248:251], a[200:203], a[228:231], v[248:251]
    s_waitcnt lgkmcnt(6)
    ds_read_b64_tr_b16 a[192:193], v11 offset:12288
    s_add_u32 s73, s73, s65
    v_mfma_f32_16x16x32_bf16 v[252:255], a[208:211], a[228:231], v[252:255]
    s_waitcnt lgkmcnt(5)
    ds_read_b64_tr_b16 a[194:195], v11 offset:14336
    s_bitset1_b32 s80, s69
    v_mfma_f32_16x16x32_bf16 v[252:255], a[212:215], a[244:247], v[252:255]
    ds_read_b64_tr_b16 a[196:197], v11 offset:8192
    v_mfma_f32_16x16x32_bf16 v[244:247], a[212:215], a[240:243], v[244:247]
    ds_read_b64_tr_b16 a[198:199], v11 offset:10240
    v_mfma_f32_16x16x32_bf16 v[244:247], a[208:211], a[224:227], v[244:247]
    s_waitcnt lgkmcnt(6)
    ds_read_b64_tr_b16 a[200:201], v10 offset:4096
    v_mfma_f32_16x16x32_bf16 v[240:243], a[184:187], a[160:163], v[240:243]
    s_waitcnt lgkmcnt(5)
    ds_read_b64_tr_b16 a[202:203], v10 offset:6144
    v_mfma_f32_16x16x32_bf16 v[240:243], a[188:191], a[176:179], v[240:243]
    ds_read_b64_tr_b16 a[204:205], v10 offset:0
    v_mfma_f32_16x16x32_bf16 v[248:251], a[188:191], a[180:183], v[248:251]
    ds_read_b64_tr_b16 a[206:207], v10 offset:2048
    v_mfma_f32_16x16x32_bf16 v[248:251], a[184:187], a[164:167], v[248:251]
    s_waitcnt lgkmcnt(6)
    ds_read_b64_tr_b16 a[208:209], v11 offset:4096
    v_mfma_f32_16x16x32_bf16 v[252:255], a[192:195], a[164:167], v[252:255]
    s_waitcnt lgkmcnt(5)
    ds_read_b64_tr_b16 a[210:211], v11 offset:6144
    v_mfma_f32_16x16x32_bf16 v[252:255], a[196:199], a[180:183], v[252:255]
    buffer_load_dwordx4 v[68:71], v14, s[24:27], s73 offen sc1
    ds_read_b64_tr_b16 a[212:213], v11 offset:0
    v_mfma_f32_16x16x32_bf16 v[244:247], a[196:199], a[176:179], v[244:247]
    ds_read_b64_tr_b16 a[214:215], v11 offset:2048
    v_mfma_f32_16x16x32_bf16 v[244:247], a[192:195], a[160:163], v[244:247]
    s_waitcnt lgkmcnt(6)
    v_mfma_f32_16x16x32_bf16 v[240:243], a[200:203], a[88:91], v[240:243]
    s_waitcnt lgkmcnt(4)
    buffer_load_dwordx4 v[72:75], v14, s[24:27], s73 offen offset:1024 sc1
    v_mfma_f32_16x16x32_bf16 v[240:243], a[204:207], a[104:107], v[240:243]
    buffer_load_dwordx2 v[66:67], v39, s[24:27], s73 offen offset:2048 sc1
    v_mfma_f32_16x16x32_bf16 v[248:251], a[204:207], a[108:111], v[248:251]
    v_mfma_f32_16x16x32_bf16 v[248:251], a[200:203], a[92:95], v[248:251]
    s_waitcnt lgkmcnt(2)
    v_mfma_f32_16x16x32_bf16 v[252:255], a[208:211], a[92:95], v[252:255]
    s_waitcnt lgkmcnt(0)
    v_mfma_f32_16x16x32_bf16 v[252:255], a[212:215], a[108:111], v[252:255]
    s_waitcnt vmcnt(7)
    s_load_dwordx8 s[28:35], s[86:87], s93 glc
    v_mfma_f32_16x16x32_bf16 v[244:247], a[212:215], a[104:107], v[244:247]
    buffer_store_dword v16, v7, s[24:27], s77 offen offset:0 sc1
    v_mfma_f32_16x16x32_bf16 v[244:247], a[208:211], a[88:91], v[244:247]
    v_mfma_f32_16x16x32_bf16 v[124:127], v[186:189], v[96:99], v[124:127]
    v_mfma_f32_16x16x32_bf16 v[240:243], v[186:189], v[98:101], v[240:243]
    v_mfma_f32_16x16x32_bf16 v[244:247], v[188:191], v[98:101], v[244:247]
    v_mfma_f32_16x16x32_bf16 v[252:255], v[188:191], v[102:105], v[252:255]
    v_mfma_f32_16x16x32_bf16 v[248:251], v[186:189], v[102:105], v[248:251]
    v_mfma_f32_16x16x32_bf16 v[124:127], v[186:189], v[106:109], v[124:127]
    v_mfma_f32_16x16x32_bf16 v[240:243], v[186:189], v[108:111], v[240:243]
    v_mfma_f32_16x16x32_bf16 v[244:247], v[188:191], v[108:111], v[244:247]
    v_mfma_f32_16x16x32_bf16 v[252:255], v[188:191], v[112:115], v[252:255]
    v_mfma_f32_16x16x32_bf16 v[248:251], v[186:189], v[112:115], v[248:251]
    v_mfma_f32_16x16x32_bf16 v[124:127], v[186:189], v[128:131], v[124:127]
    v_mfma_f32_16x16x32_bf16 v[240:243], v[186:189], v[130:133], v[240:243]
    v_mfma_f32_16x16x32_bf16 v[244:247], v[188:191], v[130:133], v[244:247]
    v_mfma_f32_16x16x32_bf16 v[252:255], v[188:191], v[134:137], v[252:255]
    v_mfma_f32_16x16x32_bf16 v[248:251], v[186:189], v[134:137], v[248:251]
    v_mfma_f32_16x16x32_bf16 v[124:127], v[186:189], v[138:141], v[124:127]
    v_mfma_f32_16x16x32_bf16 v[240:243], v[186:189], v[140:143], v[240:243]
    v_mfma_f32_16x16x32_bf16 v[244:247], v[188:191], v[140:143], v[244:247]
    v_mfma_f32_16x16x32_bf16 v[252:255], v[188:191], v[144:147], v[252:255]
    v_mfma_f32_16x16x32_bf16 v[248:251], v[186:189], v[144:147], v[248:251]
post_code:
    s_cmp_eq_u32 s80, -1
    s_cbranch_scc1 ev_st
    s_or_b64 s[88:89], s[28:29], s[30:31]
    s_or_b64 s[88:89], s[88:89], s[32:33]
    s_or_b64 s[88:89], s[88:89], s[34:35]
    s_or_b32 s66, s88, s89
    s_andn2_b32 s69, s66, s80
    s_cbranch_scc1 ev_i2
    s_branch ev_w2
ev_st:
    s_waitcnt vmcnt(1)
    v_mfma_f32_16x16x32_bf16 v[124:127], v[186:189], v[56:59], v[124:127]
    v_mfma_f32_16x16x32_bf16 v[240:243], v[186:189], v[58:61], v[240:243]
    v_mfma_f32_16x16x32_bf16 v[244:247], v[188:191], v[58:61], v[244:247]
    v_mfma_f32_16x16x32_bf16 v[252:255], v[188:191], v[62:65], v[252:255]
    v_mfma_f32_16x16x32_bf16 v[248:251], v[186:189], v[62:65], v[248:251]
    v_mfma_f32_16x16x32_bf16 v[124:127], v[186:189], v[66:69], v[124:127]
    v_mfma_f32_16x16x32_bf16 v[240:243], v[186:189], v[68:71], v[240:243]
    v_mfma_f32_16x16x32_bf16 v[244:247], v[188:191], v[68:71], v[244:247]
    v_mfma_f32_16x16x32_bf16 v[252:255], v[188:191], v[72:75], v[252:255]
    v_mfma_f32_16x16x32_bf16 v[248:251], v[186:189], v[72:75], v[248:251]
    s_branch ev_sum
ev_w0:
    s_waitcnt lgkmcnt(0)
    s_load_dwordx8 s[28:35], s[86:87], s93 glc
    s_add_u32 s101, s101, 1
    s_cmp_gt_u32 s101, 0x2000000
    s_cbranch_scc1 ev_done
    s_or_b64 s[88:89], s[28:29], s[30:31]
    s_or_b64 s[88:89], s[88:89], s[32:33]
    s_or_b64 s[88:89], s[88:89], s[34:35]
    s_or_b32 s66, s88, s89
    s_andn2_b32 s69, s66, s80
    s_cbranch_scc0 ev_w0
ev_i0:
    s_ff1_i32_b32 s69, s69
    s_xor_b32 s81, s53, s69
    s_mul_i32 s81, s81, 20480
    s_add_u32 s81, s81, s59
    s_bitset1_b32 s80, s69
    s_cmp_eq_u32 s80, -1
    s_cbranch_scc0 ev_n0
    buffer_load_dwordx4 a[122:125], v14, s[24:27], s81 offen sc1
    buffer_load_dwordx4 a[126:129], v14, s[24:27], s81 offen offset:1024 sc1
    buffer_load_dwordx2 a[120:121], v39, s[24:27], s81 offen offset:2048 sc1
    s_branch ev_z
ev_n0:
    buffer_load_dwordx4 v[58:61], v14, s[24:27], s81 offen sc1
    buffer_load_dwordx4 v[62:65], v14, s[24:27], s81 offen offset:1024 sc1
    buffer_load_dwordx2 v[56:57], v39, s[24:27], s81 offen offset:2048 sc1
    s_andn2_b32 s69, s66, s80
    s_cbranch_scc0 ev_w1
ev_i1:
    s_ff1_i32_b32 s69, s69
    s_xor_b32 s81, s53, s69
    s_mul_i32 s81, s81, 20480
    s_add_u32 s81, s81, s59
    s_bitset1_b32 s80, s69
    s_cmp_eq_u32 s80, -1
    s_cbranch_scc1 ev_l1
    buffer_load_dwordx4 v[68:71], v14, s[24:27], s81 offen sc1
    buffer_load_dwordx4 v[72:75], v14, s[24:27], s81 offen offset:1024 sc1
    buffer_load_dwordx2 v[66:67], v39, s[24:27], s81 offen offset:2048 sc1
    s_andn2_b32 s69, s66, s80
    s_cbranch_scc0 ev_w2
ev_i2:
    s_ff1_i32_b32 s69, s69
    s_xor_b32 s81, s53, s69
    s_mul_i32 s81, s81, 20480
    s_add_u32 s81, s81, s59
    s_bitset1_b32 s80, s69
    s_cmp_eq_u32 s80, -1
    s_cbranch_scc1 ev_l2
    buffer_load_dwordx4 a[2:5], v14, s[24:27], s81 offen sc1
    buffer_load_dwordx4 a[6:9], v14, s[24:27], s81 offen offset:1024 sc1
    buffer_load_dwordx2 a[0:1], v39, s[24:27], s81 offen offset:2048 sc1
    s_andn2_b32 s69, s66, s80
    s_cbranch_scc0 ev_w3
ev_i3:
    s_ff1_i32_b32 s69, s69
    s_xor_b32 s81, s53, s69
    s_mul_i32 s81, s81, 20480
    s_add_u32 s81, s81, s59
    s_bitset1_b32 s80, s69
    s_cmp_eq_u32 s80, -1
    s_cbranch_scc1 ev_l3
    buffer_load_dwordx4 a[12:15], v14, s[24:27], s81 offen sc1
    buffer_load_dwordx4 a[16:19], v14, s[24:27], s81 offen offset:1024 sc1
    buffer_load_dwordx2 a[10:11], v39, s[24:27], s81 offen offset:2048 sc1
    s_andn2_b32 s69, s66, s80
    s_cbranch_scc0 ev_w4
ev_i4:
    s_ff1_i32_b32 s69, s69
    s_xor_b32 s81, s53, s69
    s_mul_i32 s81, s81, 20480
    s_add_u32 s81, s81, s59
    s_bitset1_b32 s80, s69
    s_cmp_eq_u32 s80, -1
    s_cbranch_scc1 ev_l4
    buffer_load_dwordx4 a[22:25], v14, s[24:27], s81 offen sc1
    buffer_load_dwordx4 a[26:29], v14, s[24:27], s81 offen offset:1024 sc1
    buffer_load_dwordx2 a[20:21], v39, s[24:27], s81 offen offset:2048 sc1
    s_andn2_b32 s69, s66, s80
    s_cbranch_scc0 ev_w5
ev_i5:
    s_ff1_i32_b32 s69, s69
    s_xor_b32 s81, s53, s69
    s_mul_i32 s81, s81, 20480
    s_add_u32 s81, s81, s59
    s_bitset1_b32 s80, s69
    s_cmp_eq_u32 s80, -1
    s_cbranch_scc1 ev_l5
    buffer_load_dwordx4 a[32:35], v14, s[24:27], s81 offen sc1
    buffer_load_dwordx4 a[36:39], v14, s[24:27], s81 offen offset:1024 sc1
    buffer_load_dwordx2 a[30:31], v39, s[24:27], s81 offen offset:2048 sc1
    s_waitcnt vmcnt(0)
ev_c6:
    v_mfma_f32_16x16x32_bf16 v[124:127], v[186:189], a[30:33], v[124:127]
    v_mfma_f32_16x16x32_bf16 v[240:243], v[186:189], a[32:35], v[240:243]
    v_mfma_f32_16x16x32_bf16 v[244:247], v[188:191], a[32:35], v[244:247]
    v_mfma_f32_16x16x32_bf16 v[252:255], v[188:191], a[36:39], v[252:255]
    v_mfma_f32_16x16x32_bf16 v[248:251], v[186:189], a[36:39], v[248:251]
ev_c5:
    v_mfma_f32_16x16x32_bf16 v[124:127], v[186:189], a[20:23], v[124:127]
    v_mfma_f32_16x16x32_bf16 v[240:243], v[186:189], a[22:25], v[240:243]
    v_mfma_f32_16x16x32_bf16 v[244:247], v[188:191], a[22:25], v[244:247]
    v_mfma_f32_16x16x32_bf16 v[252:255], v[188:191], a[26:29], v[252:255]
    v_mfma_f32_16x16x32_bf16 v[248:251], v[186:189], a[26:29], v[248:251]
ev_c4:
    v_mfma_f32_16x16x32_bf16 v[124:127], v[186:189], a[10:13], v[124:127]
    v_mfma_f32_16x16x32_bf16 v[240:243], v[186:189], a[12:15], v[240:243]
    v_mfma_f32_16x16x32_bf16 v[244:247], v[188:191], a[12:15], v[244:247]
    v_mfma_f32_16x16x32_bf16 v[252:255], v[188:191], a[16:19], v[252:255]
    v_mfma_f32_16x16x32_bf16 v[248:251], v[186:189], a[16:19], v[248:251]
ev_c3:
    v_mfma_f32_16x16x32_bf16 v[124:127], v[186:189], a[0:3], v[124:127]
    v_mfma_f32_16x16x32_bf16 v[240:243], v[186:189], a[2:5], v[240:243]
    v_mfma_f32_16x16x32_bf16 v[244:247], v[188:191], a[2:5], v[244:247]
    v_mfma_f32_16x16x32_bf16 v[252:255], v[188:191], a[6:9], v[252:255]
    v_mfma_f32_16x16x32_bf16 v[248:251], v[186:189], a[6:9], v[248:251]
ev_c2:
    v_mfma_f32_16x16x32_bf16 v[124:127], v[186:189], v[66:69], v[124:127]
    v_mfma_f32_16x16x32_bf16 v[240:243], v[186:189], v[68:71], v[240:243]
    v_mfma_f32_16x16x32_bf16 v[244:247], v[188:191], v[68:71], v[244:247]
    v_mfma_f32_16x16x32_bf16 v[252:255], v[188:191], v[72:75], v[252:255]
    v_mfma_f32_16x16x32_bf16 v[248:251], v[186:189], v[72:75], v[248:251]
ev_c1:
    v_mfma_f32_16x16x32_bf16 v[124:127], v[186:189], v[56:59], v[124:127]
    v_mfma_f32_16x16x32_bf16 v[240:243], v[186:189], v[58:61], v[240:243]
    v_mfma_f32_16x16x32_bf16 v[244:247], v[188:191], v[58:61], v[244:247]
    v_mfma_f32_16x16x32_bf16 v[252:255], v[188:191], v[62:65], v[252:255]
    v_mfma_f32_16x16x32_bf16 v[248:251], v[186:189], v[62:65], v[248:251]
    s_cmp_lg_u32 s80, -1
    s_cbranch_scc1 ev_w0
ev_z:
    s_waitcnt vmcnt(0)
    v_mfma_f32_16x16x32_bf16 v[124:127], v[186:189], a[120:123], v[124:127]
    v_mfma_f32_16x16x32_bf16 v[240:243], v[186:189], a[122:125], v[240:243]
    v_mfma_f32_16x16x32_bf16 v[244:247], v[188:191], a[122:125], v[244:247]
    v_mfma_f32_16x16x32_bf16 v[252:255], v[188:191], a[126:129], v[252:255]
    v_mfma_f32_16x16x32_bf16 v[248:251], v[186:189], a[126:129], v[248:251]
ev_sum:
    s_nop 4
    v_pk_fma_f32 v[124:125], v[124:125], v[116:117], v[50:51]
    v_pk_fma_f32 v[126:127], v[126:127], v[118:119], v[52:53]
    v_cvt_pk_bf16_f32 v124, v124, v125
    v_cvt_pk_bf16_f32 v125, v126, v127
    buffer_store_dwordx2 v[124:125], v35, s[16:19], s68 offen sc1
    v_pk_fma_f32 v[240:241], v[240:241], v[208:209], v[192:193]
    v_pk_fma_f32 v[242:243], v[242:243], v[210:211], v[194:195]
    v_pk_fma_f32 v[244:245], v[244:245], v[212:213], v[196:197]
    v_pk_fma_f32 v[246:247], v[246:247], v[214:215], v[198:199]
    v_cvt_pk_bf16_f32 v240, v240, v241
    v_cvt_pk_bf16_f32 v241, v242, v243
    v_cvt_pk_bf16_f32 v242, v244, v245
    v_cvt_pk_bf16_f32 v243, v246, v247
    s_nop 1
    v_permlane16_swap_b32 v240, v242
    v_permlane16_swap_b32 v241, v243
    buffer_store_dwordx4 v[240:243], v4, s[16:19], s64 offen sc1
    v_pk_fma_f32 v[248:249], v[248:249], v[216:217], v[200:201]
    v_pk_fma_f32 v[250:251], v[250:251], v[218:219], v[202:203]
    v_pk_fma_f32 v[252:253], v[252:253], v[220:221], v[204:205]
    v_pk_fma_f32 v[254:255], v[254:255], v[222:223], v[206:207]
    v_cvt_pk_bf16_f32 v248, v248, v249
    v_cvt_pk_bf16_f32 v249, v250, v251
    v_cvt_pk_bf16_f32 v250, v252, v253
    v_cvt_pk_bf16_f32 v251, v254, v255
    s_nop 1
    v_permlane16_swap_b32 v248, v250
    v_permlane16_swap_b32 v249, v251
    buffer_store_dwordx4 v[248:251], v34, s[16:19], s64 offen sc1
ev_done:
    s_or_b32 s56, s2, s3
    s_cmp_eq_u32 s56, 0
    s_cselect_b32 s56, 0, 0x7ffffff0
    s_add_u32 s56, s56, 3203072
    buffer_store_dword v6, v15, s[24:27], s56 offen
main_fin:
main_end:
    s_endpgm
ev_w1:
    s_getreg_b32 s56, hwreg(HW_REG_IB_STS, 0, 4)
    s_cmp_eq_u32 s56, 0
    s_cbranch_scc1 ev_d1
    s_waitcnt lgkmcnt(0)
    s_load_dwordx8 s[28:35], s[86:87], s93 glc
    s_add_u32 s101, s101, 1
    s_cmp_gt_u32 s101, 0x2000000
    s_cbranch_scc1 ev_done
    s_or_b64 s[88:89], s[28:29], s[30:31]
    s_or_b64 s[88:89], s[88:89], s[32:33]
    s_or_b64 s[88:89], s[88:89], s[34:35]
    s_or_b32 s66, s88, s89
    s_andn2_b32 s69, s66, s80
    s_cbranch_scc0 ev_w1
    s_branch ev_i1
ev_d1:
    s_waitcnt vmcnt(0)
    s_branch ev_c1
ev_l1:
    buffer_load_dwordx4 a[122:125], v14, s[24:27], s81 offen sc1
    buffer_load_dwordx4 a[126:129], v14, s[24:27], s81 offen offset:1024 sc1
    buffer_load_dwordx2 a[120:121], v39, s[24:27], s81 offen offset:2048 sc1
    s_waitcnt vmcnt(3)
    s_branch ev_c1
ev_w2:
    s_getreg_b32 s56, hwreg(HW_REG_IB_STS, 0, 4)
    s_cmp_eq_u32 s56, 0
    s_cbranch_scc1 ev_d2
    s_waitcnt lgkmcnt(0)
    s_load_dwordx8 s[28:35], s[86:87], s93 glc
    s_add_u32 s101, s101, 1
    s_cmp_gt_u32 s101, 0x2000000
    s_cbranch_scc1 ev_done
    s_or_b64 s[88:89], s[28:29], s[30:31]
    s_or_b64 s[88:89], s[88:89], s[32:33]
    s_or_b64 s[88:89], s[88:89], s[34:35]
    s_or_b32 s66, s88, s89
    s_andn2_b32 s69, s66, s80
    s_cbranch_scc0 ev_w2
    s_branch ev_i2
ev_d2:
    s_waitcnt vmcnt(0)
    s_branch ev_c2
ev_l2:
    buffer_load_dwordx4 a[122:125], v14, s[24:27], s81 offen sc1
    buffer_load_dwordx4 a[126:129], v14, s[24:27], s81 offen offset:1024 sc1
    buffer_load_dwordx2 a[120:121], v39, s[24:27], s81 offen offset:2048 sc1
    s_waitcnt vmcnt(3)
    s_branch ev_c2
ev_w3:
    s_getreg_b32 s56, hwreg(HW_REG_IB_STS, 0, 4)
    s_cmp_eq_u32 s56, 0
    s_cbranch_scc1 ev_d3
    s_waitcnt lgkmcnt(0)
    s_load_dwordx8 s[28:35], s[86:87], s93 glc
    s_add_u32 s101, s101, 1
    s_cmp_gt_u32 s101, 0x2000000
    s_cbranch_scc1 ev_done
    s_or_b64 s[88:89], s[28:29], s[30:31]
    s_or_b64 s[88:89], s[88:89], s[32:33]
    s_or_b64 s[88:89], s[88:89], s[34:35]
    s_or_b32 s66, s88, s89
    s_andn2_b32 s69, s66, s80
    s_cbranch_scc0 ev_w3
    s_branch ev_i3
ev_d3:
    s_waitcnt vmcnt(0)
    s_branch ev_c3
ev_l3:
    buffer_load_dwordx4 a[122:125], v14, s[24:27], s81 offen sc1
    buffer_load_dwordx4 a[126:129], v14, s[24:27], s81 offen offset:1024 sc1
    buffer_load_dwordx2 a[120:121], v39, s[24:27], s81 offen offset:2048 sc1
    s_waitcnt vmcnt(3)
    s_branch ev_c3
ev_w4:
    s_getreg_b32 s56, hwreg(HW_REG_IB_STS, 0, 4)
    s_cmp_eq_u32 s56, 0
    s_cbranch_scc1 ev_d4
    s_waitcnt lgkmcnt(0)
    s_load_dwordx8 s[28:35], s[86:87], s93 glc
    s_add_u32 s101, s101, 1
    s_cmp_gt_u32 s101, 0x2000000
    s_cbranch_scc1 ev_done
    s_or_b64 s[88:89], s[28:29], s[30:31]
    s_or_b64 s[88:89], s[88:89], s[32:33]
    s_or_b64 s[88:89], s[88:89], s[34:35]
    s_or_b32 s66, s88, s89
    s_andn2_b32 s69, s66, s80
    s_cbranch_scc0 ev_w4
    s_branch ev_i4
ev_d4:
    s_waitcnt vmcnt(0)
    s_branch ev_c4
ev_l4:
    buffer_load_dwordx4 a[122:125], v14, s[24:27], s81 offen sc1
    buffer_load_dwordx4 a[126:129], v14, s[24:27], s81 offen offset:1024 sc1
    buffer_load_dwordx2 a[120:121], v39, s[24:27], s81 offen offset:2048 sc1
    s_waitcnt vmcnt(3)
    s_branch ev_c4
ev_w5:
    s_getreg_b32 s56, hwreg(HW_REG_IB_STS, 0, 4)
    s_cmp_eq_u32 s56, 0
    s_cbranch_scc1 ev_d5
    s_waitcnt lgkmcnt(0)
    s_load_dwordx8 s[28:35], s[86:87], s93 glc
    s_add_u32 s101, s101, 1
    s_cmp_gt_u32 s101, 0x2000000
    s_cbranch_scc1 ev_done
    s_or_b64 s[88:89], s[28:29], s[30:31]
    s_or_b64 s[88:89], s[88:89], s[32:33]
    s_or_b64 s[88:89], s[88:89], s[34:35]
    s_or_b32 s66, s88, s89
    s_andn2_b32 s69, s66, s80
    s_cbranch_scc0 ev_w5
    s_branch ev_i5
ev_d5:
    s_waitcnt vmcnt(0)
    s_branch ev_c5
ev_l5:
    buffer_load_dwordx4 a[122:125], v14, s[24:27], s81 offen sc1
    buffer_load_dwordx4 a[126:129], v14, s[24:27], s81 offen offset:1024 sc1
    buffer_load_dwordx2 a[120:121], v39, s[24:27], s81 offen offset:2048 sc1
    s_waitcnt vmcnt(3)
    s_branch ev_c5
spin_o0:
    s_load_dwordx4 s[72:75], s[86:87], s5 glc
    s_add_u32 s101, s101, 1
    s_cmp_gt_u32 s101, 0x2000000
    s_waitcnt lgkmcnt(0)
    s_cbranch_scc1 spin_o0_ret
    s_sub_u32 s78, s72, s77
    s_sub_u32 s79, s73, s77
    s_max_u32 s78, s78, s79
    s_sub_u32 s79, s74, s77
    s_max_u32 s78, s78, s79
    s_sub_u32 s79, s75, s77
    s_max_u32 s78, s78, s79
    s_cmp_gt_u32 s78, 5
    s_cbranch_scc1 spin_o0
    s_branch spin_o0_ret
spin_o1:
    s_load_dwordx4 s[72:75], s[86:87], s5 glc
    s_add_u32 s101, s101, 1
    s_cmp_gt_u32 s101, 0x2000000
    s_waitcnt lgkmcnt(0)
    s_cbranch_scc1 spin_o1_ret
    s_sub_u32 s78, s72, s77
    s_sub_u32 s79, s73, s77
    s_max_u32 s78, s78, s79
    s_sub_u32 s79, s74, s77
    s_max_u32 s78, s78, s79
    s_sub_u32 s79, s75, s77
    s_max_u32 s78, s78, s79
    s_cmp_gt_u32 s78, 4
    s_cbranch_scc1 spin_o1
    s_branch spin_o1_ret
spin_o2:
    s_load_dwordx4 s[72:75], s[86:87], s5 glc
    s_add_u32 s101, s101, 1
    s_cmp_gt_u32 s101, 0x2000000
    s_waitcnt lgkmcnt(0)
    s_cbranch_scc1 spin_o2_ret
    s_sub_u32 s78, s72, s77
    s_sub_u32 s79, s73, s77
    s_max_u32 s78, s78, s79
    s_sub_u32 s79, s74, s77
    s_max_u32 s78, s78, s79
    s_sub_u32 s79, s75, s77
    s_max_u32 s78, s78, s79
    s_cmp_gt_u32 s78, 3
    s_cbranch_scc1 spin_o2
    s_branch spin_o2_ret
spin_o3:
    s_load_dwordx4 s[72:75], s[86:87], s5 glc
    s_add_u32 s101, s101, 1
    s_cmp_gt_u32 s101, 0x2000000
    s_waitcnt lgkmcnt(0)
    s_cbranch_scc1 spin_o3_ret
    s_sub_u32 s78, s72, s77
    s_sub_u32 s79, s73, s77
    s_max_u32 s78, s78, s79
    s_sub_u32 s79, s74, s77
    s_max_u32 s78, s78, s79
    s_sub_u32 s79, s75, s77
    s_max_u32 s78, s78, s79
    s_cmp_gt_u32 s78, 2
    s_cbranch_scc1 spin_o3
    s_branch spin_o3_ret
spin_o4:
    s_load_dwordx4 s[72:75], s[86:87], s5 glc
    s_add_u32 s101, s101, 1
    s_cmp_gt_u32 s101, 0x2000000
    s_waitcnt lgkmcnt(0)
    s_cbranch_scc1 spin_o4_ret
    s_sub_u32 s78, s72, s77
    s_sub_u32 s79, s73, s77
    s_max_u32 s78, s78, s79
    s_sub_u32 s79, s74, s77
    s_max_u32 s78, s78, s79
    s_sub_u32 s79, s75, s77
    s_max_u32 s78, s78, s79
    s_cmp_gt_u32 s78, 1
    s_cbranch_scc1 spin_o4
    s_branch spin_o4_ret
spin_o5:
    s_load_dwordx4 s[72:75], s[86:87], s5 glc
    s_add_u32 s101, s101, 1
    s_cmp_gt_u32 s101, 0x2000000
    s_waitcnt lgkmcnt(0)
    s_cbranch_scc1 spin_o5_ret
    s_sub_u32 s78, s72, s77
    s_sub_u32 s79, s73, s77
    s_max_u32 s78, s78, s79
    s_sub_u32 s79, s74, s77
    s_max_u32 s78, s78, s79
    s_sub_u32 s79, s75, s77
    s_max_u32 s78, s78, s79
    s_cmp_gt_u32 s78, 0
    s_cbranch_scc1 spin_o5
    s_branch spin_o5_ret
ln_exact:
    v_mov_b32 v146, 0
    v_lshlrev_b32 v156, 16, v64
    v_and_b32 v157, s42, v64
    v_sub_f32 v156, v156, v150
    v_sub_f32 v157, v157, v150
    v_fmac_f32 v146, v156, v156
    v_fmac_f32 v146, v157, v157
    v_lshlrev_b32 v156, 16, v65
    v_and_b32 v157, s42, v65
    v_sub_f32 v156, v156, v150
    v_sub_f32 v157, v157, v150
    v_fmac_f32 v146, v156, v156
    v_fmac_f32 v146, v157, v157
    v_lshlrev_b32 v156, 16, v66
    v_and_b32 v157, s42, v66
    v_sub_f32 v156, v156, v150
    v_sub_f32 v157, v157, v150
    v_fmac_f32 v146, v156, v156
    v_fmac_f32 v146, v157, v157
    v_lshlrev_b32 v156, 16, v67
    v_and_b32 v157, s42, v67
    v_sub_f32 v156, v156, v150
    v_sub_f32 v157, v157, v150
    v_fmac_f32 v146, v156, v156
    v_fmac_f32 v146, v157, v157
    v_lshlrev_b32 v156, 16, v68
    v_and_b32 v157, s42, v68
    v_sub_f32 v156, v156, v150
    v_sub_f32 v157, v157, v150
    v_fmac_f32 v146, v156, v156
    v_fmac_f32 v146, v157, v157
    v_lshlrev_b32 v156, 16, v69
    v_and_b32 v157, s42, v69
    v_sub_f32 v156, v156, v150
    v_sub_f32 v157, v157, v150
    v_fmac_f32 v146, v156, v156
    v_fmac_f32 v146, v157, v157
    v_lshlrev_b32 v156, 16, v70
    v_and_b32 v157, s42, v70
    v_sub_f32 v156, v156, v150
    v_sub_f32 v157, v157, v150
    v_fmac_f32 v146, v156, v156
    v_fmac_f32 v146, v157, v157
    v_lshlrev_b32 v156, 16, v71
    v_and_b32 v157, s42, v71
    v_sub_f32 v156, v156, v150
    v_sub_f32 v157, v157, v150
    v_fmac_f32 v146, v156, v156
    v_fmac_f32 v146, v157, v157
    v_lshlrev_b32 v156, 16, v72
    v_and_b32 v157, s42, v72
    v_sub_f32 v156, v156, v150
    v_sub_f32 v157, v157, v150
    v_fmac_f32 v146, v156, v156
    v_fmac_f32 v146, v157, v157
    v_lshlrev_b32 v156, 16, v73
    v_and_b32 v157, s42, v73
    v_sub_f32 v156, v156, v150
    v_sub_f32 v157, v157, v150
    v_fmac_f32 v146, v156, v156
    v_fmac_f32 v146, v157, v157
    v_lshlrev_b32 v156, 16, v74
    v_and_b32 v157, s42, v74
    v_sub_f32 v156, v156, v150
    v_sub_f32 v157, v157, v150
    v_fmac_f32 v146, v156, v156
    v_fmac_f32 v146, v157, v157
    v_lshlrev_b32 v156, 16, v75
    v_and_b32 v157, s42, v75
    v_sub_f32 v156, v156, v150
    v_sub_f32 v157, v157, v150
    v_fmac_f32 v146, v156, v156
    v_fmac_f32 v146, v157, v157
    v_lshlrev_b32 v156, 16, v76
    v_and_b32 v157, s42, v76
    v_sub_f32 v156, v156, v150
    v_sub_f32 v157, v157, v150
    v_fmac_f32 v146, v156, v156
    v_fmac_f32 v146, v157, v157
    v_lshlrev_b32 v156, 16, v77
    v_and_b32 v157, s42, v77
    v_sub_f32 v156, v156, v150
    v_sub_f32 v157, v157, v150
    v_fmac_f32 v146, v156, v156
    v_fmac_f32 v146, v157, v157
    v_lshlrev_b32 v156, 16, v78
    v_and_b32 v157, s42, v78
    v_sub_f32 v156, v156, v150
    v_sub_f32 v157, v157, v150
    v_fmac_f32 v146, v156, v156
    v_fmac_f32 v146, v157, v157
    v_lshlrev_b32 v156, 16, v79
    v_and_b32 v157, s42, v79
    v_sub_f32 v156, v156, v150
    v_sub_f32 v157, v157, v150
    v_fmac_f32 v146, v156, v156
    v_fmac_f32 v146, v157, v157
    v_lshlrev_b32 v156, 16, v80
    v_and_b32 v157, s42, v80
    v_sub_f32 v156, v156, v150
    v_sub_f32 v157, v157, v150
    v_fmac_f32 v146, v156, v156
    v_fmac_f32 v146, v157, v157
    v_lshlrev_b32 v156, 16, v81
    v_and_b32 v157, s42, v81
    v_sub_f32 v156, v156, v150
    v_sub_f32 v157, v157, v150
    v_fmac_f32 v146, v156, v156
    v_fmac_f32 v146, v157, v157
    v_lshlrev_b32 v156, 16, v82
    v_and_b32 v157, s42, v82
    v_sub_f32 v156, v156, v150
    v_sub_f32 v157, v157, v150
    v_fmac_f32 v146, v156, v156
    v_fmac_f32 v146, v157, v157
    v_lshlrev_b32 v156, 16, v83
    v_and_b32 v157, s42, v83
    v_sub_f32 v156, v156, v150
    v_sub_f32 v157, v157, v150
    v_fmac_f32 v146, v156, v156
    v_fmac_f32 v146, v157, v157
    s_nop 0
    s_nop 0
    v_add_f32_dpp v146, v146, v146 quad_perm:[1,0,3,2] row_mask:0xf bank_mask:0xf
    s_nop 0
    s_nop 0
    v_add_f32_dpp v146, v146, v146 row_ror:8 row_mask:0xf bank_mask:0xf
    v_mov_b32 v148, v146
    s_nop 0
    s_nop 0
    v_permlane16_swap_b32 v146, v148
    s_nop 0
    s_nop 0
    v_add_f32 v146, v146, v148
    v_mov_b32 v148, v146
    s_nop 0
    s_nop 0
    v_permlane32_swap_b32 v146, v148
    s_nop 0
    s_nop 0
    v_add_f32 v146, v146, v148
    v_mul_f32 v154, s38, v146
    s_branch ln_back
spin_y:
    s_add_u32 s101, s101, 1
    s_cmp_gt_u32 s101, 0x2000000
    s_cbranch_scc1 spin_y_x
    buffer_load_dword v58, v65, s[24:27], s41 offen sc1
    buffer_load_dword v59, v65, s[24:27], s42 offen sc1
    s_waitcnt vmcnt(0)
    v_xor_b32 v58, s58, v58
    v_xor_b32 v59, s58, v59
    v_or_b32 v58, v58, v59
    v_cmp_ne_u32 vcc, 0, v58
    s_cbranch_vccnz spin_y
spin_y_x:
    s_branch spin_y_ret
spin_rec:
    s_add_u32 s101, s101, 1
    s_cmp_gt_u32 s101, 0x2000000
    s_cbranch_scc1 spin_rec_x
    buffer_load_dwordx4 v[32:35], v17, s[24:27], s47 offen offset:0 sc1
    buffer_load_dwordx4 v[36:39], v17, s[24:27], s47 offen offset:1024 sc1
    buffer_load_dwordx4 v[40:43], v17, s[24:27], s47 offen offset:2048 sc1
    buffer_load_dwordx4 v[44:47], v17, s[24:27], s47 offen offset:3072 sc1
    s_waitcnt vmcnt(0)
    v_xor_b32 v34, s7, v34
    v_xor_b32 v38, s7, v38
    v_xor_b32 v42, s7, v42
    v_xor_b32 v46, s7, v46
    v_or3_b32 v34, v34, v38, v42
    v_or_b32 v34, v34, v46
    v_cmp_ne_u32 vcc, 0, v34
    s_cbranch_vccnz spin_rec
spin_rec_x:
    s_branch spin_rec_ret
spin_gu:
    s_add_u32 s101, s101, 1
    s_cmp_gt_u32 s101, 0x2000000
    s_cbranch_scc1 spin_gu_x
    buffer_load_dword v23, v22, s[24:27], s42 offen sc1
    s_waitcnt vmcnt(0)
    v_cmp_ne_u32 vcc, s7, v23
    s_cbranch_vccnz spin_gu
spin_gu_x:
    s_branch spin_gu_ret
rare:
    s_nop 7
    s_nop 7
    v_and_b32 v21, 15, v1
    v_mul_u32_u24 v21, 384, v21
    v_bfe_u32 v22, v1, 4, 1
    v_bfe_u32 v23, v1, 5, 1
    v_lshl_add_u32 v22, v22, 1, v23
    v_lshl_add_u32 v21, v22, 4, v21
    v_mov_b32 v24, 0
    v_mov_b32 v25, 0
    v_mov_b32 v26, 0
    v_mov_b32 v27, 0
    v_mov_b32 v28, 0
    v_mov_b32 v29, 0
    v_mov_b32 v30, 0
    v_mov_b32 v31, 0
    v_mov_b32 v32, 0
    v_mov_b32 v33, 0
    v_mov_b32 v34, 0
    v_mov_b32 v35, 0
    v_mov_b32 v36, 0
    v_mov_b32 v37, 0
    v_mov_b32 v38, 0
    v_mov_b32 v39, 0
    v_mov_b32 v16, 0xff800000
    v_mov_b32 v17, 0xff800000
    v_mov_b32 v18, 0xff800000
    v_mov_b32 v19, 0xff800000
    s_mov_b32 s78, 0
rare_pass:
    s_mov_b32 s77, 0
rare_loop:
    buffer_load_dwordx4 a[216:219], v21, s[12:15], s77 offen offset:0
    buffer_load_dwordx4 a[220:223], v21, s[12:15], s77 offen offset:64
    buffer_load_dwordx4 a[224:227], v21, s[12:15], s77 offen offset:128
    buffer_load_dwordx4 a[228:231], v21, s[12:15], s77 offen offset:192
    buffer_load_dwordx4 a[232:235], v21, s[12:15], s77 offen offset:256
    buffer_load_dwordx4 a[236:239], v21, s[12:15], s77 offen offset:320
    s_waitcnt vmcnt(0)
    v_mfma_f32_16x16x32_bf16 v[40:43], a[216:219], a[0:3], v[24:27]
    v_mfma_f32_16x16x32_bf16 v[44:47], a[216:219], a[4:7], v[28:31]
    v_mfma_f32_16x16x32_bf16 v[48:51], a[216:219], a[8:11], v[32:35]
    v_mfma_f32_16x16x32_bf16 v[52:55], a[216:219], a[12:15], v[36:39]
    v_mfma_f32_16x16x32_bf16 v[40:43], a[220:223], a[16:19], v[40:43]
    v_mfma_f32_16x16x32_bf16 v[44:47], a[220:223], a[20:23], v[44:47]
    v_mfma_f32_16x16x32_bf16 v[48:51], a[220:223], a[24:27], v[48:51]
    v_mfma_f32_16x16x32_bf16 v[52:55], a[220:223], a[28:31], v[52:55]
    v_mfma_f32_16x16x32_bf16 v[40:43], a[224:227], a[32:35], v[40:43]
    v_mfma_f32_16x16x32_bf16 v[44:47], a[224:227], a[36:39], v[44:47]
    v_mfma_f32_16x16x32_bf16 v[48:51], a[224:227], a[40:43], v[48:51]
    v_mfma_f32_16x16x32_bf16 v[52:55], a[224:227], a[44:47], v[52:55]
    v_mfma_f32_16x16x32_bf16 v[40:43], a[228:231], a[48:51], v[40:43]
    v_mfma_f32_16x16x32_bf16 v[44:47], a[228:231], a[52:55], v[44:47]
    v_mfma_f32_16x16x32_bf16 v[48:51], a[228:231], a[56:59], v[48:51]
    v_mfma_f32_16x16x32_bf16 v[52:55], a[228:231], a[60:63], v[52:55]
    v_mfma_f32_16x16x32_bf16 v[40:43], a[232:235], a[64:67], v[40:43]
    v_mfma_f32_16x16x32_bf16 v[44:47], a[232:235], a[68:71], v[44:47]
    v_mfma_f32_16x16x32_bf16 v[48:51], a[232:235], a[72:75], v[48:51]
    v_mfma_f32_16x16x32_bf16 v[52:55], a[232:235], a[76:79], v[52:55]
    v_mfma_f32_16x16x32_bf16 v[40:43], a[236:239], a[80:83], v[40:43]
    v_mfma_f32_16x16x32_bf16 v[44:47], a[236:239], a[84:87], v[44:47]
    v_mfma_f32_16x16x32_bf16 v[48:51], a[236:239], a[88:91], v[48:51]
    v_mfma_f32_16x16x32_bf16 v[52:55], a[236:239], a[92:95], v[52:55]
    s_nop 7
    s_cmp_eq_u32 s78, 0
    s_cbranch_scc0 rare_p2
    v_max3_f32 v16, v16, v40, v41
    v_max3_f32 v16, v16, v42, v43
    v_max3_f32 v17, v17, v44, v45
    v_max3_f32 v17, v17, v46, v47
    v_max3_f32 v18, v18, v48, v49
    v_max3_f32 v18, v18, v50, v51
    v_max3_f32 v19, v19, v52, v53
    v_max3_f32 v19, v19, v54, v55
    s_add_u32 s77, s77, 6144
    s_cmp_lt_u32 s77, 196608
    s_cbranch_scc1 rare_loop
    v_mov_b32 v22, v16
    s_nop 1
    v_permlane16_swap_b32 v16, v22
    s_nop 1
    v_max_f32 v16, v16, v22
    v_mov_b32 v22, v16
    s_nop 1
    v_permlane32_swap_b32 v16, v22
    s_nop 1
    v_max_f32 v16, v16, v22
    v_sub_f32 v24, 0, v16
    v_sub_f32 v25, 0, v16
    v_sub_f32 v26, 0, v16
    v_sub_f32 v27, 0, v16
    v_mov_b32 v22, v17
    s_nop 1
    v_permlane16_swap_b32 v17, v22
    s_nop 1
    v_max_f32 v17, v17, v22
    v_mov_b32 v22, v17
    s_nop 1
    v_permlane32_swap_b32 v17, v22
    s_nop 1
    v_max_f32 v17, v17, v22
    v_sub_f32 v28, 0, v17
    v_sub_f32 v29, 0, v17
    v_sub_f32 v30, 0, v17
    v_sub_f32 v31, 0, v17
    v_mov_b32 v22, v18
    s_nop 1
    v_permlane16_swap_b32 v18, v22
    s_nop 1
    v_max_f32 v18, v18, v22
    v_mov_b32 v22, v18
    s_nop 1
    v_permlane32_swap_b32 v18, v22
    s_nop 1
    v_max_f32 v18, v18, v22
    v_sub_f32 v32, 0, v18
    v_sub_f32 v33, 0, v18
    v_sub_f32 v34, 0, v18
    v_sub_f32 v35, 0, v18
    v_mov_b32 v22, v19
    s_nop 1
    v_permlane16_swap_b32 v19, v22
    s_nop 1
    v_max_f32 v19, v19, v22
    v_mov_b32 v22, v19
    s_nop 1
    v_permlane32_swap_b32 v19, v22
    s_nop 1
    v_max_f32 v19, v19, v22
    v_sub_f32 v36, 0, v19
    v_sub_f32 v37, 0, v19
    v_sub_f32 v38, 0, v19
    v_sub_f32 v39, 0, v19
    s_mov_b32 s78, 1
    s_branch rare_pass
rare_p2:
    v_exp_f32 v40, v40
    v_exp_f32 v41, v41
    v_exp_f32 v42, v42
    v_exp_f32 v43, v43
    v_exp_f32 v44, v44
    v_exp_f32 v45, v45
    v_exp_f32 v46, v46
    v_exp_f32 v47, v47
    v_exp_f32 v48, v48
    v_exp_f32 v49, v49
    v_exp_f32 v50, v50
    v_exp_f32 v51, v51
    v_exp_f32 v52, v52
    v_exp_f32 v53, v53
    v_exp_f32 v54, v54
    v_exp_f32 v55, v55
    s_cmp_eq_u32 s77, 0
    s_cbranch_scc0 rare_d0
    v_cvt_pk_bf16_f32 v22, v40, v41
    v_cvt_pk_bf16_f32 v23, v42, v43
    v_accvgpr_write_b32 a96, v22
    v_accvgpr_write_b32 a97, v23
    v_cvt_pk_bf16_f32 v22, v44, v45
    v_cvt_pk_bf16_f32 v23, v46, v47
    v_accvgpr_write_b32 a104, v22
    v_accvgpr_write_b32 a105, v23
    v_cvt_pk_bf16_f32 v22, v48, v49
    v_cvt_pk_bf16_f32 v23, v50, v51
    v_accvgpr_write_b32 a112, v22
    v_accvgpr_write_b32 a113, v23
    v_cvt_pk_bf16_f32 v22, v52, v53
    v_cvt_pk_bf16_f32 v23, v54, v55
    v_accvgpr_write_b32 a120, v22
    v_accvgpr_write_b32 a121, v23
rare_d0:
    s_cmp_eq_u32 s77, 6144
    s_cbranch_scc0 rare_d1
    v_cvt_pk_bf16_f32 v22, v40, v41
    v_cvt_pk_bf16_f32 v23, v42, v43
    v_accvgpr_write_b32 a98, v22
    v_accvgpr_write_b32 a99, v23
    v_cvt_pk_bf16_f32 v22, v44, v45
    v_cvt_pk_bf16_f32 v23, v46, v47
    v_accvgpr_write_b32 a106, v22
    v_accvgpr_write_b32 a107, v23
    v_cvt_pk_bf16_f32 v22, v48, v49
    v_cvt_pk_bf16_f32 v23, v50, v51
    v_accvgpr_write_b32 a114, v22
    v_accvgpr_write_b32 a115, v23
    v_cvt_pk_bf16_f32 v22, v52, v53
    v_cvt_pk_bf16_f32 v23, v54, v55
    v_accvgpr_write_b32 a122, v22
    v_accvgpr_write_b32 a123, v23
rare_d1:
    s_cmp_eq_u32 s77, 12288
    s_cbranch_scc0 rare_d2
    v_cvt_pk_bf16_f32 v22, v40, v41
    v_cvt_pk_bf16_f32 v23, v42, v43
    v_accvgpr_write_b32 a100, v22
    v_accvgpr_write_b32 a101, v23
    v_cvt_pk_bf16_f32 v22, v44, v45
    v_cvt_pk_bf16_f32 v23, v46, v47
    v_accvgpr_write_b32 a108, v22
    v_accvgpr_write_b32 a109, v23
    v_cvt_pk_bf16_f32 v22, v48, v49
    v_cvt_pk_bf16_f32 v23, v50, v51
    v_accvgpr_write_b32 a116, v22
    v_accvgpr_write_b32 a117, v23
    v_cvt_pk_bf16_f32 v22, v52, v53
    v_cvt_pk_bf16_f32 v23, v54, v55
    v_accvgpr_write_b32 a124, v22
    v_accvgpr_write_b32 a125, v23
rare_d2:
    s_cmp_eq_u32 s77, 18432
    s_cbranch_scc0 rare_d3
    v_cvt_pk_bf16_f32 v22, v40, v41
    v_cvt_pk_bf16_f32 v23, v42, v43
    v_accvgpr_write_b32 a102, v22
    v_accvgpr_write_b32 a103, v23
    v_cvt_pk_bf16_f32 v22, v44, v45
    v_cvt_pk_bf16_f32 v23, v46, v47
    v_accvgpr_write_b32 a110, v22
    v_accvgpr_write_b32 a111, v23
    v_cvt_pk_bf16_f32 v22, v48, v49
    v_cvt_pk_bf16_f32 v23, v50, v51
    v_accvgpr_write_b32 a118, v22
    v_accvgpr_write_b32 a119, v23
    v_cvt_pk_bf16_f32 v22, v52, v53
    v_cvt_pk_bf16_f32 v23, v54, v55
    v_accvgpr_write_b32 a126, v22
    v_accvgpr_write_b32 a127, v23
rare_d3:
    s_cmp_eq_u32 s77, 24576
    s_cbranch_scc0 rare_d4
    v_cvt_pk_bf16_f32 v22, v40, v41
    v_cvt_pk_bf16_f32 v23, v42, v43
    v_accvgpr_write_b32 a128, v22
    v_accvgpr_write_b32 a129, v23
    v_cvt_pk_bf16_f32 v22, v44, v45
    v_cvt_pk_bf16_f32 v23, v46, v47
    v_accvgpr_write_b32 a136, v22
    v_accvgpr_write_b32 a137, v23
    v_cvt_pk_bf16_f32 v22, v48, v49
    v_cvt_pk_bf16_f32 v23, v50, v51
    v_accvgpr_write_b32 a144, v22
    v_accvgpr_write_b32 a145, v23
    v_cvt_pk_bf16_f32 v120, v52, v53
    v_cvt_pk_bf16_f32 v121, v54, v55
rare_d4:
    s_cmp_eq_u32 s77, 30720
    s_cbranch_scc0 rare_d5
    v_cvt_pk_bf16_f32 v22, v40, v41
    v_cvt_pk_bf16_f32 v23, v42, v43
    v_accvgpr_write_b32 a130, v22
    v_accvgpr_write_b32 a131, v23
    v_cvt_pk_bf16_f32 v22, v44, v45
    v_cvt_pk_bf16_f32 v23, v46, v47
    v_accvgpr_write_b32 a138, v22
    v_accvgpr_write_b32 a139, v23
    v_cvt_pk_bf16_f32 v22, v48, v49
    v_cvt_pk_bf16_f32 v23, v50, v51
    v_accvgpr_write_b32 a146, v22
    v_accvgpr_write_b32 a147, v23
    v_cvt_pk_bf16_f32 v122, v52, v53
    v_cvt_pk_bf16_f32 v123, v54, v55
rare_d5:
    s_cmp_eq_u32 s77, 36864
    s_cbranch_scc0 rare_d6
    v_cvt_pk_bf16_f32 v22, v40, v41
    v_cvt_pk_bf16_f32 v23, v42, v43
    v_accvgpr_write_b32 a132, v22
    v_accvgpr_write_b32 a133, v23
    v_cvt_pk_bf16_f32 v22, v44, v45
    v_cvt_pk_bf16_f32 v23, v46, v47
    v_accvgpr_write_b32 a140, v22
    v_accvgpr_write_b32 a141, v23
    v_cvt_pk_bf16_f32 v22, v48, v49
    v_cvt_pk_bf16_f32 v23, v50, v51
    v_accvgpr_write_b32 a148, v22
    v_accvgpr_write_b32 a149, v23
    v_cvt_pk_bf16_f32 v124, v52, v53
    v_cvt_pk_bf16_f32 v125, v54, v55
rare_d6:
    s_cmp_eq_u32 s77, 43008
    s_cbranch_scc0 rare_d7
    v_cvt_pk_bf16_f32 v22, v40, v41
    v_cvt_pk_bf16_f32 v23, v42, v43
    v_accvgpr_write_b32 a134, v22
    v_accvgpr_write_b32 a135, v23
    v_cvt_pk_bf16_f32 v22, v44, v45
    v_cvt_pk_bf16_f32 v23, v46, v47
    v_accvgpr_write_b32 a142, v22
    v_accvgpr_write_b32 a143, v23
    v_cvt_pk_bf16_f32 v22, v48, v49
    v_cvt_pk_bf16_f32 v23, v50, v51
    v_accvgpr_write_b32 a150, v22
    v_accvgpr_write_b32 a151, v23
    v_cvt_pk_bf16_f32 v126, v52, v53
    v_cvt_pk_bf16_f32 v127, v54, v55
rare_d7:
    s_cmp_eq_u32 s77, 49152
    s_cbranch_scc0 rare_d8
    v_cvt_pk_bf16_f32 v128, v40, v41
    v_cvt_pk_bf16_f32 v129, v42, v43
    v_cvt_pk_bf16_f32 v136, v44, v45
    v_cvt_pk_bf16_f32 v137, v46, v47
    v_cvt_pk_bf16_f32 v144, v48, v49
    v_cvt_pk_bf16_f32 v145, v50, v51
    v_cvt_pk_bf16_f32 v152, v52, v53
    v_cvt_pk_bf16_f32 v153, v54, v55
rare_d8:
    s_cmp_eq_u32 s77, 55296
    s_cbranch_scc0 rare_d9
    v_cvt_pk_bf16_f32 v130, v40, v41
    v_cvt_pk_bf16_f32 v131, v42, v43
    v_cvt_pk_bf16_f32 v138, v44, v45
    v_cvt_pk_bf16_f32 v139, v46, v47
    v_cvt_pk_bf16_f32 v146, v48, v49
    v_cvt_pk_bf16_f32 v147, v50, v51
    v_cvt_pk_bf16_f32 v154, v52, v53
    v_cvt_pk_bf16_f32 v155, v54, v55
rare_d9:
    s_cmp_eq_u32 s77, 61440
    s_cbranch_scc0 rare_d10
    v_cvt_pk_bf16_f32 v132, v40, v41
    v_cvt_pk_bf16_f32 v133, v42, v43
    v_cvt_pk_bf16_f32 v140, v44, v45
    v_cvt_pk_bf16_f32 v141, v46, v47
    v_cvt_pk_bf16_f32 v148, v48, v49
    v_cvt_pk_bf16_f32 v149, v50, v51
    v_cvt_pk_bf16_f32 v156, v52, v53
    v_cvt_pk_bf16_f32 v157, v54, v55
rare_d10:
    s_cmp_eq_u32 s77, 67584
    s_cbranch_scc0 rare_d11
    v_cvt_pk_bf16_f32 v134, v40, v41
    v_cvt_pk_bf16_f32 v135, v42, v43
    v_cvt_pk_bf16_f32 v142, v44, v45
    v_cvt_pk_bf16_f32 v143, v46, v47
    v_cvt_pk_bf16_f32 v150, v48, v49
    v_cvt_pk_bf16_f32 v151, v50, v51
    v_cvt_pk_bf16_f32 v158, v52, v53
    v_cvt_pk_bf16_f32 v159, v54, v55
rare_d11:
    s_cmp_eq_u32 s77, 73728
    s_cbranch_scc0 rare_d12
    v_cvt_pk_bf16_f32 v160, v40, v41
    v_cvt_pk_bf16_f32 v161, v42, v43
    v_cvt_pk_bf16_f32 v168, v44, v45
    v_cvt_pk_bf16_f32 v169, v46, v47
    v_cvt_pk_bf16_f32 v176, v48, v49
    v_cvt_pk_bf16_f32 v177, v50, v51
    v_cvt_pk_bf16_f32 v184, v52, v53
    v_cvt_pk_bf16_f32 v185, v54, v55
rare_d12:
    s_cmp_eq_u32 s77, 79872
    s_cbranch_scc0 rare_d13
    v_cvt_pk_bf16_f32 v162, v40, v41
    v_cvt_pk_bf16_f32 v163, v42, v43
    v_cvt_pk_bf16_f32 v170, v44, v45
    v_cvt_pk_bf16_f32 v171, v46, v47
    v_cvt_pk_bf16_f32 v178, v48, v49
    v_cvt_pk_bf16_f32 v179, v50, v51
    v_cvt_pk_bf16_f32 v186, v52, v53
    v_cvt_pk_bf16_f32 v187, v54, v55
rare_d13:
    s_cmp_eq_u32 s77, 86016
    s_cbranch_scc0 rare_d14
    v_cvt_pk_bf16_f32 v164, v40, v41
    v_cvt_pk_bf16_f32 v165, v42, v43
    v_cvt_pk_bf16_f32 v172, v44, v45
    v_cvt_pk_bf16_f32 v173, v46, v47
    v_cvt_pk_bf16_f32 v180, v48, v49
    v_cvt_pk_bf16_f32 v181, v50, v51
    v_cvt_pk_bf16_f32 v188, v52, v53
    v_cvt_pk_bf16_f32 v189, v54, v55
rare_d14:
    s_cmp_eq_u32 s77, 92160
    s_cbranch_scc0 rare_d15
    v_cvt_pk_bf16_f32 v166, v40, v41
    v_cvt_pk_bf16_f32 v167, v42, v43
    v_cvt_pk_bf16_f32 v174, v44, v45
    v_cvt_pk_bf16_f32 v175, v46, v47
    v_cvt_pk_bf16_f32 v182, v48, v49
    v_cvt_pk_bf16_f32 v183, v50, v51
    v_cvt_pk_bf16_f32 v190, v52, v53
    v_cvt_pk_bf16_f32 v191, v54, v55
rare_d15:
    s_cmp_eq_u32 s77, 98304
    s_cbranch_scc0 rare_d16
    v_cvt_pk_bf16_f32 v192, v40, v41
    v_cvt_pk_bf16_f32 v193, v42, v43
    v_cvt_pk_bf16_f32 v200, v44, v45
    v_cvt_pk_bf16_f32 v201, v46, v47
    v_cvt_pk_bf16_f32 v208, v48, v49
    v_cvt_pk_bf16_f32 v209, v50, v51
    v_cvt_pk_bf16_f32 v216, v52, v53
    v_cvt_pk_bf16_f32 v217, v54, v55
rare_d16:
    s_cmp_eq_u32 s77, 104448
    s_cbranch_scc0 rare_d17
    v_cvt_pk_bf16_f32 v194, v40, v41
    v_cvt_pk_bf16_f32 v195, v42, v43
    v_cvt_pk_bf16_f32 v202, v44, v45
    v_cvt_pk_bf16_f32 v203, v46, v47
    v_cvt_pk_bf16_f32 v210, v48, v49
    v_cvt_pk_bf16_f32 v211, v50, v51
    v_cvt_pk_bf16_f32 v218, v52, v53
    v_cvt_pk_bf16_f32 v219, v54, v55
rare_d17:
    s_cmp_eq_u32 s77, 110592
    s_cbranch_scc0 rare_d18
    v_cvt_pk_bf16_f32 v196, v40, v41
    v_cvt_pk_bf16_f32 v197, v42, v43
    v_cvt_pk_bf16_f32 v204, v44, v45
    v_cvt_pk_bf16_f32 v205, v46, v47
    v_cvt_pk_bf16_f32 v212, v48, v49
    v_cvt_pk_bf16_f32 v213, v50, v51
    v_cvt_pk_bf16_f32 v220, v52, v53
    v_cvt_pk_bf16_f32 v221, v54, v55
rare_d18:
    s_cmp_eq_u32 s77, 116736
    s_cbranch_scc0 rare_d19
    v_cvt_pk_bf16_f32 v198, v40, v41
    v_cvt_pk_bf16_f32 v199, v42, v43
    v_cvt_pk_bf16_f32 v206, v44, v45
    v_cvt_pk_bf16_f32 v207, v46, v47
    v_cvt_pk_bf16_f32 v214, v48, v49
    v_cvt_pk_bf16_f32 v215, v50, v51
    v_cvt_pk_bf16_f32 v222, v52, v53
    v_cvt_pk_bf16_f32 v223, v54, v55
rare_d19:
    s_cmp_eq_u32 s77, 122880
    s_cbranch_scc0 rare_d20
    v_cvt_pk_bf16_f32 v224, v40, v41
    v_cvt_pk_bf16_f32 v225, v42, v43
    v_cvt_pk_bf16_f32 v232, v44, v45
    v_cvt_pk_bf16_f32 v233, v46, v47
    v_cvt_pk_bf16_f32 v240, v48, v49
    v_cvt_pk_bf16_f32 v241, v50, v51
    v_cvt_pk_bf16_f32 v248, v52, v53
    v_cvt_pk_bf16_f32 v249, v54, v55
rare_d20:
    s_cmp_eq_u32 s77, 129024
    s_cbranch_scc0 rare_d21
    v_cvt_pk_bf16_f32 v226, v40, v41
    v_cvt_pk_bf16_f32 v227, v42, v43
    v_cvt_pk_bf16_f32 v234, v44, v45
    v_cvt_pk_bf16_f32 v235, v46, v47
    v_cvt_pk_bf16_f32 v242, v48, v49
    v_cvt_pk_bf16_f32 v243, v50, v51
    v_cvt_pk_bf16_f32 v250, v52, v53
    v_cvt_pk_bf16_f32 v251, v54, v55
rare_d21:
    s_cmp_eq_u32 s77, 135168
    s_cbranch_scc0 rare_d22
    v_cvt_pk_bf16_f32 v228, v40, v41
    v_cvt_pk_bf16_f32 v229, v42, v43
    v_cvt_pk_bf16_f32 v236, v44, v45
    v_cvt_pk_bf16_f32 v237, v46, v47
    v_cvt_pk_bf16_f32 v244, v48, v49
    v_cvt_pk_bf16_f32 v245, v50, v51
    v_cvt_pk_bf16_f32 v252, v52, v53
    v_cvt_pk_bf16_f32 v253, v54, v55
rare_d22:
    s_cmp_eq_u32 s77, 141312
    s_cbranch_scc0 rare_d23
    v_cvt_pk_bf16_f32 v230, v40, v41
    v_cvt_pk_bf16_f32 v231, v42, v43
    v_cvt_pk_bf16_f32 v238, v44, v45
    v_cvt_pk_bf16_f32 v239, v46, v47
    v_cvt_pk_bf16_f32 v246, v48, v49
    v_cvt_pk_bf16_f32 v247, v50, v51
    v_cvt_pk_bf16_f32 v254, v52, v53
    v_cvt_pk_bf16_f32 v255, v54, v55
rare_d23:
    s_cmp_eq_u32 s77, 147456
    s_cbranch_scc0 rare_d24
    v_cvt_pk_bf16_f32 v56, v40, v41
    v_cvt_pk_bf16_f32 v57, v42, v43
    v_cvt_pk_bf16_f32 v64, v44, v45
    v_cvt_pk_bf16_f32 v65, v46, v47
    v_cvt_pk_bf16_f32 v72, v48, v49
    v_cvt_pk_bf16_f32 v73, v50, v51
    v_cvt_pk_bf16_f32 v80, v52, v53
    v_cvt_pk_bf16_f32 v81, v54, v55
rare_d24:
    s_cmp_eq_u32 s77, 153600
    s_cbranch_scc0 rare_d25
    v_cvt_pk_bf16_f32 v58, v40, v41
    v_cvt_pk_bf16_f32 v59, v42, v43
    v_cvt_pk_bf16_f32 v66, v44, v45
    v_cvt_pk_bf16_f32 v67, v46, v47
    v_cvt_pk_bf16_f32 v74, v48, v49
    v_cvt_pk_bf16_f32 v75, v50, v51
    v_cvt_pk_bf16_f32 v82, v52, v53
    v_cvt_pk_bf16_f32 v83, v54, v55
rare_d25:
    s_cmp_eq_u32 s77, 159744
    s_cbranch_scc0 rare_d26
    v_cvt_pk_bf16_f32 v60, v40, v41
    v_cvt_pk_bf16_f32 v61, v42, v43
    v_cvt_pk_bf16_f32 v68, v44, v45
    v_cvt_pk_bf16_f32 v69, v46, v47
    v_cvt_pk_bf16_f32 v76, v48, v49
    v_cvt_pk_bf16_f32 v77, v50, v51
    v_cvt_pk_bf16_f32 v84, v52, v53
    v_cvt_pk_bf16_f32 v85, v54, v55
rare_d26:
    s_cmp_eq_u32 s77, 165888
    s_cbranch_scc0 rare_d27
    v_cvt_pk_bf16_f32 v62, v40, v41
    v_cvt_pk_bf16_f32 v63, v42, v43
    v_cvt_pk_bf16_f32 v70, v44, v45
    v_cvt_pk_bf16_f32 v71, v46, v47
    v_cvt_pk_bf16_f32 v78, v48, v49
    v_cvt_pk_bf16_f32 v79, v50, v51
    v_cvt_pk_bf16_f32 v86, v52, v53
    v_cvt_pk_bf16_f32 v87, v54, v55
rare_d27:
    s_cmp_eq_u32 s77, 172032
    s_cbranch_scc0 rare_d28
    v_cvt_pk_bf16_f32 v88, v40, v41
    v_cvt_pk_bf16_f32 v89, v42, v43
    v_cvt_pk_bf16_f32 v96, v44, v45
    v_cvt_pk_bf16_f32 v97, v46, v47
    v_cvt_pk_bf16_f32 v104, v48, v49
    v_cvt_pk_bf16_f32 v105, v50, v51
    v_cvt_pk_bf16_f32 v112, v52, v53
    v_cvt_pk_bf16_f32 v113, v54, v55
rare_d28:
    s_cmp_eq_u32 s77, 178176
    s_cbranch_scc0 rare_d29
    v_cvt_pk_bf16_f32 v90, v40, v41
    v_cvt_pk_bf16_f32 v91, v42, v43
    v_cvt_pk_bf16_f32 v98, v44, v45
    v_cvt_pk_bf16_f32 v99, v46, v47
    v_cvt_pk_bf16_f32 v106, v48, v49
    v_cvt_pk_bf16_f32 v107, v50, v51
    v_cvt_pk_bf16_f32 v114, v52, v53
    v_cvt_pk_bf16_f32 v115, v54, v55
rare_d29:
    s_cmp_eq_u32 s77, 184320
    s_cbranch_scc0 rare_d30
    v_cvt_pk_bf16_f32 v92, v40, v41
    v_cvt_pk_bf16_f32 v93, v42, v43
    v_cvt_pk_bf16_f32 v100, v44, v45
    v_cvt_pk_bf16_f32 v101, v46, v47
    v_cvt_pk_bf16_f32 v108, v48, v49
    v_cvt_pk_bf16_f32 v109, v50, v51
    v_cvt_pk_bf16_f32 v116, v52, v53
    v_cvt_pk_bf16_f32 v117, v54, v55
rare_d30:
    s_cmp_eq_u32 s77, 190464
    s_cbranch_scc0 rare_d31
    v_cvt_pk_bf16_f32 v94, v40, v41
    v_cvt_pk_bf16_f32 v95, v42, v43
    v_cvt_pk_bf16_f32 v102, v44, v45
    v_cvt_pk_bf16_f32 v103, v46, v47
    v_cvt_pk_bf16_f32 v110, v48, v49
    v_cvt_pk_bf16_f32 v111, v50, v51
    v_cvt_pk_bf16_f32 v118, v52, v53
    v_cvt_pk_bf16_f32 v119, v54, v55
rare_d31:
    s_add_u32 s77, s77, 6144
    s_cmp_lt_u32 s77, 196608
    s_cbranch_scc1 rare_loop
    ds_read_b64_tr_b16 a[216:217], v8 offset:0
    ds_read_b64_tr_b16 a[218:219], v8 offset:2048
    ds_read_b64_tr_b16 a[220:221], v9 offset:0
    ds_read_b64_tr_b16 a[222:223], v9 offset:2048
    s_waitcnt lgkmcnt(0)
    v_mfma_f32_16x16x32_bf16 a[152:155], a[216:219], a[96:99], 0
    v_mfma_f32_16x16x32_bf16 a[156:159], a[216:219], a[104:107], 0
    v_mfma_f32_16x16x32_bf16 a[160:163], a[216:219], a[112:115], 0
    v_mfma_f32_16x16x32_bf16 a[164:167], a[216:219], a[120:123], 0
    v_mfma_f32_16x16x32_bf16 a[168:171], a[220:223], a[96:99], 0
    v_mfma_f32_16x16x32_bf16 a[172:175], a[220:223], a[104:107], 0
    v_mfma_f32_16x16x32_bf16 a[176:179], a[220:223], a[112:115], 0
    v_mfma_f32_16x16x32_bf16 a[180:183], a[220:223], a[120:123], 0
    ds_read_b64_tr_b16 a[216:217], v8 offset:4096
    ds_read_b64_tr_b16 a[218:219], v8 offset:6144
    ds_read_b64_tr_b16 a[220:221], v9 offset:4096
    ds_read_b64_tr_b16 a[222:223], v9 offset:6144
    s_waitcnt lgkmcnt(0)
    v_mfma_f32_16x16x32_bf16 a[152:155], a[216:219], a[100:103], a[152:155]
    v_mfma_f32_16x16x32_bf16 a[156:159], a[216:219], a[108:111], a[156:159]
    v_mfma_f32_16x16x32_bf16 a[160:163], a[216:219], a[116:119], a[160:163]
    v_mfma_f32_16x16x32_bf16 a[164:167], a[216:219], a[124:127], a[164:167]
    v_mfma_f32_16x16x32_bf16 a[168:171], a[220:223], a[100:103], a[168:171]
    v_mfma_f32_16x16x32_bf16 a[172:175], a[220:223], a[108:111], a[172:175]
    v_mfma_f32_16x16x32_bf16 a[176:179], a[220:223], a[116:119], a[176:179]
    v_mfma_f32_16x16x32_bf16 a[180:183], a[220:223], a[124:127], a[180:183]
    ds_read_b64_tr_b16 a[216:217], v8 offset:8192
    ds_read_b64_tr_b16 a[218:219], v8 offset:10240
    ds_read_b64_tr_b16 a[220:221], v9 offset:8192
    ds_read_b64_tr_b16 a[222:223], v9 offset:10240
    s_waitcnt lgkmcnt(0)
    v_mfma_f32_16x16x32_bf16 a[152:155], a[216:219], a[128:131], a[152:155]
    v_mfma_f32_16x16x32_bf16 a[156:159], a[216:219], a[136:139], a[156:159]
    v_mfma_f32_16x16x32_bf16 a[160:163], a[216:219], a[144:147], a[160:163]
    v_mfma_f32_16x16x32_bf16 a[164:167], a[216:219], v[120:123], a[164:167]
    v_mfma_f32_16x16x32_bf16 a[168:171], a[220:223], a[128:131], a[168:171]
    v_mfma_f32_16x16x32_bf16 a[172:175], a[220:223], a[136:139], a[172:175]
    v_mfma_f32_16x16x32_bf16 a[176:179], a[220:223], a[144:147], a[176:179]
    v_mfma_f32_16x16x32_bf16 a[180:183], a[220:223], v[120:123], a[180:183]
    ds_read_b64_tr_b16 a[216:217], v8 offset:12288
    ds_read_b64_tr_b16 a[218:219], v8 offset:14336
    ds_read_b64_tr_b16 a[220:221], v9 offset:12288
    ds_read_b64_tr_b16 a[222:223], v9 offset:14336
    s_waitcnt lgkmcnt(0)
    v_mfma_f32_16x16x32_bf16 a[152:155], a[216:219], a[132:135], a[152:155]
    v_mfma_f32_16x16x32_bf16 a[156:159], a[216:219], a[140:143], a[156:159]
    v_mfma_f32_16x16x32_bf16 a[160:163], a[216:219], a[148:151], a[160:163]
    v_mfma_f32_16x16x32_bf16 a[164:167], a[216:219], v[124:127], a[164:167]
    v_mfma_f32_16x16x32_bf16 a[168:171], a[220:223], a[132:135], a[168:171]
    v_mfma_f32_16x16x32_bf16 a[172:175], a[220:223], a[140:143], a[172:175]
    v_mfma_f32_16x16x32_bf16 a[176:179], a[220:223], a[148:151], a[176:179]
    v_mfma_f32_16x16x32_bf16 a[180:183], a[220:223], v[124:127], a[180:183]
    ds_read_b64_tr_b16 a[216:217], v8 offset:16384
    ds_read_b64_tr_b16 a[218:219], v8 offset:18432
    ds_read_b64_tr_b16 a[220:221], v9 offset:16384
    ds_read_b64_tr_b16 a[222:223], v9 offset:18432
    s_waitcnt lgkmcnt(0)
    v_mfma_f32_16x16x32_bf16 a[152:155], a[216:219], v[128:131], a[152:155]
    v_mfma_f32_16x16x32_bf16 a[156:159], a[216:219], v[136:139], a[156:159]
    v_mfma_f32_16x16x32_bf16 a[160:163], a[216:219], v[144:147], a[160:163]
    v_mfma_f32_16x16x32_bf16 a[164:167], a[216:219], v[152:155], a[164:167]
    v_mfma_f32_16x16x32_bf16 a[168:171], a[220:223], v[128:131], a[168:171]
    v_mfma_f32_16x16x32_bf16 a[172:175], a[220:223], v[136:139], a[172:175]
    v_mfma_f32_16x16x32_bf16 a[176:179], a[220:223], v[144:147], a[176:179]
    v_mfma_f32_16x16x32_bf16 a[180:183], a[220:223], v[152:155], a[180:183]
    ds_read_b64_tr_b16 a[216:217], v8 offset:20480
    ds_read_b64_tr_b16 a[218:219], v8 offset:22528
    ds_read_b64_tr_b16 a[220:221], v9 offset:20480
    ds_read_b64_tr_b16 a[222:223], v9 offset:22528
    s_waitcnt lgkmcnt(0)
    v_mfma_f32_16x16x32_bf16 a[152:155], a[216:219], v[132:135], a[152:155]
    v_mfma_f32_16x16x32_bf16 a[156:159], a[216:219], v[140:143], a[156:159]
    v_mfma_f32_16x16x32_bf16 a[160:163], a[216:219], v[148:151], a[160:163]
    v_mfma_f32_16x16x32_bf16 a[164:167], a[216:219], v[156:159], a[164:167]
    v_mfma_f32_16x16x32_bf16 a[168:171], a[220:223], v[132:135], a[168:171]
    v_mfma_f32_16x16x32_bf16 a[172:175], a[220:223], v[140:143], a[172:175]
    v_mfma_f32_16x16x32_bf16 a[176:179], a[220:223], v[148:151], a[176:179]
    v_mfma_f32_16x16x32_bf16 a[180:183], a[220:223], v[156:159], a[180:183]
    ds_read_b64_tr_b16 a[216:217], v8 offset:24576
    ds_read_b64_tr_b16 a[218:219], v8 offset:26624
    ds_read_b64_tr_b16 a[220:221], v9 offset:24576
    ds_read_b64_tr_b16 a[222:223], v9 offset:26624
    s_waitcnt lgkmcnt(0)
    v_mfma_f32_16x16x32_bf16 a[152:155], a[216:219], v[160:163], a[152:155]
    v_mfma_f32_16x16x32_bf16 a[156:159], a[216:219], v[168:171], a[156:159]
    v_mfma_f32_16x16x32_bf16 a[160:163], a[216:219], v[176:179], a[160:163]
    v_mfma_f32_16x16x32_bf16 a[164:167], a[216:219], v[184:187], a[164:167]
    v_mfma_f32_16x16x32_bf16 a[168:171], a[220:223], v[160:163], a[168:171]
    v_mfma_f32_16x16x32_bf16 a[172:175], a[220:223], v[168:171], a[172:175]
    v_mfma_f32_16x16x32_bf16 a[176:179], a[220:223], v[176:179], a[176:179]
    v_mfma_f32_16x16x32_bf16 a[180:183], a[220:223], v[184:187], a[180:183]
    ds_read_b64_tr_b16 a[216:217], v8 offset:28672
    ds_read_b64_tr_b16 a[218:219], v8 offset:30720
    ds_read_b64_tr_b16 a[220:221], v9 offset:28672
    ds_read_b64_tr_b16 a[222:223], v9 offset:30720
    s_waitcnt lgkmcnt(0)
    v_mfma_f32_16x16x32_bf16 a[152:155], a[216:219], v[164:167], a[152:155]
    v_mfma_f32_16x16x32_bf16 a[156:159], a[216:219], v[172:175], a[156:159]
    v_mfma_f32_16x16x32_bf16 a[160:163], a[216:219], v[180:183], a[160:163]
    v_mfma_f32_16x16x32_bf16 a[164:167], a[216:219], v[188:191], a[164:167]
    v_mfma_f32_16x16x32_bf16 a[168:171], a[220:223], v[164:167], a[168:171]
    v_mfma_f32_16x16x32_bf16 a[172:175], a[220:223], v[172:175], a[172:175]
    v_mfma_f32_16x16x32_bf16 a[176:179], a[220:223], v[180:183], a[176:179]
    v_mfma_f32_16x16x32_bf16 a[180:183], a[220:223], v[188:191], a[180:183]
    ds_read_b64_tr_b16 a[216:217], v8 offset:32768
    ds_read_b64_tr_b16 a[218:219], v8 offset:34816
    ds_read_b64_tr_b16 a[220:221], v9 offset:32768
    ds_read_b64_tr_b16 a[222:223], v9 offset:34816
    s_waitcnt lgkmcnt(0)
    v_mfma_f32_16x16x32_bf16 a[152:155], a[216:219], v[192:195], a[152:155]
    v_mfma_f32_16x16x32_bf16 a[156:159], a[216:219], v[200:203], a[156:159]
    v_mfma_f32_16x16x32_bf16 a[160:163], a[216:219], v[208:211], a[160:163]
    v_mfma_f32_16x16x32_bf16 a[164:167], a[216:219], v[216:219], a[164:167]
    v_mfma_f32_16x16x32_bf16 a[168:171], a[220:223], v[192:195], a[168:171]
    v_mfma_f32_16x16x32_bf16 a[172:175], a[220:223], v[200:203], a[172:175]
    v_mfma_f32_16x16x32_bf16 a[176:179], a[220:223], v[208:211], a[176:179]
    v_mfma_f32_16x16x32_bf16 a[180:183], a[220:223], v[216:219], a[180:183]
    ds_read_b64_tr_b16 a[216:217], v8 offset:36864
    ds_read_b64_tr_b16 a[218:219], v8 offset:38912
    ds_read_b64_tr_b16 a[220:221], v9 offset:36864
    ds_read_b64_tr_b16 a[222:223], v9 offset:38912
    s_waitcnt lgkmcnt(0)
    v_mfma_f32_16x16x32_bf16 a[152:155], a[216:219], v[196:199], a[152:155]
    v_mfma_f32_16x16x32_bf16 a[156:159], a[216:219], v[204:207], a[156:159]
    v_mfma_f32_16x16x32_bf16 a[160:163], a[216:219], v[212:215], a[160:163]
    v_mfma_f32_16x16x32_bf16 a[164:167], a[216:219], v[220:223], a[164:167]
    v_mfma_f32_16x16x32_bf16 a[168:171], a[220:223], v[196:199], a[168:171]
    v_mfma_f32_16x16x32_bf16 a[172:175], a[220:223], v[204:207], a[172:175]
    v_mfma_f32_16x16x32_bf16 a[176:179], a[220:223], v[212:215], a[176:179]
    v_mfma_f32_16x16x32_bf16 a[180:183], a[220:223], v[220:223], a[180:183]
    ds_read_b64_tr_b16 a[216:217], v8 offset:40960
    ds_read_b64_tr_b16 a[218:219], v8 offset:43008
    ds_read_b64_tr_b16 a[220:221], v9 offset:40960
    ds_read_b64_tr_b16 a[222:223], v9 offset:43008
    s_waitcnt lgkmcnt(0)
    v_mfma_f32_16x16x32_bf16 a[152:155], a[216:219], v[224:227], a[152:155]
    v_mfma_f32_16x16x32_bf16 a[156:159], a[216:219], v[232:235], a[156:159]
    v_mfma_f32_16x16x32_bf16 a[160:163], a[216:219], v[240:243], a[160:163]
    v_mfma_f32_16x16x32_bf16 a[164:167], a[216:219], v[248:251], a[164:167]
    v_mfma_f32_16x16x32_bf16 a[168:171], a[220:223], v[224:227], a[168:171]
    v_mfma_f32_16x16x32_bf16 a[172:175], a[220:223], v[232:235], a[172:175]
    v_mfma_f32_16x16x32_bf16 a[176:179], a[220:223], v[240:243], a[176:179]
    v_mfma_f32_16x16x32_bf16 a[180:183], a[220:223], v[248:251], a[180:183]
    ds_read_b64_tr_b16 a[216:217], v8 offset:45056
    ds_read_b64_tr_b16 a[218:219], v8 offset:47104
    ds_read_b64_tr_b16 a[220:221], v9 offset:45056
    ds_read_b64_tr_b16 a[222:223], v9 offset:47104
    s_waitcnt lgkmcnt(0)
    v_mfma_f32_16x16x32_bf16 a[152:155], a[216:219], v[228:231], a[152:155]
    v_mfma_f32_16x16x32_bf16 a[156:159], a[216:219], v[236:239], a[156:159]
    v_mfma_f32_16x16x32_bf16 a[160:163], a[216:219], v[244:247], a[160:163]
    v_mfma_f32_16x16x32_bf16 a[164:167], a[216:219], v[252:255], a[164:167]
    v_mfma_f32_16x16x32_bf16 a[168:171], a[220:223], v[228:231], a[168:171]
    v_mfma_f32_16x16x32_bf16 a[172:175], a[220:223], v[236:239], a[172:175]
    v_mfma_f32_16x16x32_bf16 a[176:179], a[220:223], v[244:247], a[176:179]
    v_mfma_f32_16x16x32_bf16 a[180:183], a[220:223], v[252:255], a[180:183]
    ds_read_b64_tr_b16 a[216:217], v8 offset:49152
    ds_read_b64_tr_b16 a[218:219], v8 offset:51200
    ds_read_b64_tr_b16 a[220:221], v9 offset:49152
    ds_read_b64_tr_b16 a[222:223], v9 offset:51200
    s_waitcnt lgkmcnt(0)
    v_mfma_f32_16x16x32_bf16 a[152:155], a[216:219], v[56:59], a[152:155]
    v_mfma_f32_16x16x32_bf16 a[156:159], a[216:219], v[64:67], a[156:159]
    v_mfma_f32_16x16x32_bf16 a[160:163], a[216:219], v[72:75], a[160:163]
    v_mfma_f32_16x16x32_bf16 a[164:167], a[216:219], v[80:83], a[164:167]
    v_mfma_f32_16x16x32_bf16 a[168:171], a[220:223], v[56:59], a[168:171]
    v_mfma_f32_16x16x32_bf16 a[172:175], a[220:223], v[64:67], a[172:175]
    v_mfma_f32_16x16x32_bf16 a[176:179], a[220:223], v[72:75], a[176:179]
    v_mfma_f32_16x16x32_bf16 a[180:183], a[220:223], v[80:83], a[180:183]
    ds_read_b64_tr_b16 a[216:217], v8 offset:53248
    ds_read_b64_tr_b16 a[218:219], v8 offset:55296
    ds_read_b64_tr_b16 a[220:221], v9 offset:53248
    ds_read_b64_tr_b16 a[222:223], v9 offset:55296
    s_waitcnt lgkmcnt(0)
    v_mfma_f32_16x16x32_bf16 a[152:155], a[216:219], v[60:63], a[152:155]
    v_mfma_f32_16x16x32_bf16 a[156:159], a[216:219], v[68:71], a[156:159]
    v_mfma_f32_16x16x32_bf16 a[160:163], a[216:219], v[76:79], a[160:163]
    v_mfma_f32_16x16x32_bf16 a[164:167], a[216:219], v[84:87], a[164:167]
    v_mfma_f32_16x16x32_bf16 a[168:171], a[220:223], v[60:63], a[168:171]
    v_mfma_f32_16x16x32_bf16 a[172:175], a[220:223], v[68:71], a[172:175]
    v_mfma_f32_16x16x32_bf16 a[176:179], a[220:223], v[76:79], a[176:179]
    v_mfma_f32_16x16x32_bf16 a[180:183], a[220:223], v[84:87], a[180:183]
    ds_read_b64_tr_b16 a[216:217], v8 offset:57344
    ds_read_b64_tr_b16 a[218:219], v8 offset:59392
    ds_read_b64_tr_b16 a[220:221], v9 offset:57344
    ds_read_b64_tr_b16 a[222:223], v9 offset:59392
    s_waitcnt lgkmcnt(0)
    v_mfma_f32_16x16x32_bf16 a[152:155], a[216:219], v[88:91], a[152:155]
    v_mfma_f32_16x16x32_bf16 a[156:159], a[216:219], v[96:99], a[156:159]
    v_mfma_f32_16x16x32_bf16 a[160:163], a[216:219], v[104:107], a[160:163]
    v_mfma_f32_16x16x32_bf16 a[164:167], a[216:219], v[112:115], a[164:167]
    v_mfma_f32_16x16x32_bf16 a[168:171], a[220:223], v[88:91], a[168:171]
    v_mfma_f32_16x16x32_bf16 a[172:175], a[220:223], v[96:99], a[172:175]
    v_mfma_f32_16x16x32_bf16 a[176:179], a[220:223], v[104:107], a[176:179]
    v_mfma_f32_16x16x32_bf16 a[180:183], a[220:223], v[112:115], a[180:183]
    ds_read_b64_tr_b16 a[216:217], v8 offset:61440
    ds_read_b64_tr_b16 a[218:219], v8 offset:63488
    ds_read_b64_tr_b16 a[220:221], v9 offset:61440
    ds_read_b64_tr_b16 a[222:223], v9 offset:63488
    s_waitcnt lgkmcnt(0)
    v_mfma_f32_16x16x32_bf16 a[152:155], a[216:219], v[92:95], a[152:155]
    v_mfma_f32_16x16x32_bf16 a[156:159], a[216:219], v[100:103], a[156:159]
    v_mfma_f32_16x16x32_bf16 a[160:163], a[216:219], v[108:111], a[160:163]
    v_mfma_f32_16x16x32_bf16 a[164:167], a[216:219], v[116:119], a[164:167]
    v_mfma_f32_16x16x32_bf16 a[168:171], a[220:223], v[92:95], a[168:171]
    v_mfma_f32_16x16x32_bf16 a[172:175], a[220:223], v[100:103], a[172:175]
    v_mfma_f32_16x16x32_bf16 a[176:179], a[220:223], v[108:111], a[176:179]
    v_mfma_f32_16x16x32_bf16 a[180:183], a[220:223], v[116:119], a[180:183]
    v_mov_b32 v24, 0
    v_mov_b32 v25, 0
    v_mov_b32 v26, 0
    v_mov_b32 v27, 0
    v_mov_b32 v28, 0
    v_mov_b32 v29, 0
    v_mov_b32 v30, 0
    v_mov_b32 v31, 0
    v_mov_b32 v32, 0
    v_mov_b32 v33, 0
    v_mov_b32 v34, 0
    v_mov_b32 v35, 0
    v_mov_b32 v36, 0
    v_mov_b32 v37, 0
    v_mov_b32 v38, 0
    v_mov_b32 v39, 0
    s_nop 1
    v_smfmac_f32_16x16x64_bf16 v[24:27], a[248:251], a[96:103], v20
    v_smfmac_f32_16x16x64_bf16 v[28:31], a[248:251], a[104:111], v20
    v_smfmac_f32_16x16x64_bf16 v[32:35], a[248:251], a[112:119], v20
    v_smfmac_f32_16x16x64_bf16 v[36:39], a[248:251], a[120:127], v20
    v_smfmac_f32_16x16x64_bf16 v[24:27], a[248:251], a[128:135], v20
    v_smfmac_f32_16x16x64_bf16 v[28:31], a[248:251], a[136:143], v20
    v_smfmac_f32_16x16x64_bf16 v[32:35], a[248:251], a[144:151], v20
    v_smfmac_f32_16x16x64_bf16 v[36:39], a[248:251], v[120:127], v20
    v_smfmac_f32_16x16x64_bf16 v[24:27], a[248:251], v[128:135], v20
    v_smfmac_f32_16x16x64_bf16 v[28:31], a[248:251], v[136:143], v20
    v_smfmac_f32_16x16x64_bf16 v[32:35], a[248:251], v[144:151], v20
    v_smfmac_f32_16x16x64_bf16 v[36:39], a[248:251], v[152:159], v20
    v_smfmac_f32_16x16x64_bf16 v[24:27], a[248:251], v[160:167], v20
    v_smfmac_f32_16x16x64_bf16 v[28:31], a[248:251], v[168:175], v20
    v_smfmac_f32_16x16x64_bf16 v[32:35], a[248:251], v[176:183], v20
    v_smfmac_f32_16x16x64_bf16 v[36:39], a[248:251], v[184:191], v20
    v_smfmac_f32_16x16x64_bf16 v[24:27], a[248:251], v[192:199], v20
    v_smfmac_f32_16x16x64_bf16 v[28:31], a[248:251], v[200:207], v20
    v_smfmac_f32_16x16x64_bf16 v[32:35], a[248:251], v[208:215], v20
    v_smfmac_f32_16x16x64_bf16 v[36:39], a[248:251], v[216:223], v20
    v_smfmac_f32_16x16x64_bf16 v[24:27], a[248:251], v[224:231], v20
    v_smfmac_f32_16x16x64_bf16 v[28:31], a[248:251], v[232:239], v20
    v_smfmac_f32_16x16x64_bf16 v[32:35], a[248:251], v[240:247], v20
    v_smfmac_f32_16x16x64_bf16 v[36:39], a[248:251], v[248:255], v20
    v_smfmac_f32_16x16x64_bf16 v[24:27], a[248:251], v[56:63], v20
    v_smfmac_f32_16x16x64_bf16 v[28:31], a[248:251], v[64:71], v20
    v_smfmac_f32_16x16x64_bf16 v[32:35], a[248:251], v[72:79], v20
    v_smfmac_f32_16x16x64_bf16 v[36:39], a[248:251], v[80:87], v20
    v_smfmac_f32_16x16x64_bf16 v[24:27], a[248:251], v[88:95], v20
    v_smfmac_f32_16x16x64_bf16 v[28:31], a[248:251], v[96:103], v20
    v_smfmac_f32_16x16x64_bf16 v[32:35], a[248:251], v[104:111], v20
    v_smfmac_f32_16x16x64_bf16 v[36:39], a[248:251], v[112:119], v20
    s_nop 15
    v_add_f32 v24, v24, v25
    v_add_f32 v28, v28, v29
    v_add_f32 v32, v32, v33
    v_add_f32 v36, v36, v37
    v_rcp_f32 v16, v24
    v_rcp_f32 v17, v28
    v_rcp_f32 v18, v32
    v_rcp_f32 v19, v36
    s_nop 1
    s_branch rare_ret
code_end:
    s_endpgm
.section .rodata,"a"
.p2align 6
.amdhsa_kernel recurrent_scan__sliding_block_cached__moe_arch_mod__prompt_kernel
  .amdhsa_next_free_vgpr 512
  .amdhsa_next_free_sgpr 102
  .amdhsa_accum_offset 256
  .amdhsa_group_segment_fixed_size 0
  .amdhsa_kernarg_size 104
  .amdhsa_user_sgpr_count 2
  .amdhsa_user_sgpr_kernarg_segment_ptr 1
  .amdhsa_system_sgpr_workgroup_id_x 1
  .amdhsa_float_denorm_mode_32 3
.end_amdhsa_kernel
```

```asm
; @launch grid=(256,1,1) block=(256,1,1) lds=163840
.amdgcn_target "amdgcn-amd-amdhsa--gfx950"
.text
.globl recurrent_scan__sliding_block_cached__moe_arch_mod__prompt_kernel
.p2align 12
.p2align 8
.type recurrent_scan__sliding_block_cached__moe_arch_mod__prompt_kernel,@function
recurrent_scan__sliding_block_cached__moe_arch_mod__prompt_kernel:
    s_cmp_ge_u32 s2, 256
    s_cbranch_scc1 main_end
    s_load_dwordx16 s[64:79], s[0:1], 0
    s_load_dwordx4 s[80:83], s[0:1], 64
    s_load_dwordx2 s[84:85], s[0:1], 80
    s_load_dwordx2 s[86:87], s[0:1], 96
    s_lshr_b32 s56, s2, 3
    s_lshl_b32 s56, s56, 10
    v_lshrrev_b32 v18, 5, v0
    v_lshlrev_b32 v18, 7, v18
    v_add_u32 v18, s56, v18
    s_getpc_b64 s[88:89]
code0:
    v_and_b32 v19, 3, v0
    v_lshl_add_u32 v19, v19, 15, v18
    v_min_u32 v19, code_end-code0-4, v19
    global_load_dword a252, v19, s[88:89]
    v_lshrrev_b32 v17, 6, v0
    v_lshlrev_b32 v17, 12, v17
    v_and_b32 v1, 63, v0
    v_lshl_add_u32 v17, v1, 4, v17
    v_lshrrev_b32 v29, 6, v0
    v_mov_b32 v16, v0
    v_readfirstlane_b32 s3, v29
    s_and_b32 s53, s2, 7
    s_lshr_b32 s52, s2, 5
    s_bfe_u32 s51, s2, 0x20003
    s_lshl_b32 s50, s53, 2
    s_add_u32 s50, s50, s51
    s_lshl_b32 s60, s2, 3
    s_lshl2_add_u32 s60, s3, s60
    v_bfe_u32 v240, v1, 1, 2
    v_add_u32 v240, s60, v240
    v_lshrrev_b32 v241, 3, v1
    v_lshlrev_b32 v241, 5, v241
    v_and_b32 v29, 1, v1
    v_lshl_add_u32 v241, v29, 4, v241
    v_mul_u32_u24 v242, 1280, v240
    v_add_u32 v242, v242, v241
    s_cmp_lt_u32 s3, 2
    s_cselect_b32 s44, 0, 0x70000000
    v_lshrrev_b32 v29, 4, v1
    v_lshlrev_b32 v29, 1, v29
    v_and_b32 v7, 7, v1
    v_xor_b32 v7, v7, v29
    v_lshlrev_b32 v7, 4, v7
    v_lshrrev_b32 v29, 5, v1
    v_lshlrev_b32 v29, 3, v29
    v_bfe_u32 v5, v1, 3, 2
    v_add_u32 v5, v5, v29
    v_mul_u32_u24 v2, 12288, v5
    v_add_u32 v2, v2, v7
    v_add_u32 v3, 196608, v2
    s_lshl_b32 s54, s52, 2
    s_add_u32 s54, s54, s3
    s_mul_i32 s49, s3, 6144
    s_lshr_b32 s59, s3, 1
    s_lshl_b32 s59, s59, 5
    s_and_b32 s56, s3, 1
    s_lshl_b32 s56, s56, 2
    s_add_u32 s59, s59, s56
    s_mul_i32 s36, s59, 12288
    s_mov_b32 s37, 786432
    s_add_u32 s45, s51, s52
    s_and_b32 s45, s45, 3
    s_lshl_b32 s45, s45, 2
    s_lshr_b32 s45, 0x5050, s45
    s_and_b32 s45, s45, 15
    s_mul_i32 s56, s45, 786432
    s_add_u32 s36, s36, s56
    s_lshl_b32 s45, s45, 13
    s_andn2_b32 s56, 2, s2
    s_lshl_b32 s56, s56, 9
    s_add_u32 s45, s45, s56
    s_mul_i32 s56, s50, 384
    s_sub_u32 s57, 7864320, s56
    s_waitcnt lgkmcnt(0)
    s_mov_b32 s12, s64
    s_and_b32 s13, s65, 0xffff
    s_mov_b32 s14, 2621440
    s_mov_b32 s15, 0x00020000
    s_mov_b32 s16, s76
    s_and_b32 s17, s77, 0xffff
    s_mov_b32 s18, 1280
    s_mov_b32 s19, 0x00020000
    s_cmp_lt_u32 s3, 2
    s_cbranch_scc0 no_lx
    buffer_load_dwordx4 v[64:67], v242, s[12:15], 0 offen offset:0
    buffer_load_dwordx4 v[68:71], v242, s[12:15], 0 offen offset:256
    buffer_load_dwordx4 v[72:75], v242, s[12:15], 0 offen offset:512
    buffer_load_dwordx4 v[76:79], v242, s[12:15], 0 offen offset:768
    buffer_load_dwordx4 v[80:83], v242, s[12:15], 0 offen offset:1024
    buffer_load_dwordx4 v[84:87], v241, s[16:19], 0 offen offset:0
    buffer_load_dwordx4 v[88:91], v241, s[16:19], 0 offen offset:256
    buffer_load_dwordx4 v[92:95], v241, s[16:19], 0 offen offset:512
    buffer_load_dwordx4 v[96:99], v241, s[16:19], 0 offen offset:768
    buffer_load_dwordx4 v[100:103], v241, s[16:19], 0 offen offset:1024
no_lx:
    v_mov_b32 v25, 3203072
    global_load_dword v26, v25, s[86:87] sc1
    s_lshr_b32 s47, s2, 3
    s_lshl_b32 s47, s47, 7
    s_add_u32 s47, s47, 4128768
    s_load_dword s93, s[86:87], s47 glc
    s_add_u32 s8, s70, s56
    s_addc_u32 s9, s71, 0
    s_and_b32 s9, s9, 0xffff
    s_mov_b32 s10, s57
    s_mov_b32 s11, 0x00020000
    s_cmp_lt_u32 s3, 2
    s_cbranch_scc1 no_w0
    s_sub_u32 s47, s36, 393216
    s_add_u32 m0, s49, 36864
    s_nop 0
    buffer_load_dwordx4 v2, s[8:11], s47 offen offset:0 lds
    s_add_u32 m0, s49, 37760
    s_nop 0
    buffer_load_dwordx4 v2, s[8:11], s47 offen offset:128 lds
    s_add_u32 m0, s49, 38656
    s_nop 0
    buffer_load_dwordx4 v2, s[8:11], s47 offen offset:256 lds
    s_add_u32 m0, s49, 39936
    s_nop 0
    buffer_load_dwordx4 v3, s[8:11], s47 offen offset:0 lds
    s_add_u32 m0, s49, 40832
    s_nop 0
    buffer_load_dwordx4 v3, s[8:11], s47 offen offset:128 lds
    s_add_u32 m0, s49, 41728
    s_nop 0
    buffer_load_dwordx4 v3, s[8:11], s47 offen offset:256 lds
    s_add_u32 m0, s49, 49152
    s_nop 0
    buffer_load_dwordx4 v2, s[8:11], s36 offen offset:0 lds
    s_add_u32 m0, s49, 50048
    s_nop 0
    buffer_load_dwordx4 v2, s[8:11], s36 offen offset:128 lds
    s_add_u32 m0, s49, 50944
    s_nop 0
    buffer_load_dwordx4 v2, s[8:11], s36 offen offset:256 lds
    s_add_u32 m0, s49, 52224
    s_nop 0
    buffer_load_dwordx4 v3, s[8:11], s36 offen offset:0 lds
    s_add_u32 m0, s49, 53120
    s_nop 0
    buffer_load_dwordx4 v3, s[8:11], s36 offen offset:128 lds
    s_add_u32 m0, s49, 54016
    s_nop 0
    buffer_load_dwordx4 v3, s[8:11], s36 offen offset:256 lds
    s_add_u32 s36, s36, s37
    s_sub_u32 s55, s36, 7864320
    s_min_u32 s36, s36, s55
no_w0:
    s_mov_b32 s24, s86
    s_and_b32 s25, s87, 0xffff
    s_mov_b32 s26, 268435456
    s_mov_b32 s27, 0x00020000
    s_lshr_b32 s56, s60, 6
    s_mul_i32 s41, s56, 81920
    s_and_b32 s56, s60, 63
    s_lshl_b32 s56, s56, 6
    s_add_u32 s41, s41, s56
    v_lshrrev_b32 v29, 4, v1
    v_and_b32 v243, 15, v1
    v_lshlrev_b32 v243, 4, v243
    v_lshl_add_u32 v243, v29, 12, v243
    s_mov_b32 s38, 0x3acccccd
    s_mov_b32 s42, 0xffff0000
    s_mov_b32 s43, 0x3f803f80
    v_bfe_u32 v29, v1, 2, 3
    v_lshlrev_b32 v8, 7, v29
    v_lshrrev_b32 v29, 1, v29
    v_xor_b32 v29, 0, v29
    v_lshl_add_u32 v8, v29, 5, v8
    v_and_b32 v29, 3, v1
    v_lshl_add_u32 v8, v29, 3, v8
    v_lshrrev_b32 v29, 5, v1
    v_mul_u32_u24 v29, 3072, v29
    v_add_u32 v8, v8, v29
    v_add_u32 v8, 49152, v8
    v_xor_b32 v9, 32, v8
    v_xor_b32 v10, 64, v8
    v_xor_b32 v11, 96, v8
    v_and_b32 v15, 12, v1
    v_lshlrev_b32 v15, 6, v15
    v_and_b32 v29, 3, v1
    v_lshl_add_u32 v15, v29, 5, v15
    v_and_b32 v29, 16, v1
    v_add_u32 v15, v15, v29
    v_and_b32 v29, 32, v1
    v_lshl_add_u32 v15, v29, 2, v15
    s_and_b32 s56, s2, 1
    s_lshl_b32 s56, s56, 11
    v_add_u32 v15, s56, v15
    v_xor_b32 v14, 2048, v15
    s_mul_i32 s56, s54, 81920
    s_add_u32 s56, s56, 0
    s_add_u32 s20, s86, s56
    s_addc_u32 s21, s87, 0
    s_and_b32 s21, s21, 0xffff
    s_mov_b32 s22, 81920
    s_mov_b32 s23, 0x00020000
    s_lshl_b32 s46, s54, 7
    s_add_u32 s46, s46, 4128768
    s_mov_b32 s101, 0
    s_lshl_b32 s56, s53, 12
    s_add_u32 s46, s46, s56
    s_load_dword s92, s[86:87], s46 glc
    s_lshr_b32 s6, s2, 3
    s_lshl_b32 s6, s6, 7
    s_lshl_b32 s56, s53, 2
    s_add_u32 s6, s6, s56
    s_add_u32 s6, s6, 4128768
    v_lshlrev_b32 v20, 12, v1
    s_cmp_eq_u32 s3, 0
    s_cselect_b32 s6, s6, 0x70000000
    v_mov_b32 v144, 0
    v_mov_b32 v145, 0
    v_mov_b32 v146, 0
    v_mov_b32 v147, 0
    s_cmp_lt_u32 s3, 2
    s_cbranch_scc1 ln_go
no_ln:
    s_mov_b64 exec, 0
    s_cmp_eq_u32 s3, 2
    s_cbranch_scc1 pg_0
    s_branch pg_1
pg_back:
    s_mov_b64 exec, -1
    s_sub_u32 s47, s36, 393216
    s_add_u32 m0, s49, 61440
    s_nop 0
    buffer_load_dwordx4 v2, s[8:11], s47 offen offset:0 lds
    s_add_u32 m0, s49, 62336
    s_nop 0
    buffer_load_dwordx4 v2, s[8:11], s47 offen offset:128 lds
    s_add_u32 m0, s49, 63232
    s_nop 0
    buffer_load_dwordx4 v2, s[8:11], s47 offen offset:256 lds
    s_add_u32 m0, s49, 64512
    s_nop 0
    buffer_load_dwordx4 v3, s[8:11], s47 offen offset:0 lds
    s_add_u32 m0, s49, 65408
    s_nop 0
    buffer_load_dwordx4 v3, s[8:11], s47 offen offset:128 lds
    s_add_u32 m0, s49, 66304
    s_nop 0
    buffer_load_dwordx4 v3, s[8:11], s47 offen offset:256 lds
    s_add_u32 m0, s49, 73728
    s_nop 0
    buffer_load_dwordx4 v2, s[8:11], s36 offen offset:0 lds
    s_add_u32 m0, s49, 74624
    s_nop 0
    buffer_load_dwordx4 v2, s[8:11], s36 offen offset:128 lds
    s_add_u32 m0, s49, 75520
    s_nop 0
    buffer_load_dwordx4 v2, s[8:11], s36 offen offset:256 lds
    s_add_u32 m0, s49, 76800
    s_nop 0
    buffer_load_dwordx4 v3, s[8:11], s36 offen offset:0 lds
    s_add_u32 m0, s49, 77696
    s_nop 0
    buffer_load_dwordx4 v3, s[8:11], s36 offen offset:128 lds
    s_add_u32 m0, s49, 78592
    s_nop 0
    buffer_load_dwordx4 v3, s[8:11], s36 offen offset:256 lds
    s_add_u32 s36, s36, s37
    s_sub_u32 s55, s36, 7864320
    s_min_u32 s36, s36, s55
    s_waitcnt vmcnt(24)
    v_readfirstlane_b32 s7, v26
    s_lshr_b32 s7, s7, 4
    s_mul_i32 s7, s7, 0x2c9277b5
    s_add_u32 s7, s7, 0x6c564b05
    s_lshl_b32 s7, s7, 4
    s_branch ln_join
ln_go:
    s_waitcnt vmcnt(10)
    v_dot2c_f32_bf16 v144, s43, v64
    v_dot2c_f32_bf16 v146, v64, v64
    v_dot2c_f32_bf16 v145, s43, v65
    v_dot2c_f32_bf16 v147, v65, v65
    v_dot2c_f32_bf16 v144, s43, v66
    v_dot2c_f32_bf16 v146, v66, v66
    v_dot2c_f32_bf16 v145, s43, v67
    v_dot2c_f32_bf16 v147, v67, v67
    v_lshlrev_b32 v104, 16, v64
    v_and_b32 v105, s42, v64
    v_lshlrev_b32 v106, 16, v65
    v_and_b32 v107, s42, v65
    v_lshlrev_b32 v108, 16, v66
    v_and_b32 v109, s42, v66
    v_lshlrev_b32 v110, 16, v67
    s_waitcnt vmcnt(9)
    v_dot2c_f32_bf16 v144, s43, v68
    v_dot2c_f32_bf16 v146, v68, v68
    v_dot2c_f32_bf16 v145, s43, v69
    v_dot2c_f32_bf16 v147, v69, v69
    v_dot2c_f32_bf16 v144, s43, v70
    v_dot2c_f32_bf16 v146, v70, v70
    v_dot2c_f32_bf16 v145, s43, v71
    v_dot2c_f32_bf16 v147, v71, v71
    v_and_b32 v111, s42, v67
    v_lshlrev_b32 v112, 16, v68
    v_and_b32 v113, s42, v68
    v_lshlrev_b32 v114, 16, v69
    v_and_b32 v115, s42, v69
    v_lshlrev_b32 v116, 16, v70
    v_and_b32 v117, s42, v70
    s_waitcnt vmcnt(8)
    v_dot2c_f32_bf16 v144, s43, v72
    v_dot2c_f32_bf16 v146, v72, v72
    v_dot2c_f32_bf16 v145, s43, v73
    v_dot2c_f32_bf16 v147, v73, v73
    v_dot2c_f32_bf16 v144, s43, v74
    v_dot2c_f32_bf16 v146, v74, v74
    v_dot2c_f32_bf16 v145, s43, v75
    v_dot2c_f32_bf16 v147, v75, v75
    v_lshlrev_b32 v118, 16, v71
    v_and_b32 v119, s42, v71
    v_lshlrev_b32 v120, 16, v72
    v_and_b32 v121, s42, v72
    v_lshlrev_b32 v122, 16, v73
    v_and_b32 v123, s42, v73
    v_lshlrev_b32 v124, 16, v74
    s_waitcnt vmcnt(7)
    v_dot2c_f32_bf16 v144, s43, v76
    v_dot2c_f32_bf16 v146, v76, v76
    v_dot2c_f32_bf16 v145, s43, v77
    v_dot2c_f32_bf16 v147, v77, v77
    v_dot2c_f32_bf16 v144, s43, v78
    v_dot2c_f32_bf16 v146, v78, v78
    v_dot2c_f32_bf16 v145, s43, v79
    v_dot2c_f32_bf16 v147, v79, v79
    v_and_b32 v125, s42, v74
    v_lshlrev_b32 v126, 16, v75
    v_and_b32 v127, s42, v75
    v_lshlrev_b32 v128, 16, v76
    v_and_b32 v129, s42, v76
    v_lshlrev_b32 v130, 16, v77
    v_and_b32 v131, s42, v77
    s_waitcnt vmcnt(6)
    v_dot2c_f32_bf16 v144, s43, v80
    v_dot2c_f32_bf16 v146, v80, v80
    v_dot2c_f32_bf16 v145, s43, v81
    v_dot2c_f32_bf16 v147, v81, v81
    v_dot2c_f32_bf16 v144, s43, v82
    v_dot2c_f32_bf16 v146, v82, v82
    v_dot2c_f32_bf16 v145, s43, v83
    v_dot2c_f32_bf16 v147, v83, v83
    v_lshlrev_b32 v132, 16, v78
    v_and_b32 v133, s42, v78
    v_lshlrev_b32 v134, 16, v79
    v_add_f32 v144, v144, v145
    v_add_f32 v146, v146, v147
    v_and_b32 v135, s42, v79
    v_add_f32_dpp v144, v144, v144 quad_perm:[1,0,3,2] row_mask:0xf bank_mask:0xf
    v_add_f32_dpp v146, v146, v146 quad_perm:[1,0,3,2] row_mask:0xf bank_mask:0xf
    v_lshlrev_b32 v136, 16, v80
    v_add_f32_dpp v144, v144, v144 row_ror:8 row_mask:0xf bank_mask:0xf
    v_add_f32_dpp v146, v146, v146 row_ror:8 row_mask:0xf bank_mask:0xf
    v_mov_b32 v148, v144
    v_mov_b32 v149, v146
    v_and_b32 v137, s42, v80
    v_permlane16_swap_b32 v144, v148
    v_permlane16_swap_b32 v146, v149
    v_lshlrev_b32 v138, 16, v81
    v_add_f32 v144, v144, v148
    v_add_f32 v146, v146, v149
    v_mov_b32 v148, v144
    v_mov_b32 v149, v146
    v_and_b32 v139, s42, v81
    v_permlane32_swap_b32 v144, v148
    v_permlane32_swap_b32 v146, v149
    v_lshlrev_b32 v140, 16, v82
    v_add_f32 v144, v144, v148
    v_add_f32 v146, v146, v149
    v_mul_f32 v150, s38, v144
    v_mul_f32 v146, s38, v146
    v_fma_f32 v154, -v150, v150, v146
    v_mul_f32 v146, 0x3d800000, v146
    v_cmp_nge_f32 vcc, v154, v146
    s_cbranch_vccnz ln_exact
ln_back:
    v_cvt_pk_bf16_f32 v154, 0, v154
    v_cvt_pk_bf16_f32 v150, 0, v150
    v_add_f32 v154, 0x3727c5ac, v154
    v_cvt_pk_bf16_f32 v154, 0, v154
    v_sqrt_f32 v154, v154
    v_and_b32 v141, s42, v82
    v_cvt_pk_bf16_f32 v154, 0, v154
    v_rcp_f32 v151, v154
    v_lshlrev_b32 v142, 16, v83
    v_mul_f32 v144, 0x3dd53b95, v151
    v_mul_f32 v146, -v150, v144
    v_pk_fma_f32 v[156:157], v[104:105], v[144:145], v[146:147] op_sel_hi:[1,0,0]
    v_cvt_pk_bf16_f32 v160, v156, v157
    v_pk_fma_f32 v[158:159], v[106:107], v[144:145], v[146:147] op_sel_hi:[1,0,0]
    v_cvt_pk_bf16_f32 v161, v158, v159
    v_pk_fma_f32 v[156:157], v[108:109], v[144:145], v[146:147] op_sel_hi:[1,0,0]
    v_cvt_pk_bf16_f32 v162, v156, v157
    v_pk_fma_f32 v[158:159], v[110:111], v[144:145], v[146:147] op_sel_hi:[1,0,0]
    v_cvt_pk_bf16_f32 v163, v158, v159
    buffer_store_dwordx4 v[160:163], v243, s[24:27], s41 offen sc1
    s_addk_i32 s41, 16384
    v_pk_fma_f32 v[156:157], v[112:113], v[144:145], v[146:147] op_sel_hi:[1,0,0]
    v_cvt_pk_bf16_f32 v164, v156, v157
    v_pk_fma_f32 v[158:159], v[114:115], v[144:145], v[146:147] op_sel_hi:[1,0,0]
    v_cvt_pk_bf16_f32 v165, v158, v159
    v_pk_fma_f32 v[156:157], v[116:117], v[144:145], v[146:147] op_sel_hi:[1,0,0]
    v_cvt_pk_bf16_f32 v166, v156, v157
    v_pk_fma_f32 v[158:159], v[118:119], v[144:145], v[146:147] op_sel_hi:[1,0,0]
    v_cvt_pk_bf16_f32 v167, v158, v159
    buffer_store_dwordx4 v[164:167], v243, s[24:27], s41 offen sc1
    s_addk_i32 s41, 16384
    v_pk_fma_f32 v[156:157], v[120:121], v[144:145], v[146:147] op_sel_hi:[1,0,0]
    v_cvt_pk_bf16_f32 v168, v156, v157
    v_pk_fma_f32 v[158:159], v[122:123], v[144:145], v[146:147] op_sel_hi:[1,0,0]
    v_cvt_pk_bf16_f32 v169, v158, v159
    v_pk_fma_f32 v[156:157], v[124:125], v[144:145], v[146:147] op_sel_hi:[1,0,0]
    v_cvt_pk_bf16_f32 v170, v156, v157
    v_pk_fma_f32 v[158:159], v[126:127], v[144:145], v[146:147] op_sel_hi:[1,0,0]
    v_cvt_pk_bf16_f32 v171, v158, v159
    buffer_store_dwordx4 v[168:171], v243, s[24:27], s41 offen sc1
    s_addk_i32 s41, 16384
    v_pk_fma_f32 v[156:157], v[128:129], v[144:145], v[146:147] op_sel_hi:[1,0,0]
    v_cvt_pk_bf16_f32 v172, v156, v157
    v_pk_fma_f32 v[158:159], v[130:131], v[144:145], v[146:147] op_sel_hi:[1,0,0]
    v_cvt_pk_bf16_f32 v173, v158, v159
    v_pk_fma_f32 v[156:157], v[132:133], v[144:145], v[146:147] op_sel_hi:[1,0,0]
    v_cvt_pk_bf16_f32 v174, v156, v157
    v_pk_fma_f32 v[158:159], v[134:135], v[144:145], v[146:147] op_sel_hi:[1,0,0]
    v_cvt_pk_bf16_f32 v175, v158, v159
    buffer_store_dwordx4 v[172:175], v243, s[24:27], s41 offen sc1
    s_addk_i32 s41, 16384
    v_pk_fma_f32 v[156:157], v[136:137], v[144:145], v[146:147] op_sel_hi:[1,0,0]
    v_cvt_pk_bf16_f32 v176, v156, v157
    v_pk_fma_f32 v[158:159], v[138:139], v[144:145], v[146:147] op_sel_hi:[1,0,0]
    v_cvt_pk_bf16_f32 v177, v158, v159
    v_pk_fma_f32 v[156:157], v[140:141], v[144:145], v[146:147] op_sel_hi:[1,0,0]
    v_cvt_pk_bf16_f32 v178, v156, v157
    v_and_b32 v143, s42, v83
    v_pk_fma_f32 v[158:159], v[142:143], v[144:145], v[146:147] op_sel_hi:[1,0,0]
    v_cvt_pk_bf16_f32 v179, v158, v159
    buffer_store_dwordx4 v[176:179], v243, s[24:27], s41 offen sc1
    s_waitcnt vmcnt(5)
    v_readfirstlane_b32 s7, v26
    s_lshr_b32 s7, s7, 4
    s_mul_i32 s7, s7, 0x2c9277b5
    s_add_u32 s7, s7, 0x6c564b05
    s_lshl_b32 s7, s7, 4
    s_add_u32 s36, s36, s37
    s_sub_u32 s55, s36, 7864320
    s_min_u32 s36, s36, s55
    s_add_u32 s36, s36, s37
    s_sub_u32 s55, s36, 7864320
    s_min_u32 s36, s36, s55
    s_mov_b64 exec, 0
    s_cmp_eq_u32 s3, 0
    s_cbranch_scc1 pg_2
    s_branch pg_3
pg_backL:
    s_mov_b64 exec, -1
    s_waitcnt vmcnt(0)
ln_join:
    s_waitcnt lgkmcnt(0)
    s_barrier
    v_mov_b32 v21, s7
    s_mov_b64 exec, 0xff
    buffer_store_dword v21, v20, s[24:27], s6 offen sc1
    s_mov_b64 exec, 0x55
    v_lshlrev_b32 v29, 3, v240
    s_add_u32 s56, s44, 3211264
    buffer_store_dwordx2 v[150:151], v29, s[24:27], s56 offen sc1
    s_mov_b64 exec, -1
    s_add_u32 m0, s49, 98304
    s_nop 0
    buffer_load_dwordx4 v2, s[8:11], s36 offen offset:0 lds
    s_add_u32 m0, s49, 99200
    s_nop 0
    buffer_load_dwordx4 v2, s[8:11], s36 offen offset:128 lds
    s_add_u32 m0, s49, 100096
    s_nop 0
    buffer_load_dwordx4 v2, s[8:11], s36 offen offset:256 lds
    s_add_u32 m0, s49, 101376
    s_nop 0
    buffer_load_dwordx4 v3, s[8:11], s36 offen offset:0 lds
    s_add_u32 m0, s49, 102272
    s_nop 0
    buffer_load_dwordx4 v3, s[8:11], s36 offen offset:128 lds
    s_add_u32 m0, s49, 103168
    s_nop 0
    buffer_load_dwordx4 v3, s[8:11], s36 offen offset:256 lds
    s_add_u32 s36, s36, s37
    s_sub_u32 s55, s36, 7864320
    s_min_u32 s36, s36, s55
    v_mov_b32 v144, 0
    v_mov_b32 v145, 0
    s_waitcnt vmcnt(14)
    v_pk_add_f32 v[104:105], v[104:105], v[150:151] op_sel_hi:[1,0] neg_lo:[0,1] neg_hi:[0,1]
    v_cvt_pk_bf16_f32 v104, 0, v104
    v_cvt_pk_bf16_f32 v105, 0, v105
    v_pk_mul_f32 v[104:105], v[104:105], v[150:151] op_sel:[0,1]
    v_cvt_pk_bf16_f32 v104, v104, v105
    v_dot2c_f32_bf16 v144, v104, v84
    v_pk_add_f32 v[106:107], v[106:107], v[150:151] op_sel_hi:[1,0] neg_lo:[0,1] neg_hi:[0,1]
    v_cvt_pk_bf16_f32 v106, 0, v106
    v_cvt_pk_bf16_f32 v107, 0, v107
    v_pk_mul_f32 v[106:107], v[106:107], v[150:151] op_sel:[0,1]
    v_cvt_pk_bf16_f32 v106, v106, v107
    v_dot2c_f32_bf16 v145, v106, v85
    v_pk_add_f32 v[108:109], v[108:109], v[150:151] op_sel_hi:[1,0] neg_lo:[0,1] neg_hi:[0,1]
    v_cvt_pk_bf16_f32 v108, 0, v108
    v_cvt_pk_bf16_f32 v109, 0, v109
    v_pk_mul_f32 v[108:109], v[108:109], v[150:151] op_sel:[0,1]
    v_cvt_pk_bf16_f32 v108, v108, v109
    v_dot2c_f32_bf16 v144, v108, v86
    v_pk_add_f32 v[110:111], v[110:111], v[150:151] op_sel_hi:[1,0] neg_lo:[0,1] neg_hi:[0,1]
    v_cvt_pk_bf16_f32 v110, 0, v110
    v_cvt_pk_bf16_f32 v111, 0, v111
    v_pk_mul_f32 v[110:111], v[110:111], v[150:151] op_sel:[0,1]
    v_cvt_pk_bf16_f32 v110, v110, v111
    v_dot2c_f32_bf16 v145, v110, v87
    v_pk_add_f32 v[112:113], v[112:113], v[150:151] op_sel_hi:[1,0] neg_lo:[0,1] neg_hi:[0,1]
    v_cvt_pk_bf16_f32 v112, 0, v112
    v_cvt_pk_bf16_f32 v113, 0, v113
    v_pk_mul_f32 v[112:113], v[112:113], v[150:151] op_sel:[0,1]
    v_cvt_pk_bf16_f32 v112, v112, v113
    v_dot2c_f32_bf16 v144, v112, v88
    v_pk_add_f32 v[114:115], v[114:115], v[150:151] op_sel_hi:[1,0] neg_lo:[0,1] neg_hi:[0,1]
    v_cvt_pk_bf16_f32 v114, 0, v114
    v_cvt_pk_bf16_f32 v115, 0, v115
    v_pk_mul_f32 v[114:115], v[114:115], v[150:151] op_sel:[0,1]
    v_cvt_pk_bf16_f32 v114, v114, v115
    v_dot2c_f32_bf16 v145, v114, v89
    v_pk_add_f32 v[116:117], v[116:117], v[150:151] op_sel_hi:[1,0] neg_lo:[0,1] neg_hi:[0,1]
    v_cvt_pk_bf16_f32 v116, 0, v116
    v_cvt_pk_bf16_f32 v117, 0, v117
    v_pk_mul_f32 v[116:117], v[116:117], v[150:151] op_sel:[0,1]
    v_cvt_pk_bf16_f32 v116, v116, v117
    v_dot2c_f32_bf16 v144, v116, v90
    v_pk_add_f32 v[118:119], v[118:119], v[150:151] op_sel_hi:[1,0] neg_lo:[0,1] neg_hi:[0,1]
    v_cvt_pk_bf16_f32 v118, 0, v118
    v_cvt_pk_bf16_f32 v119, 0, v119
    v_pk_mul_f32 v[118:119], v[118:119], v[150:151] op_sel:[0,1]
    v_cvt_pk_bf16_f32 v118, v118, v119
    v_dot2c_f32_bf16 v145, v118, v91
    v_pk_add_f32 v[120:121], v[120:121], v[150:151] op_sel_hi:[1,0] neg_lo:[0,1] neg_hi:[0,1]
    v_cvt_pk_bf16_f32 v120, 0, v120
    v_cvt_pk_bf16_f32 v121, 0, v121
    v_pk_mul_f32 v[120:121], v[120:121], v[150:151] op_sel:[0,1]
    v_cvt_pk_bf16_f32 v120, v120, v121
    v_dot2c_f32_bf16 v144, v120, v92
    v_pk_add_f32 v[122:123], v[122:123], v[150:151] op_sel_hi:[1,0] neg_lo:[0,1] neg_hi:[0,1]
    v_cvt_pk_bf16_f32 v122, 0, v122
    v_cvt_pk_bf16_f32 v123, 0, v123
    v_pk_mul_f32 v[122:123], v[122:123], v[150:151] op_sel:[0,1]
    v_cvt_pk_bf16_f32 v122, v122, v123
    v_dot2c_f32_bf16 v145, v122, v93
    v_pk_add_f32 v[124:125], v[124:125], v[150:151] op_sel_hi:[1,0] neg_lo:[0,1] neg_hi:[0,1]
    v_cvt_pk_bf16_f32 v124, 0, v124
    v_cvt_pk_bf16_f32 v125, 0, v125
    v_pk_mul_f32 v[124:125], v[124:125], v[150:151] op_sel:[0,1]
    v_cvt_pk_bf16_f32 v124, v124, v125
    v_dot2c_f32_bf16 v144, v124, v94
    v_pk_add_f32 v[126:127], v[126:127], v[150:151] op_sel_hi:[1,0] neg_lo:[0,1] neg_hi:[0,1]
    v_cvt_pk_bf16_f32 v126, 0, v126
    v_cvt_pk_bf16_f32 v127, 0, v127
    v_pk_mul_f32 v[126:127], v[126:127], v[150:151] op_sel:[0,1]
    v_cvt_pk_bf16_f32 v126, v126, v127
    v_dot2c_f32_bf16 v145, v126, v95
    s_branch page0
    .p2align 12
    .fill 32, 4, 0xbf810000
page0:
pg_0:
    s_cbranch_execz pg_4
    v_pk_add_f32 v[128:129], v[128:129], v[150:151] op_sel_hi:[1,0] neg_lo:[0,1] neg_hi:[0,1]
    v_cvt_pk_bf16_f32 v128, 0, v128
    v_cvt_pk_bf16_f32 v129, 0, v129
    v_pk_mul_f32 v[128:129], v[128:129], v[150:151] op_sel:[0,1]
    v_cvt_pk_bf16_f32 v128, v128, v129
    v_dot2c_f32_bf16 v144, v128, v96
    v_pk_add_f32 v[130:131], v[130:131], v[150:151] op_sel_hi:[1,0] neg_lo:[0,1] neg_hi:[0,1]
    v_cvt_pk_bf16_f32 v130, 0, v130
    v_cvt_pk_bf16_f32 v131, 0, v131
    v_pk_mul_f32 v[130:131], v[130:131], v[150:151] op_sel:[0,1]
    v_cvt_pk_bf16_f32 v130, v130, v131
    v_dot2c_f32_bf16 v145, v130, v97
    v_pk_add_f32 v[132:133], v[132:133], v[150:151] op_sel_hi:[1,0] neg_lo:[0,1] neg_hi:[0,1]
    v_cvt_pk_bf16_f32 v132, 0, v132
    v_cvt_pk_bf16_f32 v133, 0, v133
    v_pk_mul_f32 v[132:133], v[132:133], v[150:151] op_sel:[0,1]
    v_cvt_pk_bf16_f32 v132, v132, v133
    v_dot2c_f32_bf16 v144, v132, v98
    v_pk_add_f32 v[134:135], v[134:135], v[150:151] op_sel_hi:[1,0] neg_lo:[0,1] neg_hi:[0,1]
    v_cvt_pk_bf16_f32 v134, 0, v134
    v_cvt_pk_bf16_f32 v135, 0, v135
    v_pk_mul_f32 v[134:135], v[134:135], v[150:151] op_sel:[0,1]
    v_cvt_pk_bf16_f32 v134, v134, v135
    v_dot2c_f32_bf16 v145, v134, v99
    s_mov_b32 s4, s7
    s_mov_b32 s5, s7
    s_add_u32 s47, s46, 32
spin_ln:
    s_load_dwordx8 s[28:35], s[86:87], s46 glc
    s_add_u32 s101, s101, 1
    s_cmp_gt_u32 s101, 0x2000000
    s_cselect_b32 s57, 0, -1
    s_waitcnt lgkmcnt(0)
    s_xor_b64 s[28:29], s[28:29], s[4:5]
    s_xor_b64 s[30:31], s[30:31], s[4:5]
    s_xor_b64 s[32:33], s[32:33], s[4:5]
    s_xor_b64 s[34:35], s[34:35], s[4:5]
    s_or_b64 s[28:29], s[28:29], s[30:31]
    s_or_b64 s[28:29], s[28:29], s[32:33]
    s_or_b64 s[28:29], s[28:29], s[34:35]
    s_or_b32 s56, s28, s29
    s_and_b32 s56, s56, s57
    s_cbranch_scc1 spin_ln
    s_add_u32 s46, s45, 0
    s_sub_u32 s77, s46, 81920
    s_min_u32 s46, s46, s77
    s_xor_b32 s77, s46, 1024
    buffer_load_dwordx4 a[160:163], v14, s[20:23], s46 offen sc1
    buffer_load_dwordx4 a[164:167], v14, s[20:23], s77 offen sc1
    buffer_load_dwordx4 a[168:171], v15, s[20:23], s46 offen sc1
    buffer_load_dwordx4 a[172:175], v15, s[20:23], s77 offen sc1
    s_add_u32 s46, s45, 4096
    s_sub_u32 s77, s46, 81920
    s_min_u32 s46, s46, s77
    s_xor_b32 s77, s46, 1024
    buffer_load_dwordx4 a[176:179], v14, s[20:23], s46 offen sc1
    buffer_load_dwordx4 a[180:183], v14, s[20:23], s77 offen sc1
    buffer_load_dwordx4 a[184:187], v15, s[20:23], s46 offen sc1
    buffer_load_dwordx4 a[188:191], v15, s[20:23], s77 offen sc1
    v_pk_add_f32 v[136:137], v[136:137], v[150:151] op_sel_hi:[1,0] neg_lo:[0,1] neg_hi:[0,1]
    v_cvt_pk_bf16_f32 v136, 0, v136
    v_cvt_pk_bf16_f32 v137, 0, v137
    v_pk_mul_f32 v[136:137], v[136:137], v[150:151] op_sel:[0,1]
    v_cvt_pk_bf16_f32 v136, v136, v137
    v_dot2c_f32_bf16 v144, v136, v100
    v_pk_add_f32 v[138:139], v[138:139], v[150:151] op_sel_hi:[1,0] neg_lo:[0,1] neg_hi:[0,1]
    v_cvt_pk_bf16_f32 v138, 0, v138
    v_cvt_pk_bf16_f32 v139, 0, v139
    v_pk_mul_f32 v[138:139], v[138:139], v[150:151] op_sel:[0,1]
    v_cvt_pk_bf16_f32 v138, v138, v139
    v_dot2c_f32_bf16 v145, v138, v101
    v_pk_add_f32 v[140:141], v[140:141], v[150:151] op_sel_hi:[1,0] neg_lo:[0,1] neg_hi:[0,1]
    v_cvt_pk_bf16_f32 v140, 0, v140
    v_cvt_pk_bf16_f32 v141, 0, v141
    v_pk_mul_f32 v[140:141], v[140:141], v[150:151] op_sel:[0,1]
    v_cvt_pk_bf16_f32 v140, v140, v141
    v_dot2c_f32_bf16 v144, v140, v102
    v_pk_add_f32 v[142:143], v[142:143], v[150:151] op_sel_hi:[1,0] neg_lo:[0,1] neg_hi:[0,1]
    v_cvt_pk_bf16_f32 v142, 0, v142
    v_cvt_pk_bf16_f32 v143, 0, v143
    v_pk_mul_f32 v[142:143], v[142:143], v[150:151] op_sel:[0,1]
    v_cvt_pk_bf16_f32 v142, v142, v143
    v_dot2c_f32_bf16 v145, v142, v103
    s_nop 2
    v_add_f32 v144, v144, v145
    s_nop 0
    s_nop 0
    v_add_f32_dpp v144, v144, v144 quad_perm:[1,0,3,2] row_mask:0xf bank_mask:0xf
    s_nop 0
    s_nop 0
    v_add_f32_dpp v144, v144, v144 row_ror:8 row_mask:0xf bank_mask:0xf
    v_mov_b32 v148, v144
    s_nop 0
    s_nop 0
    v_permlane16_swap_b32 v144, v148
    s_nop 0
    s_nop 0
    v_add_f32 v144, v144, v148
    v_mov_b32 v148, v144
    s_nop 0
    s_nop 0
    v_permlane32_swap_b32 v144, v148
    s_nop 0
    s_nop 0
    v_add_f32 v144, v144, v148
    v_cvt_pk_bf16_f32 v144, 0, v144
    v_ashrrev_i32 v146, 31, v144
    v_or_b32 v146, 0x80000000, v146
    v_xor_b32 v144, v144, v146
    v_and_b32 v144, s42, v144
    v_sub_u32 v146, 2047, v240
    v_or_b32 v144, v144, v146
    s_cmp_lt_u32 s3, 2
    s_cselect_b32 s56, -1, 0
    v_and_b32 v144, s56, v144
    v_mov_b32 v34, s7
    v_mov_b32 v35, s7
    v_max_u32_dpp v32, v144, v144 quad_perm:[2,3,0,1] row_mask:0xf bank_mask:0xf
    v_min_u32_dpp v33, v144, v144 quad_perm:[2,3,0,1] row_mask:0xf bank_mask:0xf
    s_nop 0
    v_min_u32_dpp v146, v32, v32 row_ror:4 row_mask:0xf bank_mask:0xf
    v_max_u32_dpp v33, v33, v33 row_ror:4 row_mask:0xf bank_mask:0xf
    v_max_u32_dpp v32, v32, v32 row_ror:4 row_mask:0xf bank_mask:0xf
    v_max_u32 v33, v33, v146
    s_waitcnt vmcnt(8)
head_code:
    s_waitcnt vmcnt(21)
    s_barrier
    ds_read_b64_tr_b16 a[224:225], v8 offset:0
    ds_read_b64_tr_b16 a[226:227], v8 offset:6144
    ds_read_b64_tr_b16 a[228:229], v9 offset:0
    ds_read_b64_tr_b16 a[230:231], v9 offset:6144
    ds_read_b64_tr_b16 a[232:233], v10 offset:0
    ds_read_b64_tr_b16 a[234:235], v10 offset:6144
    ds_read_b64_tr_b16 a[236:237], v11 offset:0
    ds_read_b64_tr_b16 a[238:239], v11 offset:6144
    ds_read_b64_tr_b16 a[240:241], v8 offset:1024
    ds_read_b64_tr_b16 a[242:243], v8 offset:7168
    ds_read_b64_tr_b16 a[244:245], v9 offset:1024
    ds_read_b64_tr_b16 a[246:247], v9 offset:7168
    s_waitcnt vmcnt(7) lgkmcnt(10)
    v_mfma_f32_16x16x32_bf16 v[64:67], a[224:227], a[160:163], 0
    s_waitcnt vmcnt(6) lgkmcnt(8)
    v_min_u32 v36, 1, v1
    v_lshlrev_b32 v36, 30, v36
    v_mfma_f32_16x16x32_bf16 v[68:71], a[228:231], a[160:163], 0
    s_waitcnt vmcnt(5)
    v_and_b32 v37, 31, v1
    v_lshlrev_b32 v37, 2, v37
    v_mfma_f32_16x16x32_bf16 v[76:79], a[228:231], a[164:167], 0
    s_add_u32 s46, s45, 8192
    v_mov_b32 v38, 0
    s_sub_u32 s77, s46, 81920
    v_mfma_f32_16x16x32_bf16 v[72:75], a[224:227], a[164:167], 0
    s_waitcnt vmcnt(4)
    s_min_u32 s46, s46, s77
    s_xor_b32 s77, s46, 1024
    v_mfma_f32_16x16x32_bf16 v[80:83], a[224:227], a[168:171], 0
    buffer_load_dwordx4 a[96:99], v14, s[20:23], s46 offen sc1
    v_mfma_f32_16x16x32_bf16 v[84:87], a[228:231], a[168:171], 0
    s_lshl2_add_u32 s6, s2, s3
    s_lshl_b32 s6, s6, 4
    s_add_u32 s6, s6, 3162112
    v_mfma_f32_16x16x32_bf16 v[92:95], a[228:231], a[172:175], 0
    s_waitcnt lgkmcnt(0)
    ds_read_b64_tr_b16 a[228:229], v11 offset:1024
    s_lshl2_add_u32 s93, s2, s3
    v_mfma_f32_16x16x32_bf16 v[88:91], a[224:227], a[172:175], 0
    s_lshl_b32 s93, s93, 7
    ds_read_b64_tr_b16 a[230:231], v11 offset:7168
    s_add_u32 s93, s93, 4194304
    v_mfma_f32_16x16x32_bf16 v[120:123], a[232:235], a[172:175], 0
    buffer_store_dword v38, v37, s[24:27], s93 offen sc1
    v_mfma_f32_16x16x32_bf16 v[124:127], a[236:239], a[172:175], 0
    buffer_load_dwordx4 a[100:103], v14, s[20:23], s77 offen sc1
    v_mfma_f32_16x16x32_bf16 v[116:119], a[236:239], a[168:171], 0
    s_mul_i32 s56, s50, 786432
    ds_read_b64_tr_b16 a[224:225], v10 offset:1024
    v_mul_u32_u24 v56, 3072, v5
    v_mfma_f32_16x16x32_bf16 v[112:115], a[232:235], a[168:171], 0
    s_add_u32 s56, s56, 589824
    ds_read_b64_tr_b16 a[226:227], v10 offset:7168
    v_add_u32 v56, v56, v7
    v_mfma_f32_16x16x32_bf16 v[104:107], a[232:235], a[164:167], 0
    s_add_u32 s12, s66, s56
    s_addc_u32 s13, s67, 0
    v_add_u32 v57, 49152, v56
    v_mfma_f32_16x16x32_bf16 v[108:111], a[236:239], a[164:167], 0
    s_and_b32 s13, s13, 0xffff
    v_lshrrev_b32 v29, 3, v1
    v_mul_u32_u24 v31, 384, v29
    v_mfma_f32_16x16x32_bf16 v[100:103], a[236:239], a[160:163], 0
    buffer_load_dwordx4 a[104:107], v15, s[20:23], s46 offen sc1
    v_mfma_f32_16x16x32_bf16 v[96:99], a[232:235], a[160:163], 0
    s_mov_b32 s14, 196608
    ds_read_b64_tr_b16 a[236:237], v9 offset:2048
    v_add_u32 v6, v31, v7
    v_mfma_f32_16x16x32_bf16 v[128:131], a[240:243], a[160:163], 0
    s_mov_b32 s15, 0x00020000
    ds_read_b64_tr_b16 a[238:239], v9 offset:8192
    v_bfe_u32 v29, v1, 4, 1
    v_mfma_f32_16x16x32_bf16 v[132:135], a[244:247], a[160:163], 0
    s_add_u32 s16, s68, s56
    s_addc_u32 s17, s69, 0
    v_bfe_u32 v30, v1, 5, 1
    v_mfma_f32_16x16x32_bf16 v[140:143], a[244:247], a[164:167], 0
    s_and_b32 s17, s17, 0xffff
    ds_read_b64_tr_b16 a[232:233], v8 offset:2048
    v_lshl_add_u32 v29, v29, 1, v30
    v_mfma_f32_16x16x32_bf16 v[136:139], a[240:243], a[164:167], 0
    s_mov_b32 s18, 196608
    ds_read_b64_tr_b16 a[234:235], v8 offset:8192
    v_and_b32 v30, 7, v1
    v_mfma_f32_16x16x32_bf16 v[144:147], a[240:243], a[168:171], 0
    buffer_load_dwordx4 a[108:111], v15, s[20:23], s77 offen sc1
    v_mfma_f32_16x16x32_bf16 v[148:151], a[244:247], a[168:171], 0
    s_waitcnt lgkmcnt(4)
    v_xor_b32 v30, v30, v29
    v_lshl_add_u32 v4, v30, 4, v31
    v_mfma_f32_16x16x32_bf16 v[156:159], a[244:247], a[172:175], 0
    s_add_u32 s46, s45, 12288
    ds_read_b64_tr_b16 a[244:245], v11 offset:2048
    v_xor_b32 v30, 4, v30
    v_mfma_f32_16x16x32_bf16 v[152:155], a[240:243], a[172:175], 0
    s_sub_u32 s77, s46, 81920
    ds_read_b64_tr_b16 a[246:247], v11 offset:8192
    v_lshl_add_u32 v5, v30, 4, v31
    v_mfma_f32_16x16x32_bf16 v[184:187], a[224:227], a[172:175], 0
    s_min_u32 s46, s46, s77
    ds_read_b64_tr_b16 a[240:241], v10 offset:2048
    v_add_u32 v5, 3072, v5
    v_mfma_f32_16x16x32_bf16 v[188:191], a[228:231], a[172:175], 0
    s_xor_b32 s77, s46, 1024
    ds_read_b64_tr_b16 a[242:243], v10 offset:8192
    v_bfe_u32 v30, v1, 1, 1
    v_mfma_f32_16x16x32_bf16 v[180:183], a[228:231], a[168:171], 0
    buffer_load_dwordx4 a[112:115], v14, s[20:23], s46 offen sc1
    v_mfma_f32_16x16x32_bf16 v[176:179], a[224:227], a[168:171], 0
    s_mov_b32 s19, 0x00020000
    v_bfe_u32 v31, v1, 2, 1
    v_lshl_add_u32 v30, v30, 1, v31
    v_mfma_f32_16x16x32_bf16 v[168:171], a[224:227], a[164:167], 0
    s_mov_b32 s28, s78
    v_bfe_u32 v31, v1, 3, 1
    v_lshl_add_u32 v30, v31, 2, v30
    v_mfma_f32_16x16x32_bf16 v[172:175], a[228:231], a[164:167], 0
    s_waitcnt lgkmcnt(3)
    v_xor_b32 v30, v30, v29
    v_lshlrev_b32 v30, 4, v30
    v_mfma_f32_16x16x32_bf16 v[164:167], a[228:231], a[160:163], 0
    s_and_b32 s29, s79, 0xffff
    ds_read_b64_tr_b16 a[228:229], v9 offset:12288
    v_mul_u32_u24 v31, 3072, v31
    v_mfma_f32_16x16x32_bf16 v[160:163], a[224:227], a[160:163], 0
    s_mov_b32 s30, 1966080
    ds_read_b64_tr_b16 a[230:231], v9 offset:18432
    v_and_b32 v29, 7, v1
    v_mfma_f32_16x16x32_bf16 v[192:195], a[232:235], a[160:163], 0
    buffer_load_dwordx4 a[116:119], v14, s[20:23], s77 offen sc1
    v_mfma_f32_16x16x32_bf16 v[196:199], a[236:239], a[160:163], 0
    s_mov_b32 s31, 0x00020000
    ds_read_b64_tr_b16 a[224:225], v8 offset:12288
    v_lshl_add_u32 v31, v29, 7, v31
    v_mfma_f32_16x16x32_bf16 v[204:207], a[236:239], a[164:167], 0
    s_mov_b32 s32, s80
    ds_read_b64_tr_b16 a[226:227], v8 offset:18432
    v_add_u32 v12, v31, v30
    v_mfma_f32_16x16x32_bf16 v[200:203], a[232:235], a[164:167], 0
    s_and_b32 s33, s81, 0xffff
    v_xor_b32 v30, 64, v30
    v_add_u32 v13, v31, v30
    v_mfma_f32_16x16x32_bf16 v[208:211], a[232:235], a[168:171], 0
    s_mov_b32 s34, 1966080
    v_lshrrev_b32 v19, 5, v1
    v_lshlrev_b32 v19, 11, v19
    v_mfma_f32_16x16x32_bf16 v[212:215], a[236:239], a[168:171], 0
    s_waitcnt lgkmcnt(3)
    v_sub_u32 v19, 0xffffa000, v19
    s_mov_b32 s35, 0x00020000
    v_mfma_f32_16x16x32_bf16 v[220:223], a[236:239], a[172:175], 0
    buffer_load_dwordx4 a[120:123], v15, s[20:23], s46 offen sc1
    v_mfma_f32_16x16x32_bf16 v[216:219], a[232:235], a[172:175], 0
    s_min_u32 s58, s2, 239
    ds_read_b64_tr_b16 a[236:237], v11 offset:12288
    s_mul_hi_u32 s56, s58, 178956971
    v_mfma_f32_16x16x32_bf16 v[248:251], a[240:243], a[172:175], 0
    s_mul_i32 s57, s56, 24
    ds_read_b64_tr_b16 a[238:239], v11 offset:18432
    s_sub_u32 s57, s58, s57
    v_mfma_f32_16x16x32_bf16 v[252:255], a[244:247], a[172:175], 0
    s_lshl_b32 s60, s56, 6
    ds_read_b64_tr_b16 a[232:233], v10 offset:12288
    s_add_u32 s60, s60, s59
    v_mfma_f32_16x16x32_bf16 v[244:247], a[244:247], a[168:171], 0
    s_mul_i32 s60, s60, 3072
    ds_read_b64_tr_b16 a[234:235], v10 offset:18432
    s_lshl_b32 s44, s57, 7
    v_mfma_f32_16x16x32_bf16 v[240:243], a[240:243], a[168:171], 0
    s_add_u32 s60, s60, s44
    s_lshl_b32 s61, s56, 7
    s_mul_i32 s62, s56, 1536
    v_mfma_f32_16x16x32_bf16 v[232:235], a[240:243], a[164:167], 0
    buffer_load_dwordx4 a[124:127], v15, s[20:23], s77 offen sc1
    v_mfma_f32_16x16x32_bf16 v[236:239], a[244:247], a[164:167], 0
    s_waitcnt vmcnt(12) lgkmcnt(4)
    s_add_u32 m0, s49, 122880
    s_lshl_b32 s44, s57, 6
    v_mfma_f32_16x16x32_bf16 v[228:231], a[244:247], a[160:163], 0
    s_add_u32 s62, s62, s44
    ds_read_b64_tr_b16 a[244:245], v9 offset:13312
    s_lshl_b32 s44, s3, 4
    v_mfma_f32_16x16x32_bf16 v[224:227], a[240:243], a[160:163], 0
    s_waitcnt vmcnt(11)
    ds_read_b64_tr_b16 a[246:247], v9 offset:19456
    s_add_u32 s62, s62, s44
    v_mfma_f32_16x16x32_bf16 v[64:67], a[224:227], a[176:179], v[64:67]
    s_lshl_b32 s62, s62, 4
    ds_read_b64_tr_b16 a[240:241], v8 offset:13312
    s_add_u32 s62, s62, 3276800
    v_mfma_f32_16x16x32_bf16 v[68:71], a[228:231], a[176:179], v[68:71]
    s_waitcnt vmcnt(10)
    ds_read_b64_tr_b16 a[242:243], v8 offset:19456
    s_lshl_b32 s4, s2, 8
    v_mfma_f32_16x16x32_bf16 v[76:79], a[228:231], a[180:183], v[76:79]
    buffer_load_dwordx4 v2, s[8:11], s36 offen offset:0 lds
    v_mfma_f32_16x16x32_bf16 v[72:75], a[224:227], a[180:183], v[72:75]
    s_waitcnt vmcnt(10)
    s_addk_i32 m0, 896
    s_lshl_b32 s44, s3, 2
    v_mfma_f32_16x16x32_bf16 v[80:83], a[224:227], a[184:187], v[80:83]
    s_add_u32 s4, s4, s44
    s_add_u32 s4, s4, 3932160
    s_lshl_b32 s5, s52, 3
    v_mfma_f32_16x16x32_bf16 v[84:87], a[228:231], a[184:187], v[84:87]
    s_waitcnt lgkmcnt(3)
    s_add_u32 s5, s5, s53
    s_lshl_b32 s5, s5, 2
    v_mfma_f32_16x16x32_bf16 v[92:95], a[228:231], a[188:191], v[92:95]
    s_add_u32 s5, s5, s3
    ds_read_b64_tr_b16 a[228:229], v11 offset:13312
    s_lshl_b32 s5, s5, 7
    v_mfma_f32_16x16x32_bf16 v[88:91], a[224:227], a[188:191], v[88:91]
    s_add_u32 s5, s5, 4096000
    ds_read_b64_tr_b16 a[230:231], v11 offset:19456
    s_lshl_b32 s76, s51, 2
    v_mfma_f32_16x16x32_bf16 v[120:123], a[232:235], a[188:191], v[120:123]
    buffer_load_dwordx4 v2, s[8:11], s36 offen offset:128 lds
    v_mfma_f32_16x16x32_bf16 v[124:127], a[236:239], a[188:191], v[124:127]
    s_addk_i32 m0, 896
    ds_read_b64_tr_b16 a[224:225], v10 offset:13312
    s_add_u32 s76, s76, s5
    v_mfma_f32_16x16x32_bf16 v[116:119], a[236:239], a[184:187], v[116:119]
    s_mov_b32 s92, 0xbfb8aa3b
    ds_read_b64_tr_b16 a[226:227], v10 offset:19456
    s_lshl_b32 s44, s3, 12
    v_mfma_f32_16x16x32_bf16 v[112:115], a[232:235], a[184:187], v[112:115]
    s_mov_b32 s38, s49
    s_mul_i32 s40, s3, 3072
    s_mov_b32 s47, 3162112
    v_mfma_f32_16x16x32_bf16 v[104:107], a[232:235], a[180:183], v[104:107]
    s_lshl_b32 s63, s3, 10
    v_mfma_f32_16x16x32_bf16 v[108:111], a[236:239], a[180:183], v[108:111]
    s_waitcnt lgkmcnt(3)
    v_mfma_f32_16x16x32_bf16 v[100:103], a[236:239], a[176:179], v[100:103]
    buffer_load_dwordx4 v2, s[8:11], s36 offen offset:256 lds
    v_mfma_f32_16x16x32_bf16 v[96:99], a[232:235], a[176:179], v[96:99]
    s_addk_i32 m0, 1280
    ds_read_b64_tr_b16 a[236:237], v9 offset:14336
    v_mfma_f32_16x16x32_bf16 v[128:131], a[240:243], a[176:179], v[128:131]
    s_mov_b32 s80, 0xffffff01
    ds_read_b64_tr_b16 a[238:239], v9 offset:20480
    v_mfma_f32_16x16x32_bf16 v[132:135], a[244:247], a[176:179], v[132:135]
    ds_read_b64_tr_b16 a[232:233], v8 offset:14336
    v_mfma_f32_16x16x32_bf16 v[140:143], a[244:247], a[180:183], v[140:143]
    ds_read_b64_tr_b16 a[234:235], v8 offset:20480
    v_mfma_f32_16x16x32_bf16 v[136:139], a[240:243], a[180:183], v[136:139]
    v_mfma_f32_16x16x32_bf16 v[144:147], a[240:243], a[184:187], v[144:147]
    buffer_load_dwordx4 v3, s[8:11], s36 offen offset:0 lds
    v_mfma_f32_16x16x32_bf16 v[148:151], a[244:247], a[184:187], v[148:151]
    s_waitcnt lgkmcnt(4)
    s_addk_i32 m0, 896
    v_mfma_f32_16x16x32_bf16 v[156:159], a[244:247], a[188:191], v[156:159]
    ds_read_b64_tr_b16 a[244:245], v11 offset:14336
    ds_read_b64_tr_b16 a[246:247], v11 offset:20480
    v_mfma_f32_16x16x32_bf16 v[152:155], a[240:243], a[188:191], v[152:155]
    ds_read_b64_tr_b16 a[240:241], v10 offset:14336
    ds_read_b64_tr_b16 a[242:243], v10 offset:20480
    v_mfma_f32_16x16x32_bf16 v[184:187], a[224:227], a[188:191], v[184:187]
    v_mfma_f32_16x16x32_bf16 v[188:191], a[228:231], a[188:191], v[188:191]
    v_mfma_f32_16x16x32_bf16 v[180:183], a[228:231], a[184:187], v[180:183]
    buffer_load_dwordx4 v3, s[8:11], s36 offen offset:128 lds
    s_cmp_lg_u32 s3, 0
    s_cselect_b64 exec, -1, 0
    s_cbranch_execz pg_last
pg_back2:
    s_mov_b64 exec, -1
    v_mfma_f32_16x16x32_bf16 v[176:179], a[224:227], a[184:187], v[176:179]
    s_addk_i32 m0, 896
    v_mfma_f32_16x16x32_bf16 v[168:171], a[224:227], a[180:183], v[168:171]
    v_mfma_f32_16x16x32_bf16 v[172:175], a[228:231], a[180:183], v[172:175]
    s_waitcnt lgkmcnt(2)
    v_mfma_f32_16x16x32_bf16 v[164:167], a[228:231], a[176:179], v[164:167]
    s_waitcnt lgkmcnt(0)
    s_barrier
    v_mfma_f32_16x16x32_bf16 v[160:163], a[224:227], a[176:179], v[160:163]
    s_waitcnt vmcnt(12)
    ds_read_b64_tr_b16 a[224:225], v8 offset:24576
    v_mfma_f32_16x16x32_bf16 v[192:195], a[232:235], a[176:179], v[192:195]
    buffer_store_dwordx4 v[32:35], v36, s[24:27], s6 offen sc1
    v_mfma_f32_16x16x32_bf16 v[196:199], a[236:239], a[176:179], v[196:199]
    buffer_load_dwordx4 v3, s[8:11], s36 offen offset:256 lds
    v_mfma_f32_16x16x32_bf16 v[204:207], a[236:239], a[180:183], v[204:207]
    s_add_u32 s36, s36, s37
    ds_read_b64_tr_b16 a[226:227], v8 offset:30720
    s_sub_u32 s55, s36, 7864320
    v_mfma_f32_16x16x32_bf16 v[200:203], a[232:235], a[180:183], v[200:203]
    s_min_u32 s36, s36, s55
    ds_read_b64_tr_b16 a[228:229], v8 offset:36864
    s_add_u32 m0, s49, 0
    v_mfma_f32_16x16x32_bf16 v[208:211], a[232:235], a[184:187], v[208:211]
    ds_read_b64_tr_b16 a[230:231], v8 offset:43008
    v_mfma_f32_16x16x32_bf16 v[212:215], a[236:239], a[184:187], v[212:215]
    v_mfma_f32_16x16x32_bf16 v[220:223], a[236:239], a[188:191], v[220:223]
    buffer_load_dwordx4 v2, s[8:11], s36 offen offset:0 lds
    v_mfma_f32_16x16x32_bf16 v[216:219], a[232:235], a[188:191], v[216:219]
    s_addk_i32 m0, 896
    ds_read_b64_tr_b16 a[232:233], v9 offset:24576
    v_mfma_f32_16x16x32_bf16 v[248:251], a[240:243], a[188:191], v[248:251]
    ds_read_b64_tr_b16 a[234:235], v9 offset:30720
    v_mfma_f32_16x16x32_bf16 v[252:255], a[244:247], a[188:191], v[252:255]
    ds_read_b64_tr_b16 a[236:237], v9 offset:36864
    v_mfma_f32_16x16x32_bf16 v[244:247], a[244:247], a[184:187], v[244:247]
    ds_read_b64_tr_b16 a[238:239], v9 offset:43008
    v_mfma_f32_16x16x32_bf16 v[240:243], a[240:243], a[184:187], v[240:243]
    v_mfma_f32_16x16x32_bf16 v[232:235], a[240:243], a[180:183], v[232:235]
    buffer_load_dwordx4 v2, s[8:11], s36 offen offset:128 lds
    v_mfma_f32_16x16x32_bf16 v[236:239], a[244:247], a[180:183], v[236:239]
    s_waitcnt lgkmcnt(4)
    s_addk_i32 m0, 896
    v_mfma_f32_16x16x32_bf16 v[228:231], a[244:247], a[176:179], v[228:231]
    s_waitcnt vmcnt(12)
    v_mfma_f32_16x16x32_bf16 v[224:227], a[240:243], a[176:179], v[224:227]
    s_waitcnt vmcnt(11)
    ds_read_b64_tr_b16 a[240:241], v10 offset:24576
    v_mfma_f32_16x16x32_bf16 v[64:67], a[224:227], a[96:99], v[64:67]
    ds_read_b64_tr_b16 a[242:243], v10 offset:30720
    v_mfma_f32_16x16x32_bf16 v[64:67], a[228:231], a[112:115], v[64:67]
    ds_read_b64_tr_b16 a[244:245], v10 offset:36864
    v_mfma_f32_16x16x32_bf16 v[72:75], a[228:231], a[116:119], v[72:75]
    buffer_load_dwordx4 v2, s[8:11], s36 offen offset:256 lds
    v_mfma_f32_16x16x32_bf16 v[72:75], a[224:227], a[100:103], v[72:75]
    s_waitcnt vmcnt(10)
    ds_read_b64_tr_b16 a[246:247], v10 offset:43008
    s_addk_i32 m0, 1280
    v_mfma_f32_16x16x32_bf16 v[80:83], a[224:227], a[104:107], v[80:83]
    v_mfma_f32_16x16x32_bf16 v[80:83], a[228:231], a[120:123], v[80:83]
    s_waitcnt lgkmcnt(4)
    v_mfma_f32_16x16x32_bf16 v[88:91], a[228:231], a[124:127], v[88:91]
    v_mfma_f32_16x16x32_bf16 v[88:91], a[224:227], a[108:111], v[88:91]
    ds_read_b64_tr_b16 a[224:225], v11 offset:24576
    v_mfma_f32_16x16x32_bf16 v[92:95], a[232:235], a[108:111], v[92:95]
    buffer_load_dwordx4 v3, s[8:11], s36 offen offset:0 lds
    v_mfma_f32_16x16x32_bf16 v[92:95], a[236:239], a[124:127], v[92:95]
    s_addk_i32 m0, 896
    ds_read_b64_tr_b16 a[226:227], v11 offset:30720
    v_mfma_f32_16x16x32_bf16 v[84:87], a[236:239], a[120:123], v[84:87]
    ds_read_b64_tr_b16 a[228:229], v11 offset:36864
    v_mfma_f32_16x16x32_bf16 v[84:87], a[232:235], a[104:107], v[84:87]
    ds_read_b64_tr_b16 a[230:231], v11 offset:43008
    v_mfma_f32_16x16x32_bf16 v[76:79], a[232:235], a[100:103], v[76:79]
    v_mfma_f32_16x16x32_bf16 v[76:79], a[236:239], a[116:119], v[76:79]
    s_waitcnt lgkmcnt(4)
    v_mfma_f32_16x16x32_bf16 v[68:71], a[236:239], a[112:115], v[68:71]
    buffer_load_dwordx4 v3, s[8:11], s36 offen offset:128 lds
    v_mfma_f32_16x16x32_bf16 v[68:71], a[232:235], a[96:99], v[68:71]
    s_addk_i32 m0, 896
    ds_read_b64_tr_b16 a[232:233], v8 offset:25600
    v_mfma_f32_16x16x32_bf16 v[96:99], a[240:243], a[96:99], v[96:99]
    ds_read_b64_tr_b16 a[234:235], v8 offset:31744
    v_mfma_f32_16x16x32_bf16 v[96:99], a[244:247], a[112:115], v[96:99]
    ds_read_b64_tr_b16 a[236:237], v8 offset:37888
    v_mfma_f32_16x16x32_bf16 v[104:107], a[244:247], a[116:119], v[104:107]
    ds_read_b64_tr_b16 a[238:239], v8 offset:44032
    v_mfma_f32_16x16x32_bf16 v[104:107], a[240:243], a[100:103], v[104:107]
    v_mfma_f32_16x16x32_bf16 v[112:115], a[240:243], a[104:107], v[112:115]
    buffer_load_dwordx4 v3, s[8:11], s36 offen offset:256 lds
    v_mfma_f32_16x16x32_bf16 v[112:115], a[244:247], a[120:123], v[112:115]
    s_waitcnt lgkmcnt(4)
    s_add_u32 s36, s36, s37
    s_sub_u32 s55, s36, 7864320
    v_mfma_f32_16x16x32_bf16 v[120:123], a[244:247], a[124:127], v[120:123]
    s_min_u32 s36, s36, s55
    s_add_u32 s46, s45, 16384
    s_sub_u32 s77, s46, 81920
    v_mfma_f32_16x16x32_bf16 v[120:123], a[240:243], a[108:111], v[120:123]
    s_min_u32 s46, s46, s77
    ds_read_b64_tr_b16 a[240:241], v9 offset:25600
    s_xor_b32 s77, s46, 1024
    v_mfma_f32_16x16x32_bf16 v[124:127], a[224:227], a[108:111], v[124:127]
    ds_read_b64_tr_b16 a[242:243], v9 offset:31744
    v_mfma_f32_16x16x32_bf16 v[124:127], a[228:231], a[124:127], v[124:127]
    ds_read_b64_tr_b16 a[244:245], v9 offset:37888
    v_mfma_f32_16x16x32_bf16 v[116:119], a[228:231], a[120:123], v[116:119]
    buffer_load_dwordx4 a[128:131], v14, s[20:23], s46 offen sc1
    v_mfma_f32_16x16x32_bf16 v[116:119], a[224:227], a[104:107], v[116:119]
    ds_read_b64_tr_b16 a[246:247], v9 offset:44032
    v_mfma_f32_16x16x32_bf16 v[108:111], a[224:227], a[100:103], v[108:111]
    v_mfma_f32_16x16x32_bf16 v[108:111], a[228:231], a[116:119], v[108:111]
    s_waitcnt lgkmcnt(4)
    v_mfma_f32_16x16x32_bf16 v[100:103], a[228:231], a[112:115], v[100:103]
    v_mfma_f32_16x16x32_bf16 v[100:103], a[224:227], a[96:99], v[100:103]
    ds_read_b64_tr_b16 a[224:225], v10 offset:25600
    v_mfma_f32_16x16x32_bf16 v[128:131], a[232:235], a[96:99], v[128:131]
    buffer_load_dwordx4 a[132:135], v14, s[20:23], s77 offen sc1
    v_mfma_f32_16x16x32_bf16 v[128:131], a[236:239], a[112:115], v[128:131]
    ds_read_b64_tr_b16 a[226:227], v10 offset:31744
    v_mfma_f32_16x16x32_bf16 v[136:139], a[236:239], a[116:119], v[136:139]
    ds_read_b64_tr_b16 a[228:229], v10 offset:37888
    v_mfma_f32_16x16x32_bf16 v[136:139], a[232:235], a[100:103], v[136:139]
    ds_read_b64_tr_b16 a[230:231], v10 offset:44032
    v_mfma_f32_16x16x32_bf16 v[144:147], a[232:235], a[104:107], v[144:147]
    v_mfma_f32_16x16x32_bf16 v[144:147], a[236:239], a[120:123], v[144:147]
    s_waitcnt lgkmcnt(4)
    v_mfma_f32_16x16x32_bf16 v[152:155], a[236:239], a[124:127], v[152:155]
    buffer_load_dwordx4 a[136:139], v15, s[20:23], s46 offen sc1
    v_mfma_f32_16x16x32_bf16 v[152:155], a[232:235], a[108:111], v[152:155]
    ds_read_b64_tr_b16 a[232:233], v11 offset:25600
    v_mfma_f32_16x16x32_bf16 v[156:159], a[240:243], a[108:111], v[156:159]
    ds_read_b64_tr_b16 a[234:235], v11 offset:31744
    v_mfma_f32_16x16x32_bf16 v[156:159], a[244:247], a[124:127], v[156:159]
    ds_read_b64_tr_b16 a[236:237], v11 offset:37888
    v_mfma_f32_16x16x32_bf16 v[148:151], a[244:247], a[120:123], v[148:151]
    ds_read_b64_tr_b16 a[238:239], v11 offset:44032
    v_mfma_f32_16x16x32_bf16 v[148:151], a[240:243], a[104:107], v[148:151]
    v_mfma_f32_16x16x32_bf16 v[140:143], a[240:243], a[100:103], v[140:143]
    buffer_load_dwordx4 a[140:143], v15, s[20:23], s77 offen sc1
    v_mfma_f32_16x16x32_bf16 v[140:143], a[244:247], a[116:119], v[140:143]
    s_waitcnt lgkmcnt(4)
    s_add_u32 s46, s45, 20480
    s_sub_u32 s77, s46, 81920
    v_mfma_f32_16x16x32_bf16 v[132:135], a[244:247], a[112:115], v[132:135]
    s_min_u32 s46, s46, s77
    s_xor_b32 s77, s46, 1024
    v_mfma_f32_16x16x32_bf16 v[132:135], a[240:243], a[96:99], v[132:135]
    ds_read_b64_tr_b16 a[240:241], v8 offset:26624
    v_mfma_f32_16x16x32_bf16 v[160:163], a[224:227], a[96:99], v[160:163]
    ds_read_b64_tr_b16 a[242:243], v8 offset:32768
    v_mfma_f32_16x16x32_bf16 v[160:163], a[228:231], a[112:115], v[160:163]
    ds_read_b64_tr_b16 a[244:245], v8 offset:38912
    v_mfma_f32_16x16x32_bf16 v[168:171], a[228:231], a[116:119], v[168:171]
    buffer_load_dwordx4 a[144:147], v14, s[20:23], s46 offen sc1
    v_mfma_f32_16x16x32_bf16 v[168:171], a[224:227], a[100:103], v[168:171]
    ds_read_b64_tr_b16 a[246:247], v8 offset:45056
    v_mfma_f32_16x16x32_bf16 v[176:179], a[224:227], a[104:107], v[176:179]
    v_add_u32 v8, 49152, v8
    v_mfma_f32_16x16x32_bf16 v[176:179], a[228:231], a[120:123], v[176:179]
    s_waitcnt lgkmcnt(4)
    v_mfma_f32_16x16x32_bf16 v[184:187], a[228:231], a[124:127], v[184:187]
    v_mfma_f32_16x16x32_bf16 v[184:187], a[224:227], a[108:111], v[184:187]
    ds_read_b64_tr_b16 a[224:225], v9 offset:26624
    v_mfma_f32_16x16x32_bf16 v[188:191], a[232:235], a[108:111], v[188:191]
    buffer_load_dwordx4 a[148:151], v14, s[20:23], s77 offen sc1
    v_mfma_f32_16x16x32_bf16 v[188:191], a[236:239], a[124:127], v[188:191]
    ds_read_b64_tr_b16 a[226:227], v9 offset:32768
    v_mfma_f32_16x16x32_bf16 v[180:183], a[236:239], a[120:123], v[180:183]
    ds_read_b64_tr_b16 a[228:229], v9 offset:38912
    v_mfma_f32_16x16x32_bf16 v[180:183], a[232:235], a[104:107], v[180:183]
    ds_read_b64_tr_b16 a[230:231], v9 offset:45056
    v_mfma_f32_16x16x32_bf16 v[172:175], a[232:235], a[100:103], v[172:175]
    v_add_u32 v9, 49152, v9
    v_mfma_f32_16x16x32_bf16 v[172:175], a[236:239], a[116:119], v[172:175]
    s_waitcnt lgkmcnt(4)
    v_mfma_f32_16x16x32_bf16 v[164:167], a[236:239], a[112:115], v[164:167]
    buffer_load_dwordx4 a[152:155], v15, s[20:23], s46 offen sc1
    v_mfma_f32_16x16x32_bf16 v[164:167], a[232:235], a[96:99], v[164:167]
    ds_read_b64_tr_b16 a[232:233], v10 offset:26624
    v_mfma_f32_16x16x32_bf16 v[192:195], a[240:243], a[96:99], v[192:195]
    ds_read_b64_tr_b16 a[234:235], v10 offset:32768
    v_mfma_f32_16x16x32_bf16 v[192:195], a[244:247], a[112:115], v[192:195]
    ds_read_b64_tr_b16 a[236:237], v10 offset:38912
    v_mfma_f32_16x16x32_bf16 v[200:203], a[244:247], a[116:119], v[200:203]
    ds_read_b64_tr_b16 a[238:239], v10 offset:45056
    v_mfma_f32_16x16x32_bf16 v[200:203], a[240:243], a[100:103], v[200:203]
pg_1:
    s_cbranch_execz pg_5
    v_add_u32 v10, 49152, v10
    v_mfma_f32_16x16x32_bf16 v[208:211], a[240:243], a[104:107], v[208:211]
    buffer_load_dwordx4 a[156:159], v15, s[20:23], s77 offen sc1
    v_mfma_f32_16x16x32_bf16 v[208:211], a[244:247], a[120:123], v[208:211]
    s_waitcnt lgkmcnt(4)
    s_addk_i32 m0, 19712
    v_mfma_f32_16x16x32_bf16 v[216:219], a[244:247], a[124:127], v[216:219]
    v_mfma_f32_16x16x32_bf16 v[216:219], a[240:243], a[108:111], v[216:219]
    ds_read_b64_tr_b16 a[240:241], v11 offset:26624
    ds_read_b64_tr_b16 a[242:243], v11 offset:32768
    ds_read_b64_tr_b16 a[244:245], v11 offset:38912
    v_mfma_f32_16x16x32_bf16 v[220:223], a[224:227], a[108:111], v[220:223]
    ds_read_b64_tr_b16 a[246:247], v11 offset:45056
    v_mfma_f32_16x16x32_bf16 v[220:223], a[228:231], a[124:127], v[220:223]
    v_add_u32 v11, 49152, v11
    v_mfma_f32_16x16x32_bf16 v[212:215], a[228:231], a[120:123], v[212:215]
    buffer_load_dwordx4 v2, s[8:11], s36 offen offset:0 lds
    v_mfma_f32_16x16x32_bf16 v[212:215], a[224:227], a[104:107], v[212:215]
    s_addk_i32 m0, 896
    v_mfma_f32_16x16x32_bf16 v[204:207], a[224:227], a[100:103], v[204:207]
    v_mfma_f32_16x16x32_bf16 v[204:207], a[228:231], a[116:119], v[204:207]
    s_waitcnt lgkmcnt(4)
    v_mfma_f32_16x16x32_bf16 v[196:199], a[228:231], a[112:115], v[196:199]
    s_waitcnt lgkmcnt(0)
    s_barrier
    v_mfma_f32_16x16x32_bf16 v[196:199], a[224:227], a[96:99], v[196:199]
    ds_read_b64_tr_b16 a[224:225], v8 offset:0
    v_mfma_f32_16x16x32_bf16 v[224:227], a[232:235], a[96:99], v[224:227]
    buffer_load_dwordx4 v2, s[8:11], s36 offen offset:128 lds
    v_mfma_f32_16x16x32_bf16 v[224:227], a[236:239], a[112:115], v[224:227]
    s_addk_i32 m0, 896
    ds_read_b64_tr_b16 a[226:227], v8 offset:6144
    v_mfma_f32_16x16x32_bf16 v[232:235], a[236:239], a[116:119], v[232:235]
    ds_read_b64_tr_b16 a[228:229], v8 offset:12288
    v_mfma_f32_16x16x32_bf16 v[232:235], a[232:235], a[100:103], v[232:235]
    ds_read_b64_tr_b16 a[230:231], v8 offset:18432
    v_mfma_f32_16x16x32_bf16 v[240:243], a[232:235], a[104:107], v[240:243]
    v_mfma_f32_16x16x32_bf16 v[240:243], a[236:239], a[120:123], v[240:243]
    v_mfma_f32_16x16x32_bf16 v[248:251], a[236:239], a[124:127], v[248:251]
    buffer_load_dwordx4 v2, s[8:11], s36 offen offset:256 lds
    v_mfma_f32_16x16x32_bf16 v[248:251], a[232:235], a[108:111], v[248:251]
    s_addk_i32 m0, 1280
    ds_read_b64_tr_b16 a[232:233], v9 offset:0
    v_mfma_f32_16x16x32_bf16 v[252:255], a[240:243], a[108:111], v[252:255]
    ds_read_b64_tr_b16 a[234:235], v9 offset:6144
    v_mfma_f32_16x16x32_bf16 v[252:255], a[244:247], a[124:127], v[252:255]
    ds_read_b64_tr_b16 a[236:237], v9 offset:12288
    v_mfma_f32_16x16x32_bf16 v[244:247], a[244:247], a[120:123], v[244:247]
    ds_read_b64_tr_b16 a[238:239], v9 offset:18432
    v_mfma_f32_16x16x32_bf16 v[244:247], a[240:243], a[104:107], v[244:247]
    v_mfma_f32_16x16x32_bf16 v[236:239], a[240:243], a[100:103], v[236:239]
    buffer_load_dwordx4 v3, s[8:11], s36 offen offset:0 lds
    v_mfma_f32_16x16x32_bf16 v[236:239], a[244:247], a[116:119], v[236:239]
    s_waitcnt vmcnt(11) lgkmcnt(4)
    s_addk_i32 m0, 896
    v_mfma_f32_16x16x32_bf16 v[228:231], a[244:247], a[112:115], v[228:231]
    s_waitcnt vmcnt(7)
    v_and_b32 v22, 1, v1
    v_mfma_f32_16x16x32_bf16 v[228:231], a[240:243], a[96:99], v[228:231]
    s_waitcnt vmcnt(6)
    ds_read_b64_tr_b16 a[240:241], v10 offset:0
    s_sub_u32 s56, s5, s4
    v_mfma_f32_16x16x32_bf16 v[64:67], a[224:227], a[128:131], v[64:67]
    s_sub_u32 s56, s56, 128
    ds_read_b64_tr_b16 a[242:243], v10 offset:6144
    v_mul_lo_u32 v22, v22, s56
    v_mfma_f32_16x16x32_bf16 v[64:67], a[228:231], a[144:147], v[64:67]
    buffer_load_dword a252, v22, s[24:27], s4 offen offset:128 sc1
    v_mfma_f32_16x16x32_bf16 v[72:75], a[228:231], a[148:151], v[72:75]
    buffer_load_dwordx4 v3, s[8:11], s36 offen offset:128 lds
    v_mfma_f32_16x16x32_bf16 v[72:75], a[224:227], a[132:135], v[72:75]
    s_waitcnt vmcnt(6)
    ds_read_b64_tr_b16 a[244:245], v10 offset:12288
    s_addk_i32 m0, 896
    v_mfma_f32_16x16x32_bf16 v[80:83], a[224:227], a[136:139], v[80:83]
    ds_read_b64_tr_b16 a[246:247], v10 offset:18432
    v_mfma_f32_16x16x32_bf16 v[80:83], a[228:231], a[152:155], v[80:83]
    s_waitcnt lgkmcnt(4)
    v_mfma_f32_16x16x32_bf16 v[88:91], a[228:231], a[156:159], v[88:91]
    v_mfma_f32_16x16x32_bf16 v[88:91], a[224:227], a[140:143], v[88:91]
    ds_read_b64_tr_b16 a[224:225], v11 offset:0
    v_mfma_f32_16x16x32_bf16 v[92:95], a[232:235], a[140:143], v[92:95]
    buffer_load_dwordx4 v3, s[8:11], s36 offen offset:256 lds
    v_mfma_f32_16x16x32_bf16 v[92:95], a[236:239], a[156:159], v[92:95]
    s_add_u32 s36, s36, s37
    ds_read_b64_tr_b16 a[226:227], v11 offset:6144
    s_sub_u32 s55, s36, 7864320
    v_mfma_f32_16x16x32_bf16 v[84:87], a[236:239], a[152:155], v[84:87]
    s_min_u32 s36, s36, s55
    ds_read_b64_tr_b16 a[228:229], v11 offset:12288
    s_add_u32 s46, s45, 24576
    v_mfma_f32_16x16x32_bf16 v[84:87], a[232:235], a[136:139], v[84:87]
    s_sub_u32 s77, s46, 81920
    ds_read_b64_tr_b16 a[230:231], v11 offset:18432
    s_min_u32 s46, s46, s77
    v_mfma_f32_16x16x32_bf16 v[76:79], a[232:235], a[132:135], v[76:79]
    s_xor_b32 s77, s46, 1024
    v_mfma_f32_16x16x32_bf16 v[76:79], a[236:239], a[148:151], v[76:79]
    s_waitcnt lgkmcnt(4)
    v_mfma_f32_16x16x32_bf16 v[68:71], a[236:239], a[144:147], v[68:71]
    buffer_load_dwordx4 a[192:195], v14, s[20:23], s46 offen sc1
    v_mfma_f32_16x16x32_bf16 v[68:71], a[232:235], a[128:131], v[68:71]
    ds_read_b64_tr_b16 a[232:233], v8 offset:1024
    v_mfma_f32_16x16x32_bf16 v[96:99], a[240:243], a[128:131], v[96:99]
    ds_read_b64_tr_b16 a[234:235], v8 offset:7168
    v_mfma_f32_16x16x32_bf16 v[96:99], a[244:247], a[144:147], v[96:99]
    ds_read_b64_tr_b16 a[236:237], v8 offset:13312
    v_mfma_f32_16x16x32_bf16 v[104:107], a[244:247], a[148:151], v[104:107]
    ds_read_b64_tr_b16 a[238:239], v8 offset:19456
    v_mfma_f32_16x16x32_bf16 v[104:107], a[240:243], a[132:135], v[104:107]
    v_mfma_f32_16x16x32_bf16 v[112:115], a[240:243], a[136:139], v[112:115]
    buffer_load_dwordx4 a[196:199], v14, s[20:23], s77 offen sc1
    v_mfma_f32_16x16x32_bf16 v[112:115], a[244:247], a[152:155], v[112:115]
    s_waitcnt lgkmcnt(4)
    v_mfma_f32_16x16x32_bf16 v[120:123], a[244:247], a[156:159], v[120:123]
    v_mfma_f32_16x16x32_bf16 v[120:123], a[240:243], a[140:143], v[120:123]
    ds_read_b64_tr_b16 a[240:241], v9 offset:1024
    v_mfma_f32_16x16x32_bf16 v[124:127], a[224:227], a[140:143], v[124:127]
    ds_read_b64_tr_b16 a[242:243], v9 offset:7168
    v_mfma_f32_16x16x32_bf16 v[124:127], a[228:231], a[156:159], v[124:127]
    ds_read_b64_tr_b16 a[244:245], v9 offset:13312
    v_mfma_f32_16x16x32_bf16 v[116:119], a[228:231], a[152:155], v[116:119]
    buffer_load_dwordx4 a[200:203], v15, s[20:23], s46 offen sc1
    v_mfma_f32_16x16x32_bf16 v[116:119], a[224:227], a[136:139], v[116:119]
    ds_read_b64_tr_b16 a[246:247], v9 offset:19456
    v_mfma_f32_16x16x32_bf16 v[108:111], a[224:227], a[132:135], v[108:111]
    v_mfma_f32_16x16x32_bf16 v[108:111], a[228:231], a[148:151], v[108:111]
    s_waitcnt lgkmcnt(4)
    v_mfma_f32_16x16x32_bf16 v[100:103], a[228:231], a[144:147], v[100:103]
    v_mfma_f32_16x16x32_bf16 v[100:103], a[224:227], a[128:131], v[100:103]
    ds_read_b64_tr_b16 a[224:225], v10 offset:1024
    v_mfma_f32_16x16x32_bf16 v[128:131], a[232:235], a[128:131], v[128:131]
    buffer_load_dwordx4 a[204:207], v15, s[20:23], s77 offen sc1
    v_mfma_f32_16x16x32_bf16 v[128:131], a[236:239], a[144:147], v[128:131]
    s_add_u32 s46, s45, 28672
    ds_read_b64_tr_b16 a[226:227], v10 offset:7168
    s_sub_u32 s77, s46, 81920
    v_mfma_f32_16x16x32_bf16 v[136:139], a[236:239], a[148:151], v[136:139]
    s_min_u32 s46, s46, s77
    ds_read_b64_tr_b16 a[228:229], v10 offset:13312
    s_xor_b32 s77, s46, 1024
    v_mfma_f32_16x16x32_bf16 v[136:139], a[232:235], a[132:135], v[136:139]
    ds_read_b64_tr_b16 a[230:231], v10 offset:19456
    v_mfma_f32_16x16x32_bf16 v[144:147], a[232:235], a[136:139], v[144:147]
    v_mfma_f32_16x16x32_bf16 v[144:147], a[236:239], a[152:155], v[144:147]
    s_waitcnt lgkmcnt(4)
    v_mfma_f32_16x16x32_bf16 v[152:155], a[236:239], a[156:159], v[152:155]
    buffer_load_dwordx4 v[32:35], v17, s[24:27], s47 offen offset:0 sc1
    v_mfma_f32_16x16x32_bf16 v[152:155], a[232:235], a[140:143], v[152:155]
    buffer_load_dwordx4 a[208:211], v14, s[20:23], s46 offen sc1
    v_mfma_f32_16x16x32_bf16 v[156:159], a[240:243], a[140:143], v[156:159]
    ds_read_b64_tr_b16 a[232:233], v11 offset:1024
    v_mfma_f32_16x16x32_bf16 v[156:159], a[244:247], a[156:159], v[156:159]
    ds_read_b64_tr_b16 a[234:235], v11 offset:7168
    v_mfma_f32_16x16x32_bf16 v[148:151], a[244:247], a[152:155], v[148:151]
    ds_read_b64_tr_b16 a[236:237], v11 offset:13312
    v_mfma_f32_16x16x32_bf16 v[148:151], a[240:243], a[136:139], v[148:151]
    ds_read_b64_tr_b16 a[238:239], v11 offset:19456
    v_mfma_f32_16x16x32_bf16 v[140:143], a[240:243], a[132:135], v[140:143]
    buffer_load_dwordx4 a[212:215], v14, s[20:23], s77 offen sc1
    v_mfma_f32_16x16x32_bf16 v[140:143], a[244:247], a[148:151], v[140:143]
    s_waitcnt lgkmcnt(4)
    v_mfma_f32_16x16x32_bf16 v[132:135], a[244:247], a[144:147], v[132:135]
    v_mfma_f32_16x16x32_bf16 v[132:135], a[240:243], a[128:131], v[132:135]
    ds_read_b64_tr_b16 a[240:241], v8 offset:2048
    v_mfma_f32_16x16x32_bf16 v[160:163], a[224:227], a[128:131], v[160:163]
    ds_read_b64_tr_b16 a[242:243], v8 offset:8192
    v_mfma_f32_16x16x32_bf16 v[160:163], a[228:231], a[144:147], v[160:163]
    ds_read_b64_tr_b16 a[244:245], v8 offset:14336
    v_mfma_f32_16x16x32_bf16 v[168:171], a[228:231], a[148:151], v[168:171]
    buffer_load_dwordx4 a[216:219], v15, s[20:23], s46 offen sc1
    v_mfma_f32_16x16x32_bf16 v[168:171], a[224:227], a[132:135], v[168:171]
    ds_read_b64_tr_b16 a[246:247], v8 offset:20480
    v_mfma_f32_16x16x32_bf16 v[176:179], a[224:227], a[136:139], v[176:179]
    buffer_load_dwordx4 v[36:39], v17, s[24:27], s47 offen offset:1024 sc1
    v_mfma_f32_16x16x32_bf16 v[176:179], a[228:231], a[152:155], v[176:179]
    s_waitcnt lgkmcnt(4)
    v_mfma_f32_16x16x32_bf16 v[184:187], a[228:231], a[156:159], v[184:187]
    v_mfma_f32_16x16x32_bf16 v[184:187], a[224:227], a[140:143], v[184:187]
    ds_read_b64_tr_b16 a[224:225], v9 offset:2048
    v_mfma_f32_16x16x32_bf16 v[188:191], a[232:235], a[140:143], v[188:191]
    buffer_load_dwordx4 a[220:223], v15, s[20:23], s77 offen sc1
    v_mfma_f32_16x16x32_bf16 v[188:191], a[236:239], a[156:159], v[188:191]
    s_addk_i32 m0, 19712
    ds_read_b64_tr_b16 a[226:227], v9 offset:8192
    v_mfma_f32_16x16x32_bf16 v[180:183], a[236:239], a[152:155], v[180:183]
    ds_read_b64_tr_b16 a[228:229], v9 offset:14336
    v_mfma_f32_16x16x32_bf16 v[180:183], a[232:235], a[136:139], v[180:183]
    ds_read_b64_tr_b16 a[230:231], v9 offset:20480
    v_mfma_f32_16x16x32_bf16 v[172:175], a[232:235], a[132:135], v[172:175]
    v_mfma_f32_16x16x32_bf16 v[172:175], a[236:239], a[148:151], v[172:175]
    s_waitcnt lgkmcnt(4)
    v_mfma_f32_16x16x32_bf16 v[164:167], a[236:239], a[144:147], v[164:167]
    buffer_load_dwordx4 v2, s[8:11], s36 offen offset:0 lds
    v_mfma_f32_16x16x32_bf16 v[164:167], a[232:235], a[128:131], v[164:167]
    s_addk_i32 m0, 896
    ds_read_b64_tr_b16 a[232:233], v10 offset:2048
    v_mfma_f32_16x16x32_bf16 v[192:195], a[240:243], a[128:131], v[192:195]
    ds_read_b64_tr_b16 a[234:235], v10 offset:8192
    v_mfma_f32_16x16x32_bf16 v[192:195], a[244:247], a[144:147], v[192:195]
    ds_read_b64_tr_b16 a[236:237], v10 offset:14336
    v_mfma_f32_16x16x32_bf16 v[200:203], a[244:247], a[148:151], v[200:203]
    buffer_load_dwordx4 v[40:43], v17, s[24:27], s47 offen offset:2048 sc1
    v_mfma_f32_16x16x32_bf16 v[200:203], a[240:243], a[132:135], v[200:203]
    ds_read_b64_tr_b16 a[238:239], v10 offset:20480
    v_mfma_f32_16x16x32_bf16 v[208:211], a[240:243], a[136:139], v[208:211]
    buffer_load_dwordx4 v2, s[8:11], s36 offen offset:128 lds
    v_mfma_f32_16x16x32_bf16 v[208:211], a[244:247], a[152:155], v[208:211]
    s_waitcnt lgkmcnt(4)
    s_addk_i32 m0, 896
    v_mfma_f32_16x16x32_bf16 v[216:219], a[244:247], a[156:159], v[216:219]
    v_mfma_f32_16x16x32_bf16 v[216:219], a[240:243], a[140:143], v[216:219]
    ds_read_b64_tr_b16 a[240:241], v11 offset:2048
    ds_read_b64_tr_b16 a[242:243], v11 offset:8192
    ds_read_b64_tr_b16 a[244:245], v11 offset:14336
    v_mfma_f32_16x16x32_bf16 v[220:223], a[224:227], a[140:143], v[220:223]
    ds_read_b64_tr_b16 a[246:247], v11 offset:20480
    v_mfma_f32_16x16x32_bf16 v[220:223], a[228:231], a[156:159], v[220:223]
    v_mfma_f32_16x16x32_bf16 v[212:215], a[228:231], a[152:155], v[212:215]
    buffer_load_dwordx4 v2, s[8:11], s36 offen offset:256 lds
    v_mfma_f32_16x16x32_bf16 v[212:215], a[224:227], a[136:139], v[212:215]
    s_addk_i32 m0, 1280
    v_mfma_f32_16x16x32_bf16 v[204:207], a[224:227], a[132:135], v[204:207]
    v_mfma_f32_16x16x32_bf16 v[204:207], a[228:231], a[148:151], v[204:207]
    s_waitcnt lgkmcnt(4)
    v_mfma_f32_16x16x32_bf16 v[196:199], a[228:231], a[144:147], v[196:199]
    s_waitcnt lgkmcnt(0)
    s_barrier
    v_mfma_f32_16x16x32_bf16 v[196:199], a[224:227], a[128:131], v[196:199]
    ds_read_b64_tr_b16 a[224:225], v8 offset:24576
    v_mfma_f32_16x16x32_bf16 v[224:227], a[232:235], a[128:131], v[224:227]
    buffer_load_dwordx4 v[44:47], v17, s[24:27], s47 offen offset:3072 sc1
    v_mfma_f32_16x16x32_bf16 v[224:227], a[236:239], a[144:147], v[224:227]
    buffer_load_dwordx4 v3, s[8:11], s36 offen offset:0 lds
    v_mfma_f32_16x16x32_bf16 v[232:235], a[236:239], a[148:151], v[232:235]
    s_addk_i32 m0, 896
    ds_read_b64_tr_b16 a[226:227], v8 offset:30720
    v_mfma_f32_16x16x32_bf16 v[232:235], a[232:235], a[132:135], v[232:235]
    ds_read_b64_tr_b16 a[228:229], v8 offset:36864
    v_mfma_f32_16x16x32_bf16 v[240:243], a[232:235], a[136:139], v[240:243]
    ds_read_b64_tr_b16 a[230:231], v8 offset:43008
    v_mfma_f32_16x16x32_bf16 v[240:243], a[236:239], a[152:155], v[240:243]
    v_mfma_f32_16x16x32_bf16 v[248:251], a[236:239], a[156:159], v[248:251]
    buffer_load_dwordx4 v3, s[8:11], s36 offen offset:128 lds
    v_mfma_f32_16x16x32_bf16 v[248:251], a[232:235], a[140:143], v[248:251]
    s_addk_i32 m0, 896
    ds_read_b64_tr_b16 a[232:233], v9 offset:24576
    v_mfma_f32_16x16x32_bf16 v[252:255], a[240:243], a[140:143], v[252:255]
    ds_read_b64_tr_b16 a[234:235], v9 offset:30720
    v_mfma_f32_16x16x32_bf16 v[252:255], a[244:247], a[156:159], v[252:255]
    ds_read_b64_tr_b16 a[236:237], v9 offset:36864
    v_mfma_f32_16x16x32_bf16 v[244:247], a[244:247], a[152:155], v[244:247]
    ds_read_b64_tr_b16 a[238:239], v9 offset:43008
    v_mfma_f32_16x16x32_bf16 v[244:247], a[240:243], a[136:139], v[244:247]
    v_mfma_f32_16x16x32_bf16 v[236:239], a[240:243], a[132:135], v[236:239]
    buffer_load_dwordx4 v3, s[8:11], s36 offen offset:256 lds
    v_mfma_f32_16x16x32_bf16 v[236:239], a[244:247], a[148:151], v[236:239]
    s_waitcnt vmcnt(17) lgkmcnt(4)
    s_add_u32 s36, s36, s37
    s_sub_u32 s55, s36, 7864320
    v_mfma_f32_16x16x32_bf16 v[228:231], a[244:247], a[144:147], v[228:231]
    s_waitcnt vmcnt(12)
    s_min_u32 s36, s36, s55
    s_add_u32 s46, s45, 32768
    v_mfma_f32_16x16x32_bf16 v[228:231], a[240:243], a[128:131], v[228:231]
    s_waitcnt vmcnt(11)
    ds_read_b64_tr_b16 a[240:241], v10 offset:24576
    s_sub_u32 s77, s46, 81920
    v_mfma_f32_16x16x32_bf16 v[64:67], a[224:227], a[192:195], v[64:67]
    s_min_u32 s46, s46, s77
    ds_read_b64_tr_b16 a[242:243], v10 offset:30720
    s_xor_b32 s77, s46, 1024
    v_mfma_f32_16x16x32_bf16 v[64:67], a[228:231], a[208:211], v[64:67]
    ds_read_b64_tr_b16 a[244:245], v10 offset:36864
    v_mfma_f32_16x16x32_bf16 v[72:75], a[228:231], a[212:215], v[72:75]
    buffer_load_dwordx4 a[0:3], v14, s[20:23], s46 offen sc1
    v_mfma_f32_16x16x32_bf16 v[72:75], a[224:227], a[196:199], v[72:75]
    s_waitcnt vmcnt(9)
    ds_read_b64_tr_b16 a[246:247], v10 offset:43008
    v_mfma_f32_16x16x32_bf16 v[80:83], a[224:227], a[200:203], v[80:83]
    v_mfma_f32_16x16x32_bf16 v[80:83], a[228:231], a[216:219], v[80:83]
    s_waitcnt lgkmcnt(4)
    v_mfma_f32_16x16x32_bf16 v[88:91], a[228:231], a[220:223], v[88:91]
    v_mfma_f32_16x16x32_bf16 v[88:91], a[224:227], a[204:207], v[88:91]
    ds_read_b64_tr_b16 a[224:225], v11 offset:24576
    v_mfma_f32_16x16x32_bf16 v[92:95], a[232:235], a[204:207], v[92:95]
    buffer_load_dwordx4 a[4:7], v14, s[20:23], s77 offen sc1
    v_mfma_f32_16x16x32_bf16 v[92:95], a[236:239], a[220:223], v[92:95]
    ds_read_b64_tr_b16 a[226:227], v11 offset:30720
    v_mfma_f32_16x16x32_bf16 v[84:87], a[236:239], a[216:219], v[84:87]
    ds_read_b64_tr_b16 a[228:229], v11 offset:36864
    v_mfma_f32_16x16x32_bf16 v[84:87], a[232:235], a[200:203], v[84:87]
    ds_read_b64_tr_b16 a[230:231], v11 offset:43008
    v_mfma_f32_16x16x32_bf16 v[76:79], a[232:235], a[196:199], v[76:79]
    v_mfma_f32_16x16x32_bf16 v[76:79], a[236:239], a[212:215], v[76:79]
    s_waitcnt lgkmcnt(4)
    v_mfma_f32_16x16x32_bf16 v[68:71], a[236:239], a[208:211], v[68:71]
    buffer_load_dwordx4 a[8:11], v15, s[20:23], s46 offen sc1
    v_mfma_f32_16x16x32_bf16 v[68:71], a[232:235], a[192:195], v[68:71]
    ds_read_b64_tr_b16 a[232:233], v8 offset:25600
    v_mfma_f32_16x16x32_bf16 v[96:99], a[240:243], a[192:195], v[96:99]
    ds_read_b64_tr_b16 a[234:235], v8 offset:31744
    v_mfma_f32_16x16x32_bf16 v[96:99], a[244:247], a[208:211], v[96:99]
    ds_read_b64_tr_b16 a[236:237], v8 offset:37888
    v_mfma_f32_16x16x32_bf16 v[104:107], a[244:247], a[212:215], v[104:107]
    ds_read_b64_tr_b16 a[238:239], v8 offset:44032
    v_mfma_f32_16x16x32_bf16 v[104:107], a[240:243], a[196:199], v[104:107]
    v_mfma_f32_16x16x32_bf16 v[112:115], a[240:243], a[200:203], v[112:115]
    buffer_load_dwordx4 a[12:15], v15, s[20:23], s77 offen sc1
    v_mfma_f32_16x16x32_bf16 v[112:115], a[244:247], a[216:219], v[112:115]
    s_waitcnt lgkmcnt(4)
    s_add_u32 s46, s45, 36864
    s_sub_u32 s77, s46, 81920
    v_mfma_f32_16x16x32_bf16 v[120:123], a[244:247], a[220:223], v[120:123]
    s_min_u32 s46, s46, s77
    s_xor_b32 s77, s46, 1024
    v_mfma_f32_16x16x32_bf16 v[120:123], a[240:243], a[204:207], v[120:123]
    ds_read_b64_tr_b16 a[240:241], v9 offset:25600
    v_mfma_f32_16x16x32_bf16 v[124:127], a[224:227], a[204:207], v[124:127]
    ds_read_b64_tr_b16 a[242:243], v9 offset:31744
    v_mfma_f32_16x16x32_bf16 v[124:127], a[228:231], a[220:223], v[124:127]
    ds_read_b64_tr_b16 a[244:245], v9 offset:37888
    v_mfma_f32_16x16x32_bf16 v[116:119], a[228:231], a[216:219], v[116:119]
    buffer_load_dwordx4 a[16:19], v14, s[20:23], s46 offen sc1
    v_mfma_f32_16x16x32_bf16 v[116:119], a[224:227], a[200:203], v[116:119]
    ds_read_b64_tr_b16 a[246:247], v9 offset:44032
    v_mfma_f32_16x16x32_bf16 v[108:111], a[224:227], a[196:199], v[108:111]
    v_mfma_f32_16x16x32_bf16 v[108:111], a[228:231], a[212:215], v[108:111]
    s_waitcnt lgkmcnt(4)
    v_mfma_f32_16x16x32_bf16 v[100:103], a[228:231], a[208:211], v[100:103]
    v_mfma_f32_16x16x32_bf16 v[100:103], a[224:227], a[192:195], v[100:103]
    ds_read_b64_tr_b16 a[224:225], v10 offset:25600
    v_mfma_f32_16x16x32_bf16 v[128:131], a[232:235], a[192:195], v[128:131]
    buffer_load_dwordx4 a[20:23], v14, s[20:23], s77 offen sc1
    v_mfma_f32_16x16x32_bf16 v[128:131], a[236:239], a[208:211], v[128:131]
    ds_read_b64_tr_b16 a[226:227], v10 offset:31744
    v_mfma_f32_16x16x32_bf16 v[136:139], a[236:239], a[212:215], v[136:139]
    ds_read_b64_tr_b16 a[228:229], v10 offset:37888
    v_mfma_f32_16x16x32_bf16 v[136:139], a[232:235], a[196:199], v[136:139]
    ds_read_b64_tr_b16 a[230:231], v10 offset:44032
    v_mfma_f32_16x16x32_bf16 v[144:147], a[232:235], a[200:203], v[144:147]
    v_mfma_f32_16x16x32_bf16 v[144:147], a[236:239], a[216:219], v[144:147]
    s_waitcnt lgkmcnt(4)
    v_mfma_f32_16x16x32_bf16 v[152:155], a[236:239], a[220:223], v[152:155]
    buffer_load_dwordx4 a[24:27], v15, s[20:23], s46 offen sc1
    v_mfma_f32_16x16x32_bf16 v[152:155], a[232:235], a[204:207], v[152:155]
    ds_read_b64_tr_b16 a[232:233], v11 offset:25600
    v_mfma_f32_16x16x32_bf16 v[156:159], a[240:243], a[204:207], v[156:159]
    ds_read_b64_tr_b16 a[234:235], v11 offset:31744
    v_mfma_f32_16x16x32_bf16 v[156:159], a[244:247], a[220:223], v[156:159]
    ds_read_b64_tr_b16 a[236:237], v11 offset:37888
    v_mfma_f32_16x16x32_bf16 v[148:151], a[244:247], a[216:219], v[148:151]
    ds_read_b64_tr_b16 a[238:239], v11 offset:44032
    v_mfma_f32_16x16x32_bf16 v[148:151], a[240:243], a[200:203], v[148:151]
    v_mfma_f32_16x16x32_bf16 v[140:143], a[240:243], a[196:199], v[140:143]
    buffer_load_dwordx4 a[28:31], v15, s[20:23], s77 offen sc1
    v_mfma_f32_16x16x32_bf16 v[140:143], a[244:247], a[212:215], v[140:143]
    s_waitcnt lgkmcnt(4)
    s_addk_i32 m0, 19712
    v_mfma_f32_16x16x32_bf16 v[132:135], a[244:247], a[208:211], v[132:135]
    v_mfma_f32_16x16x32_bf16 v[132:135], a[240:243], a[192:195], v[132:135]
    ds_read_b64_tr_b16 a[240:241], v8 offset:26624
    v_mfma_f32_16x16x32_bf16 v[160:163], a[224:227], a[192:195], v[160:163]
    ds_read_b64_tr_b16 a[242:243], v8 offset:32768
    v_mfma_f32_16x16x32_bf16 v[160:163], a[228:231], a[208:211], v[160:163]
    ds_read_b64_tr_b16 a[244:245], v8 offset:38912
    v_mfma_f32_16x16x32_bf16 v[168:171], a[228:231], a[212:215], v[168:171]
    buffer_load_dwordx4 v2, s[8:11], s36 offen offset:0 lds
    v_mfma_f32_16x16x32_bf16 v[168:171], a[224:227], a[196:199], v[168:171]
    s_addk_i32 m0, 896
    ds_read_b64_tr_b16 a[246:247], v8 offset:45056
    v_mfma_f32_16x16x32_bf16 v[176:179], a[224:227], a[200:203], v[176:179]
    v_subrev_u32 v8, 98304, v8
    v_mfma_f32_16x16x32_bf16 v[176:179], a[228:231], a[216:219], v[176:179]
    s_waitcnt lgkmcnt(4)
    v_mfma_f32_16x16x32_bf16 v[184:187], a[228:231], a[220:223], v[184:187]
    v_mfma_f32_16x16x32_bf16 v[184:187], a[224:227], a[204:207], v[184:187]
    ds_read_b64_tr_b16 a[224:225], v9 offset:26624
    v_mfma_f32_16x16x32_bf16 v[188:191], a[232:235], a[204:207], v[188:191]
    buffer_load_dwordx4 v2, s[8:11], s36 offen offset:128 lds
    v_mfma_f32_16x16x32_bf16 v[188:191], a[236:239], a[220:223], v[188:191]
    s_addk_i32 m0, 896
    ds_read_b64_tr_b16 a[226:227], v9 offset:32768
    v_mfma_f32_16x16x32_bf16 v[180:183], a[236:239], a[216:219], v[180:183]
    ds_read_b64_tr_b16 a[228:229], v9 offset:38912
    v_mfma_f32_16x16x32_bf16 v[180:183], a[232:235], a[200:203], v[180:183]
    ds_read_b64_tr_b16 a[230:231], v9 offset:45056
    v_mfma_f32_16x16x32_bf16 v[172:175], a[232:235], a[196:199], v[172:175]
    v_subrev_u32 v9, 98304, v9
    v_mfma_f32_16x16x32_bf16 v[172:175], a[236:239], a[212:215], v[172:175]
    s_waitcnt lgkmcnt(4)
    v_mfma_f32_16x16x32_bf16 v[164:167], a[236:239], a[208:211], v[164:167]
    buffer_load_dwordx4 v2, s[8:11], s36 offen offset:256 lds
    v_mfma_f32_16x16x32_bf16 v[164:167], a[232:235], a[192:195], v[164:167]
    s_addk_i32 m0, 1280
    ds_read_b64_tr_b16 a[232:233], v10 offset:26624
    v_xor_b32 v34, s7, v34
    v_mfma_f32_16x16x32_bf16 v[192:195], a[240:243], a[192:195], v[192:195]
    s_waitcnt vmcnt(17)
    ds_read_b64_tr_b16 a[234:235], v10 offset:32768
    v_xor_b32 v38, s7, v38
    v_mfma_f32_16x16x32_bf16 v[192:195], a[244:247], a[208:211], v[192:195]
    s_waitcnt vmcnt(14)
    ds_read_b64_tr_b16 a[236:237], v10 offset:38912
    v_xor_b32 v42, s7, v42
    v_mfma_f32_16x16x32_bf16 v[200:203], a[244:247], a[212:215], v[200:203]
    s_lshl_b32 s56, s3, 3
    ds_read_b64_tr_b16 a[238:239], v10 offset:45056
    v_xor_b32 v46, s7, v46
    v_mfma_f32_16x16x32_bf16 v[200:203], a[240:243], a[196:199], v[200:203]
    s_add_u32 s56, s56, 147456
    v_or3_b32 v34, v34, v38, v42
    v_or_b32 v34, v34, v46
    v_mfma_f32_16x16x32_bf16 v[208:211], a[240:243], a[200:203], v[208:211]
    buffer_load_dwordx4 v3, s[8:11], s36 offen offset:0 lds
    v_mfma_f32_16x16x32_bf16 v[208:211], a[244:247], a[216:219], v[208:211]
    s_waitcnt lgkmcnt(4)
    v_cmp_ne_u32 vcc, 0, v34
    s_addk_i32 m0, 896
    v_mfma_f32_16x16x32_bf16 v[216:219], a[244:247], a[220:223], v[216:219]
    s_cbranch_vccnz spin_rec
spin_rec_ret:
    v_max_u32 v20, v32, v33
    v_mfma_f32_16x16x32_bf16 v[216:219], a[240:243], a[204:207], v[216:219]
    ds_read_b64_tr_b16 a[240:241], v11 offset:26624
    v_min_u32 v21, v32, v33
    ds_read_b64_tr_b16 a[242:243], v11 offset:32768
    v_mfma_f32_16x16x32_bf16 v[220:223], a[224:227], a[204:207], v[220:223]
    ds_read_b64_tr_b16 a[244:245], v11 offset:38912
    v_med3_u32 v21, v20, v21, v36
    ds_read_b64_tr_b16 a[246:247], v11 offset:45056
    v_mfma_f32_16x16x32_bf16 v[220:223], a[228:231], a[220:223], v[220:223]
    v_max_u32 v20, v20, v36
    v_med3_u32 v21, v20, v21, v37
    v_mfma_f32_16x16x32_bf16 v[212:215], a[228:231], a[216:219], v[212:215]
    buffer_load_dwordx4 v3, s[8:11], s36 offen offset:128 lds
    v_mfma_f32_16x16x32_bf16 v[212:215], a[224:227], a[200:203], v[212:215]
    s_addk_i32 m0, 896
    v_max_u32 v20, v20, v37
    v_med3_u32 v21, v20, v21, v40
    v_mfma_f32_16x16x32_bf16 v[204:207], a[224:227], a[196:199], v[204:207]
    v_max_u32 v20, v20, v40
    v_med3_u32 v21, v20, v21, v41
    v_mfma_f32_16x16x32_bf16 v[204:207], a[228:231], a[212:215], v[204:207]
    s_waitcnt lgkmcnt(4)
    v_max_u32 v20, v20, v41
    v_med3_u32 v21, v20, v21, v44
    v_mfma_f32_16x16x32_bf16 v[196:199], a[228:231], a[208:211], v[196:199]
    s_waitcnt lgkmcnt(0)
    s_barrier
    v_mfma_f32_16x16x32_bf16 v[196:199], a[224:227], a[192:195], v[196:199]
    ds_read_b64_tr_b16 a[224:225], v8 offset:0
    v_max_u32 v20, v20, v44
    v_mfma_f32_16x16x32_bf16 v[224:227], a[232:235], a[192:195], v[224:227]
    buffer_load_dwordx4 v3, s[8:11], s36 offen offset:256 lds
    v_mfma_f32_16x16x32_bf16 v[224:227], a[236:239], a[208:211], v[224:227]
    s_add_u32 s36, s36, s37
    ds_read_b64_tr_b16 a[226:227], v8 offset:6144
    v_med3_u32 v21, v20, v21, v45
    v_mfma_f32_16x16x32_bf16 v[232:235], a[236:239], a[212:215], v[232:235]
    s_sub_u32 s55, s36, 7864320
    ds_read_b64_tr_b16 a[228:229], v8 offset:12288
    v_max_u32 v20, v20, v45
    v_mfma_f32_16x16x32_bf16 v[232:235], a[232:235], a[196:199], v[232:235]
    s_min_u32 s36, s36, s55
    ds_read_b64_tr_b16 a[230:231], v8 offset:18432
    v_mov_b32_dpp v22, v20 row_ror:8 row_mask:0xf bank_mask:0xf
    v_mfma_f32_16x16x32_bf16 v[240:243], a[232:235], a[200:203], v[240:243]
    s_add_u32 s46, s45, 40960
    v_mov_b32_dpp v23, v21 row_ror:8 row_mask:0xf bank_mask:0xf
    v_min_u32 v24, v20, v22
    v_mfma_f32_16x16x32_bf16 v[240:243], a[236:239], a[216:219], v[240:243]
    s_sub_u32 s77, s46, 81920
    v_max_u32 v20, v20, v22
    v_max3_u32 v21, v24, v21, v23
    v_mfma_f32_16x16x32_bf16 v[248:251], a[236:239], a[220:223], v[248:251]
    s_min_u32 s46, s46, s77
    v_mov_b32_dpp v22, v20 row_ror:4 row_mask:0xf bank_mask:0xf
    v_mov_b32_dpp v23, v21 row_ror:4 row_mask:0xf bank_mask:0xf
    v_mfma_f32_16x16x32_bf16 v[248:251], a[232:235], a[204:207], v[248:251]
    buffer_load_dwordx4 a[32:35], v14, s[20:23], s46 offen sc1
    v_mfma_f32_16x16x32_bf16 v[252:255], a[240:243], a[204:207], v[252:255]
    s_xor_b32 s77, s46, 1024
    ds_read_b64_tr_b16 a[232:233], v9 offset:0
    v_min_u32 v24, v20, v22
    v_mfma_f32_16x16x32_bf16 v[252:255], a[244:247], a[220:223], v[252:255]
    ds_read_b64_tr_b16 a[234:235], v9 offset:6144
    v_max_u32 v20, v20, v22
    v_mfma_f32_16x16x32_bf16 v[244:247], a[244:247], a[216:219], v[244:247]
    ds_read_b64_tr_b16 a[236:237], v9 offset:12288
    v_max3_u32 v21, v24, v21, v23
    v_mfma_f32_16x16x32_bf16 v[244:247], a[240:243], a[200:203], v[244:247]
    ds_read_b64_tr_b16 a[238:239], v9 offset:18432
    v_mov_b32_dpp v22, v20 row_ror:2 row_mask:0xf bank_mask:0xf
    v_mfma_f32_16x16x32_bf16 v[236:239], a[240:243], a[196:199], v[236:239]
    buffer_load_dwordx4 a[36:39], v14, s[20:23], s77 offen sc1
    v_mfma_f32_16x16x32_bf16 v[236:239], a[244:247], a[212:215], v[236:239]
    s_waitcnt vmcnt(15) lgkmcnt(4)
    v_mov_b32_dpp v23, v21 row_ror:2 row_mask:0xf bank_mask:0xf
    v_min_u32 v24, v20, v22
    v_mfma_f32_16x16x32_bf16 v[228:231], a[244:247], a[208:211], v[228:231]
    s_waitcnt vmcnt(11)
    v_max_u32 v20, v20, v22
    v_max3_u32 v21, v24, v21, v23
    v_mfma_f32_16x16x32_bf16 v[228:231], a[240:243], a[192:195], v[228:231]
    s_waitcnt vmcnt(10)
    v_mov_b32_dpp v22, v20 row_ror:1 row_mask:0xf bank_mask:0xf
    v_mov_b32_dpp v23, v21 row_ror:1 row_mask:0xf bank_mask:0xf
    v_mfma_f32_16x16x32_bf16 v[64:67], a[224:227], a[0:3], v[64:67]
    v_min_u32 v24, v20, v22
    v_max_u32 v20, v20, v22
    v_mfma_f32_16x16x32_bf16 v[64:67], a[228:231], a[16:19], v[64:67]
    v_max3_u32 v21, v24, v21, v23
    v_mov_b32 v22, v20
    v_mfma_f32_16x16x32_bf16 v[72:75], a[228:231], a[20:23], v[72:75]
    buffer_load_dwordx4 a[40:43], v15, s[20:23], s46 offen sc1
    v_mfma_f32_16x16x32_bf16 v[72:75], a[224:227], a[4:7], v[72:75]
    s_waitcnt vmcnt(9)
    v_permlane16_swap_b32 v20, v22
    v_mfma_f32_16x16x32_bf16 v[80:83], a[224:227], a[8:11], v[80:83]
    v_mov_b32 v23, v21
    v_min_u32 v24, v20, v22
    v_mfma_f32_16x16x32_bf16 v[80:83], a[228:231], a[24:27], v[80:83]
    s_waitcnt lgkmcnt(0)
    v_permlane16_swap_b32 v21, v23
    v_mfma_f32_16x16x32_bf16 v[88:91], a[228:231], a[28:31], v[88:91]
    v_max_u32 v20, v20, v22
    v_max3_u32 v21, v24, v21, v23
    v_subrev_u32 v10, 98304, v10
    v_mfma_f32_16x16x32_bf16 v[88:91], a[224:227], a[12:15], v[88:91]
    ds_read_b64_tr_b16 a[240:241], v10 offset:0
    v_mov_b32 v22, v20
    v_mfma_f32_16x16x32_bf16 v[92:95], a[232:235], a[12:15], v[92:95]
    s_add_u32 s46, s45, 45056
    ds_read_b64_tr_b16 a[242:243], v10 offset:6144
    v_mov_b32 v23, v21
    v_mfma_f32_16x16x32_bf16 v[92:95], a[236:239], a[28:31], v[92:95]
    ds_read_b64_tr_b16 a[244:245], v10 offset:12288
    v_subrev_u32 v11, 98304, v11
    v_mfma_f32_16x16x32_bf16 v[84:87], a[236:239], a[24:27], v[84:87]
    ds_read_b64_tr_b16 a[246:247], v10 offset:18432
    v_mfma_f32_16x16x32_bf16 v[84:87], a[232:235], a[8:11], v[84:87]
    buffer_load_dwordx4 a[44:47], v15, s[20:23], s77 offen sc1
    v_mfma_f32_16x16x32_bf16 v[76:79], a[232:235], a[4:7], v[76:79]
    s_sub_u32 s77, s46, 81920
    ds_read_b64_tr_b16 a[224:225], v11 offset:0
    s_min_u32 s46, s46, s77
    v_mfma_f32_16x16x32_bf16 v[76:79], a[236:239], a[20:23], v[76:79]
    s_xor_b32 s77, s46, 1024
    ds_read_b64_tr_b16 a[226:227], v11 offset:6144
    v_mfma_f32_16x16x32_bf16 v[68:71], a[236:239], a[16:19], v[68:71]
    buffer_load_dwordx4 a[48:51], v14, s[20:23], s46 offen sc1
    v_mfma_f32_16x16x32_bf16 v[68:71], a[232:235], a[0:3], v[68:71]
    s_waitcnt lgkmcnt(4)
    ds_read_b64_tr_b16 a[228:229], v11 offset:12288
    v_mfma_f32_16x16x32_bf16 v[96:99], a[240:243], a[0:3], v[96:99]
    s_waitcnt lgkmcnt(3)
    ds_read_b64_tr_b16 a[230:231], v11 offset:18432
    v_mfma_f32_16x16x32_bf16 v[96:99], a[244:247], a[16:19], v[96:99]
    ds_read_b64_tr_b16 a[232:233], v8 offset:1024
    v_mfma_f32_16x16x32_bf16 v[104:107], a[244:247], a[20:23], v[104:107]
    ds_read_b64_tr_b16 a[234:235], v8 offset:7168
    v_mfma_f32_16x16x32_bf16 v[104:107], a[240:243], a[4:7], v[104:107]
    ds_read_b64_tr_b16 a[236:237], v8 offset:13312
    v_mfma_f32_16x16x32_bf16 v[112:115], a[240:243], a[8:11], v[112:115]
    buffer_load_dwordx4 a[52:55], v14, s[20:23], s77 offen sc1
    v_mfma_f32_16x16x32_bf16 v[112:115], a[244:247], a[24:27], v[112:115]
pg_2:
    s_cbranch_execz pg_6
    s_waitcnt lgkmcnt(5)
    ds_read_b64_tr_b16 a[238:239], v8 offset:19456
    v_mfma_f32_16x16x32_bf16 v[120:123], a[244:247], a[28:31], v[120:123]
    v_permlane32_swap_b32 v20, v22
    v_mfma_f32_16x16x32_bf16 v[120:123], a[240:243], a[12:15], v[120:123]
    s_waitcnt lgkmcnt(4)
    ds_read_b64_tr_b16 a[240:241], v9 offset:1024
    v_min_u32 v24, v20, v22
    v_mfma_f32_16x16x32_bf16 v[124:127], a[224:227], a[12:15], v[124:127]
    ds_read_b64_tr_b16 a[242:243], v9 offset:7168
    v_max_u32 v20, v20, v22
    v_mfma_f32_16x16x32_bf16 v[124:127], a[228:231], a[28:31], v[124:127]
    ds_read_b64_tr_b16 a[244:245], v9 offset:13312
    v_mov_b32 v22, s56
    v_mfma_f32_16x16x32_bf16 v[116:119], a[228:231], a[24:27], v[116:119]
    buffer_load_dwordx4 a[56:59], v15, s[20:23], s46 offen sc1
    v_mfma_f32_16x16x32_bf16 v[116:119], a[224:227], a[8:11], v[116:119]
    ds_read_b64_tr_b16 a[246:247], v9 offset:19456
    v_mfma_f32_16x16x32_bf16 v[108:111], a[224:227], a[4:7], v[108:111]
    v_permlane32_swap_b32 v21, v23
    v_mfma_f32_16x16x32_bf16 v[108:111], a[228:231], a[20:23], v[108:111]
    s_waitcnt lgkmcnt(4)
    v_max3_u32 v21, v24, v21, v23
    v_mov_b32 v23, 147456
    v_mfma_f32_16x16x32_bf16 v[100:103], a[228:231], a[16:19], v[100:103]
    ds_write_b64 v22, v[20:21]
    v_mfma_f32_16x16x32_bf16 v[100:103], a[224:227], a[0:3], v[100:103]
    ds_read_b64_tr_b16 a[224:225], v10 offset:1024
    v_mfma_f32_16x16x32_bf16 v[128:131], a[232:235], a[0:3], v[128:131]
    buffer_load_dwordx4 a[60:63], v15, s[20:23], s77 offen sc1
    v_mfma_f32_16x16x32_bf16 v[128:131], a[236:239], a[16:19], v[128:131]
    s_addk_i32 m0, 19712
    ds_read_b64_tr_b16 a[226:227], v10 offset:7168
    v_mfma_f32_16x16x32_bf16 v[136:139], a[236:239], a[20:23], v[136:139]
    ds_read_b64_tr_b16 a[228:229], v10 offset:13312
    v_mfma_f32_16x16x32_bf16 v[136:139], a[232:235], a[4:7], v[136:139]
    ds_read_b64_tr_b16 a[230:231], v10 offset:19456
    v_mfma_f32_16x16x32_bf16 v[144:147], a[232:235], a[8:11], v[144:147]
    v_mfma_f32_16x16x32_bf16 v[144:147], a[236:239], a[24:27], v[144:147]
    s_waitcnt lgkmcnt(4)
    v_mfma_f32_16x16x32_bf16 v[152:155], a[236:239], a[28:31], v[152:155]
    buffer_load_dwordx4 v2, s[8:11], s36 offen offset:0 lds
    v_mfma_f32_16x16x32_bf16 v[152:155], a[232:235], a[12:15], v[152:155]
    s_addk_i32 m0, 896
    ds_read_b64_tr_b16 a[232:233], v11 offset:1024
    v_mfma_f32_16x16x32_bf16 v[156:159], a[240:243], a[12:15], v[156:159]
    ds_read_b64_tr_b16 a[234:235], v11 offset:7168
    v_mfma_f32_16x16x32_bf16 v[156:159], a[244:247], a[28:31], v[156:159]
    ds_read_b64_tr_b16 a[236:237], v11 offset:13312
    v_mfma_f32_16x16x32_bf16 v[148:151], a[244:247], a[24:27], v[148:151]
    ds_read_b64_tr_b16 a[238:239], v11 offset:19456
    v_mfma_f32_16x16x32_bf16 v[148:151], a[240:243], a[8:11], v[148:151]
    v_mfma_f32_16x16x32_bf16 v[140:143], a[240:243], a[4:7], v[140:143]
    buffer_load_dwordx4 v2, s[8:11], s36 offen offset:128 lds
    v_mfma_f32_16x16x32_bf16 v[140:143], a[244:247], a[20:23], v[140:143]
    s_waitcnt lgkmcnt(4)
    s_addk_i32 m0, 896
    v_mfma_f32_16x16x32_bf16 v[132:135], a[244:247], a[16:19], v[132:135]
    v_mfma_f32_16x16x32_bf16 v[132:135], a[240:243], a[0:3], v[132:135]
    ds_read_b64_tr_b16 a[240:241], v8 offset:2048
    v_mfma_f32_16x16x32_bf16 v[160:163], a[224:227], a[0:3], v[160:163]
    ds_read_b64_tr_b16 a[242:243], v8 offset:8192
    v_mfma_f32_16x16x32_bf16 v[160:163], a[228:231], a[16:19], v[160:163]
    ds_read_b64_tr_b16 a[244:245], v8 offset:14336
    v_mfma_f32_16x16x32_bf16 v[168:171], a[228:231], a[20:23], v[168:171]
    buffer_load_dwordx4 v2, s[8:11], s36 offen offset:256 lds
    v_mfma_f32_16x16x32_bf16 v[168:171], a[224:227], a[4:7], v[168:171]
    s_addk_i32 m0, 1280
    ds_read_b64_tr_b16 a[246:247], v8 offset:20480
    v_mfma_f32_16x16x32_bf16 v[176:179], a[224:227], a[8:11], v[176:179]
    v_mfma_f32_16x16x32_bf16 v[176:179], a[228:231], a[24:27], v[176:179]
    s_waitcnt lgkmcnt(4)
    v_mfma_f32_16x16x32_bf16 v[184:187], a[228:231], a[28:31], v[184:187]
    v_mfma_f32_16x16x32_bf16 v[184:187], a[224:227], a[12:15], v[184:187]
    ds_read_b64_tr_b16 a[224:225], v9 offset:2048
    v_mfma_f32_16x16x32_bf16 v[188:191], a[232:235], a[12:15], v[188:191]
    buffer_load_dwordx4 v3, s[8:11], s36 offen offset:0 lds
    v_mfma_f32_16x16x32_bf16 v[188:191], a[236:239], a[28:31], v[188:191]
    s_addk_i32 m0, 896
    ds_read_b64_tr_b16 a[226:227], v9 offset:8192
    v_mfma_f32_16x16x32_bf16 v[180:183], a[236:239], a[24:27], v[180:183]
    ds_read_b64_tr_b16 a[228:229], v9 offset:14336
    v_mfma_f32_16x16x32_bf16 v[180:183], a[232:235], a[8:11], v[180:183]
    ds_read_b64_tr_b16 a[230:231], v9 offset:20480
    v_mfma_f32_16x16x32_bf16 v[172:175], a[232:235], a[4:7], v[172:175]
    v_mfma_f32_16x16x32_bf16 v[172:175], a[236:239], a[20:23], v[172:175]
    s_waitcnt lgkmcnt(4)
    v_mfma_f32_16x16x32_bf16 v[164:167], a[236:239], a[16:19], v[164:167]
    buffer_load_dwordx4 v3, s[8:11], s36 offen offset:128 lds
    v_mfma_f32_16x16x32_bf16 v[164:167], a[232:235], a[0:3], v[164:167]
    s_addk_i32 m0, 896
    ds_read_b64_tr_b16 a[232:233], v10 offset:2048
    v_mfma_f32_16x16x32_bf16 v[192:195], a[240:243], a[0:3], v[192:195]
    ds_read_b64_tr_b16 a[234:235], v10 offset:8192
    v_mfma_f32_16x16x32_bf16 v[192:195], a[244:247], a[16:19], v[192:195]
    ds_read_b64_tr_b16 a[236:237], v10 offset:14336
    v_mfma_f32_16x16x32_bf16 v[200:203], a[244:247], a[20:23], v[200:203]
    ds_read_b64_tr_b16 a[238:239], v10 offset:20480
    v_mfma_f32_16x16x32_bf16 v[200:203], a[240:243], a[4:7], v[200:203]
    v_mfma_f32_16x16x32_bf16 v[208:211], a[240:243], a[8:11], v[208:211]
    buffer_load_dwordx4 v3, s[8:11], s36 offen offset:256 lds
    v_mfma_f32_16x16x32_bf16 v[208:211], a[244:247], a[24:27], v[208:211]
    s_waitcnt lgkmcnt(4)
    s_add_u32 s36, s36, s37
    s_sub_u32 s55, s36, 7864320
    v_mfma_f32_16x16x32_bf16 v[216:219], a[244:247], a[28:31], v[216:219]
    s_min_u32 s36, s36, s55
    s_add_u32 s46, s45, 49152
    s_sub_u32 s77, s46, 81920
    v_mfma_f32_16x16x32_bf16 v[216:219], a[240:243], a[12:15], v[216:219]
    s_min_u32 s46, s46, s77
    ds_read_b64_tr_b16 a[240:241], v11 offset:2048
    s_xor_b32 s77, s46, 1024
    ds_read_b64_tr_b16 a[242:243], v11 offset:8192
    v_mfma_f32_16x16x32_bf16 v[220:223], a[224:227], a[12:15], v[220:223]
    ds_read_b64_tr_b16 a[244:245], v11 offset:14336
    ds_read_b64_tr_b16 a[246:247], v11 offset:20480
    v_mfma_f32_16x16x32_bf16 v[220:223], a[228:231], a[28:31], v[220:223]
    v_mfma_f32_16x16x32_bf16 v[212:215], a[228:231], a[24:27], v[212:215]
    buffer_load_dwordx4 a[64:67], v14, s[20:23], s46 offen sc1
    v_mfma_f32_16x16x32_bf16 v[212:215], a[224:227], a[8:11], v[212:215]
    v_mfma_f32_16x16x32_bf16 v[204:207], a[224:227], a[4:7], v[204:207]
    v_mfma_f32_16x16x32_bf16 v[204:207], a[228:231], a[20:23], v[204:207]
    s_waitcnt lgkmcnt(4)
    v_mfma_f32_16x16x32_bf16 v[196:199], a[228:231], a[16:19], v[196:199]
    s_waitcnt lgkmcnt(0)
    s_barrier
    v_mfma_f32_16x16x32_bf16 v[196:199], a[224:227], a[0:3], v[196:199]
    ds_read_b128 v[32:35], v23 offset:0
    v_mfma_f32_16x16x32_bf16 v[224:227], a[232:235], a[0:3], v[224:227]
    buffer_load_dwordx4 a[68:71], v14, s[20:23], s77 offen sc1
    v_mfma_f32_16x16x32_bf16 v[224:227], a[236:239], a[16:19], v[224:227]
    ds_read_b128 v[36:39], v23 offset:16
    v_and_b32 v22, 1, v1
    v_mfma_f32_16x16x32_bf16 v[232:235], a[236:239], a[20:23], v[232:235]
    ds_read_b64_tr_b16 a[224:225], v8 offset:24576
    v_cmp_eq_u32 vcc, 1, v22
    v_mfma_f32_16x16x32_bf16 v[232:235], a[232:235], a[4:7], v[232:235]
    ds_read_b64_tr_b16 a[226:227], v8 offset:30720
    v_lshrrev_b32 v24, 4, v1
    v_mfma_f32_16x16x32_bf16 v[240:243], a[232:235], a[8:11], v[240:243]
    ds_read_b64_tr_b16 a[228:229], v8 offset:36864
    v_bfe_u32 v26, v1, 2, 3
    v_mfma_f32_16x16x32_bf16 v[240:243], a[236:239], a[24:27], v[240:243]
    ds_read_b64_tr_b16 a[230:231], v8 offset:43008
    v_lshlrev_b32 v25, 7, v26
    v_mfma_f32_16x16x32_bf16 v[248:251], a[236:239], a[28:31], v[248:251]
    buffer_load_dwordx4 a[72:75], v15, s[20:23], s46 offen sc1
    v_mfma_f32_16x16x32_bf16 v[248:251], a[232:235], a[12:15], v[248:251]
    s_waitcnt lgkmcnt(5)
    ds_read_b64_tr_b16 a[232:233], v9 offset:24576
    v_max_u32 v20, v32, v33
    v_mfma_f32_16x16x32_bf16 v[252:255], a[240:243], a[12:15], v[252:255]
    ds_read_b64_tr_b16 a[234:235], v9 offset:30720
    v_min_u32 v21, v32, v33
    v_mfma_f32_16x16x32_bf16 v[252:255], a[244:247], a[28:31], v[252:255]
    ds_read_b64_tr_b16 a[236:237], v9 offset:36864
    v_med3_u32 v21, v20, v21, v34
    v_mfma_f32_16x16x32_bf16 v[244:247], a[244:247], a[24:27], v[244:247]
    ds_read_b64_tr_b16 a[238:239], v9 offset:43008
    v_max_u32 v20, v20, v34
    v_mfma_f32_16x16x32_bf16 v[244:247], a[240:243], a[8:11], v[244:247]
    v_med3_u32 v21, v20, v21, v35
    v_max_u32 v20, v20, v35
    v_mfma_f32_16x16x32_bf16 v[236:239], a[240:243], a[4:7], v[236:239]
    buffer_load_dwordx4 a[76:79], v15, s[20:23], s77 offen sc1
    v_mfma_f32_16x16x32_bf16 v[236:239], a[244:247], a[20:23], v[236:239]
    s_waitcnt vmcnt(17) lgkmcnt(4)
    v_med3_u32 v21, v20, v21, v36
    v_max_u32 v20, v20, v36
    v_mfma_f32_16x16x32_bf16 v[228:231], a[244:247], a[16:19], v[228:231]
    s_waitcnt vmcnt(13)
    v_med3_u32 v21, v20, v21, v37
    v_max_u32 v20, v20, v37
    v_mfma_f32_16x16x32_bf16 v[228:231], a[240:243], a[0:3], v[228:231]
    s_waitcnt vmcnt(12)
    ds_read_b64_tr_b16 a[240:241], v10 offset:24576
    v_med3_u32 v21, v20, v21, v38
    v_mfma_f32_16x16x32_bf16 v[64:67], a[224:227], a[32:35], v[64:67]
    s_add_u32 s46, s45, 53248
    ds_read_b64_tr_b16 a[242:243], v10 offset:30720
    v_max_u32 v20, v20, v38
    v_mfma_f32_16x16x32_bf16 v[64:67], a[228:231], a[48:51], v[64:67]
    s_sub_u32 s77, s46, 81920
    ds_read_b64_tr_b16 a[244:245], v10 offset:36864
    v_med3_u32 v21, v20, v21, v39
    v_mfma_f32_16x16x32_bf16 v[72:75], a[228:231], a[52:55], v[72:75]
    s_waitcnt vmcnt(11)
    ds_read_b64_tr_b16 a[246:247], v10 offset:43008
    v_max_u32 v20, v20, v39
    v_mfma_f32_16x16x32_bf16 v[72:75], a[224:227], a[36:39], v[72:75]
    s_waitcnt vmcnt(10)
    v_readfirstlane_b32 s70, v20
    v_readfirstlane_b32 s71, v21
    v_mfma_f32_16x16x32_bf16 v[80:83], a[224:227], a[40:43], v[80:83]
    s_min_u32 s46, s46, s77
    v_cndmask_b32 v22, v20, v21, vcc
    v_and_b32 v22, 0x7ff, v22
    v_mfma_f32_16x16x32_bf16 v[80:83], a[228:231], a[56:59], v[80:83]
    buffer_load_dwordx4 a[80:83], v14, s[20:23], s46 offen sc1
    v_mfma_f32_16x16x32_bf16 v[88:91], a[228:231], a[60:63], v[88:91]
    s_waitcnt lgkmcnt(3)
    v_sub_u32 v22, 2047, v22
    v_mul_u32_u24 v23, 1280, v22
    v_mfma_f32_16x16x32_bf16 v[88:91], a[224:227], a[44:47], v[88:91]
    s_xor_b32 s77, s46, 1024
    ds_read_b64_tr_b16 a[224:225], v11 offset:24576
    v_lshl_add_u32 v23, v24, 4, v23
    v_mfma_f32_16x16x32_bf16 v[92:95], a[232:235], a[44:47], v[92:95]
    buffer_load_dwordx4 a[84:87], v14, s[20:23], s77 offen sc1
    v_mfma_f32_16x16x32_bf16 v[92:95], a[236:239], a[60:63], v[92:95]
    ds_read_b64_tr_b16 a[226:227], v11 offset:30720
    v_add_u32 v23, s61, v23
    v_mfma_f32_16x16x32_bf16 v[84:87], a[236:239], a[56:59], v[84:87]
    ds_read_b64_tr_b16 a[228:229], v11 offset:36864
    v_lshlrev_b32 v24, 3, v22
    v_mfma_f32_16x16x32_bf16 v[84:87], a[232:235], a[40:43], v[84:87]
    ds_read_b64_tr_b16 a[230:231], v11 offset:43008
    v_add_u32 v24, 3211264, v24
    v_mfma_f32_16x16x32_bf16 v[76:79], a[232:235], a[36:39], v[76:79]
    v_lshrrev_b32 v26, 1, v26
    v_xor_b32 v26, s3, v26
    v_mfma_f32_16x16x32_bf16 v[76:79], a[236:239], a[52:55], v[76:79]
    s_waitcnt lgkmcnt(4)
    v_lshl_add_u32 v25, v26, 5, v25
    v_and_b32 v26, 3, v1
    v_mfma_f32_16x16x32_bf16 v[68:71], a[236:239], a[48:51], v[68:71]
    buffer_load_dwordx4 a[88:91], v15, s[20:23], s46 offen sc1
    v_mfma_f32_16x16x32_bf16 v[68:71], a[232:235], a[32:35], v[68:71]
    ds_read_b64_tr_b16 a[232:233], v8 offset:25600
    v_lshl_add_u32 v25, v26, 3, v25
    v_mfma_f32_16x16x32_bf16 v[96:99], a[240:243], a[32:35], v[96:99]
    ds_read_b64_tr_b16 a[234:235], v8 offset:31744
    v_lshrrev_b32 v26, 5, v1
    v_mfma_f32_16x16x32_bf16 v[96:99], a[244:247], a[48:51], v[96:99]
    ds_read_b64_tr_b16 a[236:237], v8 offset:37888
    v_mul_u32_u24 v26, 2048, v26
    v_mfma_f32_16x16x32_bf16 v[104:107], a[244:247], a[52:55], v[104:107]
    ds_read_b64_tr_b16 a[238:239], v8 offset:44032
    v_add_u32 v25, v25, v26
    v_mfma_f32_16x16x32_bf16 v[104:107], a[240:243], a[36:39], v[104:107]
    v_add_u32 v25, 147456, v25
    v_lshlrev_b32 v26, 4, v1
    v_mfma_f32_16x16x32_bf16 v[112:115], a[240:243], a[40:43], v[112:115]
    buffer_load_dwordx4 a[92:95], v15, s[20:23], s77 offen sc1
    v_mfma_f32_16x16x32_bf16 v[112:115], a[244:247], a[56:59], v[112:115]
    s_waitcnt lgkmcnt(4)
    v_cmp_gt_u32 vcc, 16, v1
    v_mov_b32 v27, 0x7ffffff0
    v_mfma_f32_16x16x32_bf16 v[120:123], a[244:247], a[60:63], v[120:123]
    s_addk_i32 m0, 19712
    v_cndmask_b32 v26, v27, v26, vcc
    v_mfma_f32_16x16x32_bf16 v[120:123], a[240:243], a[44:47], v[120:123]
    ds_read_b64_tr_b16 a[240:241], v9 offset:25600
    v_mfma_f32_16x16x32_bf16 v[124:127], a[224:227], a[44:47], v[124:127]
    ds_read_b64_tr_b16 a[242:243], v9 offset:31744
    v_mfma_f32_16x16x32_bf16 v[124:127], a[228:231], a[60:63], v[124:127]
    ds_read_b64_tr_b16 a[244:245], v9 offset:37888
    v_mfma_f32_16x16x32_bf16 v[116:119], a[228:231], a[56:59], v[116:119]
    buffer_load_dwordx4 v2, s[8:11], s36 offen offset:0 lds
    v_mfma_f32_16x16x32_bf16 v[116:119], a[224:227], a[40:43], v[116:119]
    s_addk_i32 m0, 896
    ds_read_b64_tr_b16 a[246:247], v9 offset:44032
    v_mfma_f32_16x16x32_bf16 v[108:111], a[224:227], a[36:39], v[108:111]
    v_min_u32 v27, 1, v1
    v_mfma_f32_16x16x32_bf16 v[108:111], a[228:231], a[52:55], v[108:111]
    s_waitcnt lgkmcnt(4)
    v_lshlrev_b32 v27, 30, v27
    v_mfma_f32_16x16x32_bf16 v[100:103], a[228:231], a[48:51], v[100:103]
    v_mfma_f32_16x16x32_bf16 v[100:103], a[224:227], a[32:35], v[100:103]
    ds_read_b64_tr_b16 a[224:225], v10 offset:25600
    v_mfma_f32_16x16x32_bf16 v[128:131], a[232:235], a[32:35], v[128:131]
    buffer_load_dwordx4 v2, s[8:11], s36 offen offset:128 lds
    v_mfma_f32_16x16x32_bf16 v[128:131], a[236:239], a[48:51], v[128:131]
    s_addk_i32 m0, 896
    ds_read_b64_tr_b16 a[226:227], v10 offset:31744
    v_mfma_f32_16x16x32_bf16 v[136:139], a[236:239], a[52:55], v[136:139]
    ds_read_b64_tr_b16 a[228:229], v10 offset:37888
    v_mfma_f32_16x16x32_bf16 v[136:139], a[232:235], a[36:39], v[136:139]
    ds_read_b64_tr_b16 a[230:231], v10 offset:44032
    v_mfma_f32_16x16x32_bf16 v[144:147], a[232:235], a[40:43], v[144:147]
    v_mfma_f32_16x16x32_bf16 v[144:147], a[236:239], a[56:59], v[144:147]
    s_waitcnt lgkmcnt(4)
    v_mfma_f32_16x16x32_bf16 v[152:155], a[236:239], a[60:63], v[152:155]
    buffer_load_dwordx4 v2, s[8:11], s36 offen offset:256 lds
    v_mfma_f32_16x16x32_bf16 v[152:155], a[232:235], a[44:47], v[152:155]
    s_addk_i32 m0, 1280
    ds_read_b64_tr_b16 a[232:233], v11 offset:25600
    v_mfma_f32_16x16x32_bf16 v[156:159], a[240:243], a[44:47], v[156:159]
    ds_read_b64_tr_b16 a[234:235], v11 offset:31744
    v_mfma_f32_16x16x32_bf16 v[156:159], a[244:247], a[60:63], v[156:159]
    ds_read_b64_tr_b16 a[236:237], v11 offset:37888
    v_mfma_f32_16x16x32_bf16 v[148:151], a[244:247], a[56:59], v[148:151]
    ds_read_b64_tr_b16 a[238:239], v11 offset:44032
    v_mfma_f32_16x16x32_bf16 v[148:151], a[240:243], a[40:43], v[148:151]
    v_mfma_f32_16x16x32_bf16 v[140:143], a[240:243], a[36:39], v[140:143]
    buffer_load_dwordx4 v3, s[8:11], s36 offen offset:0 lds
    v_mfma_f32_16x16x32_bf16 v[140:143], a[244:247], a[52:55], v[140:143]
    s_waitcnt lgkmcnt(4)
    s_addk_i32 m0, 896
    v_mfma_f32_16x16x32_bf16 v[132:135], a[244:247], a[48:51], v[132:135]
    v_mfma_f32_16x16x32_bf16 v[132:135], a[240:243], a[32:35], v[132:135]
    ds_read_b64_tr_b16 a[240:241], v8 offset:26624
    v_mfma_f32_16x16x32_bf16 v[160:163], a[224:227], a[32:35], v[160:163]
    ds_read_b64_tr_b16 a[242:243], v8 offset:32768
    v_mfma_f32_16x16x32_bf16 v[160:163], a[228:231], a[48:51], v[160:163]
    ds_read_b64_tr_b16 a[244:245], v8 offset:38912
    v_mfma_f32_16x16x32_bf16 v[168:171], a[228:231], a[52:55], v[168:171]
    global_load_dwordx4 v[48:51], v23, s[64:65]
    v_mfma_f32_16x16x32_bf16 v[168:171], a[224:227], a[36:39], v[168:171]
    global_load_dwordx4 v[52:55], v23, s[64:65] offset:64
    v_mfma_f32_16x16x32_bf16 v[176:179], a[224:227], a[40:43], v[176:179]
    buffer_load_dwordx2 v[40:41], v24, s[24:27], 0 offen sc1
    v_mfma_f32_16x16x32_bf16 v[176:179], a[228:231], a[56:59], v[176:179]
    buffer_load_dwordx4 v3, s[8:11], s36 offen offset:128 lds
    v_mfma_f32_16x16x32_bf16 v[184:187], a[228:231], a[60:63], v[184:187]
    s_waitcnt lgkmcnt(2)
    ds_read_b64_tr_b16 a[246:247], v8 offset:45056
    s_addk_i32 m0, 896
    v_mfma_f32_16x16x32_bf16 v[184:187], a[224:227], a[44:47], v[184:187]
    ds_read_b64_tr_b16 a[224:225], v9 offset:26624
    v_mfma_f32_16x16x32_bf16 v[188:191], a[232:235], a[44:47], v[188:191]
    buffer_load_dwordx4 v3, s[8:11], s36 offen offset:256 lds
    v_mfma_f32_16x16x32_bf16 v[188:191], a[236:239], a[60:63], v[188:191]
    s_add_u32 s36, s36, s37
    ds_read_b64_tr_b16 a[226:227], v9 offset:32768
    s_sub_u32 s55, s36, 7864320
    v_mfma_f32_16x16x32_bf16 v[180:183], a[236:239], a[56:59], v[180:183]
    s_min_u32 s36, s36, s55
    ds_read_b64_tr_b16 a[228:229], v9 offset:38912
    s_add_u32 s46, s45, 57344
    v_mfma_f32_16x16x32_bf16 v[180:183], a[232:235], a[40:43], v[180:183]
    s_sub_u32 s77, s46, 81920
    ds_read_b64_tr_b16 a[230:231], v9 offset:45056
    s_min_u32 s46, s46, s77
    v_mfma_f32_16x16x32_bf16 v[172:175], a[232:235], a[36:39], v[172:175]
    s_xor_b32 s77, s46, 1024
    v_add_u32 v8, 49152, v8
    v_mfma_f32_16x16x32_bf16 v[172:175], a[236:239], a[52:55], v[172:175]
    s_waitcnt lgkmcnt(4)
    v_add_u32 v9, 49152, v9
    v_mfma_f32_16x16x32_bf16 v[164:167], a[236:239], a[48:51], v[164:167]
    buffer_load_dwordx4 a[160:163], v14, s[20:23], s46 offen sc1
    v_mfma_f32_16x16x32_bf16 v[164:167], a[232:235], a[32:35], v[164:167]
    ds_read_b64_tr_b16 a[232:233], v10 offset:26624
    v_mfma_f32_16x16x32_bf16 v[192:195], a[240:243], a[32:35], v[192:195]
    ds_read_b64_tr_b16 a[234:235], v10 offset:32768
    v_mfma_f32_16x16x32_bf16 v[192:195], a[244:247], a[48:51], v[192:195]
    ds_read_b64_tr_b16 a[236:237], v10 offset:38912
    v_mfma_f32_16x16x32_bf16 v[200:203], a[244:247], a[52:55], v[200:203]
    ds_read_b64_tr_b16 a[238:239], v10 offset:45056
    v_mfma_f32_16x16x32_bf16 v[200:203], a[240:243], a[36:39], v[200:203]
    v_add_u32 v10, 49152, v10
    v_mfma_f32_16x16x32_bf16 v[208:211], a[240:243], a[40:43], v[208:211]
    buffer_load_dwordx4 a[164:167], v14, s[20:23], s77 offen sc1
    v_mfma_f32_16x16x32_bf16 v[208:211], a[244:247], a[56:59], v[208:211]
    s_waitcnt lgkmcnt(4)
    v_mfma_f32_16x16x32_bf16 v[216:219], a[244:247], a[60:63], v[216:219]
    v_mfma_f32_16x16x32_bf16 v[216:219], a[240:243], a[44:47], v[216:219]
    ds_read_b64_tr_b16 a[240:241], v11 offset:26624
    ds_read_b64_tr_b16 a[242:243], v11 offset:32768
    ds_read_b64_tr_b16 a[244:245], v11 offset:38912
    v_mfma_f32_16x16x32_bf16 v[220:223], a[224:227], a[44:47], v[220:223]
    ds_read_b64_tr_b16 a[246:247], v11 offset:45056
    v_mfma_f32_16x16x32_bf16 v[220:223], a[228:231], a[60:63], v[220:223]
    v_add_u32 v11, 49152, v11
    v_mfma_f32_16x16x32_bf16 v[212:215], a[228:231], a[56:59], v[212:215]
    buffer_load_dwordx4 a[168:171], v15, s[20:23], s46 offen sc1
    v_mfma_f32_16x16x32_bf16 v[212:215], a[224:227], a[40:43], v[212:215]
    v_mfma_f32_16x16x32_bf16 v[204:207], a[224:227], a[36:39], v[204:207]
    v_mfma_f32_16x16x32_bf16 v[204:207], a[228:231], a[52:55], v[204:207]
    s_waitcnt lgkmcnt(4)
    v_mfma_f32_16x16x32_bf16 v[196:199], a[228:231], a[48:51], v[196:199]
    s_waitcnt lgkmcnt(0)
    s_barrier
    v_mfma_f32_16x16x32_bf16 v[196:199], a[224:227], a[32:35], v[196:199]
    ds_read_b64_tr_b16 a[224:225], v8 offset:0
    v_mfma_f32_16x16x32_bf16 v[224:227], a[232:235], a[32:35], v[224:227]
    buffer_load_dwordx4 a[172:175], v15, s[20:23], s77 offen sc1
    v_mfma_f32_16x16x32_bf16 v[224:227], a[236:239], a[48:51], v[224:227]
    s_add_u32 m0, s44, 147456
    ds_read_b64_tr_b16 a[226:227], v8 offset:6144
    v_mfma_f32_16x16x32_bf16 v[232:235], a[236:239], a[52:55], v[232:235]
    ds_read_b64_tr_b16 a[228:229], v8 offset:12288
    v_mfma_f32_16x16x32_bf16 v[232:235], a[232:235], a[36:39], v[232:235]
    ds_read_b64_tr_b16 a[230:231], v8 offset:18432
    v_mfma_f32_16x16x32_bf16 v[240:243], a[232:235], a[40:43], v[240:243]
    v_mfma_f32_16x16x32_bf16 v[240:243], a[236:239], a[56:59], v[240:243]
    v_mfma_f32_16x16x32_bf16 v[248:251], a[236:239], a[60:63], v[248:251]
    buffer_load_dwordx4 v56, s[28:31], s60 offen lds
    v_mfma_f32_16x16x32_bf16 v[248:251], a[232:235], a[44:47], v[248:251]
    s_addk_i32 m0, 1024
    ds_read_b64_tr_b16 a[232:233], v9 offset:0
    v_mfma_f32_16x16x32_bf16 v[252:255], a[240:243], a[44:47], v[252:255]
    ds_read_b64_tr_b16 a[234:235], v9 offset:6144
    v_mfma_f32_16x16x32_bf16 v[252:255], a[244:247], a[60:63], v[252:255]
    ds_read_b64_tr_b16 a[236:237], v9 offset:12288
    v_mfma_f32_16x16x32_bf16 v[244:247], a[244:247], a[56:59], v[244:247]
    ds_read_b64_tr_b16 a[238:239], v9 offset:18432
    v_mfma_f32_16x16x32_bf16 v[244:247], a[240:243], a[40:43], v[244:247]
    v_mfma_f32_16x16x32_bf16 v[236:239], a[240:243], a[36:39], v[236:239]
    buffer_load_dwordx4 v56, s[32:35], s60 offen lds
    v_mfma_f32_16x16x32_bf16 v[236:239], a[244:247], a[52:55], v[236:239]
    s_waitcnt vmcnt(22) lgkmcnt(4)
    s_addk_i32 m0, 1024
    v_mfma_f32_16x16x32_bf16 v[228:231], a[244:247], a[48:51], v[228:231]
    s_waitcnt vmcnt(18)
    v_mfma_f32_16x16x32_bf16 v[228:231], a[240:243], a[32:35], v[228:231]
    s_waitcnt vmcnt(17)
    ds_read_b64_tr_b16 a[240:241], v10 offset:0
    v_mfma_f32_16x16x32_bf16 v[64:67], a[224:227], a[64:67], v[64:67]
    ds_read_b64_tr_b16 a[242:243], v10 offset:6144
    v_mfma_f32_16x16x32_bf16 v[64:67], a[228:231], a[80:83], v[64:67]
    ds_read_b64_tr_b16 a[244:245], v10 offset:12288
    v_mfma_f32_16x16x32_bf16 v[72:75], a[228:231], a[84:87], v[72:75]
    buffer_load_dwordx4 v57, s[28:31], s60 offen lds
    v_mfma_f32_16x16x32_bf16 v[72:75], a[224:227], a[68:71], v[72:75]
    s_waitcnt vmcnt(16)
    ds_read_b64_tr_b16 a[246:247], v10 offset:18432
    s_addk_i32 m0, 1024
    v_mfma_f32_16x16x32_bf16 v[80:83], a[224:227], a[72:75], v[80:83]
    v_mfma_f32_16x16x32_bf16 v[80:83], a[228:231], a[88:91], v[80:83]
    s_waitcnt lgkmcnt(4)
    v_mfma_f32_16x16x32_bf16 v[88:91], a[228:231], a[92:95], v[88:91]
    v_mfma_f32_16x16x32_bf16 v[88:91], a[224:227], a[76:79], v[88:91]
    ds_read_b64_tr_b16 a[224:225], v11 offset:0
    v_mfma_f32_16x16x32_bf16 v[92:95], a[232:235], a[76:79], v[92:95]
    buffer_load_dwordx4 v57, s[32:35], s60 offen lds
    v_mfma_f32_16x16x32_bf16 v[92:95], a[236:239], a[92:95], v[92:95]
    s_add_u32 s46, s45, 61440
    ds_read_b64_tr_b16 a[226:227], v11 offset:6144
    s_sub_u32 s77, s46, 81920
    v_mfma_f32_16x16x32_bf16 v[84:87], a[236:239], a[88:91], v[84:87]
    s_min_u32 s46, s46, s77
    ds_read_b64_tr_b16 a[228:229], v11 offset:12288
    s_xor_b32 s77, s46, 1024
    v_mfma_f32_16x16x32_bf16 v[84:87], a[232:235], a[72:75], v[84:87]
    ds_read_b64_tr_b16 a[230:231], v11 offset:18432
    v_mfma_f32_16x16x32_bf16 v[76:79], a[232:235], a[68:71], v[76:79]
    v_mfma_f32_16x16x32_bf16 v[76:79], a[236:239], a[84:87], v[76:79]
    s_waitcnt lgkmcnt(4)
    v_mfma_f32_16x16x32_bf16 v[68:71], a[236:239], a[80:83], v[68:71]
    buffer_load_dwordx4 a[176:179], v14, s[20:23], s46 offen sc1
    v_mfma_f32_16x16x32_bf16 v[68:71], a[232:235], a[64:67], v[68:71]
    ds_read_b64_tr_b16 a[232:233], v8 offset:1024
    v_mfma_f32_16x16x32_bf16 v[96:99], a[240:243], a[64:67], v[96:99]
    ds_read_b64_tr_b16 a[234:235], v8 offset:7168
    v_mfma_f32_16x16x32_bf16 v[96:99], a[244:247], a[80:83], v[96:99]
    ds_read_b64_tr_b16 a[236:237], v8 offset:13312
    v_mfma_f32_16x16x32_bf16 v[104:107], a[244:247], a[84:87], v[104:107]
    ds_read_b64_tr_b16 a[238:239], v8 offset:19456
    v_mfma_f32_16x16x32_bf16 v[104:107], a[240:243], a[68:71], v[104:107]
    v_mfma_f32_16x16x32_bf16 v[112:115], a[240:243], a[72:75], v[112:115]
    buffer_load_dwordx4 a[180:183], v14, s[20:23], s77 offen sc1
    v_mfma_f32_16x16x32_bf16 v[112:115], a[244:247], a[88:91], v[112:115]
    s_waitcnt lgkmcnt(4)
    v_mfma_f32_16x16x32_bf16 v[120:123], a[244:247], a[92:95], v[120:123]
    s_add_u32 s88, s88, 32768
    s_addc_u32 s89, s89, 0
    v_mfma_f32_16x16x32_bf16 v[120:123], a[240:243], a[76:79], v[120:123]
    ds_read_b64_tr_b16 a[240:241], v9 offset:1024
    v_mfma_f32_16x16x32_bf16 v[124:127], a[224:227], a[76:79], v[124:127]
    global_load_dword a252, v18, s[88:89]
    v_mfma_f32_16x16x32_bf16 v[124:127], a[228:231], a[92:95], v[124:127]
    ds_read_b64_tr_b16 a[242:243], v9 offset:7168
    v_mfma_f32_16x16x32_bf16 v[116:119], a[228:231], a[88:91], v[116:119]
    buffer_load_dwordx4 a[184:187], v15, s[20:23], s46 offen sc1
    v_mfma_f32_16x16x32_bf16 v[116:119], a[224:227], a[72:75], v[116:119]
    ds_read_b64_tr_b16 a[244:245], v9 offset:13312
    v_mfma_f32_16x16x32_bf16 v[108:111], a[224:227], a[68:71], v[108:111]
    ds_read_b64_tr_b16 a[246:247], v9 offset:19456
    v_mfma_f32_16x16x32_bf16 v[108:111], a[228:231], a[84:87], v[108:111]
    s_waitcnt lgkmcnt(4)
    v_mfma_f32_16x16x32_bf16 v[100:103], a[228:231], a[80:83], v[100:103]
    v_mfma_f32_16x16x32_bf16 v[100:103], a[224:227], a[64:67], v[100:103]
    ds_read_b64_tr_b16 a[224:225], v10 offset:1024
    v_mfma_f32_16x16x32_bf16 v[128:131], a[232:235], a[64:67], v[128:131]
    buffer_load_dwordx4 a[188:191], v15, s[20:23], s77 offen sc1
    v_mfma_f32_16x16x32_bf16 v[128:131], a[236:239], a[80:83], v[128:131]
    s_add_u32 s46, s45, 65536
    ds_read_b64_tr_b16 a[226:227], v10 offset:7168
    s_sub_u32 s77, s46, 81920
    v_mfma_f32_16x16x32_bf16 v[136:139], a[236:239], a[84:87], v[136:139]
    s_min_u32 s46, s46, s77
    ds_read_b64_tr_b16 a[228:229], v10 offset:13312
    s_xor_b32 s77, s46, 1024
    v_mfma_f32_16x16x32_bf16 v[136:139], a[232:235], a[68:71], v[136:139]
    ds_read_b64_tr_b16 a[230:231], v10 offset:19456
    v_mfma_f32_16x16x32_bf16 v[144:147], a[232:235], a[72:75], v[144:147]
    v_mfma_f32_16x16x32_bf16 v[144:147], a[236:239], a[88:91], v[144:147]
    s_waitcnt lgkmcnt(4)
    v_mfma_f32_16x16x32_bf16 v[152:155], a[236:239], a[92:95], v[152:155]
    buffer_load_dwordx4 a[96:99], v14, s[20:23], s46 offen sc1
    v_mfma_f32_16x16x32_bf16 v[152:155], a[232:235], a[76:79], v[152:155]
    ds_read_b64_tr_b16 a[232:233], v11 offset:1024
    v_mfma_f32_16x16x32_bf16 v[156:159], a[240:243], a[76:79], v[156:159]
    ds_read_b64_tr_b16 a[234:235], v11 offset:7168
    v_mfma_f32_16x16x32_bf16 v[156:159], a[244:247], a[92:95], v[156:159]
    ds_read_b64_tr_b16 a[236:237], v11 offset:13312
    v_mfma_f32_16x16x32_bf16 v[148:151], a[244:247], a[88:91], v[148:151]
    ds_read_b64_tr_b16 a[238:239], v11 offset:19456
    v_mfma_f32_16x16x32_bf16 v[148:151], a[240:243], a[72:75], v[148:151]
    v_mfma_f32_16x16x32_bf16 v[140:143], a[240:243], a[68:71], v[140:143]
    buffer_load_dwordx4 a[100:103], v14, s[20:23], s77 offen sc1
    v_mfma_f32_16x16x32_bf16 v[140:143], a[244:247], a[84:87], v[140:143]
    s_waitcnt lgkmcnt(4)
    v_mfma_f32_16x16x32_bf16 v[132:135], a[244:247], a[80:83], v[132:135]
    v_mfma_f32_16x16x32_bf16 v[132:135], a[240:243], a[64:67], v[132:135]
    ds_read_b64_tr_b16 a[240:241], v8 offset:2048
    v_mfma_f32_16x16x32_bf16 v[160:163], a[224:227], a[64:67], v[160:163]
    ds_read_b64_tr_b16 a[242:243], v8 offset:8192
    v_mfma_f32_16x16x32_bf16 v[160:163], a[228:231], a[80:83], v[160:163]
    ds_read_b64_tr_b16 a[244:245], v8 offset:14336
    v_mfma_f32_16x16x32_bf16 v[168:171], a[228:231], a[84:87], v[168:171]
    buffer_load_dwordx4 a[104:107], v15, s[20:23], s46 offen sc1
    v_mfma_f32_16x16x32_bf16 v[168:171], a[224:227], a[68:71], v[168:171]
    ds_read_b64_tr_b16 a[246:247], v8 offset:20480
    v_mfma_f32_16x16x32_bf16 v[176:179], a[224:227], a[72:75], v[176:179]
    v_mfma_f32_16x16x32_bf16 v[176:179], a[228:231], a[88:91], v[176:179]
    s_waitcnt lgkmcnt(4)
    v_mfma_f32_16x16x32_bf16 v[184:187], a[228:231], a[92:95], v[184:187]
    s_waitcnt vmcnt(20)
    v_lshlrev_b32 v42, 16, v48
    v_and_b32 v43, 0xffff0000, v48
    v_mfma_f32_16x16x32_bf16 v[184:187], a[224:227], a[76:79], v[184:187]
    ds_read_b64_tr_b16 a[224:225], v9 offset:2048
    v_mfma_f32_16x16x32_bf16 v[188:191], a[232:235], a[76:79], v[188:191]
    buffer_load_dwordx4 a[108:111], v15, s[20:23], s77 offen sc1
    v_mfma_f32_16x16x32_bf16 v[188:191], a[236:239], a[92:95], v[188:191]
    s_add_u32 s46, s45, 69632
    ds_read_b64_tr_b16 a[226:227], v9 offset:8192
    s_sub_u32 s77, s46, 81920
    v_mfma_f32_16x16x32_bf16 v[180:183], a[236:239], a[88:91], v[180:183]
    s_min_u32 s46, s46, s77
    ds_read_b64_tr_b16 a[228:229], v9 offset:14336
    s_xor_b32 s77, s46, 1024
    v_mfma_f32_16x16x32_bf16 v[180:183], a[232:235], a[72:75], v[180:183]
    s_waitcnt vmcnt(19)
    ds_read_b64_tr_b16 a[230:231], v9 offset:20480
    v_sub_f32 v42, v42, v40
    v_mfma_f32_16x16x32_bf16 v[172:175], a[232:235], a[68:71], v[172:175]
    v_sub_f32 v43, v43, v40
    v_cvt_pk_bf16_f32 v42, 0, v42
    v_mfma_f32_16x16x32_bf16 v[172:175], a[236:239], a[84:87], v[172:175]
    s_waitcnt lgkmcnt(4)
    v_cvt_pk_bf16_f32 v43, 0, v43
    v_mul_f32 v42, v42, v41
    v_mfma_f32_16x16x32_bf16 v[164:167], a[236:239], a[80:83], v[164:167]
    buffer_load_dwordx4 a[112:115], v14, s[20:23], s46 offen sc1
    v_mfma_f32_16x16x32_bf16 v[164:167], a[232:235], a[64:67], v[164:167]
    ds_read_b64_tr_b16 a[232:233], v10 offset:2048
    v_mul_f32 v43, v43, v41
    v_mfma_f32_16x16x32_bf16 v[192:195], a[240:243], a[64:67], v[192:195]
    ds_read_b64_tr_b16 a[234:235], v10 offset:8192
    v_cvt_pk_bf16_f32 v48, v42, v43
    v_mfma_f32_16x16x32_bf16 v[192:195], a[244:247], a[80:83], v[192:195]
    ds_read_b64_tr_b16 a[236:237], v10 offset:14336
    v_lshlrev_b32 v42, 16, v49
    v_mfma_f32_16x16x32_bf16 v[200:203], a[244:247], a[84:87], v[200:203]
    ds_read_b64_tr_b16 a[238:239], v10 offset:20480
    v_and_b32 v43, 0xffff0000, v49
    v_mfma_f32_16x16x32_bf16 v[200:203], a[240:243], a[68:71], v[200:203]
    v_sub_f32 v42, v42, v40
    v_sub_f32 v43, v43, v40
    v_mfma_f32_16x16x32_bf16 v[208:211], a[240:243], a[72:75], v[208:211]
    buffer_load_dwordx4 a[116:119], v14, s[20:23], s77 offen sc1
    v_mfma_f32_16x16x32_bf16 v[208:211], a[244:247], a[88:91], v[208:211]
pg_3:
    s_cbranch_execz pg_7
    s_waitcnt lgkmcnt(4)
    v_cvt_pk_bf16_f32 v42, 0, v42
    v_cvt_pk_bf16_f32 v43, 0, v43
    v_mfma_f32_16x16x32_bf16 v[216:219], a[244:247], a[92:95], v[216:219]
    v_mul_f32 v42, v42, v41
    v_mul_f32 v43, v43, v41
    v_mfma_f32_16x16x32_bf16 v[216:219], a[240:243], a[76:79], v[216:219]
    ds_read_b64_tr_b16 a[240:241], v11 offset:2048
    v_cvt_pk_bf16_f32 v49, v42, v43
    ds_read_b64_tr_b16 a[242:243], v11 offset:8192
    v_mfma_f32_16x16x32_bf16 v[220:223], a[224:227], a[76:79], v[220:223]
    ds_read_b64_tr_b16 a[244:245], v11 offset:14336
    v_lshlrev_b32 v42, 16, v50
    ds_read_b64_tr_b16 a[246:247], v11 offset:20480
    v_mfma_f32_16x16x32_bf16 v[220:223], a[228:231], a[92:95], v[220:223]
    v_and_b32 v43, 0xffff0000, v50
    v_sub_f32 v42, v42, v40
    v_mfma_f32_16x16x32_bf16 v[212:215], a[228:231], a[88:91], v[212:215]
    buffer_load_dwordx4 a[120:123], v15, s[20:23], s46 offen sc1
    v_mfma_f32_16x16x32_bf16 v[212:215], a[224:227], a[72:75], v[212:215]
    v_sub_f32 v43, v43, v40
    v_cvt_pk_bf16_f32 v42, 0, v42
    v_mfma_f32_16x16x32_bf16 v[204:207], a[224:227], a[68:71], v[204:207]
    v_cvt_pk_bf16_f32 v43, 0, v43
    v_mul_f32 v42, v42, v41
    v_mfma_f32_16x16x32_bf16 v[204:207], a[228:231], a[84:87], v[204:207]
    s_waitcnt lgkmcnt(4)
    v_mul_f32 v43, v43, v41
    v_cvt_pk_bf16_f32 v50, v42, v43
    v_mfma_f32_16x16x32_bf16 v[196:199], a[228:231], a[80:83], v[196:199]
    s_waitcnt vmcnt(12) lgkmcnt(0)
    s_barrier
    v_mfma_f32_16x16x32_bf16 v[196:199], a[224:227], a[64:67], v[196:199]
    ds_read_b64_tr_b16 a[224:225], v8 offset:24576
    v_lshlrev_b32 v42, 16, v51
    v_mfma_f32_16x16x32_bf16 v[224:227], a[232:235], a[64:67], v[224:227]
    buffer_load_dwordx4 a[124:127], v15, s[20:23], s77 offen sc1
    v_mfma_f32_16x16x32_bf16 v[224:227], a[236:239], a[80:83], v[224:227]
    s_add_u32 s46, s45, 73728
    ds_read_b64_tr_b16 a[226:227], v8 offset:30720
    v_and_b32 v43, 0xffff0000, v51
    v_mfma_f32_16x16x32_bf16 v[232:235], a[236:239], a[84:87], v[232:235]
    s_sub_u32 s77, s46, 81920
    ds_read_b64_tr_b16 a[228:229], v8 offset:36864
    v_sub_f32 v42, v42, v40
    v_mfma_f32_16x16x32_bf16 v[232:235], a[232:235], a[68:71], v[232:235]
    s_min_u32 s46, s46, s77
    ds_read_b64_tr_b16 a[230:231], v8 offset:43008
    v_sub_f32 v43, v43, v40
    v_mfma_f32_16x16x32_bf16 v[240:243], a[232:235], a[72:75], v[240:243]
    s_xor_b32 s77, s46, 1024
    v_cvt_pk_bf16_f32 v42, 0, v42
    v_cvt_pk_bf16_f32 v43, 0, v43
    v_mfma_f32_16x16x32_bf16 v[240:243], a[236:239], a[88:91], v[240:243]
    v_mul_f32 v42, v42, v41
    v_mul_f32 v43, v43, v41
    v_mfma_f32_16x16x32_bf16 v[248:251], a[236:239], a[92:95], v[248:251]
    buffer_load_dwordx4 a[128:131], v14, s[20:23], s46 offen sc1
    v_mfma_f32_16x16x32_bf16 v[248:251], a[232:235], a[76:79], v[248:251]
    ds_read_b64_tr_b16 a[232:233], v9 offset:24576
    v_cvt_pk_bf16_f32 v51, v42, v43
    v_mfma_f32_16x16x32_bf16 v[252:255], a[240:243], a[76:79], v[252:255]
    ds_read_b64_tr_b16 a[234:235], v9 offset:30720
    v_lshlrev_b32 v42, 16, v52
    v_mfma_f32_16x16x32_bf16 v[252:255], a[244:247], a[92:95], v[252:255]
    ds_read_b64_tr_b16 a[236:237], v9 offset:36864
    v_and_b32 v43, 0xffff0000, v52
    v_mfma_f32_16x16x32_bf16 v[244:247], a[244:247], a[88:91], v[244:247]
    ds_read_b64_tr_b16 a[238:239], v9 offset:43008
    v_sub_f32 v42, v42, v40
    v_mfma_f32_16x16x32_bf16 v[244:247], a[240:243], a[72:75], v[244:247]
    v_sub_f32 v43, v43, v40
    v_cvt_pk_bf16_f32 v42, 0, v42
    v_mfma_f32_16x16x32_bf16 v[236:239], a[240:243], a[68:71], v[236:239]
    buffer_load_dwordx4 a[132:135], v14, s[20:23], s77 offen sc1
    v_mfma_f32_16x16x32_bf16 v[236:239], a[244:247], a[84:87], v[236:239]
    s_waitcnt lgkmcnt(4)
    v_cvt_pk_bf16_f32 v43, 0, v43
    v_mul_f32 v42, v42, v41
    v_mfma_f32_16x16x32_bf16 v[228:231], a[244:247], a[80:83], v[228:231]
    s_waitcnt vmcnt(14)
    v_mul_f32 v43, v43, v41
    v_cvt_pk_bf16_f32 v52, v42, v43
    v_mfma_f32_16x16x32_bf16 v[228:231], a[240:243], a[64:67], v[228:231]
    s_waitcnt vmcnt(13)
    ds_read_b64_tr_b16 a[240:241], v10 offset:24576
    v_lshlrev_b32 v42, 16, v53
    v_mfma_f32_16x16x32_bf16 v[64:67], a[224:227], a[160:163], v[64:67]
    ds_read_b64_tr_b16 a[242:243], v10 offset:30720
    v_and_b32 v43, 0xffff0000, v53
    v_mfma_f32_16x16x32_bf16 v[64:67], a[228:231], a[176:179], v[64:67]
    ds_read_b64_tr_b16 a[244:245], v10 offset:36864
    v_sub_f32 v42, v42, v40
    v_mfma_f32_16x16x32_bf16 v[72:75], a[228:231], a[180:183], v[72:75]
    buffer_load_dwordx4 a[136:139], v15, s[20:23], s46 offen sc1
    v_mfma_f32_16x16x32_bf16 v[72:75], a[224:227], a[164:167], v[72:75]
    s_waitcnt vmcnt(11)
    ds_read_b64_tr_b16 a[246:247], v10 offset:43008
    v_sub_f32 v43, v43, v40
    v_mfma_f32_16x16x32_bf16 v[80:83], a[224:227], a[168:171], v[80:83]
    v_cvt_pk_bf16_f32 v42, 0, v42
    v_cvt_pk_bf16_f32 v43, 0, v43
    v_mfma_f32_16x16x32_bf16 v[80:83], a[228:231], a[184:187], v[80:83]
    s_waitcnt lgkmcnt(4)
    v_mul_f32 v42, v42, v41
    v_mul_f32 v43, v43, v41
    v_mfma_f32_16x16x32_bf16 v[88:91], a[228:231], a[188:191], v[88:91]
    v_cvt_pk_bf16_f32 v53, v42, v43
    v_lshlrev_b32 v42, 16, v54
    v_mfma_f32_16x16x32_bf16 v[88:91], a[224:227], a[172:175], v[88:91]
    ds_read_b64_tr_b16 a[224:225], v11 offset:24576
    v_and_b32 v43, 0xffff0000, v54
    v_mfma_f32_16x16x32_bf16 v[92:95], a[232:235], a[172:175], v[92:95]
    buffer_load_dwordx4 a[140:143], v15, s[20:23], s77 offen sc1
    v_mfma_f32_16x16x32_bf16 v[92:95], a[236:239], a[188:191], v[92:95]
    s_add_u32 s46, s45, 77824
    ds_read_b64_tr_b16 a[226:227], v11 offset:30720
    v_sub_f32 v42, v42, v40
    v_mfma_f32_16x16x32_bf16 v[84:87], a[236:239], a[184:187], v[84:87]
    s_sub_u32 s77, s46, 81920
    ds_read_b64_tr_b16 a[228:229], v11 offset:36864
    v_sub_f32 v43, v43, v40
    v_mfma_f32_16x16x32_bf16 v[84:87], a[232:235], a[168:171], v[84:87]
    s_min_u32 s46, s46, s77
    ds_read_b64_tr_b16 a[230:231], v11 offset:43008
    v_cvt_pk_bf16_f32 v42, 0, v42
    v_mfma_f32_16x16x32_bf16 v[76:79], a[232:235], a[164:167], v[76:79]
    s_xor_b32 s77, s46, 1024
    v_cvt_pk_bf16_f32 v43, 0, v43
    v_mul_f32 v42, v42, v41
    v_mfma_f32_16x16x32_bf16 v[76:79], a[236:239], a[180:183], v[76:79]
    s_waitcnt lgkmcnt(4)
    v_mul_f32 v43, v43, v41
    v_cvt_pk_bf16_f32 v54, v42, v43
    v_mfma_f32_16x16x32_bf16 v[68:71], a[236:239], a[176:179], v[68:71]
    buffer_load_dwordx4 a[144:147], v14, s[20:23], s46 offen sc1
    v_mfma_f32_16x16x32_bf16 v[68:71], a[232:235], a[160:163], v[68:71]
    ds_read_b64_tr_b16 a[232:233], v8 offset:25600
    v_lshlrev_b32 v42, 16, v55
    v_mfma_f32_16x16x32_bf16 v[96:99], a[240:243], a[160:163], v[96:99]
    ds_read_b64_tr_b16 a[234:235], v8 offset:31744
    v_and_b32 v43, 0xffff0000, v55
    v_mfma_f32_16x16x32_bf16 v[96:99], a[244:247], a[176:179], v[96:99]
    ds_read_b64_tr_b16 a[236:237], v8 offset:37888
    v_sub_f32 v42, v42, v40
    v_mfma_f32_16x16x32_bf16 v[104:107], a[244:247], a[180:183], v[104:107]
    ds_read_b64_tr_b16 a[238:239], v8 offset:44032
    v_sub_f32 v43, v43, v40
    v_mfma_f32_16x16x32_bf16 v[104:107], a[240:243], a[164:167], v[104:107]
    v_cvt_pk_bf16_f32 v42, 0, v42
    v_cvt_pk_bf16_f32 v43, 0, v43
    v_mfma_f32_16x16x32_bf16 v[112:115], a[240:243], a[168:171], v[112:115]
    buffer_load_dwordx4 a[148:151], v14, s[20:23], s77 offen sc1
    v_mfma_f32_16x16x32_bf16 v[112:115], a[244:247], a[184:187], v[112:115]
    s_waitcnt lgkmcnt(4)
    v_mul_f32 v42, v42, v41
    v_mul_f32 v43, v43, v41
    v_mfma_f32_16x16x32_bf16 v[120:123], a[244:247], a[188:191], v[120:123]
    v_cvt_pk_bf16_f32 v55, v42, v43
    v_mfma_f32_16x16x32_bf16 v[120:123], a[240:243], a[172:175], v[120:123]
    ds_read_b64_tr_b16 a[240:241], v9 offset:25600
    v_mfma_f32_16x16x32_bf16 v[124:127], a[224:227], a[172:175], v[124:127]
    ds_read_b64_tr_b16 a[242:243], v9 offset:31744
    v_mfma_f32_16x16x32_bf16 v[124:127], a[228:231], a[188:191], v[124:127]
    ds_read_b64_tr_b16 a[244:245], v9 offset:37888
    v_mfma_f32_16x16x32_bf16 v[116:119], a[228:231], a[184:187], v[116:119]
    buffer_load_dwordx4 a[152:155], v15, s[20:23], s46 offen sc1
    v_mfma_f32_16x16x32_bf16 v[116:119], a[224:227], a[168:171], v[116:119]
    ds_read_b64_tr_b16 a[246:247], v9 offset:44032
    v_mfma_f32_16x16x32_bf16 v[108:111], a[224:227], a[164:167], v[108:111]
    v_mfma_f32_16x16x32_bf16 v[108:111], a[228:231], a[180:183], v[108:111]
    s_waitcnt lgkmcnt(4)
    v_mfma_f32_16x16x32_bf16 v[100:103], a[228:231], a[176:179], v[100:103]
    v_mfma_f32_16x16x32_bf16 v[100:103], a[224:227], a[160:163], v[100:103]
    ds_read_b64_tr_b16 a[224:225], v10 offset:25600
    v_mfma_f32_16x16x32_bf16 v[128:131], a[232:235], a[160:163], v[128:131]
    buffer_load_dwordx4 a[156:159], v15, s[20:23], s77 offen sc1
    v_mfma_f32_16x16x32_bf16 v[128:131], a[236:239], a[176:179], v[128:131]
    s_add_u32 m0, s49, 0
    ds_read_b64_tr_b16 a[226:227], v10 offset:31744
    v_mfma_f32_16x16x32_bf16 v[136:139], a[236:239], a[180:183], v[136:139]
    ds_read_b64_tr_b16 a[228:229], v10 offset:37888
    v_mfma_f32_16x16x32_bf16 v[136:139], a[232:235], a[164:167], v[136:139]
    ds_read_b64_tr_b16 a[230:231], v10 offset:44032
    v_mfma_f32_16x16x32_bf16 v[144:147], a[232:235], a[168:171], v[144:147]
    v_mfma_f32_16x16x32_bf16 v[144:147], a[236:239], a[184:187], v[144:147]
    s_waitcnt lgkmcnt(4)
    v_mfma_f32_16x16x32_bf16 v[152:155], a[236:239], a[188:191], v[152:155]
    buffer_load_dwordx4 v4, s[12:15], s38 offen offset:0 lds
    v_mfma_f32_16x16x32_bf16 v[152:155], a[232:235], a[172:175], v[152:155]
    s_addk_i32 m0, 896
    ds_read_b64_tr_b16 a[232:233], v11 offset:25600
    v_mfma_f32_16x16x32_bf16 v[156:159], a[240:243], a[172:175], v[156:159]
    ds_read_b64_tr_b16 a[234:235], v11 offset:31744
    v_mfma_f32_16x16x32_bf16 v[156:159], a[244:247], a[188:191], v[156:159]
    ds_read_b64_tr_b16 a[236:237], v11 offset:37888
    v_mfma_f32_16x16x32_bf16 v[148:151], a[244:247], a[184:187], v[148:151]
    ds_read_b64_tr_b16 a[238:239], v11 offset:44032
    v_mfma_f32_16x16x32_bf16 v[148:151], a[240:243], a[168:171], v[148:151]
    v_mfma_f32_16x16x32_bf16 v[140:143], a[240:243], a[164:167], v[140:143]
    buffer_load_dwordx4 v4, s[12:15], s38 offen offset:128 lds
    v_mfma_f32_16x16x32_bf16 v[140:143], a[244:247], a[180:183], v[140:143]
    s_waitcnt lgkmcnt(4)
    s_addk_i32 m0, 896
    v_mfma_f32_16x16x32_bf16 v[132:135], a[244:247], a[176:179], v[132:135]
    v_mfma_f32_16x16x32_bf16 v[132:135], a[240:243], a[160:163], v[132:135]
    ds_read_b64_tr_b16 a[240:241], v8 offset:26624
    v_mfma_f32_16x16x32_bf16 v[160:163], a[224:227], a[160:163], v[160:163]
    ds_read_b64_tr_b16 a[242:243], v8 offset:32768
    v_mfma_f32_16x16x32_bf16 v[160:163], a[228:231], a[176:179], v[160:163]
    ds_read_b64_tr_b16 a[244:245], v8 offset:38912
    v_mfma_f32_16x16x32_bf16 v[168:171], a[228:231], a[180:183], v[168:171]
    buffer_load_dwordx4 v4, s[12:15], s38 offen offset:256 lds
    v_mfma_f32_16x16x32_bf16 v[168:171], a[224:227], a[164:167], v[168:171]
    s_addk_i32 m0, 1280
    ds_read_b64_tr_b16 a[246:247], v8 offset:45056
    v_mfma_f32_16x16x32_bf16 v[176:179], a[224:227], a[168:171], v[176:179]
    ds_read_b64_tr_b16 v[32:33], v25 offset:0
    v_mfma_f32_16x16x32_bf16 v[176:179], a[228:231], a[184:187], v[176:179]
    s_waitcnt lgkmcnt(5)
    ds_read_b64_tr_b16 v[34:35], v25 offset:4096
    v_mfma_f32_16x16x32_bf16 v[184:187], a[228:231], a[188:191], v[184:187]
    ds_read_b64_tr_b16 v[36:37], v25 offset:1024
    v_mfma_f32_16x16x32_bf16 v[184:187], a[224:227], a[172:175], v[184:187]
    ds_read_b64_tr_b16 v[38:39], v25 offset:5120
    v_mfma_f32_16x16x32_bf16 v[188:191], a[232:235], a[172:175], v[188:191]
    buffer_load_dwordx4 v5, s[12:15], s38 offen offset:0 lds
    v_mfma_f32_16x16x32_bf16 v[188:191], a[236:239], a[188:191], v[188:191]
    s_addk_i32 m0, 896
    ds_read_b64_tr_b16 v[40:41], v25 offset:8192
    v_mfma_f32_16x16x32_bf16 v[180:183], a[236:239], a[184:187], v[180:183]
    ds_read_b64_tr_b16 v[42:43], v25 offset:12288
    v_mfma_f32_16x16x32_bf16 v[180:183], a[232:235], a[168:171], v[180:183]
    ds_read_b64_tr_b16 v[44:45], v25 offset:9216
    v_mfma_f32_16x16x32_bf16 v[172:175], a[232:235], a[164:167], v[172:175]
    s_waitcnt lgkmcnt(5)
    ds_read_b64_tr_b16 v[46:47], v25 offset:13312
    ds_read_b64_tr_b16 a[224:225], v9 offset:26624
    v_mfma_f32_16x16x32_bf16 v[172:175], a[236:239], a[180:183], v[172:175]
    ds_read_b64_tr_b16 a[226:227], v9 offset:32768
    v_mfma_f32_16x16x32_bf16 v[164:167], a[236:239], a[176:179], v[164:167]
    ds_read_b64_tr_b16 a[228:229], v9 offset:38912
    v_mfma_f32_16x16x32_bf16 v[164:167], a[232:235], a[160:163], v[164:167]
    ds_read_b64_tr_b16 a[230:231], v9 offset:45056
    v_mfma_f32_16x16x32_bf16 v[192:195], a[240:243], a[160:163], v[192:195]
    ds_read_b64_tr_b16 a[232:233], v10 offset:26624
    v_mfma_f32_16x16x32_bf16 v[192:195], a[244:247], a[176:179], v[192:195]
    s_waitcnt lgkmcnt(7)
    ds_read_b64_tr_b16 a[234:235], v10 offset:32768
    v_mfma_f32_16x16x32_bf16 v[200:203], a[244:247], a[180:183], v[200:203]
    ds_read_b64_tr_b16 a[236:237], v10 offset:38912
    v_mfma_f32_16x16x32_bf16 v[200:203], a[240:243], a[164:167], v[200:203]
    ds_read_b64_tr_b16 a[238:239], v10 offset:45056
    v_mfma_f32_16x16x32_bf16 v[208:211], a[240:243], a[168:171], v[208:211]
    buffer_load_dwordx4 v5, s[12:15], s38 offen offset:128 lds
    v_mfma_f32_16x16x32_bf16 v[208:211], a[244:247], a[184:187], v[208:211]
    s_waitcnt lgkmcnt(5)
    v_add_u32 v8, 49152, v8
    s_addk_i32 m0, 896
    v_mfma_f32_16x16x32_bf16 v[216:219], a[244:247], a[188:191], v[216:219]
    buffer_load_dwordx4 v5, s[12:15], s38 offen offset:256 lds
    v_mfma_f32_16x16x32_bf16 v[216:219], a[240:243], a[172:175], v[216:219]
    s_waitcnt lgkmcnt(3)
    ds_read_b64_tr_b16 a[240:241], v11 offset:26624
    s_add_u32 s38, s38, 24576
    ds_read_b64_tr_b16 a[242:243], v11 offset:32768
    v_mfma_f32_16x16x32_bf16 v[220:223], a[224:227], a[172:175], v[220:223]
    s_addk_i32 m0, 19712
    ds_read_b64_tr_b16 a[244:245], v11 offset:38912
    ds_read_b64_tr_b16 a[246:247], v11 offset:45056
    v_mfma_f32_16x16x32_bf16 v[220:223], a[228:231], a[188:191], v[220:223]
    v_add_u32 v9, 49152, v9
    v_mfma_f32_16x16x32_bf16 v[212:215], a[228:231], a[184:187], v[212:215]
    buffer_load_dwordx4 v4, s[12:15], s38 offen offset:0 lds
    v_mfma_f32_16x16x32_bf16 v[212:215], a[224:227], a[168:171], v[212:215]
    s_addk_i32 m0, 896
    v_add_u32 v10, 49152, v10
    v_mfma_f32_16x16x32_bf16 v[204:207], a[224:227], a[164:167], v[204:207]
    v_add_u32 v11, 49152, v11
    v_mfma_f32_16x16x32_bf16 v[204:207], a[228:231], a[180:183], v[204:207]
    s_waitcnt lgkmcnt(4)
    v_mfma_f32_16x16x32_bf16 v[196:199], a[228:231], a[176:179], v[196:199]
    s_waitcnt lgkmcnt(0)
    s_barrier
    v_mfma_f32_16x16x32_bf16 v[196:199], a[224:227], a[160:163], v[196:199]
    ds_read_b64_tr_b16 a[224:225], v8 offset:0
    v_mfma_f32_16x16x32_bf16 v[224:227], a[232:235], a[160:163], v[224:227]
    buffer_load_dwordx4 v4, s[12:15], s38 offen offset:128 lds
    v_mfma_f32_16x16x32_bf16 v[224:227], a[236:239], a[176:179], v[224:227]
    s_addk_i32 m0, 896
    ds_read_b64_tr_b16 a[226:227], v8 offset:6144
    v_mfma_f32_16x16x32_bf16 v[232:235], a[236:239], a[180:183], v[232:235]
    ds_read_b64_tr_b16 a[228:229], v8 offset:12288
    v_mfma_f32_16x16x32_bf16 v[232:235], a[232:235], a[164:167], v[232:235]
    ds_read_b64_tr_b16 a[230:231], v8 offset:18432
    v_mfma_f32_16x16x32_bf16 v[240:243], a[232:235], a[168:171], v[240:243]
    v_mfma_f32_16x16x32_bf16 v[240:243], a[236:239], a[184:187], v[240:243]
    v_mfma_f32_16x16x32_bf16 v[248:251], a[236:239], a[188:191], v[248:251]
    buffer_load_dwordx4 v4, s[12:15], s38 offen offset:256 lds
    v_mfma_f32_16x16x32_bf16 v[248:251], a[232:235], a[172:175], v[248:251]
    s_addk_i32 m0, 1280
    ds_read_b64_tr_b16 a[232:233], v8 offset:24576
    v_mfma_f32_16x16x32_bf16 v[20:23], v[48:51], v[32:35], 0
    ds_read_b64_tr_b16 a[234:235], v8 offset:30720
    v_mfma_f32_16x16x32_bf16 v[58:61], v[48:51], v[36:39], 0
    ds_read_b64_tr_b16 a[236:237], v8 offset:36864
    v_mfma_f32_16x16x32_bf16 v[20:23], v[52:55], v[40:43], v[20:23]
    ds_read_b64_tr_b16 a[238:239], v8 offset:43008
    v_mfma_f32_16x16x32_bf16 v[58:61], v[52:55], v[44:47], v[58:61]
    v_mfma_f32_16x16x32_bf16 v[252:255], a[240:243], a[172:175], v[252:255]
    buffer_load_dwordx4 v5, s[12:15], s38 offen offset:0 lds
    v_mfma_f32_16x16x32_bf16 v[252:255], a[244:247], a[188:191], v[252:255]
    s_addk_i32 m0, 896
    v_lshlrev_b32 v14, 4, v1
    v_min_u32 v15, 1, v1
    v_mfma_f32_16x16x32_bf16 v[244:247], a[244:247], a[184:187], v[244:247]
    s_mul_i32 s56, s53, 983040
    v_mov_b32 v22, v58
    v_mov_b32 v23, v59
    v_mfma_f32_16x16x32_bf16 v[244:247], a[240:243], a[168:171], v[244:247]
    buffer_store_dwordx4 v[20:23], v26, s[24:27], s62 offen sc1
    v_mov_b32 v26, s7
    v_mfma_f32_16x16x32_bf16 v[236:239], a[240:243], a[164:167], v[236:239]
    s_mul_i32 s57, s51, 320
    v_lshrrev_b32 v21, 3, v1
    v_mul_u32_u24 v21, 1280, v21
    v_mfma_f32_16x16x32_bf16 v[236:239], a[244:247], a[180:183], v[236:239]
    s_waitcnt vmcnt(26) lgkmcnt(0)
    v_and_b32 v22, 16, v1
    v_lshlrev_b32 v22, 1, v22
    v_mfma_f32_16x16x32_bf16 v[228:231], a[244:247], a[176:179], v[228:231]
    buffer_load_dwordx4 v5, s[12:15], s38 offen offset:128 lds
    v_mfma_f32_16x16x32_bf16 v[228:231], a[240:243], a[160:163], v[228:231]
    s_waitcnt vmcnt(22)
    ds_read_b64_tr_b16 a[240:241], v9 offset:0
    v_lshlrev_b32 v15, 30, v15
    v_mfma_f32_16x16x32_bf16 v[64:67], a[224:227], a[96:99], v[64:67]
    s_addk_i32 m0, 896
    ds_read_b64_tr_b16 a[242:243], v9 offset:6144
    v_and_b32 v20, 1, v1
    v_mfma_f32_16x16x32_bf16 v[64:67], a[228:231], a[112:115], v[64:67]
    s_add_u32 s56, s56, s57
    ds_read_b64_tr_b16 a[244:245], v9 offset:12288
    v_mul_u32_u24 v20, 0xaaaa, v20
    v_mfma_f32_16x16x32_bf16 v[72:75], a[228:231], a[116:119], v[72:75]
    s_waitcnt vmcnt(21)
    ds_read_b64_tr_b16 a[246:247], v9 offset:18432
    v_add_u32 v20, 0x4444, v20
    v_mfma_f32_16x16x32_bf16 v[72:75], a[224:227], a[100:103], v[72:75]
    s_waitcnt vmcnt(20)
    s_add_u32 s39, s40, 0
    s_sub_u32 s57, 7864320, s56
    v_mfma_f32_16x16x32_bf16 v[80:83], a[224:227], a[104:107], v[80:83]
    buffer_load_dwordx4 v5, s[12:15], s38 offen offset:256 lds
    v_mfma_f32_16x16x32_bf16 v[80:83], a[228:231], a[120:123], v[80:83]
    s_waitcnt vmcnt(17)
    s_add_u32 s38, s38, 24576
    s_add_u32 m0, s63, 73728
    v_mfma_f32_16x16x32_bf16 v[88:91], a[228:231], a[124:127], v[88:91]
    s_waitcnt vmcnt(13)
    s_mov_b32 s10, s57
    s_mov_b32 s11, 0x00020000
    v_mfma_f32_16x16x32_bf16 v[88:91], a[224:227], a[108:111], v[88:91]
    s_add_u32 s8, s72, s56
    s_addc_u32 s9, s73, 0
    s_and_b32 s9, s9, 0xffff
    v_mfma_f32_16x16x32_bf16 v[88:91], a[232:235], a[140:143], v[88:91]
    s_mul_i32 s56, s53, 983040
    ds_read_b64_tr_b16 a[224:225], v9 offset:24576
    s_mov_b32 s34, 983040
    v_mfma_f32_16x16x32_bf16 v[88:91], a[236:239], a[156:159], v[88:91]
    s_add_u32 s32, s72, s56
    s_addc_u32 s33, s73, 0
    s_and_b32 s33, s33, 0xffff
    v_mfma_f32_16x16x32_bf16 v[80:83], a[236:239], a[152:155], v[80:83]
    buffer_load_dwordx4 v6, s[16:19], s39 offen lds
    v_mfma_f32_16x16x32_bf16 v[80:83], a[232:235], a[136:139], v[80:83]
    s_add_u32 s39, s40, 12288
    ds_read_b64_tr_b16 a[226:227], v9 offset:30720
    v_cvt_pk_bf16_f32 v88, v88, v89
    v_mfma_f32_16x16x32_bf16 v[72:75], a[232:235], a[132:135], v[72:75]
    s_addk_i32 m0, 4096
    ds_read_b64_tr_b16 a[228:229], v9 offset:36864
    v_cvt_pk_bf16_f32 v89, v90, v91
    v_mfma_f32_16x16x32_bf16 v[72:75], a[236:239], a[148:151], v[72:75]
    s_waitcnt lgkmcnt(3)
    ds_read_b64_tr_b16 a[230:231], v9 offset:43008
    v_cvt_pk_bf16_f32 v80, v80, v81
    v_mfma_f32_16x16x32_bf16 v[64:67], a[236:239], a[144:147], v[64:67]
    s_mov_b32 s35, 0x00020000
    v_cvt_pk_bf16_f32 v81, v82, v83
    s_mul_i32 s56, s53, 3145728
    v_mfma_f32_16x16x32_bf16 v[64:67], a[232:235], a[128:131], v[64:67]
    s_add_u32 s56, s56, 16777216
    ds_read_b64_tr_b16 a[232:233], v10 offset:0
    v_cvt_pk_bf16_f32 v72, v72, v73
    v_mfma_f32_16x16x32_bf16 v[68:71], a[240:243], a[96:99], v[68:71]
    buffer_load_dwordx4 v6, s[16:19], s39 offen lds
    v_mfma_f32_16x16x32_bf16 v[68:71], a[244:247], a[112:115], v[68:71]
    s_add_u32 s39, s40, 24576
    ds_read_b64_tr_b16 a[234:235], v10 offset:6144
    v_cvt_pk_bf16_f32 v64, v64, v65
    v_mfma_f32_16x16x32_bf16 v[76:79], a[244:247], a[116:119], v[76:79]
    s_addk_i32 m0, 4096
    ds_read_b64_tr_b16 a[236:237], v10 offset:12288
    v_cvt_pk_bf16_f32 v65, v66, v67
    v_mfma_f32_16x16x32_bf16 v[76:79], a[240:243], a[100:103], v[76:79]
    s_add_u32 s20, s86, s56
    s_addc_u32 s21, s87, 0
    v_cvt_pk_bf16_f32 v73, v74, v75
    v_mfma_f32_16x16x32_bf16 v[84:87], a[240:243], a[104:107], v[84:87]
    s_and_b32 s21, s21, 0xffff
    ds_read_b64_tr_b16 a[238:239], v10 offset:18432
    s_mov_b32 s22, 3145728
    v_mfma_f32_16x16x32_bf16 v[84:87], a[244:247], a[120:123], v[84:87]
    s_waitcnt lgkmcnt(4)
    s_mov_b32 s23, 0x00020000
    s_lshl_b32 s55, s51, 5
    v_mfma_f32_16x16x32_bf16 v[92:95], a[244:247], a[124:127], v[92:95]
    buffer_load_dwordx4 v6, s[16:19], s39 offen lds
    v_mfma_f32_16x16x32_bf16 v[92:95], a[240:243], a[108:111], v[92:95]
    s_add_u32 s39, s40, 36864
    ds_read_b64_tr_b16 a[240:241], v10 offset:24576
    s_addk_i32 m0, 4096
    v_mfma_f32_16x16x32_bf16 v[92:95], a[224:227], a[140:143], v[92:95]
    s_add_u32 s55, s55, s54
    ds_read_b64_tr_b16 a[242:243], v10 offset:30720
    s_mul_i32 s55, s55, 24576
    v_mfma_f32_16x16x32_bf16 v[92:95], a[228:231], a[156:159], v[92:95]
    s_lshr_b32 s50, s53, 1
    ds_read_b64_tr_b16 a[244:245], v10 offset:36864
    s_xor_b32 s67, s50, 3
    v_mfma_f32_16x16x32_bf16 v[84:87], a[228:231], a[152:155], v[84:87]
    s_lshl_b32 s67, s67, 10
    ds_read_b64_tr_b16 a[246:247], v10 offset:43008
    s_add_u32 s56, s51, 0
    v_mfma_f32_16x16x32_bf16 v[84:87], a[224:227], a[136:139], v[84:87]
    s_and_b32 s56, s56, 3
    v_cvt_pk_bf16_f32 v90, v92, v93
    v_cvt_pk_bf16_f32 v91, v94, v95
    v_mfma_f32_16x16x32_bf16 v[76:79], a[224:227], a[132:135], v[76:79]
    buffer_load_dwordx4 v6, s[16:19], s39 offen lds
    v_mfma_f32_16x16x32_bf16 v[76:79], a[228:231], a[148:151], v[76:79]
    s_waitcnt lgkmcnt(4)
    v_permlane16_swap_b32 v88, v90
    v_mfma_f32_16x16x32_bf16 v[68:71], a[228:231], a[144:147], v[68:71]
    s_mul_i32 s44, s56, 245760
    v_permlane16_swap_b32 v89, v91
    v_mfma_f32_16x16x32_bf16 v[68:71], a[224:227], a[128:131], v[68:71]
    s_add_u32 s56, s51, 1
    ds_read_b64_tr_b16 a[224:225], v11 offset:0
    v_cvt_pk_bf16_f32 v74, v76, v77
    v_mfma_f32_16x16x32_bf16 v[96:99], a[232:235], a[96:99], v[96:99]
    s_and_b32 s56, s56, 3
    ds_read_b64_tr_b16 a[226:227], v11 offset:6144
    v_cvt_pk_bf16_f32 v75, v78, v79
    v_mfma_f32_16x16x32_bf16 v[96:99], a[236:239], a[112:115], v[96:99]
    s_mul_i32 s45, s56, 245760
    ds_read_b64_tr_b16 a[228:229], v11 offset:12288
    v_cvt_pk_bf16_f32 v66, v68, v69
    v_mfma_f32_16x16x32_bf16 v[104:107], a[236:239], a[116:119], v[104:107]
    s_lshl_b32 s56, s56, 5
    ds_read_b64_tr_b16 a[230:231], v11 offset:18432
    v_cvt_pk_bf16_f32 v67, v70, v71
    v_mfma_f32_16x16x32_bf16 v[104:107], a[232:235], a[100:103], v[104:107]
    s_add_u32 s56, s56, s54
    v_permlane16_swap_b32 v64, v66
    v_mfma_f32_16x16x32_bf16 v[112:115], a[232:235], a[104:107], v[112:115]
    s_mul_i32 s59, s56, 24576
    v_permlane16_swap_b32 v65, v67
    v_mfma_f32_16x16x32_bf16 v[112:115], a[236:239], a[120:123], v[112:115]
    s_waitcnt lgkmcnt(4)
    v_permlane16_swap_b32 v72, v74
    v_mfma_f32_16x16x32_bf16 v[120:123], a[236:239], a[124:127], v[120:123]
    s_add_u32 s56, s51, 2
    v_permlane16_swap_b32 v73, v75
    v_mfma_f32_16x16x32_bf16 v[120:123], a[232:235], a[108:111], v[120:123]
    s_and_b32 s56, s56, 3
    ds_read_b64_tr_b16 a[232:233], v11 offset:24576
    v_cvt_pk_bf16_f32 v82, v84, v85
    v_mfma_f32_16x16x32_bf16 v[120:123], a[240:243], a[140:143], v[120:123]
    s_mul_i32 s46, s56, 245760
    ds_read_b64_tr_b16 a[234:235], v11 offset:30720
    v_cvt_pk_bf16_f32 v83, v86, v87
    v_mfma_f32_16x16x32_bf16 v[120:123], a[244:247], a[156:159], v[120:123]
    s_lshl_b32 s56, s56, 5
    ds_read_b64_tr_b16 a[236:237], v11 offset:36864
    v_accvgpr_write_b32 a0, v64
    v_mfma_f32_16x16x32_bf16 v[112:115], a[244:247], a[152:155], v[112:115]
    s_add_u32 s56, s56, s54
    ds_read_b64_tr_b16 a[238:239], v11 offset:43008
    v_accvgpr_write_b32 a1, v65
    v_mfma_f32_16x16x32_bf16 v[112:115], a[240:243], a[136:139], v[112:115]
    s_mul_i32 s60, s56, 24576
    v_permlane16_swap_b32 v80, v82
    v_mfma_f32_16x16x32_bf16 v[104:107], a[240:243], a[132:135], v[104:107]
    s_add_u32 s56, s51, 3
    v_permlane16_swap_b32 v81, v83
    v_mfma_f32_16x16x32_bf16 v[104:107], a[244:247], a[148:151], v[104:107]
    s_waitcnt lgkmcnt(4)
    v_accvgpr_write_b32 a2, v66
    v_accvgpr_write_b32 a3, v67
    v_mfma_f32_16x16x32_bf16 v[96:99], a[244:247], a[144:147], v[96:99]
    s_and_b32 s56, s56, 3
    v_accvgpr_write_b32 a4, v72
    v_accvgpr_write_b32 a5, v73
    v_mfma_f32_16x16x32_bf16 v[96:99], a[240:243], a[128:131], v[96:99]
    s_mul_i32 s47, s56, 245760
    ds_read_b64_tr_b16 a[240:241], v8 offset:1024
    v_accvgpr_write_b32 a6, v74
    v_mfma_f32_16x16x32_bf16 v[100:103], a[224:227], a[96:99], v[100:103]
    s_lshl_b32 s56, s56, 5
    ds_read_b64_tr_b16 a[242:243], v8 offset:7168
    v_accvgpr_write_b32 a7, v75
    v_mfma_f32_16x16x32_bf16 v[100:103], a[228:231], a[112:115], v[100:103]
    s_add_u32 s56, s56, s54
    ds_read_b64_tr_b16 a[244:245], v8 offset:13312
    v_accvgpr_write_b32 a8, v80
    v_mfma_f32_16x16x32_bf16 v[108:111], a[228:231], a[116:119], v[108:111]
    s_mul_i32 s61, s56, 24576
    ds_read_b64_tr_b16 a[246:247], v8 offset:19456
    v_accvgpr_write_b32 a9, v81
    v_mfma_f32_16x16x32_bf16 v[108:111], a[224:227], a[100:103], v[108:111]
    s_mov_b32 s72, s7
    v_accvgpr_write_b32 a10, v82
    v_accvgpr_write_b32 a11, v83
    v_mfma_f32_16x16x32_bf16 v[116:119], a[224:227], a[104:107], v[116:119]
    s_mov_b32 s73, s7
    v_accvgpr_write_b32 a12, v88
    v_accvgpr_write_b32 a13, v89
    v_mfma_f32_16x16x32_bf16 v[116:119], a[228:231], a[120:123], v[116:119]
    s_waitcnt lgkmcnt(4)
    v_accvgpr_write_b32 a14, v90
    v_accvgpr_write_b32 a15, v91
    v_mfma_f32_16x16x32_bf16 v[124:127], a[228:231], a[124:127], v[124:127]
    s_mov_b32 s74, s7
    v_cvt_pk_bf16_f32 v96, v96, v97
    v_cvt_pk_bf16_f32 v97, v98, v99
    v_mfma_f32_16x16x32_bf16 v[124:127], a[224:227], a[108:111], v[124:127]
    s_mov_b32 s75, s7
    ds_read_b64_tr_b16 a[224:225], v8 offset:25600
    v_cvt_pk_bf16_f32 v104, v104, v105
    v_mfma_f32_16x16x32_bf16 v[124:127], a[232:235], a[140:143], v[124:127]
    s_lshl_b32 s56, s50, 6
    ds_read_b64_tr_b16 a[226:227], v8 offset:31744
    v_cvt_pk_bf16_f32 v105, v106, v107
    v_mfma_f32_16x16x32_bf16 v[124:127], a[236:239], a[156:159], v[124:127]
    s_xor_b32 s56, s56, 192
    ds_read_b64_tr_b16 a[228:229], v8 offset:37888
    v_xor_b32 v2, s56, v7
    v_mfma_f32_16x16x32_bf16 v[116:119], a[236:239], a[152:155], v[116:119]
    s_and_b32 s56, s51, 1
    ds_read_b64_tr_b16 a[230:231], v8 offset:44032
    v_xor_b32 v3, 128, v2
    v_mfma_f32_16x16x32_bf16 v[116:119], a[232:235], a[136:139], v[116:119]
    s_lshl_b32 s56, s56, 6
    v_cvt_pk_bf16_f32 v112, v112, v113
    v_cvt_pk_bf16_f32 v113, v114, v115
    v_mfma_f32_16x16x32_bf16 v[108:111], a[232:235], a[132:135], v[108:111]
    s_mul_i32 s57, s3, 10240
    v_cvt_pk_bf16_f32 v120, v120, v121
    v_cvt_pk_bf16_f32 v121, v122, v123
    v_mfma_f32_16x16x32_bf16 v[108:111], a[236:239], a[148:151], v[108:111]
    s_waitcnt lgkmcnt(4)
    v_cvt_pk_bf16_f32 v114, v116, v117
    v_cvt_pk_bf16_f32 v115, v118, v119
    v_mfma_f32_16x16x32_bf16 v[100:103], a[236:239], a[144:147], v[100:103]
    s_add_u32 s56, s56, s57
    v_permlane16_swap_b32 v112, v114
    v_mfma_f32_16x16x32_bf16 v[100:103], a[232:235], a[128:131], v[100:103]
    s_and_b32 s57, s3, 1
    ds_read_b64_tr_b16 a[232:233], v9 offset:1024
    v_add_u32 v21, s56, v21
    v_mfma_f32_16x16x32_bf16 v[128:131], a[240:243], a[96:99], v[128:131]
    s_and_b32 s56, s51, 1
    ds_read_b64_tr_b16 a[234:235], v9 offset:7168
    v_add_u32 v2, v2, v21
    v_mfma_f32_16x16x32_bf16 v[128:131], a[244:247], a[112:115], v[128:131]
    s_xor_b32 s56, s56, 1
    ds_read_b64_tr_b16 a[236:237], v9 offset:13312
    v_add_u32 v3, v3, v21
    v_mfma_f32_16x16x32_bf16 v[136:139], a[244:247], a[116:119], v[136:139]
    s_lshl_b32 s56, s56, 8
    ds_read_b64_tr_b16 a[238:239], v9 offset:19456
    v_and_b32 v21, 3, v1
    v_mfma_f32_16x16x32_bf16 v[136:139], a[240:243], a[100:103], v[136:139]
pg_4:
    s_cbranch_execz pg_8
    s_mul_i32 s57, s57, 20480
    v_lshlrev_b32 v21, 4, v21
    v_xor_b32 v21, v21, v22
    v_mfma_f32_16x16x32_bf16 v[144:147], a[240:243], a[104:107], v[144:147]
    s_add_u32 s56, s56, s57
    v_lshrrev_b32 v22, 2, v1
    v_mul_u32_u24 v22, 1280, v22
    v_mfma_f32_16x16x32_bf16 v[144:147], a[244:247], a[120:123], v[144:147]
    s_waitcnt lgkmcnt(4)
    v_add_u32 v21, v21, v22
    v_add_u32 v7, s56, v21
    v_mfma_f32_16x16x32_bf16 v[152:155], a[244:247], a[124:127], v[152:155]
    s_lshr_b32 s42, s2, 3
    v_mov_b32 v21, 0x3f803f80
    v_accvgpr_write_b32 a248, v21
    v_mfma_f32_16x16x32_bf16 v[152:155], a[240:243], a[108:111], v[152:155]
    s_lshl_b32 s42, s42, 2
    ds_read_b64_tr_b16 a[240:241], v9 offset:25600
    v_accvgpr_write_b32 a249, v21
    v_mfma_f32_16x16x32_bf16 v[152:155], a[224:227], a[140:143], v[152:155]
    s_add_u32 s42, s42, s3
    ds_read_b64_tr_b16 a[242:243], v9 offset:31744
    v_accvgpr_write_b32 a250, v21
    v_mfma_f32_16x16x32_bf16 v[152:155], a[228:231], a[156:159], v[152:155]
    s_mul_i32 s42, s42, 7680
    ds_read_b64_tr_b16 a[244:245], v9 offset:37888
    v_accvgpr_write_b32 a251, v21
    v_mfma_f32_16x16x32_bf16 v[144:147], a[228:231], a[152:155], v[144:147]
    ds_read_b64_tr_b16 a[246:247], v9 offset:44032
    v_min_u32 v22, 11, v1
    v_mfma_f32_16x16x32_bf16 v[144:147], a[224:227], a[136:139], v[144:147]
    v_lshlrev_b32 v22, 7, v22
    v_cvt_pk_bf16_f32 v98, v100, v101
    v_mfma_f32_16x16x32_bf16 v[136:139], a[224:227], a[132:135], v[136:139]
    v_permlane16_swap_b32 v113, v115
    v_mfma_f32_16x16x32_bf16 v[136:139], a[228:231], a[148:151], v[136:139]
    s_waitcnt lgkmcnt(4)
    v_permlane16_swap_b32 v96, v98
    v_mfma_f32_16x16x32_bf16 v[128:131], a[228:231], a[144:147], v[128:131]
    v_cvt_pk_bf16_f32 v99, v102, v103
    v_cvt_pk_bf16_f32 v106, v108, v109
    v_mfma_f32_16x16x32_bf16 v[128:131], a[224:227], a[128:131], v[128:131]
    ds_read_b64_tr_b16 a[224:225], v10 offset:1024
    v_cvt_pk_bf16_f32 v107, v110, v111
    v_mfma_f32_16x16x32_bf16 v[132:135], a[232:235], a[96:99], v[132:135]
    ds_read_b64_tr_b16 a[226:227], v10 offset:7168
    v_accvgpr_write_b32 a16, v96
    v_mfma_f32_16x16x32_bf16 v[132:135], a[236:239], a[112:115], v[132:135]
    ds_read_b64_tr_b16 a[228:229], v10 offset:13312
    v_accvgpr_write_b32 a18, v98
    v_mfma_f32_16x16x32_bf16 v[140:143], a[236:239], a[116:119], v[140:143]
    ds_read_b64_tr_b16 a[230:231], v10 offset:19456
    v_cvt_pk_bf16_f32 v122, v124, v125
    v_mfma_f32_16x16x32_bf16 v[140:143], a[232:235], a[100:103], v[140:143]
    v_permlane16_swap_b32 v97, v99
    v_mfma_f32_16x16x32_bf16 v[148:151], a[232:235], a[104:107], v[148:151]
    v_permlane16_swap_b32 v104, v106
    v_mfma_f32_16x16x32_bf16 v[148:151], a[236:239], a[120:123], v[148:151]
    s_waitcnt lgkmcnt(4)
    v_permlane16_swap_b32 v105, v107
    v_mfma_f32_16x16x32_bf16 v[156:159], a[236:239], a[124:127], v[156:159]
    s_waitcnt vmcnt(6)
    v_permlane16_swap_b32 v120, v122
    v_mfma_f32_16x16x32_bf16 v[156:159], a[232:235], a[108:111], v[156:159]
    buffer_store_dword v26, v27, s[24:27], s4 offen offset:144 sc1
    v_mfma_f32_16x16x32_bf16 v[156:159], a[240:243], a[140:143], v[156:159]
    ds_read_b64_tr_b16 a[232:233], v10 offset:25600
    v_accvgpr_write_b32 a17, v97
    v_mfma_f32_16x16x32_bf16 v[156:159], a[244:247], a[156:159], v[156:159]
    ds_read_b64_tr_b16 a[234:235], v10 offset:31744
    v_accvgpr_write_b32 a19, v99
    v_mfma_f32_16x16x32_bf16 v[148:151], a[244:247], a[152:155], v[148:151]
    ds_read_b64_tr_b16 a[236:237], v10 offset:37888
    v_cvt_pk_bf16_f32 v123, v126, v127
    v_mfma_f32_16x16x32_bf16 v[148:151], a[240:243], a[136:139], v[148:151]
    ds_read_b64_tr_b16 a[238:239], v10 offset:44032
    v_accvgpr_write_b32 a20, v104
    v_mfma_f32_16x16x32_bf16 v[140:143], a[240:243], a[132:135], v[140:143]
    v_permlane16_swap_b32 v121, v123
    v_mfma_f32_16x16x32_bf16 v[140:143], a[244:247], a[148:151], v[140:143]
    s_waitcnt lgkmcnt(4)
    v_accvgpr_write_b32 a21, v105
    v_accvgpr_write_b32 a22, v106
    v_mfma_f32_16x16x32_bf16 v[132:135], a[244:247], a[144:147], v[132:135]
    v_accvgpr_write_b32 a23, v107
    v_accvgpr_write_b32 a24, v112
    v_mfma_f32_16x16x32_bf16 v[132:135], a[240:243], a[128:131], v[132:135]
    ds_read_b64_tr_b16 a[240:241], v11 offset:1024
    v_accvgpr_write_b32 a25, v113
    v_mfma_f32_16x16x32_bf16 v[160:163], a[224:227], a[96:99], v[160:163]
    ds_read_b64_tr_b16 a[242:243], v11 offset:7168
    v_accvgpr_write_b32 a26, v114
    v_mfma_f32_16x16x32_bf16 v[160:163], a[228:231], a[112:115], v[160:163]
    ds_read_b64_tr_b16 a[244:245], v11 offset:13312
    v_accvgpr_write_b32 a27, v115
    v_mfma_f32_16x16x32_bf16 v[168:171], a[228:231], a[116:119], v[168:171]
    ds_read_b64_tr_b16 a[246:247], v11 offset:19456
    v_accvgpr_write_b32 a28, v120
    v_mfma_f32_16x16x32_bf16 v[168:171], a[224:227], a[100:103], v[168:171]
    v_accvgpr_write_b32 a29, v121
    v_accvgpr_write_b32 a30, v122
    v_mfma_f32_16x16x32_bf16 v[176:179], a[224:227], a[104:107], v[176:179]
    v_accvgpr_write_b32 a31, v123
    v_cvt_pk_bf16_f32 v128, v128, v129
    v_mfma_f32_16x16x32_bf16 v[176:179], a[228:231], a[120:123], v[176:179]
    s_waitcnt lgkmcnt(4)
    v_cvt_pk_bf16_f32 v129, v130, v131
    v_cvt_pk_bf16_f32 v130, v132, v133
    v_mfma_f32_16x16x32_bf16 v[184:187], a[228:231], a[124:127], v[184:187]
    v_cvt_pk_bf16_f32 v131, v134, v135
    v_cvt_pk_bf16_f32 v136, v136, v137
    v_mfma_f32_16x16x32_bf16 v[184:187], a[224:227], a[108:111], v[184:187]
    ds_read_b64_tr_b16 a[224:225], v11 offset:25600
    v_cvt_pk_bf16_f32 v137, v138, v139
    v_mfma_f32_16x16x32_bf16 v[184:187], a[232:235], a[140:143], v[184:187]
    ds_read_b64_tr_b16 a[226:227], v11 offset:31744
    v_cvt_pk_bf16_f32 v138, v140, v141
    v_mfma_f32_16x16x32_bf16 v[184:187], a[236:239], a[156:159], v[184:187]
    ds_read_b64_tr_b16 a[228:229], v11 offset:37888
    v_cvt_pk_bf16_f32 v139, v142, v143
    v_mfma_f32_16x16x32_bf16 v[176:179], a[236:239], a[152:155], v[176:179]
    ds_read_b64_tr_b16 a[230:231], v11 offset:44032
    v_cvt_pk_bf16_f32 v144, v144, v145
    v_mfma_f32_16x16x32_bf16 v[176:179], a[232:235], a[136:139], v[176:179]
    v_permlane16_swap_b32 v128, v130
    v_mfma_f32_16x16x32_bf16 v[168:171], a[232:235], a[132:135], v[168:171]
    v_permlane16_swap_b32 v129, v131
    v_mfma_f32_16x16x32_bf16 v[168:171], a[236:239], a[148:151], v[168:171]
    s_waitcnt lgkmcnt(4)
    v_permlane16_swap_b32 v136, v138
    v_mfma_f32_16x16x32_bf16 v[160:163], a[236:239], a[144:147], v[160:163]
    v_permlane16_swap_b32 v137, v139
    v_mfma_f32_16x16x32_bf16 v[160:163], a[232:235], a[128:131], v[160:163]
    ds_read_b64_tr_b16 a[232:233], v8 offset:2048
    v_cvt_pk_bf16_f32 v145, v146, v147
    v_mfma_f32_16x16x32_bf16 v[164:167], a[240:243], a[96:99], v[164:167]
    ds_read_b64_tr_b16 a[234:235], v8 offset:8192
    v_cvt_pk_bf16_f32 v146, v148, v149
    v_mfma_f32_16x16x32_bf16 v[164:167], a[244:247], a[112:115], v[164:167]
    ds_read_b64_tr_b16 a[236:237], v8 offset:14336
    v_cvt_pk_bf16_f32 v147, v150, v151
    v_mfma_f32_16x16x32_bf16 v[172:175], a[244:247], a[116:119], v[172:175]
    ds_read_b64_tr_b16 a[238:239], v8 offset:20480
    v_accvgpr_write_b32 a32, v128
    v_mfma_f32_16x16x32_bf16 v[172:175], a[240:243], a[100:103], v[172:175]
    v_permlane16_swap_b32 v144, v146
    v_mfma_f32_16x16x32_bf16 v[180:183], a[240:243], a[104:107], v[180:183]
    v_permlane16_swap_b32 v145, v147
    v_mfma_f32_16x16x32_bf16 v[180:183], a[244:247], a[120:123], v[180:183]
    s_waitcnt lgkmcnt(4)
    v_accvgpr_write_b32 a33, v129
    v_accvgpr_write_b32 a34, v130
    v_mfma_f32_16x16x32_bf16 v[188:191], a[244:247], a[124:127], v[188:191]
    v_accvgpr_write_b32 a35, v131
    v_cvt_pk_bf16_f32 v152, v152, v153
    v_mfma_f32_16x16x32_bf16 v[188:191], a[240:243], a[108:111], v[188:191]
    ds_read_b64_tr_b16 a[240:241], v8 offset:26624
    v_cvt_pk_bf16_f32 v153, v154, v155
    v_mfma_f32_16x16x32_bf16 v[188:191], a[224:227], a[140:143], v[188:191]
    ds_read_b64_tr_b16 a[242:243], v8 offset:32768
    v_cvt_pk_bf16_f32 v154, v156, v157
    v_mfma_f32_16x16x32_bf16 v[188:191], a[228:231], a[156:159], v[188:191]
    ds_read_b64_tr_b16 a[244:245], v8 offset:38912
    v_cvt_pk_bf16_f32 v155, v158, v159
    v_mfma_f32_16x16x32_bf16 v[180:183], a[228:231], a[152:155], v[180:183]
    ds_read_b64_tr_b16 a[246:247], v8 offset:45056
    v_accvgpr_write_b32 a36, v136
    v_mfma_f32_16x16x32_bf16 v[180:183], a[224:227], a[136:139], v[180:183]
    v_permlane16_swap_b32 v152, v154
    v_mfma_f32_16x16x32_bf16 v[172:175], a[224:227], a[132:135], v[172:175]
    s_add_u32 s88, s88, code_end-code0-65536
    s_addc_u32 s89, s89, 0
    v_accvgpr_write_b32 a37, v137
    v_mfma_f32_16x16x32_bf16 v[172:175], a[228:231], a[148:151], v[172:175]
    s_waitcnt lgkmcnt(4)
    v_permlane16_swap_b32 v153, v155
    v_mfma_f32_16x16x32_bf16 v[164:167], a[228:231], a[144:147], v[164:167]
    v_accvgpr_write_b32 a38, v138
    v_accvgpr_write_b32 a39, v139
    v_mfma_f32_16x16x32_bf16 v[164:167], a[224:227], a[128:131], v[164:167]
    ds_read_b64_tr_b16 a[224:225], v9 offset:2048
    v_accvgpr_write_b32 a40, v144
    v_mfma_f32_16x16x32_bf16 v[192:195], a[232:235], a[96:99], v[192:195]
    global_load_dword a252, v18, s[88:89]
    v_mfma_f32_16x16x32_bf16 v[192:195], a[236:239], a[112:115], v[192:195]
    ds_read_b64_tr_b16 a[226:227], v9 offset:8192
    v_accvgpr_write_b32 a41, v145
    v_mfma_f32_16x16x32_bf16 v[200:203], a[236:239], a[116:119], v[200:203]
    ds_read_b64_tr_b16 a[228:229], v9 offset:14336
    v_accvgpr_write_b32 a42, v146
    v_mfma_f32_16x16x32_bf16 v[200:203], a[232:235], a[100:103], v[200:203]
    ds_read_b64_tr_b16 a[230:231], v9 offset:20480
    v_accvgpr_write_b32 a43, v147
    v_mfma_f32_16x16x32_bf16 v[208:211], a[232:235], a[104:107], v[208:211]
    v_accvgpr_write_b32 a44, v152
    v_accvgpr_write_b32 a45, v153
    v_mfma_f32_16x16x32_bf16 v[208:211], a[236:239], a[120:123], v[208:211]
    s_waitcnt lgkmcnt(4)
    v_accvgpr_write_b32 a46, v154
    v_accvgpr_write_b32 a47, v155
    v_mfma_f32_16x16x32_bf16 v[216:219], a[236:239], a[124:127], v[216:219]
    v_cvt_pk_bf16_f32 v160, v160, v161
    v_cvt_pk_bf16_f32 v161, v162, v163
    v_mfma_f32_16x16x32_bf16 v[216:219], a[232:235], a[108:111], v[216:219]
    ds_read_b64_tr_b16 a[232:233], v9 offset:26624
    v_cvt_pk_bf16_f32 v162, v164, v165
    v_mfma_f32_16x16x32_bf16 v[216:219], a[240:243], a[140:143], v[216:219]
    ds_read_b64_tr_b16 a[234:235], v9 offset:32768
    v_cvt_pk_bf16_f32 v163, v166, v167
    v_mfma_f32_16x16x32_bf16 v[216:219], a[244:247], a[156:159], v[216:219]
    ds_read_b64_tr_b16 a[236:237], v9 offset:38912
    v_cvt_pk_bf16_f32 v168, v168, v169
    v_mfma_f32_16x16x32_bf16 v[208:211], a[244:247], a[152:155], v[208:211]
    ds_read_b64_tr_b16 a[238:239], v9 offset:45056
    v_cvt_pk_bf16_f32 v169, v170, v171
    v_mfma_f32_16x16x32_bf16 v[208:211], a[240:243], a[136:139], v[208:211]
    v_permlane16_swap_b32 v160, v162
    v_mfma_f32_16x16x32_bf16 v[200:203], a[240:243], a[132:135], v[200:203]
    v_permlane16_swap_b32 v161, v163
    v_mfma_f32_16x16x32_bf16 v[200:203], a[244:247], a[148:151], v[200:203]
    s_waitcnt lgkmcnt(4)
    v_cvt_pk_bf16_f32 v170, v172, v173
    v_cvt_pk_bf16_f32 v171, v174, v175
    v_mfma_f32_16x16x32_bf16 v[192:195], a[244:247], a[144:147], v[192:195]
    v_permlane16_swap_b32 v168, v170
    v_mfma_f32_16x16x32_bf16 v[192:195], a[240:243], a[128:131], v[192:195]
    ds_read_b64_tr_b16 a[240:241], v10 offset:2048
    v_cvt_pk_bf16_f32 v176, v176, v177
    v_mfma_f32_16x16x32_bf16 v[196:199], a[224:227], a[96:99], v[196:199]
    ds_read_b64_tr_b16 a[242:243], v10 offset:8192
    v_cvt_pk_bf16_f32 v177, v178, v179
    v_mfma_f32_16x16x32_bf16 v[196:199], a[228:231], a[112:115], v[196:199]
    ds_read_b64_tr_b16 a[244:245], v10 offset:14336
    v_cvt_pk_bf16_f32 v178, v180, v181
    v_mfma_f32_16x16x32_bf16 v[204:207], a[228:231], a[116:119], v[204:207]
    ds_read_b64_tr_b16 a[246:247], v10 offset:20480
    v_cvt_pk_bf16_f32 v179, v182, v183
    v_mfma_f32_16x16x32_bf16 v[204:207], a[224:227], a[100:103], v[204:207]
    v_permlane16_swap_b32 v169, v171
    v_mfma_f32_16x16x32_bf16 v[212:215], a[224:227], a[104:107], v[212:215]
    v_permlane16_swap_b32 v176, v178
    v_mfma_f32_16x16x32_bf16 v[212:215], a[228:231], a[120:123], v[212:215]
    s_waitcnt lgkmcnt(4)
    v_permlane16_swap_b32 v177, v179
    v_mfma_f32_16x16x32_bf16 v[220:223], a[228:231], a[124:127], v[220:223]
    v_accvgpr_write_b32 a48, v160
    v_accvgpr_write_b32 a49, v161
    v_mfma_f32_16x16x32_bf16 v[220:223], a[224:227], a[108:111], v[220:223]
    ds_read_b64_tr_b16 a[224:225], v10 offset:26624
    v_accvgpr_write_b32 a50, v162
    v_mfma_f32_16x16x32_bf16 v[220:223], a[232:235], a[140:143], v[220:223]
    ds_read_b64_tr_b16 a[226:227], v10 offset:32768
    v_accvgpr_write_b32 a51, v163
    v_mfma_f32_16x16x32_bf16 v[220:223], a[236:239], a[156:159], v[220:223]
    ds_read_b64_tr_b16 a[228:229], v10 offset:38912
    v_cvt_pk_bf16_f32 v184, v184, v185
    v_mfma_f32_16x16x32_bf16 v[212:215], a[236:239], a[152:155], v[212:215]
    ds_read_b64_tr_b16 a[230:231], v10 offset:45056
    v_cvt_pk_bf16_f32 v185, v186, v187
    v_mfma_f32_16x16x32_bf16 v[212:215], a[232:235], a[136:139], v[212:215]
    v_cvt_pk_bf16_f32 v186, v188, v189
    v_cvt_pk_bf16_f32 v187, v190, v191
    v_mfma_f32_16x16x32_bf16 v[204:207], a[232:235], a[132:135], v[204:207]
    v_permlane16_swap_b32 v184, v186
    v_mfma_f32_16x16x32_bf16 v[204:207], a[236:239], a[148:151], v[204:207]
    s_waitcnt lgkmcnt(4)
    v_permlane16_swap_b32 v185, v187
    v_mfma_f32_16x16x32_bf16 v[196:199], a[236:239], a[144:147], v[196:199]
    v_accvgpr_write_b32 a52, v168
    v_accvgpr_write_b32 a53, v169
    v_mfma_f32_16x16x32_bf16 v[196:199], a[232:235], a[128:131], v[196:199]
    ds_read_b64_tr_b16 a[232:233], v11 offset:2048
    v_accvgpr_write_b32 a54, v170
    ds_read_b64_tr_b16 a[234:235], v11 offset:8192
    v_mfma_f32_16x16x32_bf16 v[224:227], a[240:243], a[96:99], v[224:227]
    ds_read_b64_tr_b16 a[236:237], v11 offset:14336
    v_accvgpr_write_b32 a55, v171
    ds_read_b64_tr_b16 a[238:239], v11 offset:20480
    v_mfma_f32_16x16x32_bf16 v[224:227], a[244:247], a[112:115], v[224:227]
    v_accvgpr_write_b32 a56, v176
    v_accvgpr_write_b32 a57, v177
    v_mfma_f32_16x16x32_bf16 v[232:235], a[244:247], a[116:119], v[232:235]
    v_accvgpr_write_b32 a58, v178
    v_accvgpr_write_b32 a59, v179
    v_mfma_f32_16x16x32_bf16 v[232:235], a[240:243], a[100:103], v[232:235]
    v_accvgpr_write_b32 a60, v184
    v_accvgpr_write_b32 a61, v185
    v_mfma_f32_16x16x32_bf16 v[240:243], a[240:243], a[104:107], v[240:243]
    v_accvgpr_write_b32 a62, v186
    v_accvgpr_write_b32 a63, v187
    v_mfma_f32_16x16x32_bf16 v[240:243], a[244:247], a[120:123], v[240:243]
    s_waitcnt lgkmcnt(4)
    v_cvt_pk_bf16_f32 v192, v192, v193
    v_cvt_pk_bf16_f32 v193, v194, v195
    v_mfma_f32_16x16x32_bf16 v[248:251], a[244:247], a[124:127], v[248:251]
    s_waitcnt lgkmcnt(0)
    s_barrier
    v_mfma_f32_16x16x32_bf16 v[248:251], a[240:243], a[108:111], v[248:251]
    s_add_u32 m0, s49, 49152
    ds_read_b128 a[184:187], v12 offset:0
    v_cvt_pk_bf16_f32 v194, v196, v197
    v_mfma_f32_16x16x32_bf16 v[248:251], a[224:227], a[140:143], v[248:251]
    ds_read_b128 a[188:191], v13 offset:0
    v_cvt_pk_bf16_f32 v195, v198, v199
    v_mfma_f32_16x16x32_bf16 v[248:251], a[228:231], a[156:159], v[248:251]
    ds_read_b128 a[192:195], v12 offset:1024
    v_cvt_pk_bf16_f32 v200, v200, v201
    v_mfma_f32_16x16x32_bf16 v[240:243], a[228:231], a[152:155], v[240:243]
    ds_read_b128 a[196:199], v13 offset:1024
    v_cvt_pk_bf16_f32 v201, v202, v203
    v_mfma_f32_16x16x32_bf16 v[240:243], a[224:227], a[136:139], v[240:243]
    ds_read_b128 a[200:203], v12 offset:2048
    v_cvt_pk_bf16_f32 v202, v204, v205
    v_mfma_f32_16x16x32_bf16 v[232:235], a[224:227], a[132:135], v[232:235]
    buffer_load_dwordx4 v4, s[12:15], s38 offen offset:0 lds
    v_mfma_f32_16x16x32_bf16 v[232:235], a[228:231], a[148:151], v[232:235]
    ds_read_b64_tr_b16 a[240:241], v11 offset:26624
    v_cvt_pk_bf16_f32 v203, v206, v207
    v_mfma_f32_16x16x32_bf16 v[224:227], a[228:231], a[144:147], v[224:227]
    ds_read_b64_tr_b16 a[242:243], v11 offset:32768
    v_cvt_pk_bf16_f32 v208, v208, v209
    v_mfma_f32_16x16x32_bf16 v[224:227], a[224:227], a[128:131], v[224:227]
    ds_read_b64_tr_b16 a[244:245], v11 offset:38912
    v_cvt_pk_bf16_f32 v209, v210, v211
    v_mfma_f32_16x16x32_bf16 v[228:231], a[232:235], a[96:99], v[228:231]
    ds_read_b64_tr_b16 a[246:247], v11 offset:45056
    v_cvt_pk_bf16_f32 v210, v212, v213
    v_mfma_f32_16x16x32_bf16 v[228:231], a[236:239], a[112:115], v[228:231]
    v_permlane16_swap_b32 v192, v194
    v_mfma_f32_16x16x32_bf16 v[236:239], a[236:239], a[116:119], v[236:239]
    s_addk_i32 m0, 896
    v_permlane16_swap_b32 v193, v195
    v_mfma_f32_16x16x32_bf16 v[236:239], a[232:235], a[100:103], v[236:239]
    v_permlane16_swap_b32 v200, v202
    v_mfma_f32_16x16x32_bf16 v[244:247], a[232:235], a[104:107], v[244:247]
    v_permlane16_swap_b32 v201, v203
    v_mfma_f32_16x16x32_bf16 v[244:247], a[236:239], a[120:123], v[244:247]
    s_waitcnt lgkmcnt(2)
    v_permlane16_swap_b32 v208, v210
    v_mfma_f32_16x16x32_bf16 v[252:255], a[236:239], a[124:127], v[252:255]
    ds_read_b128 a[204:207], v13 offset:2048
    v_cvt_pk_bf16_f32 v211, v214, v215
    v_mfma_f32_16x16x32_bf16 v[252:255], a[232:235], a[108:111], v[252:255]
    s_waitcnt lgkmcnt(1)
    v_permlane16_swap_b32 v209, v211
    v_mfma_f32_16x16x32_bf16 v[252:255], a[240:243], a[140:143], v[252:255]
    buffer_load_dwordx4 v4, s[12:15], s38 offen offset:128 lds
    v_mfma_f32_16x16x32_bf16 v[252:255], a[244:247], a[156:159], v[252:255]
    v_accvgpr_write_b32 a64, v192
    v_accvgpr_write_b32 a65, v193
    v_mfma_f32_16x16x32_bf16 v[244:247], a[244:247], a[152:155], v[244:247]
    ds_read_b128 a[208:211], v12 offset:6144
    v_accvgpr_write_b32 a66, v194
    v_mfma_f32_16x16x32_bf16 v[244:247], a[240:243], a[136:139], v[244:247]
    ds_read_b128 a[212:215], v13 offset:6144
    v_accvgpr_write_b32 a67, v195
    v_mfma_f32_16x16x32_bf16 v[236:239], a[240:243], a[132:135], v[236:239]
    ds_read_b128 a[216:219], v12 offset:7168
    v_cvt_pk_bf16_f32 v216, v216, v217
    v_mfma_f32_16x16x32_bf16 v[236:239], a[244:247], a[148:151], v[236:239]
    ds_read_b128 a[220:223], v13 offset:7168
    v_cvt_pk_bf16_f32 v217, v218, v219
    v_mfma_f32_16x16x32_bf16 v[228:231], a[244:247], a[144:147], v[228:231]
    s_addk_i32 m0, 896
    ds_read_b128 a[224:227], v12 offset:8192
    v_cvt_pk_bf16_f32 v218, v220, v221
    v_mfma_f32_16x16x32_bf16 v[228:231], a[240:243], a[128:131], v[228:231]
    ds_read_b128 a[228:231], v13 offset:8192
    v_cvt_pk_bf16_f32 v219, v222, v223
    v_mfma_f32_16x16x32_bf16 v[64:67], a[184:187], a[0:3], 0
    v_permlane16_swap_b32 v216, v218
    v_mfma_f32_16x16x32_bf16 v[64:67], a[188:191], a[16:19], v[64:67]
    v_permlane16_swap_b32 v217, v219
    v_mfma_f32_16x16x32_bf16 v[64:67], a[192:195], a[32:35], v[64:67]
    v_accvgpr_write_b32 a68, v200
    v_accvgpr_write_b32 a69, v201
    v_mfma_f32_16x16x32_bf16 v[64:67], a[196:199], a[48:51], v[64:67]
    v_accvgpr_write_b32 a70, v202
    v_accvgpr_write_b32 a71, v203
    v_mfma_f32_16x16x32_bf16 v[64:67], a[200:203], a[64:67], v[64:67]
    buffer_load_dwordx4 v4, s[12:15], s38 offen offset:256 lds
    v_mfma_f32_16x16x32_bf16 v[72:75], a[200:203], a[68:71], 0
    v_accvgpr_write_b32 a72, v208
    v_accvgpr_write_b32 a73, v209
    v_mfma_f32_16x16x32_bf16 v[72:75], a[196:199], a[52:55], v[72:75]
    v_accvgpr_write_b32 a74, v210
    v_accvgpr_write_b32 a75, v211
    v_mfma_f32_16x16x32_bf16 v[72:75], a[192:195], a[36:39], v[72:75]
    v_accvgpr_write_b32 a76, v216
    v_accvgpr_write_b32 a77, v217
    v_mfma_f32_16x16x32_bf16 v[72:75], a[188:191], a[20:23], v[72:75]
    v_accvgpr_write_b32 a78, v218
    v_accvgpr_write_b32 a79, v219
    v_mfma_f32_16x16x32_bf16 v[72:75], a[184:187], a[4:7], v[72:75]
    v_cvt_pk_bf16_f32 v224, v224, v225
    v_cvt_pk_bf16_f32 v225, v226, v227
    v_mfma_f32_16x16x32_bf16 v[80:83], a[184:187], a[8:11], 0
    s_addk_i32 m0, 1280
    v_cvt_pk_bf16_f32 v226, v228, v229
    v_cvt_pk_bf16_f32 v227, v230, v231
    v_mfma_f32_16x16x32_bf16 v[80:83], a[188:191], a[24:27], v[80:83]
    v_permlane16_swap_b32 v224, v226
    v_mfma_f32_16x16x32_bf16 v[80:83], a[192:195], a[40:43], v[80:83]
    v_permlane16_swap_b32 v225, v227
    v_mfma_f32_16x16x32_bf16 v[80:83], a[196:199], a[56:59], v[80:83]
    v_cvt_pk_bf16_f32 v232, v232, v233
    v_cvt_pk_bf16_f32 v233, v234, v235
    v_mfma_f32_16x16x32_bf16 v[80:83], a[200:203], a[72:75], v[80:83]
    v_cvt_pk_bf16_f32 v234, v236, v237
    v_cvt_pk_bf16_f32 v235, v238, v239
    v_mfma_f32_16x16x32_bf16 v[88:91], a[200:203], a[76:79], 0
    v_permlane16_swap_b32 v232, v234
    v_mfma_f32_16x16x32_bf16 v[88:91], a[196:199], a[60:63], v[88:91]
    buffer_load_dwordx4 v5, s[12:15], s38 offen offset:0 lds
    v_mfma_f32_16x16x32_bf16 v[88:91], a[192:195], a[44:47], v[88:91]
    s_waitcnt lgkmcnt(0)
    v_permlane16_swap_b32 v233, v235
    v_mfma_f32_16x16x32_bf16 v[88:91], a[188:191], a[28:31], v[88:91]
    v_cvt_pk_bf16_f32 v240, v240, v241
    v_cvt_pk_bf16_f32 v241, v242, v243
    v_mfma_f32_16x16x32_bf16 v[88:91], a[184:187], a[12:15], v[88:91]
    ds_read_b128 a[184:187], v12 offset:12288
    v_cvt_pk_bf16_f32 v242, v244, v245
    v_mfma_f32_16x16x32_bf16 v[64:67], a[204:207], v[224:227], v[64:67]
    ds_read_b128 a[188:191], v13 offset:12288
    v_cvt_pk_bf16_f32 v243, v246, v247
    v_cvt_pk_bf16_f32 v248, v248, v249
    v_cvt_pk_bf16_f32 v249, v250, v251
    v_mfma_f32_16x16x32_bf16 v[72:75], a[204:207], v[232:235], v[72:75]
    ds_read_b128 a[192:195], v12 offset:13312
    v_cvt_pk_bf16_f32 v250, v252, v253
    v_permlane16_swap_b32 v240, v242
    v_permlane16_swap_b32 v241, v243
    s_nop 1
    v_mfma_f32_16x16x32_bf16 v[80:83], a[204:207], v[240:243], v[80:83]
    s_addk_i32 m0, 896
    ds_read_b128 a[196:199], v13 offset:13312
    v_cvt_pk_bf16_f32 v251, v254, v255
    v_permlane16_swap_b32 v248, v250
    v_accvgpr_write_b32 a80, v224
    v_permlane16_swap_b32 v249, v251
    s_nop 1
    v_mfma_f32_16x16x32_bf16 v[88:91], a[204:207], v[248:251], v[88:91]
    ds_read_b128 a[200:203], v12 offset:14336
    v_accvgpr_write_b32 a81, v225
    v_mfma_f32_16x16x32_bf16 v[24:27], a[208:211], a[0:3], 0
    ds_read_b128 a[204:207], v13 offset:14336
    v_accvgpr_write_b32 a82, v226
    v_mfma_f32_16x16x32_bf16 v[24:27], a[212:215], a[16:19], v[24:27]
    v_exp_f32 v64, v64
    v_mfma_f32_16x16x32_bf16 v[24:27], a[216:219], a[32:35], v[24:27]
    v_exp_f32 v65, v65
    v_mfma_f32_16x16x32_bf16 v[24:27], a[220:223], a[48:51], v[24:27]
    v_exp_f32 v66, v66
    v_mfma_f32_16x16x32_bf16 v[24:27], a[224:227], a[64:67], v[24:27]
    buffer_load_dwordx4 v5, s[12:15], s38 offen offset:128 lds
    v_accvgpr_write_b32 a83, v227
    s_nop 1
    v_mfma_f32_16x16x32_bf16 v[24:27], a[228:231], a[80:83], v[24:27]
    v_exp_f32 v67, v67
    v_accvgpr_write_b32 a84, v232
    v_accvgpr_write_b32 a85, v233
    v_accvgpr_write_b32 a86, v234
    v_accvgpr_write_b32 a87, v235
    s_nop 1
    v_mfma_f32_16x16x32_bf16 v[28:31], a[228:231], a[84:87], 0
    v_exp_f32 v72, v72
    v_mfma_f32_16x16x32_bf16 v[28:31], a[224:227], a[68:71], v[28:31]
    v_exp_f32 v73, v73
    v_mfma_f32_16x16x32_bf16 v[28:31], a[220:223], a[52:55], v[28:31]
    v_exp_f32 v74, v74
    v_mfma_f32_16x16x32_bf16 v[28:31], a[216:219], a[36:39], v[28:31]
    v_exp_f32 v75, v75
    v_mfma_f32_16x16x32_bf16 v[28:31], a[212:215], a[20:23], v[28:31]
    s_addk_i32 m0, 896
    v_exp_f32 v80, v80
    v_mfma_f32_16x16x32_bf16 v[28:31], a[208:211], a[4:7], v[28:31]
    v_exp_f32 v81, v81
    v_mfma_f32_16x16x32_bf16 v[32:35], a[208:211], a[8:11], 0
    v_exp_f32 v82, v82
    v_mfma_f32_16x16x32_bf16 v[32:35], a[212:215], a[24:27], v[32:35]
    v_exp_f32 v83, v83
    v_mfma_f32_16x16x32_bf16 v[32:35], a[216:219], a[40:43], v[32:35]
    v_exp_f32 v88, v88
    v_mfma_f32_16x16x32_bf16 v[32:35], a[220:223], a[56:59], v[32:35]
    v_exp_f32 v89, v89
    v_mfma_f32_16x16x32_bf16 v[32:35], a[224:227], a[72:75], v[32:35]
    buffer_load_dwordx4 v5, s[12:15], s38 offen offset:256 lds
    v_accvgpr_write_b32 a88, v240
    v_accvgpr_write_b32 a89, v241
    v_accvgpr_write_b32 a90, v242
    v_accvgpr_write_b32 a91, v243
    s_nop 1
    v_mfma_f32_16x16x32_bf16 v[32:35], a[228:231], a[88:91], v[32:35]
    s_add_u32 s38, s38, 24576
    v_exp_f32 v90, v90
    v_accvgpr_write_b32 a92, v248
    v_accvgpr_write_b32 a93, v249
    v_accvgpr_write_b32 a94, v250
    v_accvgpr_write_b32 a95, v251
    s_nop 1
    v_mfma_f32_16x16x32_bf16 v[36:39], a[228:231], a[92:95], 0
    v_exp_f32 v91, v91
    v_mfma_f32_16x16x32_bf16 v[36:39], a[224:227], a[76:79], v[36:39]
    v_cvt_pk_bf16_f32 v64, v64, v65
    v_cvt_pk_bf16_f32 v65, v66, v67
    v_mfma_f32_16x16x32_bf16 v[36:39], a[220:223], a[60:63], v[36:39]
    s_add_u32 s39, s40, 49152
    v_exp_f32 v24, v24
    v_mfma_f32_16x16x32_bf16 v[36:39], a[216:219], a[44:47], v[36:39]
    s_waitcnt lgkmcnt(0)
    v_exp_f32 v25, v25
    v_mfma_f32_16x16x32_bf16 v[36:39], a[212:215], a[28:31], v[36:39]
    s_add_u32 m0, s63, 90112
    ds_read_b128 a[212:215], v13 offset:18432
    v_cvt_pk_bf16_f32 v72, v72, v73
    v_mfma_f32_16x16x32_bf16 v[36:39], a[208:211], a[12:15], v[36:39]
    ds_read_b128 a[220:223], v13 offset:19456
    v_cvt_pk_bf16_f32 v73, v74, v75
    v_mfma_f32_16x16x32_bf16 v[68:71], a[184:187], a[0:3], 0
    ds_read_b128 a[208:211], v12 offset:18432
    v_cvt_pk_bf16_f32 v80, v80, v81
    v_mfma_f32_16x16x32_bf16 v[68:71], a[188:191], a[16:19], v[68:71]
    ds_read_b128 a[216:219], v12 offset:19456
    v_cvt_pk_bf16_f32 v81, v82, v83
    v_mfma_f32_16x16x32_bf16 v[68:71], a[192:195], a[32:35], v[68:71]
    ds_read_b128 a[224:227], v12 offset:20480
    v_cvt_pk_bf16_f32 v88, v88, v89
    v_mfma_f32_16x16x32_bf16 v[68:71], a[196:199], a[48:51], v[68:71]
    ds_read_b128 a[228:231], v13 offset:20480
    v_cvt_pk_bf16_f32 v89, v90, v91
    v_mfma_f32_16x16x32_bf16 v[68:71], a[200:203], a[64:67], v[68:71]
    buffer_load_dwordx4 v6, s[16:19], s39 offen lds
    v_mfma_f32_16x16x32_bf16 v[68:71], a[204:207], a[80:83], v[68:71]
    v_exp_f32 v26, v26
    v_mfma_f32_16x16x32_bf16 v[76:79], a[204:207], a[84:87], 0
    v_exp_f32 v27, v27
    v_mfma_f32_16x16x32_bf16 v[76:79], a[200:203], a[68:71], v[76:79]
    v_exp_f32 v28, v28
    v_mfma_f32_16x16x32_bf16 v[76:79], a[196:199], a[52:55], v[76:79]
    s_add_u32 s39, s40, 61440
    v_exp_f32 v29, v29
    v_mfma_f32_16x16x32_bf16 v[76:79], a[192:195], a[36:39], v[76:79]
    v_exp_f32 v30, v30
    v_mfma_f32_16x16x32_bf16 v[76:79], a[188:191], a[20:23], v[76:79]
    s_addk_i32 m0, 4096
    v_exp_f32 v31, v31
    v_mfma_f32_16x16x32_bf16 v[76:79], a[184:187], a[4:7], v[76:79]
    v_cvt_pk_bf16_f32 v66, v24, v25
    v_cvt_pk_bf16_f32 v67, v26, v27
    v_mfma_f32_16x16x32_bf16 v[84:87], a[184:187], a[8:11], 0
    v_exp_f32 v32, v32
    v_mfma_f32_16x16x32_bf16 v[84:87], a[188:191], a[24:27], v[84:87]
    v_exp_f32 v33, v33
    v_mfma_f32_16x16x32_bf16 v[84:87], a[192:195], a[40:43], v[84:87]
    v_exp_f32 v34, v34
    v_mfma_f32_16x16x32_bf16 v[84:87], a[196:199], a[56:59], v[84:87]
    v_exp_f32 v35, v35
    v_mfma_f32_16x16x32_bf16 v[84:87], a[200:203], a[72:75], v[84:87]
    buffer_load_dwordx4 v6, s[16:19], s39 offen lds
    v_mfma_f32_16x16x32_bf16 v[84:87], a[204:207], a[88:91], v[84:87]
    v_cvt_pk_bf16_f32 v74, v28, v29
    v_cvt_pk_bf16_f32 v75, v30, v31
    v_mfma_f32_16x16x32_bf16 v[92:95], a[204:207], a[92:95], 0
    v_exp_f32 v36, v36
    v_mfma_f32_16x16x32_bf16 v[92:95], a[200:203], a[76:79], v[92:95]
pg_5:
    s_cbranch_execz pg_9
    v_exp_f32 v37, v37
    v_mfma_f32_16x16x32_bf16 v[92:95], a[196:199], a[60:63], v[92:95]
    v_exp_f32 v38, v38
    v_mfma_f32_16x16x32_bf16 v[92:95], a[192:195], a[44:47], v[92:95]
    s_waitcnt lgkmcnt(0)
    v_exp_f32 v39, v39
    v_mfma_f32_16x16x32_bf16 v[92:95], a[188:191], a[28:31], v[92:95]
    s_add_u32 m0, s49, 0
    v_add_u32 v8, v19, v8
    v_add_u32 v9, v19, v9
    v_mfma_f32_16x16x32_bf16 v[92:95], a[184:187], a[12:15], v[92:95]
    v_add_u32 v10, v19, v10
    v_add_u32 v11, v19, v11
    v_mfma_f32_16x16x32_bf16 v[40:43], a[208:211], a[0:3], 0
    s_waitcnt vmcnt(13)
    v_cvt_pk_bf16_f32 v82, v32, v33
    v_cvt_pk_bf16_f32 v83, v34, v35
    v_mfma_f32_16x16x32_bf16 v[40:43], a[212:215], a[16:19], v[40:43]
    s_barrier
    v_mfma_f32_16x16x32_bf16 v[40:43], a[216:219], a[32:35], v[40:43]
    ds_read_b128 a[184:187], v12 offset:24576
    v_cvt_pk_bf16_f32 v90, v36, v37
    v_mfma_f32_16x16x32_bf16 v[40:43], a[220:223], a[48:51], v[40:43]
    ds_read_b128 a[188:191], v13 offset:24576
    v_cvt_pk_bf16_f32 v91, v38, v39
    v_mfma_f32_16x16x32_bf16 v[40:43], a[224:227], a[64:67], v[40:43]
    buffer_load_dwordx4 v4, s[12:15], s38 offen offset:0 lds
    v_mfma_f32_16x16x32_bf16 v[40:43], a[228:231], a[80:83], v[40:43]
    v_exp_f32 v68, v68
    v_mfma_f32_16x16x32_bf16 v[44:47], a[228:231], a[84:87], 0
    v_exp_f32 v69, v69
    v_mfma_f32_16x16x32_bf16 v[44:47], a[224:227], a[68:71], v[44:47]
    ds_read_b128 a[192:195], v12 offset:25600
    v_cvt_pk_bf16_f32 v68, v68, v69
    v_mfma_f32_16x16x32_bf16 v[44:47], a[220:223], a[52:55], v[44:47]
    v_exp_f32 v70, v70
    v_mfma_f32_16x16x32_bf16 v[44:47], a[216:219], a[36:39], v[44:47]
    v_exp_f32 v71, v71
    v_mfma_f32_16x16x32_bf16 v[44:47], a[212:215], a[20:23], v[44:47]
    s_addk_i32 m0, 896
    ds_read_b128 a[196:199], v13 offset:25600
    v_cvt_pk_bf16_f32 v69, v70, v71
    v_mfma_f32_16x16x32_bf16 v[44:47], a[208:211], a[4:7], v[44:47]
    v_exp_f32 v76, v76
    v_mfma_f32_16x16x32_bf16 v[48:51], a[208:211], a[8:11], 0
    buffer_load_dword a252, v22, s[32:35], s42 offen offset:0
    v_mfma_f32_16x16x32_bf16 v[48:51], a[212:215], a[24:27], v[48:51]
    v_exp_f32 v77, v77
    v_mfma_f32_16x16x32_bf16 v[48:51], a[216:219], a[40:43], v[48:51]
    ds_read_b128 a[200:203], v12 offset:26624
    v_cvt_pk_bf16_f32 v76, v76, v77
    v_mfma_f32_16x16x32_bf16 v[48:51], a[220:223], a[56:59], v[48:51]
    v_exp_f32 v78, v78
    v_mfma_f32_16x16x32_bf16 v[48:51], a[224:227], a[72:75], v[48:51]
    buffer_load_dwordx4 v4, s[12:15], s38 offen offset:128 lds
    v_mfma_f32_16x16x32_bf16 v[48:51], a[228:231], a[88:91], v[48:51]
    v_exp_f32 v79, v79
    v_mfma_f32_16x16x32_bf16 v[52:55], a[228:231], a[92:95], 0
    ds_read_b128 a[204:207], v13 offset:26624
    v_cvt_pk_bf16_f32 v77, v78, v79
    v_mfma_f32_16x16x32_bf16 v[52:55], a[224:227], a[76:79], v[52:55]
    v_exp_f32 v84, v84
    v_mfma_f32_16x16x32_bf16 v[52:55], a[220:223], a[60:63], v[52:55]
    v_exp_f32 v85, v85
    v_mfma_f32_16x16x32_bf16 v[52:55], a[216:219], a[44:47], v[52:55]
    s_waitcnt lgkmcnt(1)
    v_exp_f32 v86, v86
    v_mfma_f32_16x16x32_bf16 v[52:55], a[212:215], a[28:31], v[52:55]
    s_addk_i32 m0, 896
    ds_read_b128 a[212:215], v13 offset:30720
    v_cvt_pk_bf16_f32 v84, v84, v85
    v_mfma_f32_16x16x32_bf16 v[52:55], a[208:211], a[12:15], v[52:55]
    v_exp_f32 v87, v87
    v_mfma_f32_16x16x32_bf16 v[96:99], a[184:187], a[0:3], 0
    ds_read_b128 a[220:223], v13 offset:31744
    v_cvt_pk_bf16_f32 v85, v86, v87
    v_mfma_f32_16x16x32_bf16 v[96:99], a[188:191], a[16:19], v[96:99]
    v_exp_f32 v92, v92
    v_mfma_f32_16x16x32_bf16 v[96:99], a[192:195], a[32:35], v[96:99]
    s_waitcnt lgkmcnt(2)
    v_exp_f32 v93, v93
    v_mfma_f32_16x16x32_bf16 v[96:99], a[196:199], a[48:51], v[96:99]
    ds_read_b128 a[208:211], v12 offset:30720
    v_cvt_pk_bf16_f32 v92, v92, v93
    v_mfma_f32_16x16x32_bf16 v[96:99], a[200:203], a[64:67], v[96:99]
    buffer_load_dwordx4 v4, s[12:15], s38 offen offset:256 lds
    v_mfma_f32_16x16x32_bf16 v[96:99], a[204:207], a[80:83], v[96:99]
    v_exp_f32 v94, v94
    v_mfma_f32_16x16x32_bf16 v[104:107], a[204:207], a[84:87], 0
    v_exp_f32 v95, v95
    v_mfma_f32_16x16x32_bf16 v[104:107], a[200:203], a[68:71], v[104:107]
    ds_read_b128 a[216:219], v12 offset:31744
    v_cvt_pk_bf16_f32 v93, v94, v95
    v_mfma_f32_16x16x32_bf16 v[104:107], a[196:199], a[52:55], v[104:107]
    v_exp_f32 v40, v40
    v_mfma_f32_16x16x32_bf16 v[104:107], a[192:195], a[36:39], v[104:107]
    v_exp_f32 v41, v41
    v_mfma_f32_16x16x32_bf16 v[104:107], a[188:191], a[20:23], v[104:107]
    s_addk_i32 m0, 1280
    ds_read_b128 a[224:227], v12 offset:32768
    v_cvt_pk_bf16_f32 v70, v40, v41
    v_mfma_f32_16x16x32_bf16 v[104:107], a[184:187], a[4:7], v[104:107]
    v_exp_f32 v42, v42
    v_mfma_f32_16x16x32_bf16 v[112:115], a[184:187], a[8:11], 0
    v_exp_f32 v43, v43
    v_mfma_f32_16x16x32_bf16 v[112:115], a[188:191], a[24:27], v[112:115]
    ds_read_b128 a[228:231], v13 offset:32768
    v_cvt_pk_bf16_f32 v71, v42, v43
    v_mfma_f32_16x16x32_bf16 v[112:115], a[192:195], a[40:43], v[112:115]
    v_exp_f32 v44, v44
    v_mfma_f32_16x16x32_bf16 v[112:115], a[196:199], a[56:59], v[112:115]
    v_exp_f32 v45, v45
    v_mfma_f32_16x16x32_bf16 v[112:115], a[200:203], a[72:75], v[112:115]
    buffer_load_dwordx4 v5, s[12:15], s38 offen offset:0 lds
    v_mfma_f32_16x16x32_bf16 v[112:115], a[204:207], a[88:91], v[112:115]
    v_exp_f32 v46, v46
    v_mfma_f32_16x16x32_bf16 v[120:123], a[204:207], a[92:95], 0
    ds_read_b64_tr_b16 a[232:233], v8 offset:0
    v_cvt_pk_bf16_f32 v78, v44, v45
    v_mfma_f32_16x16x32_bf16 v[120:123], a[200:203], a[76:79], v[120:123]
    v_exp_f32 v47, v47
    v_mfma_f32_16x16x32_bf16 v[120:123], a[196:199], a[60:63], v[120:123]
    ds_read_b64_tr_b16 a[234:235], v8 offset:2048
    v_cvt_pk_bf16_f32 v79, v46, v47
    v_mfma_f32_16x16x32_bf16 v[120:123], a[192:195], a[44:47], v[120:123]
    s_waitcnt lgkmcnt(2)
    v_exp_f32 v48, v48
    v_mfma_f32_16x16x32_bf16 v[120:123], a[188:191], a[28:31], v[120:123]
    s_addk_i32 m0, 896
    v_exp_f32 v49, v49
    v_mfma_f32_16x16x32_bf16 v[120:123], a[184:187], a[12:15], v[120:123]
    ds_read_b64_tr_b16 a[236:237], v9 offset:0
    v_cvt_pk_bf16_f32 v86, v48, v49
    v_mfma_f32_16x16x32_bf16 v[24:27], a[208:211], a[0:3], 0
    v_exp_f32 v50, v50
    v_mfma_f32_16x16x32_bf16 v[24:27], a[212:215], a[16:19], v[24:27]
    v_exp_f32 v51, v51
    v_mfma_f32_16x16x32_bf16 v[24:27], a[216:219], a[32:35], v[24:27]
    ds_read_b64_tr_b16 a[238:239], v9 offset:2048
    v_cvt_pk_bf16_f32 v87, v50, v51
    v_mfma_f32_16x16x32_bf16 v[24:27], a[220:223], a[48:51], v[24:27]
    v_exp_f32 v52, v52
    v_mfma_f32_16x16x32_bf16 v[24:27], a[224:227], a[64:67], v[24:27]
    buffer_load_dwordx4 v5, s[12:15], s38 offen offset:128 lds
    v_mfma_f32_16x16x32_bf16 v[24:27], a[228:231], a[80:83], v[24:27]
    v_exp_f32 v53, v53
    v_mfma_f32_16x16x32_bf16 v[28:31], a[228:231], a[84:87], 0
    ds_read_b128 a[184:187], v12 offset:36864
    v_cvt_pk_bf16_f32 v94, v52, v53
    v_mfma_f32_16x16x32_bf16 v[28:31], a[224:227], a[68:71], v[28:31]
    v_exp_f32 v54, v54
    v_mfma_f32_16x16x32_bf16 v[28:31], a[220:223], a[52:55], v[28:31]
    v_exp_f32 v55, v55
    v_mfma_f32_16x16x32_bf16 v[28:31], a[216:219], a[36:39], v[28:31]
    ds_read_b128 a[188:191], v13 offset:36864
    v_cvt_pk_bf16_f32 v95, v54, v55
    v_mfma_f32_16x16x32_bf16 v[28:31], a[212:215], a[20:23], v[28:31]
    s_addk_i32 m0, 896
    v_exp_f32 v96, v96
    v_mfma_f32_16x16x32_bf16 v[28:31], a[208:211], a[4:7], v[28:31]
    v_exp_f32 v97, v97
    v_mfma_f32_16x16x32_bf16 v[32:35], a[208:211], a[8:11], 0
    ds_read_b128 a[192:195], v12 offset:37888
    v_cvt_pk_bf16_f32 v96, v96, v97
    v_mfma_f32_16x16x32_bf16 v[32:35], a[212:215], a[24:27], v[32:35]
    v_exp_f32 v98, v98
    v_mfma_f32_16x16x32_bf16 v[32:35], a[216:219], a[40:43], v[32:35]
    v_exp_f32 v99, v99
    v_mfma_f32_16x16x32_bf16 v[32:35], a[220:223], a[56:59], v[32:35]
    ds_read_b128 a[196:199], v13 offset:37888
    v_cvt_pk_bf16_f32 v97, v98, v99
    v_mfma_f32_16x16x32_bf16 v[32:35], a[224:227], a[72:75], v[32:35]
    buffer_load_dwordx4 v5, s[12:15], s38 offen offset:256 lds
    v_mfma_f32_16x16x32_bf16 v[32:35], a[228:231], a[88:91], v[32:35]
    s_add_u32 s38, s38, 24576
    v_exp_f32 v104, v104
    v_mfma_f32_16x16x32_bf16 v[36:39], a[228:231], a[92:95], 0
    v_exp_f32 v105, v105
    v_mfma_f32_16x16x32_bf16 v[36:39], a[224:227], a[76:79], v[36:39]
    ds_read_b128 a[200:203], v12 offset:38912
    v_cvt_pk_bf16_f32 v104, v104, v105
    v_mfma_f32_16x16x32_bf16 v[36:39], a[220:223], a[60:63], v[36:39]
    s_add_u32 s39, s40, 73728
    v_exp_f32 v106, v106
    v_mfma_f32_16x16x32_bf16 v[36:39], a[216:219], a[44:47], v[36:39]
    s_waitcnt lgkmcnt(2)
    v_exp_f32 v107, v107
    v_mfma_f32_16x16x32_bf16 v[36:39], a[212:215], a[28:31], v[36:39]
    s_add_u32 m0, s63, 98304
    ds_read_b128 a[204:207], v13 offset:38912
    v_cvt_pk_bf16_f32 v105, v106, v107
    v_mfma_f32_16x16x32_bf16 v[36:39], a[208:211], a[12:15], v[36:39]
    v_exp_f32 v112, v112
    v_mfma_f32_16x16x32_bf16 a[152:155], a[232:235], v[64:67], 0
    v_exp_f32 v113, v113
    v_mfma_f32_16x16x32_bf16 a[168:171], a[236:239], v[64:67], 0
    v_exp_f32 v114, v114
    v_mfma_f32_16x16x32_bf16 a[172:175], a[236:239], v[72:75], 0
    ds_read_b128 a[208:211], v12 offset:43008
    v_cvt_pk_bf16_f32 v112, v112, v113
    v_mfma_f32_16x16x32_bf16 a[156:159], a[232:235], v[72:75], 0
    v_exp_f32 v115, v115
    v_mfma_f32_16x16x32_bf16 a[160:163], a[232:235], v[80:83], 0
    buffer_load_dwordx4 v6, s[16:19], s39 offen lds
    v_mfma_f32_16x16x32_bf16 a[176:179], a[236:239], v[80:83], 0
    ds_read_b128 a[212:215], v13 offset:43008
    v_cvt_pk_bf16_f32 v113, v114, v115
    v_mfma_f32_16x16x32_bf16 a[180:183], a[236:239], v[88:91], 0
    v_exp_f32 v120, v120
    v_mfma_f32_16x16x32_bf16 a[164:167], a[232:235], v[88:91], 0
    v_exp_f32 v121, v121
    v_mfma_f32_16x16x32_bf16 v[100:103], a[184:187], a[0:3], 0
    s_waitcnt lgkmcnt(2)
    ds_read_b128 a[216:219], v12 offset:44032
    v_cvt_pk_bf16_f32 v120, v120, v121
    v_mfma_f32_16x16x32_bf16 v[100:103], a[188:191], a[16:19], v[100:103]
    s_add_u32 s39, s40, 86016
    v_exp_f32 v122, v122
    v_mfma_f32_16x16x32_bf16 v[100:103], a[192:195], a[32:35], v[100:103]
    s_addk_i32 m0, 4096
    v_exp_f32 v123, v123
    v_mfma_f32_16x16x32_bf16 v[100:103], a[196:199], a[48:51], v[100:103]
    ds_read_b128 a[220:223], v13 offset:44032
    v_cvt_pk_bf16_f32 v121, v122, v123
    v_mfma_f32_16x16x32_bf16 v[100:103], a[200:203], a[64:67], v[100:103]
    v_exp_f32 v24, v24
    v_mfma_f32_16x16x32_bf16 v[100:103], a[204:207], a[80:83], v[100:103]
    v_exp_f32 v25, v25
    v_mfma_f32_16x16x32_bf16 v[108:111], a[204:207], a[84:87], 0
    ds_read_b128 a[224:227], v12 offset:45056
    v_cvt_pk_bf16_f32 v98, v24, v25
    v_mfma_f32_16x16x32_bf16 v[108:111], a[200:203], a[68:71], v[108:111]
    v_exp_f32 v26, v26
    v_mfma_f32_16x16x32_bf16 v[108:111], a[196:199], a[52:55], v[108:111]
    buffer_load_dwordx4 v6, s[16:19], s39 offen lds
    v_mfma_f32_16x16x32_bf16 v[108:111], a[192:195], a[36:39], v[108:111]
    v_exp_f32 v27, v27
    v_mfma_f32_16x16x32_bf16 v[108:111], a[188:191], a[20:23], v[108:111]
    ds_read_b128 a[228:231], v13 offset:45056
    v_cvt_pk_bf16_f32 v99, v26, v27
    v_mfma_f32_16x16x32_bf16 v[108:111], a[184:187], a[4:7], v[108:111]
    v_exp_f32 v28, v28
    v_mfma_f32_16x16x32_bf16 v[116:119], a[184:187], a[8:11], 0
    v_exp_f32 v29, v29
    v_mfma_f32_16x16x32_bf16 v[116:119], a[188:191], a[24:27], v[116:119]
    v_exp_f32 v30, v30
    v_mfma_f32_16x16x32_bf16 v[116:119], a[192:195], a[40:43], v[116:119]
    v_exp_f32 v31, v31
    v_mfma_f32_16x16x32_bf16 v[116:119], a[196:199], a[56:59], v[116:119]
    v_exp_f32 v32, v32
    v_mfma_f32_16x16x32_bf16 v[116:119], a[200:203], a[72:75], v[116:119]
    v_exp_f32 v33, v33
    v_mfma_f32_16x16x32_bf16 v[116:119], a[204:207], a[88:91], v[116:119]
    v_exp_f32 v34, v34
    v_mfma_f32_16x16x32_bf16 v[124:127], a[204:207], a[92:95], 0
    v_exp_f32 v35, v35
    v_mfma_f32_16x16x32_bf16 v[124:127], a[200:203], a[76:79], v[124:127]
    v_cvt_pk_bf16_f32 v106, v28, v29
    v_cvt_pk_bf16_f32 v107, v30, v31
    v_mfma_f32_16x16x32_bf16 v[124:127], a[196:199], a[60:63], v[124:127]
    s_add_u32 m0, s49, 24576
    v_exp_f32 v36, v36
    v_mfma_f32_16x16x32_bf16 v[124:127], a[192:195], a[44:47], v[124:127]
    s_waitcnt lgkmcnt(0)
    v_exp_f32 v37, v37
    v_mfma_f32_16x16x32_bf16 v[124:127], a[188:191], a[28:31], v[124:127]
    v_exp_f32 v38, v38
    v_mfma_f32_16x16x32_bf16 v[124:127], a[184:187], a[12:15], v[124:127]
    v_exp_f32 v39, v39
    v_mfma_f32_16x16x32_bf16 v[40:43], a[208:211], a[0:3], 0
    s_waitcnt vmcnt(11)
    v_cvt_pk_bf16_f32 v114, v32, v33
    v_cvt_pk_bf16_f32 v115, v34, v35
    v_mfma_f32_16x16x32_bf16 v[40:43], a[212:215], a[16:19], v[40:43]
    s_barrier
    v_mfma_f32_16x16x32_bf16 v[40:43], a[216:219], a[32:35], v[40:43]
    buffer_load_dwordx4 v4, s[12:15], s38 offen offset:0 lds
    v_mfma_f32_16x16x32_bf16 v[40:43], a[220:223], a[48:51], v[40:43]
    ds_read_b64_tr_b16 a[240:241], v8 offset:4096
    v_cvt_pk_bf16_f32 v122, v36, v37
    v_mfma_f32_16x16x32_bf16 v[40:43], a[224:227], a[64:67], v[40:43]
    ds_read_b64_tr_b16 a[242:243], v8 offset:6144
    v_cvt_pk_bf16_f32 v123, v38, v39
    v_mfma_f32_16x16x32_bf16 v[40:43], a[228:231], a[80:83], v[40:43]
    v_exp_f32 v100, v100
    v_mfma_f32_16x16x32_bf16 v[44:47], a[228:231], a[84:87], 0
    v_exp_f32 v101, v101
    v_mfma_f32_16x16x32_bf16 v[44:47], a[224:227], a[68:71], v[44:47]
    ds_read_b64_tr_b16 a[244:245], v9 offset:4096
    v_cvt_pk_bf16_f32 v100, v100, v101
    v_mfma_f32_16x16x32_bf16 v[44:47], a[220:223], a[52:55], v[44:47]
    s_addk_i32 m0, 896
    v_exp_f32 v102, v102
    v_mfma_f32_16x16x32_bf16 v[44:47], a[216:219], a[36:39], v[44:47]
    v_exp_f32 v103, v103
    v_mfma_f32_16x16x32_bf16 v[44:47], a[212:215], a[20:23], v[44:47]
    ds_read_b64_tr_b16 a[246:247], v9 offset:6144
    v_cvt_pk_bf16_f32 v101, v102, v103
    v_mfma_f32_16x16x32_bf16 v[44:47], a[208:211], a[4:7], v[44:47]
    v_exp_f32 v108, v108
    v_mfma_f32_16x16x32_bf16 v[48:51], a[208:211], a[8:11], 0
    buffer_load_dword a252, v22, s[32:35], s42 offen offset:1536
    s_add_u32 s42, s42, 3072
    v_mfma_f32_16x16x32_bf16 v[48:51], a[212:215], a[24:27], v[48:51]
    v_exp_f32 v109, v109
    v_mfma_f32_16x16x32_bf16 v[48:51], a[216:219], a[40:43], v[48:51]
    buffer_load_dwordx4 v4, s[12:15], s38 offen offset:128 lds
    v_mfma_f32_16x16x32_bf16 v[48:51], a[220:223], a[56:59], v[48:51]
    ds_read_b128 a[184:187], v12 offset:49152
    v_cvt_pk_bf16_f32 v108, v108, v109
    v_mfma_f32_16x16x32_bf16 v[48:51], a[224:227], a[72:75], v[48:51]
    v_exp_f32 v110, v110
    v_mfma_f32_16x16x32_bf16 v[48:51], a[228:231], a[88:91], v[48:51]
    v_exp_f32 v111, v111
    v_mfma_f32_16x16x32_bf16 v[52:55], a[228:231], a[92:95], 0
    ds_read_b128 a[188:191], v13 offset:49152
    v_cvt_pk_bf16_f32 v109, v110, v111
    v_mfma_f32_16x16x32_bf16 v[52:55], a[224:227], a[76:79], v[52:55]
    v_exp_f32 v116, v116
    v_mfma_f32_16x16x32_bf16 v[52:55], a[220:223], a[60:63], v[52:55]
    s_addk_i32 m0, 896
    ds_read_b128 a[192:195], v12 offset:50176
    v_accvgpr_write_b32 a96, v64
    v_mfma_f32_16x16x32_bf16 v[52:55], a[216:219], a[44:47], v[52:55]
    s_waitcnt lgkmcnt(3)
    v_exp_f32 v117, v117
    v_mfma_f32_16x16x32_bf16 v[52:55], a[212:215], a[28:31], v[52:55]
    ds_read_b128 a[196:199], v13 offset:50176
    v_cvt_pk_bf16_f32 v116, v116, v117
    v_mfma_f32_16x16x32_bf16 v[52:55], a[208:211], a[12:15], v[52:55]
    v_exp_f32 v118, v118
    v_mfma_f32_16x16x32_bf16 a[164:167], a[240:243], v[92:95], a[164:167]
    v_exp_f32 v119, v119
    v_mfma_f32_16x16x32_bf16 a[180:183], a[244:247], v[92:95], a[180:183]
    ds_read_b128 a[200:203], v12 offset:51200
    v_cvt_pk_bf16_f32 v117, v118, v119
    v_mfma_f32_16x16x32_bf16 a[176:179], a[244:247], v[84:87], a[176:179]
    buffer_load_dwordx4 v4, s[12:15], s38 offen offset:256 lds
    v_mfma_f32_16x16x32_bf16 a[160:163], a[240:243], v[84:87], a[160:163]
    ds_read_b128 a[204:207], v13 offset:51200
    v_accvgpr_write_b32 a97, v65
    v_mfma_f32_16x16x32_bf16 a[156:159], a[240:243], v[76:79], a[156:159]
    v_exp_f32 v124, v124
    v_mfma_f32_16x16x32_bf16 a[172:175], a[244:247], v[76:79], a[172:175]
    s_waitcnt lgkmcnt(2)
    v_exp_f32 v125, v125
    v_mfma_f32_16x16x32_bf16 a[168:171], a[244:247], v[68:71], a[168:171]
    ds_read_b128 a[208:211], v12 offset:55296
    v_cvt_pk_bf16_f32 v124, v124, v125
    v_mfma_f32_16x16x32_bf16 a[152:155], a[240:243], v[68:71], a[152:155]
    v_exp_f32 v126, v126
    v_mfma_f32_16x16x32_bf16 v[128:131], a[184:187], a[0:3], 0
    s_addk_i32 m0, 1280
    v_exp_f32 v127, v127
    v_mfma_f32_16x16x32_bf16 v[128:131], a[188:191], a[16:19], v[128:131]
    s_waitcnt lgkmcnt(2)
    ds_read_b128 a[212:215], v13 offset:55296
    v_cvt_pk_bf16_f32 v125, v126, v127
    v_mfma_f32_16x16x32_bf16 v[128:131], a[192:195], a[32:35], v[128:131]
    s_waitcnt lgkmcnt(2)
    v_exp_f32 v40, v40
    v_mfma_f32_16x16x32_bf16 v[128:131], a[196:199], a[48:51], v[128:131]
    ds_read_b128 a[216:219], v12 offset:56320
    v_accvgpr_write_b32 a98, v66
    v_mfma_f32_16x16x32_bf16 v[128:131], a[200:203], a[64:67], v[128:131]
    v_exp_f32 v41, v41
    v_mfma_f32_16x16x32_bf16 v[128:131], a[204:207], a[80:83], v[128:131]
    ds_read_b128 a[220:223], v13 offset:56320
    v_cvt_pk_bf16_f32 v102, v40, v41
    v_mfma_f32_16x16x32_bf16 v[136:139], a[204:207], a[84:87], 0
    buffer_load_dwordx4 v5, s[12:15], s38 offen offset:0 lds
    v_mfma_f32_16x16x32_bf16 v[136:139], a[200:203], a[68:71], v[136:139]
    v_exp_f32 v42, v42
    v_mfma_f32_16x16x32_bf16 v[136:139], a[196:199], a[52:55], v[136:139]
    v_exp_f32 v43, v43
    v_mfma_f32_16x16x32_bf16 v[136:139], a[192:195], a[36:39], v[136:139]
    ds_read_b128 a[224:227], v12 offset:57344
    v_cvt_pk_bf16_f32 v103, v42, v43
    v_mfma_f32_16x16x32_bf16 v[136:139], a[188:191], a[20:23], v[136:139]
    v_exp_f32 v44, v44
    v_mfma_f32_16x16x32_bf16 v[136:139], a[184:187], a[4:7], v[136:139]
    ds_read_b128 a[228:231], v13 offset:57344
    v_accvgpr_write_b32 a99, v67
    v_mfma_f32_16x16x32_bf16 v[144:147], a[184:187], a[8:11], 0
    s_addk_i32 m0, 896
    v_exp_f32 v45, v45
    v_mfma_f32_16x16x32_bf16 v[144:147], a[188:191], a[24:27], v[144:147]
    v_exp_f32 v46, v46
    v_mfma_f32_16x16x32_bf16 v[144:147], a[192:195], a[40:43], v[144:147]
    v_exp_f32 v47, v47
    v_mfma_f32_16x16x32_bf16 v[144:147], a[196:199], a[56:59], v[144:147]
    v_exp_f32 v48, v48
    v_mfma_f32_16x16x32_bf16 v[144:147], a[200:203], a[72:75], v[144:147]
    v_exp_f32 v49, v49
    v_mfma_f32_16x16x32_bf16 v[144:147], a[204:207], a[88:91], v[144:147]
    v_exp_f32 v50, v50
    v_mfma_f32_16x16x32_bf16 v[152:155], a[204:207], a[92:95], 0
    buffer_load_dwordx4 v5, s[12:15], s38 offen offset:128 lds
    v_mfma_f32_16x16x32_bf16 v[152:155], a[200:203], a[76:79], v[152:155]
    ds_read_b64_tr_b16 a[232:233], v8 offset:8192
    v_cvt_pk_bf16_f32 v110, v44, v45
    v_mfma_f32_16x16x32_bf16 v[152:155], a[196:199], a[60:63], v[152:155]
    ds_read_b64_tr_b16 a[234:235], v8 offset:10240
    v_cvt_pk_bf16_f32 v111, v46, v47
    v_mfma_f32_16x16x32_bf16 v[152:155], a[192:195], a[44:47], v[152:155]
    s_waitcnt lgkmcnt(2)
    ds_read_b64_tr_b16 a[236:237], v9 offset:8192
    v_cvt_pk_bf16_f32 v118, v48, v49
    v_mfma_f32_16x16x32_bf16 v[152:155], a[188:191], a[28:31], v[152:155]
    ds_read_b64_tr_b16 a[238:239], v9 offset:10240
    v_accvgpr_write_b32 a100, v68
    v_mfma_f32_16x16x32_bf16 v[152:155], a[184:187], a[12:15], v[152:155]
    v_exp_f32 v51, v51
    v_mfma_f32_16x16x32_bf16 v[24:27], a[208:211], a[0:3], 0
    s_addk_i32 m0, 896
    v_exp_f32 v52, v52
    v_mfma_f32_16x16x32_bf16 v[24:27], a[212:215], a[16:19], v[24:27]
    v_exp_f32 v53, v53
    v_mfma_f32_16x16x32_bf16 v[24:27], a[216:219], a[32:35], v[24:27]
    ds_read_b128 a[184:187], v12 offset:61440
    v_cvt_pk_bf16_f32 v119, v50, v51
    v_mfma_f32_16x16x32_bf16 v[24:27], a[220:223], a[48:51], v[24:27]
    ds_read_b128 a[188:191], v13 offset:61440
    v_cvt_pk_bf16_f32 v126, v52, v53
    v_mfma_f32_16x16x32_bf16 v[24:27], a[224:227], a[64:67], v[24:27]
    ds_read_b128 a[192:195], v12 offset:62464
    v_accvgpr_write_b32 a101, v69
    v_mfma_f32_16x16x32_bf16 v[24:27], a[228:231], a[80:83], v[24:27]
    v_exp_f32 v54, v54
    v_mfma_f32_16x16x32_bf16 v[28:31], a[228:231], a[84:87], 0
    buffer_load_dwordx4 v5, s[12:15], s38 offen offset:256 lds
    v_mfma_f32_16x16x32_bf16 v[28:31], a[224:227], a[68:71], v[28:31]
    s_add_u32 s38, s38, 24576
    v_exp_f32 v55, v55
    v_mfma_f32_16x16x32_bf16 v[28:31], a[220:223], a[52:55], v[28:31]
    ds_read_b128 a[196:199], v13 offset:62464
    v_cvt_pk_bf16_f32 v127, v54, v55
    v_mfma_f32_16x16x32_bf16 v[28:31], a[216:219], a[36:39], v[28:31]
    v_exp_f32 v128, v128
    v_mfma_f32_16x16x32_bf16 v[28:31], a[212:215], a[20:23], v[28:31]
    s_add_u32 s39, s40, 98304
    ds_read_b128 a[200:203], v12 offset:63488
    v_add_u32 v12, 67584, v12
    v_mfma_f32_16x16x32_bf16 v[28:31], a[208:211], a[4:7], v[28:31]
    ds_read_b128 a[204:207], v13 offset:63488
    v_add_u32 v13, 67584, v13
    v_mfma_f32_16x16x32_bf16 v[32:35], a[208:211], a[8:11], 0
    s_add_u32 m0, s63, 106496
    v_exp_f32 v129, v129
    v_mfma_f32_16x16x32_bf16 v[32:35], a[212:215], a[24:27], v[32:35]
    v_exp_f32 v130, v130
    v_mfma_f32_16x16x32_bf16 v[32:35], a[216:219], a[40:43], v[32:35]
    v_exp_f32 v131, v131
    v_mfma_f32_16x16x32_bf16 v[32:35], a[220:223], a[56:59], v[32:35]
    v_exp_f32 v136, v136
    v_mfma_f32_16x16x32_bf16 v[32:35], a[224:227], a[72:75], v[32:35]
    v_exp_f32 v137, v137
    v_mfma_f32_16x16x32_bf16 v[32:35], a[228:231], a[88:91], v[32:35]
    v_exp_f32 v138, v138
    v_mfma_f32_16x16x32_bf16 v[36:39], a[228:231], a[92:95], 0
    buffer_load_dwordx4 v6, s[16:19], s39 offen lds
    v_mfma_f32_16x16x32_bf16 v[36:39], a[224:227], a[76:79], v[36:39]
    v_exp_f32 v139, v139
    v_mfma_f32_16x16x32_bf16 v[36:39], a[220:223], a[60:63], v[36:39]
    v_cvt_pk_bf16_f32 v128, v128, v129
    v_cvt_pk_bf16_f32 v129, v130, v131
    v_mfma_f32_16x16x32_bf16 v[36:39], a[216:219], a[44:47], v[36:39]
    s_waitcnt lgkmcnt(0)
    v_exp_f32 v144, v144
    v_mfma_f32_16x16x32_bf16 v[36:39], a[212:215], a[28:31], v[36:39]
    s_add_u32 s39, s40, 110592
    v_exp_f32 v145, v145
    v_mfma_f32_16x16x32_bf16 v[36:39], a[208:211], a[12:15], v[36:39]
    v_exp_f32 v146, v146
    v_mfma_f32_16x16x32_bf16 a[152:155], a[232:235], v[96:99], a[152:155]
    s_addk_i32 m0, 4096
    v_exp_f32 v147, v147
    v_mfma_f32_16x16x32_bf16 a[168:171], a[236:239], v[96:99], a[168:171]
    v_cvt_pk_bf16_f32 v136, v136, v137
    v_cvt_pk_bf16_f32 v137, v138, v139
    v_mfma_f32_16x16x32_bf16 a[172:175], a[236:239], v[104:107], a[172:175]
    ds_read_b128 a[208:211], v12 offset:0
    v_cvt_pk_bf16_f32 v144, v144, v145
    v_mfma_f32_16x16x32_bf16 a[156:159], a[232:235], v[104:107], a[156:159]
    ds_read_b128 a[212:215], v13 offset:0
    v_cvt_pk_bf16_f32 v145, v146, v147
    v_mfma_f32_16x16x32_bf16 a[160:163], a[232:235], v[112:115], a[160:163]
    ds_read_b128 a[216:219], v12 offset:1024
    v_accvgpr_write_b32 a102, v70
    v_mfma_f32_16x16x32_bf16 a[176:179], a[236:239], v[112:115], a[176:179]
    ds_read_b128 a[220:223], v13 offset:1024
    v_accvgpr_write_b32 a103, v71
    v_mfma_f32_16x16x32_bf16 a[180:183], a[236:239], v[120:123], a[180:183]
    buffer_load_dwordx4 v6, s[16:19], s39 offen lds
    v_mfma_f32_16x16x32_bf16 a[164:167], a[232:235], v[120:123], a[164:167]
    ds_read_b128 a[224:227], v12 offset:2048
    v_accvgpr_write_b32 a104, v72
    v_mfma_f32_16x16x32_bf16 v[132:135], a[184:187], a[0:3], 0
    ds_read_b128 a[228:231], v13 offset:2048
    v_subrev_u32 v12, 67584, v12
    v_mfma_f32_16x16x32_bf16 v[132:135], a[188:191], a[16:19], v[132:135]
    v_exp_f32 v152, v152
    v_mfma_f32_16x16x32_bf16 v[132:135], a[192:195], a[32:35], v[132:135]
    v_exp_f32 v153, v153
    v_mfma_f32_16x16x32_bf16 v[132:135], a[196:199], a[48:51], v[132:135]
    v_exp_f32 v154, v154
    v_mfma_f32_16x16x32_bf16 v[132:135], a[200:203], a[64:67], v[132:135]
    v_exp_f32 v155, v155
    v_mfma_f32_16x16x32_bf16 v[132:135], a[204:207], a[80:83], v[132:135]
    v_exp_f32 v24, v24
    v_mfma_f32_16x16x32_bf16 v[140:143], a[204:207], a[84:87], 0
    v_exp_f32 v25, v25
    v_mfma_f32_16x16x32_bf16 v[140:143], a[200:203], a[68:71], v[140:143]
    v_exp_f32 v26, v26
    v_mfma_f32_16x16x32_bf16 v[140:143], a[196:199], a[52:55], v[140:143]
    v_exp_f32 v27, v27
    v_mfma_f32_16x16x32_bf16 v[140:143], a[192:195], a[36:39], v[140:143]
    v_cvt_pk_bf16_f32 v152, v152, v153
    v_cvt_pk_bf16_f32 v153, v154, v155
    v_mfma_f32_16x16x32_bf16 v[140:143], a[188:191], a[20:23], v[140:143]
    v_exp_f32 v28, v28
    v_mfma_f32_16x16x32_bf16 v[140:143], a[184:187], a[4:7], v[140:143]
    v_exp_f32 v29, v29
    v_mfma_f32_16x16x32_bf16 v[148:151], a[184:187], a[8:11], 0
    v_exp_f32 v30, v30
    v_mfma_f32_16x16x32_bf16 v[148:151], a[188:191], a[24:27], v[148:151]
    v_exp_f32 v31, v31
    v_mfma_f32_16x16x32_bf16 v[148:151], a[192:195], a[40:43], v[148:151]
    v_cvt_pk_bf16_f32 v130, v24, v25
    v_cvt_pk_bf16_f32 v131, v26, v27
    v_mfma_f32_16x16x32_bf16 v[148:151], a[196:199], a[56:59], v[148:151]
    v_exp_f32 v32, v32
    v_mfma_f32_16x16x32_bf16 v[148:151], a[200:203], a[72:75], v[148:151]
    v_exp_f32 v33, v33
    v_mfma_f32_16x16x32_bf16 v[148:151], a[204:207], a[88:91], v[148:151]
    v_exp_f32 v34, v34
    v_mfma_f32_16x16x32_bf16 v[156:159], a[204:207], a[92:95], 0
    v_exp_f32 v35, v35
    v_mfma_f32_16x16x32_bf16 v[156:159], a[200:203], a[76:79], v[156:159]
    v_cvt_pk_bf16_f32 v138, v28, v29
    v_cvt_pk_bf16_f32 v139, v30, v31
    v_mfma_f32_16x16x32_bf16 v[156:159], a[196:199], a[60:63], v[156:159]
    s_add_u32 m0, s49, 49152
    v_exp_f32 v36, v36
    v_mfma_f32_16x16x32_bf16 v[156:159], a[192:195], a[44:47], v[156:159]
    s_waitcnt lgkmcnt(0)
    v_exp_f32 v37, v37
    v_mfma_f32_16x16x32_bf16 v[156:159], a[188:191], a[28:31], v[156:159]
    v_exp_f32 v38, v38
    v_mfma_f32_16x16x32_bf16 v[156:159], a[184:187], a[12:15], v[156:159]
    v_exp_f32 v39, v39
    v_mfma_f32_16x16x32_bf16 v[40:43], a[208:211], a[0:3], 0
    s_waitcnt vmcnt(11)
    v_cvt_pk_bf16_f32 v146, v32, v33
    v_cvt_pk_bf16_f32 v147, v34, v35
    v_mfma_f32_16x16x32_bf16 v[40:43], a[212:215], a[16:19], v[40:43]
    s_barrier
    v_mfma_f32_16x16x32_bf16 v[40:43], a[216:219], a[32:35], v[40:43]
    buffer_load_dwordx4 v4, s[12:15], s38 offen offset:0 lds
    v_mfma_f32_16x16x32_bf16 v[40:43], a[220:223], a[48:51], v[40:43]
    ds_read_b64_tr_b16 a[240:241], v8 offset:12288
    v_cvt_pk_bf16_f32 v154, v36, v37
    v_mfma_f32_16x16x32_bf16 v[40:43], a[224:227], a[64:67], v[40:43]
    ds_read_b64_tr_b16 a[242:243], v8 offset:14336
    v_cvt_pk_bf16_f32 v155, v38, v39
    v_mfma_f32_16x16x32_bf16 v[40:43], a[228:231], a[80:83], v[40:43]
    ds_read_b64_tr_b16 a[244:245], v9 offset:12288
    v_accvgpr_write_b32 a105, v73
    v_mfma_f32_16x16x32_bf16 v[44:47], a[228:231], a[84:87], 0
    ds_read_b64_tr_b16 a[246:247], v9 offset:14336
    v_subrev_u32 v13, 67584, v13
    v_mfma_f32_16x16x32_bf16 v[44:47], a[224:227], a[68:71], v[44:47]
    ds_read_b128 a[184:187], v12 offset:0
    v_accvgpr_write_b32 a106, v74
    v_mfma_f32_16x16x32_bf16 v[44:47], a[220:223], a[52:55], v[44:47]
    s_addk_i32 m0, 896
    ds_read_b128 a[188:191], v13 offset:0
    v_accvgpr_write_b32 a107, v75
    v_mfma_f32_16x16x32_bf16 v[44:47], a[216:219], a[36:39], v[44:47]
    ds_read_b128 a[192:195], v12 offset:1024
    v_accvgpr_write_b32 a108, v76
    v_mfma_f32_16x16x32_bf16 v[44:47], a[212:215], a[20:23], v[44:47]
    ds_read_b128 a[196:199], v13 offset:1024
    v_accvgpr_write_b32 a109, v77
    v_mfma_f32_16x16x32_bf16 v[44:47], a[208:211], a[4:7], v[44:47]
    v_exp_f32 v132, v132
    v_mfma_f32_16x16x32_bf16 v[48:51], a[208:211], a[8:11], 0
    buffer_load_dword a252, v22, s[32:35], s42 offen offset:0
    v_mfma_f32_16x16x32_bf16 v[48:51], a[212:215], a[24:27], v[48:51]
    v_exp_f32 v133, v133
    v_mfma_f32_16x16x32_bf16 v[48:51], a[216:219], a[40:43], v[48:51]
    buffer_load_dwordx4 v4, s[12:15], s38 offen offset:128 lds
    v_mfma_f32_16x16x32_bf16 v[48:51], a[220:223], a[56:59], v[48:51]
    ds_read_b128 a[200:203], v12 offset:2048
    v_cvt_pk_bf16_f32 v132, v132, v133
    v_mfma_f32_16x16x32_bf16 v[48:51], a[224:227], a[72:75], v[48:51]
    v_exp_f32 v134, v134
    v_mfma_f32_16x16x32_bf16 v[48:51], a[228:231], a[88:91], v[48:51]
pg_6:
    s_cbranch_execz pg_10
    ds_read_b128 a[204:207], v13 offset:2048
    v_accvgpr_write_b32 a110, v78
    v_mfma_f32_16x16x32_bf16 v[52:55], a[228:231], a[92:95], 0
    v_exp_f32 v135, v135
    v_mfma_f32_16x16x32_bf16 v[52:55], a[224:227], a[76:79], v[52:55]
    v_exp_f32 v140, v140
    v_mfma_f32_16x16x32_bf16 v[52:55], a[220:223], a[60:63], v[52:55]
    s_addk_i32 m0, 896
    v_exp_f32 v141, v141
    v_mfma_f32_16x16x32_bf16 v[52:55], a[216:219], a[44:47], v[52:55]
    s_waitcnt lgkmcnt(2)
    v_exp_f32 v142, v142
    v_mfma_f32_16x16x32_bf16 v[52:55], a[212:215], a[28:31], v[52:55]
    v_exp_f32 v143, v143
    v_mfma_f32_16x16x32_bf16 v[52:55], a[208:211], a[12:15], v[52:55]
    v_exp_f32 v148, v148
    v_mfma_f32_16x16x32_bf16 a[164:167], a[240:243], v[124:127], a[164:167]
    v_exp_f32 v149, v149
    v_mfma_f32_16x16x32_bf16 a[180:183], a[244:247], v[124:127], a[180:183]
    v_cvt_pk_bf16_f32 v133, v134, v135
    v_cvt_pk_bf16_f32 v140, v140, v141
    v_mfma_f32_16x16x32_bf16 a[176:179], a[244:247], v[116:119], a[176:179]
    buffer_load_dwordx4 v4, s[12:15], s38 offen offset:256 lds
    v_mfma_f32_16x16x32_bf16 a[160:163], a[240:243], v[116:119], a[160:163]
    ds_read_b128 a[208:211], v12 offset:6144
    v_cvt_pk_bf16_f32 v141, v142, v143
    v_mfma_f32_16x16x32_bf16 a[156:159], a[240:243], v[108:111], a[156:159]
    ds_read_b128 a[212:215], v13 offset:6144
    v_cvt_pk_bf16_f32 v148, v148, v149
    v_mfma_f32_16x16x32_bf16 a[172:175], a[244:247], v[108:111], a[172:175]
    ds_read_b128 a[216:219], v12 offset:7168
    v_accvgpr_write_b32 a111, v79
    v_mfma_f32_16x16x32_bf16 a[168:171], a[244:247], v[100:103], a[168:171]
    v_exp_f32 v150, v150
    v_mfma_f32_16x16x32_bf16 a[152:155], a[240:243], v[100:103], a[152:155]
    v_exp_f32 v151, v151
    v_mfma_f32_16x16x32_bf16 v[160:163], a[184:187], a[0:3], 0
    s_addk_i32 m0, 1280
    ds_read_b128 a[220:223], v13 offset:7168
    v_cvt_pk_bf16_f32 v149, v150, v151
    v_mfma_f32_16x16x32_bf16 v[160:163], a[188:191], a[16:19], v[160:163]
    s_waitcnt lgkmcnt(4)
    ds_read_b128 a[224:227], v12 offset:8192
    v_accvgpr_write_b32 a112, v80
    v_mfma_f32_16x16x32_bf16 v[160:163], a[192:195], a[32:35], v[160:163]
    v_exp_f32 v156, v156
    v_mfma_f32_16x16x32_bf16 v[160:163], a[196:199], a[48:51], v[160:163]
    v_exp_f32 v157, v157
    v_mfma_f32_16x16x32_bf16 v[160:163], a[200:203], a[64:67], v[160:163]
    ds_read_b128 a[228:231], v13 offset:8192
    v_cvt_pk_bf16_f32 v156, v156, v157
    v_mfma_f32_16x16x32_bf16 v[160:163], a[204:207], a[80:83], v[160:163]
    v_exp_f32 v158, v158
    v_mfma_f32_16x16x32_bf16 v[168:171], a[204:207], a[84:87], 0
    buffer_load_dwordx4 v5, s[12:15], s38 offen offset:0 lds
    v_mfma_f32_16x16x32_bf16 v[168:171], a[200:203], a[68:71], v[168:171]
    v_exp_f32 v159, v159
    v_mfma_f32_16x16x32_bf16 v[168:171], a[196:199], a[52:55], v[168:171]
    v_exp_f32 v40, v40
    v_mfma_f32_16x16x32_bf16 v[168:171], a[192:195], a[36:39], v[168:171]
    v_exp_f32 v41, v41
    v_mfma_f32_16x16x32_bf16 v[168:171], a[188:191], a[20:23], v[168:171]
    v_exp_f32 v42, v42
    v_mfma_f32_16x16x32_bf16 v[168:171], a[184:187], a[4:7], v[168:171]
    v_exp_f32 v43, v43
    v_mfma_f32_16x16x32_bf16 v[176:179], a[184:187], a[8:11], 0
    s_addk_i32 m0, 896
    v_cvt_pk_bf16_f32 v157, v158, v159
    v_cvt_pk_bf16_f32 v134, v40, v41
    v_mfma_f32_16x16x32_bf16 v[176:179], a[188:191], a[24:27], v[176:179]
    v_exp_f32 v44, v44
    v_mfma_f32_16x16x32_bf16 v[176:179], a[192:195], a[40:43], v[176:179]
    v_exp_f32 v45, v45
    v_mfma_f32_16x16x32_bf16 v[176:179], a[196:199], a[56:59], v[176:179]
    v_exp_f32 v46, v46
    v_mfma_f32_16x16x32_bf16 v[176:179], a[200:203], a[72:75], v[176:179]
    v_exp_f32 v47, v47
    v_mfma_f32_16x16x32_bf16 v[176:179], a[204:207], a[88:91], v[176:179]
    v_cvt_pk_bf16_f32 v135, v42, v43
    v_cvt_pk_bf16_f32 v142, v44, v45
    v_mfma_f32_16x16x32_bf16 v[184:187], a[204:207], a[92:95], 0
    buffer_load_dwordx4 v5, s[12:15], s38 offen offset:128 lds
    v_mfma_f32_16x16x32_bf16 v[184:187], a[200:203], a[76:79], v[184:187]
    ds_read_b64_tr_b16 a[232:233], v8 offset:16384
    v_cvt_pk_bf16_f32 v143, v46, v47
    v_mfma_f32_16x16x32_bf16 v[184:187], a[196:199], a[60:63], v[184:187]
    ds_read_b64_tr_b16 a[234:235], v8 offset:18432
    v_accvgpr_write_b32 a113, v81
    v_mfma_f32_16x16x32_bf16 v[184:187], a[192:195], a[44:47], v[184:187]
    s_waitcnt lgkmcnt(2)
    ds_read_b64_tr_b16 a[236:237], v9 offset:16384
    v_accvgpr_write_b32 a114, v82
    v_mfma_f32_16x16x32_bf16 v[184:187], a[188:191], a[28:31], v[184:187]
    v_exp_f32 v48, v48
    v_mfma_f32_16x16x32_bf16 v[184:187], a[184:187], a[12:15], v[184:187]
    v_exp_f32 v49, v49
    v_mfma_f32_16x16x32_bf16 v[24:27], a[208:211], a[0:3], 0
    s_addk_i32 m0, 896
    ds_read_b64_tr_b16 a[238:239], v9 offset:18432
    v_cvt_pk_bf16_f32 v150, v48, v49
    v_mfma_f32_16x16x32_bf16 v[24:27], a[212:215], a[16:19], v[24:27]
    v_exp_f32 v50, v50
    v_mfma_f32_16x16x32_bf16 v[24:27], a[216:219], a[32:35], v[24:27]
    ds_read_b128 a[184:187], v12 offset:12288
    v_accvgpr_write_b32 a115, v83
    v_mfma_f32_16x16x32_bf16 v[24:27], a[220:223], a[48:51], v[24:27]
    v_exp_f32 v51, v51
    v_mfma_f32_16x16x32_bf16 v[24:27], a[224:227], a[64:67], v[24:27]
    ds_read_b128 a[188:191], v13 offset:12288
    v_cvt_pk_bf16_f32 v151, v50, v51
    v_mfma_f32_16x16x32_bf16 v[24:27], a[228:231], a[80:83], v[24:27]
    v_exp_f32 v52, v52
    v_mfma_f32_16x16x32_bf16 v[28:31], a[228:231], a[84:87], 0
    buffer_load_dwordx4 v5, s[12:15], s38 offen offset:256 lds
    v_mfma_f32_16x16x32_bf16 v[28:31], a[224:227], a[68:71], v[28:31]
    s_add_u32 s38, s38, 24576
    v_exp_f32 v53, v53
    v_mfma_f32_16x16x32_bf16 v[28:31], a[220:223], a[52:55], v[28:31]
    ds_read_b128 a[192:195], v12 offset:13312
    v_cvt_pk_bf16_f32 v158, v52, v53
    v_mfma_f32_16x16x32_bf16 v[28:31], a[216:219], a[36:39], v[28:31]
    ds_read_b128 a[196:199], v13 offset:13312
    v_accvgpr_write_b32 a116, v84
    v_mfma_f32_16x16x32_bf16 v[28:31], a[212:215], a[20:23], v[28:31]
    s_add_u32 s39, s40, 122880
    v_exp_f32 v54, v54
    v_mfma_f32_16x16x32_bf16 v[28:31], a[208:211], a[4:7], v[28:31]
    v_exp_f32 v55, v55
    v_mfma_f32_16x16x32_bf16 v[32:35], a[208:211], a[8:11], 0
    s_add_u32 m0, s63, 114688
    ds_read_b128 a[200:203], v12 offset:14336
    v_cvt_pk_bf16_f32 v159, v54, v55
    v_mfma_f32_16x16x32_bf16 v[32:35], a[212:215], a[24:27], v[32:35]
    v_exp_f32 v160, v160
    v_mfma_f32_16x16x32_bf16 v[32:35], a[216:219], a[40:43], v[32:35]
    v_exp_f32 v161, v161
    v_mfma_f32_16x16x32_bf16 v[32:35], a[220:223], a[56:59], v[32:35]
    ds_read_b128 a[204:207], v13 offset:14336
    v_cvt_pk_bf16_f32 v160, v160, v161
    v_mfma_f32_16x16x32_bf16 v[32:35], a[224:227], a[72:75], v[32:35]
    v_exp_f32 v162, v162
    v_mfma_f32_16x16x32_bf16 v[32:35], a[228:231], a[88:91], v[32:35]
    v_exp_f32 v163, v163
    v_mfma_f32_16x16x32_bf16 v[36:39], a[228:231], a[92:95], 0
    buffer_load_dwordx4 v6, s[16:19], s39 offen lds
    v_mfma_f32_16x16x32_bf16 v[36:39], a[224:227], a[76:79], v[36:39]
    v_exp_f32 v168, v168
    v_mfma_f32_16x16x32_bf16 v[36:39], a[220:223], a[60:63], v[36:39]
    v_exp_f32 v169, v169
    v_mfma_f32_16x16x32_bf16 v[36:39], a[216:219], a[44:47], v[36:39]
    s_waitcnt lgkmcnt(1)
    v_exp_f32 v170, v170
    v_mfma_f32_16x16x32_bf16 v[36:39], a[212:215], a[28:31], v[36:39]
    s_add_u32 s39, s40, 135168
    v_exp_f32 v171, v171
    v_mfma_f32_16x16x32_bf16 v[36:39], a[208:211], a[12:15], v[36:39]
    v_exp_f32 v176, v176
    v_mfma_f32_16x16x32_bf16 a[152:155], a[232:235], v[128:131], a[152:155]
    s_addk_i32 m0, 4096
    v_cvt_pk_bf16_f32 v161, v162, v163
    v_cvt_pk_bf16_f32 v168, v168, v169
    v_mfma_f32_16x16x32_bf16 a[168:171], a[236:239], v[128:131], a[168:171]
    v_exp_f32 v177, v177
    v_mfma_f32_16x16x32_bf16 a[172:175], a[236:239], v[136:139], a[172:175]
    ds_read_b128 a[208:211], v12 offset:18432
    v_cvt_pk_bf16_f32 v169, v170, v171
    v_mfma_f32_16x16x32_bf16 a[156:159], a[232:235], v[136:139], a[156:159]
    ds_read_b128 a[212:215], v13 offset:18432
    v_cvt_pk_bf16_f32 v176, v176, v177
    v_mfma_f32_16x16x32_bf16 a[160:163], a[232:235], v[144:147], a[160:163]
    ds_read_b128 a[216:219], v12 offset:19456
    v_accvgpr_write_b32 a117, v85
    v_mfma_f32_16x16x32_bf16 a[176:179], a[236:239], v[144:147], a[176:179]
    ds_read_b128 a[220:223], v13 offset:19456
    v_accvgpr_write_b32 a118, v86
    v_mfma_f32_16x16x32_bf16 a[180:183], a[236:239], v[152:155], a[180:183]
    buffer_load_dwordx4 v6, s[16:19], s39 offen lds
    v_mfma_f32_16x16x32_bf16 a[164:167], a[232:235], v[152:155], a[164:167]
    ds_read_b128 a[224:227], v12 offset:20480
    v_accvgpr_write_b32 a119, v87
    v_mfma_f32_16x16x32_bf16 v[164:167], a[184:187], a[0:3], 0
    v_exp_f32 v178, v178
    v_mfma_f32_16x16x32_bf16 v[164:167], a[188:191], a[16:19], v[164:167]
    v_exp_f32 v179, v179
    v_mfma_f32_16x16x32_bf16 v[164:167], a[192:195], a[32:35], v[164:167]
    s_waitcnt lgkmcnt(3)
    ds_read_b128 a[228:231], v13 offset:20480
    v_cvt_pk_bf16_f32 v177, v178, v179
    v_mfma_f32_16x16x32_bf16 v[164:167], a[196:199], a[48:51], v[164:167]
    v_exp_f32 v184, v184
    v_mfma_f32_16x16x32_bf16 v[164:167], a[200:203], a[64:67], v[164:167]
    v_exp_f32 v185, v185
    v_mfma_f32_16x16x32_bf16 v[164:167], a[204:207], a[80:83], v[164:167]
    v_exp_f32 v186, v186
    v_mfma_f32_16x16x32_bf16 v[172:175], a[204:207], a[84:87], 0
    v_exp_f32 v187, v187
    v_mfma_f32_16x16x32_bf16 v[172:175], a[200:203], a[68:71], v[172:175]
    v_exp_f32 v24, v24
    v_mfma_f32_16x16x32_bf16 v[172:175], a[196:199], a[52:55], v[172:175]
    v_exp_f32 v25, v25
    v_mfma_f32_16x16x32_bf16 v[172:175], a[192:195], a[36:39], v[172:175]
    v_exp_f32 v26, v26
    v_mfma_f32_16x16x32_bf16 v[172:175], a[188:191], a[20:23], v[172:175]
    v_exp_f32 v27, v27
    v_mfma_f32_16x16x32_bf16 v[172:175], a[184:187], a[4:7], v[172:175]
    v_cvt_pk_bf16_f32 v184, v184, v185
    v_cvt_pk_bf16_f32 v185, v186, v187
    v_mfma_f32_16x16x32_bf16 v[180:183], a[184:187], a[8:11], 0
    v_exp_f32 v28, v28
    v_mfma_f32_16x16x32_bf16 v[180:183], a[188:191], a[24:27], v[180:183]
    v_exp_f32 v29, v29
    v_mfma_f32_16x16x32_bf16 v[180:183], a[192:195], a[40:43], v[180:183]
    v_exp_f32 v30, v30
    v_mfma_f32_16x16x32_bf16 v[180:183], a[196:199], a[56:59], v[180:183]
    v_exp_f32 v31, v31
    v_mfma_f32_16x16x32_bf16 v[180:183], a[200:203], a[72:75], v[180:183]
    v_cvt_pk_bf16_f32 v162, v24, v25
    v_cvt_pk_bf16_f32 v163, v26, v27
    v_mfma_f32_16x16x32_bf16 v[180:183], a[204:207], a[88:91], v[180:183]
    v_exp_f32 v32, v32
    v_mfma_f32_16x16x32_bf16 v[188:191], a[204:207], a[92:95], 0
    v_exp_f32 v33, v33
    v_mfma_f32_16x16x32_bf16 v[188:191], a[200:203], a[76:79], v[188:191]
    v_exp_f32 v34, v34
    v_mfma_f32_16x16x32_bf16 v[188:191], a[196:199], a[60:63], v[188:191]
    s_add_u32 m0, s49, 0
    v_exp_f32 v35, v35
    v_mfma_f32_16x16x32_bf16 v[188:191], a[192:195], a[44:47], v[188:191]
    v_cvt_pk_bf16_f32 v170, v28, v29
    v_cvt_pk_bf16_f32 v171, v30, v31
    v_mfma_f32_16x16x32_bf16 v[188:191], a[188:191], a[28:31], v[188:191]
    v_exp_f32 v36, v36
    v_mfma_f32_16x16x32_bf16 v[188:191], a[184:187], a[12:15], v[188:191]
    s_waitcnt lgkmcnt(0)
    v_exp_f32 v37, v37
    v_mfma_f32_16x16x32_bf16 v[40:43], a[208:211], a[0:3], 0
    s_waitcnt vmcnt(11)
    v_exp_f32 v38, v38
    v_mfma_f32_16x16x32_bf16 v[40:43], a[212:215], a[16:19], v[40:43]
    s_barrier
    v_mfma_f32_16x16x32_bf16 v[40:43], a[216:219], a[32:35], v[40:43]
    buffer_load_dwordx4 v4, s[12:15], s38 offen offset:0 lds
    v_mfma_f32_16x16x32_bf16 v[40:43], a[220:223], a[48:51], v[40:43]
    ds_read_b64_tr_b16 a[240:241], v8 offset:20480
    v_cvt_pk_bf16_f32 v178, v32, v33
    v_mfma_f32_16x16x32_bf16 v[40:43], a[224:227], a[64:67], v[40:43]
    ds_read_b64_tr_b16 a[242:243], v8 offset:22528
    v_cvt_pk_bf16_f32 v179, v34, v35
    v_mfma_f32_16x16x32_bf16 v[40:43], a[228:231], a[80:83], v[40:43]
    ds_read_b64_tr_b16 a[244:245], v9 offset:20480
    v_cvt_pk_bf16_f32 v186, v36, v37
    v_mfma_f32_16x16x32_bf16 v[44:47], a[228:231], a[84:87], 0
    ds_read_b64_tr_b16 a[246:247], v9 offset:22528
    v_accvgpr_write_b32 a120, v88
    v_mfma_f32_16x16x32_bf16 v[44:47], a[224:227], a[68:71], v[44:47]
    ds_read_b128 a[184:187], v12 offset:24576
    v_accvgpr_write_b32 a121, v89
    v_mfma_f32_16x16x32_bf16 v[44:47], a[220:223], a[52:55], v[44:47]
    s_addk_i32 m0, 896
    ds_read_b128 a[188:191], v13 offset:24576
    v_accvgpr_write_b32 a122, v90
    v_mfma_f32_16x16x32_bf16 v[44:47], a[216:219], a[36:39], v[44:47]
    ds_read_b128 a[192:195], v12 offset:25600
    v_accvgpr_write_b32 a123, v91
    v_mfma_f32_16x16x32_bf16 v[44:47], a[212:215], a[20:23], v[44:47]
    v_exp_f32 v39, v39
    v_mfma_f32_16x16x32_bf16 v[44:47], a[208:211], a[4:7], v[44:47]
    ds_read_b128 a[196:199], v13 offset:25600
    v_cvt_pk_bf16_f32 v187, v38, v39
    v_mfma_f32_16x16x32_bf16 v[48:51], a[208:211], a[8:11], 0
    buffer_load_dword a252, v22, s[32:35], s42 offen offset:1536
    s_add_u32 s42, s42, 3072
    v_mfma_f32_16x16x32_bf16 v[48:51], a[212:215], a[24:27], v[48:51]
    v_exp_f32 v164, v164
    v_mfma_f32_16x16x32_bf16 v[48:51], a[216:219], a[40:43], v[48:51]
    buffer_load_dwordx4 v4, s[12:15], s38 offen offset:128 lds
    v_mfma_f32_16x16x32_bf16 v[48:51], a[220:223], a[56:59], v[48:51]
    ds_read_b128 a[200:203], v12 offset:26624
    v_accvgpr_write_b32 a124, v92
    v_mfma_f32_16x16x32_bf16 v[48:51], a[224:227], a[72:75], v[48:51]
    v_exp_f32 v165, v165
    v_mfma_f32_16x16x32_bf16 v[48:51], a[228:231], a[88:91], v[48:51]
    ds_read_b128 a[204:207], v13 offset:26624
    v_cvt_pk_bf16_f32 v164, v164, v165
    v_mfma_f32_16x16x32_bf16 v[52:55], a[228:231], a[92:95], 0
    v_exp_f32 v166, v166
    v_mfma_f32_16x16x32_bf16 v[52:55], a[224:227], a[76:79], v[52:55]
    v_exp_f32 v167, v167
    v_mfma_f32_16x16x32_bf16 v[52:55], a[220:223], a[60:63], v[52:55]
    s_addk_i32 m0, 896
    v_exp_f32 v172, v172
    v_mfma_f32_16x16x32_bf16 v[52:55], a[216:219], a[44:47], v[52:55]
    s_waitcnt lgkmcnt(2)
    v_exp_f32 v173, v173
    v_mfma_f32_16x16x32_bf16 v[52:55], a[212:215], a[28:31], v[52:55]
    v_exp_f32 v174, v174
    v_mfma_f32_16x16x32_bf16 v[52:55], a[208:211], a[12:15], v[52:55]
    v_exp_f32 v175, v175
    v_mfma_f32_16x16x32_bf16 a[164:167], a[240:243], v[156:159], a[164:167]
    v_exp_f32 v180, v180
    v_mfma_f32_16x16x32_bf16 a[180:183], a[244:247], v[156:159], a[180:183]
    v_exp_f32 v181, v181
    v_mfma_f32_16x16x32_bf16 a[176:179], a[244:247], v[148:151], a[176:179]
    buffer_load_dwordx4 v4, s[12:15], s38 offen offset:256 lds
    v_mfma_f32_16x16x32_bf16 a[160:163], a[240:243], v[148:151], a[160:163]
    ds_read_b128 a[208:211], v12 offset:30720
    v_cvt_pk_bf16_f32 v165, v166, v167
    v_mfma_f32_16x16x32_bf16 a[156:159], a[240:243], v[140:143], a[156:159]
    ds_read_b128 a[212:215], v13 offset:30720
    v_cvt_pk_bf16_f32 v172, v172, v173
    v_mfma_f32_16x16x32_bf16 a[172:175], a[244:247], v[140:143], a[172:175]
    ds_read_b128 a[216:219], v12 offset:31744
    v_cvt_pk_bf16_f32 v173, v174, v175
    v_mfma_f32_16x16x32_bf16 a[168:171], a[244:247], v[132:135], a[168:171]
    ds_read_b128 a[220:223], v13 offset:31744
    v_cvt_pk_bf16_f32 v180, v180, v181
    v_mfma_f32_16x16x32_bf16 a[152:155], a[240:243], v[132:135], a[152:155]
    ds_read_b128 a[224:227], v12 offset:32768
    v_accvgpr_write_b32 a125, v93
    v_mfma_f32_16x16x32_bf16 v[192:195], a[184:187], a[0:3], 0
    s_addk_i32 m0, 1280
    ds_read_b128 a[228:231], v13 offset:32768
    v_accvgpr_write_b32 a126, v94
    v_mfma_f32_16x16x32_bf16 v[192:195], a[188:191], a[16:19], v[192:195]
    s_waitcnt lgkmcnt(6)
    v_exp_f32 v182, v182
    v_mfma_f32_16x16x32_bf16 v[192:195], a[192:195], a[32:35], v[192:195]
    v_exp_f32 v183, v183
    v_mfma_f32_16x16x32_bf16 v[192:195], a[196:199], a[48:51], v[192:195]
    v_exp_f32 v188, v188
    v_mfma_f32_16x16x32_bf16 v[192:195], a[200:203], a[64:67], v[192:195]
    v_exp_f32 v189, v189
    v_mfma_f32_16x16x32_bf16 v[192:195], a[204:207], a[80:83], v[192:195]
    v_exp_f32 v190, v190
    v_mfma_f32_16x16x32_bf16 v[200:203], a[204:207], a[84:87], 0
    buffer_load_dwordx4 v5, s[12:15], s38 offen offset:0 lds
    v_mfma_f32_16x16x32_bf16 v[200:203], a[200:203], a[68:71], v[200:203]
    v_exp_f32 v191, v191
    v_mfma_f32_16x16x32_bf16 v[200:203], a[196:199], a[52:55], v[200:203]
    v_exp_f32 v40, v40
    v_mfma_f32_16x16x32_bf16 v[200:203], a[192:195], a[36:39], v[200:203]
    v_exp_f32 v41, v41
    v_mfma_f32_16x16x32_bf16 v[200:203], a[188:191], a[20:23], v[200:203]
    v_cvt_pk_bf16_f32 v181, v182, v183
    v_cvt_pk_bf16_f32 v188, v188, v189
    v_mfma_f32_16x16x32_bf16 v[200:203], a[184:187], a[4:7], v[200:203]
    v_exp_f32 v42, v42
    v_mfma_f32_16x16x32_bf16 v[208:211], a[184:187], a[8:11], 0
    s_addk_i32 m0, 896
    v_exp_f32 v43, v43
    v_mfma_f32_16x16x32_bf16 v[208:211], a[188:191], a[24:27], v[208:211]
    v_cvt_pk_bf16_f32 v189, v190, v191
    v_cvt_pk_bf16_f32 v166, v40, v41
    v_mfma_f32_16x16x32_bf16 v[208:211], a[192:195], a[40:43], v[208:211]
    v_exp_f32 v44, v44
    v_mfma_f32_16x16x32_bf16 v[208:211], a[196:199], a[56:59], v[208:211]
    v_exp_f32 v45, v45
    v_mfma_f32_16x16x32_bf16 v[208:211], a[200:203], a[72:75], v[208:211]
    v_exp_f32 v46, v46
    v_mfma_f32_16x16x32_bf16 v[208:211], a[204:207], a[88:91], v[208:211]
    v_exp_f32 v47, v47
    v_mfma_f32_16x16x32_bf16 v[216:219], a[204:207], a[92:95], 0
    buffer_load_dwordx4 v5, s[12:15], s38 offen offset:128 lds
    v_mfma_f32_16x16x32_bf16 v[216:219], a[200:203], a[76:79], v[216:219]
    ds_read_b64_tr_b16 a[232:233], v8 offset:24576
    v_cvt_pk_bf16_f32 v167, v42, v43
    v_mfma_f32_16x16x32_bf16 v[216:219], a[196:199], a[60:63], v[216:219]
    ds_read_b64_tr_b16 a[234:235], v8 offset:26624
    v_cvt_pk_bf16_f32 v174, v44, v45
    v_mfma_f32_16x16x32_bf16 v[216:219], a[192:195], a[44:47], v[216:219]
    s_waitcnt lgkmcnt(2)
    ds_read_b64_tr_b16 a[236:237], v9 offset:24576
    v_cvt_pk_bf16_f32 v175, v46, v47
    v_mfma_f32_16x16x32_bf16 v[216:219], a[188:191], a[28:31], v[216:219]
    ds_read_b64_tr_b16 a[238:239], v9 offset:26624
    v_accvgpr_write_b32 a127, v95
    v_mfma_f32_16x16x32_bf16 v[216:219], a[184:187], a[12:15], v[216:219]
    v_exp_f32 v48, v48
    v_mfma_f32_16x16x32_bf16 v[24:27], a[208:211], a[0:3], 0
    s_addk_i32 m0, 896
    v_exp_f32 v49, v49
    v_mfma_f32_16x16x32_bf16 v[24:27], a[212:215], a[16:19], v[24:27]
    v_exp_f32 v50, v50
    v_mfma_f32_16x16x32_bf16 v[24:27], a[216:219], a[32:35], v[24:27]
    ds_read_b128 a[184:187], v12 offset:36864
    v_cvt_pk_bf16_f32 v182, v48, v49
    v_mfma_f32_16x16x32_bf16 v[24:27], a[220:223], a[48:51], v[24:27]
    ds_read_b128 a[188:191], v13 offset:36864
    v_accvgpr_write_b32 a128, v96
    v_mfma_f32_16x16x32_bf16 v[24:27], a[224:227], a[64:67], v[24:27]
    ds_read_b128 a[192:195], v12 offset:37888
    v_accvgpr_write_b32 a129, v97
    v_mfma_f32_16x16x32_bf16 v[24:27], a[228:231], a[80:83], v[24:27]
    ds_read_b128 a[196:199], v13 offset:37888
    v_accvgpr_write_b32 a130, v98
    v_mfma_f32_16x16x32_bf16 v[28:31], a[228:231], a[84:87], 0
    buffer_load_dwordx4 v5, s[12:15], s38 offen offset:256 lds
    v_mfma_f32_16x16x32_bf16 v[28:31], a[224:227], a[68:71], v[28:31]
    s_add_u32 s38, s38, 24576
    v_exp_f32 v51, v51
    v_mfma_f32_16x16x32_bf16 v[28:31], a[220:223], a[52:55], v[28:31]
    ds_read_b128 a[200:203], v12 offset:38912
    v_cvt_pk_bf16_f32 v183, v50, v51
    v_mfma_f32_16x16x32_bf16 v[28:31], a[216:219], a[36:39], v[28:31]
    v_exp_f32 v52, v52
    v_mfma_f32_16x16x32_bf16 v[28:31], a[212:215], a[20:23], v[28:31]
    s_add_u32 s39, s40, 147456
    v_exp_f32 v53, v53
    v_mfma_f32_16x16x32_bf16 v[28:31], a[208:211], a[4:7], v[28:31]
    ds_read_b128 a[204:207], v13 offset:38912
    v_cvt_pk_bf16_f32 v190, v52, v53
    v_mfma_f32_16x16x32_bf16 v[32:35], a[208:211], a[8:11], 0
    s_add_u32 m0, s63, 122880
    v_exp_f32 v54, v54
    v_mfma_f32_16x16x32_bf16 v[32:35], a[212:215], a[24:27], v[32:35]
    v_exp_f32 v55, v55
    v_mfma_f32_16x16x32_bf16 v[32:35], a[216:219], a[40:43], v[32:35]
    v_exp_f32 v192, v192
    v_mfma_f32_16x16x32_bf16 v[32:35], a[220:223], a[56:59], v[32:35]
    v_exp_f32 v193, v193
    v_mfma_f32_16x16x32_bf16 v[32:35], a[224:227], a[72:75], v[32:35]
    v_exp_f32 v194, v194
    v_mfma_f32_16x16x32_bf16 v[32:35], a[228:231], a[88:91], v[32:35]
    v_exp_f32 v195, v195
    v_mfma_f32_16x16x32_bf16 v[36:39], a[228:231], a[92:95], 0
    buffer_load_dwordx4 v6, s[16:19], s39 offen lds
    v_mfma_f32_16x16x32_bf16 v[36:39], a[224:227], a[76:79], v[36:39]
    v_exp_f32 v200, v200
    v_mfma_f32_16x16x32_bf16 v[36:39], a[220:223], a[60:63], v[36:39]
    v_exp_f32 v201, v201
    v_mfma_f32_16x16x32_bf16 v[36:39], a[216:219], a[44:47], v[36:39]
    s_waitcnt lgkmcnt(0)
    v_cvt_pk_bf16_f32 v191, v54, v55
    v_cvt_pk_bf16_f32 v192, v192, v193
    v_mfma_f32_16x16x32_bf16 v[36:39], a[212:215], a[28:31], v[36:39]
    s_add_u32 s39, s40, 159744
    v_exp_f32 v202, v202
    v_mfma_f32_16x16x32_bf16 v[36:39], a[208:211], a[12:15], v[36:39]
    v_exp_f32 v203, v203
    v_mfma_f32_16x16x32_bf16 a[152:155], a[232:235], v[160:163], a[152:155]
    s_addk_i32 m0, 4096
    v_cvt_pk_bf16_f32 v193, v194, v195
    v_cvt_pk_bf16_f32 v200, v200, v201
    v_mfma_f32_16x16x32_bf16 a[168:171], a[236:239], v[160:163], a[168:171]
    v_exp_f32 v208, v208
    v_mfma_f32_16x16x32_bf16 a[172:175], a[236:239], v[168:171], a[172:175]
    ds_read_b128 a[208:211], v12 offset:43008
    v_cvt_pk_bf16_f32 v201, v202, v203
    v_mfma_f32_16x16x32_bf16 a[156:159], a[232:235], v[168:171], a[156:159]
    ds_read_b128 a[212:215], v13 offset:43008
    v_accvgpr_write_b32 a131, v99
    v_mfma_f32_16x16x32_bf16 a[160:163], a[232:235], v[176:179], a[160:163]
    ds_read_b128 a[216:219], v12 offset:44032
    v_accvgpr_write_b32 a132, v100
    v_mfma_f32_16x16x32_bf16 a[176:179], a[236:239], v[176:179], a[176:179]
    ds_read_b128 a[220:223], v13 offset:44032
    v_accvgpr_write_b32 a133, v101
    v_mfma_f32_16x16x32_bf16 a[180:183], a[236:239], v[184:187], a[180:183]
    buffer_load_dwordx4 v6, s[16:19], s39 offen lds
    v_mfma_f32_16x16x32_bf16 a[164:167], a[232:235], v[184:187], a[164:167]
    v_exp_f32 v209, v209
    v_mfma_f32_16x16x32_bf16 v[196:199], a[184:187], a[0:3], 0
    ds_read_b128 a[224:227], v12 offset:45056
    v_cvt_pk_bf16_f32 v208, v208, v209
    v_mfma_f32_16x16x32_bf16 v[196:199], a[188:191], a[16:19], v[196:199]
    v_exp_f32 v210, v210
    v_mfma_f32_16x16x32_bf16 v[196:199], a[192:195], a[32:35], v[196:199]
    v_exp_f32 v211, v211
    v_mfma_f32_16x16x32_bf16 v[196:199], a[196:199], a[48:51], v[196:199]
    ds_read_b128 a[228:231], v13 offset:45056
    v_cvt_pk_bf16_f32 v209, v210, v211
    v_mfma_f32_16x16x32_bf16 v[196:199], a[200:203], a[64:67], v[196:199]
    v_exp_f32 v216, v216
    v_mfma_f32_16x16x32_bf16 v[196:199], a[204:207], a[80:83], v[196:199]
    v_exp_f32 v217, v217
    v_mfma_f32_16x16x32_bf16 v[204:207], a[204:207], a[84:87], 0
    v_exp_f32 v218, v218
    v_mfma_f32_16x16x32_bf16 v[204:207], a[200:203], a[68:71], v[204:207]
    v_exp_f32 v219, v219
    v_mfma_f32_16x16x32_bf16 v[204:207], a[196:199], a[52:55], v[204:207]
    v_exp_f32 v24, v24
    v_mfma_f32_16x16x32_bf16 v[204:207], a[192:195], a[36:39], v[204:207]
    v_exp_f32 v25, v25
    v_mfma_f32_16x16x32_bf16 v[204:207], a[188:191], a[20:23], v[204:207]
    v_exp_f32 v26, v26
    v_mfma_f32_16x16x32_bf16 v[204:207], a[184:187], a[4:7], v[204:207]
    v_exp_f32 v27, v27
    v_mfma_f32_16x16x32_bf16 v[212:215], a[184:187], a[8:11], 0
    v_cvt_pk_bf16_f32 v216, v216, v217
    v_cvt_pk_bf16_f32 v217, v218, v219
    v_mfma_f32_16x16x32_bf16 v[212:215], a[188:191], a[24:27], v[212:215]
    v_exp_f32 v28, v28
    v_mfma_f32_16x16x32_bf16 v[212:215], a[192:195], a[40:43], v[212:215]
    v_exp_f32 v29, v29
    v_mfma_f32_16x16x32_bf16 v[212:215], a[196:199], a[56:59], v[212:215]
    v_exp_f32 v30, v30
    v_mfma_f32_16x16x32_bf16 v[212:215], a[200:203], a[72:75], v[212:215]
    v_exp_f32 v31, v31
    v_mfma_f32_16x16x32_bf16 v[212:215], a[204:207], a[88:91], v[212:215]
    v_cvt_pk_bf16_f32 v194, v24, v25
    v_cvt_pk_bf16_f32 v195, v26, v27
    v_mfma_f32_16x16x32_bf16 v[220:223], a[204:207], a[92:95], 0
    v_exp_f32 v32, v32
    v_mfma_f32_16x16x32_bf16 v[220:223], a[200:203], a[76:79], v[220:223]
    v_exp_f32 v33, v33
    v_mfma_f32_16x16x32_bf16 v[220:223], a[196:199], a[60:63], v[220:223]
    s_add_u32 m0, s49, 24576
    v_exp_f32 v34, v34
    v_mfma_f32_16x16x32_bf16 v[220:223], a[192:195], a[44:47], v[220:223]
    s_waitcnt lgkmcnt(0)
    v_exp_f32 v35, v35
    v_mfma_f32_16x16x32_bf16 v[220:223], a[188:191], a[28:31], v[220:223]
    v_cvt_pk_bf16_f32 v202, v28, v29
    v_cvt_pk_bf16_f32 v203, v30, v31
    v_mfma_f32_16x16x32_bf16 v[220:223], a[184:187], a[12:15], v[220:223]
    v_exp_f32 v36, v36
    v_mfma_f32_16x16x32_bf16 v[40:43], a[208:211], a[0:3], 0
    s_waitcnt vmcnt(11)
    v_exp_f32 v37, v37
    v_mfma_f32_16x16x32_bf16 v[40:43], a[212:215], a[16:19], v[40:43]
    s_barrier
    v_mfma_f32_16x16x32_bf16 v[40:43], a[216:219], a[32:35], v[40:43]
    buffer_load_dwordx4 v4, s[12:15], s38 offen offset:0 lds
    v_mfma_f32_16x16x32_bf16 v[40:43], a[220:223], a[48:51], v[40:43]
    ds_read_b64_tr_b16 a[240:241], v8 offset:28672
    v_cvt_pk_bf16_f32 v210, v32, v33
    v_mfma_f32_16x16x32_bf16 v[40:43], a[224:227], a[64:67], v[40:43]
    ds_read_b64_tr_b16 a[242:243], v8 offset:30720
    v_cvt_pk_bf16_f32 v211, v34, v35
    v_mfma_f32_16x16x32_bf16 v[40:43], a[228:231], a[80:83], v[40:43]
    ds_read_b64_tr_b16 a[244:245], v9 offset:28672
    v_cvt_pk_bf16_f32 v218, v36, v37
    v_mfma_f32_16x16x32_bf16 v[44:47], a[228:231], a[84:87], 0
    ds_read_b64_tr_b16 a[246:247], v9 offset:30720
    v_accvgpr_write_b32 a134, v102
    v_mfma_f32_16x16x32_bf16 v[44:47], a[224:227], a[68:71], v[44:47]
    ds_read_b128 a[184:187], v12 offset:49152
    v_accvgpr_write_b32 a135, v103
    v_mfma_f32_16x16x32_bf16 v[44:47], a[220:223], a[52:55], v[44:47]
    s_addk_i32 m0, 896
    ds_read_b128 a[188:191], v13 offset:49152
    v_accvgpr_write_b32 a136, v104
    v_mfma_f32_16x16x32_bf16 v[44:47], a[216:219], a[36:39], v[44:47]
    ds_read_b128 a[192:195], v12 offset:50176
    v_accvgpr_write_b32 a137, v105
    v_mfma_f32_16x16x32_bf16 v[44:47], a[212:215], a[20:23], v[44:47]
    v_exp_f32 v38, v38
    v_mfma_f32_16x16x32_bf16 v[44:47], a[208:211], a[4:7], v[44:47]
    v_exp_f32 v39, v39
    v_mfma_f32_16x16x32_bf16 v[48:51], a[208:211], a[8:11], 0
    buffer_load_dword a252, v22, s[32:35], s42 offen offset:0
    v_mfma_f32_16x16x32_bf16 v[48:51], a[212:215], a[24:27], v[48:51]
    ds_read_b128 a[196:199], v13 offset:50176
    v_cvt_pk_bf16_f32 v219, v38, v39
    v_mfma_f32_16x16x32_bf16 v[48:51], a[216:219], a[40:43], v[48:51]
    buffer_load_dwordx4 v4, s[12:15], s38 offen offset:128 lds
    v_mfma_f32_16x16x32_bf16 v[48:51], a[220:223], a[56:59], v[48:51]
    ds_read_b128 a[200:203], v12 offset:51200
    v_accvgpr_write_b32 a138, v106
    v_mfma_f32_16x16x32_bf16 v[48:51], a[224:227], a[72:75], v[48:51]
    v_exp_f32 v196, v196
    v_mfma_f32_16x16x32_bf16 v[48:51], a[228:231], a[88:91], v[48:51]
    v_exp_f32 v197, v197
    v_mfma_f32_16x16x32_bf16 v[52:55], a[228:231], a[92:95], 0
    ds_read_b128 a[204:207], v13 offset:51200
    v_cvt_pk_bf16_f32 v196, v196, v197
    v_mfma_f32_16x16x32_bf16 v[52:55], a[224:227], a[76:79], v[52:55]
    v_exp_f32 v198, v198
    v_mfma_f32_16x16x32_bf16 v[52:55], a[220:223], a[60:63], v[52:55]
    s_addk_i32 m0, 896
    v_exp_f32 v199, v199
    v_mfma_f32_16x16x32_bf16 v[52:55], a[216:219], a[44:47], v[52:55]
    s_waitcnt lgkmcnt(2)
    v_exp_f32 v204, v204
    v_mfma_f32_16x16x32_bf16 v[52:55], a[212:215], a[28:31], v[52:55]
    v_exp_f32 v205, v205
    v_mfma_f32_16x16x32_bf16 v[52:55], a[208:211], a[12:15], v[52:55]
    v_exp_f32 v206, v206
    v_mfma_f32_16x16x32_bf16 a[164:167], a[240:243], v[188:191], a[164:167]
    v_exp_f32 v207, v207
    v_mfma_f32_16x16x32_bf16 a[180:183], a[244:247], v[188:191], a[180:183]
    v_exp_f32 v212, v212
    v_mfma_f32_16x16x32_bf16 a[176:179], a[244:247], v[180:183], a[176:179]
    buffer_load_dwordx4 v4, s[12:15], s38 offen offset:256 lds
    v_mfma_f32_16x16x32_bf16 a[160:163], a[240:243], v[180:183], a[160:163]
    ds_read_b128 a[208:211], v12 offset:55296
    v_cvt_pk_bf16_f32 v197, v198, v199
    v_mfma_f32_16x16x32_bf16 a[156:159], a[240:243], v[172:175], a[156:159]
    ds_read_b128 a[212:215], v13 offset:55296
    v_cvt_pk_bf16_f32 v204, v204, v205
    v_mfma_f32_16x16x32_bf16 a[172:175], a[244:247], v[172:175], a[172:175]
    ds_read_b128 a[216:219], v12 offset:56320
    v_cvt_pk_bf16_f32 v205, v206, v207
    v_mfma_f32_16x16x32_bf16 a[168:171], a[244:247], v[164:167], a[168:171]
pg_7:
    s_cbranch_execz pg_11
    ds_read_b128 a[220:223], v13 offset:56320
    v_accvgpr_write_b32 a139, v107
    v_mfma_f32_16x16x32_bf16 a[152:155], a[240:243], v[164:167], a[152:155]
    ds_read_b128 a[224:227], v12 offset:57344
    v_accvgpr_write_b32 a140, v108
    v_mfma_f32_16x16x32_bf16 v[224:227], a[184:187], a[0:3], 0
    s_addk_i32 m0, 1280
    v_exp_f32 v213, v213
    v_mfma_f32_16x16x32_bf16 v[224:227], a[188:191], a[16:19], v[224:227]
    s_waitcnt lgkmcnt(5)
    ds_read_b128 a[228:231], v13 offset:57344
    v_cvt_pk_bf16_f32 v212, v212, v213
    v_mfma_f32_16x16x32_bf16 v[224:227], a[192:195], a[32:35], v[224:227]
    v_exp_f32 v214, v214
    v_mfma_f32_16x16x32_bf16 v[224:227], a[196:199], a[48:51], v[224:227]
    v_exp_f32 v215, v215
    v_mfma_f32_16x16x32_bf16 v[224:227], a[200:203], a[64:67], v[224:227]
    v_exp_f32 v220, v220
    v_mfma_f32_16x16x32_bf16 v[224:227], a[204:207], a[80:83], v[224:227]
    v_exp_f32 v221, v221
    v_mfma_f32_16x16x32_bf16 v[232:235], a[204:207], a[84:87], 0
    buffer_load_dwordx4 v5, s[12:15], s38 offen offset:0 lds
    v_mfma_f32_16x16x32_bf16 v[232:235], a[200:203], a[68:71], v[232:235]
    v_exp_f32 v222, v222
    v_mfma_f32_16x16x32_bf16 v[232:235], a[196:199], a[52:55], v[232:235]
    v_exp_f32 v223, v223
    v_mfma_f32_16x16x32_bf16 v[232:235], a[192:195], a[36:39], v[232:235]
    v_exp_f32 v40, v40
    v_mfma_f32_16x16x32_bf16 v[232:235], a[188:191], a[20:23], v[232:235]
    v_exp_f32 v41, v41
    v_mfma_f32_16x16x32_bf16 v[232:235], a[184:187], a[4:7], v[232:235]
    v_cvt_pk_bf16_f32 v213, v214, v215
    v_cvt_pk_bf16_f32 v220, v220, v221
    v_mfma_f32_16x16x32_bf16 v[240:243], a[184:187], a[8:11], 0
    s_addk_i32 m0, 896
    v_exp_f32 v42, v42
    v_mfma_f32_16x16x32_bf16 v[240:243], a[188:191], a[24:27], v[240:243]
    v_exp_f32 v43, v43
    v_mfma_f32_16x16x32_bf16 v[240:243], a[192:195], a[40:43], v[240:243]
    v_cvt_pk_bf16_f32 v221, v222, v223
    v_cvt_pk_bf16_f32 v198, v40, v41
    v_mfma_f32_16x16x32_bf16 v[240:243], a[196:199], a[56:59], v[240:243]
    v_exp_f32 v44, v44
    v_mfma_f32_16x16x32_bf16 v[240:243], a[200:203], a[72:75], v[240:243]
    v_exp_f32 v45, v45
    v_mfma_f32_16x16x32_bf16 v[240:243], a[204:207], a[88:91], v[240:243]
    v_exp_f32 v46, v46
    v_mfma_f32_16x16x32_bf16 v[248:251], a[204:207], a[92:95], 0
    buffer_load_dwordx4 v5, s[12:15], s38 offen offset:128 lds
    v_mfma_f32_16x16x32_bf16 v[248:251], a[200:203], a[76:79], v[248:251]
    ds_read_b64_tr_b16 a[232:233], v8 offset:32768
    v_cvt_pk_bf16_f32 v199, v42, v43
    v_mfma_f32_16x16x32_bf16 v[248:251], a[196:199], a[60:63], v[248:251]
    ds_read_b64_tr_b16 a[234:235], v8 offset:34816
    v_cvt_pk_bf16_f32 v206, v44, v45
    v_mfma_f32_16x16x32_bf16 v[248:251], a[192:195], a[44:47], v[248:251]
    s_waitcnt lgkmcnt(2)
    ds_read_b64_tr_b16 a[236:237], v9 offset:32768
    v_accvgpr_write_b32 a141, v109
    v_mfma_f32_16x16x32_bf16 v[248:251], a[188:191], a[28:31], v[248:251]
    ds_read_b64_tr_b16 a[238:239], v9 offset:34816
    v_accvgpr_write_b32 a142, v110
    v_mfma_f32_16x16x32_bf16 v[248:251], a[184:187], a[12:15], v[248:251]
    v_exp_f32 v47, v47
    v_mfma_f32_16x16x32_bf16 v[24:27], a[208:211], a[0:3], 0
    s_addk_i32 m0, 896
    v_exp_f32 v48, v48
    v_mfma_f32_16x16x32_bf16 v[24:27], a[212:215], a[16:19], v[24:27]
    v_exp_f32 v49, v49
    v_mfma_f32_16x16x32_bf16 v[24:27], a[216:219], a[32:35], v[24:27]
    ds_read_b128 a[184:187], v12 offset:61440
    v_cvt_pk_bf16_f32 v207, v46, v47
    v_mfma_f32_16x16x32_bf16 v[24:27], a[220:223], a[48:51], v[24:27]
    ds_read_b128 a[188:191], v13 offset:61440
    v_cvt_pk_bf16_f32 v214, v48, v49
    v_mfma_f32_16x16x32_bf16 v[24:27], a[224:227], a[64:67], v[24:27]
    ds_read_b128 a[192:195], v12 offset:62464
    v_accvgpr_write_b32 a143, v111
    v_mfma_f32_16x16x32_bf16 v[24:27], a[228:231], a[80:83], v[24:27]
    ds_read_b128 a[196:199], v13 offset:62464
    v_accvgpr_write_b32 a144, v112
    v_mfma_f32_16x16x32_bf16 v[28:31], a[228:231], a[84:87], 0
    buffer_load_dwordx4 v5, s[12:15], s38 offen offset:256 lds
    v_mfma_f32_16x16x32_bf16 v[28:31], a[224:227], a[68:71], v[28:31]
    s_add_u32 s38, s38, 24576
    v_exp_f32 v50, v50
    v_mfma_f32_16x16x32_bf16 v[28:31], a[220:223], a[52:55], v[28:31]
    v_exp_f32 v51, v51
    v_mfma_f32_16x16x32_bf16 v[28:31], a[216:219], a[36:39], v[28:31]
    ds_read_b128 a[200:203], v12 offset:63488
    v_cvt_pk_bf16_f32 v215, v50, v51
    v_mfma_f32_16x16x32_bf16 v[28:31], a[212:215], a[20:23], v[28:31]
    s_add_u32 s39, s40, 172032
    ds_read_b128 a[204:207], v13 offset:63488
    v_add_u32 v12, 67584, v12
    v_mfma_f32_16x16x32_bf16 v[28:31], a[208:211], a[4:7], v[28:31]
    v_exp_f32 v52, v52
    v_mfma_f32_16x16x32_bf16 v[32:35], a[208:211], a[8:11], 0
    s_add_u32 m0, s63, 131072
    v_exp_f32 v53, v53
    v_mfma_f32_16x16x32_bf16 v[32:35], a[212:215], a[24:27], v[32:35]
    v_exp_f32 v54, v54
    v_mfma_f32_16x16x32_bf16 v[32:35], a[216:219], a[40:43], v[32:35]
    v_exp_f32 v55, v55
    v_mfma_f32_16x16x32_bf16 v[32:35], a[220:223], a[56:59], v[32:35]
    v_cvt_pk_bf16_f32 v222, v52, v53
    v_cvt_pk_bf16_f32 v223, v54, v55
    v_mfma_f32_16x16x32_bf16 v[32:35], a[224:227], a[72:75], v[32:35]
    v_exp_f32 v224, v224
    v_mfma_f32_16x16x32_bf16 v[32:35], a[228:231], a[88:91], v[32:35]
    v_exp_f32 v225, v225
    v_mfma_f32_16x16x32_bf16 v[36:39], a[228:231], a[92:95], 0
    buffer_load_dwordx4 v6, s[16:19], s39 offen lds
    v_mfma_f32_16x16x32_bf16 v[36:39], a[224:227], a[76:79], v[36:39]
    v_exp_f32 v226, v226
    v_mfma_f32_16x16x32_bf16 v[36:39], a[220:223], a[60:63], v[36:39]
    v_exp_f32 v227, v227
    v_mfma_f32_16x16x32_bf16 v[36:39], a[216:219], a[44:47], v[36:39]
    s_waitcnt lgkmcnt(0)
    v_exp_f32 v232, v232
    v_mfma_f32_16x16x32_bf16 v[36:39], a[212:215], a[28:31], v[36:39]
    s_add_u32 s39, s40, 184320
    v_exp_f32 v233, v233
    v_mfma_f32_16x16x32_bf16 v[36:39], a[208:211], a[12:15], v[36:39]
    v_exp_f32 v234, v234
    v_mfma_f32_16x16x32_bf16 a[152:155], a[232:235], v[192:195], a[152:155]
    s_addk_i32 m0, 4096
    v_exp_f32 v235, v235
    v_mfma_f32_16x16x32_bf16 a[168:171], a[236:239], v[192:195], a[168:171]
    v_cvt_pk_bf16_f32 v224, v224, v225
    v_cvt_pk_bf16_f32 v225, v226, v227
    v_mfma_f32_16x16x32_bf16 a[172:175], a[236:239], v[200:203], a[172:175]
    ds_read_b128 a[208:211], v12 offset:0
    v_cvt_pk_bf16_f32 v232, v232, v233
    v_mfma_f32_16x16x32_bf16 a[156:159], a[232:235], v[200:203], a[156:159]
    v_exp_f32 v240, v240
    v_mfma_f32_16x16x32_bf16 a[160:163], a[232:235], v[208:211], a[160:163]
    v_exp_f32 v241, v241
    v_mfma_f32_16x16x32_bf16 a[176:179], a[236:239], v[208:211], a[176:179]
    v_exp_f32 v242, v242
    v_mfma_f32_16x16x32_bf16 a[180:183], a[236:239], v[216:219], a[180:183]
    buffer_load_dwordx4 v6, s[16:19], s39 offen lds
    v_mfma_f32_16x16x32_bf16 a[164:167], a[232:235], v[216:219], a[164:167]
    v_exp_f32 v243, v243
    v_mfma_f32_16x16x32_bf16 v[228:231], a[184:187], a[0:3], 0
    v_cvt_pk_bf16_f32 v233, v234, v235
    v_cvt_pk_bf16_f32 v240, v240, v241
    v_mfma_f32_16x16x32_bf16 v[228:231], a[188:191], a[16:19], v[228:231]
    v_exp_f32 v248, v248
    v_mfma_f32_16x16x32_bf16 v[228:231], a[192:195], a[32:35], v[228:231]
    v_exp_f32 v249, v249
    v_mfma_f32_16x16x32_bf16 v[228:231], a[196:199], a[48:51], v[228:231]
    v_exp_f32 v250, v250
    v_mfma_f32_16x16x32_bf16 v[228:231], a[200:203], a[64:67], v[228:231]
    v_exp_f32 v251, v251
    v_mfma_f32_16x16x32_bf16 v[228:231], a[204:207], a[80:83], v[228:231]
    v_cvt_pk_bf16_f32 v241, v242, v243
    v_cvt_pk_bf16_f32 v248, v248, v249
    v_mfma_f32_16x16x32_bf16 v[236:239], a[204:207], a[84:87], 0
    v_exp_f32 v24, v24
    v_mfma_f32_16x16x32_bf16 v[236:239], a[200:203], a[68:71], v[236:239]
    v_exp_f32 v25, v25
    v_mfma_f32_16x16x32_bf16 v[236:239], a[196:199], a[52:55], v[236:239]
    v_exp_f32 v26, v26
    v_mfma_f32_16x16x32_bf16 v[236:239], a[192:195], a[36:39], v[236:239]
    v_exp_f32 v27, v27
    v_mfma_f32_16x16x32_bf16 v[236:239], a[188:191], a[20:23], v[236:239]
    v_cvt_pk_bf16_f32 v249, v250, v251
    v_cvt_pk_bf16_f32 v226, v24, v25
    v_mfma_f32_16x16x32_bf16 v[236:239], a[184:187], a[4:7], v[236:239]
    v_exp_f32 v28, v28
    v_mfma_f32_16x16x32_bf16 v[244:247], a[184:187], a[8:11], 0
    v_exp_f32 v29, v29
    v_mfma_f32_16x16x32_bf16 v[244:247], a[188:191], a[24:27], v[244:247]
    v_exp_f32 v30, v30
    v_add_u32 v13, 67584, v13
    v_mfma_f32_16x16x32_bf16 v[244:247], a[192:195], a[40:43], v[244:247]
    ds_read_b128 a[212:215], v13 offset:0
    v_cvt_pk_bf16_f32 v227, v26, v27
    v_mfma_f32_16x16x32_bf16 v[244:247], a[196:199], a[56:59], v[244:247]
    ds_read_b128 a[216:219], v12 offset:1024
    v_cvt_pk_bf16_f32 v234, v28, v29
    v_mfma_f32_16x16x32_bf16 v[244:247], a[200:203], a[72:75], v[244:247]
    ds_read_b128 a[220:223], v13 offset:1024
    v_accvgpr_write_b32 a145, v113
    v_mfma_f32_16x16x32_bf16 v[244:247], a[204:207], a[88:91], v[244:247]
    ds_read_b128 a[224:227], v12 offset:2048
    v_accvgpr_write_b32 a146, v114
    v_mfma_f32_16x16x32_bf16 v[252:255], a[204:207], a[92:95], 0
    s_add_u32 s39, s40, 128
    ds_read_b128 a[228:231], v13 offset:2048
    v_accvgpr_write_b32 a147, v115
    v_mfma_f32_16x16x32_bf16 v[252:255], a[200:203], a[76:79], v[252:255]
    v_exp_f32 v31, v31
    v_mfma_f32_16x16x32_bf16 v[252:255], a[196:199], a[60:63], v[252:255]
    s_add_u32 m0, s63, 49152
    v_exp_f32 v32, v32
    v_mfma_f32_16x16x32_bf16 v[252:255], a[192:195], a[44:47], v[252:255]
    s_waitcnt lgkmcnt(4)
    v_exp_f32 v33, v33
    v_mfma_f32_16x16x32_bf16 v[252:255], a[188:191], a[28:31], v[252:255]
    v_exp_f32 v34, v34
    v_mfma_f32_16x16x32_bf16 v[252:255], a[184:187], a[12:15], v[252:255]
    s_waitcnt lgkmcnt(2)
    v_exp_f32 v35, v35
    v_mfma_f32_16x16x32_bf16 v[40:43], a[208:211], a[0:3], 0
    s_waitcnt vmcnt(11) lgkmcnt(0)
    v_cvt_pk_bf16_f32 v235, v30, v31
    v_cvt_pk_bf16_f32 v242, v32, v33
    v_mfma_f32_16x16x32_bf16 v[40:43], a[212:215], a[16:19], v[40:43]
    s_barrier
    v_mfma_f32_16x16x32_bf16 v[40:43], a[216:219], a[32:35], v[40:43]
    buffer_load_dwordx4 v6, s[16:19], s39 offen lds
    v_mfma_f32_16x16x32_bf16 v[40:43], a[220:223], a[48:51], v[40:43]
    ds_read_b64_tr_b16 a[240:241], v8 offset:36864
    v_cvt_pk_bf16_f32 v243, v34, v35
    v_mfma_f32_16x16x32_bf16 v[40:43], a[224:227], a[64:67], v[40:43]
    ds_read_b64_tr_b16 a[242:243], v8 offset:38912
    v_subrev_u32 v12, 67584, v12
    v_mfma_f32_16x16x32_bf16 v[40:43], a[228:231], a[80:83], v[40:43]
    ds_read_b64_tr_b16 a[244:245], v9 offset:36864
    v_accvgpr_write_b32 a148, v116
    v_mfma_f32_16x16x32_bf16 v[44:47], a[228:231], a[84:87], 0
    s_add_u32 s39, s40, 12416
    ds_read_b64_tr_b16 a[246:247], v9 offset:38912
    v_subrev_u32 v13, 67584, v13
    v_mfma_f32_16x16x32_bf16 v[44:47], a[224:227], a[68:71], v[44:47]
    ds_read_b128 a[184:187], v12 offset:0
    v_accvgpr_write_b32 a149, v117
    v_mfma_f32_16x16x32_bf16 v[44:47], a[220:223], a[52:55], v[44:47]
    s_addk_i32 m0, 4096
    ds_read_b128 a[188:191], v13 offset:0
    v_accvgpr_write_b32 a150, v118
    v_mfma_f32_16x16x32_bf16 v[44:47], a[216:219], a[36:39], v[44:47]
    ds_read_b128 a[192:195], v12 offset:1024
    v_accvgpr_write_b32 a151, v119
    v_mfma_f32_16x16x32_bf16 v[44:47], a[212:215], a[20:23], v[44:47]
    v_exp_f32 v36, v36
    v_mfma_f32_16x16x32_bf16 v[44:47], a[208:211], a[4:7], v[44:47]
    v_exp_f32 v37, v37
    v_mfma_f32_16x16x32_bf16 v[48:51], a[208:211], a[8:11], 0
    s_lshl_b32 s42, s54, 4
    ds_read_b128 a[196:199], v13 offset:1024
    v_cvt_pk_bf16_f32 v250, v36, v37
    v_mfma_f32_16x16x32_bf16 v[48:51], a[212:215], a[24:27], v[48:51]
    s_mul_i32 s42, s42, 384
    ds_read_b128 a[200:203], v12 offset:2048
    v_and_b32 v22, 15, v1
    v_mfma_f32_16x16x32_bf16 v[48:51], a[216:219], a[40:43], v[48:51]
    buffer_load_dwordx4 v6, s[16:19], s39 offen lds
    v_mfma_f32_16x16x32_bf16 v[48:51], a[220:223], a[56:59], v[48:51]
    ds_read_b128 a[204:207], v13 offset:2048
    v_mul_u32_u24 v22, 384, v22
    v_mfma_f32_16x16x32_bf16 v[48:51], a[224:227], a[72:75], v[48:51]
    buffer_load_dword a252, v22, s[16:19], s42 offen offset:256
    v_mfma_f32_16x16x32_bf16 v[48:51], a[228:231], a[88:91], v[48:51]
    v_exp_f32 v38, v38
    v_mfma_f32_16x16x32_bf16 v[52:55], a[228:231], a[92:95], 0
    s_add_u32 s39, s40, 24704
    v_exp_f32 v39, v39
    v_mfma_f32_16x16x32_bf16 v[52:55], a[224:227], a[76:79], v[52:55]
    v_exp_f32 v228, v228
    v_mfma_f32_16x16x32_bf16 v[52:55], a[220:223], a[60:63], v[52:55]
    s_addk_i32 m0, 4096
    v_exp_f32 v229, v229
    v_mfma_f32_16x16x32_bf16 v[52:55], a[216:219], a[44:47], v[52:55]
    s_waitcnt lgkmcnt(1)
    v_exp_f32 v230, v230
    v_mfma_f32_16x16x32_bf16 v[52:55], a[212:215], a[28:31], v[52:55]
    v_exp_f32 v231, v231
    v_mfma_f32_16x16x32_bf16 v[52:55], a[208:211], a[12:15], v[52:55]
    v_exp_f32 v236, v236
    v_mfma_f32_16x16x32_bf16 a[164:167], a[240:243], v[220:223], a[164:167]
    v_exp_f32 v237, v237
    v_mfma_f32_16x16x32_bf16 a[180:183], a[244:247], v[220:223], a[180:183]
    v_exp_f32 v238, v238
    v_mfma_f32_16x16x32_bf16 a[176:179], a[244:247], v[212:215], a[176:179]
    buffer_load_dwordx4 v6, s[16:19], s39 offen lds
    v_mfma_f32_16x16x32_bf16 a[160:163], a[240:243], v[212:215], a[160:163]
    ds_read_b128 a[208:211], v12 offset:6144
    v_cvt_pk_bf16_f32 v251, v38, v39
    v_mfma_f32_16x16x32_bf16 a[156:159], a[240:243], v[204:207], a[156:159]
    ds_read_b128 a[212:215], v13 offset:6144
    v_cvt_pk_bf16_f32 v228, v228, v229
    v_mfma_f32_16x16x32_bf16 a[172:175], a[244:247], v[204:207], a[172:175]
    ds_read_b128 a[216:219], v12 offset:7168
    v_cvt_pk_bf16_f32 v229, v230, v231
    v_mfma_f32_16x16x32_bf16 a[168:171], a[244:247], v[196:199], a[168:171]
    s_add_u32 s39, s40, 36992
    ds_read_b128 a[220:223], v13 offset:7168
    v_cvt_pk_bf16_f32 v236, v236, v237
    v_mfma_f32_16x16x32_bf16 a[152:155], a[240:243], v[196:199], a[152:155]
    v_exp_f32 v239, v239
    v_mfma_f32_16x16x32_bf16 v[56:59], a[184:187], a[0:3], 0
    s_addk_i32 m0, 4096
    ds_read_b128 a[224:227], v12 offset:8192
    v_cvt_pk_bf16_f32 v237, v238, v239
    v_mfma_f32_16x16x32_bf16 v[56:59], a[188:191], a[16:19], v[56:59]
    v_exp_f32 v244, v244
    v_mfma_f32_16x16x32_bf16 v[56:59], a[192:195], a[32:35], v[56:59]
    s_waitcnt lgkmcnt(4)
    v_exp_f32 v245, v245
    v_mfma_f32_16x16x32_bf16 v[56:59], a[196:199], a[48:51], v[56:59]
    ds_read_b128 a[228:231], v13 offset:8192
    v_cvt_pk_bf16_f32 v244, v244, v245
    v_mfma_f32_16x16x32_bf16 v[56:59], a[200:203], a[64:67], v[56:59]
    v_exp_f32 v246, v246
    v_mfma_f32_16x16x32_bf16 v[56:59], a[204:207], a[80:83], v[56:59]
    v_exp_f32 v247, v247
    v_mfma_f32_16x16x32_bf16 v[64:67], a[204:207], a[84:87], 0
    buffer_load_dwordx4 v6, s[16:19], s39 offen lds
    v_mfma_f32_16x16x32_bf16 v[64:67], a[200:203], a[68:71], v[64:67]
    v_exp_f32 v252, v252
    v_mfma_f32_16x16x32_bf16 v[64:67], a[196:199], a[52:55], v[64:67]
    v_exp_f32 v253, v253
    v_mfma_f32_16x16x32_bf16 v[64:67], a[192:195], a[36:39], v[64:67]
    v_exp_f32 v254, v254
    v_mfma_f32_16x16x32_bf16 v[64:67], a[188:191], a[20:23], v[64:67]
    v_exp_f32 v255, v255
    v_mfma_f32_16x16x32_bf16 v[64:67], a[184:187], a[4:7], v[64:67]
    v_exp_f32 v40, v40
    v_mfma_f32_16x16x32_bf16 v[72:75], a[184:187], a[8:11], 0
    v_exp_f32 v41, v41
    v_mfma_f32_16x16x32_bf16 v[72:75], a[188:191], a[24:27], v[72:75]
    v_exp_f32 v42, v42
    v_mfma_f32_16x16x32_bf16 v[72:75], a[192:195], a[40:43], v[72:75]
    v_exp_f32 v43, v43
    v_mfma_f32_16x16x32_bf16 v[72:75], a[196:199], a[56:59], v[72:75]
    v_cvt_pk_bf16_f32 v245, v246, v247
    v_cvt_pk_bf16_f32 v252, v252, v253
    v_mfma_f32_16x16x32_bf16 v[72:75], a[200:203], a[72:75], v[72:75]
    v_exp_f32 v44, v44
    v_mfma_f32_16x16x32_bf16 v[72:75], a[204:207], a[88:91], v[72:75]
    v_exp_f32 v45, v45
    v_mfma_f32_16x16x32_bf16 v[80:83], a[204:207], a[92:95], 0
    ds_read_b64_tr_b16 a[232:233], v8 offset:40960
    v_cvt_pk_bf16_f32 v253, v254, v255
    v_mfma_f32_16x16x32_bf16 v[80:83], a[200:203], a[76:79], v[80:83]
    ds_read_b64_tr_b16 a[234:235], v8 offset:43008
    v_cvt_pk_bf16_f32 v230, v40, v41
    v_mfma_f32_16x16x32_bf16 v[80:83], a[196:199], a[60:63], v[80:83]
    ds_read_b64_tr_b16 a[236:237], v9 offset:40960
    v_cvt_pk_bf16_f32 v231, v42, v43
    v_mfma_f32_16x16x32_bf16 v[80:83], a[192:195], a[44:47], v[80:83]
    ds_read_b64_tr_b16 a[238:239], v9 offset:43008
    v_cvt_pk_bf16_f32 v238, v44, v45
    v_mfma_f32_16x16x32_bf16 v[80:83], a[188:191], a[28:31], v[80:83]
    s_waitcnt lgkmcnt(4)
    v_exp_f32 v46, v46
    v_mfma_f32_16x16x32_bf16 v[80:83], a[184:187], a[12:15], v[80:83]
    v_exp_f32 v47, v47
    v_mfma_f32_16x16x32_bf16 v[24:27], a[208:211], a[0:3], 0
    v_exp_f32 v48, v48
    v_mfma_f32_16x16x32_bf16 v[24:27], a[212:215], a[16:19], v[24:27]
    v_exp_f32 v49, v49
    v_mfma_f32_16x16x32_bf16 v[24:27], a[216:219], a[32:35], v[24:27]
    ds_read_b128 a[184:187], v12 offset:12288
    v_cvt_pk_bf16_f32 v239, v46, v47
    v_mfma_f32_16x16x32_bf16 v[24:27], a[220:223], a[48:51], v[24:27]
    ds_read_b128 a[188:191], v13 offset:12288
    v_cvt_pk_bf16_f32 v246, v48, v49
    v_mfma_f32_16x16x32_bf16 v[24:27], a[224:227], a[64:67], v[24:27]
    v_exp_f32 v50, v50
    v_mfma_f32_16x16x32_bf16 v[24:27], a[228:231], a[80:83], v[24:27]
    v_exp_f32 v51, v51
    v_mfma_f32_16x16x32_bf16 v[28:31], a[228:231], a[84:87], 0
    ds_read_b128 a[192:195], v12 offset:13312
    v_cvt_pk_bf16_f32 v247, v50, v51
    v_mfma_f32_16x16x32_bf16 v[28:31], a[224:227], a[68:71], v[28:31]
    v_exp_f32 v52, v52
    v_mfma_f32_16x16x32_bf16 v[28:31], a[220:223], a[52:55], v[28:31]
    v_exp_f32 v53, v53
    v_mfma_f32_16x16x32_bf16 v[28:31], a[216:219], a[36:39], v[28:31]
    ds_read_b128 a[196:199], v13 offset:13312
    v_cvt_pk_bf16_f32 v254, v52, v53
    v_mfma_f32_16x16x32_bf16 v[28:31], a[212:215], a[20:23], v[28:31]
    v_exp_f32 v54, v54
    v_mfma_f32_16x16x32_bf16 v[28:31], a[208:211], a[4:7], v[28:31]
    v_exp_f32 v55, v55
    v_mfma_f32_16x16x32_bf16 v[32:35], a[208:211], a[8:11], 0
    ds_read_b128 a[200:203], v12 offset:14336
    v_cvt_pk_bf16_f32 v255, v54, v55
    v_mfma_f32_16x16x32_bf16 v[32:35], a[212:215], a[24:27], v[32:35]
    v_exp_f32 v56, v56
    v_mfma_f32_16x16x32_bf16 v[32:35], a[216:219], a[40:43], v[32:35]
    v_exp_f32 v57, v57
    v_mfma_f32_16x16x32_bf16 v[32:35], a[220:223], a[56:59], v[32:35]
    ds_read_b128 a[204:207], v13 offset:14336
    v_cvt_pk_bf16_f32 v56, v56, v57
    v_mfma_f32_16x16x32_bf16 v[32:35], a[224:227], a[72:75], v[32:35]
    v_exp_f32 v58, v58
    v_mfma_f32_16x16x32_bf16 v[32:35], a[228:231], a[88:91], v[32:35]
    v_exp_f32 v59, v59
    v_mfma_f32_16x16x32_bf16 v[36:39], a[228:231], a[92:95], 0
    v_exp_f32 v64, v64
    v_mfma_f32_16x16x32_bf16 v[36:39], a[224:227], a[76:79], v[36:39]
    v_exp_f32 v65, v65
    v_mfma_f32_16x16x32_bf16 v[36:39], a[220:223], a[60:63], v[36:39]
    v_exp_f32 v66, v66
    v_mfma_f32_16x16x32_bf16 v[36:39], a[216:219], a[44:47], v[36:39]
    s_waitcnt lgkmcnt(1)
    v_exp_f32 v67, v67
    v_mfma_f32_16x16x32_bf16 v[36:39], a[212:215], a[28:31], v[36:39]
    v_exp_f32 v72, v72
    v_mfma_f32_16x16x32_bf16 v[36:39], a[208:211], a[12:15], v[36:39]
    v_exp_f32 v73, v73
    v_mfma_f32_16x16x32_bf16 a[152:155], a[232:235], v[224:227], a[152:155]
    v_exp_f32 v74, v74
    v_mfma_f32_16x16x32_bf16 a[168:171], a[236:239], v[224:227], a[168:171]
    v_exp_f32 v75, v75
    v_mfma_f32_16x16x32_bf16 a[172:175], a[236:239], v[232:235], a[172:175]
    ds_read_b128 a[208:211], v12 offset:18432
    v_cvt_pk_bf16_f32 v57, v58, v59
    v_mfma_f32_16x16x32_bf16 a[156:159], a[232:235], v[232:235], a[156:159]
    ds_read_b128 a[212:215], v13 offset:18432
    v_cvt_pk_bf16_f32 v64, v64, v65
    v_mfma_f32_16x16x32_bf16 a[160:163], a[232:235], v[240:243], a[160:163]
    ds_read_b128 a[216:219], v12 offset:19456
    v_cvt_pk_bf16_f32 v65, v66, v67
    v_mfma_f32_16x16x32_bf16 a[176:179], a[236:239], v[240:243], a[176:179]
    ds_read_b128 a[220:223], v13 offset:19456
    v_cvt_pk_bf16_f32 v72, v72, v73
    v_mfma_f32_16x16x32_bf16 a[180:183], a[236:239], v[248:251], a[180:183]
    ds_read_b128 a[224:227], v12 offset:20480
    v_cvt_pk_bf16_f32 v73, v74, v75
    v_mfma_f32_16x16x32_bf16 a[164:167], a[232:235], v[248:251], a[164:167]
    v_exp_f32 v80, v80
    v_mfma_f32_16x16x32_bf16 v[60:63], a[184:187], a[0:3], 0
    v_exp_f32 v81, v81
    v_mfma_f32_16x16x32_bf16 v[60:63], a[188:191], a[16:19], v[60:63]
    ds_read_b128 a[228:231], v13 offset:20480
    v_cvt_pk_bf16_f32 v80, v80, v81
    v_mfma_f32_16x16x32_bf16 v[60:63], a[192:195], a[32:35], v[60:63]
    s_waitcnt lgkmcnt(4)
    v_exp_f32 v82, v82
    v_mfma_f32_16x16x32_bf16 v[60:63], a[196:199], a[48:51], v[60:63]
    v_exp_f32 v83, v83
    v_mfma_f32_16x16x32_bf16 v[60:63], a[200:203], a[64:67], v[60:63]
    v_exp_f32 v24, v24
    v_mfma_f32_16x16x32_bf16 v[60:63], a[204:207], a[80:83], v[60:63]
    v_exp_f32 v25, v25
    v_mfma_f32_16x16x32_bf16 v[68:71], a[204:207], a[84:87], 0
    v_exp_f32 v26, v26
    v_mfma_f32_16x16x32_bf16 v[68:71], a[200:203], a[68:71], v[68:71]
    v_exp_f32 v27, v27
    v_mfma_f32_16x16x32_bf16 v[68:71], a[196:199], a[52:55], v[68:71]
    v_exp_f32 v28, v28
    v_mfma_f32_16x16x32_bf16 v[68:71], a[192:195], a[36:39], v[68:71]
    v_exp_f32 v29, v29
    v_mfma_f32_16x16x32_bf16 v[68:71], a[188:191], a[20:23], v[68:71]
    v_cvt_pk_bf16_f32 v81, v82, v83
    v_cvt_pk_bf16_f32 v58, v24, v25
    v_mfma_f32_16x16x32_bf16 v[68:71], a[184:187], a[4:7], v[68:71]
    v_exp_f32 v30, v30
    v_mfma_f32_16x16x32_bf16 v[76:79], a[184:187], a[8:11], 0
    v_exp_f32 v31, v31
    v_mfma_f32_16x16x32_bf16 v[76:79], a[188:191], a[24:27], v[76:79]
    v_exp_f32 v32, v32
    v_mfma_f32_16x16x32_bf16 v[76:79], a[192:195], a[40:43], v[76:79]
    v_exp_f32 v33, v33
    v_mfma_f32_16x16x32_bf16 v[76:79], a[196:199], a[56:59], v[76:79]
    v_cvt_pk_bf16_f32 v59, v26, v27
    v_cvt_pk_bf16_f32 v66, v28, v29
    v_mfma_f32_16x16x32_bf16 v[76:79], a[200:203], a[72:75], v[76:79]
    v_exp_f32 v34, v34
    v_mfma_f32_16x16x32_bf16 v[76:79], a[204:207], a[88:91], v[76:79]
    v_exp_f32 v35, v35
    v_mfma_f32_16x16x32_bf16 v[84:87], a[204:207], a[92:95], 0
    s_add_u32 s39, s40, 49280
    v_exp_f32 v36, v36
    v_mfma_f32_16x16x32_bf16 v[84:87], a[200:203], a[76:79], v[84:87]
    v_exp_f32 v37, v37
    v_mfma_f32_16x16x32_bf16 v[84:87], a[196:199], a[60:63], v[84:87]
    s_add_u32 m0, s63, 0
    v_cvt_pk_bf16_f32 v67, v30, v31
    v_cvt_pk_bf16_f32 v74, v32, v33
    v_mfma_f32_16x16x32_bf16 v[84:87], a[192:195], a[44:47], v[84:87]
    v_exp_f32 v38, v38
    v_mfma_f32_16x16x32_bf16 v[84:87], a[188:191], a[28:31], v[84:87]
    v_exp_f32 v39, v39
    v_mfma_f32_16x16x32_bf16 v[84:87], a[184:187], a[12:15], v[84:87]
    s_waitcnt lgkmcnt(0)
    v_exp_f32 v60, v60
    v_mfma_f32_16x16x32_bf16 v[40:43], a[208:211], a[0:3], 0
    s_waitcnt vmcnt(7)
    v_exp_f32 v61, v61
    v_mfma_f32_16x16x32_bf16 v[40:43], a[212:215], a[16:19], v[40:43]
    s_barrier
    v_mfma_f32_16x16x32_bf16 v[40:43], a[216:219], a[32:35], v[40:43]
    buffer_load_dwordx4 v6, s[16:19], s39 offen lds
    v_mfma_f32_16x16x32_bf16 v[40:43], a[220:223], a[48:51], v[40:43]
    ds_read_b64_tr_b16 a[240:241], v8 offset:45056
    v_cvt_pk_bf16_f32 v75, v34, v35
    v_mfma_f32_16x16x32_bf16 v[40:43], a[224:227], a[64:67], v[40:43]
    ds_read_b64_tr_b16 a[242:243], v8 offset:47104
    v_cvt_pk_bf16_f32 v82, v36, v37
    v_mfma_f32_16x16x32_bf16 v[40:43], a[228:231], a[80:83], v[40:43]
    ds_read_b64_tr_b16 a[244:245], v9 offset:45056
    v_cvt_pk_bf16_f32 v83, v38, v39
    v_mfma_f32_16x16x32_bf16 v[44:47], a[228:231], a[84:87], 0
    s_add_u32 s39, s40, 61568
    ds_read_b64_tr_b16 a[246:247], v9 offset:47104
    v_cvt_pk_bf16_f32 v60, v60, v61
    v_mfma_f32_16x16x32_bf16 v[44:47], a[224:227], a[68:71], v[44:47]
    v_exp_f32 v62, v62
    v_mfma_f32_16x16x32_bf16 v[44:47], a[220:223], a[52:55], v[44:47]
    s_addk_i32 m0, 4096
    v_exp_f32 v63, v63
    v_mfma_f32_16x16x32_bf16 v[44:47], a[216:219], a[36:39], v[44:47]
    ds_read_b128 a[184:187], v12 offset:24576
    v_cvt_pk_bf16_f32 v61, v62, v63
    v_mfma_f32_16x16x32_bf16 v[44:47], a[212:215], a[20:23], v[44:47]
    v_exp_f32 v68, v68
    v_mfma_f32_16x16x32_bf16 v[44:47], a[208:211], a[4:7], v[44:47]
    v_exp_f32 v69, v69
    v_mfma_f32_16x16x32_bf16 v[48:51], a[208:211], a[8:11], 0
    s_mov_b32 s28, s82
    ds_read_b128 a[188:191], v13 offset:24576
    v_cvt_pk_bf16_f32 v68, v68, v69
    v_mfma_f32_16x16x32_bf16 v[48:51], a[212:215], a[24:27], v[48:51]
    s_and_b32 s29, s83, 0xffff
    ds_read_b128 a[192:195], v12 offset:25600
    v_and_b32 v22, 15, v1
    v_mfma_f32_16x16x32_bf16 v[48:51], a[216:219], a[40:43], v[48:51]
    buffer_load_dwordx4 v6, s[16:19], s39 offen lds
    v_mfma_f32_16x16x32_bf16 v[48:51], a[220:223], a[56:59], v[48:51]
    s_mov_b32 s30, 1966080
    ds_read_b128 a[196:199], v13 offset:25600
    v_mul_u32_u24 v22, 1280, v22
    v_mfma_f32_16x16x32_bf16 v[48:51], a[224:227], a[72:75], v[48:51]
    s_mov_b32 s31, 0x00020000
    v_exp_f32 v70, v70
    v_mfma_f32_16x16x32_bf16 v[48:51], a[228:231], a[88:91], v[48:51]
    s_mul_hi_u32 s48, s58, 429496730
    v_exp_f32 v71, v71
    v_mfma_f32_16x16x32_bf16 v[52:55], a[228:231], a[92:95], 0
    s_add_u32 s39, s40, 73856
    ds_read_b128 a[200:203], v12 offset:26624
    v_cvt_pk_bf16_f32 v69, v70, v71
    v_mfma_f32_16x16x32_bf16 v[52:55], a[224:227], a[76:79], v[52:55]
    s_mul_i32 s42, s48, 80640
    v_exp_f32 v76, v76
    v_mfma_f32_16x16x32_bf16 v[52:55], a[220:223], a[60:63], v[52:55]
    s_addk_i32 m0, 4096
    v_exp_f32 v77, v77
    v_mfma_f32_16x16x32_bf16 v[52:55], a[216:219], a[44:47], v[52:55]
    s_waitcnt lgkmcnt(2)
    ds_read_b128 a[204:207], v13 offset:26624
    v_cvt_pk_bf16_f32 v76, v76, v77
    v_mfma_f32_16x16x32_bf16 v[52:55], a[212:215], a[28:31], v[52:55]
    s_lshl_b32 s56, s58, 7
    v_exp_f32 v78, v78
    v_mfma_f32_16x16x32_bf16 v[52:55], a[208:211], a[12:15], v[52:55]
    s_add_u32 s42, s42, s56
    v_exp_f32 v79, v79
    v_mfma_f32_16x16x32_bf16 a[164:167], a[240:243], v[252:255], a[164:167]
    s_mul_i32 s56, s3, 20480
    v_exp_f32 v84, v84
    v_mfma_f32_16x16x32_bf16 a[180:183], a[244:247], v[252:255], a[180:183]
    s_add_u32 s42, s42, s56
    v_exp_f32 v85, v85
    v_mfma_f32_16x16x32_bf16 a[176:179], a[244:247], v[244:247], a[176:179]
    buffer_load_dword a252, v22, s[28:31], s42 offen
    v_mfma_f32_16x16x32_bf16 a[160:163], a[240:243], v[244:247], a[160:163]
    buffer_load_dwordx4 v6, s[16:19], s39 offen lds
    v_mfma_f32_16x16x32_bf16 a[156:159], a[240:243], v[236:239], a[156:159]
    s_add_u32 s56, s7, 1
    ds_read_b128 a[208:211], v12 offset:30720
    v_cvt_pk_bf16_f32 v77, v78, v79
    v_mfma_f32_16x16x32_bf16 a[172:175], a[244:247], v[236:239], a[172:175]
    ds_read_b128 a[212:215], v13 offset:30720
    v_cvt_pk_bf16_f32 v84, v84, v85
    v_mfma_f32_16x16x32_bf16 a[168:171], a[244:247], v[228:231], a[168:171]
    s_add_u32 s39, s40, 86144
    ds_read_b128 a[216:219], v12 offset:31744
    v_mov_b32 v4, s56
    v_mfma_f32_16x16x32_bf16 a[152:155], a[240:243], v[228:231], a[152:155]
    s_add_u32 s56, s7, 2
    v_exp_f32 v86, v86
    v_mfma_f32_16x16x32_bf16 v[88:91], a[184:187], a[0:3], 0
    s_waitcnt lgkmcnt(3)
    v_exp_f32 v87, v87
    v_mfma_f32_16x16x32_bf16 v[88:91], a[188:191], a[16:19], v[88:91]
    s_addk_i32 m0, 4096
    ds_read_b128 a[220:223], v13 offset:31744
    v_cvt_pk_bf16_f32 v85, v86, v87
    v_mfma_f32_16x16x32_bf16 v[88:91], a[192:195], a[32:35], v[88:91]
    v_exp_f32 v40, v40
    v_mfma_f32_16x16x32_bf16 v[88:91], a[196:199], a[48:51], v[88:91]
    v_exp_f32 v41, v41
    v_mfma_f32_16x16x32_bf16 v[88:91], a[200:203], a[64:67], v[88:91]
    ds_read_b128 a[224:227], v12 offset:32768
    v_cvt_pk_bf16_f32 v62, v40, v41
    v_mfma_f32_16x16x32_bf16 v[88:91], a[204:207], a[80:83], v[88:91]
    v_exp_f32 v42, v42
    v_mfma_f32_16x16x32_bf16 v[96:99], a[204:207], a[84:87], 0
    buffer_load_dwordx4 v6, s[16:19], s39 offen lds
    v_mfma_f32_16x16x32_bf16 v[96:99], a[200:203], a[68:71], v[96:99]
    v_exp_f32 v43, v43
    v_mfma_f32_16x16x32_bf16 v[96:99], a[196:199], a[52:55], v[96:99]
pg_8:
    s_cbranch_execz pg_12
    ds_read_b128 a[228:231], v13 offset:32768
    v_cvt_pk_bf16_f32 v63, v42, v43
    v_mfma_f32_16x16x32_bf16 v[96:99], a[192:195], a[36:39], v[96:99]
    v_exp_f32 v44, v44
    v_mfma_f32_16x16x32_bf16 v[96:99], a[188:191], a[20:23], v[96:99]
    s_add_u32 s39, s40, 98432
    v_exp_f32 v45, v45
    v_mfma_f32_16x16x32_bf16 v[96:99], a[184:187], a[4:7], v[96:99]
    v_exp_f32 v46, v46
    v_mfma_f32_16x16x32_bf16 v[104:107], a[184:187], a[8:11], 0
    s_addk_i32 m0, 4096
    v_exp_f32 v47, v47
    v_mfma_f32_16x16x32_bf16 v[104:107], a[188:191], a[24:27], v[104:107]
    v_exp_f32 v48, v48
    v_mfma_f32_16x16x32_bf16 v[104:107], a[192:195], a[40:43], v[104:107]
    v_exp_f32 v49, v49
    v_mfma_f32_16x16x32_bf16 v[104:107], a[196:199], a[56:59], v[104:107]
    v_exp_f32 v50, v50
    v_mfma_f32_16x16x32_bf16 v[104:107], a[200:203], a[72:75], v[104:107]
    v_exp_f32 v51, v51
    v_mfma_f32_16x16x32_bf16 v[104:107], a[204:207], a[88:91], v[104:107]
    v_cvt_pk_bf16_f32 v70, v44, v45
    v_cvt_pk_bf16_f32 v71, v46, v47
    v_mfma_f32_16x16x32_bf16 v[112:115], a[204:207], a[92:95], 0
    buffer_load_dwordx4 v6, s[16:19], s39 offen lds
    v_mfma_f32_16x16x32_bf16 v[112:115], a[200:203], a[76:79], v[112:115]
    ds_read_b64_tr_b16 a[232:233], v8 offset:49152
    v_cvt_pk_bf16_f32 v78, v48, v49
    v_mfma_f32_16x16x32_bf16 v[112:115], a[196:199], a[60:63], v[112:115]
    ds_read_b64_tr_b16 a[234:235], v8 offset:51200
    v_cvt_pk_bf16_f32 v79, v50, v51
    v_mfma_f32_16x16x32_bf16 v[112:115], a[192:195], a[44:47], v[112:115]
    s_waitcnt lgkmcnt(2)
    v_exp_f32 v52, v52
    v_mfma_f32_16x16x32_bf16 v[112:115], a[188:191], a[28:31], v[112:115]
    s_add_u32 s39, s40, 110720
    v_exp_f32 v53, v53
    v_mfma_f32_16x16x32_bf16 v[112:115], a[184:187], a[12:15], v[112:115]
    ds_read_b64_tr_b16 a[236:237], v9 offset:49152
    v_cvt_pk_bf16_f32 v86, v52, v53
    v_mfma_f32_16x16x32_bf16 v[24:27], a[208:211], a[0:3], 0
    s_addk_i32 m0, 4096
    v_exp_f32 v54, v54
    v_mfma_f32_16x16x32_bf16 v[24:27], a[212:215], a[16:19], v[24:27]
    v_exp_f32 v55, v55
    v_mfma_f32_16x16x32_bf16 v[24:27], a[216:219], a[32:35], v[24:27]
    ds_read_b64_tr_b16 a[238:239], v9 offset:51200
    v_cvt_pk_bf16_f32 v87, v54, v55
    v_mfma_f32_16x16x32_bf16 v[24:27], a[220:223], a[48:51], v[24:27]
    v_exp_f32 v88, v88
    v_mfma_f32_16x16x32_bf16 v[24:27], a[224:227], a[64:67], v[24:27]
    v_exp_f32 v89, v89
    v_mfma_f32_16x16x32_bf16 v[24:27], a[228:231], a[80:83], v[24:27]
    ds_read_b128 a[184:187], v12 offset:36864
    v_cvt_pk_bf16_f32 v88, v88, v89
    v_mfma_f32_16x16x32_bf16 v[28:31], a[228:231], a[84:87], 0
    buffer_load_dwordx4 v6, s[16:19], s39 offen lds
    v_mfma_f32_16x16x32_bf16 v[28:31], a[224:227], a[68:71], v[28:31]
    v_exp_f32 v90, v90
    v_mfma_f32_16x16x32_bf16 v[28:31], a[220:223], a[52:55], v[28:31]
    v_exp_f32 v91, v91
    v_mfma_f32_16x16x32_bf16 v[28:31], a[216:219], a[36:39], v[28:31]
    ds_read_b128 a[188:191], v13 offset:36864
    v_cvt_pk_bf16_f32 v89, v90, v91
    v_mfma_f32_16x16x32_bf16 v[28:31], a[212:215], a[20:23], v[28:31]
    v_exp_f32 v96, v96
    v_mfma_f32_16x16x32_bf16 v[28:31], a[208:211], a[4:7], v[28:31]
    v_exp_f32 v97, v97
    v_mfma_f32_16x16x32_bf16 v[32:35], a[208:211], a[8:11], 0
    ds_read_b128 a[192:195], v12 offset:37888
    v_cvt_pk_bf16_f32 v96, v96, v97
    v_mfma_f32_16x16x32_bf16 v[32:35], a[212:215], a[24:27], v[32:35]
    v_exp_f32 v98, v98
    v_mfma_f32_16x16x32_bf16 v[32:35], a[216:219], a[40:43], v[32:35]
    v_exp_f32 v99, v99
    v_mfma_f32_16x16x32_bf16 v[32:35], a[220:223], a[56:59], v[32:35]
    ds_read_b128 a[196:199], v13 offset:37888
    v_cvt_pk_bf16_f32 v97, v98, v99
    v_mfma_f32_16x16x32_bf16 v[32:35], a[224:227], a[72:75], v[32:35]
    v_exp_f32 v104, v104
    v_mfma_f32_16x16x32_bf16 v[32:35], a[228:231], a[88:91], v[32:35]
    v_exp_f32 v105, v105
    v_mfma_f32_16x16x32_bf16 v[36:39], a[228:231], a[92:95], 0
    ds_read_b128 a[200:203], v12 offset:38912
    v_cvt_pk_bf16_f32 v104, v104, v105
    v_mfma_f32_16x16x32_bf16 v[36:39], a[224:227], a[76:79], v[36:39]
    v_exp_f32 v106, v106
    v_mfma_f32_16x16x32_bf16 v[36:39], a[220:223], a[60:63], v[36:39]
    v_exp_f32 v107, v107
    v_mfma_f32_16x16x32_bf16 v[36:39], a[216:219], a[44:47], v[36:39]
    s_waitcnt lgkmcnt(2)
    ds_read_b128 a[204:207], v13 offset:38912
    v_cvt_pk_bf16_f32 v105, v106, v107
    v_mfma_f32_16x16x32_bf16 v[36:39], a[212:215], a[28:31], v[36:39]
    v_exp_f32 v112, v112
    v_mfma_f32_16x16x32_bf16 v[36:39], a[208:211], a[12:15], v[36:39]
    v_exp_f32 v113, v113
    v_mfma_f32_16x16x32_bf16 a[152:155], a[232:235], v[56:59], a[152:155]
    v_exp_f32 v114, v114
    v_mfma_f32_16x16x32_bf16 a[168:171], a[236:239], v[56:59], a[168:171]
    v_exp_f32 v115, v115
    v_mfma_f32_16x16x32_bf16 a[172:175], a[236:239], v[64:67], a[172:175]
    ds_read_b128 a[208:211], v12 offset:43008
    v_cvt_pk_bf16_f32 v112, v112, v113
    v_mfma_f32_16x16x32_bf16 a[156:159], a[232:235], v[64:67], a[156:159]
    ds_read_b128 a[212:215], v13 offset:43008
    v_cvt_pk_bf16_f32 v113, v114, v115
    v_mfma_f32_16x16x32_bf16 a[160:163], a[232:235], v[72:75], a[160:163]
    v_exp_f32 v24, v24
    v_mfma_f32_16x16x32_bf16 a[176:179], a[236:239], v[72:75], a[176:179]
    v_exp_f32 v25, v25
    v_mfma_f32_16x16x32_bf16 a[180:183], a[236:239], v[80:83], a[180:183]
    ds_read_b128 a[216:219], v12 offset:44032
    v_cvt_pk_bf16_f32 v90, v24, v25
    v_mfma_f32_16x16x32_bf16 a[164:167], a[232:235], v[80:83], a[164:167]
    ds_read_b128 a[220:223], v13 offset:44032
    v_mov_b32 v24, 0
    v_mfma_f32_16x16x32_bf16 v[92:95], a[184:187], a[0:3], 0
    s_waitcnt lgkmcnt(4)
    ds_read_b128 a[224:227], v12 offset:45056
    v_mov_b32 v25, 0
    v_mfma_f32_16x16x32_bf16 v[92:95], a[188:191], a[16:19], v[92:95]
    v_exp_f32 v26, v26
    v_mfma_f32_16x16x32_bf16 v[92:95], a[192:195], a[32:35], v[92:95]
    v_exp_f32 v27, v27
    v_mfma_f32_16x16x32_bf16 v[92:95], a[196:199], a[48:51], v[92:95]
    ds_read_b128 a[228:231], v13 offset:45056
    v_cvt_pk_bf16_f32 v91, v26, v27
    v_mfma_f32_16x16x32_bf16 v[92:95], a[200:203], a[64:67], v[92:95]
    v_exp_f32 v28, v28
    v_mfma_f32_16x16x32_bf16 v[92:95], a[204:207], a[80:83], v[92:95]
    v_exp_f32 v29, v29
    v_mfma_f32_16x16x32_bf16 v[100:103], a[204:207], a[84:87], 0
    v_exp_f32 v30, v30
    v_mfma_f32_16x16x32_bf16 v[100:103], a[200:203], a[68:71], v[100:103]
    v_exp_f32 v31, v31
    v_mfma_f32_16x16x32_bf16 v[100:103], a[196:199], a[52:55], v[100:103]
    v_exp_f32 v32, v32
    v_mfma_f32_16x16x32_bf16 v[100:103], a[192:195], a[36:39], v[100:103]
    v_exp_f32 v33, v33
    v_mfma_f32_16x16x32_bf16 v[100:103], a[188:191], a[20:23], v[100:103]
    v_exp_f32 v34, v34
    v_mfma_f32_16x16x32_bf16 v[100:103], a[184:187], a[4:7], v[100:103]
    v_exp_f32 v35, v35
    v_mfma_f32_16x16x32_bf16 v[108:111], a[184:187], a[8:11], 0
    v_cvt_pk_bf16_f32 v98, v28, v29
    v_cvt_pk_bf16_f32 v99, v30, v31
    v_mfma_f32_16x16x32_bf16 v[108:111], a[188:191], a[24:27], v[108:111]
    v_exp_f32 v36, v36
    v_mfma_f32_16x16x32_bf16 v[108:111], a[192:195], a[40:43], v[108:111]
    v_exp_f32 v37, v37
    v_mfma_f32_16x16x32_bf16 v[108:111], a[196:199], a[56:59], v[108:111]
    v_exp_f32 v38, v38
    v_mfma_f32_16x16x32_bf16 v[108:111], a[200:203], a[72:75], v[108:111]
    v_exp_f32 v39, v39
    v_mfma_f32_16x16x32_bf16 v[108:111], a[204:207], a[88:91], v[108:111]
    v_cvt_pk_bf16_f32 v106, v32, v33
    v_cvt_pk_bf16_f32 v107, v34, v35
    v_mfma_f32_16x16x32_bf16 v[116:119], a[204:207], a[92:95], 0
    s_add_u32 s39, s40, 123008
    v_cvt_pk_bf16_f32 v114, v36, v37
    v_cvt_pk_bf16_f32 v115, v38, v39
    v_mfma_f32_16x16x32_bf16 v[116:119], a[200:203], a[76:79], v[116:119]
    v_exp_f32 v92, v92
    v_mfma_f32_16x16x32_bf16 v[116:119], a[196:199], a[60:63], v[116:119]
    s_addk_i32 m0, 4096
    v_exp_f32 v93, v93
    v_mfma_f32_16x16x32_bf16 v[116:119], a[192:195], a[44:47], v[116:119]
    s_waitcnt lgkmcnt(0)
    v_exp_f32 v94, v94
    v_mfma_f32_16x16x32_bf16 v[116:119], a[188:191], a[28:31], v[116:119]
    v_exp_f32 v95, v95
    v_mfma_f32_16x16x32_bf16 v[116:119], a[184:187], a[12:15], v[116:119]
    v_exp_f32 v100, v100
    v_mfma_f32_16x16x32_bf16 v[40:43], a[208:211], a[0:3], 0
    s_waitcnt vmcnt(12)
    v_exp_f32 v101, v101
    v_mfma_f32_16x16x32_bf16 v[40:43], a[212:215], a[16:19], v[40:43]
    s_barrier
    v_mfma_f32_16x16x32_bf16 v[40:43], a[216:219], a[32:35], v[40:43]
    buffer_load_dwordx4 v6, s[16:19], s39 offen lds
    v_mfma_f32_16x16x32_bf16 v[40:43], a[220:223], a[48:51], v[40:43]
    s_add_u32 s39, s40, 135296
    ds_read_b64_tr_b16 a[240:241], v8 offset:53248
    v_cvt_pk_bf16_f32 v92, v92, v93
    v_mfma_f32_16x16x32_bf16 v[40:43], a[224:227], a[64:67], v[40:43]
    s_addk_i32 m0, 4096
    ds_read_b64_tr_b16 a[242:243], v8 offset:55296
    v_cvt_pk_bf16_f32 v93, v94, v95
    v_mfma_f32_16x16x32_bf16 v[40:43], a[228:231], a[80:83], v[40:43]
    ds_read_b64_tr_b16 a[244:245], v9 offset:53248
    v_cvt_pk_bf16_f32 v100, v100, v101
    v_mfma_f32_16x16x32_bf16 v[44:47], a[228:231], a[84:87], 0
    ds_read_b64_tr_b16 a[246:247], v9 offset:55296
    v_mov_b32 v28, 0
    v_mfma_f32_16x16x32_bf16 v[44:47], a[224:227], a[68:71], v[44:47]
    v_exp_f32 v102, v102
    v_mfma_f32_16x16x32_bf16 v[44:47], a[220:223], a[52:55], v[44:47]
    v_exp_f32 v103, v103
    v_mfma_f32_16x16x32_bf16 v[44:47], a[216:219], a[36:39], v[44:47]
    v_exp_f32 v108, v108
    v_mfma_f32_16x16x32_bf16 v[44:47], a[212:215], a[20:23], v[44:47]
    buffer_load_dwordx4 v6, s[16:19], s39 offen lds
    v_mfma_f32_16x16x32_bf16 v[44:47], a[208:211], a[4:7], v[44:47]
    s_add_u32 s39, s40, 147584
    v_exp_f32 v109, v109
    v_mfma_f32_16x16x32_bf16 v[48:51], a[208:211], a[8:11], 0
    s_addk_i32 m0, 4096
    v_exp_f32 v110, v110
    v_mfma_f32_16x16x32_bf16 v[48:51], a[212:215], a[24:27], v[48:51]
    v_exp_f32 v111, v111
    v_mfma_f32_16x16x32_bf16 v[48:51], a[216:219], a[40:43], v[48:51]
    v_cvt_pk_bf16_f32 v101, v102, v103
    v_cvt_pk_bf16_f32 v108, v108, v109
    v_mfma_f32_16x16x32_bf16 v[48:51], a[220:223], a[56:59], v[48:51]
    v_exp_f32 v116, v116
    v_mfma_f32_16x16x32_bf16 v[48:51], a[224:227], a[72:75], v[48:51]
    v_exp_f32 v117, v117
    v_mfma_f32_16x16x32_bf16 v[48:51], a[228:231], a[88:91], v[48:51]
    v_exp_f32 v118, v118
    v_mfma_f32_16x16x32_bf16 v[52:55], a[228:231], a[92:95], 0
    buffer_load_dwordx4 v6, s[16:19], s39 offen lds
    v_mfma_f32_16x16x32_bf16 v[52:55], a[224:227], a[76:79], v[52:55]
    s_add_u32 s39, s40, 159872
    v_exp_f32 v119, v119
    v_mfma_f32_16x16x32_bf16 v[52:55], a[220:223], a[60:63], v[52:55]
    s_addk_i32 m0, 4096
    v_cvt_pk_bf16_f32 v109, v110, v111
    v_cvt_pk_bf16_f32 v116, v116, v117
    v_mfma_f32_16x16x32_bf16 v[52:55], a[216:219], a[44:47], v[52:55]
    s_waitcnt lgkmcnt(0)
    v_exp_f32 v40, v40
    v_mfma_f32_16x16x32_bf16 v[52:55], a[212:215], a[28:31], v[52:55]
    v_exp_f32 v41, v41
    v_mfma_f32_16x16x32_bf16 v[52:55], a[208:211], a[12:15], v[52:55]
    v_exp_f32 v42, v42
    v_mfma_f32_16x16x32_bf16 a[164:167], a[240:243], v[84:87], a[164:167]
    v_exp_f32 v43, v43
    v_mfma_f32_16x16x32_bf16 a[180:183], a[244:247], v[84:87], a[180:183]
    v_cvt_pk_bf16_f32 v117, v118, v119
    v_cvt_pk_bf16_f32 v94, v40, v41
    v_mfma_f32_16x16x32_bf16 a[176:179], a[244:247], v[76:79], a[176:179]
    buffer_load_dwordx4 v6, s[16:19], s39 offen lds
    v_mfma_f32_16x16x32_bf16 a[160:163], a[240:243], v[76:79], a[160:163]
    s_add_u32 s39, s40, 172160
    v_exp_f32 v44, v44
    v_mfma_f32_16x16x32_bf16 a[156:159], a[240:243], v[68:71], a[156:159]
    s_addk_i32 m0, 4096
    v_exp_f32 v45, v45
    v_mfma_f32_16x16x32_bf16 a[172:175], a[244:247], v[68:71], a[172:175]
    v_exp_f32 v46, v46
    v_mfma_f32_16x16x32_bf16 a[168:171], a[244:247], v[60:63], a[168:171]
    v_exp_f32 v47, v47
    v_mfma_f32_16x16x32_bf16 a[152:155], a[240:243], v[60:63], a[152:155]
    v_cvt_pk_bf16_f32 v95, v42, v43
    v_cvt_pk_bf16_f32 v102, v44, v45
    v_smfmac_f32_16x16x64_bf16 v[24:27], a[248:251], a[96:103], v20
    v_cvt_pk_bf16_f32 v103, v46, v47
    v_mov_b32 v29, 0
    s_nop 1
    v_smfmac_f32_16x16x64_bf16 v[28:31], a[248:251], a[104:111], v20
    v_mov_b32 v32, 0
    v_mov_b32 v33, 0
    s_nop 1
    v_smfmac_f32_16x16x64_bf16 v[32:35], a[248:251], a[112:119], v20
    buffer_load_dwordx4 v6, s[16:19], s39 offen lds
    v_mov_b32 v36, 0
    v_mov_b32 v37, 0
    s_nop 1
    v_smfmac_f32_16x16x64_bf16 v[36:39], a[248:251], a[120:127], v20
    s_add_u32 s39, s40, 184448
    ds_read_b64_tr_b16 a[232:233], v8 offset:57344
    v_smfmac_f32_16x16x64_bf16 v[24:27], a[248:251], a[128:135], v20
    s_addk_i32 m0, 4096
    ds_read_b64_tr_b16 a[234:235], v8 offset:59392
    v_smfmac_f32_16x16x64_bf16 v[28:31], a[248:251], a[136:143], v20
    ds_read_b64_tr_b16 a[236:237], v9 offset:57344
    v_smfmac_f32_16x16x64_bf16 v[32:35], a[248:251], a[144:151], v20
    ds_read_b64_tr_b16 a[238:239], v9 offset:59392
    v_smfmac_f32_16x16x64_bf16 v[36:39], a[248:251], v[120:127], v20
    v_smfmac_f32_16x16x64_bf16 v[24:27], a[248:251], v[128:135], v20
    v_smfmac_f32_16x16x64_bf16 v[28:31], a[248:251], v[136:143], v20
    v_smfmac_f32_16x16x64_bf16 v[32:35], a[248:251], v[144:151], v20
    buffer_load_dwordx4 v6, s[16:19], s39 offen lds
    v_smfmac_f32_16x16x64_bf16 v[36:39], a[248:251], v[152:159], v20
    s_add_u32 s38, s44, 0
    ds_read_b64_tr_b16 a[240:241], v8 offset:61440
    s_add_u32 s36, s44, 40960
    v_smfmac_f32_16x16x64_bf16 v[24:27], a[248:251], v[160:167], v20
    s_cmp_lt_u32 s3, 2
    s_cselect_b32 s38, s38, s36
    s_add_u32 m0, s63, 155648
    v_smfmac_f32_16x16x64_bf16 v[28:31], a[248:251], v[168:175], v20
    ds_read_b64_tr_b16 a[242:243], v8 offset:63488
    v_smfmac_f32_16x16x64_bf16 v[32:35], a[248:251], v[176:183], v20
    ds_read_b64_tr_b16 a[244:245], v9 offset:61440
    v_smfmac_f32_16x16x64_bf16 v[36:39], a[248:251], v[184:191], v20
    ds_read_b64_tr_b16 a[246:247], v9 offset:63488
    v_smfmac_f32_16x16x64_bf16 v[24:27], a[248:251], v[192:199], v20
    v_smfmac_f32_16x16x64_bf16 v[28:31], a[248:251], v[200:207], v20
    v_smfmac_f32_16x16x64_bf16 v[32:35], a[248:251], v[208:215], v20
    buffer_load_dwordx4 v7, s[8:11], s38 offen lds
    v_smfmac_f32_16x16x64_bf16 v[36:39], a[248:251], v[216:223], v20
    s_add_u32 s38, s44, 0
    ds_read_b64_tr_b16 a[184:185], v10 offset:0
    v_smfmac_f32_16x16x64_bf16 v[24:27], a[248:251], v[224:231], v20
    s_addk_i32 m0, -16384
    ds_read_b64_tr_b16 a[186:187], v10 offset:2048
    v_smfmac_f32_16x16x64_bf16 v[28:31], a[248:251], v[232:239], v20
    ds_read_b64_tr_b16 a[188:189], v10 offset:4096
    v_smfmac_f32_16x16x64_bf16 v[32:35], a[248:251], v[240:247], v20
    s_waitcnt lgkmcnt(3)
    ds_read_b64_tr_b16 a[190:191], v10 offset:6144
    v_smfmac_f32_16x16x64_bf16 v[36:39], a[248:251], v[248:255], v20
    v_smfmac_f32_16x16x64_bf16 v[24:27], a[248:251], v[56:63], v20
    v_smfmac_f32_16x16x64_bf16 v[28:31], a[248:251], v[64:71], v20
    v_smfmac_f32_16x16x64_bf16 v[32:35], a[248:251], v[72:79], v20
    buffer_load_dwordx4 v2, s[8:11], s38 offen lds
    v_smfmac_f32_16x16x64_bf16 v[36:39], a[248:251], v[80:87], v20
    s_add_u32 s38, s44, 0
    ds_read_b64_tr_b16 a[192:193], v10 offset:8192
    v_smfmac_f32_16x16x64_bf16 v[24:27], a[248:251], v[88:95], v20
    s_addk_i32 m0, 4096
    ds_read_b64_tr_b16 a[194:195], v10 offset:10240
    v_smfmac_f32_16x16x64_bf16 v[28:31], a[248:251], v[96:103], v20
    ds_read_b64_tr_b16 a[196:197], v10 offset:12288
    v_exp_f32 v48, v48
    v_exp_f32 v49, v49
    v_exp_f32 v50, v50
    v_exp_f32 v51, v51
    v_cvt_pk_bf16_f32 v110, v48, v49
    v_cvt_pk_bf16_f32 v111, v50, v51
    s_nop 1
    v_smfmac_f32_16x16x64_bf16 v[32:35], a[248:251], v[104:111], v20
    ds_read_b64_tr_b16 a[198:199], v10 offset:14336
    v_add_f32 v24, v24, v25
    v_exp_f32 v52, v52
    v_exp_f32 v53, v53
    v_exp_f32 v54, v54
    v_exp_f32 v55, v55
    v_cvt_pk_bf16_f32 v118, v52, v53
    v_cvt_pk_bf16_f32 v119, v54, v55
    s_nop 1
    v_smfmac_f32_16x16x64_bf16 v[36:39], a[248:251], v[112:119], v20
    v_add_f32 v28, v28, v29
    v_mfma_f32_16x16x32_bf16 a[152:155], a[232:235], v[88:91], a[152:155]
    v_rcp_f32 v16, v24
    v_mfma_f32_16x16x32_bf16 a[168:171], a[236:239], v[88:91], a[168:171]
    v_rcp_f32 v17, v28
    v_mfma_f32_16x16x32_bf16 a[172:175], a[236:239], v[96:99], a[172:175]
    buffer_load_dwordx4 v3, s[8:11], s38 offen lds
    v_mfma_f32_16x16x32_bf16 a[156:159], a[232:235], v[96:99], a[156:159]
    s_add_u32 s38, s44, 40960
    ds_read_b64_tr_b16 a[200:201], v10 offset:16384
    v_add_f32 v32, v32, v33
    v_mfma_f32_16x16x32_bf16 a[160:163], a[232:235], v[104:107], a[160:163]
    s_addk_i32 m0, 4096
    ds_read_b64_tr_b16 a[202:203], v10 offset:18432
    v_add_f32 v36, v36, v37
    v_mfma_f32_16x16x32_bf16 a[176:179], a[236:239], v[104:107], a[176:179]
    ds_read_b64_tr_b16 a[204:205], v10 offset:20480
    v_max3_f32 v21, v24, v28, v32
    v_mfma_f32_16x16x32_bf16 a[180:183], a[236:239], v[112:115], a[180:183]
    s_waitcnt lgkmcnt(3)
    ds_read_b64_tr_b16 a[206:207], v10 offset:22528
    v_max3_f32 v21, v21, v36, v16
    v_mfma_f32_16x16x32_bf16 a[164:167], a[232:235], v[112:115], a[164:167]
    v_rcp_f32 v18, v32
    v_mfma_f32_16x16x32_bf16 a[164:167], a[240:243], v[116:119], a[164:167]
    v_rcp_f32 v19, v36
    v_mfma_f32_16x16x32_bf16 a[180:183], a[244:247], v[116:119], a[180:183]
    v_max3_f32 v21, v21, v17, v18
    v_max_f32 v21, v21, v19
    v_mfma_f32_16x16x32_bf16 a[176:179], a[244:247], v[108:111], a[176:179]
    buffer_load_dwordx4 v2, s[8:11], s38 offen lds
    v_mfma_f32_16x16x32_bf16 a[160:163], a[240:243], v[108:111], a[160:163]
    s_add_u32 s38, s44, 40960
    ds_read_b64_tr_b16 a[208:209], v10 offset:24576
    v_cmp_nge_f32 vcc, 0x5f800000, v21
    v_mfma_f32_16x16x32_bf16 a[156:159], a[240:243], v[100:103], a[156:159]
    s_addk_i32 m0, 4096
    ds_read_b64_tr_b16 a[210:211], v10 offset:26624
    v_mfma_f32_16x16x32_bf16 a[172:175], a[244:247], v[100:103], a[172:175]
    ds_read_b64_tr_b16 a[212:213], v10 offset:28672
    v_mfma_f32_16x16x32_bf16 a[168:171], a[244:247], v[92:95], a[168:171]
    ds_read_b64_tr_b16 a[214:215], v10 offset:30720
    v_mfma_f32_16x16x32_bf16 a[152:155], a[240:243], v[92:95], a[152:155]
    s_cbranch_vccnz rare
rare_ret:
    v_mfma_f32_16x16x32_bf16 v[40:43], a[184:187], a[96:99], 0
    v_subrev_u32 v8, 73728, v8
    v_subrev_u32 v9, 73728, v9
    v_mfma_f32_16x16x32_bf16 v[40:43], a[188:191], a[100:103], v[40:43]
    v_mfma_f32_16x16x32_bf16 v[44:47], a[188:191], a[108:111], 0
    s_barrier
    v_mfma_f32_16x16x32_bf16 v[44:47], a[184:187], a[104:107], v[44:47]
    buffer_load_dwordx4 v3, s[8:11], s38 offen lds
    v_mfma_f32_16x16x32_bf16 v[48:51], a[184:187], a[112:115], 0
    v_accvgpr_read_b32 v21, a152
    v_accvgpr_read_b32 v22, a153
    v_mfma_f32_16x16x32_bf16 v[48:51], a[188:191], a[116:119], v[48:51]
    v_accvgpr_read_b32 v23, a154
    v_accvgpr_read_b32 v5, a155
    v_mfma_f32_16x16x32_bf16 v[52:55], a[188:191], a[124:127], 0
    v_mul_f32 v21, v16, v21
    v_mul_f32 v22, v16, v22
    v_mfma_f32_16x16x32_bf16 v[52:55], a[184:187], a[120:123], v[52:55]
    ds_read_b64_tr_b16 a[184:185], v10 offset:32768
    v_mul_f32 v23, v16, v23
    v_mfma_f32_16x16x32_bf16 v[52:55], a[192:195], v[120:123], v[52:55]
    ds_read_b64_tr_b16 a[186:187], v10 offset:34816
    v_mul_f32 v5, v16, v5
    v_mfma_f32_16x16x32_bf16 v[52:55], a[196:199], v[124:127], v[52:55]
    ds_read_b64_tr_b16 a[188:189], v10 offset:36864
    v_cvt_pk_bf16_f32 v21, v21, v22
    v_mfma_f32_16x16x32_bf16 v[48:51], a[196:199], a[148:151], v[48:51]
    s_waitcnt lgkmcnt(3)
    ds_read_b64_tr_b16 a[190:191], v10 offset:38912
    v_cvt_pk_bf16_f32 v22, v23, v5
    v_mfma_f32_16x16x32_bf16 v[48:51], a[192:195], a[144:147], v[48:51]
    v_accvgpr_write_b32 a0, v21
    v_accvgpr_write_b32 a1, v22
    v_mfma_f32_16x16x32_bf16 v[44:47], a[192:195], a[136:139], v[44:47]
    v_accvgpr_read_b32 v21, a168
    v_accvgpr_read_b32 v22, a169
    v_mfma_f32_16x16x32_bf16 v[44:47], a[196:199], a[140:143], v[44:47]
    v_accvgpr_read_b32 v23, a170
    v_accvgpr_read_b32 v5, a171
    v_mfma_f32_16x16x32_bf16 v[40:43], a[196:199], a[132:135], v[40:43]
    v_mul_f32 v21, v16, v21
    v_mul_f32 v22, v16, v22
    v_mfma_f32_16x16x32_bf16 v[40:43], a[192:195], a[128:131], v[40:43]
    ds_read_b64_tr_b16 a[192:193], v10 offset:40960
    v_mul_f32 v23, v16, v23
    v_mfma_f32_16x16x32_bf16 v[40:43], a[200:203], v[128:131], v[40:43]
    ds_read_b64_tr_b16 a[194:195], v10 offset:43008
    v_mul_f32 v5, v16, v5
    v_mfma_f32_16x16x32_bf16 v[40:43], a[204:207], v[132:135], v[40:43]
    ds_read_b64_tr_b16 a[196:197], v10 offset:45056
    v_cvt_pk_bf16_f32 v21, v21, v22
    v_mfma_f32_16x16x32_bf16 v[44:47], a[204:207], v[140:143], v[44:47]
    ds_read_b64_tr_b16 a[198:199], v10 offset:47104
    v_cvt_pk_bf16_f32 v22, v23, v5
    v_mfma_f32_16x16x32_bf16 v[44:47], a[200:203], v[136:139], v[44:47]
    v_accvgpr_write_b32 a2, v21
    v_accvgpr_write_b32 a3, v22
    v_mfma_f32_16x16x32_bf16 v[48:51], a[200:203], v[144:147], v[48:51]
    buffer_store_dwordx4 a[0:3], v14, s[20:23], s55 offen offset:0 sc1
    v_accvgpr_read_b32 v21, a156
    v_mfma_f32_16x16x32_bf16 v[48:51], a[204:207], v[148:151], v[48:51]
    v_accvgpr_read_b32 v22, a157
    v_accvgpr_read_b32 v23, a158
    v_mfma_f32_16x16x32_bf16 v[52:55], a[204:207], v[156:159], v[52:55]
    v_accvgpr_read_b32 v5, a159
    v_mul_f32 v21, v17, v21
    v_mfma_f32_16x16x32_bf16 v[52:55], a[200:203], v[152:155], v[52:55]
    ds_read_b64_tr_b16 a[200:201], v10 offset:49152
    v_mul_f32 v22, v17, v22
    v_mfma_f32_16x16x32_bf16 v[52:55], a[208:211], v[184:187], v[52:55]
    ds_read_b64_tr_b16 a[202:203], v10 offset:51200
    v_mul_f32 v23, v17, v23
    v_mfma_f32_16x16x32_bf16 v[52:55], a[212:215], v[188:191], v[52:55]
    ds_read_b64_tr_b16 a[204:205], v10 offset:53248
    v_mul_f32 v5, v17, v5
    v_mfma_f32_16x16x32_bf16 v[48:51], a[212:215], v[180:183], v[48:51]
    s_waitcnt lgkmcnt(3)
    ds_read_b64_tr_b16 a[206:207], v10 offset:55296
    v_cvt_pk_bf16_f32 v21, v21, v22
    v_mfma_f32_16x16x32_bf16 v[48:51], a[208:211], v[176:179], v[48:51]
    v_cvt_pk_bf16_f32 v22, v23, v5
    v_accvgpr_write_b32 a4, v21
    v_mfma_f32_16x16x32_bf16 v[44:47], a[208:211], v[168:171], v[44:47]
    v_accvgpr_write_b32 a5, v22
    v_accvgpr_read_b32 v21, a172
    v_mfma_f32_16x16x32_bf16 v[44:47], a[212:215], v[172:175], v[44:47]
    v_accvgpr_read_b32 v22, a173
    v_accvgpr_read_b32 v23, a174
    v_mfma_f32_16x16x32_bf16 v[40:43], a[212:215], v[164:167], v[40:43]
    v_accvgpr_read_b32 v5, a175
    v_mul_f32 v21, v17, v21
    v_mfma_f32_16x16x32_bf16 v[40:43], a[208:211], v[160:163], v[40:43]
    ds_read_b64_tr_b16 a[208:209], v10 offset:57344
    v_mul_f32 v22, v17, v22
    v_mfma_f32_16x16x32_bf16 v[40:43], a[184:187], v[192:195], v[40:43]
    ds_read_b64_tr_b16 a[210:211], v10 offset:59392
    v_mul_f32 v23, v17, v23
    v_mfma_f32_16x16x32_bf16 v[40:43], a[188:191], v[196:199], v[40:43]
    ds_read_b64_tr_b16 a[212:213], v10 offset:61440
    v_mul_f32 v5, v17, v5
    v_mfma_f32_16x16x32_bf16 v[44:47], a[188:191], v[204:207], v[44:47]
    ds_read_b64_tr_b16 a[214:215], v10 offset:63488
    v_subrev_u32 v10, 73728, v10
    v_mfma_f32_16x16x32_bf16 v[44:47], a[184:187], v[200:203], v[44:47]
    v_cvt_pk_bf16_f32 v21, v21, v22
    v_cvt_pk_bf16_f32 v22, v23, v5
    v_mfma_f32_16x16x32_bf16 v[48:51], a[184:187], v[208:211], v[48:51]
    v_accvgpr_write_b32 a6, v21
    v_accvgpr_write_b32 a7, v22
    v_mfma_f32_16x16x32_bf16 v[48:51], a[188:191], v[212:215], v[48:51]
    buffer_store_dwordx4 a[4:7], v14, s[20:23], s55 offen offset:1024 sc1
    v_accvgpr_read_b32 v21, a160
    v_mfma_f32_16x16x32_bf16 v[52:55], a[188:191], v[220:223], v[52:55]
    v_accvgpr_read_b32 v22, a161
    v_accvgpr_read_b32 v23, a162
    v_mfma_f32_16x16x32_bf16 v[52:55], a[184:187], v[216:219], v[52:55]
    ds_read_b64_tr_b16 a[184:185], v11 offset:0
    v_accvgpr_read_b32 v5, a163
    v_mfma_f32_16x16x32_bf16 v[52:55], a[192:195], v[248:251], v[52:55]
    ds_read_b64_tr_b16 a[186:187], v11 offset:2048
    v_mul_f32 v21, v18, v21
    v_mfma_f32_16x16x32_bf16 v[52:55], a[196:199], v[252:255], v[52:55]
    ds_read_b64_tr_b16 a[188:189], v11 offset:4096
    v_mul_f32 v22, v18, v22
    v_mfma_f32_16x16x32_bf16 v[48:51], a[196:199], v[244:247], v[48:51]
    s_waitcnt lgkmcnt(3)
    ds_read_b64_tr_b16 a[190:191], v11 offset:6144
    v_mul_f32 v23, v18, v23
    v_mfma_f32_16x16x32_bf16 v[48:51], a[192:195], v[240:243], v[48:51]
    v_mul_f32 v5, v18, v5
    v_cvt_pk_bf16_f32 v21, v21, v22
    v_mfma_f32_16x16x32_bf16 v[44:47], a[192:195], v[232:235], v[44:47]
    v_cvt_pk_bf16_f32 v22, v23, v5
    v_accvgpr_write_b32 a8, v21
    v_mfma_f32_16x16x32_bf16 v[44:47], a[196:199], v[236:239], v[44:47]
    v_accvgpr_write_b32 a9, v22
    v_accvgpr_read_b32 v21, a176
    v_mfma_f32_16x16x32_bf16 v[40:43], a[196:199], v[228:231], v[40:43]
    v_accvgpr_read_b32 v22, a177
    v_accvgpr_read_b32 v23, a178
    v_mfma_f32_16x16x32_bf16 v[40:43], a[192:195], v[224:227], v[40:43]
    ds_read_b64_tr_b16 a[192:193], v11 offset:8192
    v_accvgpr_read_b32 v5, a179
    v_mfma_f32_16x16x32_bf16 v[40:43], a[200:203], v[56:59], v[40:43]
    ds_read_b64_tr_b16 a[194:195], v11 offset:10240
    v_mul_f32 v21, v18, v21
    v_mfma_f32_16x16x32_bf16 v[40:43], a[204:207], v[60:63], v[40:43]
    ds_read_b64_tr_b16 a[196:197], v11 offset:12288
    v_mul_f32 v22, v18, v22
    v_mfma_f32_16x16x32_bf16 v[44:47], a[204:207], v[68:71], v[44:47]
    ds_read_b64_tr_b16 a[198:199], v11 offset:14336
    v_mul_f32 v23, v18, v23
    v_mfma_f32_16x16x32_bf16 v[44:47], a[200:203], v[64:67], v[44:47]
    v_mul_f32 v5, v18, v5
    v_cvt_pk_bf16_f32 v21, v21, v22
    v_mfma_f32_16x16x32_bf16 v[48:51], a[200:203], v[72:75], v[48:51]
    v_cvt_pk_bf16_f32 v22, v23, v5
    v_accvgpr_write_b32 a10, v21
    v_mfma_f32_16x16x32_bf16 v[48:51], a[204:207], v[76:79], v[48:51]
    v_accvgpr_write_b32 a11, v22
    v_accvgpr_read_b32 v21, a164
    v_mfma_f32_16x16x32_bf16 v[52:55], a[204:207], v[84:87], v[52:55]
    buffer_store_dwordx4 a[8:11], v14, s[20:23], s55 offen offset:2048 sc1
    v_accvgpr_read_b32 v22, a165
    v_mfma_f32_16x16x32_bf16 v[52:55], a[200:203], v[80:83], v[52:55]
    ds_read_b64_tr_b16 a[200:201], v11 offset:16384
    v_accvgpr_read_b32 v23, a166
    v_mfma_f32_16x16x32_bf16 v[52:55], a[208:211], v[112:115], v[52:55]
    ds_read_b64_tr_b16 a[202:203], v11 offset:18432
    v_accvgpr_read_b32 v5, a167
    v_mfma_f32_16x16x32_bf16 v[52:55], a[212:215], v[116:119], v[52:55]
    ds_read_b64_tr_b16 a[204:205], v11 offset:20480
    v_mul_f32 v21, v19, v21
    v_mfma_f32_16x16x32_bf16 v[48:51], a[212:215], v[108:111], v[48:51]
    s_waitcnt lgkmcnt(3)
    ds_read_b64_tr_b16 a[206:207], v11 offset:22528
    v_mul_f32 v22, v19, v22
    v_mfma_f32_16x16x32_bf16 v[48:51], a[208:211], v[104:107], v[48:51]
    v_mul_f32 v23, v19, v23
    v_mul_f32 v5, v19, v5
    v_mfma_f32_16x16x32_bf16 v[44:47], a[208:211], v[96:99], v[44:47]
    v_cvt_pk_bf16_f32 v21, v21, v22
    v_cvt_pk_bf16_f32 v22, v23, v5
    v_mfma_f32_16x16x32_bf16 v[44:47], a[212:215], v[100:103], v[44:47]
    v_accvgpr_write_b32 a12, v21
    v_accvgpr_write_b32 a13, v22
    v_mfma_f32_16x16x32_bf16 v[40:43], a[212:215], v[92:95], v[40:43]
    v_accvgpr_read_b32 v21, a180
    v_accvgpr_read_b32 v22, a181
    v_mfma_f32_16x16x32_bf16 v[40:43], a[208:211], v[88:91], v[40:43]
    ds_read_b64_tr_b16 a[208:209], v11 offset:24576
    v_accvgpr_read_b32 v23, a182
    v_mfma_f32_16x16x32_bf16 v[24:27], a[184:187], a[96:99], 0
    ds_read_b64_tr_b16 a[210:211], v11 offset:26624
    v_accvgpr_read_b32 v5, a183
    v_mfma_f32_16x16x32_bf16 v[24:27], a[188:191], a[100:103], v[24:27]
    ds_read_b64_tr_b16 a[212:213], v11 offset:28672
    v_mul_f32 v21, v19, v21
    v_mfma_f32_16x16x32_bf16 v[28:31], a[188:191], a[108:111], 0
    ds_read_b64_tr_b16 a[214:215], v11 offset:30720
    v_mul_f32 v22, v19, v22
    v_mfma_f32_16x16x32_bf16 v[28:31], a[184:187], a[104:107], v[28:31]
    v_mul_f32 v23, v19, v23
    v_mul_f32 v5, v19, v5
    v_mfma_f32_16x16x32_bf16 v[32:35], a[184:187], a[112:115], 0
pg_9:
    s_cbranch_execz pg_13
    v_cvt_pk_bf16_f32 v21, v21, v22
    v_cvt_pk_bf16_f32 v22, v23, v5
    v_mfma_f32_16x16x32_bf16 v[32:35], a[188:191], a[116:119], v[32:35]
    v_accvgpr_write_b32 a14, v21
    v_accvgpr_write_b32 a15, v22
    v_mfma_f32_16x16x32_bf16 v[36:39], a[188:191], a[124:127], 0
    buffer_store_dwordx4 a[12:15], v14, s[20:23], s55 offen offset:3072 sc1
    v_mul_f32 v40, v16, v40
    v_mfma_f32_16x16x32_bf16 v[36:39], a[184:187], a[120:123], v[36:39]
    s_add_u32 s55, s55, 4096
    ds_read_b64_tr_b16 a[184:185], v11 offset:32768
    v_mul_f32 v41, v16, v41
    v_mfma_f32_16x16x32_bf16 v[36:39], a[192:195], v[120:123], v[36:39]
    ds_read_b64_tr_b16 a[186:187], v11 offset:34816
    v_mul_f32 v42, v16, v42
    v_mfma_f32_16x16x32_bf16 v[36:39], a[196:199], v[124:127], v[36:39]
    ds_read_b64_tr_b16 a[188:189], v11 offset:36864
    v_mul_f32 v43, v16, v43
    v_mfma_f32_16x16x32_bf16 v[32:35], a[196:199], a[148:151], v[32:35]
    s_waitcnt lgkmcnt(3)
    ds_read_b64_tr_b16 a[190:191], v11 offset:38912
    v_cvt_pk_bf16_f32 v40, v40, v41
    v_mfma_f32_16x16x32_bf16 v[32:35], a[192:195], a[144:147], v[32:35]
    v_cvt_pk_bf16_f32 v41, v42, v43
    v_accvgpr_write_b32 a16, v40
    v_mfma_f32_16x16x32_bf16 v[28:31], a[192:195], a[136:139], v[28:31]
    v_accvgpr_write_b32 a17, v41
    v_mul_f32 v44, v17, v44
    v_mfma_f32_16x16x32_bf16 v[28:31], a[196:199], a[140:143], v[28:31]
    v_mul_f32 v45, v17, v45
    v_mul_f32 v46, v17, v46
    v_mfma_f32_16x16x32_bf16 v[24:27], a[196:199], a[132:135], v[24:27]
    v_mul_f32 v47, v17, v47
    v_cvt_pk_bf16_f32 v44, v44, v45
    v_mfma_f32_16x16x32_bf16 v[24:27], a[192:195], a[128:131], v[24:27]
    ds_read_b64_tr_b16 a[192:193], v11 offset:40960
    v_cvt_pk_bf16_f32 v45, v46, v47
    v_mfma_f32_16x16x32_bf16 v[24:27], a[200:203], v[128:131], v[24:27]
    ds_read_b64_tr_b16 a[194:195], v11 offset:43008
    v_accvgpr_write_b32 a20, v44
    v_mfma_f32_16x16x32_bf16 v[24:27], a[204:207], v[132:135], v[24:27]
    ds_read_b64_tr_b16 a[196:197], v11 offset:45056
    v_accvgpr_write_b32 a21, v45
    v_mfma_f32_16x16x32_bf16 v[28:31], a[204:207], v[140:143], v[28:31]
    ds_read_b64_tr_b16 a[198:199], v11 offset:47104
    v_mul_f32 v48, v18, v48
    v_mfma_f32_16x16x32_bf16 v[28:31], a[200:203], v[136:139], v[28:31]
    v_mul_f32 v49, v18, v49
    v_mul_f32 v50, v18, v50
    v_mfma_f32_16x16x32_bf16 v[32:35], a[200:203], v[144:147], v[32:35]
    v_mul_f32 v51, v18, v51
    v_cvt_pk_bf16_f32 v48, v48, v49
    v_mfma_f32_16x16x32_bf16 v[32:35], a[204:207], v[148:151], v[32:35]
    v_cvt_pk_bf16_f32 v49, v50, v51
    v_accvgpr_write_b32 a24, v48
    v_mfma_f32_16x16x32_bf16 v[36:39], a[204:207], v[156:159], v[36:39]
    v_accvgpr_write_b32 a25, v49
    v_mul_f32 v52, v19, v52
    v_mfma_f32_16x16x32_bf16 v[36:39], a[200:203], v[152:155], v[36:39]
    ds_read_b64_tr_b16 a[200:201], v11 offset:49152
    v_mul_f32 v53, v19, v53
    v_mfma_f32_16x16x32_bf16 v[36:39], a[208:211], v[184:187], v[36:39]
    ds_read_b64_tr_b16 a[202:203], v11 offset:51200
    v_mul_f32 v54, v19, v54
    v_mfma_f32_16x16x32_bf16 v[36:39], a[212:215], v[188:191], v[36:39]
    ds_read_b64_tr_b16 a[204:205], v11 offset:53248
    v_mul_f32 v55, v19, v55
    v_mfma_f32_16x16x32_bf16 v[32:35], a[212:215], v[180:183], v[32:35]
    s_waitcnt lgkmcnt(3)
    ds_read_b64_tr_b16 a[206:207], v11 offset:55296
    v_cvt_pk_bf16_f32 v52, v52, v53
    v_mfma_f32_16x16x32_bf16 v[32:35], a[208:211], v[176:179], v[32:35]
    v_cvt_pk_bf16_f32 v53, v54, v55
    v_accvgpr_write_b32 a28, v52
    v_mfma_f32_16x16x32_bf16 v[28:31], a[208:211], v[168:171], v[28:31]
    v_accvgpr_write_b32 a29, v53
    v_mfma_f32_16x16x32_bf16 v[28:31], a[212:215], v[172:175], v[28:31]
    v_mfma_f32_16x16x32_bf16 v[24:27], a[212:215], v[164:167], v[24:27]
    v_mfma_f32_16x16x32_bf16 v[24:27], a[208:211], v[160:163], v[24:27]
    ds_read_b64_tr_b16 a[208:209], v11 offset:57344
    v_mfma_f32_16x16x32_bf16 v[24:27], a[184:187], v[192:195], v[24:27]
    ds_read_b64_tr_b16 a[210:211], v11 offset:59392
    v_mfma_f32_16x16x32_bf16 v[24:27], a[188:191], v[196:199], v[24:27]
    ds_read_b64_tr_b16 a[212:213], v11 offset:61440
    v_mfma_f32_16x16x32_bf16 v[28:31], a[188:191], v[204:207], v[28:31]
    ds_read_b64_tr_b16 a[214:215], v11 offset:63488
    v_subrev_u32 v11, 73728, v11
    v_mfma_f32_16x16x32_bf16 v[28:31], a[184:187], v[200:203], v[28:31]
    s_add_u32 s39, s40, 256
    v_mfma_f32_16x16x32_bf16 v[32:35], a[184:187], v[208:211], v[32:35]
    v_mfma_f32_16x16x32_bf16 v[32:35], a[188:191], v[212:215], v[32:35]
    s_add_u32 m0, s63, 73728
    v_mfma_f32_16x16x32_bf16 v[36:39], a[188:191], v[220:223], v[36:39]
    v_mfma_f32_16x16x32_bf16 v[36:39], a[184:187], v[216:219], v[36:39]
    v_mfma_f32_16x16x32_bf16 v[36:39], a[192:195], v[248:251], v[36:39]
    v_mfma_f32_16x16x32_bf16 v[36:39], a[196:199], v[252:255], v[36:39]
    s_waitcnt vmcnt(17) lgkmcnt(0)
    v_mfma_f32_16x16x32_bf16 v[32:35], a[196:199], v[244:247], v[32:35]
    s_barrier
    v_mfma_f32_16x16x32_bf16 v[32:35], a[192:195], v[240:243], v[32:35]
    buffer_load_dwordx4 v6, s[16:19], s39 offen lds
    v_mfma_f32_16x16x32_bf16 v[28:31], a[192:195], v[232:235], v[28:31]
    s_add_u32 s39, s40, 12544
    ds_read_b64_tr_b16 a[184:185], v8 offset:49152
    v_mfma_f32_16x16x32_bf16 v[28:31], a[196:199], v[236:239], v[28:31]
    ds_read_b64_tr_b16 a[186:187], v8 offset:51200
    v_mfma_f32_16x16x32_bf16 v[24:27], a[196:199], v[228:231], v[24:27]
    s_addk_i32 m0, 4096
    ds_read_b64_tr_b16 a[188:189], v8 offset:53248
    v_mfma_f32_16x16x32_bf16 v[24:27], a[192:195], v[224:227], v[24:27]
    ds_read_b64_tr_b16 a[190:191], v8 offset:55296
    v_mfma_f32_16x16x32_bf16 v[24:27], a[200:203], v[56:59], v[24:27]
    ds_read_b64_tr_b16 a[192:193], v8 offset:57344
    v_mfma_f32_16x16x32_bf16 v[24:27], a[204:207], v[60:63], v[24:27]
    ds_read_b64_tr_b16 a[194:195], v8 offset:59392
    v_mfma_f32_16x16x32_bf16 v[28:31], a[204:207], v[68:71], v[28:31]
    ds_read_b64_tr_b16 a[196:197], v8 offset:61440
    v_mfma_f32_16x16x32_bf16 v[28:31], a[200:203], v[64:67], v[28:31]
    ds_read_b64_tr_b16 a[198:199], v8 offset:63488
    v_mfma_f32_16x16x32_bf16 v[32:35], a[200:203], v[72:75], v[32:35]
    buffer_load_dwordx4 v6, s[16:19], s39 offen lds
    v_mfma_f32_16x16x32_bf16 v[32:35], a[204:207], v[76:79], v[32:35]
    s_add_u32 s39, s40, 24832
    v_mfma_f32_16x16x32_bf16 v[36:39], a[204:207], v[84:87], v[36:39]
    v_mfma_f32_16x16x32_bf16 v[36:39], a[200:203], v[80:83], v[36:39]
    s_addk_i32 m0, 4096
    ds_read_b64_tr_b16 a[200:201], v8 offset:0
    v_mfma_f32_16x16x32_bf16 v[36:39], a[208:211], v[112:115], v[36:39]
    ds_read_b64_tr_b16 a[202:203], v8 offset:2048
    v_mfma_f32_16x16x32_bf16 v[36:39], a[212:215], v[116:119], v[36:39]
    ds_read_b64_tr_b16 a[204:205], v8 offset:4096
    v_mfma_f32_16x16x32_bf16 v[32:35], a[212:215], v[108:111], v[32:35]
    s_waitcnt lgkmcnt(3)
    ds_read_b64_tr_b16 a[206:207], v8 offset:6144
    v_mfma_f32_16x16x32_bf16 v[32:35], a[208:211], v[104:107], v[32:35]
    v_mfma_f32_16x16x32_bf16 v[28:31], a[208:211], v[96:99], v[28:31]
    v_mfma_f32_16x16x32_bf16 v[28:31], a[212:215], v[100:103], v[28:31]
    buffer_load_dwordx4 v6, s[16:19], s39 offen lds
    v_mfma_f32_16x16x32_bf16 v[24:27], a[212:215], v[92:95], v[24:27]
    s_add_u32 s39, s40, 37120
    v_mul_f32 v36, v19, v36
    v_mfma_f32_16x16x32_bf16 v[24:27], a[208:211], v[88:91], v[24:27]
    ds_read_b64_tr_b16 a[208:209], v8 offset:8192
    v_mul_f32 v32, v18, v32
    v_mfma_f32_16x16x32_bf16 v[40:43], a[184:187], a[96:99], 0
    s_addk_i32 m0, 4096
    ds_read_b64_tr_b16 a[210:211], v8 offset:10240
    v_mul_f32 v28, v17, v28
    v_mfma_f32_16x16x32_bf16 v[40:43], a[188:191], a[100:103], v[40:43]
    ds_read_b64_tr_b16 a[212:213], v8 offset:12288
    v_mul_f32 v24, v16, v24
    v_mfma_f32_16x16x32_bf16 v[44:47], a[188:191], a[108:111], 0
    s_waitcnt vmcnt(3)
    ds_read_b64_tr_b16 a[214:215], v8 offset:14336
    v_mul_f32 v25, v16, v25
    v_mfma_f32_16x16x32_bf16 v[44:47], a[184:187], a[104:107], v[44:47]
    buffer_store_dword v4, v15, s[24:27], s76 offen sc1
    v_mfma_f32_16x16x32_bf16 v[48:51], a[184:187], a[112:115], 0
    v_mov_b32 v4, s56
    v_mul_f32 v26, v16, v26
    v_mfma_f32_16x16x32_bf16 v[48:51], a[188:191], a[116:119], v[48:51]
    s_add_u32 s56, s7, 3
    v_mul_f32 v27, v16, v27
    v_cvt_pk_bf16_f32 v24, v24, v25
    v_mfma_f32_16x16x32_bf16 v[52:55], a[188:191], a[124:127], 0
    buffer_load_dwordx4 v6, s[16:19], s39 offen lds
    v_mfma_f32_16x16x32_bf16 v[52:55], a[184:187], a[120:123], v[52:55]
    s_add_u32 s39, s40, 49408
    v_cvt_pk_bf16_f32 v25, v26, v27
    v_accvgpr_write_b32 a18, v24
    v_mfma_f32_16x16x32_bf16 v[52:55], a[192:195], v[120:123], v[52:55]
    v_accvgpr_write_b32 a19, v25
    v_mul_f32 v29, v17, v29
    v_mfma_f32_16x16x32_bf16 v[52:55], a[196:199], v[124:127], v[52:55]
    buffer_store_dwordx4 a[16:19], v14, s[20:23], s55 offen offset:0 sc1
    v_mul_f32 v30, v17, v30
    v_mfma_f32_16x16x32_bf16 v[48:51], a[196:199], a[148:151], v[48:51]
    s_addk_i32 m0, 4096
    v_mul_f32 v31, v17, v31
    v_cvt_pk_bf16_f32 v28, v28, v29
    v_mfma_f32_16x16x32_bf16 v[48:51], a[192:195], a[144:147], v[48:51]
    v_cvt_pk_bf16_f32 v29, v30, v31
    v_accvgpr_write_b32 a22, v28
    v_mfma_f32_16x16x32_bf16 v[44:47], a[192:195], a[136:139], v[44:47]
    v_accvgpr_write_b32 a23, v29
    v_mfma_f32_16x16x32_bf16 v[44:47], a[196:199], a[140:143], v[44:47]
    buffer_store_dwordx4 a[20:23], v14, s[20:23], s55 offen offset:1024 sc1
    v_mul_f32 v33, v18, v33
    v_mfma_f32_16x16x32_bf16 v[40:43], a[196:199], a[132:135], v[40:43]
    s_waitcnt lgkmcnt(0)
    v_mul_f32 v34, v18, v34
    v_mul_f32 v35, v18, v35
    v_mfma_f32_16x16x32_bf16 v[40:43], a[192:195], a[128:131], v[40:43]
    buffer_load_dwordx4 v6, s[16:19], s39 offen lds
    v_mfma_f32_16x16x32_bf16 v[40:43], a[200:203], v[128:131], v[40:43]
    s_add_u32 s39, s40, 61696
    v_cvt_pk_bf16_f32 v32, v32, v33
    v_cvt_pk_bf16_f32 v33, v34, v35
    v_mfma_f32_16x16x32_bf16 v[40:43], a[204:207], v[132:135], v[40:43]
    v_accvgpr_write_b32 a26, v32
    v_accvgpr_write_b32 a27, v33
    v_mfma_f32_16x16x32_bf16 v[44:47], a[204:207], v[140:143], v[44:47]
    buffer_store_dwordx4 a[24:27], v14, s[20:23], s55 offen offset:2048 sc1
    v_mul_f32 v37, v19, v37
    v_mfma_f32_16x16x32_bf16 v[44:47], a[200:203], v[136:139], v[44:47]
    s_addk_i32 m0, 4096
    v_mul_f32 v38, v19, v38
    v_mfma_f32_16x16x32_bf16 v[48:51], a[200:203], v[144:147], v[48:51]
    s_barrier
    v_mfma_f32_16x16x32_bf16 v[48:51], a[204:207], v[148:151], v[48:51]
    ds_read_b64_tr_b16 a[184:185], v8 offset:16384
    v_mul_f32 v39, v19, v39
    v_mfma_f32_16x16x32_bf16 v[52:55], a[204:207], v[156:159], v[52:55]
    ds_read_b64_tr_b16 a[186:187], v8 offset:18432
    v_cvt_pk_bf16_f32 v36, v36, v37
    v_mfma_f32_16x16x32_bf16 v[52:55], a[200:203], v[152:155], v[52:55]
    ds_read_b64_tr_b16 a[188:189], v8 offset:20480
    v_cvt_pk_bf16_f32 v37, v38, v39
    v_mfma_f32_16x16x32_bf16 v[52:55], a[208:211], v[184:187], v[52:55]
    buffer_load_dwordx4 v6, s[16:19], s39 offen lds
    v_mfma_f32_16x16x32_bf16 v[52:55], a[212:215], v[188:191], v[52:55]
    s_add_u32 s39, s40, 73984
    ds_read_b64_tr_b16 a[190:191], v8 offset:22528
    v_accvgpr_write_b32 a30, v36
    v_mfma_f32_16x16x32_bf16 v[48:51], a[212:215], v[180:183], v[48:51]
    ds_read_b64_tr_b16 a[192:193], v8 offset:24576
    v_accvgpr_write_b32 a31, v37
    v_mfma_f32_16x16x32_bf16 v[48:51], a[208:211], v[176:179], v[48:51]
    buffer_store_dwordx4 a[28:31], v14, s[20:23], s55 offen offset:3072 sc1
    v_mfma_f32_16x16x32_bf16 v[44:47], a[208:211], v[168:171], v[44:47]
    s_addk_i32 m0, 4096
    ds_read_b64_tr_b16 a[194:195], v8 offset:26624
    s_add_u32 s55, s55, 4096
    v_mfma_f32_16x16x32_bf16 v[44:47], a[212:215], v[172:175], v[44:47]
    s_waitcnt lgkmcnt(4)
    ds_read_b64_tr_b16 a[196:197], v8 offset:28672
    v_mfma_f32_16x16x32_bf16 v[40:43], a[212:215], v[164:167], v[40:43]
    ds_read_b64_tr_b16 a[198:199], v8 offset:30720
    v_mfma_f32_16x16x32_bf16 v[40:43], a[208:211], v[160:163], v[40:43]
    ds_read_b64_tr_b16 a[200:201], v8 offset:32768
    v_mfma_f32_16x16x32_bf16 v[40:43], a[184:187], v[192:195], v[40:43]
    s_waitcnt lgkmcnt(5)
    ds_read_b64_tr_b16 a[202:203], v8 offset:34816
    v_mfma_f32_16x16x32_bf16 v[40:43], a[188:191], v[196:199], v[40:43]
    buffer_load_dwordx4 v6, s[16:19], s39 offen lds
    v_mfma_f32_16x16x32_bf16 v[44:47], a[188:191], v[204:207], v[44:47]
    s_add_u32 s39, s40, 86272
    ds_read_b64_tr_b16 a[204:205], v8 offset:36864
    v_mfma_f32_16x16x32_bf16 v[44:47], a[184:187], v[200:203], v[44:47]
    ds_read_b64_tr_b16 a[206:207], v8 offset:38912
    v_mfma_f32_16x16x32_bf16 v[48:51], a[184:187], v[208:211], v[48:51]
    s_addk_i32 m0, 4096
    ds_read_b64_tr_b16 a[208:209], v8 offset:40960
    v_mfma_f32_16x16x32_bf16 v[48:51], a[188:191], v[212:215], v[48:51]
    s_waitcnt lgkmcnt(5)
    ds_read_b64_tr_b16 a[210:211], v8 offset:43008
    v_mfma_f32_16x16x32_bf16 v[52:55], a[188:191], v[220:223], v[52:55]
    ds_read_b64_tr_b16 a[212:213], v8 offset:45056
    v_mfma_f32_16x16x32_bf16 v[52:55], a[184:187], v[216:219], v[52:55]
    ds_read_b64_tr_b16 a[214:215], v8 offset:47104
    v_add_u32 v8, 73728, v8
    v_mfma_f32_16x16x32_bf16 v[52:55], a[192:195], v[248:251], v[52:55]
    ds_read_b64_tr_b16 a[184:185], v9 offset:49152
    v_mfma_f32_16x16x32_bf16 v[52:55], a[196:199], v[252:255], v[52:55]
    ds_read_b64_tr_b16 a[186:187], v9 offset:51200
    v_mfma_f32_16x16x32_bf16 v[48:51], a[196:199], v[244:247], v[48:51]
    buffer_load_dwordx4 v6, s[16:19], s39 offen lds
    v_mfma_f32_16x16x32_bf16 v[48:51], a[192:195], v[240:243], v[48:51]
    s_add_u32 s39, s40, 98560
    ds_read_b64_tr_b16 a[188:189], v9 offset:53248
    v_mfma_f32_16x16x32_bf16 v[44:47], a[192:195], v[232:235], v[44:47]
    s_waitcnt lgkmcnt(5)
    ds_read_b64_tr_b16 a[190:191], v9 offset:55296
    v_mfma_f32_16x16x32_bf16 v[44:47], a[196:199], v[236:239], v[44:47]
    s_addk_i32 m0, 4096
    v_mfma_f32_16x16x32_bf16 v[40:43], a[196:199], v[228:231], v[40:43]
    v_mfma_f32_16x16x32_bf16 v[40:43], a[192:195], v[224:227], v[40:43]
    ds_read_b64_tr_b16 a[192:193], v9 offset:57344
    v_mfma_f32_16x16x32_bf16 v[40:43], a[200:203], v[56:59], v[40:43]
    ds_read_b64_tr_b16 a[194:195], v9 offset:59392
    v_mfma_f32_16x16x32_bf16 v[40:43], a[204:207], v[60:63], v[40:43]
    ds_read_b64_tr_b16 a[196:197], v9 offset:61440
    v_mfma_f32_16x16x32_bf16 v[44:47], a[204:207], v[68:71], v[44:47]
    ds_read_b64_tr_b16 a[198:199], v9 offset:63488
    v_mfma_f32_16x16x32_bf16 v[44:47], a[200:203], v[64:67], v[44:47]
    buffer_load_dwordx4 v6, s[16:19], s39 offen lds
    v_mfma_f32_16x16x32_bf16 v[48:51], a[200:203], v[72:75], v[48:51]
    s_add_u32 s39, s40, 110848
    v_mfma_f32_16x16x32_bf16 v[48:51], a[204:207], v[76:79], v[48:51]
    v_mfma_f32_16x16x32_bf16 v[52:55], a[204:207], v[84:87], v[52:55]
    s_waitcnt lgkmcnt(3)
    s_addk_i32 m0, 4096
    v_mfma_f32_16x16x32_bf16 v[52:55], a[200:203], v[80:83], v[52:55]
    ds_read_b64_tr_b16 a[200:201], v9 offset:0
    v_mfma_f32_16x16x32_bf16 v[52:55], a[208:211], v[112:115], v[52:55]
    ds_read_b64_tr_b16 a[202:203], v9 offset:2048
    v_mfma_f32_16x16x32_bf16 v[52:55], a[212:215], v[116:119], v[52:55]
    ds_read_b64_tr_b16 a[204:205], v9 offset:4096
    v_mfma_f32_16x16x32_bf16 v[48:51], a[212:215], v[108:111], v[48:51]
    ds_read_b64_tr_b16 a[206:207], v9 offset:6144
    v_mfma_f32_16x16x32_bf16 v[48:51], a[208:211], v[104:107], v[48:51]
    v_mfma_f32_16x16x32_bf16 v[44:47], a[208:211], v[96:99], v[44:47]
    buffer_load_dwordx4 v6, s[16:19], s39 offen lds
    v_mfma_f32_16x16x32_bf16 v[44:47], a[212:215], v[100:103], v[44:47]
    s_add_u32 s39, s40, 123136
    v_mul_f32 v52, v19, v52
    v_mfma_f32_16x16x32_bf16 v[40:43], a[212:215], v[92:95], v[40:43]
    v_mul_f32 v53, v19, v53
    v_mfma_f32_16x16x32_bf16 v[40:43], a[208:211], v[88:91], v[40:43]
    s_addk_i32 m0, 4096
    ds_read_b64_tr_b16 a[208:209], v9 offset:8192
    v_mul_f32 v48, v18, v48
    v_mfma_f32_16x16x32_bf16 v[24:27], a[184:187], a[96:99], 0
    ds_read_b64_tr_b16 a[210:211], v9 offset:10240
    v_mul_f32 v44, v17, v44
    v_mfma_f32_16x16x32_bf16 v[24:27], a[188:191], a[100:103], v[24:27]
    ds_read_b64_tr_b16 a[212:213], v9 offset:12288
    v_mul_f32 v40, v16, v40
    v_mfma_f32_16x16x32_bf16 v[28:31], a[188:191], a[108:111], 0
    ds_read_b64_tr_b16 a[214:215], v9 offset:14336
    v_mul_f32 v41, v16, v41
    v_mfma_f32_16x16x32_bf16 v[28:31], a[184:187], a[104:107], v[28:31]
    s_waitcnt lgkmcnt(4)
    v_mul_f32 v42, v16, v42
    v_mul_f32 v43, v16, v43
    v_mfma_f32_16x16x32_bf16 v[32:35], a[184:187], a[112:115], 0
    v_cvt_pk_bf16_f32 v40, v40, v41
    v_cvt_pk_bf16_f32 v41, v42, v43
    v_mfma_f32_16x16x32_bf16 v[32:35], a[188:191], a[116:119], v[32:35]
    buffer_load_dwordx4 v6, s[16:19], s39 offen lds
    v_mfma_f32_16x16x32_bf16 v[36:39], a[188:191], a[124:127], 0
    s_add_u32 s39, s40, 135424
    v_accvgpr_write_b32 a32, v40
    v_accvgpr_write_b32 a33, v41
    v_mfma_f32_16x16x32_bf16 v[36:39], a[184:187], a[120:123], v[36:39]
    ds_read_b64_tr_b16 a[184:185], v9 offset:16384
    v_mul_f32 v45, v17, v45
    v_mfma_f32_16x16x32_bf16 v[36:39], a[192:195], v[120:123], v[36:39]
    s_addk_i32 m0, 4096
    ds_read_b64_tr_b16 a[186:187], v9 offset:18432
    v_mul_f32 v46, v17, v46
    v_mfma_f32_16x16x32_bf16 v[36:39], a[196:199], v[124:127], v[36:39]
    ds_read_b64_tr_b16 a[188:189], v9 offset:20480
    v_mul_f32 v47, v17, v47
    v_mfma_f32_16x16x32_bf16 v[32:35], a[196:199], a[148:151], v[32:35]
    ds_read_b64_tr_b16 a[190:191], v9 offset:22528
    v_cvt_pk_bf16_f32 v44, v44, v45
    v_mfma_f32_16x16x32_bf16 v[32:35], a[192:195], a[144:147], v[32:35]
    v_cvt_pk_bf16_f32 v45, v46, v47
    v_accvgpr_write_b32 a36, v44
    v_mfma_f32_16x16x32_bf16 v[28:31], a[192:195], a[136:139], v[28:31]
    v_accvgpr_write_b32 a37, v45
    v_mfma_f32_16x16x32_bf16 v[28:31], a[196:199], a[140:143], v[28:31]
    v_mul_f32 v49, v18, v49
    v_mfma_f32_16x16x32_bf16 v[24:27], a[196:199], a[132:135], v[24:27]
    buffer_load_dwordx4 v6, s[16:19], s39 offen lds
    v_mfma_f32_16x16x32_bf16 v[24:27], a[192:195], a[128:131], v[24:27]
    s_add_u32 s39, s40, 147712
    ds_read_b64_tr_b16 a[192:193], v9 offset:24576
    v_mul_f32 v50, v18, v50
    v_mfma_f32_16x16x32_bf16 v[24:27], a[200:203], v[128:131], v[24:27]
    ds_read_b64_tr_b16 a[194:195], v9 offset:26624
    v_mul_f32 v51, v18, v51
    v_mfma_f32_16x16x32_bf16 v[24:27], a[204:207], v[132:135], v[24:27]
    s_addk_i32 m0, 4096
    ds_read_b64_tr_b16 a[196:197], v9 offset:28672
    v_cvt_pk_bf16_f32 v48, v48, v49
    v_mfma_f32_16x16x32_bf16 v[28:31], a[204:207], v[140:143], v[28:31]
    s_waitcnt lgkmcnt(3)
    ds_read_b64_tr_b16 a[198:199], v9 offset:30720
    v_cvt_pk_bf16_f32 v49, v50, v51
    v_mfma_f32_16x16x32_bf16 v[28:31], a[200:203], v[136:139], v[28:31]
    v_accvgpr_write_b32 a40, v48
    v_accvgpr_write_b32 a41, v49
    v_mfma_f32_16x16x32_bf16 v[32:35], a[200:203], v[144:147], v[32:35]
    v_mul_f32 v54, v19, v54
    v_mul_f32 v55, v19, v55
    v_mfma_f32_16x16x32_bf16 v[32:35], a[204:207], v[148:151], v[32:35]
    v_cvt_pk_bf16_f32 v52, v52, v53
    v_cvt_pk_bf16_f32 v53, v54, v55
    v_mfma_f32_16x16x32_bf16 v[36:39], a[204:207], v[156:159], v[36:39]
    v_accvgpr_write_b32 a44, v52
    v_accvgpr_write_b32 a45, v53
    v_mfma_f32_16x16x32_bf16 v[36:39], a[200:203], v[152:155], v[36:39]
    buffer_load_dwordx4 v6, s[16:19], s39 offen lds
    v_mfma_f32_16x16x32_bf16 v[36:39], a[208:211], v[184:187], v[36:39]
    s_add_u32 s39, s40, 160000
    ds_read_b64_tr_b16 a[200:201], v9 offset:32768
    v_mfma_f32_16x16x32_bf16 v[36:39], a[212:215], v[188:191], v[36:39]
    s_waitcnt vmcnt(7)
    ds_read_b64_tr_b16 a[202:203], v9 offset:34816
    v_mfma_f32_16x16x32_bf16 v[32:35], a[212:215], v[180:183], v[32:35]
    buffer_store_dword v4, v15, s[24:27], s76 offen sc1
    v_mfma_f32_16x16x32_bf16 v[32:35], a[208:211], v[176:179], v[32:35]
    s_addk_i32 m0, 4096
    ds_read_b64_tr_b16 a[204:205], v9 offset:36864
    v_mfma_f32_16x16x32_bf16 v[28:31], a[208:211], v[168:171], v[28:31]
    ds_read_b64_tr_b16 a[206:207], v9 offset:38912
    v_mfma_f32_16x16x32_bf16 v[28:31], a[212:215], v[172:175], v[28:31]
    v_mov_b32 v4, s56
    v_mfma_f32_16x16x32_bf16 v[24:27], a[212:215], v[164:167], v[24:27]
    s_add_u32 s56, s7, 4
    v_mfma_f32_16x16x32_bf16 v[24:27], a[208:211], v[160:163], v[24:27]
    ds_read_b64_tr_b16 a[208:209], v9 offset:40960
    v_mfma_f32_16x16x32_bf16 v[24:27], a[184:187], v[192:195], v[24:27]
    buffer_load_dwordx4 v6, s[16:19], s39 offen lds
    v_mfma_f32_16x16x32_bf16 v[24:27], a[188:191], v[196:199], v[24:27]
    s_load_dwordx4 s[72:75], s[86:87], s5 glc
    ds_read_b64_tr_b16 a[210:211], v9 offset:43008
    s_add_u32 s39, s40, 172288
    v_mfma_f32_16x16x32_bf16 v[28:31], a[188:191], v[204:207], v[28:31]
    ds_read_b64_tr_b16 a[212:213], v9 offset:45056
    v_mfma_f32_16x16x32_bf16 v[28:31], a[184:187], v[200:203], v[28:31]
    s_waitcnt lgkmcnt(5)
    ds_read_b64_tr_b16 a[214:215], v9 offset:47104
    v_add_u32 v9, 73728, v9
    v_mfma_f32_16x16x32_bf16 v[32:35], a[184:187], v[208:211], v[32:35]
    s_add_u32 m0, s63, 131072
    v_mfma_f32_16x16x32_bf16 v[32:35], a[188:191], v[212:215], v[32:35]
    v_mfma_f32_16x16x32_bf16 v[36:39], a[188:191], v[220:223], v[36:39]
    v_mfma_f32_16x16x32_bf16 v[36:39], a[184:187], v[216:219], v[36:39]
    ds_read_b64_tr_b16 a[184:185], v10 offset:49152
    v_mfma_f32_16x16x32_bf16 v[36:39], a[192:195], v[248:251], v[36:39]
    ds_read_b64_tr_b16 a[186:187], v10 offset:51200
    v_mfma_f32_16x16x32_bf16 v[36:39], a[196:199], v[252:255], v[36:39]
    buffer_load_dwordx4 v6, s[16:19], s39 offen lds
    v_mfma_f32_16x16x32_bf16 v[32:35], a[196:199], v[244:247], v[32:35]
    s_add_u32 s39, s40, 184576
    ds_read_b64_tr_b16 a[188:189], v10 offset:53248
    v_mfma_f32_16x16x32_bf16 v[32:35], a[192:195], v[240:243], v[32:35]
    ds_read_b64_tr_b16 a[190:191], v10 offset:55296
    v_mfma_f32_16x16x32_bf16 v[28:31], a[192:195], v[232:235], v[28:31]
    s_addk_i32 m0, 4096
    v_mfma_f32_16x16x32_bf16 v[28:31], a[196:199], v[236:239], v[28:31]
    v_mfma_f32_16x16x32_bf16 v[24:27], a[196:199], v[228:231], v[24:27]
    s_waitcnt lgkmcnt(5)
    v_mfma_f32_16x16x32_bf16 v[24:27], a[192:195], v[224:227], v[24:27]
    ds_read_b64_tr_b16 a[192:193], v10 offset:57344
    v_mfma_f32_16x16x32_bf16 v[24:27], a[200:203], v[56:59], v[24:27]
    ds_read_b64_tr_b16 a[194:195], v10 offset:59392
    v_mfma_f32_16x16x32_bf16 v[24:27], a[204:207], v[60:63], v[24:27]
    ds_read_b64_tr_b16 a[196:197], v10 offset:61440
    v_mfma_f32_16x16x32_bf16 v[28:31], a[204:207], v[68:71], v[28:31]
    buffer_load_dwordx4 v6, s[16:19], s39 offen lds
    v_mfma_f32_16x16x32_bf16 v[28:31], a[200:203], v[64:67], v[28:31]
    ds_read_b64_tr_b16 a[198:199], v10 offset:63488
    v_mfma_f32_16x16x32_bf16 v[32:35], a[200:203], v[72:75], v[32:35]
    v_mov_b32 v6, s7
    v_mfma_f32_16x16x32_bf16 v[32:35], a[204:207], v[76:79], v[32:35]
    v_mfma_f32_16x16x32_bf16 v[36:39], a[204:207], v[84:87], v[36:39]
    s_waitcnt lgkmcnt(5)
    v_mfma_f32_16x16x32_bf16 v[36:39], a[200:203], v[80:83], v[36:39]
    ds_read_b64_tr_b16 a[200:201], v10 offset:0
    v_mfma_f32_16x16x32_bf16 v[36:39], a[208:211], v[112:115], v[36:39]
    ds_read_b64_tr_b16 a[202:203], v10 offset:2048
    v_mfma_f32_16x16x32_bf16 v[36:39], a[212:215], v[116:119], v[36:39]
    ds_read_b64_tr_b16 a[204:205], v10 offset:4096
    v_mfma_f32_16x16x32_bf16 v[32:35], a[212:215], v[108:111], v[32:35]
    s_add_u32 s77, s7, 1
    ds_read_b64_tr_b16 a[206:207], v10 offset:6144
    v_mfma_f32_16x16x32_bf16 v[32:35], a[208:211], v[104:107], v[32:35]
    v_mfma_f32_16x16x32_bf16 v[28:31], a[208:211], v[96:99], v[28:31]
    v_mfma_f32_16x16x32_bf16 v[28:31], a[212:215], v[100:103], v[28:31]
    v_mfma_f32_16x16x32_bf16 v[24:27], a[212:215], v[92:95], v[24:27]
    s_waitcnt lgkmcnt(5)
    v_mul_f32 v36, v19, v36
    v_mfma_f32_16x16x32_bf16 v[24:27], a[208:211], v[88:91], v[24:27]
    ds_read_b64_tr_b16 a[208:209], v10 offset:8192
    v_mfma_f32_16x16x32_bf16 v[40:43], a[184:187], a[96:99], 0
    s_lshl_b32 s42, s48, 8
    ds_read_b64_tr_b16 a[210:211], v10 offset:10240
    v_lshrrev_b32 v22, 2, v1
    v_mfma_f32_16x16x32_bf16 v[40:43], a[188:191], a[100:103], v[40:43]
    s_add_u32 s42, s42, 3932304
    ds_read_b64_tr_b16 a[212:213], v10 offset:12288
    v_min_u32 v22, 9, v22
    v_mfma_f32_16x16x32_bf16 v[44:47], a[188:191], a[108:111], 0
    ds_read_b64_tr_b16 a[214:215], v10 offset:14336
    v_mul_u32_u24 v22, 6144, v22
    v_mfma_f32_16x16x32_bf16 v[44:47], a[184:187], a[104:107], v[44:47]
    v_and_b32 v23, 3, v1
    v_lshl_add_u32 v22, v23, 2, v22
    v_mfma_f32_16x16x32_bf16 v[48:51], a[184:187], a[112:115], 0
    buffer_load_dword v23, v22, s[24:27], s42 offen sc1
    v_mfma_f32_16x16x32_bf16 v[48:51], a[188:191], a[116:119], v[48:51]
    v_mul_f32 v24, v16, v24
    v_mul_f32 v25, v16, v25
    v_mfma_f32_16x16x32_bf16 v[52:55], a[188:191], a[124:127], 0
    s_waitcnt lgkmcnt(5)
    v_mul_f32 v26, v16, v26
    v_mul_f32 v27, v16, v27
    v_mfma_f32_16x16x32_bf16 v[52:55], a[184:187], a[120:123], v[52:55]
    ds_read_b64_tr_b16 a[184:185], v10 offset:16384
    v_cvt_pk_bf16_f32 v24, v24, v25
    v_mfma_f32_16x16x32_bf16 v[52:55], a[192:195], v[120:123], v[52:55]
    ds_read_b64_tr_b16 a[186:187], v10 offset:18432
    v_cvt_pk_bf16_f32 v25, v26, v27
    v_mfma_f32_16x16x32_bf16 v[52:55], a[196:199], v[124:127], v[52:55]
    ds_read_b64_tr_b16 a[188:189], v10 offset:20480
    v_accvgpr_write_b32 a34, v24
    v_mfma_f32_16x16x32_bf16 v[48:51], a[196:199], a[148:151], v[48:51]
    ds_read_b64_tr_b16 a[190:191], v10 offset:22528
    v_accvgpr_write_b32 a35, v25
    v_mfma_f32_16x16x32_bf16 v[48:51], a[192:195], a[144:147], v[48:51]
    buffer_store_dwordx4 a[32:35], v14, s[20:23], s55 offen offset:0 sc1
    v_mul_f32 v28, v17, v28
    v_mfma_f32_16x16x32_bf16 v[44:47], a[192:195], a[136:139], v[44:47]
    v_mul_f32 v29, v17, v29
    v_mul_f32 v30, v17, v30
    v_mfma_f32_16x16x32_bf16 v[44:47], a[196:199], a[140:143], v[44:47]
    v_mul_f32 v31, v17, v31
    v_cvt_pk_bf16_f32 v28, v28, v29
    v_mfma_f32_16x16x32_bf16 v[40:43], a[196:199], a[132:135], v[40:43]
    s_waitcnt lgkmcnt(5)
    v_cvt_pk_bf16_f32 v29, v30, v31
    v_accvgpr_write_b32 a38, v28
    v_mfma_f32_16x16x32_bf16 v[40:43], a[192:195], a[128:131], v[40:43]
    s_sub_u32 s78, s72, s77
    ds_read_b64_tr_b16 a[192:193], v10 offset:24576
    v_accvgpr_write_b32 a39, v29
    v_mfma_f32_16x16x32_bf16 v[40:43], a[200:203], v[128:131], v[40:43]
    buffer_store_dwordx4 a[36:39], v14, s[20:23], s55 offen offset:1024 sc1
    v_mul_f32 v32, v18, v32
    v_mfma_f32_16x16x32_bf16 v[40:43], a[204:207], v[132:135], v[40:43]
    s_sub_u32 s79, s73, s77
    ds_read_b64_tr_b16 a[194:195], v10 offset:26624
    v_mul_f32 v33, v18, v33
    v_mfma_f32_16x16x32_bf16 v[44:47], a[204:207], v[140:143], v[44:47]
    s_max_u32 s78, s78, s79
    ds_read_b64_tr_b16 a[196:197], v10 offset:28672
    v_mul_f32 v34, v18, v34
    v_mfma_f32_16x16x32_bf16 v[44:47], a[200:203], v[136:139], v[44:47]
    s_sub_u32 s79, s74, s77
    ds_read_b64_tr_b16 a[198:199], v10 offset:30720
    v_mul_f32 v35, v18, v35
    v_mfma_f32_16x16x32_bf16 v[48:51], a[200:203], v[144:147], v[48:51]
    s_max_u32 s78, s78, s79
    v_cvt_pk_bf16_f32 v32, v32, v33
    v_cvt_pk_bf16_f32 v33, v34, v35
    v_mfma_f32_16x16x32_bf16 v[48:51], a[204:207], v[148:151], v[48:51]
    s_sub_u32 s79, s75, s77
    v_accvgpr_write_b32 a42, v32
    v_accvgpr_write_b32 a43, v33
    v_mfma_f32_16x16x32_bf16 v[52:55], a[204:207], v[156:159], v[52:55]
    buffer_store_dwordx4 a[40:43], v14, s[20:23], s55 offen offset:2048 sc1
    v_mul_f32 v37, v19, v37
    v_mfma_f32_16x16x32_bf16 v[52:55], a[200:203], v[152:155], v[52:55]
    s_waitcnt lgkmcnt(3)
    ds_read_b64_tr_b16 a[200:201], v10 offset:32768
    v_mul_f32 v38, v19, v38
    v_mfma_f32_16x16x32_bf16 v[52:55], a[208:211], v[184:187], v[52:55]
    s_max_u32 s78, s78, s79
    ds_read_b64_tr_b16 a[202:203], v10 offset:34816
    v_mul_f32 v39, v19, v39
    v_mfma_f32_16x16x32_bf16 v[52:55], a[212:215], v[188:191], v[52:55]
    s_cmp_gt_u32 s78, 5
    s_cbranch_scc1 spin_o0
spin_o0_ret:
    v_cvt_pk_bf16_f32 v36, v36, v37
    v_mfma_f32_16x16x32_bf16 v[48:51], a[212:215], v[180:183], v[48:51]
    s_add_u32 s37, s59, 0
    ds_read_b64_tr_b16 a[204:205], v10 offset:36864
    v_cvt_pk_bf16_f32 v37, v38, v39
    v_mfma_f32_16x16x32_bf16 v[48:51], a[208:211], v[176:179], v[48:51]
    buffer_load_dwordx4 a[216:219], v14, s[20:23], s37 offen offset:0 sc1
    v_mfma_f32_16x16x32_bf16 v[44:47], a[208:211], v[168:171], v[44:47]
    ds_read_b64_tr_b16 a[206:207], v10 offset:38912
    v_accvgpr_write_b32 a46, v36
    v_mfma_f32_16x16x32_bf16 v[44:47], a[212:215], v[172:175], v[44:47]
    v_accvgpr_write_b32 a47, v37
    v_mfma_f32_16x16x32_bf16 v[40:43], a[212:215], v[164:167], v[40:43]
    buffer_store_dwordx4 a[44:47], v14, s[20:23], s55 offen offset:3072 sc1
    v_mfma_f32_16x16x32_bf16 v[40:43], a[208:211], v[160:163], v[40:43]
pg_10:
    s_cbranch_execz pg_14
    s_add_u32 s55, s55, 4096
    ds_read_b64_tr_b16 a[208:209], v10 offset:40960
    v_mfma_f32_16x16x32_bf16 v[40:43], a[184:187], v[192:195], v[40:43]
    ds_read_b64_tr_b16 a[210:211], v10 offset:43008
    v_mfma_f32_16x16x32_bf16 v[40:43], a[188:191], v[196:199], v[40:43]
    buffer_load_dwordx4 a[220:223], v14, s[20:23], s37 offen offset:1024 sc1
    v_mfma_f32_16x16x32_bf16 v[44:47], a[188:191], v[204:207], v[44:47]
    ds_read_b64_tr_b16 a[212:213], v10 offset:45056
    v_mfma_f32_16x16x32_bf16 v[44:47], a[184:187], v[200:203], v[44:47]
    ds_read_b64_tr_b16 a[214:215], v10 offset:47104
    v_add_u32 v10, 73728, v10
    v_mfma_f32_16x16x32_bf16 v[48:51], a[184:187], v[208:211], v[48:51]
    s_waitcnt lgkmcnt(4)
    v_mfma_f32_16x16x32_bf16 v[48:51], a[188:191], v[212:215], v[48:51]
    v_mfma_f32_16x16x32_bf16 v[52:55], a[188:191], v[220:223], v[52:55]
    v_mfma_f32_16x16x32_bf16 v[52:55], a[184:187], v[216:219], v[52:55]
    ds_read_b64_tr_b16 a[184:185], v11 offset:49152
    v_mfma_f32_16x16x32_bf16 v[52:55], a[192:195], v[248:251], v[52:55]
    ds_read_b64_tr_b16 a[186:187], v11 offset:51200
    v_mfma_f32_16x16x32_bf16 v[52:55], a[196:199], v[252:255], v[52:55]
    ds_read_b64_tr_b16 a[188:189], v11 offset:53248
    v_mfma_f32_16x16x32_bf16 v[48:51], a[196:199], v[244:247], v[48:51]
    buffer_load_dwordx4 a[224:227], v14, s[20:23], s37 offen offset:2048 sc1
    v_mfma_f32_16x16x32_bf16 v[48:51], a[192:195], v[240:243], v[48:51]
    ds_read_b64_tr_b16 a[190:191], v11 offset:55296
    v_mfma_f32_16x16x32_bf16 v[44:47], a[192:195], v[232:235], v[44:47]
    v_mfma_f32_16x16x32_bf16 v[44:47], a[196:199], v[236:239], v[44:47]
    v_mfma_f32_16x16x32_bf16 v[40:43], a[196:199], v[228:231], v[40:43]
    v_mfma_f32_16x16x32_bf16 v[40:43], a[192:195], v[224:227], v[40:43]
    ds_read_b64_tr_b16 a[192:193], v11 offset:57344
    v_mfma_f32_16x16x32_bf16 v[40:43], a[200:203], v[56:59], v[40:43]
    ds_read_b64_tr_b16 a[194:195], v11 offset:59392
    v_mfma_f32_16x16x32_bf16 v[40:43], a[204:207], v[60:63], v[40:43]
    ds_read_b64_tr_b16 a[196:197], v11 offset:61440
    v_mfma_f32_16x16x32_bf16 v[44:47], a[204:207], v[68:71], v[44:47]
    s_waitcnt lgkmcnt(3)
    ds_read_b64_tr_b16 a[198:199], v11 offset:63488
    v_mfma_f32_16x16x32_bf16 v[44:47], a[200:203], v[64:67], v[44:47]
    buffer_load_dwordx4 a[228:231], v14, s[20:23], s37 offen offset:3072 sc1
    v_mfma_f32_16x16x32_bf16 v[48:51], a[200:203], v[72:75], v[48:51]
    v_mfma_f32_16x16x32_bf16 v[48:51], a[204:207], v[76:79], v[48:51]
    v_mfma_f32_16x16x32_bf16 v[52:55], a[204:207], v[84:87], v[52:55]
    v_mfma_f32_16x16x32_bf16 v[52:55], a[200:203], v[80:83], v[52:55]
    ds_read_b64_tr_b16 a[200:201], v11 offset:0
    v_mfma_f32_16x16x32_bf16 v[52:55], a[208:211], v[112:115], v[52:55]
    ds_read_b64_tr_b16 a[202:203], v11 offset:2048
    v_mfma_f32_16x16x32_bf16 v[52:55], a[212:215], v[116:119], v[52:55]
    ds_read_b64_tr_b16 a[204:205], v11 offset:4096
    v_mfma_f32_16x16x32_bf16 v[48:51], a[212:215], v[108:111], v[48:51]
    ds_read_b64_tr_b16 a[206:207], v11 offset:6144
    v_mfma_f32_16x16x32_bf16 v[48:51], a[208:211], v[104:107], v[48:51]
    v_mfma_f32_16x16x32_bf16 v[44:47], a[208:211], v[96:99], v[44:47]
    v_mfma_f32_16x16x32_bf16 v[44:47], a[212:215], v[100:103], v[44:47]
    v_mfma_f32_16x16x32_bf16 v[40:43], a[212:215], v[92:95], v[40:43]
    s_add_u32 s37, s60, 0
    v_mul_f32 v52, v19, v52
    v_mfma_f32_16x16x32_bf16 v[40:43], a[208:211], v[88:91], v[40:43]
    ds_read_b64_tr_b16 a[208:209], v11 offset:8192
    v_mfma_f32_16x16x32_bf16 v[24:27], a[184:187], a[96:99], 0
    s_waitcnt vmcnt(8)
    ds_read_b64_tr_b16 a[210:211], v11 offset:10240
    v_cmp_ne_u32 vcc, s7, v23
    v_mfma_f32_16x16x32_bf16 v[24:27], a[188:191], a[100:103], v[24:27]
    s_cbranch_vccnz spin_gu
spin_gu_ret:
    v_mul_f32 v44, v17, v44
    v_mfma_f32_16x16x32_bf16 v[28:31], a[188:191], a[108:111], 0
    ds_read_b64_tr_b16 a[212:213], v11 offset:12288
    v_mul_f32 v40, v16, v40
    v_mfma_f32_16x16x32_bf16 v[28:31], a[184:187], a[104:107], v[28:31]
    s_waitcnt lgkmcnt(3)
    ds_read_b64_tr_b16 a[214:215], v11 offset:14336
    v_mul_f32 v41, v16, v41
    v_mfma_f32_16x16x32_bf16 v[32:35], a[184:187], a[112:115], 0
    buffer_load_dwordx4 a[232:235], v14, s[20:23], s37 offen offset:0 sc1
    v_mfma_f32_16x16x32_bf16 v[32:35], a[188:191], a[116:119], v[32:35]
    v_mul_f32 v42, v16, v42
    v_mul_f32 v43, v16, v43
    v_mfma_f32_16x16x32_bf16 v[36:39], a[188:191], a[124:127], 0
    v_cvt_pk_bf16_f32 v40, v40, v41
    v_cvt_pk_bf16_f32 v41, v42, v43
    v_mfma_f32_16x16x32_bf16 v[36:39], a[184:187], a[120:123], v[36:39]
    ds_read_b64_tr_b16 a[184:185], v11 offset:16384
    v_accvgpr_write_b32 a48, v40
    v_mfma_f32_16x16x32_bf16 v[36:39], a[192:195], v[120:123], v[36:39]
    ds_read_b64_tr_b16 a[186:187], v11 offset:18432
    v_accvgpr_write_b32 a49, v41
    v_mfma_f32_16x16x32_bf16 v[36:39], a[196:199], v[124:127], v[36:39]
    ds_read_b64_tr_b16 a[188:189], v11 offset:20480
    v_mul_f32 v45, v17, v45
    v_mfma_f32_16x16x32_bf16 v[32:35], a[196:199], a[148:151], v[32:35]
    ds_read_b64_tr_b16 a[190:191], v11 offset:22528
    v_mul_f32 v46, v17, v46
    v_mfma_f32_16x16x32_bf16 v[32:35], a[192:195], a[144:147], v[32:35]
    v_mul_f32 v47, v17, v47
    v_cvt_pk_bf16_f32 v44, v44, v45
    v_mfma_f32_16x16x32_bf16 v[28:31], a[192:195], a[136:139], v[28:31]
    v_cvt_pk_bf16_f32 v45, v46, v47
    v_accvgpr_write_b32 a52, v44
    v_mfma_f32_16x16x32_bf16 v[28:31], a[196:199], a[140:143], v[28:31]
    buffer_load_dwordx4 a[236:239], v14, s[20:23], s37 offen offset:1024 sc1
    v_mfma_f32_16x16x32_bf16 v[24:27], a[196:199], a[132:135], v[24:27]
    v_accvgpr_write_b32 a53, v45
    v_mul_f32 v48, v18, v48
    v_mfma_f32_16x16x32_bf16 v[24:27], a[192:195], a[128:131], v[24:27]
    ds_read_b64_tr_b16 a[192:193], v11 offset:24576
    v_mul_f32 v49, v18, v49
    v_mfma_f32_16x16x32_bf16 v[24:27], a[200:203], v[128:131], v[24:27]
    ds_read_b64_tr_b16 a[194:195], v11 offset:26624
    v_mul_f32 v50, v18, v50
    v_mfma_f32_16x16x32_bf16 v[24:27], a[204:207], v[132:135], v[24:27]
    ds_read_b64_tr_b16 a[196:197], v11 offset:28672
    v_mul_f32 v51, v18, v51
    v_mfma_f32_16x16x32_bf16 v[28:31], a[204:207], v[140:143], v[28:31]
    s_waitcnt lgkmcnt(3)
    ds_read_b64_tr_b16 a[198:199], v11 offset:30720
    v_cvt_pk_bf16_f32 v48, v48, v49
    v_mfma_f32_16x16x32_bf16 v[28:31], a[200:203], v[136:139], v[28:31]
    v_cvt_pk_bf16_f32 v49, v50, v51
    v_accvgpr_write_b32 a56, v48
    v_mfma_f32_16x16x32_bf16 v[32:35], a[200:203], v[144:147], v[32:35]
    v_accvgpr_write_b32 a57, v49
    v_mul_f32 v53, v19, v53
    v_mfma_f32_16x16x32_bf16 v[32:35], a[204:207], v[148:151], v[32:35]
    v_mul_f32 v54, v19, v54
    v_mul_f32 v55, v19, v55
    v_mfma_f32_16x16x32_bf16 v[36:39], a[204:207], v[156:159], v[36:39]
    buffer_load_dwordx4 a[240:243], v14, s[20:23], s37 offen offset:2048 sc1
    v_mfma_f32_16x16x32_bf16 v[36:39], a[200:203], v[152:155], v[36:39]
    ds_read_b64_tr_b16 a[200:201], v11 offset:32768
    v_cvt_pk_bf16_f32 v52, v52, v53
    v_mfma_f32_16x16x32_bf16 v[36:39], a[208:211], v[184:187], v[36:39]
    ds_read_b64_tr_b16 a[202:203], v11 offset:34816
    v_cvt_pk_bf16_f32 v53, v54, v55
    v_mfma_f32_16x16x32_bf16 v[36:39], a[212:215], v[188:191], v[36:39]
    ds_read_b64_tr_b16 a[204:205], v11 offset:36864
    v_accvgpr_write_b32 a60, v52
    v_mfma_f32_16x16x32_bf16 v[32:35], a[212:215], v[180:183], v[32:35]
    s_waitcnt vmcnt(6)
    ds_read_b64_tr_b16 a[206:207], v11 offset:38912
    v_accvgpr_write_b32 a61, v53
    v_mfma_f32_16x16x32_bf16 v[32:35], a[208:211], v[176:179], v[32:35]
    buffer_store_dword v4, v15, s[24:27], s76 offen sc1
    v_mfma_f32_16x16x32_bf16 v[28:31], a[208:211], v[168:171], v[28:31]
    v_mov_b32 v4, s56
    v_mfma_f32_16x16x32_bf16 v[28:31], a[212:215], v[172:175], v[28:31]
    v_cmp_gt_u32 vcc, 16, v1
    v_mfma_f32_16x16x32_bf16 v[24:27], a[212:215], v[164:167], v[24:27]
    v_mfma_f32_16x16x32_bf16 v[24:27], a[208:211], v[160:163], v[24:27]
    buffer_load_dwordx4 a[244:247], v14, s[20:23], s37 offen offset:3072 sc1
    v_mfma_f32_16x16x32_bf16 v[24:27], a[184:187], v[192:195], v[24:27]
    ds_read_b64_tr_b16 a[208:209], v11 offset:40960
    v_mfma_f32_16x16x32_bf16 v[24:27], a[188:191], v[196:199], v[24:27]
    ds_read_b64_tr_b16 a[210:211], v11 offset:43008
    v_mfma_f32_16x16x32_bf16 v[28:31], a[188:191], v[204:207], v[28:31]
    s_add_u32 s37, s61, 0
    ds_read_b64_tr_b16 a[212:213], v11 offset:45056
    v_mfma_f32_16x16x32_bf16 v[28:31], a[184:187], v[200:203], v[28:31]
    s_waitcnt lgkmcnt(3)
    ds_read_b64_tr_b16 a[214:215], v11 offset:47104
    v_add_u32 v11, 73728, v11
    v_mfma_f32_16x16x32_bf16 v[32:35], a[184:187], v[208:211], v[32:35]
    s_add_u32 s38, s44, 81920
    s_add_u32 s36, s44, 122880
    v_mfma_f32_16x16x32_bf16 v[32:35], a[188:191], v[212:215], v[32:35]
    s_cmp_lt_u32 s3, 2
    s_cselect_b32 s38, s38, s36
    s_add_u32 m0, s63, 16384
    v_mfma_f32_16x16x32_bf16 v[36:39], a[188:191], v[220:223], v[36:39]
    v_mfma_f32_16x16x32_bf16 v[36:39], a[184:187], v[216:219], v[36:39]
    v_mfma_f32_16x16x32_bf16 v[36:39], a[192:195], v[248:251], v[36:39]
    buffer_load_dwordx4 a[152:155], v14, s[20:23], s37 offen offset:0 sc1
    v_mfma_f32_16x16x32_bf16 v[36:39], a[196:199], v[252:255], v[36:39]
    s_waitcnt lgkmcnt(0)
    v_mfma_f32_16x16x32_bf16 v[32:35], a[196:199], v[244:247], v[32:35]
    s_barrier
    v_mfma_f32_16x16x32_bf16 v[32:35], a[192:195], v[240:243], v[32:35]
    buffer_load_dwordx4 v7, s[8:11], s38 offen lds
    v_mfma_f32_16x16x32_bf16 v[28:31], a[192:195], v[232:235], v[28:31]
    ds_read_b64_tr_b16 a[184:185], v8 offset:0
    v_mfma_f32_16x16x32_bf16 v[28:31], a[196:199], v[236:239], v[28:31]
    ds_read_b64_tr_b16 a[186:187], v8 offset:2048
    v_mfma_f32_16x16x32_bf16 v[24:27], a[196:199], v[228:231], v[24:27]
    ds_read_b64_tr_b16 a[188:189], v8 offset:4096
    v_mfma_f32_16x16x32_bf16 v[24:27], a[192:195], v[224:227], v[24:27]
    s_add_u32 s38, s44, 81920
    ds_read_b64_tr_b16 a[190:191], v8 offset:6144
    v_mfma_f32_16x16x32_bf16 v[24:27], a[200:203], v[56:59], v[24:27]
    ds_read_b64_tr_b16 a[192:193], v8 offset:8192
    v_mfma_f32_16x16x32_bf16 v[24:27], a[204:207], v[60:63], v[24:27]
    buffer_load_dwordx4 a[156:159], v14, s[20:23], s37 offen offset:1024 sc1
    v_mfma_f32_16x16x32_bf16 v[28:31], a[204:207], v[68:71], v[28:31]
    s_addk_i32 m0, -16384
    ds_read_b64_tr_b16 a[194:195], v8 offset:10240
    v_mfma_f32_16x16x32_bf16 v[28:31], a[200:203], v[64:67], v[28:31]
    ds_read_b64_tr_b16 a[196:197], v8 offset:12288
    v_mfma_f32_16x16x32_bf16 v[32:35], a[200:203], v[72:75], v[32:35]
    ds_read_b64_tr_b16 a[198:199], v8 offset:14336
    v_mfma_f32_16x16x32_bf16 v[32:35], a[204:207], v[76:79], v[32:35]
    v_mfma_f32_16x16x32_bf16 v[36:39], a[204:207], v[84:87], v[36:39]
    v_mfma_f32_16x16x32_bf16 v[36:39], a[200:203], v[80:83], v[36:39]
    buffer_load_dwordx4 v2, s[8:11], s38 offen lds
    v_mfma_f32_16x16x32_bf16 v[36:39], a[208:211], v[112:115], v[36:39]
    ds_read_b64_tr_b16 a[200:201], v8 offset:16384
    v_mfma_f32_16x16x32_bf16 v[36:39], a[212:215], v[116:119], v[36:39]
    ds_read_b64_tr_b16 a[202:203], v8 offset:18432
    v_mfma_f32_16x16x32_bf16 v[32:35], a[212:215], v[108:111], v[32:35]
    buffer_load_dwordx4 a[160:163], v14, s[20:23], s37 offen offset:2048 sc1
    v_mfma_f32_16x16x32_bf16 v[32:35], a[208:211], v[104:107], v[32:35]
    s_load_dwordx4 s[72:75], s[86:87], s5 glc
    ds_read_b64_tr_b16 a[204:205], v8 offset:20480
    s_add_u32 s38, s44, 81920
    v_mfma_f32_16x16x32_bf16 v[28:31], a[208:211], v[96:99], v[28:31]
    s_waitcnt lgkmcnt(5)
    ds_read_b64_tr_b16 a[206:207], v8 offset:22528
    v_mfma_f32_16x16x32_bf16 v[28:31], a[212:215], v[100:103], v[28:31]
    s_add_u32 m0, s63, 4096
    v_mul_f32 v32, v18, v32
    v_mul_f32 v33, v18, v33
    v_mfma_f32_16x16x32_bf16 v[24:27], a[212:215], v[92:95], v[24:27]
    v_mul_f32 v34, v18, v34
    v_mfma_f32_16x16x32_bf16 v[24:27], a[208:211], v[88:91], v[24:27]
    ds_read_b64_tr_b16 a[208:209], v8 offset:24576
    v_mfma_f32_16x16x32_bf16 v[40:43], a[184:187], a[96:99], 0
    ds_read_b64_tr_b16 a[210:211], v8 offset:26624
    v_mul_f32 v28, v17, v28
    v_mfma_f32_16x16x32_bf16 v[40:43], a[188:191], a[100:103], v[40:43]
    ds_read_b64_tr_b16 a[212:213], v8 offset:28672
    v_mul_f32 v29, v17, v29
    v_mfma_f32_16x16x32_bf16 v[44:47], a[188:191], a[108:111], 0
    ds_read_b64_tr_b16 a[214:215], v8 offset:30720
    v_mul_f32 v24, v16, v24
    v_mfma_f32_16x16x32_bf16 v[44:47], a[184:187], a[104:107], v[44:47]
    buffer_load_dwordx4 a[164:167], v14, s[20:23], s37 offen offset:3072 sc1
    v_mfma_f32_16x16x32_bf16 v[48:51], a[184:187], a[112:115], 0
    buffer_load_dwordx4 v3, s[8:11], s38 offen lds
    v_mfma_f32_16x16x32_bf16 v[48:51], a[188:191], a[116:119], v[48:51]
    v_mul_f32 v25, v16, v25
    v_mul_f32 v26, v16, v26
    v_mfma_f32_16x16x32_bf16 v[52:55], a[188:191], a[124:127], 0
    s_waitcnt lgkmcnt(5)
    v_mul_f32 v27, v16, v27
    v_cvt_pk_bf16_f32 v24, v24, v25
    v_mfma_f32_16x16x32_bf16 v[52:55], a[184:187], a[120:123], v[52:55]
    s_add_u32 s38, s44, 122880
    ds_read_b64_tr_b16 a[184:185], v8 offset:32768
    v_cvt_pk_bf16_f32 v25, v26, v27
    v_mfma_f32_16x16x32_bf16 v[52:55], a[192:195], v[120:123], v[52:55]
    ds_read_b64_tr_b16 a[186:187], v8 offset:34816
    v_accvgpr_write_b32 a50, v24
    v_mfma_f32_16x16x32_bf16 v[52:55], a[196:199], v[124:127], v[52:55]
    s_addk_i32 m0, 4096
    ds_read_b64_tr_b16 a[188:189], v8 offset:36864
    v_accvgpr_write_b32 a51, v25
    v_mfma_f32_16x16x32_bf16 v[48:51], a[196:199], a[148:151], v[48:51]
    buffer_store_dwordx4 a[48:51], v14, s[20:23], s55 offen offset:0 sc1
    v_mul_f32 v30, v17, v30
    v_mfma_f32_16x16x32_bf16 v[48:51], a[192:195], a[144:147], v[48:51]
    ds_read_b64_tr_b16 a[190:191], v8 offset:38912
    v_mul_f32 v31, v17, v31
    v_mfma_f32_16x16x32_bf16 v[44:47], a[192:195], a[136:139], v[44:47]
    v_cvt_pk_bf16_f32 v28, v28, v29
    v_cvt_pk_bf16_f32 v29, v30, v31
    v_mfma_f32_16x16x32_bf16 v[44:47], a[196:199], a[140:143], v[44:47]
    v_accvgpr_write_b32 a54, v28
    v_accvgpr_write_b32 a55, v29
    v_mfma_f32_16x16x32_bf16 v[40:43], a[196:199], a[132:135], v[40:43]
    buffer_store_dwordx4 a[52:55], v14, s[20:23], s55 offen offset:1024 sc1
    v_mul_f32 v35, v18, v35
    v_mfma_f32_16x16x32_bf16 v[40:43], a[192:195], a[128:131], v[40:43]
    buffer_load_dwordx4 v2, s[8:11], s38 offen lds
    v_mfma_f32_16x16x32_bf16 v[40:43], a[200:203], v[128:131], v[40:43]
    s_waitcnt lgkmcnt(3)
    ds_read_b64_tr_b16 a[192:193], v8 offset:40960
    v_cvt_pk_bf16_f32 v32, v32, v33
    v_mfma_f32_16x16x32_bf16 v[40:43], a[204:207], v[132:135], v[40:43]
    ds_read_b64_tr_b16 a[194:195], v8 offset:43008
    v_cvt_pk_bf16_f32 v33, v34, v35
    v_mfma_f32_16x16x32_bf16 v[44:47], a[204:207], v[140:143], v[44:47]
    ds_read_b64_tr_b16 a[196:197], v8 offset:45056
    v_accvgpr_write_b32 a58, v32
    v_mfma_f32_16x16x32_bf16 v[44:47], a[200:203], v[136:139], v[44:47]
    s_add_u32 s38, s44, 122880
    ds_read_b64_tr_b16 a[198:199], v8 offset:47104
    v_accvgpr_write_b32 a59, v33
    v_mfma_f32_16x16x32_bf16 v[48:51], a[200:203], v[144:147], v[48:51]
    buffer_store_dwordx4 a[56:59], v14, s[20:23], s55 offen offset:2048 sc1
    v_mul_f32 v36, v19, v36
    v_mfma_f32_16x16x32_bf16 v[48:51], a[204:207], v[148:151], v[48:51]
    s_addk_i32 m0, 4096
    v_mul_f32 v37, v19, v37
    v_mul_f32 v38, v19, v38
    v_mfma_f32_16x16x32_bf16 v[52:55], a[204:207], v[156:159], v[52:55]
    v_mul_f32 v39, v19, v39
    v_cvt_pk_bf16_f32 v36, v36, v37
    v_mfma_f32_16x16x32_bf16 v[52:55], a[200:203], v[152:155], v[52:55]
    ds_read_b64_tr_b16 a[200:201], v8 offset:49152
    v_cvt_pk_bf16_f32 v37, v38, v39
    v_mfma_f32_16x16x32_bf16 v[52:55], a[208:211], v[184:187], v[52:55]
    ds_read_b64_tr_b16 a[202:203], v8 offset:51200
    v_accvgpr_write_b32 a62, v36
    v_mfma_f32_16x16x32_bf16 v[52:55], a[212:215], v[188:191], v[52:55]
    ds_read_b64_tr_b16 a[204:205], v8 offset:53248
    v_accvgpr_write_b32 a63, v37
    v_mfma_f32_16x16x32_bf16 v[48:51], a[212:215], v[180:183], v[48:51]
    buffer_store_dwordx4 a[60:63], v14, s[20:23], s55 offen offset:3072 sc1
    v_mfma_f32_16x16x32_bf16 v[48:51], a[208:211], v[176:179], v[48:51]
    buffer_load_dwordx4 v3, s[8:11], s38 offen lds
    v_mfma_f32_16x16x32_bf16 v[44:47], a[208:211], v[168:171], v[44:47]
    s_add_u32 s55, s55, 4096
    ds_read_b64_tr_b16 a[206:207], v8 offset:55296
    v_mfma_f32_16x16x32_bf16 v[44:47], a[212:215], v[172:175], v[44:47]
    s_waitcnt lgkmcnt(6)
    v_mfma_f32_16x16x32_bf16 v[40:43], a[212:215], v[164:167], v[40:43]
    s_add_u32 s77, s7, 2
    v_mfma_f32_16x16x32_bf16 v[40:43], a[208:211], v[160:163], v[40:43]
    s_add_u32 s38, s44, 163840
    ds_read_b64_tr_b16 a[208:209], v8 offset:57344
    s_add_u32 s36, s45, 0
    v_mfma_f32_16x16x32_bf16 v[40:43], a[184:187], v[192:195], v[40:43]
    s_cmp_lt_u32 s3, 2
    s_cselect_b32 s38, s38, s36
    v_mfma_f32_16x16x32_bf16 v[40:43], a[188:191], v[196:199], v[40:43]
    s_addk_i32 m0, 24576
    ds_read_b64_tr_b16 a[210:211], v8 offset:59392
    v_mfma_f32_16x16x32_bf16 v[44:47], a[188:191], v[204:207], v[44:47]
    ds_read_b64_tr_b16 a[212:213], v8 offset:61440
    v_mfma_f32_16x16x32_bf16 v[44:47], a[184:187], v[200:203], v[44:47]
    ds_read_b64_tr_b16 a[214:215], v8 offset:63488
    v_add_u32 v8, 65536, v8
    v_mfma_f32_16x16x32_bf16 v[48:51], a[184:187], v[208:211], v[48:51]
    v_mfma_f32_16x16x32_bf16 v[48:51], a[188:191], v[212:215], v[48:51]
    v_mfma_f32_16x16x32_bf16 v[52:55], a[188:191], v[220:223], v[52:55]
    s_waitcnt lgkmcnt(5)
    v_mfma_f32_16x16x32_bf16 v[52:55], a[184:187], v[216:219], v[52:55]
    buffer_load_dwordx4 v7, s[8:11], s38 offen lds
    v_mfma_f32_16x16x32_bf16 v[52:55], a[192:195], v[248:251], v[52:55]
    ds_read_b64_tr_b16 a[184:185], v9 offset:0
    v_mfma_f32_16x16x32_bf16 v[52:55], a[196:199], v[252:255], v[52:55]
    ds_read_b64_tr_b16 a[186:187], v9 offset:2048
    v_mfma_f32_16x16x32_bf16 v[48:51], a[196:199], v[244:247], v[48:51]
    ds_read_b64_tr_b16 a[188:189], v9 offset:4096
    v_mfma_f32_16x16x32_bf16 v[48:51], a[192:195], v[240:243], v[48:51]
    s_add_u32 s38, s44, 163840
    ds_read_b64_tr_b16 a[190:191], v9 offset:6144
    v_mfma_f32_16x16x32_bf16 v[44:47], a[192:195], v[232:235], v[44:47]
    v_mfma_f32_16x16x32_bf16 v[44:47], a[196:199], v[236:239], v[44:47]
    s_addk_i32 m0, -16384
    v_mfma_f32_16x16x32_bf16 v[40:43], a[196:199], v[228:231], v[40:43]
    s_waitcnt lgkmcnt(4)
    s_sub_u32 s78, s72, s77
    s_sub_u32 s79, s73, s77
    v_mfma_f32_16x16x32_bf16 v[40:43], a[192:195], v[224:227], v[40:43]
    s_max_u32 s78, s78, s79
    ds_read_b64_tr_b16 a[192:193], v9 offset:8192
    s_sub_u32 s79, s74, s77
    v_mfma_f32_16x16x32_bf16 v[40:43], a[200:203], v[56:59], v[40:43]
    s_max_u32 s78, s78, s79
    ds_read_b64_tr_b16 a[194:195], v9 offset:10240
    s_sub_u32 s79, s75, s77
    v_mfma_f32_16x16x32_bf16 v[40:43], a[204:207], v[60:63], v[40:43]
    s_max_u32 s78, s78, s79
    ds_read_b64_tr_b16 a[196:197], v9 offset:12288
    v_mfma_f32_16x16x32_bf16 v[44:47], a[204:207], v[68:71], v[44:47]
    s_cmp_gt_u32 s78, 4
    s_cbranch_scc1 spin_o1
spin_o1_ret:
    s_add_u32 s37, s59, 4096
    v_mfma_f32_16x16x32_bf16 v[44:47], a[200:203], v[64:67], v[44:47]
    buffer_load_dwordx4 v2, s[8:11], s38 offen lds
    v_mfma_f32_16x16x32_bf16 v[48:51], a[200:203], v[72:75], v[48:51]
    ds_read_b64_tr_b16 a[198:199], v9 offset:14336
    v_mfma_f32_16x16x32_bf16 v[48:51], a[204:207], v[76:79], v[48:51]
    v_mfma_f32_16x16x32_bf16 v[52:55], a[204:207], v[84:87], v[52:55]
    v_mfma_f32_16x16x32_bf16 v[52:55], a[200:203], v[80:83], v[52:55]
    s_add_u32 s38, s44, 163840
    ds_read_b64_tr_b16 a[200:201], v9 offset:16384
    v_mfma_f32_16x16x32_bf16 v[52:55], a[208:211], v[112:115], v[52:55]
    buffer_load_dwordx4 a[168:171], v14, s[20:23], s37 offen offset:0 sc1
    v_mfma_f32_16x16x32_bf16 v[52:55], a[212:215], v[116:119], v[52:55]
    s_addk_i32 m0, 4096
    ds_read_b64_tr_b16 a[202:203], v9 offset:18432
    v_mfma_f32_16x16x32_bf16 v[48:51], a[212:215], v[108:111], v[48:51]
    ds_read_b64_tr_b16 a[204:205], v9 offset:20480
    v_mfma_f32_16x16x32_bf16 v[48:51], a[208:211], v[104:107], v[48:51]
    s_waitcnt lgkmcnt(3)
    ds_read_b64_tr_b16 a[206:207], v9 offset:22528
    v_mfma_f32_16x16x32_bf16 v[44:47], a[208:211], v[96:99], v[44:47]
    v_mul_f32 v52, v19, v52
    v_mfma_f32_16x16x32_bf16 v[44:47], a[212:215], v[100:103], v[44:47]
    v_mul_f32 v53, v19, v53
    v_mfma_f32_16x16x32_bf16 v[40:43], a[212:215], v[92:95], v[40:43]
    v_mul_f32 v54, v19, v54
    v_mfma_f32_16x16x32_bf16 v[40:43], a[208:211], v[88:91], v[40:43]
    buffer_load_dwordx4 v3, s[8:11], s38 offen lds
    v_mfma_f32_16x16x32_bf16 v[24:27], a[184:187], a[96:99], 0
    ds_read_b64_tr_b16 a[208:209], v9 offset:24576
    v_mfma_f32_16x16x32_bf16 v[24:27], a[188:191], a[100:103], v[24:27]
    buffer_load_dwordx4 a[172:175], v14, s[20:23], s37 offen offset:1024 sc1
    v_mfma_f32_16x16x32_bf16 v[28:31], a[188:191], a[108:111], 0
    ds_read_b64_tr_b16 a[210:211], v9 offset:26624
    v_mul_f32 v44, v17, v44
    v_mfma_f32_16x16x32_bf16 v[28:31], a[184:187], a[104:107], v[28:31]
    s_add_u32 s38, s45, 0
    ds_read_b64_tr_b16 a[212:213], v9 offset:28672
    v_mul_f32 v40, v16, v40
    v_mfma_f32_16x16x32_bf16 v[32:35], a[184:187], a[112:115], 0
    ds_read_b64_tr_b16 a[214:215], v9 offset:30720
    v_mul_f32 v41, v16, v41
    v_mfma_f32_16x16x32_bf16 v[32:35], a[188:191], a[116:119], v[32:35]
    s_addk_i32 m0, 4096
    v_mul_f32 v42, v16, v42
    v_mul_f32 v43, v16, v43
    v_mfma_f32_16x16x32_bf16 v[36:39], a[188:191], a[124:127], 0
    v_cvt_pk_bf16_f32 v40, v40, v41
    v_cvt_pk_bf16_f32 v41, v42, v43
    v_mfma_f32_16x16x32_bf16 v[36:39], a[184:187], a[120:123], v[36:39]
    ds_read_b64_tr_b16 a[184:185], v9 offset:32768
    v_accvgpr_write_b32 a64, v40
    v_mfma_f32_16x16x32_bf16 v[36:39], a[192:195], v[120:123], v[36:39]
    ds_read_b64_tr_b16 a[186:187], v9 offset:34816
    v_accvgpr_write_b32 a65, v41
    v_mfma_f32_16x16x32_bf16 v[36:39], a[196:199], v[124:127], v[36:39]
    ds_read_b64_tr_b16 a[188:189], v9 offset:36864
    v_mul_f32 v45, v17, v45
    v_mfma_f32_16x16x32_bf16 v[32:35], a[196:199], a[148:151], v[32:35]
    s_waitcnt lgkmcnt(4)
    ds_read_b64_tr_b16 a[190:191], v9 offset:38912
    v_mul_f32 v46, v17, v46
    v_mfma_f32_16x16x32_bf16 v[32:35], a[192:195], a[144:147], v[32:35]
    buffer_load_dwordx4 a[176:179], v14, s[20:23], s37 offen offset:2048 sc1
    v_mfma_f32_16x16x32_bf16 v[28:31], a[192:195], a[136:139], v[28:31]
    buffer_load_dwordx4 v2, s[8:11], s38 offen lds
    v_mfma_f32_16x16x32_bf16 v[28:31], a[196:199], a[140:143], v[28:31]
    s_mov_b32 s12, s64
    v_mul_f32 v47, v17, v47
    v_cvt_pk_bf16_f32 v44, v44, v45
    v_mfma_f32_16x16x32_bf16 v[24:27], a[196:199], a[132:135], v[24:27]
    s_and_b32 s13, s65, 0xffff
    v_cvt_pk_bf16_f32 v45, v46, v47
    v_accvgpr_write_b32 a68, v44
    v_mfma_f32_16x16x32_bf16 v[24:27], a[192:195], a[128:131], v[24:27]
    s_add_u32 s38, s45, 0
    ds_read_b64_tr_b16 a[192:193], v9 offset:40960
    v_accvgpr_write_b32 a69, v45
    v_mfma_f32_16x16x32_bf16 v[24:27], a[200:203], v[128:131], v[24:27]
    s_mov_b32 s14, 2621440
    ds_read_b64_tr_b16 a[194:195], v9 offset:43008
    v_mul_f32 v48, v18, v48
    v_mfma_f32_16x16x32_bf16 v[24:27], a[204:207], v[132:135], v[24:27]
    s_addk_i32 m0, 4096
    ds_read_b64_tr_b16 a[196:197], v9 offset:45056
    v_mul_f32 v49, v18, v49
    v_mfma_f32_16x16x32_bf16 v[28:31], a[204:207], v[140:143], v[28:31]
    s_mov_b32 s15, 0x00020000
    ds_read_b64_tr_b16 a[198:199], v9 offset:47104
    v_mul_f32 v50, v18, v50
    v_mfma_f32_16x16x32_bf16 v[28:31], a[200:203], v[136:139], v[28:31]
    buffer_load_dwordx4 a[180:183], v14, s[20:23], s37 offen offset:3072 sc1
    v_mfma_f32_16x16x32_bf16 v[32:35], a[200:203], v[144:147], v[32:35]
    s_lshl_b32 s56, s54, 1
    v_mul_f32 v51, v18, v51
    v_cvt_pk_bf16_f32 v48, v48, v49
    v_mfma_f32_16x16x32_bf16 v[32:35], a[204:207], v[148:151], v[32:35]
    s_and_b32 s57, s53, 1
    v_cvt_pk_bf16_f32 v49, v50, v51
    v_accvgpr_write_b32 a72, v48
    v_mfma_f32_16x16x32_bf16 v[36:39], a[204:207], v[156:159], v[36:39]
    s_waitcnt lgkmcnt(3)
    v_accvgpr_write_b32 a73, v49
    v_mul_f32 v55, v19, v55
    v_mfma_f32_16x16x32_bf16 v[36:39], a[200:203], v[152:155], v[36:39]
    buffer_load_dwordx4 v3, s[8:11], s38 offen lds
    v_mfma_f32_16x16x32_bf16 v[36:39], a[208:211], v[184:187], v[36:39]
    s_waitcnt vmcnt(10)
    ds_read_b64_tr_b16 a[200:201], v9 offset:49152
    v_cvt_pk_bf16_f32 v52, v52, v53
    v_mfma_f32_16x16x32_bf16 v[36:39], a[212:215], v[188:191], v[36:39]
    buffer_store_dword v4, v15, s[24:27], s76 offen sc1
    v_mfma_f32_16x16x32_bf16 v[32:35], a[212:215], v[180:183], v[32:35]
    s_add_u32 s56, s56, s57
    ds_read_b64_tr_b16 a[202:203], v9 offset:51200
    v_cvt_pk_bf16_f32 v53, v54, v55
    v_mfma_f32_16x16x32_bf16 v[32:35], a[208:211], v[176:179], v[32:35]
    s_add_u32 s38, s46, 0
    ds_read_b64_tr_b16 a[204:205], v9 offset:53248
    v_accvgpr_write_b32 a76, v52
    v_mfma_f32_16x16x32_bf16 v[28:31], a[208:211], v[168:171], v[28:31]
    s_add_u32 s36, s47, 0
    ds_read_b64_tr_b16 a[206:207], v9 offset:55296
    v_accvgpr_write_b32 a77, v53
    v_mfma_f32_16x16x32_bf16 v[28:31], a[212:215], v[172:175], v[28:31]
    s_cmp_lt_u32 s3, 2
    s_cselect_b32 s38, s38, s36
    s_addk_i32 m0, 24576
    v_mfma_f32_16x16x32_bf16 v[24:27], a[212:215], v[164:167], v[24:27]
    s_lshl_b32 s6, s56, 5
    s_andn2_b32 s56, 2, s53
    s_lshl3_add_u32 s6, s56, s6
    v_mfma_f32_16x16x32_bf16 v[24:27], a[208:211], v[160:163], v[24:27]
    s_mul_i32 s56, s51, 320
    ds_read_b64_tr_b16 a[208:209], v9 offset:57344
    s_and_b32 s57, s51, 1
    v_mfma_f32_16x16x32_bf16 v[24:27], a[184:187], v[192:195], v[24:27]
    s_add_u32 s64, s57, s50
    ds_read_b64_tr_b16 a[210:211], v9 offset:59392
    s_lshl_b32 s64, s64, 6
    v_mfma_f32_16x16x32_bf16 v[24:27], a[188:191], v[196:199], v[24:27]
    s_add_u32 s64, s64, s56
    ds_read_b64_tr_b16 a[212:213], v9 offset:61440
    s_xor_b32 s57, s57, 1
    v_mfma_f32_16x16x32_bf16 v[28:31], a[188:191], v[204:207], v[28:31]
    s_lshl_b32 s57, s57, 8
    ds_read_b64_tr_b16 a[214:215], v9 offset:63488
    v_add_u32 v9, 65536, v9
    v_mfma_f32_16x16x32_bf16 v[28:31], a[184:187], v[200:203], v[28:31]
    s_waitcnt lgkmcnt(4)
    s_add_u32 s68, s56, s57
    v_mfma_f32_16x16x32_bf16 v[32:35], a[184:187], v[208:211], v[32:35]
    buffer_load_dwordx4 v7, s[8:11], s38 offen lds
    v_mfma_f32_16x16x32_bf16 v[32:35], a[188:191], v[212:215], v[32:35]
    s_add_u32 s56, s7, 5
    v_mov_b32 v4, s56
    v_mfma_f32_16x16x32_bf16 v[36:39], a[188:191], v[220:223], v[36:39]
    v_mfma_f32_16x16x32_bf16 v[36:39], a[184:187], v[216:219], v[36:39]
    s_add_u32 s38, s46, 0
    ds_read_b64_tr_b16 a[184:185], v10 offset:0
    v_mfma_f32_16x16x32_bf16 v[36:39], a[192:195], v[248:251], v[36:39]
    ds_read_b64_tr_b16 a[186:187], v10 offset:2048
    v_mfma_f32_16x16x32_bf16 v[36:39], a[196:199], v[252:255], v[36:39]
    s_addk_i32 m0, -16384
    ds_read_b64_tr_b16 a[188:189], v10 offset:4096
    v_mfma_f32_16x16x32_bf16 v[32:35], a[196:199], v[244:247], v[32:35]
    ds_read_b64_tr_b16 a[190:191], v10 offset:6144
    v_mfma_f32_16x16x32_bf16 v[32:35], a[192:195], v[240:243], v[32:35]
    v_mfma_f32_16x16x32_bf16 v[28:31], a[192:195], v[232:235], v[28:31]
    v_mfma_f32_16x16x32_bf16 v[28:31], a[196:199], v[236:239], v[28:31]
    v_mfma_f32_16x16x32_bf16 v[24:27], a[196:199], v[228:231], v[24:27]
    v_mfma_f32_16x16x32_bf16 v[24:27], a[192:195], v[224:227], v[24:27]
    buffer_load_dwordx4 v2, s[8:11], s38 offen lds
    v_mfma_f32_16x16x32_bf16 v[24:27], a[200:203], v[56:59], v[24:27]
    ds_read_b64_tr_b16 a[192:193], v10 offset:8192
    v_mfma_f32_16x16x32_bf16 v[24:27], a[204:207], v[60:63], v[24:27]
    ds_read_b64_tr_b16 a[194:195], v10 offset:10240
    v_mfma_f32_16x16x32_bf16 v[28:31], a[204:207], v[68:71], v[28:31]
    ds_read_b64_tr_b16 a[196:197], v10 offset:12288
    v_mfma_f32_16x16x32_bf16 v[28:31], a[200:203], v[64:67], v[28:31]
    s_waitcnt lgkmcnt(3)
    ds_read_b64_tr_b16 a[198:199], v10 offset:14336
    s_add_u32 s38, s46, 0
    v_mfma_f32_16x16x32_bf16 v[32:35], a[200:203], v[72:75], v[32:35]
    v_mfma_f32_16x16x32_bf16 v[32:35], a[204:207], v[76:79], v[32:35]
    s_addk_i32 m0, 4096
    v_mfma_f32_16x16x32_bf16 v[36:39], a[204:207], v[84:87], v[36:39]
    v_mfma_f32_16x16x32_bf16 v[36:39], a[200:203], v[80:83], v[36:39]
    ds_read_b64_tr_b16 a[200:201], v10 offset:16384
    v_mfma_f32_16x16x32_bf16 v[36:39], a[208:211], v[112:115], v[36:39]
    ds_read_b64_tr_b16 a[202:203], v10 offset:18432
    v_mfma_f32_16x16x32_bf16 v[36:39], a[212:215], v[116:119], v[36:39]
    ds_read_b64_tr_b16 a[204:205], v10 offset:20480
    v_mfma_f32_16x16x32_bf16 v[32:35], a[212:215], v[108:111], v[32:35]
    ds_read_b64_tr_b16 a[206:207], v10 offset:22528
    v_mfma_f32_16x16x32_bf16 v[32:35], a[208:211], v[104:107], v[32:35]
    buffer_load_dwordx4 v3, s[8:11], s38 offen lds
    v_mfma_f32_16x16x32_bf16 v[28:31], a[208:211], v[96:99], v[28:31]
    v_mfma_f32_16x16x32_bf16 v[28:31], a[212:215], v[100:103], v[28:31]
    v_mfma_f32_16x16x32_bf16 v[24:27], a[212:215], v[92:95], v[24:27]
    v_mul_f32 v36, v19, v36
    v_mfma_f32_16x16x32_bf16 v[24:27], a[208:211], v[88:91], v[24:27]
    s_add_u32 s38, s47, 0
    ds_read_b64_tr_b16 a[208:209], v10 offset:24576
    v_mul_f32 v32, v18, v32
    v_mfma_f32_16x16x32_bf16 v[40:43], a[184:187], a[96:99], 0
    s_mul_i32 s57, s48, 10
    ds_read_b64_tr_b16 a[210:211], v10 offset:26624
    v_lshrrev_b32 v5, 5, v1
    v_mfma_f32_16x16x32_bf16 v[40:43], a[188:191], a[100:103], v[40:43]
pg_11:
    s_cbranch_execz pg_15
    s_addk_i32 m0, 4096
    ds_read_b64_tr_b16 a[212:213], v10 offset:28672
    v_lshlrev_b32 v5, 3, v5
    v_mfma_f32_16x16x32_bf16 v[44:47], a[188:191], a[108:111], 0
    s_waitcnt lgkmcnt(3)
    ds_read_b64_tr_b16 a[214:215], v10 offset:30720
    v_bfe_u32 v22, v1, 3, 2
    v_mfma_f32_16x16x32_bf16 v[44:47], a[184:187], a[104:107], v[44:47]
    s_sub_u32 s57, s58, s57
    v_add_u32 v22, v22, v5
    v_mul_u32_u24 v22, 1280, v22
    v_mfma_f32_16x16x32_bf16 v[48:51], a[184:187], a[112:115], 0
    s_mul_i32 s62, s48, 1280
    v_lshrrev_b32 v5, 4, v1
    v_lshlrev_b32 v5, 1, v5
    v_mfma_f32_16x16x32_bf16 v[48:51], a[188:191], a[116:119], v[48:51]
    s_lshl_b32 s56, s57, 6
    v_and_b32 v23, 7, v1
    v_xor_b32 v23, v23, v5
    v_mfma_f32_16x16x32_bf16 v[52:55], a[188:191], a[124:127], 0
    s_add_u32 s62, s62, s56
    v_lshlrev_b32 v23, 4, v23
    v_add_u32 v22, v22, v23
    v_mfma_f32_16x16x32_bf16 v[52:55], a[184:187], a[120:123], v[52:55]
    buffer_load_dwordx4 v2, s[8:11], s38 offen lds
    v_mfma_f32_16x16x32_bf16 v[52:55], a[192:195], v[120:123], v[52:55]
    s_lshl_b32 s56, s3, 4
    ds_read_b64_tr_b16 a[184:185], v10 offset:32768
    v_add_u32 v23, 20480, v22
    v_mfma_f32_16x16x32_bf16 v[52:55], a[196:199], v[124:127], v[52:55]
    s_add_u32 s62, s62, s56
    ds_read_b64_tr_b16 a[186:187], v10 offset:34816
    v_mul_f32 v24, v16, v24
    v_mfma_f32_16x16x32_bf16 v[48:51], a[196:199], a[148:151], v[48:51]
    s_lshl_b32 s62, s62, 2
    ds_read_b64_tr_b16 a[188:189], v10 offset:36864
    v_mul_f32 v25, v16, v25
    v_mfma_f32_16x16x32_bf16 v[48:51], a[192:195], a[144:147], v[48:51]
    s_add_u32 s38, s47, 0
    ds_read_b64_tr_b16 a[190:191], v10 offset:38912
    v_mul_f32 v26, v16, v26
    v_mfma_f32_16x16x32_bf16 v[44:47], a[192:195], a[136:139], v[44:47]
    s_add_u32 s62, s62, 3670016
    v_mul_f32 v27, v16, v27
    v_cvt_pk_bf16_f32 v24, v24, v25
    v_mfma_f32_16x16x32_bf16 v[44:47], a[196:199], a[140:143], v[44:47]
    s_addk_i32 m0, 4096
    v_cvt_pk_bf16_f32 v25, v26, v27
    v_accvgpr_write_b32 a66, v24
    v_mfma_f32_16x16x32_bf16 v[40:43], a[196:199], a[132:135], v[40:43]
    s_lshl_b32 s41, s48, 6
    v_accvgpr_write_b32 a67, v25
    v_mul_f32 v28, v17, v28
    v_mfma_f32_16x16x32_bf16 v[40:43], a[192:195], a[128:131], v[40:43]
    buffer_store_dwordx4 a[64:67], v14, s[20:23], s55 offen offset:0 sc1
    v_mul_f32 v29, v17, v29
    v_mfma_f32_16x16x32_bf16 v[40:43], a[200:203], v[128:131], v[40:43]
    s_lshr_b32 s56, s3, 1
    ds_read_b64_tr_b16 a[192:193], v10 offset:40960
    v_mul_f32 v30, v17, v30
    v_mfma_f32_16x16x32_bf16 v[40:43], a[204:207], v[132:135], v[40:43]
    s_lshl_b32 s56, s56, 5
    ds_read_b64_tr_b16 a[194:195], v10 offset:43008
    v_mul_f32 v31, v17, v31
    v_mfma_f32_16x16x32_bf16 v[44:47], a[204:207], v[140:143], v[44:47]
    s_add_u32 s41, s41, s56
    ds_read_b64_tr_b16 a[196:197], v10 offset:45056
    v_cvt_pk_bf16_f32 v28, v28, v29
    v_mfma_f32_16x16x32_bf16 v[44:47], a[200:203], v[136:139], v[44:47]
    s_waitcnt lgkmcnt(3)
    ds_read_b64_tr_b16 a[198:199], v10 offset:47104
    v_cvt_pk_bf16_f32 v29, v30, v31
    v_mfma_f32_16x16x32_bf16 v[48:51], a[200:203], v[144:147], v[48:51]
    buffer_load_dwordx4 v3, s[8:11], s38 offen lds
    v_mfma_f32_16x16x32_bf16 v[48:51], a[204:207], v[148:151], v[48:51]
    s_and_b32 s56, s3, 1
    v_accvgpr_write_b32 a70, v28
    v_accvgpr_write_b32 a71, v29
    v_mfma_f32_16x16x32_bf16 v[52:55], a[204:207], v[156:159], v[52:55]
    buffer_store_dwordx4 a[68:71], v14, s[20:23], s55 offen offset:1024 sc1
    v_mul_f32 v33, v18, v33
    v_mfma_f32_16x16x32_bf16 v[52:55], a[200:203], v[152:155], v[52:55]
    s_lshl_b32 s56, s56, 2
    ds_read_b64_tr_b16 a[200:201], v10 offset:49152
    v_mul_f32 v34, v18, v34
    v_mfma_f32_16x16x32_bf16 v[52:55], a[208:211], v[184:187], v[52:55]
    s_add_u32 s41, s41, s56
    ds_read_b64_tr_b16 a[202:203], v10 offset:51200
    v_mul_f32 v35, v18, v35
    v_mfma_f32_16x16x32_bf16 v[52:55], a[212:215], v[188:191], v[52:55]
    s_add_u32 s56, s3, 0
    ds_read_b64_tr_b16 a[204:205], v10 offset:53248
    v_cvt_pk_bf16_f32 v32, v32, v33
    v_mfma_f32_16x16x32_bf16 v[48:51], a[212:215], v[180:183], v[48:51]
    s_min_u32 s56, s56, 9
    ds_read_b64_tr_b16 a[206:207], v10 offset:55296
    v_cvt_pk_bf16_f32 v33, v34, v35
    v_mfma_f32_16x16x32_bf16 v[48:51], a[208:211], v[176:179], v[48:51]
    s_mul_i32 s38, s56, 24576
    v_accvgpr_write_b32 a74, v32
    v_accvgpr_write_b32 a75, v33
    v_mfma_f32_16x16x32_bf16 v[44:47], a[208:211], v[168:171], v[44:47]
    buffer_store_dwordx4 a[72:75], v14, s[20:23], s55 offen offset:2048 sc1
    v_mul_f32 v37, v19, v37
    v_mfma_f32_16x16x32_bf16 v[44:47], a[212:215], v[172:175], v[44:47]
    s_lshl_b32 s56, s56, 10
    v_mul_f32 v38, v19, v38
    v_mul_f32 v39, v19, v39
    v_mfma_f32_16x16x32_bf16 v[40:43], a[212:215], v[164:167], v[40:43]
    s_add_u32 m0, s56, 61440
    v_cvt_pk_bf16_f32 v36, v36, v37
    v_cvt_pk_bf16_f32 v37, v38, v39
    v_mfma_f32_16x16x32_bf16 v[40:43], a[208:211], v[160:163], v[40:43]
    s_mul_i32 s41, s41, 1280
    ds_read_b64_tr_b16 a[208:209], v10 offset:57344
    v_accvgpr_write_b32 a78, v36
    v_mfma_f32_16x16x32_bf16 v[40:43], a[184:187], v[192:195], v[40:43]
    s_lshl_b32 s57, s57, 7
    ds_read_b64_tr_b16 a[210:211], v10 offset:59392
    v_accvgpr_write_b32 a79, v37
    v_mfma_f32_16x16x32_bf16 v[40:43], a[188:191], v[196:199], v[40:43]
    buffer_store_dwordx4 a[76:79], v14, s[20:23], s55 offen offset:3072 sc1
    v_mfma_f32_16x16x32_bf16 v[44:47], a[188:191], v[204:207], v[44:47]
    s_add_u32 s56, s3, 4
    ds_read_b64_tr_b16 a[212:213], v10 offset:61440
    s_min_u32 s56, s56, 9
    v_mfma_f32_16x16x32_bf16 v[44:47], a[184:187], v[200:203], v[44:47]
    s_waitcnt lgkmcnt(3)
    ds_read_b64_tr_b16 a[214:215], v10 offset:63488
    v_add_u32 v10, 65536, v10
    v_mfma_f32_16x16x32_bf16 v[48:51], a[184:187], v[208:211], v[48:51]
    s_add_u32 s55, s55, 4096
    s_add_u32 s41, s41, s57
    s_lshl_b32 s57, s48, 10
    v_mfma_f32_16x16x32_bf16 v[48:51], a[188:191], v[212:215], v[48:51]
    s_add_u32 s38, s38, s57
    s_add_u32 s38, s38, 3276800
    s_lshl_b32 s57, s48, 10
    v_mfma_f32_16x16x32_bf16 v[52:55], a[188:191], v[220:223], v[52:55]
    buffer_load_dwordx4 v14, s[24:27], s38 offen sc1 lds
    v_mfma_f32_16x16x32_bf16 v[52:55], a[184:187], v[216:219], v[52:55]
    s_mul_i32 s38, s56, 24576
    ds_read_b64_tr_b16 a[184:185], v11 offset:0
    s_add_u32 s38, s38, s57
    v_mfma_f32_16x16x32_bf16 v[52:55], a[192:195], v[248:251], v[52:55]
    s_add_u32 s38, s38, 3276800
    ds_read_b64_tr_b16 a[186:187], v11 offset:2048
    s_lshl_b32 s56, s56, 10
    v_mfma_f32_16x16x32_bf16 v[52:55], a[196:199], v[252:255], v[52:55]
    s_add_u32 m0, s56, 61440
    ds_read_b64_tr_b16 a[188:189], v11 offset:4096
    s_lshl_b32 s43, s3, 11
    v_mfma_f32_16x16x32_bf16 v[48:51], a[196:199], v[244:247], v[48:51]
    buffer_load_dwordx4 v14, s[24:27], s38 offen sc1 lds
    v_mfma_f32_16x16x32_bf16 v[48:51], a[192:195], v[240:243], v[48:51]
    s_add_u32 s56, s3, 8
    ds_read_b64_tr_b16 a[190:191], v11 offset:6144
    s_min_u32 s56, s56, 9
    v_mfma_f32_16x16x32_bf16 v[44:47], a[192:195], v[232:235], v[44:47]
    s_mul_i32 s38, s56, 24576
    s_lshl_b32 s57, s48, 10
    s_add_u32 s38, s38, s57
    v_mfma_f32_16x16x32_bf16 v[44:47], a[196:199], v[236:239], v[44:47]
    s_add_u32 s38, s38, 3276800
    s_lshl_b32 s56, s56, 10
    s_add_u32 m0, s56, 61440
    v_mfma_f32_16x16x32_bf16 v[40:43], a[196:199], v[228:231], v[40:43]
    s_add_u32 s56, s7, 6
    v_lshrrev_b32 v12, 2, v1
    v_mfma_f32_16x16x32_bf16 v[40:43], a[192:195], v[224:227], v[40:43]
    ds_read_b64_tr_b16 a[192:193], v11 offset:8192
    v_mfma_f32_16x16x32_bf16 v[40:43], a[200:203], v[56:59], v[40:43]
    s_load_dwordx4 s[72:75], s[86:87], s5 glc
    ds_read_b64_tr_b16 a[194:195], v11 offset:10240
    v_mfma_f32_16x16x32_bf16 v[40:43], a[204:207], v[60:63], v[40:43]
    ds_read_b64_tr_b16 a[196:197], v11 offset:12288
    v_mfma_f32_16x16x32_bf16 v[44:47], a[204:207], v[68:71], v[44:47]
    s_waitcnt lgkmcnt(5)
    ds_read_b64_tr_b16 a[198:199], v11 offset:14336
    v_mfma_f32_16x16x32_bf16 v[44:47], a[200:203], v[64:67], v[44:47]
    buffer_load_dwordx4 v14, s[24:27], s38 offen sc1 lds
    v_mfma_f32_16x16x32_bf16 v[48:51], a[200:203], v[72:75], v[48:51]
    v_lshlrev_b32 v12, 6, v12
    v_mfma_f32_16x16x32_bf16 v[48:51], a[204:207], v[76:79], v[48:51]
    v_and_b32 v21, 3, v1
    v_mfma_f32_16x16x32_bf16 v[52:55], a[204:207], v[84:87], v[52:55]
    v_lshl_add_u32 v12, v21, 3, v12
    v_mfma_f32_16x16x32_bf16 v[52:55], a[200:203], v[80:83], v[52:55]
    ds_read_b64_tr_b16 a[200:201], v11 offset:16384
    v_mfma_f32_16x16x32_bf16 v[52:55], a[208:211], v[112:115], v[52:55]
    ds_read_b64_tr_b16 a[202:203], v11 offset:18432
    v_mfma_f32_16x16x32_bf16 v[52:55], a[212:215], v[116:119], v[52:55]
    ds_read_b64_tr_b16 a[204:205], v11 offset:20480
    v_mfma_f32_16x16x32_bf16 v[48:51], a[212:215], v[108:111], v[48:51]
    ds_read_b64_tr_b16 a[206:207], v11 offset:22528
    v_mfma_f32_16x16x32_bf16 v[48:51], a[208:211], v[104:107], v[48:51]
    v_and_b32 v21, 16, v1
    v_mfma_f32_16x16x32_bf16 v[44:47], a[208:211], v[96:99], v[44:47]
    v_lshl_add_u32 v12, v21, 1, v12
    v_mfma_f32_16x16x32_bf16 v[44:47], a[212:215], v[100:103], v[44:47]
    v_mul_f32 v52, v19, v52
    v_mfma_f32_16x16x32_bf16 v[40:43], a[212:215], v[92:95], v[40:43]
    s_waitcnt lgkmcnt(5)
    v_mul_f32 v53, v19, v53
    v_mul_f32 v48, v18, v48
    v_mfma_f32_16x16x32_bf16 v[40:43], a[208:211], v[88:91], v[40:43]
    s_add_u32 s37, s60, 4096
    ds_read_b64_tr_b16 a[208:209], v11 offset:24576
    v_mul_f32 v44, v17, v44
    v_mfma_f32_16x16x32_bf16 v[24:27], a[184:187], a[96:99], 0
    ds_read_b64_tr_b16 a[210:211], v11 offset:26624
    v_mul_f32 v45, v17, v45
    v_mfma_f32_16x16x32_bf16 v[24:27], a[188:191], a[100:103], v[24:27]
    ds_read_b64_tr_b16 a[212:213], v11 offset:28672
    v_mul_f32 v40, v16, v40
    v_mfma_f32_16x16x32_bf16 v[28:31], a[188:191], a[108:111], 0
    ds_read_b64_tr_b16 a[214:215], v11 offset:30720
    v_mul_f32 v41, v16, v41
    v_mfma_f32_16x16x32_bf16 v[28:31], a[184:187], a[104:107], v[28:31]
    v_mul_f32 v42, v16, v42
    v_mul_f32 v43, v16, v43
    v_mfma_f32_16x16x32_bf16 v[32:35], a[184:187], a[112:115], 0
    buffer_load_dwordx4 a[96:99], v14, s[20:23], s37 offen offset:0 sc1
    v_mfma_f32_16x16x32_bf16 v[32:35], a[188:191], a[116:119], v[32:35]
    v_cvt_pk_bf16_f32 v40, v40, v41
    v_cvt_pk_bf16_f32 v41, v42, v43
    v_mfma_f32_16x16x32_bf16 v[36:39], a[188:191], a[124:127], 0
    s_waitcnt lgkmcnt(5)
    v_accvgpr_write_b32 a80, v40
    v_accvgpr_write_b32 a81, v41
    v_mfma_f32_16x16x32_bf16 v[36:39], a[184:187], a[120:123], v[36:39]
    ds_read_b64_tr_b16 a[184:185], v11 offset:32768
    v_mul_f32 v46, v17, v46
    v_mfma_f32_16x16x32_bf16 v[36:39], a[192:195], v[120:123], v[36:39]
    ds_read_b64_tr_b16 a[186:187], v11 offset:34816
    v_mul_f32 v47, v17, v47
    v_mfma_f32_16x16x32_bf16 v[36:39], a[196:199], v[124:127], v[36:39]
    ds_read_b64_tr_b16 a[188:189], v11 offset:36864
    v_cvt_pk_bf16_f32 v44, v44, v45
    v_mfma_f32_16x16x32_bf16 v[32:35], a[196:199], a[148:151], v[32:35]
    ds_read_b64_tr_b16 a[190:191], v11 offset:38912
    v_cvt_pk_bf16_f32 v45, v46, v47
    v_mfma_f32_16x16x32_bf16 v[32:35], a[192:195], a[144:147], v[32:35]
    v_accvgpr_write_b32 a84, v44
    v_accvgpr_write_b32 a85, v45
    v_mfma_f32_16x16x32_bf16 v[28:31], a[192:195], a[136:139], v[28:31]
    v_mul_f32 v49, v18, v49
    v_mul_f32 v50, v18, v50
    v_mfma_f32_16x16x32_bf16 v[28:31], a[196:199], a[140:143], v[28:31]
    v_mul_f32 v51, v18, v51
    v_cvt_pk_bf16_f32 v48, v48, v49
    v_mfma_f32_16x16x32_bf16 v[24:27], a[196:199], a[132:135], v[24:27]
    buffer_load_dwordx4 a[100:103], v14, s[20:23], s37 offen offset:1024 sc1
    v_mfma_f32_16x16x32_bf16 v[24:27], a[192:195], a[128:131], v[24:27]
    s_waitcnt lgkmcnt(4)
    ds_read_b64_tr_b16 a[192:193], v11 offset:40960
    v_cvt_pk_bf16_f32 v49, v50, v51
    v_mfma_f32_16x16x32_bf16 v[24:27], a[200:203], v[128:131], v[24:27]
    ds_read_b64_tr_b16 a[194:195], v11 offset:43008
    v_accvgpr_write_b32 a88, v48
    v_mfma_f32_16x16x32_bf16 v[24:27], a[204:207], v[132:135], v[24:27]
    ds_read_b64_tr_b16 a[196:197], v11 offset:45056
    v_accvgpr_write_b32 a89, v49
    v_mfma_f32_16x16x32_bf16 v[28:31], a[204:207], v[140:143], v[28:31]
    ds_read_b64_tr_b16 a[198:199], v11 offset:47104
    v_mfma_f32_16x16x32_bf16 v[28:31], a[200:203], v[136:139], v[28:31]
    v_mul_f32 v54, v19, v54
    v_mfma_f32_16x16x32_bf16 v[32:35], a[200:203], v[144:147], v[32:35]
    v_mul_f32 v55, v19, v55
    v_cvt_pk_bf16_f32 v52, v52, v53
    v_mfma_f32_16x16x32_bf16 v[32:35], a[204:207], v[148:151], v[32:35]
    v_cvt_pk_bf16_f32 v53, v54, v55
    v_accvgpr_write_b32 a92, v52
    v_mfma_f32_16x16x32_bf16 v[36:39], a[204:207], v[156:159], v[36:39]
    v_accvgpr_write_b32 a93, v53
    v_mfma_f32_16x16x32_bf16 v[36:39], a[200:203], v[152:155], v[36:39]
    ds_read_b64_tr_b16 a[200:201], v11 offset:49152
    v_mfma_f32_16x16x32_bf16 v[36:39], a[208:211], v[184:187], v[36:39]
    buffer_load_dwordx4 a[104:107], v14, s[20:23], s37 offen offset:2048 sc1
    v_mfma_f32_16x16x32_bf16 v[36:39], a[212:215], v[188:191], v[36:39]
    ds_read_b64_tr_b16 a[202:203], v11 offset:51200
    v_mfma_f32_16x16x32_bf16 v[32:35], a[212:215], v[180:183], v[32:35]
    ds_read_b64_tr_b16 a[204:205], v11 offset:53248
    v_mfma_f32_16x16x32_bf16 v[32:35], a[208:211], v[176:179], v[32:35]
    s_waitcnt lgkmcnt(5)
    ds_read_b64_tr_b16 a[206:207], v11 offset:55296
    v_mfma_f32_16x16x32_bf16 v[28:31], a[208:211], v[168:171], v[28:31]
    v_add_u32 v12, 98304, v12
    v_mfma_f32_16x16x32_bf16 v[28:31], a[212:215], v[172:175], v[28:31]
    s_waitcnt vmcnt(6)
    v_lshrrev_b32 v13, 2, v1
    v_mfma_f32_16x16x32_bf16 v[24:27], a[212:215], v[164:167], v[24:27]
    buffer_store_dword v4, v15, s[24:27], s76 offen sc1
    v_mfma_f32_16x16x32_bf16 v[24:27], a[208:211], v[160:163], v[24:27]
    ds_read_b64_tr_b16 a[208:209], v11 offset:57344
    v_mfma_f32_16x16x32_bf16 v[24:27], a[184:187], v[192:195], v[24:27]
    ds_read_b64_tr_b16 a[210:211], v11 offset:59392
    v_mfma_f32_16x16x32_bf16 v[24:27], a[188:191], v[196:199], v[24:27]
    ds_read_b64_tr_b16 a[212:213], v11 offset:61440
    v_mfma_f32_16x16x32_bf16 v[28:31], a[188:191], v[204:207], v[28:31]
    buffer_load_dwordx4 a[108:111], v14, s[20:23], s37 offen offset:3072 sc1
    v_mfma_f32_16x16x32_bf16 v[28:31], a[184:187], v[200:203], v[28:31]
    ds_read_b64_tr_b16 a[214:215], v11 offset:63488
    v_add_u32 v11, 65536, v11
    v_mfma_f32_16x16x32_bf16 v[32:35], a[184:187], v[208:211], v[32:35]
    v_lshlrev_b32 v13, 6, v13
    v_mfma_f32_16x16x32_bf16 v[32:35], a[188:191], v[212:215], v[32:35]
    v_and_b32 v21, 3, v1
    v_mfma_f32_16x16x32_bf16 v[36:39], a[188:191], v[220:223], v[36:39]
    s_waitcnt lgkmcnt(3)
    v_lshl_add_u32 v13, v21, 3, v13
    s_add_u32 s37, s61, 4096
    v_mfma_f32_16x16x32_bf16 v[36:39], a[184:187], v[216:219], v[36:39]
    v_and_b32 v21, 16, v1
    v_mfma_f32_16x16x32_bf16 v[36:39], a[192:195], v[248:251], v[36:39]
    v_lshl_add_u32 v13, v21, 1, v13
    v_mfma_f32_16x16x32_bf16 v[36:39], a[196:199], v[252:255], v[36:39]
    s_waitcnt lgkmcnt(0)
    v_xor_b32 v13, 32, v13
    v_mfma_f32_16x16x32_bf16 v[32:35], a[196:199], v[244:247], v[32:35]
    s_barrier
    v_mfma_f32_16x16x32_bf16 v[32:35], a[192:195], v[240:243], v[32:35]
    ds_read_b64_tr_b16 a[184:185], v12 offset:57344
    v_mfma_f32_16x16x32_bf16 v[28:31], a[192:195], v[232:235], v[28:31]
    buffer_load_dwordx4 a[112:115], v14, s[20:23], s37 offen offset:0 sc1
    v_mfma_f32_16x16x32_bf16 v[28:31], a[196:199], v[236:239], v[28:31]
    ds_read_b64_tr_b16 a[186:187], v12 offset:58368
    v_mfma_f32_16x16x32_bf16 v[24:27], a[196:199], v[228:231], v[24:27]
    ds_read_b64_tr_b16 a[188:189], v12 offset:59392
    v_add_u32 v13, 98304, v13
    v_mfma_f32_16x16x32_bf16 v[24:27], a[192:195], v[224:227], v[24:27]
    ds_read_b64_tr_b16 a[190:191], v12 offset:60416
    v_subrev_u32 v12, 81920, v12
    v_mfma_f32_16x16x32_bf16 v[24:27], a[200:203], v[56:59], v[24:27]
    ds_read_b64_tr_b16 a[192:193], v13 offset:57344
    v_mfma_f32_16x16x32_bf16 v[24:27], a[204:207], v[60:63], v[24:27]
    ds_read_b64_tr_b16 a[194:195], v13 offset:58368
    v_mfma_f32_16x16x32_bf16 v[28:31], a[204:207], v[68:71], v[28:31]
    ds_read_b64_tr_b16 a[196:197], v13 offset:59392
    v_mfma_f32_16x16x32_bf16 v[28:31], a[200:203], v[64:67], v[28:31]
    ds_read_b64_tr_b16 a[198:199], v13 offset:60416
    v_subrev_u32 v13, 81920, v13
    v_mfma_f32_16x16x32_bf16 v[32:35], a[200:203], v[72:75], v[32:35]
    v_mov_b32 v55, s56
    v_mfma_f32_16x16x32_bf16 v[32:35], a[204:207], v[76:79], v[32:35]
    s_lshl_b32 s56, s3, 8
    v_mfma_f32_16x16x32_bf16 v[36:39], a[204:207], v[84:87], v[36:39]
    buffer_load_dwordx4 a[116:119], v14, s[20:23], s37 offen offset:1024 sc1
    v_mfma_f32_16x16x32_bf16 v[36:39], a[200:203], v[80:83], v[36:39]
    s_add_u32 s77, s7, 3
    ds_read_b64_tr_b16 a[200:201], v8 offset:0
    v_mfma_f32_16x16x32_bf16 v[36:39], a[208:211], v[112:115], v[36:39]
    s_add_u32 s56, s56, 71680
    ds_read_b64_tr_b16 a[202:203], v8 offset:2048
    v_mfma_f32_16x16x32_bf16 v[36:39], a[212:215], v[116:119], v[36:39]
    ds_read_b64_tr_b16 a[204:205], v8 offset:8192
    v_mfma_f32_16x16x32_bf16 v[32:35], a[212:215], v[108:111], v[32:35]
    s_waitcnt lgkmcnt(3)
    ds_read_b64_tr_b16 a[206:207], v8 offset:10240
    v_mfma_f32_16x16x32_bf16 v[32:35], a[208:211], v[104:107], v[32:35]
    v_mfma_f32_16x16x32_bf16 v[28:31], a[208:211], v[96:99], v[28:31]
    v_mfma_f32_16x16x32_bf16 v[28:31], a[212:215], v[100:103], v[28:31]
    v_mfma_f32_16x16x32_bf16 v[24:27], a[212:215], v[92:95], v[24:27]
    v_mul_f32 v36, v19, v36
    v_mfma_f32_16x16x32_bf16 v[24:27], a[208:211], v[88:91], v[24:27]
    ds_read_b64_tr_b16 a[208:209], v9 offset:0
    v_mfma_f32_16x16x32_bf16 v[96:99], a[184:187], a[0:3], 0
    buffer_load_dwordx4 a[120:123], v14, s[20:23], s37 offen offset:2048 sc1
    v_mfma_f32_16x16x32_bf16 v[96:99], a[188:191], a[16:19], v[96:99]
    ds_read_b64_tr_b16 a[210:211], v9 offset:2048
    v_mul_f32 v28, v17, v28
    v_mfma_f32_16x16x32_bf16 v[104:107], a[188:191], a[20:23], 0
    ds_read_b64_tr_b16 a[212:213], v9 offset:8192
    v_mul_f32 v24, v16, v24
    v_mfma_f32_16x16x32_bf16 v[104:107], a[184:187], a[4:7], v[104:107]
    ds_read_b64_tr_b16 a[214:215], v9 offset:10240
    v_mul_f32 v25, v16, v25
    v_mfma_f32_16x16x32_bf16 v[112:115], a[184:187], a[8:11], 0
    v_mul_f32 v26, v16, v26
    v_mul_f32 v27, v16, v27
    v_mfma_f32_16x16x32_bf16 v[112:115], a[188:191], a[24:27], v[112:115]
    v_cvt_pk_bf16_f32 v24, v24, v25
    v_cvt_pk_bf16_f32 v25, v26, v27
    v_mfma_f32_16x16x32_bf16 v[120:123], a[188:191], a[28:31], 0
    v_accvgpr_write_b32 a82, v24
    v_accvgpr_write_b32 a83, v25
    v_mfma_f32_16x16x32_bf16 v[120:123], a[184:187], a[12:15], v[120:123]
    buffer_store_dwordx4 a[80:83], v14, s[20:23], s55 offen offset:0 sc1
    v_mul_f32 v29, v17, v29
    v_mfma_f32_16x16x32_bf16 v[124:127], a[192:195], a[12:15], 0
    ds_read_b64_tr_b16 a[184:185], v10 offset:0
    v_mul_f32 v30, v17, v30
    v_mfma_f32_16x16x32_bf16 v[124:127], a[196:199], a[28:31], v[124:127]
    ds_read_b64_tr_b16 a[186:187], v10 offset:2048
    v_mul_f32 v31, v17, v31
    v_mfma_f32_16x16x32_bf16 v[116:119], a[196:199], a[24:27], 0
    buffer_load_dwordx4 a[124:127], v14, s[20:23], s37 offen offset:3072 sc1
    v_mfma_f32_16x16x32_bf16 v[116:119], a[192:195], a[8:11], v[116:119]
    s_sub_u32 s78, s72, s77
    ds_read_b64_tr_b16 a[188:189], v10 offset:8192
    v_cvt_pk_bf16_f32 v28, v28, v29
    v_mfma_f32_16x16x32_bf16 v[108:111], a[192:195], a[4:7], 0
    s_waitcnt lgkmcnt(3)
    ds_read_b64_tr_b16 a[190:191], v10 offset:10240
    v_cvt_pk_bf16_f32 v29, v30, v31
    v_mfma_f32_16x16x32_bf16 v[108:111], a[196:199], a[20:23], v[108:111]
    s_sub_u32 s79, s73, s77
    v_accvgpr_write_b32 a86, v28
    v_accvgpr_write_b32 a87, v29
    v_mfma_f32_16x16x32_bf16 v[100:103], a[196:199], a[16:19], 0
    buffer_store_dwordx4 a[84:87], v14, s[20:23], s55 offen offset:1024 sc1
    v_mul_f32 v32, v18, v32
    v_mfma_f32_16x16x32_bf16 v[100:103], a[192:195], a[0:3], v[100:103]
    s_max_u32 s78, s78, s79
    ds_read_b64_tr_b16 a[192:193], v11 offset:0
    v_mul_f32 v33, v18, v33
    v_mfma_f32_16x16x32_bf16 v[128:131], a[200:203], a[0:3], 0
    s_sub_u32 s79, s74, s77
    ds_read_b64_tr_b16 a[194:195], v11 offset:2048
    v_mul_f32 v34, v18, v34
    v_mfma_f32_16x16x32_bf16 v[128:131], a[204:207], a[16:19], v[128:131]
    s_max_u32 s78, s78, s79
    ds_read_b64_tr_b16 a[196:197], v11 offset:8192
    v_mul_f32 v35, v18, v35
    v_mfma_f32_16x16x32_bf16 v[136:139], a[204:207], a[20:23], 0
    s_sub_u32 s79, s75, s77
    ds_read_b64_tr_b16 a[198:199], v11 offset:10240
    v_cvt_pk_bf16_f32 v32, v32, v33
    v_mfma_f32_16x16x32_bf16 v[136:139], a[200:203], a[4:7], v[136:139]
    s_max_u32 s78, s78, s79
    v_cvt_pk_bf16_f32 v33, v34, v35
    v_accvgpr_write_b32 a90, v32
    v_mfma_f32_16x16x32_bf16 v[144:147], a[200:203], a[8:11], 0
    s_cmp_gt_u32 s78, 3
    s_cbranch_scc1 spin_o2
spin_o2_ret:
    v_accvgpr_write_b32 a91, v33
    v_mfma_f32_16x16x32_bf16 v[144:147], a[204:207], a[24:27], v[144:147]
    buffer_store_dwordx4 a[88:91], v14, s[20:23], s55 offen offset:2048 sc1
    v_mul_f32 v37, v19, v37
    v_mfma_f32_16x16x32_bf16 v[152:155], a[204:207], a[28:31], 0
    s_add_u32 s37, s59, 8192
    v_mul_f32 v38, v19, v38
    v_mul_f32 v39, v19, v39
    v_mfma_f32_16x16x32_bf16 v[152:155], a[200:203], a[12:15], v[152:155]
    buffer_load_dwordx4 a[128:131], v14, s[20:23], s37 offen offset:0 sc1
    v_mfma_f32_16x16x32_bf16 v[156:159], a[208:211], a[12:15], 0
    ds_read_b64_tr_b16 a[200:201], v8 offset:4096
    v_cvt_pk_bf16_f32 v36, v36, v37
    v_mfma_f32_16x16x32_bf16 v[156:159], a[212:215], a[28:31], v[156:159]
    ds_read_b64_tr_b16 a[202:203], v8 offset:6144
    v_cvt_pk_bf16_f32 v37, v38, v39
    v_mfma_f32_16x16x32_bf16 v[148:151], a[212:215], a[24:27], 0
    ds_read_b64_tr_b16 a[204:205], v8 offset:12288
    v_accvgpr_write_b32 a94, v36
    v_mfma_f32_16x16x32_bf16 v[148:151], a[208:211], a[8:11], v[148:151]
    s_waitcnt lgkmcnt(3)
    ds_read_b64_tr_b16 a[206:207], v8 offset:14336
    v_subrev_u32 v8, 139264, v8
    v_mfma_f32_16x16x32_bf16 v[140:143], a[208:211], a[4:7], 0
    v_accvgpr_write_b32 a95, v37
    v_mfma_f32_16x16x32_bf16 v[140:143], a[212:215], a[20:23], v[140:143]
    buffer_store_dwordx4 a[92:95], v14, s[20:23], s55 offen offset:3072 sc1
    v_mfma_f32_16x16x32_bf16 v[132:135], a[212:215], a[16:19], 0
    buffer_load_dwordx4 a[132:135], v14, s[20:23], s37 offen offset:1024 sc1
    v_mfma_f32_16x16x32_bf16 v[132:135], a[208:211], a[0:3], v[132:135]
    s_add_u32 s55, s55, 4096
    ds_read_b64_tr_b16 a[208:209], v9 offset:4096
    v_mfma_f32_16x16x32_bf16 v[160:163], a[184:187], a[0:3], 0
    ds_read_b64_tr_b16 a[210:211], v9 offset:6144
    v_mfma_f32_16x16x32_bf16 v[160:163], a[188:191], a[16:19], v[160:163]
    ds_read_b64_tr_b16 a[212:213], v9 offset:12288
    v_mfma_f32_16x16x32_bf16 v[168:171], a[188:191], a[20:23], 0
    ds_read_b64_tr_b16 a[214:215], v9 offset:14336
    v_subrev_u32 v9, 139264, v9
    v_mfma_f32_16x16x32_bf16 v[168:171], a[184:187], a[4:7], v[168:171]
    v_mfma_f32_16x16x32_bf16 v[176:179], a[184:187], a[8:11], 0
    v_mfma_f32_16x16x32_bf16 v[176:179], a[188:191], a[24:27], v[176:179]
    v_mfma_f32_16x16x32_bf16 v[184:187], a[188:191], a[28:31], 0
    v_mfma_f32_16x16x32_bf16 v[184:187], a[184:187], a[12:15], v[184:187]
    ds_read_b64_tr_b16 a[184:185], v10 offset:4096
    v_mfma_f32_16x16x32_bf16 v[188:191], a[192:195], a[12:15], 0
    buffer_load_dwordx4 a[136:139], v14, s[20:23], s37 offen offset:2048 sc1
    v_mfma_f32_16x16x32_bf16 v[188:191], a[196:199], a[28:31], v[188:191]
    ds_read_b64_tr_b16 a[186:187], v10 offset:6144
    v_mfma_f32_16x16x32_bf16 v[180:183], a[196:199], a[24:27], 0
    ds_read_b64_tr_b16 a[188:189], v10 offset:12288
    v_mfma_f32_16x16x32_bf16 v[180:183], a[192:195], a[8:11], v[180:183]
    s_waitcnt lgkmcnt(3)
    ds_read_b64_tr_b16 a[190:191], v10 offset:14336
    v_subrev_u32 v10, 139264, v10
    v_mfma_f32_16x16x32_bf16 v[172:175], a[192:195], a[4:7], 0
    s_add_u32 m0, s43, 114688
    v_mfma_f32_16x16x32_bf16 v[172:175], a[196:199], a[20:23], v[172:175]
    v_mfma_f32_16x16x32_bf16 v[164:167], a[196:199], a[16:19], 0
    v_mfma_f32_16x16x32_bf16 v[164:167], a[192:195], a[0:3], v[164:167]
    ds_read_b64_tr_b16 a[192:193], v11 offset:4096
    v_mfma_f32_16x16x32_bf16 v[192:195], a[200:203], a[0:3], 0
    ds_read_b64_tr_b16 a[194:195], v11 offset:6144
    v_mfma_f32_16x16x32_bf16 v[192:195], a[204:207], a[16:19], v[192:195]
    ds_read_b64_tr_b16 a[196:197], v11 offset:12288
    v_mfma_f32_16x16x32_bf16 v[200:203], a[204:207], a[20:23], 0
    buffer_load_dwordx4 a[140:143], v14, s[20:23], s37 offen offset:3072 sc1
    v_mfma_f32_16x16x32_bf16 v[200:203], a[200:203], a[4:7], v[200:203]
    ds_read_b64_tr_b16 a[198:199], v11 offset:14336
    v_subrev_u32 v11, 139264, v11
    v_mfma_f32_16x16x32_bf16 v[208:211], a[200:203], a[8:11], 0
    buffer_load_dwordx4 v22, s[28:31], s41 offen lds
    v_mfma_f32_16x16x32_bf16 v[208:211], a[204:207], a[24:27], v[208:211]
    v_mfma_f32_16x16x32_bf16 v[216:219], a[204:207], a[28:31], 0
    v_add_u32 v21, 61440, v14
    v_mfma_f32_16x16x32_bf16 v[216:219], a[200:203], a[12:15], v[216:219]
    v_mfma_f32_16x16x32_bf16 v[220:223], a[208:211], a[12:15], 0
    s_addk_i32 m0, 1024
    v_mfma_f32_16x16x32_bf16 v[220:223], a[212:215], a[28:31], v[220:223]
    s_waitcnt vmcnt(18) lgkmcnt(0)
    v_mfma_f32_16x16x32_bf16 v[212:215], a[212:215], a[24:27], 0
    s_barrier
    v_mfma_f32_16x16x32_bf16 v[212:215], a[208:211], a[8:11], v[212:215]
    ds_read_b64_tr_b16 a[200:201], v12 offset:0
    v_mfma_f32_16x16x32_bf16 v[204:207], a[208:211], a[4:7], 0
    ds_read_b64_tr_b16 a[202:203], v12 offset:1024
    v_mfma_f32_16x16x32_bf16 v[204:207], a[212:215], a[20:23], v[204:207]
    ds_read_b64_tr_b16 a[204:205], v12 offset:2048
    v_mfma_f32_16x16x32_bf16 v[196:199], a[212:215], a[16:19], 0
    buffer_load_dwordx4 v23, s[28:31], s41 offen lds
    v_mfma_f32_16x16x32_bf16 v[196:199], a[208:211], a[0:3], v[196:199]
    s_mov_b64 s[28:29], 0
    ds_read_b64_tr_b16 a[206:207], v12 offset:3072
    v_mfma_f32_16x16x32_bf16 v[224:227], a[184:187], a[0:3], 0
    s_mov_b64 s[30:31], 0
    ds_read_b64_tr_b16 a[208:209], v13 offset:0
    v_mfma_f32_16x16x32_bf16 v[224:227], a[188:191], a[16:19], v[224:227]
    s_mov_b64 s[32:33], 0
    ds_read_b64_tr_b16 a[210:211], v13 offset:1024
    v_mfma_f32_16x16x32_bf16 v[232:235], a[188:191], a[20:23], 0
    s_add_u32 s38, s45, 40960
    ds_read_b64_tr_b16 a[212:213], v13 offset:2048
    s_add_u32 s36, s44, 204800
    v_mfma_f32_16x16x32_bf16 v[232:235], a[184:187], a[4:7], v[232:235]
    s_cmp_lt_u32 s3, 2
    s_cselect_b32 s38, s38, s36
    v_mfma_f32_16x16x32_bf16 v[240:243], a[184:187], a[8:11], 0
    s_add_u32 m0, s63, 90112
    ds_read_b64_tr_b16 a[214:215], v13 offset:3072
    v_mfma_f32_16x16x32_bf16 v[240:243], a[188:191], a[24:27], v[240:243]
    s_mov_b64 s[34:35], 0
    ds_read_b128 v[56:59], v21 offset:0
    v_mfma_f32_16x16x32_bf16 v[248:251], a[188:191], a[28:31], 0
    ds_read_b128 v[60:63], v21 offset:1024
    v_mfma_f32_16x16x32_bf16 v[248:251], a[184:187], a[12:15], v[248:251]
    ds_read_b128 v[64:67], v21 offset:2048
    v_mfma_f32_16x16x32_bf16 v[252:255], a[192:195], a[12:15], 0
    s_waitcnt lgkmcnt(5)
    ds_read_b64_tr_b16 a[184:185], v8 offset:0
    s_load_dwordx4 s[72:75], s[86:87], s5 glc
    v_mfma_f32_16x16x32_bf16 v[252:255], a[196:199], a[28:31], v[252:255]
    ds_read_b64_tr_b16 a[186:187], v8 offset:2048
    v_mfma_f32_16x16x32_bf16 v[244:247], a[196:199], a[24:27], 0
    buffer_load_dwordx4 v7, s[8:11], s38 offen lds
    v_mfma_f32_16x16x32_bf16 v[244:247], a[192:195], a[8:11], v[244:247]
    s_add_u32 s37, s60, 8192
    ds_read_b64_tr_b16 a[188:189], v8 offset:8192
    v_mfma_f32_16x16x32_bf16 v[236:239], a[192:195], a[4:7], 0
    ds_read_b64_tr_b16 a[190:191], v8 offset:10240
    v_mfma_f32_16x16x32_bf16 v[236:239], a[196:199], a[20:23], v[236:239]
    s_waitcnt lgkmcnt(5)
    ds_read_b128 v[68:71], v21 offset:3072
    v_add_f32 v56, v56, v60
    v_mfma_f32_16x16x32_bf16 v[228:231], a[196:199], a[16:19], 0
    s_add_u32 s38, s45, 40960
    ds_read_b128 v[72:75], v21 offset:4096
    v_add_f32 v57, v57, v61
    v_mfma_f32_16x16x32_bf16 v[228:231], a[192:195], a[0:3], v[228:231]
    s_waitcnt lgkmcnt(6)
    ds_read_b128 v[76:79], v21 offset:5120
    v_add_f32 v58, v58, v62
    v_mfma_f32_16x16x32_bf16 v[96:99], a[200:203], a[32:35], v[96:99]
    buffer_load_dwordx4 a[0:3], v14, s[20:23], s37 offen offset:0 sc1
    v_mfma_f32_16x16x32_bf16 v[96:99], a[204:207], a[48:51], v[96:99]
    s_add_u32 m0, s63, 73728
    ds_read_b64_tr_b16 a[192:193], v9 offset:0
    v_add_f32 v59, v59, v63
    v_mfma_f32_16x16x32_bf16 v[104:107], a[204:207], a[52:55], v[104:107]
pg_12:
    s_cbranch_execz pg_back
    ds_read_b64_tr_b16 a[194:195], v9 offset:2048
    v_add_f32 v56, v56, v64
    v_mfma_f32_16x16x32_bf16 v[104:107], a[200:203], a[36:39], v[104:107]
    ds_read_b64_tr_b16 a[196:197], v9 offset:8192
    v_add_f32 v57, v57, v65
    v_mfma_f32_16x16x32_bf16 v[112:115], a[200:203], a[40:43], v[112:115]
    s_waitcnt lgkmcnt(5)
    ds_read_b64_tr_b16 a[198:199], v9 offset:10240
    v_add_f32 v58, v58, v66
    v_mfma_f32_16x16x32_bf16 v[112:115], a[204:207], a[56:59], v[112:115]
    ds_read_b128 v[80:83], v21 offset:6144
    v_add_f32 v59, v59, v67
    v_mfma_f32_16x16x32_bf16 v[120:123], a[204:207], a[60:63], v[120:123]
    buffer_load_dwordx4 v2, s[8:11], s38 offen lds
    v_mfma_f32_16x16x32_bf16 v[120:123], a[200:203], a[44:47], v[120:123]
    ds_read_b128 v[84:87], v21 offset:7168
    v_add_f32 v56, v56, v68
    v_mfma_f32_16x16x32_bf16 v[124:127], a[208:211], a[44:47], v[124:127]
    s_waitcnt lgkmcnt(7)
    ds_read_b64_tr_b16 a[200:201], v10 offset:0
    v_add_f32 v57, v57, v69
    v_mfma_f32_16x16x32_bf16 v[124:127], a[212:215], a[60:63], v[124:127]
    s_waitcnt vmcnt(8)
    ds_read_b64_tr_b16 a[202:203], v10 offset:2048
    v_add_f32 v58, v58, v70
    v_mfma_f32_16x16x32_bf16 v[116:119], a[212:215], a[56:59], v[116:119]
    buffer_store_dword v55, v15, s[24:27], s76 offen sc1
    v_mfma_f32_16x16x32_bf16 v[116:119], a[208:211], a[40:43], v[116:119]
    buffer_load_dwordx4 a[4:7], v14, s[20:23], s37 offen offset:1024 sc1
    v_mfma_f32_16x16x32_bf16 v[108:111], a[208:211], a[36:39], v[108:111]
    s_add_u32 s38, s45, 40960
    ds_read_b64_tr_b16 a[204:205], v10 offset:8192
    v_add_f32 v59, v59, v71
    v_mfma_f32_16x16x32_bf16 v[108:111], a[212:215], a[52:55], v[108:111]
    s_addk_i32 m0, 4096
    ds_read_b64_tr_b16 a[206:207], v10 offset:10240
    v_add_f32 v56, v56, v72
    v_mfma_f32_16x16x32_bf16 v[100:103], a[212:215], a[48:51], v[100:103]
    s_waitcnt lgkmcnt(6)
    ds_read_b128 v[88:91], v21 offset:8192
    v_add_f32 v57, v57, v73
    v_mfma_f32_16x16x32_bf16 v[100:103], a[208:211], a[32:35], v[100:103]
    ds_read_b128 v[92:95], v21 offset:9216
    v_add_f32 v58, v58, v74
    v_mfma_f32_16x16x32_bf16 v[128:131], a[184:187], a[32:35], v[128:131]
    ds_read_b64_tr_b16 a[208:209], v11 offset:0
    v_add_f32 v59, v59, v75
    v_mfma_f32_16x16x32_bf16 v[128:131], a[188:191], a[48:51], v[128:131]
    ds_read_b64_tr_b16 a[210:211], v11 offset:2048
    v_add_f32 v56, v56, v76
    v_mfma_f32_16x16x32_bf16 v[136:139], a[188:191], a[52:55], v[136:139]
    buffer_load_dwordx4 v3, s[8:11], s38 offen lds
    v_mfma_f32_16x16x32_bf16 v[136:139], a[184:187], a[36:39], v[136:139]
    s_waitcnt lgkmcnt(7)
    ds_read_b64_tr_b16 a[212:213], v11 offset:8192
    v_add_f32 v57, v57, v77
    v_mfma_f32_16x16x32_bf16 v[144:147], a[184:187], a[40:43], v[144:147]
    buffer_load_dwordx4 a[8:11], v14, s[20:23], s37 offen offset:2048 sc1
    v_mfma_f32_16x16x32_bf16 v[144:147], a[188:191], a[56:59], v[144:147]
    ds_read_b64_tr_b16 a[214:215], v11 offset:10240
    v_add_f32 v58, v58, v78
    v_mfma_f32_16x16x32_bf16 v[152:155], a[188:191], a[60:63], v[152:155]
    s_add_u32 s38, s44, 204800
    v_add_f32 v59, v59, v79
    v_add_f32 v56, v56, v80
    v_mfma_f32_16x16x32_bf16 v[152:155], a[184:187], a[44:47], v[152:155]
    ds_read_b64_tr_b16 a[184:185], v8 offset:4096
    v_add_f32 v57, v57, v81
    v_mfma_f32_16x16x32_bf16 v[156:159], a[192:195], a[44:47], v[156:159]
    s_addk_i32 m0, 4096
    ds_read_b64_tr_b16 a[186:187], v8 offset:6144
    v_add_f32 v58, v58, v82
    v_mfma_f32_16x16x32_bf16 v[156:159], a[196:199], a[60:63], v[156:159]
    s_waitcnt lgkmcnt(6)
    ds_read_b64_tr_b16 a[188:189], v8 offset:12288
    v_add_f32 v59, v59, v83
    v_mfma_f32_16x16x32_bf16 v[148:151], a[196:199], a[56:59], v[148:151]
    ds_read_b64_tr_b16 a[190:191], v8 offset:14336
    v_add_f32 v56, v56, v84
    v_mfma_f32_16x16x32_bf16 v[148:151], a[192:195], a[40:43], v[148:151]
    v_add_f32 v57, v57, v85
    v_add_f32 v58, v58, v86
    v_mfma_f32_16x16x32_bf16 v[140:143], a[192:195], a[36:39], v[140:143]
    v_add_f32 v59, v59, v87
    v_add_f32 v56, v56, v88
    v_mfma_f32_16x16x32_bf16 v[140:143], a[196:199], a[52:55], v[140:143]
    v_add_f32 v57, v57, v89
    v_add_f32 v58, v58, v90
    v_mfma_f32_16x16x32_bf16 v[132:135], a[196:199], a[48:51], v[132:135]
    buffer_load_dwordx4 a[12:15], v14, s[20:23], s37 offen offset:3072 sc1
    v_mfma_f32_16x16x32_bf16 v[132:135], a[192:195], a[32:35], v[132:135]
    buffer_load_dwordx4 v2, s[8:11], s38 offen lds
    v_mfma_f32_16x16x32_bf16 v[160:163], a[200:203], a[32:35], v[160:163]
    ds_read_b64_tr_b16 a[192:193], v9 offset:4096
    v_add_f32 v59, v59, v91
    v_mfma_f32_16x16x32_bf16 v[160:163], a[204:207], a[48:51], v[160:163]
    ds_read_b64_tr_b16 a[194:195], v9 offset:6144
    v_add_f32 v56, v56, v92
    v_mfma_f32_16x16x32_bf16 v[168:171], a[204:207], a[52:55], v[168:171]
    s_add_u32 s37, s61, 8192
    ds_read_b64_tr_b16 a[196:197], v9 offset:12288
    v_add_f32 v57, v57, v93
    v_mfma_f32_16x16x32_bf16 v[168:171], a[200:203], a[36:39], v[168:171]
    s_waitcnt lgkmcnt(5)
    ds_read_b64_tr_b16 a[198:199], v9 offset:14336
    v_add_f32 v58, v58, v94
    v_mfma_f32_16x16x32_bf16 v[176:179], a[200:203], a[40:43], v[176:179]
    s_add_u32 s38, s44, 204800
    v_add_f32 v59, v59, v95
    v_cvt_pk_bf16_f32 v56, 0, v56
    v_mfma_f32_16x16x32_bf16 v[176:179], a[204:207], a[56:59], v[176:179]
    s_addk_i32 m0, 4096
    v_cvt_pk_bf16_f32 v57, 0, v57
    v_cvt_pk_bf16_f32 v58, 0, v58
    v_mfma_f32_16x16x32_bf16 v[184:187], a[204:207], a[60:63], v[184:187]
    v_cvt_pk_bf16_f32 v59, 0, v59
    v_mul_f32 v60, s92, v56
    v_mfma_f32_16x16x32_bf16 v[184:187], a[200:203], a[44:47], v[184:187]
    ds_read_b64_tr_b16 a[200:201], v10 offset:4096
    v_mul_f32 v61, s92, v57
    v_mfma_f32_16x16x32_bf16 v[188:191], a[208:211], a[44:47], v[188:191]
    buffer_load_dwordx4 a[16:19], v14, s[20:23], s37 offen offset:0 sc1
    v_mfma_f32_16x16x32_bf16 v[188:191], a[212:215], a[60:63], v[188:191]
    ds_read_b64_tr_b16 a[202:203], v10 offset:6144
    v_lshlrev_b32 v64, 1, v1
    v_mfma_f32_16x16x32_bf16 v[180:183], a[212:215], a[56:59], v[180:183]
    buffer_load_dwordx4 v3, s[8:11], s38 offen lds
    v_mfma_f32_16x16x32_bf16 v[180:183], a[208:211], a[40:43], v[180:183]
    ds_read_b64_tr_b16 a[204:205], v10 offset:12288
    v_add_u32 v64, s56, v64
    v_mfma_f32_16x16x32_bf16 v[172:175], a[208:211], a[36:39], v[172:175]
    ds_read_b64_tr_b16 a[206:207], v10 offset:14336
    v_and_b32 v65, 1, v1
    v_mfma_f32_16x16x32_bf16 v[172:175], a[212:215], a[52:55], v[172:175]
    v_exp_f32 v60, v60
    v_mfma_f32_16x16x32_bf16 v[164:167], a[212:215], a[48:51], v[164:167]
    s_waitcnt lgkmcnt(3)
    v_exp_f32 v61, v61
    v_mfma_f32_16x16x32_bf16 v[164:167], a[208:211], a[32:35], v[164:167]
    s_add_u32 s38, s46, 40960
    ds_read_b64_tr_b16 a[208:209], v11 offset:4096
    v_add_f32 v60, 1.0, v60
    v_mfma_f32_16x16x32_bf16 v[192:195], a[184:187], a[32:35], v[192:195]
    s_add_u32 s36, s47, 40960
    ds_read_b64_tr_b16 a[210:211], v11 offset:6144
    v_add_f32 v61, 1.0, v61
    v_mfma_f32_16x16x32_bf16 v[192:195], a[188:191], a[48:51], v[192:195]
    s_cmp_lt_u32 s3, 2
    s_cselect_b32 s38, s38, s36
    v_lshlrev_b32 v65, 7, v65
    v_mfma_f32_16x16x32_bf16 v[200:203], a[188:191], a[52:55], v[200:203]
    s_addk_i32 m0, 24576
    ds_read_b64_tr_b16 a[212:213], v11 offset:12288
    v_lshrrev_b32 v67, 4, v1
    v_mfma_f32_16x16x32_bf16 v[200:203], a[184:187], a[36:39], v[200:203]
    s_add_u32 s77, s7, 4
    ds_read_b64_tr_b16 a[214:215], v11 offset:14336
    v_lshl_add_u32 v65, v67, 4, v65
    v_mfma_f32_16x16x32_bf16 v[208:211], a[184:187], a[40:43], v[208:211]
    buffer_load_dwordx4 a[20:23], v14, s[20:23], s37 offen offset:1024 sc1
    v_mfma_f32_16x16x32_bf16 v[208:211], a[188:191], a[56:59], v[208:211]
    v_rcp_f32 v60, v60
    v_mfma_f32_16x16x32_bf16 v[216:219], a[188:191], a[60:63], v[216:219]
    buffer_load_dwordx4 v7, s[8:11], s38 offen lds
    v_mfma_f32_16x16x32_bf16 v[216:219], a[184:187], a[44:47], v[216:219]
    v_rcp_f32 v61, v61
    v_mfma_f32_16x16x32_bf16 v[220:223], a[192:195], a[44:47], v[220:223]
    v_mul_f32 v56, v56, v60
    v_cvt_pk_bf16_f32 v56, 0, v56
    v_mfma_f32_16x16x32_bf16 v[220:223], a[196:199], a[60:63], v[220:223]
    s_waitcnt lgkmcnt(0)
    v_mul_f32 v56, v56, v58
    v_mul_f32 v57, v57, v61
    v_mfma_f32_16x16x32_bf16 v[212:215], a[196:199], a[56:59], v[212:215]
    s_barrier
    v_mfma_f32_16x16x32_bf16 v[212:215], a[192:195], a[40:43], v[212:215]
    s_add_u32 s38, s46, 40960
    ds_read_b64_tr_b16 a[184:185], v12 offset:20480
    v_cvt_pk_bf16_f32 v57, 0, v57
    v_mfma_f32_16x16x32_bf16 v[204:207], a[192:195], a[36:39], v[204:207]
    buffer_load_dwordx4 a[24:27], v14, s[20:23], s37 offen offset:2048 sc1
    v_mfma_f32_16x16x32_bf16 v[204:207], a[196:199], a[52:55], v[204:207]
    s_addk_i32 m0, -16384
    ds_read_b64_tr_b16 a[186:187], v12 offset:21504
    v_mul_f32 v57, v57, v59
    v_mfma_f32_16x16x32_bf16 v[196:199], a[196:199], a[48:51], v[196:199]
    ds_read_b64_tr_b16 a[188:189], v12 offset:22528
    v_cvt_pk_bf16_f32 v56, v56, v57
    v_mfma_f32_16x16x32_bf16 v[196:199], a[192:195], a[32:35], v[196:199]
    ds_write_b16 v64, v56
    v_mfma_f32_16x16x32_bf16 v[224:227], a[200:203], a[32:35], v[224:227]
    ds_write_b16_d16_hi v64, v56 offset:128
    v_mfma_f32_16x16x32_bf16 v[224:227], a[204:207], a[48:51], v[224:227]
    ds_read_b64_tr_b16 a[190:191], v12 offset:23552
    v_add_u32 v65, s56, v65
    v_mfma_f32_16x16x32_bf16 v[232:235], a[204:207], a[52:55], v[232:235]
    buffer_load_dwordx4 v2, s[8:11], s38 offen lds
    v_mfma_f32_16x16x32_bf16 v[232:235], a[200:203], a[36:39], v[232:235]
    ds_read_b128 v[68:71], v65
    v_bfe_u32 v67, v1, 2, 3
    v_mfma_f32_16x16x32_bf16 v[240:243], a[200:203], a[40:43], v[240:243]
    ds_read_b128 v[72:75], v65 offset:64
    v_lshlrev_b32 v66, 7, v67
    v_mfma_f32_16x16x32_bf16 v[240:243], a[204:207], a[56:59], v[240:243]
    ds_read_b64_tr_b16 a[192:193], v13 offset:20480
    v_lshrrev_b32 v67, 1, v67
    v_mfma_f32_16x16x32_bf16 v[248:251], a[204:207], a[60:63], v[248:251]
    buffer_load_dwordx4 a[28:31], v14, s[20:23], s37 offen offset:3072 sc1
    v_mfma_f32_16x16x32_bf16 v[248:251], a[200:203], a[44:47], v[248:251]
    s_add_u32 s38, s46, 40960
    ds_read_b64_tr_b16 a[194:195], v13 offset:21504
    v_xor_b32 v67, s3, v67
    v_mfma_f32_16x16x32_bf16 v[252:255], a[208:211], a[44:47], v[252:255]
    s_addk_i32 m0, 4096
    ds_read_b64_tr_b16 a[196:197], v13 offset:22528
    v_lshl_add_u32 v66, v67, 5, v66
    v_mfma_f32_16x16x32_bf16 v[252:255], a[212:215], a[60:63], v[252:255]
    s_waitcnt lgkmcnt(5)
    ds_read_b64_tr_b16 a[198:199], v13 offset:23552
    v_and_b32 v67, 3, v1
    v_mfma_f32_16x16x32_bf16 v[244:247], a[212:215], a[56:59], v[244:247]
    s_sub_u32 s78, s72, s77
    ds_read_b64_tr_b16 a[200:201], v8 offset:20480
    v_lshl_add_u32 v66, v67, 3, v66
    v_mfma_f32_16x16x32_bf16 v[244:247], a[208:211], a[40:43], v[244:247]
    s_sub_u32 s79, s73, s77
    ds_read_b64_tr_b16 a[202:203], v8 offset:22528
    v_lshrrev_b32 v67, 5, v1
    v_mfma_f32_16x16x32_bf16 v[236:239], a[208:211], a[36:39], v[236:239]
    s_max_u32 s78, s78, s79
    ds_read_b64_tr_b16 a[204:205], v8 offset:28672
    v_mul_u32_u24 v67, 1024, v67
    v_mfma_f32_16x16x32_bf16 v[236:239], a[212:215], a[52:55], v[236:239]
    s_sub_u32 s79, s74, s77
    ds_read_b64_tr_b16 a[206:207], v8 offset:30720
    v_add_u32 v66, v66, v67
    v_mfma_f32_16x16x32_bf16 v[228:231], a[212:215], a[48:51], v[228:231]
    buffer_load_dwordx4 v3, s[8:11], s38 offen lds
    v_mfma_f32_16x16x32_bf16 v[228:231], a[208:211], a[32:35], v[228:231]
    s_max_u32 s78, s78, s79
    ds_read_b64_tr_b16 a[208:209], v9 offset:20480
    v_add_u32 v66, 114688, v66
    v_mfma_f32_16x16x32_bf16 v[96:99], a[184:187], a[64:67], v[96:99]
    s_waitcnt lgkmcnt(5)
    ds_read_b64_tr_b16 a[210:211], v9 offset:22528
    v_lshlrev_b32 v62, 2, v1
    v_mfma_f32_16x16x32_bf16 v[96:99], a[188:191], a[216:219], v[96:99]
    s_sub_u32 s79, s75, s77
    ds_read_b64_tr_b16 a[212:213], v9 offset:28672
    v_mov_b32 v67, 0x7ffffff0
    v_mfma_f32_16x16x32_bf16 v[104:107], a[188:191], a[220:223], v[104:107]
    s_max_u32 s78, s78, s79
    ds_read_b64_tr_b16 a[214:215], v9 offset:30720
    v_cndmask_b32 v62, v67, v62, vcc
    v_mfma_f32_16x16x32_bf16 v[104:107], a[184:187], a[68:71], v[104:107]
    s_cmp_gt_u32 s78, 2
    s_cbranch_scc1 spin_o3
spin_o3_ret:
    s_load_dwordx4 s[72:75], s[86:87], s5 glc
    v_mfma_f32_16x16x32_bf16 v[112:115], a[184:187], a[72:75], v[112:115]
    s_add_u32 s37, s59, 12288
    s_add_u32 s38, s47, 40960
    s_add_u32 m0, s63, 102400
    v_mfma_f32_16x16x32_bf16 v[112:115], a[188:191], a[224:227], v[112:115]
    buffer_load_dwordx4 a[32:35], v14, s[20:23], s37 offen offset:0 sc1
    v_mfma_f32_16x16x32_bf16 v[120:123], a[188:191], a[228:231], v[120:123]
    v_mfma_f32_16x16x32_bf16 v[120:123], a[184:187], a[76:79], v[120:123]
    ds_read_b64_tr_b16 a[184:185], v10 offset:20480
    v_mfma_f32_16x16x32_bf16 v[124:127], a[192:195], a[76:79], v[124:127]
    ds_read_b64_tr_b16 a[186:187], v10 offset:22528
    v_mfma_f32_16x16x32_bf16 v[124:127], a[196:199], a[228:231], v[124:127]
    ds_read_b64_tr_b16 a[188:189], v10 offset:28672
    v_mfma_f32_16x16x32_bf16 v[116:119], a[196:199], a[224:227], v[116:119]
    s_waitcnt lgkmcnt(5)
    ds_read_b64_tr_b16 a[190:191], v10 offset:30720
    v_mfma_f32_16x16x32_bf16 v[116:119], a[192:195], a[72:75], v[116:119]
    buffer_load_dwordx4 a[36:39], v14, s[20:23], s37 offen offset:1024 sc1
    v_mfma_f32_16x16x32_bf16 v[108:111], a[192:195], a[68:71], v[108:111]
    buffer_load_dwordx4 v2, s[8:11], s38 offen lds
    v_mfma_f32_16x16x32_bf16 v[108:111], a[196:199], a[220:223], v[108:111]
    v_mfma_f32_16x16x32_bf16 v[100:103], a[196:199], a[216:219], v[100:103]
    s_add_u32 s38, s47, 40960
    v_mfma_f32_16x16x32_bf16 v[100:103], a[192:195], a[64:67], v[100:103]
    ds_read_b64_tr_b16 a[192:193], v11 offset:20480
    v_mfma_f32_16x16x32_bf16 v[128:131], a[200:203], a[64:67], v[128:131]
    s_addk_i32 m0, 4096
    ds_read_b64_tr_b16 a[194:195], v11 offset:22528
    v_mfma_f32_16x16x32_bf16 v[128:131], a[204:207], a[216:219], v[128:131]
    ds_read_b64_tr_b16 a[196:197], v11 offset:28672
    v_mfma_f32_16x16x32_bf16 v[136:139], a[204:207], a[220:223], v[136:139]
    ds_read_b64_tr_b16 a[198:199], v11 offset:30720
    v_mfma_f32_16x16x32_bf16 v[136:139], a[200:203], a[68:71], v[136:139]
    v_mfma_f32_16x16x32_bf16 v[144:147], a[200:203], a[72:75], v[144:147]
    buffer_load_dwordx4 a[40:43], v14, s[20:23], s37 offen offset:2048 sc1
    v_mfma_f32_16x16x32_bf16 v[144:147], a[204:207], a[224:227], v[144:147]
    v_mfma_f32_16x16x32_bf16 v[152:155], a[204:207], a[228:231], v[152:155]
    buffer_load_dwordx4 v3, s[8:11], s38 offen lds
    v_mfma_f32_16x16x32_bf16 v[152:155], a[200:203], a[76:79], v[152:155]
    s_waitcnt lgkmcnt(4)
    ds_read_b64_tr_b16 a[200:201], v8 offset:24576
    v_mfma_f32_16x16x32_bf16 v[156:159], a[208:211], a[76:79], v[156:159]
    ds_read_b64_tr_b16 a[202:203], v8 offset:26624
    v_mfma_f32_16x16x32_bf16 v[156:159], a[212:215], a[228:231], v[156:159]
    ds_read_b64_tr_b16 a[204:205], v8 offset:32768
    v_mfma_f32_16x16x32_bf16 v[148:151], a[212:215], a[224:227], v[148:151]
    s_add_u32 s38, s45, 81920
    ds_read_b64_tr_b16 a[206:207], v8 offset:34816
    s_add_u32 s36, s46, 81920
    v_mfma_f32_16x16x32_bf16 v[148:151], a[208:211], a[72:75], v[148:151]
    s_cmp_lt_u32 s3, 2
    s_cselect_b32 s38, s38, s36
    v_mfma_f32_16x16x32_bf16 v[140:143], a[208:211], a[68:71], v[140:143]
    s_add_u32 m0, s63, 139264
    v_mfma_f32_16x16x32_bf16 v[140:143], a[212:215], a[220:223], v[140:143]
    v_mfma_f32_16x16x32_bf16 v[132:135], a[212:215], a[216:219], v[132:135]
    buffer_load_dwordx4 a[44:47], v14, s[20:23], s37 offen offset:3072 sc1
    v_mfma_f32_16x16x32_bf16 v[132:135], a[208:211], a[64:67], v[132:135]
    ds_read_b64_tr_b16 a[208:209], v9 offset:24576
    v_mfma_f32_16x16x32_bf16 v[160:163], a[184:187], a[64:67], v[160:163]
    ds_read_b64_tr_b16 a[210:211], v9 offset:26624
    v_mfma_f32_16x16x32_bf16 v[160:163], a[188:191], a[216:219], v[160:163]
    ds_read_b64_tr_b16 a[212:213], v9 offset:32768
    v_mfma_f32_16x16x32_bf16 v[168:171], a[188:191], a[220:223], v[168:171]
    s_waitcnt lgkmcnt(5)
    ds_read_b64_tr_b16 a[214:215], v9 offset:34816
    s_add_u32 s37, s60, 12288
    v_mfma_f32_16x16x32_bf16 v[168:171], a[184:187], a[68:71], v[168:171]
    buffer_load_dwordx4 v7, s[8:11], s38 offen lds
    v_mfma_f32_16x16x32_bf16 v[176:179], a[184:187], a[72:75], v[176:179]
    v_mfma_f32_16x16x32_bf16 v[176:179], a[188:191], a[224:227], v[176:179]
    v_mfma_f32_16x16x32_bf16 v[184:187], a[188:191], a[228:231], v[184:187]
    v_mfma_f32_16x16x32_bf16 v[184:187], a[184:187], a[76:79], v[184:187]
    ds_read_b64_tr_b16 a[184:185], v10 offset:24576
    v_mfma_f32_16x16x32_bf16 v[188:191], a[192:195], a[76:79], v[188:191]
    buffer_load_dwordx4 a[48:51], v14, s[20:23], s37 offen offset:0 sc1
    v_mfma_f32_16x16x32_bf16 v[188:191], a[196:199], a[228:231], v[188:191]
    s_mov_b32 s16, s84
    ds_read_b64_tr_b16 a[186:187], v10 offset:26624
    v_and_b32 v5, 15, v1
    v_mfma_f32_16x16x32_bf16 v[180:183], a[196:199], a[224:227], v[180:183]
    s_and_b32 s17, s85, 0xffff
    ds_read_b64_tr_b16 a[188:189], v10 offset:32768
    v_add_u32 v5, s6, v5
    v_mfma_f32_16x16x32_bf16 v[180:183], a[192:195], a[72:75], v[180:183]
    s_mov_b32 s18, 2621440
    ds_read_b64_tr_b16 a[190:191], v10 offset:34816
    v_bfe_u32 v50, v1, 4, 1
    v_mfma_f32_16x16x32_bf16 v[172:175], a[192:195], a[68:71], v[172:175]
    s_mov_b32 s19, 0x00020000
    v_bfe_u32 v51, v1, 5, 1
    v_lshl_add_u32 v50, v50, 1, v51
    v_mfma_f32_16x16x32_bf16 v[172:175], a[196:199], a[220:223], v[172:175]
    s_and_b32 s56, s53, 4
    v_mul_u32_u24 v4, 1280, v5
    v_lshl_add_u32 v4, v50, 4, v4
    v_mfma_f32_16x16x32_bf16 v[164:167], a[196:199], a[216:219], v[164:167]
    s_waitcnt lgkmcnt(5)
    v_xor_b32 v51, 16, v5
    v_mul_u32_u24 v35, 1280, v51
    v_mfma_f32_16x16x32_bf16 v[164:167], a[192:195], a[64:67], v[164:167]
    s_add_u32 s38, s47, 81920
    ds_read_b64_tr_b16 a[192:193], v11 offset:24576
    v_lshl_add_u32 v34, v50, 4, v35
    v_mfma_f32_16x16x32_bf16 v[192:195], a[200:203], a[64:67], v[192:195]
    s_add_u32 s36, s45, 122880
    ds_read_b64_tr_b16 a[194:195], v11 offset:26624
    v_and_b32 v51, 0xfffffff7, v51
    v_mfma_f32_16x16x32_bf16 v[192:195], a[204:207], a[216:219], v[192:195]
    s_cmp_lt_u32 s3, 2
    s_cselect_b32 s38, s38, s36
    v_lshrrev_b32 v50, 4, v1
    v_mfma_f32_16x16x32_bf16 v[200:203], a[204:207], a[220:223], v[200:203]
    s_addk_i32 m0, 4096
    ds_read_b64_tr_b16 a[196:197], v11 offset:32768
    s_lshl_b32 s56, s56, 1
    v_mfma_f32_16x16x32_bf16 v[200:203], a[200:203], a[68:71], v[200:203]
    ds_read_b64_tr_b16 a[198:199], v11 offset:34816
    v_or_b32 v37, s56, v51
    v_mfma_f32_16x16x32_bf16 v[208:211], a[200:203], a[72:75], v[208:211]
    buffer_load_dwordx4 a[52:55], v14, s[20:23], s37 offen offset:1024 sc1
    v_mfma_f32_16x16x32_bf16 v[208:211], a[204:207], a[224:227], v[208:211]
    s_xor_b32 s56, s56, 8
    v_mul_u32_u24 v35, 1280, v37
    v_lshl_add_u32 v35, v50, 3, v35
    v_mfma_f32_16x16x32_bf16 v[216:219], a[204:207], a[228:231], v[216:219]
    buffer_load_dwordx4 v7, s[8:11], s38 offen lds
    v_mfma_f32_16x16x32_bf16 v[216:219], a[200:203], a[76:79], v[216:219]
    s_waitcnt lgkmcnt(2)
    v_xor_b32 v50, s56, v1
    v_and_b32 v50, 8, v50
    v_mfma_f32_16x16x32_bf16 v[220:223], a[208:211], a[76:79], v[220:223]
    v_lshl_add_u32 v35, v50, 2, v35
    v_lshlrev_b32 v52, 3, v37
    v_mfma_f32_16x16x32_bf16 v[220:223], a[212:215], a[228:231], v[220:223]
    s_waitcnt vmcnt(27) lgkmcnt(0)
    v_add_u32 v52, 3211264, v52
    v_lshlrev_b32 v50, 3, v5
    v_mfma_f32_16x16x32_bf16 v[212:215], a[212:215], a[224:227], v[212:215]
    s_barrier
    v_mfma_f32_16x16x32_bf16 v[212:215], a[208:211], a[72:75], v[212:215]
    ds_read_b64_tr_b16 a[200:201], v12 offset:40960
    v_add_u32 v50, 3211264, v50
    v_mfma_f32_16x16x32_bf16 v[204:207], a[208:211], a[68:71], v[204:207]
    buffer_load_dwordx4 a[56:59], v14, s[20:23], s37 offen offset:2048 sc1
    v_mfma_f32_16x16x32_bf16 v[204:207], a[212:215], a[220:223], v[204:207]
    ds_read_b64_tr_b16 a[202:203], v12 offset:41984
    v_xor_b32 v51, 128, v50
    v_mfma_f32_16x16x32_bf16 v[196:199], a[212:215], a[216:219], v[196:199]
    ds_read_b64_tr_b16 a[204:205], v12 offset:43008
    v_mfma_f32_16x16x32_bf16 v[196:199], a[208:211], a[64:67], v[196:199]
    ds_read_b64_tr_b16 a[206:207], v12 offset:44032
    v_add_u32 v12, 73728, v12
    v_mfma_f32_16x16x32_bf16 v[224:227], a[184:187], a[64:67], v[224:227]
    ds_read_b64_tr_b16 a[208:209], v13 offset:40960
    v_mfma_f32_16x16x32_bf16 v[224:227], a[188:191], a[216:219], v[224:227]
    ds_read_b64_tr_b16 a[210:211], v13 offset:41984
    v_mfma_f32_16x16x32_bf16 v[232:235], a[188:191], a[220:223], v[232:235]
    s_add_u32 s38, s46, 122880
    ds_read_b64_tr_b16 a[212:213], v13 offset:43008
    s_add_u32 s36, s47, 122880
    v_mfma_f32_16x16x32_bf16 v[232:235], a[184:187], a[68:71], v[232:235]
    s_cmp_lt_u32 s3, 2
    s_cselect_b32 s38, s38, s36
    v_mfma_f32_16x16x32_bf16 v[240:243], a[184:187], a[72:75], v[240:243]
    s_addk_i32 m0, 4096
    ds_read_b64_tr_b16 a[214:215], v13 offset:44032
    v_add_u32 v13, 73728, v13
    v_mfma_f32_16x16x32_bf16 v[240:243], a[188:191], a[224:227], v[240:243]
    v_mfma_f32_16x16x32_bf16 v[248:251], a[188:191], a[228:231], v[248:251]
    buffer_load_dwordx4 a[60:63], v14, s[20:23], s37 offen offset:3072 sc1
    v_mfma_f32_16x16x32_bf16 v[248:251], a[184:187], a[76:79], v[248:251]
    ds_read_b64_tr_b16 a[184:185], v8 offset:40960
    v_mfma_f32_16x16x32_bf16 v[252:255], a[192:195], a[76:79], v[252:255]
    ds_read_b64_tr_b16 a[186:187], v8 offset:43008
    v_mfma_f32_16x16x32_bf16 v[252:255], a[196:199], a[228:231], v[252:255]
    ds_read_b64_tr_b16 a[188:189], v8 offset:49152
    v_mfma_f32_16x16x32_bf16 v[244:247], a[196:199], a[224:227], v[244:247]
    s_waitcnt lgkmcnt(4)
    ds_read_b64_tr_b16 a[190:191], v8 offset:51200
    s_add_u32 s37, s61, 12288
    v_mfma_f32_16x16x32_bf16 v[244:247], a[192:195], a[72:75], v[244:247]
    buffer_load_dwordx4 v7, s[8:11], s38 offen lds
    v_mfma_f32_16x16x32_bf16 v[236:239], a[192:195], a[68:71], v[236:239]
    v_mfma_f32_16x16x32_bf16 v[236:239], a[196:199], a[220:223], v[236:239]
    v_mfma_f32_16x16x32_bf16 v[228:231], a[196:199], a[216:219], v[228:231]
    v_mfma_f32_16x16x32_bf16 v[228:231], a[192:195], a[64:67], v[228:231]
    ds_read_b64_tr_b16 a[192:193], v9 offset:40960
    v_mfma_f32_16x16x32_bf16 v[96:99], a[200:203], a[232:235], v[96:99]
    buffer_load_dwordx4 a[64:67], v14, s[20:23], s37 offen offset:0 sc1
    v_mfma_f32_16x16x32_bf16 v[96:99], a[204:207], a[152:155], v[96:99]
    buffer_load_dwordx2 v[16:17], v50, s[24:27], 0 offen sc1
    v_mfma_f32_16x16x32_bf16 v[104:107], a[204:207], a[156:159], v[104:107]
    ds_read_b64_tr_b16 a[194:195], v9 offset:43008
    v_mfma_f32_16x16x32_bf16 v[104:107], a[200:203], a[236:239], v[104:107]
    ds_read_b64_tr_b16 a[196:197], v9 offset:49152
    v_mfma_f32_16x16x32_bf16 v[112:115], a[200:203], a[240:243], v[112:115]
    ds_read_b64_tr_b16 a[198:199], v9 offset:51200
    v_mfma_f32_16x16x32_bf16 v[112:115], a[204:207], a[160:163], v[112:115]
    ds_read_b64_tr_b16 v[76:77], v66 offset:0
    v_mfma_f32_16x16x32_bf16 v[120:123], a[204:207], a[164:167], v[120:123]
    s_waitcnt lgkmcnt(4)
    ds_read_b64_tr_b16 v[78:79], v66 offset:2048
    s_add_u32 s38, s45, 163840
    v_mfma_f32_16x16x32_bf16 v[120:123], a[200:203], a[244:247], v[120:123]
    s_add_u32 s36, s46, 163840
    ds_read_b64_tr_b16 v[80:81], v66 offset:4096
    v_mfma_f32_16x16x32_bf16 v[124:127], a[208:211], a[244:247], v[124:127]
    s_cmp_lt_u32 s3, 2
    s_cselect_b32 s38, s38, s36
    s_addk_i32 m0, 4096
    v_mfma_f32_16x16x32_bf16 v[124:127], a[212:215], a[164:167], v[124:127]
    ds_read_b64_tr_b16 v[82:83], v66 offset:6144
    v_mfma_f32_16x16x32_bf16 v[116:119], a[212:215], a[160:163], v[116:119]
    buffer_load_dwordx4 a[68:71], v14, s[20:23], s37 offen offset:1024 sc1
    v_mfma_f32_16x16x32_bf16 v[116:119], a[208:211], a[240:243], v[116:119]
    s_add_u32 s77, s7, 5
    ds_read_b64_tr_b16 a[200:201], v10 offset:40960
    v_mfma_f32_16x16x32_bf16 v[108:111], a[208:211], a[236:239], v[108:111]
    ds_read_b64_tr_b16 a[202:203], v10 offset:43008
    v_mfma_f32_16x16x32_bf16 v[108:111], a[212:215], a[156:159], v[108:111]
    ds_read_b64_tr_b16 a[204:205], v10 offset:49152
    v_mfma_f32_16x16x32_bf16 v[100:103], a[212:215], a[152:155], v[100:103]
    buffer_load_dwordx4 v7, s[8:11], s38 offen lds
    v_mfma_f32_16x16x32_bf16 v[100:103], a[208:211], a[232:235], v[100:103]
    buffer_load_dwordx2 v[18:19], v51, s[24:27], 0 offen sc1
    v_mfma_f32_16x16x32_bf16 v[128:131], a[184:187], a[232:235], v[128:131]
    ds_read_b64_tr_b16 a[206:207], v10 offset:51200
    v_mfma_f32_16x16x32_bf16 v[128:131], a[188:191], a[152:155], v[128:131]
    s_waitcnt lgkmcnt(4)
    ds_read_b64_tr_b16 a[208:209], v11 offset:40960
    v_mfma_f32_16x16x32_bf16 v[136:139], a[188:191], a[156:159], v[136:139]
    ds_read_b64_tr_b16 a[210:211], v11 offset:43008
    v_mfma_f32_16x16x32_bf16 v[136:139], a[184:187], a[236:239], v[136:139]
    ds_read_b64_tr_b16 a[212:213], v11 offset:49152
    v_mfma_f32_16x16x32_bf16 v[144:147], a[184:187], a[240:243], v[144:147]
    buffer_load_dwordx4 a[72:75], v14, s[20:23], s37 offen offset:2048 sc1
    v_mfma_f32_16x16x32_bf16 v[144:147], a[188:191], a[160:163], v[144:147]
    ds_read_b64_tr_b16 a[214:215], v11 offset:51200
    v_mfma_f32_16x16x32_bf16 v[152:155], a[188:191], a[164:167], v[152:155]
    v_mfma_f32_16x16x32_bf16 v[152:155], a[184:187], a[244:247], v[152:155]
    ds_read_b64_tr_b16 a[184:185], v8 offset:45056
    v_mfma_f32_16x16x32_bf16 v[156:159], a[192:195], a[244:247], v[156:159]
    ds_read_b64_tr_b16 a[186:187], v8 offset:47104
    v_mfma_f32_16x16x32_bf16 v[156:159], a[196:199], a[164:167], v[156:159]
    ds_read_b64_tr_b16 a[188:189], v8 offset:53248
    v_mfma_f32_16x16x32_bf16 v[148:151], a[196:199], a[160:163], v[148:151]
    s_waitcnt lgkmcnt(4)
    ds_read_b64_tr_b16 a[190:191], v8 offset:55296
    v_add_u32 v8, 73728, v8
    v_mfma_f32_16x16x32_bf16 v[148:151], a[192:195], a[240:243], v[148:151]
    s_add_u32 s38, s47, 163840
    s_add_u32 s36, s45, 204800
    v_mfma_f32_16x16x32_bf16 v[140:143], a[192:195], a[236:239], v[140:143]
    buffer_load_dwordx2 v[38:39], v52, s[24:27], 0 offen sc1
    v_mfma_f32_16x16x32_bf16 v[140:143], a[196:199], a[156:159], v[140:143]
    s_cmp_lt_u32 s3, 2
    s_cselect_b32 s38, s38, s36
    s_addk_i32 m0, 4096
    v_mfma_f32_16x16x32_bf16 v[132:135], a[196:199], a[152:155], v[132:135]
    buffer_load_dwordx4 a[76:79], v14, s[20:23], s37 offen offset:3072 sc1
    v_mfma_f32_16x16x32_bf16 v[132:135], a[192:195], a[232:235], v[132:135]
    s_sub_u32 s78, s72, s77
    ds_read_b64_tr_b16 a[192:193], v9 offset:45056
    s_sub_u32 s79, s73, s77
    v_mfma_f32_16x16x32_bf16 v[84:87], v[68:71], v[76:79], 0
    s_max_u32 s78, s78, s79
    ds_read_b64_tr_b16 a[194:195], v9 offset:47104
    s_sub_u32 s79, s74, s77
    v_mfma_f32_16x16x32_bf16 v[84:87], v[72:75], v[80:83], v[84:87]
    s_max_u32 s78, s78, s79
    ds_read_b64_tr_b16 a[196:197], v9 offset:53248
    s_sub_u32 s79, s75, s77
    v_mfma_f32_16x16x32_bf16 v[160:163], a[200:203], a[232:235], v[160:163]
    buffer_load_dwordx4 v7, s[8:11], s38 offen lds
    v_mfma_f32_16x16x32_bf16 v[160:163], a[204:207], a[152:155], v[160:163]
    s_max_u32 s78, s78, s79
    ds_read_b64_tr_b16 a[198:199], v9 offset:55296
    v_add_u32 v9, 73728, v9
    v_mfma_f32_16x16x32_bf16 v[168:171], a[204:207], a[156:159], v[168:171]
    buffer_store_dword v84, v62, s[24:27], s62 offen sc1
    v_mfma_f32_16x16x32_bf16 v[168:171], a[200:203], a[236:239], v[168:171]
    buffer_store_dword v85, v62, s[24:27], s62 offen offset:2560 sc1
    v_mfma_f32_16x16x32_bf16 v[176:179], a[200:203], a[240:243], v[176:179]
    s_cmp_gt_u32 s78, 1
    s_cbranch_scc1 spin_o4
spin_o4_ret:
    s_add_u32 s37, s59, 16384
    v_mfma_f32_16x16x32_bf16 v[176:179], a[204:207], a[160:163], v[176:179]
    v_mfma_f32_16x16x32_bf16 v[184:187], a[204:207], a[164:167], v[184:187]
    buffer_load_dwordx4 a[216:219], v14, s[20:23], s37 offen offset:0 sc1
    v_mfma_f32_16x16x32_bf16 v[184:187], a[200:203], a[244:247], v[184:187]
    s_waitcnt lgkmcnt(1)
    ds_read_b64_tr_b16 a[200:201], v10 offset:45056
    v_mfma_f32_16x16x32_bf16 v[188:191], a[208:211], a[244:247], v[188:191]
    buffer_load_dwordx2 v[32:33], v35, s[12:15], s68 offen
    v_mfma_f32_16x16x32_bf16 v[188:191], a[212:215], a[164:167], v[188:191]
    ds_read_b64_tr_b16 a[202:203], v10 offset:47104
    v_mfma_f32_16x16x32_bf16 v[180:183], a[212:215], a[160:163], v[180:183]
    ds_read_b64_tr_b16 a[204:205], v10 offset:53248
    v_mfma_f32_16x16x32_bf16 v[180:183], a[208:211], a[240:243], v[180:183]
    ds_read_b64_tr_b16 a[206:207], v10 offset:55296
    v_add_u32 v10, 73728, v10
    v_mfma_f32_16x16x32_bf16 v[172:175], a[208:211], a[236:239], v[172:175]
    s_add_u32 s38, s46, 204800
    s_add_u32 s36, s47, 204800
    v_mfma_f32_16x16x32_bf16 v[172:175], a[212:215], a[156:159], v[172:175]
    s_cmp_lt_u32 s3, 2
    s_cselect_b32 s38, s38, s36
    v_mfma_f32_16x16x32_bf16 v[164:167], a[212:215], a[152:155], v[164:167]
    s_addk_i32 m0, 4096
    v_mfma_f32_16x16x32_bf16 v[164:167], a[208:211], a[232:235], v[164:167]
    ds_read_b64_tr_b16 a[208:209], v11 offset:45056
    v_mfma_f32_16x16x32_bf16 v[192:195], a[184:187], a[232:235], v[192:195]
    buffer_load_dwordx4 a[220:223], v14, s[20:23], s37 offen offset:1024 sc1
    v_mfma_f32_16x16x32_bf16 v[192:195], a[188:191], a[152:155], v[192:195]
    ds_read_b64_tr_b16 a[210:211], v11 offset:47104
    v_mfma_f32_16x16x32_bf16 v[200:203], a[188:191], a[156:159], v[200:203]
    ds_read_b64_tr_b16 a[212:213], v11 offset:53248
    v_mfma_f32_16x16x32_bf16 v[200:203], a[184:187], a[236:239], v[200:203]
    ds_read_b64_tr_b16 a[214:215], v11 offset:55296
    v_add_u32 v11, 73728, v11
    v_mfma_f32_16x16x32_bf16 v[208:211], a[184:187], a[240:243], v[208:211]
    buffer_load_dwordx4 v7, s[8:11], s38 offen lds
    v_mfma_f32_16x16x32_bf16 v[208:211], a[188:191], a[160:163], v[208:211]
pg_13:
    s_cbranch_execz pg_back
    v_mfma_f32_16x16x32_bf16 v[216:219], a[188:191], a[164:167], v[216:219]
    buffer_load_dwordx4 v[24:27], v4, s[12:15], s64 offen
    v_mfma_f32_16x16x32_bf16 v[216:219], a[184:187], a[244:247], v[216:219]
    s_waitcnt lgkmcnt(3)
    v_mfma_f32_16x16x32_bf16 v[220:223], a[192:195], a[244:247], v[220:223]
    v_mfma_f32_16x16x32_bf16 v[220:223], a[196:199], a[164:167], v[220:223]
    s_waitcnt vmcnt(35) lgkmcnt(1)
    v_mfma_f32_16x16x32_bf16 v[212:215], a[196:199], a[160:163], v[212:215]
    s_barrier
    v_mfma_f32_16x16x32_bf16 v[212:215], a[192:195], a[240:243], v[212:215]
    buffer_load_dwordx4 a[224:227], v14, s[20:23], s37 offen offset:2048 sc1
    v_mfma_f32_16x16x32_bf16 v[204:207], a[192:195], a[236:239], v[204:207]
    ds_read_b64_tr_b16 a[184:185], v12 offset:0
    v_mfma_f32_16x16x32_bf16 v[204:207], a[196:199], a[156:159], v[204:207]
    ds_read_b64_tr_b16 a[186:187], v12 offset:1024
    v_mfma_f32_16x16x32_bf16 v[196:199], a[196:199], a[152:155], v[196:199]
    ds_read_b64_tr_b16 a[188:189], v12 offset:2048
    v_mfma_f32_16x16x32_bf16 v[196:199], a[192:195], a[232:235], v[196:199]
    ds_read_b64_tr_b16 a[190:191], v12 offset:3072
    v_mfma_f32_16x16x32_bf16 v[224:227], a[200:203], a[232:235], v[224:227]
    s_add_u32 s38, s45, 81920
    ds_read_b64_tr_b16 a[192:193], v13 offset:0
    v_mfma_f32_16x16x32_bf16 v[224:227], a[204:207], a[152:155], v[224:227]
    ds_read_b64_tr_b16 a[194:195], v13 offset:1024
    v_mfma_f32_16x16x32_bf16 v[232:235], a[204:207], a[156:159], v[232:235]
    s_add_u32 m0, s63, 0
    ds_read_b64_tr_b16 a[196:197], v13 offset:2048
    v_mfma_f32_16x16x32_bf16 v[232:235], a[200:203], a[236:239], v[232:235]
    ds_read_b64_tr_b16 a[198:199], v13 offset:3072
    v_mfma_f32_16x16x32_bf16 v[240:243], a[200:203], a[240:243], v[240:243]
    buffer_load_dwordx4 a[228:231], v14, s[20:23], s37 offen offset:3072 sc1
    v_mfma_f32_16x16x32_bf16 v[240:243], a[204:207], a[160:163], v[240:243]
    buffer_load_dwordx4 v[28:31], v34, s[12:15], s64 offen
    v_mfma_f32_16x16x32_bf16 v[248:251], a[204:207], a[164:167], v[248:251]
    s_waitcnt lgkmcnt(4)
    v_mfma_f32_16x16x32_bf16 v[248:251], a[200:203], a[244:247], v[248:251]
    ds_read_b64_tr_b16 a[200:201], v8 offset:0
    v_mfma_f32_16x16x32_bf16 v[252:255], a[208:211], a[244:247], v[252:255]
    buffer_load_dwordx4 v2, s[8:11], s38 offen lds
    v_mfma_f32_16x16x32_bf16 v[252:255], a[212:215], a[164:167], v[252:255]
    ds_read_b64_tr_b16 a[202:203], v8 offset:2048
    v_mfma_f32_16x16x32_bf16 v[244:247], a[212:215], a[160:163], v[244:247]
    s_add_u32 s37, s60, 16384
    ds_read_b64_tr_b16 a[204:205], v8 offset:8192
    v_mfma_f32_16x16x32_bf16 v[244:247], a[208:211], a[240:243], v[244:247]
    ds_read_b64_tr_b16 a[206:207], v8 offset:10240
    v_mfma_f32_16x16x32_bf16 v[236:239], a[208:211], a[236:239], v[236:239]
    v_mfma_f32_16x16x32_bf16 v[236:239], a[212:215], a[156:159], v[236:239]
    v_mfma_f32_16x16x32_bf16 v[228:231], a[212:215], a[152:155], v[228:231]
    s_add_u32 s38, s46, 81920
    v_mfma_f32_16x16x32_bf16 v[228:231], a[208:211], a[232:235], v[228:231]
    ds_read_b64_tr_b16 a[208:209], v9 offset:0
    v_mfma_f32_16x16x32_bf16 v[96:99], a[184:187], a[168:171], v[96:99]
    buffer_load_dwordx4 a[232:235], v14, s[20:23], s37 offen offset:0 sc1
    v_mfma_f32_16x16x32_bf16 v[96:99], a[188:191], a[80:83], v[96:99]
    s_addk_i32 m0, 4096
    ds_read_b64_tr_b16 a[210:211], v9 offset:2048
    v_mfma_f32_16x16x32_bf16 v[104:107], a[188:191], a[84:87], v[104:107]
    ds_read_b64_tr_b16 a[212:213], v9 offset:8192
    v_mfma_f32_16x16x32_bf16 v[104:107], a[184:187], a[172:175], v[104:107]
    s_waitcnt lgkmcnt(3)
    ds_read_b64_tr_b16 a[214:215], v9 offset:10240
    v_mfma_f32_16x16x32_bf16 v[112:115], a[184:187], a[176:179], v[112:115]
    v_mfma_f32_16x16x32_bf16 v[112:115], a[188:191], a[88:91], v[112:115]
    v_mfma_f32_16x16x32_bf16 v[120:123], a[188:191], a[92:95], v[120:123]
    buffer_load_dwordx4 v2, s[8:11], s38 offen lds
    v_mfma_f32_16x16x32_bf16 v[120:123], a[184:187], a[180:183], v[120:123]
    ds_read_b64_tr_b16 a[184:185], v10 offset:0
    v_mfma_f32_16x16x32_bf16 v[124:127], a[192:195], a[180:183], v[124:127]
    ds_read_b64_tr_b16 a[186:187], v10 offset:2048
    v_mfma_f32_16x16x32_bf16 v[124:127], a[196:199], a[92:95], v[124:127]
    ds_read_b64_tr_b16 a[188:189], v10 offset:8192
    v_mfma_f32_16x16x32_bf16 v[116:119], a[196:199], a[88:91], v[116:119]
    buffer_load_dwordx4 a[236:239], v14, s[20:23], s37 offen offset:1024 sc1
    v_mfma_f32_16x16x32_bf16 v[116:119], a[192:195], a[176:179], v[116:119]
    ds_read_b64_tr_b16 a[190:191], v10 offset:10240
    v_mfma_f32_16x16x32_bf16 v[108:111], a[192:195], a[172:175], v[108:111]
    s_add_u32 s38, s47, 81920
    v_mfma_f32_16x16x32_bf16 v[108:111], a[196:199], a[84:87], v[108:111]
    v_mfma_f32_16x16x32_bf16 v[100:103], a[196:199], a[80:83], v[100:103]
    s_addk_i32 m0, 4096
    v_mfma_f32_16x16x32_bf16 v[100:103], a[192:195], a[168:171], v[100:103]
    ds_read_b64_tr_b16 a[192:193], v11 offset:0
    v_mfma_f32_16x16x32_bf16 v[128:131], a[200:203], a[168:171], v[128:131]
    ds_read_b64_tr_b16 a[194:195], v11 offset:2048
    v_mfma_f32_16x16x32_bf16 v[128:131], a[204:207], a[80:83], v[128:131]
    ds_read_b64_tr_b16 a[196:197], v11 offset:8192
    v_mfma_f32_16x16x32_bf16 v[136:139], a[204:207], a[84:87], v[136:139]
    s_waitcnt lgkmcnt(3)
    ds_read_b64_tr_b16 a[198:199], v11 offset:10240
    v_lshrrev_b32 v65, 1, v1
    v_mfma_f32_16x16x32_bf16 v[136:139], a[200:203], a[172:175], v[136:139]
    s_and_b32 s39, s70, 0x7ff
    v_min_u32 v65, 23, v65
    v_mul_u32_u24 v65, 2560, v65
    v_mfma_f32_16x16x32_bf16 v[144:147], a[200:203], a[176:179], v[144:147]
    buffer_load_dwordx4 a[240:243], v14, s[20:23], s37 offen offset:2048 sc1
    v_mfma_f32_16x16x32_bf16 v[144:147], a[204:207], a[88:91], v[144:147]
    buffer_load_dwordx4 v2, s[8:11], s38 offen lds
    v_mfma_f32_16x16x32_bf16 v[152:155], a[204:207], a[92:95], v[152:155]
    s_sub_u32 s39, 2047, s39
    v_and_b32 v56, 1, v1
    v_lshl_add_u32 v65, v56, 2, v65
    v_mfma_f32_16x16x32_bf16 v[152:155], a[200:203], a[180:183], v[152:155]
    s_and_b32 s40, s71, 0x7ff
    ds_read_b64_tr_b16 a[200:201], v8 offset:4096
    v_cmp_lt_u32 vcc, 31, v1
    v_mfma_f32_16x16x32_bf16 v[156:159], a[208:211], a[180:183], v[156:159]
    s_load_dwordx4 s[72:75], s[86:87], s5 glc
    ds_read_b64_tr_b16 a[202:203], v8 offset:6144
    v_mov_b32 v54, s70
    v_mfma_f32_16x16x32_bf16 v[156:159], a[212:215], a[92:95], v[156:159]
    s_sub_u32 s40, 2047, s40
    ds_read_b64_tr_b16 a[204:205], v8 offset:12288
    v_mov_b32 v64, s71
    v_mfma_f32_16x16x32_bf16 v[148:151], a[212:215], a[88:91], v[148:151]
    s_add_u32 s38, s45, 122880
    ds_read_b64_tr_b16 a[206:207], v8 offset:14336
    v_cndmask_b32 v54, v54, v64, vcc
    v_mfma_f32_16x16x32_bf16 v[148:151], a[208:211], a[176:179], v[148:151]
    s_xor_b32 s56, s39, s6
    v_bfe_i32 v56, v1, 3, 1
    v_and_b32 v57, 7, v1
    v_mfma_f32_16x16x32_bf16 v[140:143], a[208:211], a[172:175], v[140:143]
    s_add_u32 m0, s63, 12288
    s_xor_b32 s57, s40, s6
    s_min_u32 s56, s56, s57
    v_mfma_f32_16x16x32_bf16 v[140:143], a[212:215], a[84:87], v[140:143]
    s_cmp_lt_u32 s56, 32
    s_cselect_b32 s43, 0, 0x70000000
    s_cselect_b32 s58, s7, 0
    v_mfma_f32_16x16x32_bf16 v[132:135], a[212:215], a[80:83], v[132:135]
    buffer_load_dwordx4 a[244:247], v14, s[20:23], s37 offen offset:3072 sc1
    v_mfma_f32_16x16x32_bf16 v[132:135], a[208:211], a[168:171], v[132:135]
    s_lshr_b32 s41, s64, 7
    ds_read_b64_tr_b16 a[208:209], v9 offset:4096
    v_or_b32 v65, s43, v65
    v_mfma_f32_16x16x32_bf16 v[160:163], a[184:187], a[168:171], v[160:163]
    s_lshl_b32 s41, s41, 8
    ds_read_b64_tr_b16 a[210:211], v9 offset:6144
    s_bfe_u32 s56, s64, 0x10006
    v_mfma_f32_16x16x32_bf16 v[160:163], a[188:191], a[80:83], v[160:163]
    s_lshl3_add_u32 s41, s56, s41
    ds_read_b64_tr_b16 a[212:213], v9 offset:12288
    s_add_u32 s41, s41, 3932320
    v_mfma_f32_16x16x32_bf16 v[168:171], a[188:191], a[84:87], v[168:171]
    s_waitcnt lgkmcnt(5)
    ds_read_b64_tr_b16 a[214:215], v9 offset:14336
    s_add_u32 s37, s61, 16384
    v_mfma_f32_16x16x32_bf16 v[168:171], a[184:187], a[172:175], v[168:171]
    buffer_load_dwordx4 v2, s[8:11], s38 offen lds
    v_mfma_f32_16x16x32_bf16 v[176:179], a[184:187], a[176:179], v[176:179]
    s_waitcnt vmcnt(16)
    s_lshr_b32 s42, s68, 7
    s_lshl_b32 s42, s42, 8
    v_mfma_f32_16x16x32_bf16 v[176:179], a[188:191], a[88:91], v[176:179]
    buffer_store_dword v6, v15, s[24:27], s4 offen offset:160 sc1
    v_mfma_f32_16x16x32_bf16 v[184:187], a[188:191], a[92:95], v[184:187]
    s_bfe_u32 s56, s68, 0x10006
    s_lshl3_add_u32 s42, s56, s42
    s_add_u32 s42, s42, 3932320
    v_mfma_f32_16x16x32_bf16 v[184:187], a[184:187], a[180:183], v[184:187]
    s_sub_u32 s56, s68, s64
    ds_read_b64_tr_b16 a[184:185], v10 offset:4096
    v_and_b32 v56, s56, v56
    v_mfma_f32_16x16x32_bf16 v[188:191], a[192:195], a[180:183], v[188:191]
    buffer_load_dwordx4 a[152:155], v14, s[20:23], s37 offen offset:0 sc1
    v_mfma_f32_16x16x32_bf16 v[188:191], a[196:199], a[92:95], v[188:191]
    s_add_u32 s38, s46, 122880
    ds_read_b64_tr_b16 a[186:187], v10 offset:6144
    v_lshl_add_u32 v64, v57, 3, v56
    v_mfma_f32_16x16x32_bf16 v[180:183], a[196:199], a[88:91], v[180:183]
    s_addk_i32 m0, 4096
    ds_read_b64_tr_b16 a[188:189], v10 offset:12288
    v_add_u32 v55, s64, v64
    v_mfma_f32_16x16x32_bf16 v[180:183], a[192:195], a[176:179], v[180:183]
    s_or_b32 s57, s64, s43
    ds_read_b64_tr_b16 a[190:191], v10 offset:14336
    v_add_u32 v64, s57, v64
    v_mfma_f32_16x16x32_bf16 v[172:175], a[192:195], a[172:175], v[172:175]
    s_add_u32 s55, s43, 3670016
    v_lshrrev_b32 v56, 5, v1
    v_bfe_u32 v57, v1, 4, 1
    v_mfma_f32_16x16x32_bf16 v[172:175], a[196:199], a[84:87], v[172:175]
    s_add_u32 s56, s43, 3211264
    v_lshl_add_u32 v56, v57, 1, v56
    v_mul_u32_u24 v56, 2560, v56
    v_mfma_f32_16x16x32_bf16 v[164:167], a[196:199], a[80:83], v[164:167]
    s_waitcnt lgkmcnt(5)
    v_lshl_add_u32 v55, v55, 1, v56
    v_and_b32 v56, 0x7ff, v54
    v_mfma_f32_16x16x32_bf16 v[164:167], a[192:195], a[168:171], v[164:167]
    ds_read_b64_tr_b16 a[192:193], v11 offset:4096
    v_sub_u32 v56, 2047, v56
    v_mfma_f32_16x16x32_bf16 v[192:195], a[200:203], a[168:171], v[192:195]
    buffer_load_dwordx4 v2, s[8:11], s38 offen lds
    v_mfma_f32_16x16x32_bf16 v[192:195], a[204:207], a[80:83], v[192:195]
    ds_read_b64_tr_b16 a[194:195], v11 offset:6144
    v_mul_u32_u24 v57, 1280, v56
    v_mfma_f32_16x16x32_bf16 v[200:203], a[204:207], a[84:87], v[200:203]
    buffer_load_dwordx4 a[156:159], v14, s[20:23], s37 offen offset:1024 sc1
    v_mfma_f32_16x16x32_bf16 v[200:203], a[200:203], a[172:175], v[200:203]
    s_add_u32 s77, s7, 6
    ds_read_b64_tr_b16 a[196:197], v11 offset:12288
    v_add_u32 v57, v57, v64
    v_mfma_f32_16x16x32_bf16 v[208:211], a[200:203], a[176:179], v[208:211]
    buffer_load_dwordx2 v[66:67], v57, s[12:15], 0 offen
    v_mfma_f32_16x16x32_bf16 v[208:211], a[204:207], a[88:91], v[208:211]
    ds_read_b64_tr_b16 a[198:199], v11 offset:14336
    v_lshlrev_b32 v56, 3, v56
    v_mfma_f32_16x16x32_bf16 v[216:219], a[204:207], a[92:95], v[216:219]
    buffer_load_dwordx2 v[68:69], v56, s[24:27], s56 offen sc1
    v_mfma_f32_16x16x32_bf16 v[216:219], a[200:203], a[180:183], v[216:219]
    s_waitcnt lgkmcnt(5)
    v_and_b32 v54, 0xffff0000, v54
    v_ashrrev_i32 v56, 31, v54
    v_mfma_f32_16x16x32_bf16 v[220:223], a[208:211], a[180:183], v[220:223]
    s_add_u32 s38, s47, 122880
    v_not_b32 v56, v56
    v_or_b32 v56, 0x80000000, v56
    v_mfma_f32_16x16x32_bf16 v[220:223], a[212:215], a[92:95], v[220:223]
    s_addk_i32 m0, 4096
    v_xor_b32 v54, v54, v56
    v_and_b32 v54, 0xffff0000, v54
    v_mfma_f32_16x16x32_bf16 v[212:215], a[212:215], a[88:91], v[212:215]
    s_barrier
    v_mfma_f32_16x16x32_bf16 v[212:215], a[208:211], a[176:179], v[212:215]
    ds_read_b64_tr_b16 a[200:201], v12 offset:20480
    v_mul_f32 v54, s92, v54
    v_mfma_f32_16x16x32_bf16 v[204:207], a[208:211], a[172:175], v[204:207]
    buffer_load_dwordx4 a[160:163], v14, s[20:23], s37 offen offset:2048 sc1
    v_mfma_f32_16x16x32_bf16 v[204:207], a[212:215], a[84:87], v[204:207]
    ds_read_b64_tr_b16 a[202:203], v12 offset:21504
    v_mfma_f32_16x16x32_bf16 v[196:199], a[212:215], a[80:83], v[196:199]
    buffer_load_dwordx4 v2, s[8:11], s38 offen lds
    v_mfma_f32_16x16x32_bf16 v[196:199], a[208:211], a[168:171], v[196:199]
    s_waitcnt lgkmcnt(4)
    ds_read_b64_tr_b16 a[204:205], v13 offset:20480
    v_mfma_f32_16x16x32_bf16 v[224:227], a[184:187], a[168:171], v[224:227]
    ds_read_b64_tr_b16 a[206:207], v13 offset:21504
    v_mfma_f32_16x16x32_bf16 v[224:227], a[188:191], a[80:83], v[224:227]
    ds_read_b64_tr_b16 a[208:209], v8 offset:20480
    v_mfma_f32_16x16x32_bf16 v[232:235], a[188:191], a[84:87], v[232:235]
    ds_read_b64_tr_b16 a[210:211], v8 offset:22528
    v_mfma_f32_16x16x32_bf16 v[232:235], a[184:187], a[172:175], v[232:235]
    ds_read_b64_tr_b16 a[212:213], v9 offset:20480
    v_mfma_f32_16x16x32_bf16 v[240:243], a[184:187], a[176:179], v[240:243]
    s_add_u32 s38, s45, 163840
    ds_read_b64_tr_b16 a[214:215], v9 offset:22528
    v_mfma_f32_16x16x32_bf16 v[240:243], a[188:191], a[88:91], v[240:243]
    v_exp_f32 v54, v54
    v_mfma_f32_16x16x32_bf16 v[248:251], a[188:191], a[92:95], v[248:251]
    buffer_load_dwordx4 a[164:167], v14, s[20:23], s37 offen offset:3072 sc1
    v_mfma_f32_16x16x32_bf16 v[248:251], a[184:187], a[180:183], v[248:251]
    s_waitcnt lgkmcnt(6)
    ds_read_b64_tr_b16 a[188:189], v11 offset:20480
    v_add_f32 v54, 1.0, v54
    v_mfma_f32_16x16x32_bf16 v[252:255], a[192:195], a[180:183], v[252:255]
    s_addk_i32 m0, 4096
    ds_read_b64_tr_b16 a[190:191], v11 offset:22528
    s_sub_u32 s78, s72, s77
    v_mfma_f32_16x16x32_bf16 v[252:255], a[196:199], a[92:95], v[252:255]
    s_sub_u32 s79, s73, s77
    ds_read_b64_tr_b16 a[184:185], v10 offset:20480
    s_max_u32 s78, s78, s79
    v_mfma_f32_16x16x32_bf16 v[244:247], a[196:199], a[88:91], v[244:247]
    s_sub_u32 s79, s74, s77
    ds_read_b64_tr_b16 a[186:187], v10 offset:22528
    s_max_u32 s78, s78, s79
    v_mfma_f32_16x16x32_bf16 v[244:247], a[192:195], a[176:179], v[244:247]
    s_sub_u32 s79, s75, s77
    v_rcp_f32 v54, v54
    v_mfma_f32_16x16x32_bf16 v[236:239], a[192:195], a[172:175], v[236:239]
    buffer_load_dwordx4 v2, s[8:11], s38 offen lds
    v_mfma_f32_16x16x32_bf16 v[236:239], a[196:199], a[84:87], v[236:239]
    s_max_u32 s78, s78, s79
    v_cvt_pk_bf16_f32 v54, 0, v54
    s_add_u32 s37, s59, 20480
    v_mfma_f32_16x16x32_bf16 v[228:231], a[196:199], a[80:83], v[228:231]
    s_waitcnt lgkmcnt(3)
    v_mfma_f32_16x16x32_bf16 v[228:231], a[192:195], a[168:171], v[228:231]
    s_waitcnt vmcnt(24)
    ds_read_b64_tr_b16 a[192:193], v8 offset:24576
    v_lshlrev_b32 v20, 16, v32
    v_mfma_f32_16x16x32_bf16 v[96:99], a[200:203], a[96:99], v[96:99]
    s_cmp_gt_u32 s78, 0
    s_cbranch_scc1 spin_o5
spin_o5_ret:
    v_and_b32 v21, 0xffff0000, v32
    v_mfma_f32_16x16x32_bf16 v[100:103], a[204:207], a[96:99], v[100:103]
    buffer_load_dwordx4 a[168:171], v14, s[20:23], s37 offen offset:0 sc1
    v_mfma_f32_16x16x32_bf16 v[108:111], a[204:207], a[100:103], v[108:111]
    s_xor_b32 s77, s50, 2
    ds_read_b64_tr_b16 a[194:195], v8 offset:26624
    v_sub_f32 v20, v20, v38
    v_mfma_f32_16x16x32_bf16 v[104:107], a[200:203], a[100:103], v[104:107]
    s_lshl_b32 s77, s77, 10
    ds_read_b64_tr_b16 a[196:197], v9 offset:24576
    v_sub_f32 v21, v21, v38
    v_mfma_f32_16x16x32_bf16 v[112:115], a[200:203], a[104:107], v[112:115]
    s_add_u32 s38, s46, 163840
    ds_read_b64_tr_b16 a[198:199], v9 offset:26624
    v_cvt_pk_bf16_f32 v20, 0, v20
    v_mfma_f32_16x16x32_bf16 v[116:119], a[204:207], a[104:107], v[116:119]
    s_addk_i32 m0, 4096
    v_cvt_pk_bf16_f32 v21, 0, v21
    v_mul_f32 v20, v20, v39
    v_mfma_f32_16x16x32_bf16 v[124:127], a[204:207], a[108:111], v[124:127]
    s_waitcnt vmcnt(22)
    ds_read_b64_tr_b16 a[204:205], v11 offset:24576
    v_mul_f32 v21, v21, v39
    v_mfma_f32_16x16x32_bf16 v[120:123], a[200:203], a[108:111], v[120:123]
    s_lshr_b32 s56, s2, 3
    ds_read_b64_tr_b16 a[206:207], v11 offset:26624
    v_cvt_pk_bf16_f32 v20, 0, v20
    v_mfma_f32_16x16x32_bf16 v[152:155], a[208:211], a[108:111], v[152:155]
    s_lshl2_add_u32 s56, s56, s3
    ds_read_b64_tr_b16 a[200:201], v10 offset:24576
    v_cvt_pk_bf16_f32 v21, 0, v21
    v_mfma_f32_16x16x32_bf16 v[156:159], a[212:215], a[108:111], v[156:159]
    s_lshl_b32 s56, s56, 7
    ds_read_b64_tr_b16 a[202:203], v10 offset:26624
    v_mul_f32 v23, s92, v20
    v_mfma_f32_16x16x32_bf16 v[148:151], a[212:215], a[104:107], v[148:151]
    s_waitcnt lgkmcnt(5)
    v_exp_f32 v23, v23
    v_mfma_f32_16x16x32_bf16 v[144:147], a[208:211], a[104:107], v[144:147]
    buffer_load_dwordx4 a[172:175], v14, s[20:23], s37 offen offset:1024 sc1
    v_mfma_f32_16x16x32_bf16 v[136:139], a[208:211], a[100:103], v[136:139]
    buffer_load_dwordx4 v2, s[8:11], s38 offen lds
    v_mfma_f32_16x16x32_bf16 v[140:143], a[212:215], a[100:103], v[140:143]
    s_add_u32 s56, s56, rare-code_end+16384
    v_permlane16_swap_b32 v24, v26
    v_mfma_f32_16x16x32_bf16 v[132:135], a[212:215], a[96:99], v[132:135]
    ds_read_b64_tr_b16 a[212:213], v13 offset:22528
    v_mul_f32 v36, s92, v21
    v_mfma_f32_16x16x32_bf16 v[128:131], a[208:211], a[96:99], v[128:131]
    ds_read_b64_tr_b16 a[214:215], v13 offset:23552
    v_add_f32 v23, 1.0, v23
    v_mfma_f32_16x16x32_bf16 v[160:163], a[184:187], a[96:99], v[160:163]
    s_add_u32 s38, s47, 163840
    ds_read_b64_tr_b16 a[208:209], v12 offset:22528
    v_mov_b32 v70, s56
    v_mfma_f32_16x16x32_bf16 v[164:167], a[188:191], a[96:99], v[164:167]
    global_load_dword a252, v70, s[88:89]
    v_mfma_f32_16x16x32_bf16 v[172:175], a[188:191], a[100:103], v[172:175]
    s_addk_i32 m0, 4096
    ds_read_b64_tr_b16 a[210:211], v12 offset:23552
    v_mfma_f32_16x16x32_bf16 v[168:171], a[184:187], a[100:103], v[168:171]
    s_waitcnt vmcnt(22)
    v_exp_f32 v36, v36
    v_mfma_f32_16x16x32_bf16 v[176:179], a[184:187], a[104:107], v[176:179]
    buffer_load_dwordx4 a[176:179], v14, s[20:23], s37 offen offset:2048 sc1
    v_mfma_f32_16x16x32_bf16 v[180:183], a[188:191], a[104:107], v[180:183]
    v_rcp_f32 v23, v23
    v_mfma_f32_16x16x32_bf16 v[188:191], a[188:191], a[108:111], v[188:191]
    s_waitcnt lgkmcnt(2)
    v_permlane16_swap_b32 v25, v27
    v_mfma_f32_16x16x32_bf16 v[184:187], a[184:187], a[108:111], v[184:187]
    ds_read_b64_tr_b16 a[184:185], v8 offset:28672
    v_add_f32 v36, 1.0, v36
    v_mfma_f32_16x16x32_bf16 v[216:219], a[192:195], a[108:111], v[216:219]
    buffer_load_dwordx4 v2, s[8:11], s38 offen lds
    v_mfma_f32_16x16x32_bf16 v[220:223], a[196:199], a[108:111], v[220:223]
    ds_read_b64_tr_b16 a[186:187], v8 offset:30720
    v_mul_f32 v20, v20, v23
    v_mfma_f32_16x16x32_bf16 v[212:215], a[196:199], a[104:107], v[212:215]
    ds_read_b64_tr_b16 a[188:189], v9 offset:28672
    v_mfma_f32_16x16x32_bf16 v[208:211], a[192:195], a[104:107], v[208:211]
    ds_read_b64_tr_b16 a[190:191], v9 offset:30720
    v_mfma_f32_16x16x32_bf16 v[200:203], a[192:195], a[100:103], v[200:203]
    v_rcp_f32 v36, v36
    v_mfma_f32_16x16x32_bf16 v[204:207], a[196:199], a[100:103], v[204:207]
    v_permlane16_swap_b32 v28, v30
    v_mfma_f32_16x16x32_bf16 v[196:199], a[196:199], a[96:99], v[196:199]
    buffer_load_dwordx4 a[180:183], v14, s[20:23], s37 offen offset:3072 sc1
    v_mfma_f32_16x16x32_bf16 v[192:195], a[192:195], a[96:99], v[192:195]
    s_add_u32 s38, s45, 204800
    ds_read_b64_tr_b16 a[196:197], v11 offset:28672
    v_mul_f32 v21, v21, v36
    v_mfma_f32_16x16x32_bf16 v[224:227], a[200:203], a[96:99], v[224:227]
    s_addk_i32 m0, 4096
    ds_read_b64_tr_b16 a[198:199], v11 offset:30720
    v_cvt_pk_bf16_f32 v48, v20, v21
    v_mfma_f32_16x16x32_bf16 v[228:231], a[204:207], a[96:99], v[228:231]
    ds_read_b64_tr_b16 a[192:193], v10 offset:28672
    v_lshlrev_b32 v20, 16, v33
    v_mfma_f32_16x16x32_bf16 v[236:239], a[204:207], a[100:103], v[236:239]
    s_add_u32 s37, s60, 20480
    ds_read_b64_tr_b16 a[194:195], v10 offset:30720
    v_and_b32 v21, 0xffff0000, v33
    v_mfma_f32_16x16x32_bf16 v[232:235], a[200:203], a[100:103], v[232:235]
    v_permlane16_swap_b32 v29, v31
    v_mfma_f32_16x16x32_bf16 v[240:243], a[200:203], a[104:107], v[240:243]
    v_sub_f32 v20, v20, v38
    v_sub_f32 v21, v21, v38
    v_mfma_f32_16x16x32_bf16 v[244:247], a[204:207], a[104:107], v[244:247]
    s_waitcnt lgkmcnt(4)
    v_cvt_pk_bf16_f32 v20, 0, v20
    v_cvt_pk_bf16_f32 v21, 0, v21
    v_mfma_f32_16x16x32_bf16 v[252:255], a[204:207], a[108:111], v[252:255]
    buffer_load_dwordx4 v2, s[8:11], s38 offen lds
    v_mfma_f32_16x16x32_bf16 v[248:251], a[200:203], a[108:111], v[248:251]
    ds_read_b64_tr_b16 a[200:201], v8 offset:32768
    v_mul_f32 v20, v20, v39
    v_mfma_f32_16x16x32_bf16 v[120:123], a[208:211], a[124:127], v[120:123]
    buffer_load_dwordx4 a[80:83], v14, s[20:23], s37 offen offset:0 sc1
    v_mfma_f32_16x16x32_bf16 v[124:127], a[212:215], a[124:127], v[124:127]
    ds_read_b64_tr_b16 a[202:203], v8 offset:34816
    v_subrev_u32 v8, 73728, v8
    v_mfma_f32_16x16x32_bf16 v[116:119], a[212:215], a[120:123], v[116:119]
    ds_read_b64_tr_b16 a[204:205], v9 offset:32768
    v_mul_f32 v21, v21, v39
    v_mfma_f32_16x16x32_bf16 v[112:115], a[208:211], a[120:123], v[112:115]
    ds_read_b64_tr_b16 a[206:207], v9 offset:34816
    v_subrev_u32 v9, 73728, v9
    v_mfma_f32_16x16x32_bf16 v[104:107], a[208:211], a[116:119], v[104:107]
    s_add_u32 s38, s46, 204800
    v_cvt_pk_bf16_f32 v20, 0, v20
    v_cvt_pk_bf16_f32 v21, 0, v21
    v_mfma_f32_16x16x32_bf16 v[108:111], a[212:215], a[116:119], v[108:111]
    v_mul_f32 v23, s92, v20
    v_mul_f32 v36, s92, v21
    v_mfma_f32_16x16x32_bf16 v[100:103], a[212:215], a[112:115], v[100:103]
    s_addk_i32 m0, 4096
    ds_read_b64_tr_b16 a[212:213], v11 offset:32768
    v_mfma_f32_16x16x32_bf16 v[96:99], a[208:211], a[112:115], v[96:99]
    ds_read_b64_tr_b16 a[214:215], v11 offset:34816
    v_subrev_u32 v11, 73728, v11
    v_mfma_f32_16x16x32_bf16 v[128:131], a[184:187], a[112:115], v[128:131]
    ds_read_b64_tr_b16 a[208:209], v10 offset:32768
    v_mfma_f32_16x16x32_bf16 v[132:135], a[188:191], a[112:115], v[132:135]
    s_waitcnt lgkmcnt(4)
    ds_read_b64_tr_b16 a[210:211], v10 offset:34816
    v_subrev_u32 v10, 73728, v10
    v_mfma_f32_16x16x32_bf16 v[140:143], a[188:191], a[116:119], v[140:143]
    buffer_load_dwordx4 a[84:87], v14, s[20:23], s37 offen offset:1024 sc1
    v_mfma_f32_16x16x32_bf16 v[136:139], a[184:187], a[116:119], v[136:139]
    v_exp_f32 v23, v23
    v_mfma_f32_16x16x32_bf16 v[144:147], a[184:187], a[120:123], v[144:147]
    buffer_load_dwordx4 v2, s[8:11], s38 offen lds
    v_mfma_f32_16x16x32_bf16 v[148:151], a[188:191], a[120:123], v[148:151]
    v_exp_f32 v36, v36
    v_mfma_f32_16x16x32_bf16 v[156:159], a[188:191], a[124:127], v[156:159]
    v_add_f32 v23, 1.0, v23
    v_add_f32 v36, 1.0, v36
    v_mfma_f32_16x16x32_bf16 v[152:155], a[184:187], a[124:127], v[152:155]
    v_rcp_f32 v23, v23
    v_mfma_f32_16x16x32_bf16 v[184:187], a[192:195], a[124:127], v[184:187]
    v_rcp_f32 v36, v36
    v_mfma_f32_16x16x32_bf16 v[188:191], a[196:199], a[124:127], v[188:191]
    s_waitcnt lgkmcnt(0)
    v_mul_f32 v20, v20, v23
    v_mul_f32 v21, v21, v36
    v_mfma_f32_16x16x32_bf16 v[180:183], a[196:199], a[120:123], v[180:183]
    s_barrier
    v_mfma_f32_16x16x32_bf16 v[176:179], a[192:195], a[120:123], v[176:179]
    s_add_u32 s38, s47, 204800
    ds_read_b64_tr_b16 a[184:185], v12 offset:49152
    v_cvt_pk_bf16_f32 v49, v20, v21
    v_mfma_f32_16x16x32_bf16 v[168:171], a[192:195], a[116:119], v[168:171]
    buffer_load_dwordx4 a[88:91], v14, s[20:23], s37 offen offset:2048 sc1
    v_mfma_f32_16x16x32_bf16 v[172:175], a[196:199], a[116:119], v[172:175]
    s_addk_i32 m0, 4096
    ds_read_b64_tr_b16 a[186:187], v12 offset:50176
    v_lshlrev_b32 v20, 16, v24
    v_mfma_f32_16x16x32_bf16 v[164:167], a[196:199], a[112:115], v[164:167]
    s_waitcnt vmcnt(17)
    ds_read_b64_tr_b16 a[188:189], v12 offset:51200
    v_and_b32 v21, 0xffff0000, v24
    v_mfma_f32_16x16x32_bf16 v[160:163], a[192:195], a[112:115], v[160:163]
    ds_read_b64_tr_b16 a[190:191], v12 offset:52224
    v_sub_f32 v20, v20, v16
    v_mfma_f32_16x16x32_bf16 v[192:195], a[200:203], a[112:115], v[192:195]
    ds_read_b64_tr_b16 a[192:193], v13 offset:49152
    v_sub_f32 v21, v21, v16
    v_mfma_f32_16x16x32_bf16 v[196:199], a[204:207], a[112:115], v[196:199]
    ds_read_b64_tr_b16 a[194:195], v13 offset:50176
    v_cvt_pk_bf16_f32 v20, 0, v20
    v_mfma_f32_16x16x32_bf16 v[204:207], a[204:207], a[116:119], v[204:207]
    buffer_load_dwordx4 v2, s[8:11], s38 offen lds
    v_mfma_f32_16x16x32_bf16 v[200:203], a[200:203], a[116:119], v[200:203]
    ds_read_b64_tr_b16 a[196:197], v13 offset:51200
    v_cvt_pk_bf16_f32 v21, 0, v21
    v_mfma_f32_16x16x32_bf16 v[208:211], a[200:203], a[120:123], v[208:211]
    ds_read_b64_tr_b16 a[198:199], v13 offset:52224
    v_mul_f32 v20, v20, v17
    v_mfma_f32_16x16x32_bf16 v[212:215], a[204:207], a[120:123], v[212:215]
    v_mul_f32 v21, v21, v17
    v_cvt_pk_bf16_f32 v20, 0, v20
    v_mfma_f32_16x16x32_bf16 v[220:223], a[204:207], a[124:127], v[220:223]
    buffer_load_dwordx4 a[92:95], v14, s[20:23], s37 offen offset:3072 sc1
    v_mfma_f32_16x16x32_bf16 v[216:219], a[200:203], a[124:127], v[216:219]
    ds_read_b64_tr_b16 a[200:201], v12 offset:53248
    v_cvt_pk_bf16_f32 v21, 0, v21
    v_mfma_f32_16x16x32_bf16 v[248:251], a[208:211], a[124:127], v[248:251]
    ds_read_b64_tr_b16 a[202:203], v12 offset:54272
    v_mul_f32 v23, s92, v20
    v_mfma_f32_16x16x32_bf16 v[252:255], a[212:215], a[124:127], v[252:255]
    ds_read_b64_tr_b16 a[204:205], v12 offset:55296
    v_mul_f32 v36, s92, v21
    v_mfma_f32_16x16x32_bf16 v[244:247], a[212:215], a[120:123], v[244:247]
    s_waitcnt lgkmcnt(4)
    ds_read_b64_tr_b16 a[206:207], v12 offset:56320
    v_lshlrev_b32 v50, 16, v66
    v_mfma_f32_16x16x32_bf16 v[240:243], a[208:211], a[120:123], v[240:243]
    s_add_u32 s37, s61, 20480
    v_exp_f32 v23, v23
    v_mfma_f32_16x16x32_bf16 v[232:235], a[208:211], a[116:119], v[232:235]
    s_waitcnt vmcnt(18)
    v_exp_f32 v36, v36
    v_mfma_f32_16x16x32_bf16 v[236:239], a[212:215], a[116:119], v[236:239]
    v_and_b32 v51, 0xffff0000, v66
    v_lshlrev_b32 v52, 16, v67
    v_mfma_f32_16x16x32_bf16 v[228:231], a[212:215], a[112:115], v[228:231]
    v_and_b32 v53, 0xffff0000, v67
    v_sub_f32 v50, v50, v68
    v_mfma_f32_16x16x32_bf16 v[224:227], a[208:211], a[112:115], v[224:227]
    ds_read_b64_tr_b16 a[208:209], v13 offset:53248
    v_sub_f32 v51, v51, v68
    v_mfma_f32_16x16x32_bf16 v[96:99], a[184:187], a[128:131], v[96:99]
    buffer_load_dwordx4 a[96:99], v14, s[20:23], s37 offen offset:0 sc1
    v_mfma_f32_16x16x32_bf16 v[96:99], a[188:191], a[0:3], v[96:99]
    ds_read_b64_tr_b16 a[210:211], v13 offset:54272
    v_sub_f32 v52, v52, v68
    v_mfma_f32_16x16x32_bf16 v[104:107], a[188:191], a[4:7], v[104:107]
    ds_read_b64_tr_b16 a[212:213], v13 offset:55296
    v_sub_f32 v53, v53, v68
    v_mfma_f32_16x16x32_bf16 v[104:107], a[184:187], a[132:135], v[104:107]
    ds_read_b64_tr_b16 a[214:215], v13 offset:56320
    v_cvt_pk_bf16_f32 v50, 0, v50
    v_mfma_f32_16x16x32_bf16 v[112:115], a[184:187], a[136:139], v[112:115]
    v_cvt_pk_bf16_f32 v51, 0, v51
    v_cvt_pk_bf16_f32 v52, 0, v52
    v_mfma_f32_16x16x32_bf16 v[112:115], a[188:191], a[8:11], v[112:115]
    v_cvt_pk_bf16_f32 v53, 0, v53
    v_mul_f32 v50, v50, v69
    v_mfma_f32_16x16x32_bf16 v[120:123], a[188:191], a[12:15], v[120:123]
    s_waitcnt lgkmcnt(3)
    v_mul_f32 v51, v51, v69
    v_mul_f32 v52, v52, v69
    v_mfma_f32_16x16x32_bf16 v[120:123], a[184:187], a[140:143], v[120:123]
    ds_read_b64_tr_b16 a[184:185], v12 offset:57344
    v_mul_f32 v53, v53, v69
    v_mfma_f32_16x16x32_bf16 v[124:127], a[192:195], a[140:143], v[124:127]
    ds_read_b64_tr_b16 a[186:187], v12 offset:58368
    v_cvt_pk_bf16_f32 v50, 0, v50
    v_mfma_f32_16x16x32_bf16 v[124:127], a[196:199], a[12:15], v[124:127]
    ds_read_b64_tr_b16 a[188:189], v12 offset:59392
    v_cvt_pk_bf16_f32 v51, 0, v51
    v_mfma_f32_16x16x32_bf16 v[116:119], a[196:199], a[8:11], v[116:119]
    buffer_load_dwordx4 a[100:103], v14, s[20:23], s37 offen offset:1024 sc1
    v_mfma_f32_16x16x32_bf16 v[116:119], a[192:195], a[136:139], v[116:119]
    s_lshl2_add_u32 s60, s54, s51
    ds_read_b64_tr_b16 a[190:191], v12 offset:60416
    v_lshrrev_b32 v70, 1, v1
    v_mfma_f32_16x16x32_bf16 v[108:111], a[192:195], a[132:135], v[108:111]
    s_mul_i32 s60, s60, 163840
    v_min_u32 v70, 1, v70
    v_and_b32 v39, 7, v1
    v_mfma_f32_16x16x32_bf16 v[108:111], a[196:199], a[4:7], v[108:111]
    s_add_u32 s60, s60, 50331648
    v_cvt_pk_bf16_f32 v52, 0, v52
    v_cvt_pk_bf16_f32 v53, 0, v53
    v_mfma_f32_16x16x32_bf16 v[100:103], a[196:199], a[0:3], v[100:103]
    s_mul_i32 s56, s53, 2560
    v_add_f32 v23, 1.0, v23
    v_add_f32 v36, 1.0, v36
    v_mfma_f32_16x16x32_bf16 v[100:103], a[192:195], a[128:131], v[100:103]
    s_add_u32 s59, s60, s56
    ds_read_b64_tr_b16 a[192:193], v13 offset:57344
    s_mul_i32 s56, s53, 20480
    v_mfma_f32_16x16x32_bf16 v[96:99], a[200:203], a[16:19], v[96:99]
    s_add_u32 s60, s60, s56
    ds_read_b64_tr_b16 a[194:195], v13 offset:58368
    s_andn2_b32 s61, s2, 7
    v_mfma_f32_16x16x32_bf16 v[96:99], a[204:207], a[32:35], v[96:99]
    s_lshl_b32 s61, s61, 2
    ds_read_b64_tr_b16 a[196:197], v13 offset:59392
    s_add_u32 s61, s61, s3
    v_mfma_f32_16x16x32_bf16 v[104:107], a[204:207], a[36:39], v[104:107]
    s_lshl_b32 s61, s61, 7
    ds_read_b64_tr_b16 a[198:199], v13 offset:60416
    s_add_u32 s61, s61, 4194304
    v_mfma_f32_16x16x32_bf16 v[104:107], a[200:203], a[20:23], v[104:107]
    s_waitcnt lgkmcnt(4)
    v_rcp_f32 v23, v23
    v_mfma_f32_16x16x32_bf16 v[112:115], a[200:203], a[24:27], v[112:115]
    buffer_load_dwordx4 a[104:107], v14, s[20:23], s37 offen offset:2048 sc1
    v_mfma_f32_16x16x32_bf16 v[112:115], a[204:207], a[40:43], v[112:115]
    s_and_b32 s56, s53, 1
    v_xor_b32 v7, s56, v1
    v_add_u32 v2, 1, v7
    v_mfma_f32_16x16x32_bf16 v[120:123], a[204:207], a[44:47], v[120:123]
pg_14:
    s_cbranch_execz pg_backL
    s_andn2_b32 s56, 4, s53
    v_lshlrev_b32 v7, 2, v7
    v_lshl_add_u32 v7, v1, 9, v7
    v_mfma_f32_16x16x32_bf16 v[120:123], a[200:203], a[28:31], v[120:123]
    s_lshl_b32 s56, s56, 1
    ds_read_b64_tr_b16 a[200:201], v12 offset:61440
    v_lshl_or_b32 v7, v70, 30, v7
    v_mfma_f32_16x16x32_bf16 v[124:127], a[208:211], a[28:31], v[124:127]
    s_add_u32 s67, s61, s67
    ds_read_b64_tr_b16 a[202:203], v12 offset:62464
    v_lshrrev_b32 v70, 4, v1
    v_mfma_f32_16x16x32_bf16 v[124:127], a[212:215], a[44:47], v[124:127]
    s_add_u32 s77, s61, s77
    ds_read_b64_tr_b16 a[204:205], v12 offset:63488
    v_lshl_add_u32 v39, v70, 3, v39
    v_mfma_f32_16x16x32_bf16 v[116:119], a[212:215], a[40:43], v[116:119]
    s_add_u32 s38, s45, 81920
    ds_read_b64_tr_b16 a[206:207], v12 offset:64512
    v_add_u32 v12, 65536, v12
    v_mfma_f32_16x16x32_bf16 v[116:119], a[208:211], a[24:27], v[116:119]
    s_add_u32 m0, s63, 135168
    v_lshlrev_b32 v39, 4, v39
    v_and_b32 v70, 8, v1
    v_mfma_f32_16x16x32_bf16 v[108:111], a[208:211], a[20:23], v[108:111]
    buffer_load_dwordx4 v3, s[8:11], s38 offen lds
    v_mfma_f32_16x16x32_bf16 v[108:111], a[212:215], a[36:39], v[108:111]
    s_add_u32 s38, s46, 81920
    v_mul_u32_u24 v38, 1280, v70
    v_add_u32 v38, v38, v39
    v_mfma_f32_16x16x32_bf16 v[100:103], a[212:215], a[32:35], v[100:103]
    buffer_load_dwordx4 a[108:111], v14, s[20:23], s37 offen offset:3072 sc1
    v_mfma_f32_16x16x32_bf16 v[100:103], a[208:211], a[16:19], v[100:103]
    s_addk_i32 m0, -4096
    ds_read_b64_tr_b16 a[208:209], v13 offset:61440
    v_xor_b32 v70, s56, v70
    v_mfma_f32_16x16x32_bf16 v[96:99], a[184:187], a[48:51], v[96:99]
    buffer_load_dwordx4 v3, s[8:11], s38 offen lds
    v_mfma_f32_16x16x32_bf16 v[96:99], a[188:191], a[64:67], v[96:99]
    ds_read_b64_tr_b16 a[210:211], v13 offset:62464
    v_add_u32 v39, v39, v70
    v_mfma_f32_16x16x32_bf16 v[104:107], a[188:191], a[68:71], v[104:107]
    s_add_u32 s38, s47, 81920
    ds_read_b64_tr_b16 a[212:213], v13 offset:63488
    v_cmp_ne_u32 s[74:75], 0, v70
    v_mfma_f32_16x16x32_bf16 v[104:107], a[184:187], a[52:55], v[104:107]
    s_waitcnt lgkmcnt(3)
    ds_read_b64_tr_b16 a[214:215], v13 offset:64512
    v_add_u32 v13, 65536, v13
    v_mfma_f32_16x16x32_bf16 v[112:115], a[184:187], a[56:59], v[112:115]
    s_add_u32 m0, s63, 126976
    v_rcp_f32 v36, v36
    v_mfma_f32_16x16x32_bf16 v[112:115], a[188:191], a[72:75], v[112:115]
    v_mul_f32 v20, v20, v23
    v_mul_f32 v21, v21, v36
    v_mfma_f32_16x16x32_bf16 v[120:123], a[188:191], a[76:79], v[120:123]
    v_cvt_pk_bf16_f32 v40, v20, v21
    v_lshlrev_b32 v20, 16, v25
    v_mfma_f32_16x16x32_bf16 v[120:123], a[184:187], a[60:63], v[120:123]
    ds_read_b64_tr_b16 a[184:185], v12 offset:0
    v_and_b32 v21, 0xffff0000, v25
    v_mfma_f32_16x16x32_bf16 v[124:127], a[192:195], a[60:63], v[124:127]
    ds_read_b64_tr_b16 a[186:187], v12 offset:1024
    v_sub_f32 v20, v20, v16
    v_mfma_f32_16x16x32_bf16 v[124:127], a[196:199], a[76:79], v[124:127]
    ds_read_b64_tr_b16 a[188:189], v12 offset:2048
    v_sub_f32 v21, v21, v16
    v_mfma_f32_16x16x32_bf16 v[116:119], a[196:199], a[72:75], v[116:119]
    buffer_load_dwordx4 v3, s[8:11], s38 offen lds
    v_mfma_f32_16x16x32_bf16 v[116:119], a[192:195], a[56:59], v[116:119]
    ds_read_b64_tr_b16 a[190:191], v12 offset:3072
    v_cvt_pk_bf16_f32 v20, 0, v20
    v_mfma_f32_16x16x32_bf16 v[108:111], a[192:195], a[52:55], v[108:111]
    v_cvt_pk_bf16_f32 v21, 0, v21
    v_mul_f32 v20, v20, v17
    v_mfma_f32_16x16x32_bf16 v[108:111], a[196:199], a[68:71], v[108:111]
    v_mul_f32 v21, v21, v17
    v_cvt_pk_bf16_f32 v20, 0, v20
    v_mfma_f32_16x16x32_bf16 v[100:103], a[196:199], a[64:67], v[100:103]
    s_add_u32 s38, s45, 122880
    v_cvt_pk_bf16_f32 v21, 0, v21
    v_mul_f32 v23, s92, v20
    v_mfma_f32_16x16x32_bf16 v[100:103], a[192:195], a[48:51], v[100:103]
    ds_read_b64_tr_b16 a[192:193], v13 offset:0
    v_mul_f32 v36, s92, v21
    v_mfma_f32_16x16x32_bf16 v[96:99], a[200:203], a[216:219], v[96:99]
    s_addk_i32 m0, -4096
    ds_read_b64_tr_b16 a[194:195], v13 offset:1024
    v_mfma_f32_16x16x32_bf16 v[96:99], a[204:207], a[232:235], v[96:99]
    ds_read_b64_tr_b16 a[196:197], v13 offset:2048
    v_mfma_f32_16x16x32_bf16 v[104:107], a[204:207], a[236:239], v[104:107]
    s_waitcnt lgkmcnt(3)
    ds_read_b64_tr_b16 a[198:199], v13 offset:3072
    v_mfma_f32_16x16x32_bf16 v[104:107], a[200:203], a[220:223], v[104:107]
    v_exp_f32 v23, v23
    v_mfma_f32_16x16x32_bf16 v[112:115], a[200:203], a[224:227], v[112:115]
    v_exp_f32 v36, v36
    v_mfma_f32_16x16x32_bf16 v[112:115], a[204:207], a[240:243], v[112:115]
    v_add_f32 v23, 1.0, v23
    v_add_f32 v36, 1.0, v36
    v_mfma_f32_16x16x32_bf16 v[120:123], a[204:207], a[244:247], v[120:123]
    buffer_load_dwordx4 v3, s[8:11], s38 offen lds
    v_mfma_f32_16x16x32_bf16 v[120:123], a[200:203], a[228:231], v[120:123]
    ds_read_b64_tr_b16 a[200:201], v12 offset:4096
    v_mfma_f32_16x16x32_bf16 v[124:127], a[208:211], a[228:231], v[124:127]
    ds_read_b64_tr_b16 a[202:203], v12 offset:5120
    v_mfma_f32_16x16x32_bf16 v[124:127], a[212:215], a[244:247], v[124:127]
    ds_read_b64_tr_b16 a[204:205], v12 offset:6144
    v_mfma_f32_16x16x32_bf16 v[116:119], a[212:215], a[240:243], v[116:119]
    buffer_load_dword v58, v65, s[24:27], s41 offen sc1
    v_mfma_f32_16x16x32_bf16 v[116:119], a[208:211], a[224:227], v[116:119]
    buffer_load_dword v59, v65, s[24:27], s42 offen sc1
    v_mfma_f32_16x16x32_bf16 v[108:111], a[208:211], a[220:223], v[108:111]
    s_add_u32 s38, s46, 122880
    ds_read_b64_tr_b16 a[206:207], v12 offset:7168
    s_addk_i32 m0, -4096
    v_mfma_f32_16x16x32_bf16 v[108:111], a[212:215], a[236:239], v[108:111]
    v_rcp_f32 v23, v23
    v_mfma_f32_16x16x32_bf16 v[100:103], a[212:215], a[232:235], v[100:103]
    s_waitcnt vmcnt(23)
    v_rcp_f32 v36, v36
    v_mfma_f32_16x16x32_bf16 v[100:103], a[208:211], a[216:219], v[100:103]
    s_waitcnt vmcnt(22)
    ds_read_b64_tr_b16 a[208:209], v13 offset:4096
    v_mul_f32 v20, v20, v23
    v_mfma_f32_16x16x32_bf16 v[96:99], a[184:187], a[152:155], v[96:99]
    ds_read_b64_tr_b16 a[210:211], v13 offset:5120
    v_mul_f32 v21, v21, v36
    v_mfma_f32_16x16x32_bf16 v[96:99], a[188:191], a[168:171], v[96:99]
    ds_read_b64_tr_b16 a[212:213], v13 offset:6144
    v_cvt_pk_bf16_f32 v41, v20, v21
    v_mfma_f32_16x16x32_bf16 v[104:107], a[188:191], a[172:175], v[104:107]
    s_waitcnt vmcnt(19) lgkmcnt(4)
    ds_read_b64_tr_b16 a[214:215], v13 offset:7168
    v_lshlrev_b32 v20, 16, v26
    v_mfma_f32_16x16x32_bf16 v[104:107], a[184:187], a[156:159], v[104:107]
    buffer_load_dwordx4 v3, s[8:11], s38 offen lds
    v_mfma_f32_16x16x32_bf16 v[112:115], a[184:187], a[160:163], v[112:115]
    s_waitcnt vmcnt(18)
    v_and_b32 v21, 0xffff0000, v26
    v_sub_f32 v20, v20, v16
    v_mfma_f32_16x16x32_bf16 v[112:115], a[188:191], a[176:179], v[112:115]
    v_sub_f32 v21, v21, v16
    v_cvt_pk_bf16_f32 v20, 0, v20
    v_mfma_f32_16x16x32_bf16 v[120:123], a[188:191], a[180:183], v[120:123]
    s_add_u32 s38, s47, 122880
    v_cvt_pk_bf16_f32 v21, 0, v21
    v_mul_f32 v20, v20, v17
    v_mfma_f32_16x16x32_bf16 v[120:123], a[184:187], a[164:167], v[120:123]
    v_mul_f32 v21, v21, v17
    v_cvt_pk_bf16_f32 v20, 0, v20
    v_mfma_f32_16x16x32_bf16 v[124:127], a[192:195], a[164:167], v[124:127]
    s_addk_i32 m0, -4096
    v_cvt_pk_bf16_f32 v21, 0, v21
    v_mul_f32 v23, s92, v20
    v_mfma_f32_16x16x32_bf16 v[124:127], a[196:199], a[180:183], v[124:127]
    v_exp_f32 v23, v23
    v_mfma_f32_16x16x32_bf16 v[116:119], a[196:199], a[176:179], v[116:119]
    s_barrier
    v_mfma_f32_16x16x32_bf16 v[116:119], a[192:195], a[160:163], v[116:119]
    ds_read_b64_tr_b16 a[184:185], v8 offset:0
    v_mul_f32 v36, s92, v21
    v_mfma_f32_16x16x32_bf16 v[108:111], a[192:195], a[156:159], v[108:111]
    ds_read_b64_tr_b16 a[186:187], v8 offset:2048
    v_add_f32 v23, 1.0, v23
    v_mfma_f32_16x16x32_bf16 v[108:111], a[196:199], a[172:175], v[108:111]
    s_waitcnt vmcnt(16)
    ds_read_b64_tr_b16 a[188:189], v8 offset:4096
    v_mfma_f32_16x16x32_bf16 v[100:103], a[196:199], a[168:171], v[100:103]
    buffer_load_dwordx4 v3, s[8:11], s38 offen lds
    v_mfma_f32_16x16x32_bf16 v[100:103], a[192:195], a[152:155], v[100:103]
    s_waitcnt vmcnt(10) lgkmcnt(3)
    ds_read_b64_tr_b16 a[190:191], v8 offset:6144
    v_mfma_f32_16x16x32_bf16 v[96:99], a[200:203], a[80:83], v[96:99]
    ds_read_b64_tr_b16 a[192:193], v9 offset:0
    v_mfma_f32_16x16x32_bf16 v[96:99], a[204:207], a[96:99], v[96:99]
    ds_read_b64_tr_b16 a[194:195], v9 offset:2048
    v_mfma_f32_16x16x32_bf16 v[104:107], a[204:207], a[100:103], v[104:107]
    s_waitcnt vmcnt(9)
    ds_read_b64_tr_b16 a[196:197], v9 offset:4096
    s_add_u32 s38, s45, 163840
    v_mfma_f32_16x16x32_bf16 v[104:107], a[200:203], a[84:87], v[104:107]
    s_waitcnt vmcnt(7)
    ds_read_b64_tr_b16 a[198:199], v9 offset:6144
    v_cvt_pk_bf16_f32 v96, v96, v97
    v_mfma_f32_16x16x32_bf16 v[112:115], a[200:203], a[88:91], v[112:115]
    s_addk_i32 m0, -4096
    v_cvt_pk_bf16_f32 v97, v98, v99
    v_mfma_f32_16x16x32_bf16 v[112:115], a[204:207], a[104:107], v[112:115]
    s_xor_b32 s78, s53, 3
    v_cvt_pk_bf16_f32 v104, v104, v105
    v_cvt_pk_bf16_f32 v105, v106, v107
    v_mfma_f32_16x16x32_bf16 v[120:123], a[204:207], a[108:111], v[120:123]
    s_and_b32 s78, s78, 3
    v_exp_f32 v36, v36
    v_mfma_f32_16x16x32_bf16 v[120:123], a[200:203], a[92:95], v[120:123]
    s_mul_i32 s78, s78, 2560
    ds_read_b64_tr_b16 a[200:201], v8 offset:8192
    v_cvt_pk_bf16_f32 v112, v112, v113
    v_mfma_f32_16x16x32_bf16 v[124:127], a[208:211], a[92:95], v[124:127]
    s_add_u32 s78, s78, s60
    ds_read_b64_tr_b16 a[202:203], v8 offset:10240
    v_cvt_pk_bf16_f32 v113, v114, v115
    v_mfma_f32_16x16x32_bf16 v[124:127], a[212:215], a[108:111], v[124:127]
    s_xor_b32 s79, s53, 1
    ds_read_b64_tr_b16 a[204:205], v8 offset:12288
    v_add_f32 v36, 1.0, v36
    v_mfma_f32_16x16x32_bf16 v[116:119], a[212:215], a[104:107], v[116:119]
    s_waitcnt lgkmcnt(3)
    ds_read_b64_tr_b16 a[206:207], v8 offset:14336
    s_and_b32 s79, s79, 3
    v_mfma_f32_16x16x32_bf16 v[116:119], a[208:211], a[88:91], v[116:119]
    buffer_load_dwordx4 v3, s[8:11], s38 offen lds
    v_mfma_f32_16x16x32_bf16 v[108:111], a[208:211], a[84:87], v[108:111]
    s_mul_i32 s79, s79, 2560
    v_rcp_f32 v23, v23
    v_mfma_f32_16x16x32_bf16 v[108:111], a[212:215], a[100:103], v[108:111]
    s_add_u32 s79, s79, s60
    v_rcp_f32 v36, v36
    v_mfma_f32_16x16x32_bf16 v[100:103], a[212:215], a[96:99], v[100:103]
    s_add_u32 s38, s46, 163840
    v_cvt_pk_bf16_f32 v114, v116, v117
    v_cvt_pk_bf16_f32 v115, v118, v119
    v_mfma_f32_16x16x32_bf16 v[100:103], a[208:211], a[80:83], v[100:103]
    ds_read_b64_tr_b16 a[208:209], v9 offset:8192
    v_cvt_pk_bf16_f32 v106, v108, v109
    v_mfma_f32_16x16x32_bf16 v[128:131], a[184:187], a[128:131], v[128:131]
    s_addk_i32 m0, -4096
    ds_read_b64_tr_b16 a[210:211], v9 offset:10240
    v_cvt_pk_bf16_f32 v107, v110, v111
    v_mfma_f32_16x16x32_bf16 v[128:131], a[188:191], a[0:3], v[128:131]
    ds_read_b64_tr_b16 a[212:213], v9 offset:12288
    v_cvt_pk_bf16_f32 v98, v100, v101
    v_mfma_f32_16x16x32_bf16 v[136:139], a[188:191], a[4:7], v[136:139]
    ds_read_b64_tr_b16 a[214:215], v9 offset:14336
    v_cvt_pk_bf16_f32 v99, v102, v103
    v_mfma_f32_16x16x32_bf16 v[136:139], a[184:187], a[132:135], v[136:139]
    buffer_store_dwordx4 v[96:99], v38, s[24:27], s78 offen offset:2048 sc1
    v_mov_b32_dpp v116, v120 row_ror:8 row_mask:0xf bank_mask:0xf
    v_mfma_f32_16x16x32_bf16 v[144:147], a[184:187], a[136:139], v[144:147]
    s_xor_b32 s78, s53, 2
    v_mov_b32_dpp v117, v121 row_ror:8 row_mask:0xf bank_mask:0xf
    v_mov_b32_dpp v118, v122 row_ror:8 row_mask:0xf bank_mask:0xf
    v_mfma_f32_16x16x32_bf16 v[144:147], a[188:191], a[8:11], v[144:147]
    buffer_store_dwordx4 v[104:107], v38, s[24:27], s79 offen offset:2048 sc1
    v_mov_b32_dpp v119, v123 row_ror:8 row_mask:0xf bank_mask:0xf
    v_mfma_f32_16x16x32_bf16 v[152:155], a[188:191], a[12:15], v[152:155]
    buffer_load_dwordx4 v3, s[8:11], s38 offen lds
    v_mfma_f32_16x16x32_bf16 v[152:155], a[184:187], a[140:143], v[152:155]
    s_and_b32 s78, s78, 3
    ds_read_b64_tr_b16 a[184:185], v8 offset:16384
    v_cvt_pk_bf16_f32 v120, v120, v121
    v_mfma_f32_16x16x32_bf16 v[156:159], a[192:195], a[140:143], v[156:159]
    s_mul_i32 s78, s78, 2560
    ds_read_b64_tr_b16 a[186:187], v8 offset:18432
    v_cvt_pk_bf16_f32 v121, v122, v123
    v_mfma_f32_16x16x32_bf16 v[156:159], a[196:199], a[12:15], v[156:159]
    s_add_u32 s78, s78, s60
    ds_read_b64_tr_b16 a[188:189], v8 offset:20480
    v_cvt_pk_bf16_f32 v122, v124, v125
    v_mfma_f32_16x16x32_bf16 v[148:151], a[196:199], a[8:11], v[148:151]
    s_waitcnt lgkmcnt(3)
    ds_read_b64_tr_b16 a[190:191], v8 offset:22528
    v_cvt_pk_bf16_f32 v123, v126, v127
    v_mfma_f32_16x16x32_bf16 v[148:151], a[192:195], a[136:139], v[148:151]
    buffer_store_dwordx4 v[112:115], v38, s[24:27], s78 offen offset:2048 sc1
    v_mul_f32 v20, v20, v23
    v_mfma_f32_16x16x32_bf16 v[140:143], a[192:195], a[132:135], v[140:143]
    s_xor_b32 s79, s53, 0
    v_mul_f32 v21, v21, v36
    v_cvt_pk_bf16_f32 v42, v20, v21
    v_mfma_f32_16x16x32_bf16 v[140:143], a[196:199], a[4:7], v[140:143]
    s_and_b32 s79, s79, 3
    v_lshlrev_b32 v20, 16, v27
    v_and_b32 v21, 0xffff0000, v27
    v_mfma_f32_16x16x32_bf16 v[132:135], a[196:199], a[0:3], v[132:135]
    s_mul_i32 s79, s79, 2560
    v_sub_f32 v20, v20, v16
    v_sub_f32 v21, v21, v16
    v_mfma_f32_16x16x32_bf16 v[132:135], a[192:195], a[128:131], v[132:135]
    s_add_u32 s79, s79, s60
    ds_read_b64_tr_b16 a[192:193], v9 offset:16384
    v_lshlrev_b32 v16, 4, v2
    v_mfma_f32_16x16x32_bf16 v[128:131], a[200:203], a[16:19], v[128:131]
    s_add_u32 s38, s47, 163840
    ds_read_b64_tr_b16 a[194:195], v9 offset:18432
    v_cvt_pk_bf16_f32 v20, 0, v20
    v_mfma_f32_16x16x32_bf16 v[128:131], a[204:207], a[32:35], v[128:131]
    buffer_store_dwordx4 v[120:123], v38, s[24:27], s79 offen offset:2048 sc1
    v_cvt_pk_bf16_f32 v21, 0, v21
    v_mfma_f32_16x16x32_bf16 v[136:139], a[204:207], a[36:39], v[136:139]
    s_addk_i32 m0, -4096
    ds_read_b64_tr_b16 a[196:197], v9 offset:20480
    v_mul_f32 v20, v20, v17
    v_mfma_f32_16x16x32_bf16 v[136:139], a[200:203], a[20:23], v[136:139]
    buffer_load_dwordx4 v3, s[8:11], s38 offen lds
    v_mfma_f32_16x16x32_bf16 v[144:147], a[200:203], a[24:27], v[144:147]
    ds_read_b64_tr_b16 a[198:199], v9 offset:22528
    v_mul_f32 v21, v21, v17
    v_mfma_f32_16x16x32_bf16 v[144:147], a[204:207], a[40:43], v[144:147]
    v_lshlrev_b32 v17, 6, v2
    v_cvt_pk_bf16_f32 v20, 0, v20
    v_mfma_f32_16x16x32_bf16 v[152:155], a[204:207], a[44:47], v[152:155]
    s_add_u32 s38, s45, 204800
    v_cvt_pk_bf16_f32 v21, 0, v21
    v_mul_f32 v23, s92, v20
    v_mfma_f32_16x16x32_bf16 v[152:155], a[200:203], a[28:31], v[152:155]
    v_exp_f32 v23, v23
    v_mfma_f32_16x16x32_bf16 v[156:159], a[208:211], a[28:31], v[156:159]
    s_addk_i32 m0, -4096
    v_mul_f32 v36, s92, v21
    v_add_f32 v23, 1.0, v23
    v_mfma_f32_16x16x32_bf16 v[156:159], a[212:215], a[44:47], v[156:159]
    v_exp_f32 v36, v36
    v_mfma_f32_16x16x32_bf16 v[148:151], a[212:215], a[40:43], v[148:151]
    s_barrier
    v_mfma_f32_16x16x32_bf16 v[148:151], a[208:211], a[24:27], v[148:151]
    s_waitcnt vmcnt(10)
    ds_read_b64_tr_b16 a[200:201], v8 offset:24576
    v_xor_b32 v58, s58, v58
    v_mfma_f32_16x16x32_bf16 v[140:143], a[208:211], a[20:23], v[140:143]
    s_waitcnt vmcnt(9)
    ds_read_b64_tr_b16 a[202:203], v8 offset:26624
    v_xor_b32 v59, s58, v59
    v_mfma_f32_16x16x32_bf16 v[140:143], a[212:215], a[36:39], v[140:143]
    s_waitcnt lgkmcnt(2)
    ds_read_b64_tr_b16 a[204:205], v8 offset:28672
    v_or_b32 v58, v58, v59
    v_mfma_f32_16x16x32_bf16 v[132:135], a[212:215], a[32:35], v[132:135]
    buffer_load_dwordx4 v3, s[8:11], s38 offen lds
    v_mfma_f32_16x16x32_bf16 v[132:135], a[208:211], a[16:19], v[132:135]
    ds_read_b64_tr_b16 a[206:207], v8 offset:30720
    v_cmp_ne_u32 vcc, 0, v58
    v_mfma_f32_16x16x32_bf16 v[128:131], a[184:187], a[48:51], v[128:131]
    s_cbranch_vccnz spin_y
spin_y_ret:
    v_add_f32 v36, 1.0, v36
    v_mfma_f32_16x16x32_bf16 v[128:131], a[188:191], a[64:67], v[128:131]
    ds_read_b64_tr_b16 a[208:209], v9 offset:24576
    v_cndmask_b32 v124, v116, v124, s[74:75]
    v_mfma_f32_16x16x32_bf16 v[136:139], a[188:191], a[68:71], v[136:139]
    s_add_u32 s38, s46, 204800
    ds_read_b64_tr_b16 a[210:211], v9 offset:26624
    v_cndmask_b32 v125, v117, v125, s[74:75]
    v_mfma_f32_16x16x32_bf16 v[136:139], a[184:187], a[52:55], v[136:139]
    ds_read_b64_tr_b16 a[212:213], v9 offset:28672
    v_cndmask_b32 v126, v118, v126, s[74:75]
    v_mfma_f32_16x16x32_bf16 v[144:147], a[184:187], a[56:59], v[144:147]
    s_addk_i32 m0, -4096
    ds_read_b64_tr_b16 a[214:215], v9 offset:30720
    v_cndmask_b32 v127, v119, v127, s[74:75]
    v_mfma_f32_16x16x32_bf16 v[144:147], a[188:191], a[72:75], v[144:147]
    buffer_load_dwordx4 v[116:119], v55, s[24:27], s55 offen sc1
    v_mfma_f32_16x16x32_bf16 v[152:155], a[188:191], a[76:79], v[152:155]
    s_add_u32 s55, s55, 10240
    v_rcp_f32 v23, v23
    v_mfma_f32_16x16x32_bf16 v[152:155], a[184:187], a[60:63], v[152:155]
    buffer_load_dwordx4 v[120:123], v55, s[24:27], s55 offen sc1
    v_mfma_f32_16x16x32_bf16 v[156:159], a[192:195], a[60:63], v[156:159]
    s_add_u32 s55, s55, 10240
    ds_read_b64_tr_b16 a[184:185], v8 offset:32768
    v_mul_f32 v20, v20, v23
    v_mfma_f32_16x16x32_bf16 v[156:159], a[196:199], a[76:79], v[156:159]
    buffer_load_dwordx4 v[56:59], v55, s[24:27], s55 offen sc1
    v_mfma_f32_16x16x32_bf16 v[148:151], a[196:199], a[72:75], v[148:151]
    buffer_load_dwordx4 v3, s[8:11], s38 offen lds
    v_mfma_f32_16x16x32_bf16 v[148:151], a[192:195], a[56:59], v[148:151]
    s_add_u32 s55, s55, 10240
    ds_read_b64_tr_b16 a[186:187], v8 offset:34816
    v_mfma_f32_16x16x32_bf16 v[140:143], a[192:195], a[52:55], v[140:143]
    buffer_load_dwordx4 v[60:63], v55, s[24:27], s55 offen sc1
    v_mfma_f32_16x16x32_bf16 v[140:143], a[196:199], a[68:71], v[140:143]
    s_waitcnt lgkmcnt(2)
    ds_read_b64_tr_b16 a[188:189], v8 offset:36864
    s_add_u32 s55, s55, 10240
    v_mfma_f32_16x16x32_bf16 v[132:135], a[196:199], a[64:67], v[132:135]
    s_add_u32 s38, s47, 204800
    ds_read_b64_tr_b16 a[190:191], v8 offset:38912
    v_mfma_f32_16x16x32_bf16 v[132:135], a[192:195], a[48:51], v[132:135]
    ds_read_b64_tr_b16 a[192:193], v9 offset:32768
    v_mfma_f32_16x16x32_bf16 v[128:131], a[200:203], a[216:219], v[128:131]
    buffer_load_dwordx4 v[64:67], v55, s[24:27], s55 offen sc1
    v_mfma_f32_16x16x32_bf16 v[128:131], a[204:207], a[232:235], v[128:131]
    s_add_u32 s55, s55, 10240
    ds_read_b64_tr_b16 a[194:195], v9 offset:34816
    s_addk_i32 m0, -4096
    v_mfma_f32_16x16x32_bf16 v[136:139], a[204:207], a[236:239], v[136:139]
    ds_read_b64_tr_b16 a[196:197], v9 offset:36864
    v_mfma_f32_16x16x32_bf16 v[136:139], a[200:203], a[220:223], v[136:139]
    ds_read_b64_tr_b16 a[198:199], v9 offset:38912
    v_mfma_f32_16x16x32_bf16 v[144:147], a[200:203], a[224:227], v[144:147]
    buffer_load_dwordx4 v[68:71], v55, s[24:27], s55 offen sc1
    v_mfma_f32_16x16x32_bf16 v[144:147], a[204:207], a[240:243], v[144:147]
    s_add_u32 s55, s55, 10240
    v_rcp_f32 v36, v36
    v_mfma_f32_16x16x32_bf16 v[152:155], a[204:207], a[244:247], v[152:155]
    buffer_load_dwordx4 v3, s[8:11], s38 offen lds
    v_mfma_f32_16x16x32_bf16 v[152:155], a[200:203], a[228:231], v[152:155]
    ds_read_b64_tr_b16 a[200:201], v8 offset:40960
    v_mul_f32 v21, v21, v36
    v_mfma_f32_16x16x32_bf16 v[156:159], a[208:211], a[228:231], v[156:159]
    buffer_load_dwordx4 v[72:75], v55, s[24:27], s55 offen sc1
    v_mfma_f32_16x16x32_bf16 v[156:159], a[212:215], a[244:247], v[156:159]
    s_add_u32 s55, s55, 10240
    ds_read_b64_tr_b16 a[202:203], v8 offset:43008
    v_cvt_pk_bf16_f32 v43, v20, v21
    v_mfma_f32_16x16x32_bf16 v[148:151], a[212:215], a[240:243], v[148:151]
    ds_read_b64_tr_b16 a[204:205], v8 offset:45056
    v_lshlrev_b32 v20, 16, v28
    v_mfma_f32_16x16x32_bf16 v[148:151], a[208:211], a[224:227], v[148:151]
    s_waitcnt lgkmcnt(3)
    ds_read_b64_tr_b16 a[206:207], v8 offset:47104
    v_add_u32 v8, 90112, v8
    v_mfma_f32_16x16x32_bf16 v[140:143], a[208:211], a[220:223], v[140:143]
    buffer_load_dwordx4 v[76:79], v55, s[24:27], s55 offen sc1
    v_mfma_f32_16x16x32_bf16 v[140:143], a[212:215], a[236:239], v[140:143]
    s_add_u32 s55, s55, 10240
    v_and_b32 v21, 0xffff0000, v28
    v_sub_f32 v20, v20, v18
    v_mfma_f32_16x16x32_bf16 v[132:135], a[212:215], a[232:235], v[132:135]
    v_sub_f32 v21, v21, v18
    v_cvt_pk_bf16_f32 v20, 0, v20
    v_mfma_f32_16x16x32_bf16 v[132:135], a[208:211], a[216:219], v[132:135]
    ds_read_b64_tr_b16 a[208:209], v9 offset:40960
    v_cvt_pk_bf16_f32 v21, 0, v21
    v_mfma_f32_16x16x32_bf16 v[128:131], a[184:187], a[152:155], v[128:131]
    buffer_load_dwordx4 v[80:83], v55, s[24:27], s55 offen sc1
    v_mfma_f32_16x16x32_bf16 v[128:131], a[188:191], a[168:171], v[128:131]
    s_add_u32 s55, s55, 10240
    ds_read_b64_tr_b16 a[210:211], v9 offset:43008
    v_mul_f32 v20, v20, v19
    v_mfma_f32_16x16x32_bf16 v[136:139], a[188:191], a[172:175], v[136:139]
    ds_read_b64_tr_b16 a[212:213], v9 offset:45056
    v_mul_f32 v21, v21, v19
    v_mfma_f32_16x16x32_bf16 v[136:139], a[184:187], a[156:159], v[136:139]
    ds_read_b64_tr_b16 a[214:215], v9 offset:47104
    v_add_u32 v9, 90112, v9
    v_mfma_f32_16x16x32_bf16 v[144:147], a[184:187], a[160:163], v[144:147]
    buffer_load_dwordx4 v[84:87], v55, s[24:27], s55 offen sc1
    v_mfma_f32_16x16x32_bf16 v[144:147], a[188:191], a[176:179], v[144:147]
    s_add_u32 s55, s55, 10240
    v_cvt_pk_bf16_f32 v20, 0, v20
    v_cvt_pk_bf16_f32 v21, 0, v21
    v_mfma_f32_16x16x32_bf16 v[152:155], a[188:191], a[180:183], v[152:155]
    v_mul_f32 v23, s92, v20
    v_mul_f32 v36, s92, v21
    v_mfma_f32_16x16x32_bf16 v[152:155], a[184:187], a[164:167], v[152:155]
    ds_read_b64_tr_b16 a[184:185], v10 offset:0
    v_mfma_f32_16x16x32_bf16 v[156:159], a[192:195], a[164:167], v[156:159]
    buffer_load_dwordx4 v[88:91], v55, s[24:27], s55 offen sc1
    v_mfma_f32_16x16x32_bf16 v[156:159], a[196:199], a[180:183], v[156:159]
    s_add_u32 s55, s55, 10240
    ds_read_b64_tr_b16 a[186:187], v10 offset:2048
    v_mfma_f32_16x16x32_bf16 v[148:151], a[196:199], a[176:179], v[148:151]
    ds_read_b64_tr_b16 a[188:189], v10 offset:4096
    v_mfma_f32_16x16x32_bf16 v[148:151], a[192:195], a[160:163], v[148:151]
    s_waitcnt lgkmcnt(3)
    ds_read_b64_tr_b16 a[190:191], v10 offset:6144
    v_mfma_f32_16x16x32_bf16 v[140:143], a[192:195], a[156:159], v[140:143]
    buffer_load_dwordx4 v[92:95], v55, s[24:27], s55 offen sc1
    v_mfma_f32_16x16x32_bf16 v[140:143], a[196:199], a[172:175], v[140:143]
    v_exp_f32 v23, v23
    v_mfma_f32_16x16x32_bf16 v[132:135], a[196:199], a[168:171], v[132:135]
    v_exp_f32 v36, v36
    v_mfma_f32_16x16x32_bf16 v[132:135], a[192:195], a[152:155], v[132:135]
    ds_read_b64_tr_b16 a[192:193], v11 offset:0
    v_add_f32 v23, 1.0, v23
    v_mfma_f32_16x16x32_bf16 v[128:131], a[200:203], a[80:83], v[128:131]
    ds_read_b64_tr_b16 a[194:195], v11 offset:2048
    v_add_f32 v36, 1.0, v36
    v_mfma_f32_16x16x32_bf16 v[128:131], a[204:207], a[96:99], v[128:131]
    ds_read_b64_tr_b16 a[196:197], v11 offset:4096
    v_mfma_f32_16x16x32_bf16 v[136:139], a[204:207], a[100:103], v[136:139]
    s_load_dwordx8 s[28:35], s[86:87], s93 glc
    ds_read_b64_tr_b16 a[198:199], v11 offset:6144
    v_mfma_f32_16x16x32_bf16 v[136:139], a[200:203], a[84:87], v[136:139]
    v_rcp_f32 v23, v23
    v_mfma_f32_16x16x32_bf16 v[144:147], a[200:203], a[88:91], v[144:147]
    v_rcp_f32 v36, v36
    v_mfma_f32_16x16x32_bf16 v[144:147], a[204:207], a[104:107], v[144:147]
    s_xor_b32 s78, s53, 7
    v_cvt_pk_bf16_f32 v128, v128, v129
    v_cvt_pk_bf16_f32 v129, v130, v131
    v_mfma_f32_16x16x32_bf16 v[152:155], a[204:207], a[108:111], v[152:155]
    s_mul_i32 s78, s78, 2560
    v_cvt_pk_bf16_f32 v136, v136, v137
    v_cvt_pk_bf16_f32 v137, v138, v139
    v_mfma_f32_16x16x32_bf16 v[152:155], a[200:203], a[92:95], v[152:155]
    s_add_u32 s78, s78, s60
    ds_read_b64_tr_b16 a[200:201], v10 offset:8192
    v_cvt_pk_bf16_f32 v144, v144, v145
    v_mfma_f32_16x16x32_bf16 v[156:159], a[208:211], a[92:95], v[156:159]
    s_xor_b32 s79, s53, 6
    ds_read_b64_tr_b16 a[202:203], v10 offset:10240
    v_cvt_pk_bf16_f32 v145, v146, v147
    v_mfma_f32_16x16x32_bf16 v[156:159], a[212:215], a[108:111], v[156:159]
    s_mul_i32 s79, s79, 2560
    ds_read_b64_tr_b16 a[204:205], v10 offset:12288
    v_cvt_pk_bf16_f32 v152, v152, v153
    v_mfma_f32_16x16x32_bf16 v[148:151], a[212:215], a[104:107], v[148:151]
    s_waitcnt lgkmcnt(5)
    ds_read_b64_tr_b16 a[206:207], v10 offset:14336
    v_cvt_pk_bf16_f32 v153, v154, v155
    v_mfma_f32_16x16x32_bf16 v[148:151], a[208:211], a[88:91], v[148:151]
    s_add_u32 s79, s79, s60
    v_cvt_pk_bf16_f32 v154, v156, v157
    v_cvt_pk_bf16_f32 v155, v158, v159
    v_mfma_f32_16x16x32_bf16 v[140:143], a[208:211], a[84:87], v[140:143]
    s_lshl_b32 s56, s3, 9
    v_mul_f32 v20, v20, v23
    v_mul_f32 v21, v21, v36
    v_mfma_f32_16x16x32_bf16 v[140:143], a[212:215], a[100:103], v[140:143]
    s_add_u32 s56, s56, 61440
    v_cvt_pk_bf16_f32 v146, v148, v149
    v_cvt_pk_bf16_f32 v147, v150, v151
    v_mfma_f32_16x16x32_bf16 v[132:135], a[212:215], a[96:99], v[132:135]
    v_cvt_pk_bf16_f32 v44, v20, v21
    v_lshlrev_b32 v20, 16, v29
    v_mfma_f32_16x16x32_bf16 v[132:135], a[208:211], a[80:83], v[132:135]
    ds_read_b64_tr_b16 a[208:209], v11 offset:8192
    v_cvt_pk_bf16_f32 v138, v140, v141
    v_mfma_f32_16x16x32_bf16 v[160:163], a[184:187], a[128:131], v[160:163]
    ds_read_b64_tr_b16 a[210:211], v11 offset:10240
    v_cvt_pk_bf16_f32 v139, v142, v143
    v_mfma_f32_16x16x32_bf16 v[160:163], a[188:191], a[0:3], v[160:163]
    ds_read_b64_tr_b16 a[212:213], v11 offset:12288
    v_and_b32 v21, 0xffff0000, v29
    v_mfma_f32_16x16x32_bf16 v[168:171], a[188:191], a[4:7], v[168:171]
    ds_read_b64_tr_b16 a[214:215], v11 offset:14336
    v_cvt_pk_bf16_f32 v130, v132, v133
    v_mfma_f32_16x16x32_bf16 v[168:171], a[184:187], a[132:135], v[168:171]
    v_cvt_pk_bf16_f32 v131, v134, v135
    v_sub_f32 v20, v20, v18
    v_mfma_f32_16x16x32_bf16 v[176:179], a[184:187], a[136:139], v[176:179]
    buffer_store_dwordx4 v[128:131], v14, s[24:27], s78 offen offset:1024 sc1
    v_sub_f32 v21, v21, v18
    v_mfma_f32_16x16x32_bf16 v[176:179], a[188:191], a[8:11], v[176:179]
    buffer_store_dwordx4 v[136:139], v14, s[24:27], s78 offen offset:0 sc1
    v_cvt_pk_bf16_f32 v20, 0, v20
    v_mfma_f32_16x16x32_bf16 v[184:187], a[188:191], a[12:15], v[184:187]
    s_waitcnt lgkmcnt(5)
    v_cvt_pk_bf16_f32 v21, 0, v21
    v_mul_f32 v20, v20, v19
    v_mfma_f32_16x16x32_bf16 v[184:187], a[184:187], a[140:143], v[184:187]
    ds_read_b64_tr_b16 a[184:185], v10 offset:16384
    v_mul_f32 v21, v21, v19
    v_mfma_f32_16x16x32_bf16 v[188:191], a[192:195], a[140:143], v[188:191]
    ds_read_b64_tr_b16 a[186:187], v10 offset:18432
    v_cvt_pk_bf16_f32 v20, 0, v20
    v_mfma_f32_16x16x32_bf16 v[188:191], a[196:199], a[12:15], v[188:191]
    ds_read_b64_tr_b16 a[188:189], v10 offset:20480
    v_cvt_pk_bf16_f32 v21, 0, v21
    v_mfma_f32_16x16x32_bf16 v[180:183], a[196:199], a[8:11], v[180:183]
    ds_read_b64_tr_b16 a[190:191], v10 offset:22528
    v_mul_f32 v23, s92, v20
    v_mfma_f32_16x16x32_bf16 v[180:183], a[192:195], a[136:139], v[180:183]
    buffer_store_dwordx4 v[144:147], v14, s[24:27], s79 offen offset:1024 sc1
    v_mul_f32 v36, s92, v21
    v_mfma_f32_16x16x32_bf16 v[172:175], a[192:195], a[132:135], v[172:175]
    v_exp_f32 v23, v23
    v_mfma_f32_16x16x32_bf16 v[172:175], a[196:199], a[4:7], v[172:175]
    s_or_b64 s[88:89], s[28:29], s[30:31]
    v_exp_f32 v36, v36
    v_mfma_f32_16x16x32_bf16 v[164:167], a[196:199], a[0:3], v[164:167]
    s_waitcnt lgkmcnt(5)
    v_add_f32 v23, 1.0, v23
    v_add_f32 v36, 1.0, v36
    v_mfma_f32_16x16x32_bf16 v[164:167], a[192:195], a[128:131], v[164:167]
    s_or_b64 s[88:89], s[88:89], s[32:33]
    ds_read_b64_tr_b16 a[192:193], v11 offset:16384
    v_cmp_eq_u32 s[8:9], s39, v5
    v_mfma_f32_16x16x32_bf16 v[160:163], a[200:203], a[16:19], v[160:163]
    s_load_dwordx8 s[28:35], s[86:87], s93 glc
    ds_read_b64_tr_b16 a[194:195], v11 offset:18432
    v_cmp_eq_u32 s[20:21], s40, v5
    v_mfma_f32_16x16x32_bf16 v[160:163], a[204:207], a[32:35], v[160:163]
    buffer_store_dwordx4 v[152:155], v14, s[24:27], s79 offen offset:0 sc1
    v_lshl_add_u32 v12, v1, 3, s56
    v_mfma_f32_16x16x32_bf16 v[168:171], a[204:207], a[36:39], v[168:171]
    s_or_b64 s[88:89], s[88:89], s[34:35]
    ds_read_b64_tr_b16 a[196:197], v11 offset:20480
    s_or_b32 s66, s88, s89
    v_mfma_f32_16x16x32_bf16 v[168:171], a[200:203], a[20:23], v[168:171]
    s_andn2_b32 s69, s66, s80
    s_cselect_b32 s65, s59, 0x70000000
    s_ff1_i32_b32 s69, s69
    v_mfma_f32_16x16x32_bf16 v[176:179], a[200:203], a[24:27], v[176:179]
pg_15:
    s_cbranch_execz pg_backL
    s_xor_b32 s81, s53, s69
    ds_read_b64_tr_b16 a[198:199], v11 offset:22528
    s_mul_i32 s81, s81, 20480
    v_mfma_f32_16x16x32_bf16 v[176:179], a[204:207], a[40:43], v[176:179]
    s_add_u32 s81, s81, s65
    v_rcp_f32 v23, v23
    v_mfma_f32_16x16x32_bf16 v[184:187], a[204:207], a[44:47], v[184:187]
    s_waitcnt lgkmcnt(7)
    v_rcp_f32 v36, v36
    v_mfma_f32_16x16x32_bf16 v[184:187], a[200:203], a[28:31], v[184:187]
    s_bitset1_b32 s80, s69
    ds_read_b64_tr_b16 a[200:201], v10 offset:24576
    v_mul_f32 v20, v20, v23
    v_mfma_f32_16x16x32_bf16 v[188:191], a[208:211], a[28:31], v[188:191]
    s_waitcnt vmcnt(16)
    ds_read_b64_tr_b16 a[202:203], v10 offset:26624
    v_mul_f32 v21, v21, v36
    v_mfma_f32_16x16x32_bf16 v[188:191], a[212:215], a[44:47], v[188:191]
    s_or_b64 s[8:9], s[8:9], s[20:21]
    ds_read_b64_tr_b16 a[204:205], v10 offset:28672
    v_cvt_pk_bf16_f32 v45, v20, v21
    v_mfma_f32_16x16x32_bf16 v[180:183], a[212:215], a[40:43], v[180:183]
    ds_read_b64_tr_b16 a[206:207], v10 offset:30720
    v_lshlrev_b32 v20, 16, v30
    v_mfma_f32_16x16x32_bf16 v[180:183], a[208:211], a[24:27], v[180:183]
    s_waitcnt lgkmcnt(8)
    v_and_b32 v21, 0xffff0000, v30
    v_sub_f32 v20, v20, v18
    v_mfma_f32_16x16x32_bf16 v[172:175], a[208:211], a[20:23], v[172:175]
    v_sub_f32 v21, v21, v18
    v_cvt_pk_bf16_f32 v20, 0, v20
    v_mfma_f32_16x16x32_bf16 v[172:175], a[212:215], a[36:39], v[172:175]
    v_cvt_pk_bf16_f32 v21, 0, v21
    v_mul_f32 v20, v20, v19
    v_mfma_f32_16x16x32_bf16 v[164:167], a[212:215], a[32:35], v[164:167]
    v_mul_f32 v21, v21, v19
    v_cvt_pk_bf16_f32 v20, 0, v20
    v_mfma_f32_16x16x32_bf16 v[164:167], a[208:211], a[16:19], v[164:167]
    buffer_load_dwordx4 v[98:101], v14, s[24:27], s81 offen sc1
    v_mfma_f32_16x16x32_bf16 v[160:163], a[184:187], a[48:51], v[160:163]
    ds_read_b64_tr_b16 a[208:209], v11 offset:24576
    v_cvt_pk_bf16_f32 v21, 0, v21
    v_mfma_f32_16x16x32_bf16 v[160:163], a[188:191], a[64:67], v[160:163]
    ds_read_b64_tr_b16 a[210:211], v11 offset:26624
    v_mul_f32 v23, s92, v20
    v_mfma_f32_16x16x32_bf16 v[168:171], a[188:191], a[68:71], v[168:171]
    buffer_load_dwordx4 v[102:105], v14, s[24:27], s81 offen offset:1024 sc1
    v_mfma_f32_16x16x32_bf16 v[168:171], a[184:187], a[52:55], v[168:171]
    ds_read_b64_tr_b16 a[212:213], v11 offset:28672
    v_mul_f32 v36, s92, v21
    v_mfma_f32_16x16x32_bf16 v[176:179], a[184:187], a[56:59], v[176:179]
    s_waitcnt lgkmcnt(7)
    ds_read_b64_tr_b16 a[214:215], v11 offset:30720
    v_add_f32 v116, v116, v120
    v_mfma_f32_16x16x32_bf16 v[176:179], a[188:191], a[72:75], v[176:179]
    buffer_load_dwordx2 v[96:97], v39, s[24:27], s81 offen offset:2048 sc1
    v_mfma_f32_16x16x32_bf16 v[184:187], a[188:191], a[76:79], v[184:187]
    s_waitcnt vmcnt(18)
    v_exp_f32 v23, v23
    v_mfma_f32_16x16x32_bf16 v[184:187], a[184:187], a[60:63], v[184:187]
    ds_read_b64_tr_b16 a[184:185], v10 offset:32768
    v_add_f32 v23, 1.0, v23
    v_mfma_f32_16x16x32_bf16 v[188:191], a[192:195], a[60:63], v[188:191]
    ds_read_b64_tr_b16 a[186:187], v10 offset:34816
    v_add_f32 v117, v117, v121
    v_mfma_f32_16x16x32_bf16 v[188:191], a[196:199], a[76:79], v[188:191]
    ds_read_b64_tr_b16 a[188:189], v10 offset:36864
    v_add_f32 v118, v118, v122
    v_mfma_f32_16x16x32_bf16 v[180:183], a[196:199], a[72:75], v[180:183]
    s_waitcnt lgkmcnt(6)
    ds_read_b64_tr_b16 a[190:191], v10 offset:38912
    v_add_f32 v119, v119, v123
    v_mfma_f32_16x16x32_bf16 v[180:183], a[192:195], a[56:59], v[180:183]
    v_exp_f32 v36, v36
    v_mfma_f32_16x16x32_bf16 v[172:175], a[192:195], a[52:55], v[172:175]
    v_rcp_f32 v23, v23
    v_mfma_f32_16x16x32_bf16 v[172:175], a[196:199], a[68:71], v[172:175]
    v_add_f32 v36, 1.0, v36
    v_mul_f32 v20, v20, v23
    v_mfma_f32_16x16x32_bf16 v[164:167], a[196:199], a[64:67], v[164:167]
    v_rcp_f32 v36, v36
    v_mfma_f32_16x16x32_bf16 v[164:167], a[192:195], a[48:51], v[164:167]
    ds_read_b64_tr_b16 a[192:193], v11 offset:32768
    v_mul_f32 v21, v21, v36
    v_mfma_f32_16x16x32_bf16 v[160:163], a[200:203], a[216:219], v[160:163]
    s_or_b64 s[88:89], s[28:29], s[30:31]
    ds_read_b64_tr_b16 a[194:195], v11 offset:34816
    v_cvt_pk_bf16_f32 v46, v20, v21
    v_mfma_f32_16x16x32_bf16 v[160:163], a[204:207], a[232:235], v[160:163]
    s_or_b64 s[88:89], s[88:89], s[32:33]
    ds_read_b64_tr_b16 a[196:197], v11 offset:36864
    v_lshlrev_b32 v20, 16, v31
    v_mfma_f32_16x16x32_bf16 v[168:171], a[204:207], a[236:239], v[168:171]
    s_or_b64 s[88:89], s[88:89], s[34:35]
    ds_read_b64_tr_b16 a[198:199], v11 offset:38912
    v_and_b32 v21, 0xffff0000, v31
    v_mfma_f32_16x16x32_bf16 v[168:171], a[200:203], a[220:223], v[168:171]
    s_waitcnt lgkmcnt(6)
    v_sub_f32 v20, v20, v18
    v_sub_f32 v21, v21, v18
    v_mfma_f32_16x16x32_bf16 v[176:179], a[200:203], a[224:227], v[176:179]
    s_or_b32 s66, s88, s89
    v_cvt_pk_bf16_f32 v20, 0, v20
    v_cvt_pk_bf16_f32 v21, 0, v21
    v_mfma_f32_16x16x32_bf16 v[176:179], a[204:207], a[240:243], v[176:179]
    v_mul_f32 v20, v20, v19
    v_mul_f32 v21, v21, v19
    v_mfma_f32_16x16x32_bf16 v[184:187], a[204:207], a[244:247], v[184:187]
    s_andn2_b32 s69, s66, s80
    s_cselect_b32 s65, s59, 0x70000000
    v_cvt_pk_bf16_f32 v20, 0, v20
    v_mfma_f32_16x16x32_bf16 v[184:187], a[200:203], a[228:231], v[184:187]
    s_ff1_i32_b32 s69, s69
    ds_read_b64_tr_b16 a[200:201], v10 offset:40960
    v_cvt_pk_bf16_f32 v21, 0, v21
    v_mfma_f32_16x16x32_bf16 v[188:191], a[208:211], a[228:231], v[188:191]
    s_xor_b32 s72, s53, s69
    ds_read_b64_tr_b16 a[202:203], v10 offset:43008
    v_mul_f32 v23, s92, v20
    v_mfma_f32_16x16x32_bf16 v[188:191], a[212:215], a[244:247], v[188:191]
    s_mul_i32 s72, s72, 20480
    ds_read_b64_tr_b16 a[204:205], v10 offset:45056
    v_mul_f32 v36, s92, v21
    v_mfma_f32_16x16x32_bf16 v[180:183], a[212:215], a[240:243], v[180:183]
    s_add_u32 s72, s72, s65
    ds_read_b64_tr_b16 a[206:207], v10 offset:47104
    v_add_u32 v10, 90112, v10
    v_mfma_f32_16x16x32_bf16 v[180:183], a[208:211], a[224:227], v[180:183]
    s_bitset1_b32 s80, s69
    v_exp_f32 v23, v23
    v_mfma_f32_16x16x32_bf16 v[172:175], a[208:211], a[220:223], v[172:175]
    v_exp_f32 v36, v36
    v_mfma_f32_16x16x32_bf16 v[172:175], a[212:215], a[236:239], v[172:175]
    v_add_f32 v23, 1.0, v23
    v_add_f32 v36, 1.0, v36
    v_mfma_f32_16x16x32_bf16 v[164:167], a[212:215], a[232:235], v[164:167]
    s_waitcnt lgkmcnt(5)
    v_rcp_f32 v23, v23
    v_mfma_f32_16x16x32_bf16 v[164:167], a[208:211], a[216:219], v[164:167]
    ds_read_b64_tr_b16 a[208:209], v11 offset:40960
    v_mul_f32 v20, v20, v23
    v_mfma_f32_16x16x32_bf16 v[160:163], a[184:187], a[152:155], v[160:163]
    ds_read_b64_tr_b16 a[210:211], v11 offset:43008
    v_add_f32 v116, v116, v56
    v_mfma_f32_16x16x32_bf16 v[160:163], a[188:191], a[168:171], v[160:163]
    s_waitcnt vmcnt(16)
    ds_read_b64_tr_b16 a[212:213], v11 offset:45056
    v_add_f32 v117, v117, v57
    v_mfma_f32_16x16x32_bf16 v[168:171], a[188:191], a[172:175], v[168:171]
    buffer_load_dwordx4 v[108:111], v14, s[24:27], s72 offen sc1
    v_mfma_f32_16x16x32_bf16 v[168:171], a[184:187], a[156:159], v[168:171]
    s_waitcnt vmcnt(4)
    ds_read_b64_tr_b16 a[214:215], v11 offset:47104
    v_add_u32 v11, 90112, v11
    v_mfma_f32_16x16x32_bf16 v[176:179], a[184:187], a[160:163], v[176:179]
    buffer_store_dword v17, v7, s[24:27], s67 offen offset:24 sc1
    v_mfma_f32_16x16x32_bf16 v[176:179], a[188:191], a[176:179], v[176:179]
    buffer_load_dwordx4 v[112:115], v14, s[24:27], s72 offen offset:1024 sc1
    v_mfma_f32_16x16x32_bf16 v[184:187], a[188:191], a[180:183], v[184:187]
    s_waitcnt lgkmcnt(3)
    v_lshlrev_b32 v17, 2, v2
    v_add_f32 v118, v118, v58
    v_mfma_f32_16x16x32_bf16 v[184:187], a[184:187], a[164:167], v[184:187]
    s_xor_b32 s67, s50, 1
    v_rcp_f32 v36, v36
    v_mfma_f32_16x16x32_bf16 v[188:191], a[192:195], a[164:167], v[188:191]
    buffer_load_dwordx2 v[106:107], v39, s[24:27], s72 offen offset:2048 sc1
    v_mfma_f32_16x16x32_bf16 v[188:191], a[196:199], a[180:183], v[188:191]
    s_lshl_b32 s67, s67, 10
    v_mul_f32 v21, v21, v36
    v_cvt_pk_bf16_f32 v47, v20, v21
    v_mfma_f32_16x16x32_bf16 v[180:183], a[196:199], a[176:179], v[180:183]
    s_barrier
    v_mfma_f32_16x16x32_bf16 v[180:183], a[192:195], a[160:163], v[180:183]
    s_add_u32 s67, s61, s67
    ds_read_b64_tr_b16 a[184:185], v8 offset:45056
    v_add_f32 v119, v119, v59
    v_mfma_f32_16x16x32_bf16 v[172:175], a[192:195], a[156:159], v[172:175]
    ds_read_b64_tr_b16 a[186:187], v8 offset:47104
    v_add_f32 v116, v116, v60
    v_mfma_f32_16x16x32_bf16 v[172:175], a[196:199], a[172:175], v[172:175]
    ds_read_b64_tr_b16 a[188:189], v8 offset:40960
    v_add_f32 v117, v117, v61
    v_mfma_f32_16x16x32_bf16 v[164:167], a[196:199], a[168:171], v[164:167]
    ds_read_b64_tr_b16 a[190:191], v8 offset:43008
    v_add_f32 v118, v118, v62
    v_mfma_f32_16x16x32_bf16 v[164:167], a[192:195], a[152:155], v[164:167]
    ds_read_b64_tr_b16 a[192:193], v9 offset:45056
    v_add_f32 v119, v119, v63
    v_mfma_f32_16x16x32_bf16 v[160:163], a[200:203], a[80:83], v[160:163]
    s_load_dwordx8 s[28:35], s[86:87], s93 glc
    ds_read_b64_tr_b16 a[194:195], v9 offset:47104
    v_add_f32 v116, v116, v64
    v_mfma_f32_16x16x32_bf16 v[160:163], a[204:207], a[96:99], v[160:163]
    ds_read_b64_tr_b16 a[196:197], v9 offset:40960
    v_add_f32 v117, v117, v65
    v_mfma_f32_16x16x32_bf16 v[168:171], a[204:207], a[100:103], v[168:171]
    ds_read_b64_tr_b16 a[198:199], v9 offset:43008
    v_add_f32 v118, v118, v66
    v_mfma_f32_16x16x32_bf16 v[168:171], a[200:203], a[84:87], v[168:171]
    s_waitcnt lgkmcnt(8)
    v_add_f32 v119, v119, v67
    v_cvt_pk_bf16_f32 v160, v160, v161
    v_mfma_f32_16x16x32_bf16 v[176:179], a[200:203], a[88:91], v[176:179]
    v_cvt_pk_bf16_f32 v161, v162, v163
    v_add_f32 v116, v116, v68
    v_mfma_f32_16x16x32_bf16 v[176:179], a[204:207], a[104:107], v[176:179]
    s_xor_b32 s78, s53, 5
    v_cvt_pk_bf16_f32 v168, v168, v169
    v_cvt_pk_bf16_f32 v169, v170, v171
    v_mfma_f32_16x16x32_bf16 v[184:187], a[204:207], a[108:111], v[184:187]
    s_mul_i32 s78, s78, 2560
    v_add_f32 v117, v117, v69
    v_add_f32 v118, v118, v70
    v_mfma_f32_16x16x32_bf16 v[184:187], a[200:203], a[92:95], v[184:187]
    s_add_u32 s78, s78, s60
    ds_read_b64_tr_b16 a[200:201], v8 offset:36864
    v_cvt_pk_bf16_f32 v176, v176, v177
    v_mfma_f32_16x16x32_bf16 v[188:191], a[208:211], a[92:95], v[188:191]
    s_xor_b32 s79, s53, 4
    ds_read_b64_tr_b16 a[202:203], v8 offset:38912
    v_cvt_pk_bf16_f32 v177, v178, v179
    v_mfma_f32_16x16x32_bf16 v[188:191], a[212:215], a[108:111], v[188:191]
    s_mul_i32 s79, s79, 2560
    ds_read_b64_tr_b16 a[204:205], v8 offset:32768
    v_cvt_pk_bf16_f32 v184, v184, v185
    v_mfma_f32_16x16x32_bf16 v[180:183], a[212:215], a[104:107], v[180:183]
    s_waitcnt lgkmcnt(5)
    ds_read_b64_tr_b16 a[206:207], v8 offset:34816
    v_cvt_pk_bf16_f32 v185, v186, v187
    v_mfma_f32_16x16x32_bf16 v[180:183], a[208:211], a[88:91], v[180:183]
    s_add_u32 s79, s79, s60
    v_cvt_pk_bf16_f32 v186, v188, v189
    v_cvt_pk_bf16_f32 v187, v190, v191
    v_mfma_f32_16x16x32_bf16 v[172:175], a[208:211], a[84:87], v[172:175]
    v_add_f32 v119, v119, v71
    v_add_f32 v116, v116, v72
    v_mfma_f32_16x16x32_bf16 v[172:175], a[212:215], a[100:103], v[172:175]
    v_add_f32 v117, v117, v73
    v_cvt_pk_bf16_f32 v178, v180, v181
    v_mfma_f32_16x16x32_bf16 v[164:167], a[212:215], a[96:99], v[164:167]
    v_cvt_pk_bf16_f32 v179, v182, v183
    v_add_f32 v118, v118, v74
    v_mfma_f32_16x16x32_bf16 v[164:167], a[208:211], a[80:83], v[164:167]
    ds_read_b64_tr_b16 a[208:209], v9 offset:36864
    v_add_f32 v119, v119, v75
    v_mfma_f32_16x16x32_bf16 v[192:195], a[184:187], a[128:131], v[192:195]
    ds_read_b64_tr_b16 a[210:211], v9 offset:38912
    v_cvt_pk_bf16_f32 v170, v172, v173
    v_mfma_f32_16x16x32_bf16 v[192:195], a[188:191], a[0:3], v[192:195]
    ds_read_b64_tr_b16 a[212:213], v9 offset:32768
    v_cvt_pk_bf16_f32 v171, v174, v175
    v_mfma_f32_16x16x32_bf16 v[200:203], a[188:191], a[4:7], v[200:203]
    ds_read_b64_tr_b16 a[214:215], v9 offset:34816
    v_cvt_pk_bf16_f32 v162, v164, v165
    v_mfma_f32_16x16x32_bf16 v[200:203], a[184:187], a[132:135], v[200:203]
    v_cvt_pk_bf16_f32 v163, v166, v167
    v_add_f32 v116, v116, v76
    v_mfma_f32_16x16x32_bf16 v[208:211], a[184:187], a[136:139], v[208:211]
    buffer_store_dwordx4 v[160:163], v14, s[24:27], s78 offen offset:0 sc1
    v_add_f32 v117, v117, v77
    v_mfma_f32_16x16x32_bf16 v[208:211], a[188:191], a[8:11], v[208:211]
    buffer_store_dwordx4 v[168:171], v14, s[24:27], s78 offen offset:1024 sc1
    v_add_f32 v118, v118, v78
    v_mfma_f32_16x16x32_bf16 v[216:219], a[188:191], a[12:15], v[216:219]
    s_waitcnt lgkmcnt(5)
    v_add_f32 v119, v119, v79
    v_add_f32 v116, v116, v80
    v_mfma_f32_16x16x32_bf16 v[216:219], a[184:187], a[140:143], v[216:219]
    ds_read_b64_tr_b16 a[184:185], v8 offset:28672
    v_add_f32 v117, v117, v81
    v_mfma_f32_16x16x32_bf16 v[220:223], a[192:195], a[140:143], v[220:223]
    ds_read_b64_tr_b16 a[186:187], v8 offset:30720
    v_add_f32 v118, v118, v82
    v_mfma_f32_16x16x32_bf16 v[220:223], a[196:199], a[12:15], v[220:223]
    ds_read_b64_tr_b16 a[188:189], v8 offset:24576
    v_add_f32 v119, v119, v83
    v_mfma_f32_16x16x32_bf16 v[212:215], a[196:199], a[8:11], v[212:215]
    ds_read_b64_tr_b16 a[190:191], v8 offset:26624
    v_add_f32 v116, v116, v84
    v_mfma_f32_16x16x32_bf16 v[212:215], a[192:195], a[136:139], v[212:215]
    buffer_store_dwordx4 v[176:179], v14, s[24:27], s79 offen offset:0 sc1
    v_add_f32 v117, v117, v85
    v_mfma_f32_16x16x32_bf16 v[204:207], a[192:195], a[132:135], v[204:207]
    s_or_b64 s[88:89], s[28:29], s[30:31]
    v_add_f32 v118, v118, v86
    v_add_f32 v119, v119, v87
    v_mfma_f32_16x16x32_bf16 v[204:207], a[196:199], a[4:7], v[204:207]
    s_or_b64 s[88:89], s[88:89], s[32:33]
    v_add_f32 v116, v116, v88
    v_add_f32 v117, v117, v89
    v_mfma_f32_16x16x32_bf16 v[196:199], a[196:199], a[0:3], v[196:199]
    s_waitcnt lgkmcnt(5)
    v_add_f32 v118, v118, v90
    v_add_f32 v119, v119, v91
    v_mfma_f32_16x16x32_bf16 v[196:199], a[192:195], a[128:131], v[196:199]
    s_load_dwordx8 s[28:35], s[86:87], s93 glc
    ds_read_b64_tr_b16 a[192:193], v9 offset:28672
    v_add_f32 v116, v116, v92
    v_mfma_f32_16x16x32_bf16 v[192:195], a[200:203], a[16:19], v[192:195]
    s_or_b64 s[88:89], s[88:89], s[34:35]
    ds_read_b64_tr_b16 a[194:195], v9 offset:30720
    v_add_f32 v117, v117, v93
    v_mfma_f32_16x16x32_bf16 v[192:195], a[204:207], a[32:35], v[192:195]
    buffer_store_dwordx4 v[184:187], v14, s[24:27], s79 offen offset:1024 sc1
    v_add_f32 v118, v118, v94
    v_mfma_f32_16x16x32_bf16 v[200:203], a[204:207], a[36:39], v[200:203]
    s_or_b32 s66, s88, s89
    ds_read_b64_tr_b16 a[196:197], v9 offset:24576
    v_add_f32 v119, v119, v95
    v_mfma_f32_16x16x32_bf16 v[200:203], a[200:203], a[20:23], v[200:203]
    s_andn2_b32 s69, s66, s80
    s_cselect_b32 s65, s59, 0x70000000
    v_mov_b32 v120, v116
    v_mfma_f32_16x16x32_bf16 v[208:211], a[200:203], a[24:27], v[208:211]
    s_ff1_i32_b32 s69, s69
    ds_read_b64_tr_b16 a[198:199], v9 offset:26624
    v_mov_b32 v121, v117
    v_mfma_f32_16x16x32_bf16 v[208:211], a[204:207], a[40:43], v[208:211]
    s_xor_b32 s73, s53, s69
    v_permlane16_swap_b32 v116, v120
    v_mfma_f32_16x16x32_bf16 v[216:219], a[204:207], a[44:47], v[216:219]
    s_waitcnt lgkmcnt(7)
    v_permlane16_swap_b32 v117, v121
    v_mfma_f32_16x16x32_bf16 v[216:219], a[200:203], a[28:31], v[216:219]
    s_mul_i32 s73, s73, 20480
    v_mov_b32 v122, v118
    v_mov_b32 v123, v119
    v_mfma_f32_16x16x32_bf16 v[220:223], a[208:211], a[28:31], v[220:223]
    s_add_u32 s73, s73, s65
    v_permlane16_swap_b32 v118, v122
    v_mfma_f32_16x16x32_bf16 v[220:223], a[212:215], a[44:47], v[220:223]
    s_bitset1_b32 s80, s69
    v_permlane16_swap_b32 v119, v123
    v_mfma_f32_16x16x32_bf16 v[212:215], a[212:215], a[40:43], v[212:215]
    s_barrier
    v_mfma_f32_16x16x32_bf16 v[212:215], a[208:211], a[24:27], v[212:215]
    ds_read_b64_tr_b16 a[200:201], v8 offset:20480
    v_add_f32 v116, v116, v120
    v_mfma_f32_16x16x32_bf16 v[204:207], a[208:211], a[20:23], v[204:207]
    ds_read_b64_tr_b16 a[202:203], v8 offset:22528
    v_add_f32 v117, v117, v121
    v_mfma_f32_16x16x32_bf16 v[204:207], a[212:215], a[36:39], v[204:207]
    s_waitcnt lgkmcnt(6)
    ds_read_b64_tr_b16 a[204:205], v8 offset:16384
    v_add_f32 v118, v118, v122
    v_mfma_f32_16x16x32_bf16 v[196:199], a[212:215], a[32:35], v[196:199]
    buffer_load_dwordx4 v[130:133], v14, s[24:27], s73 offen sc1
    v_mfma_f32_16x16x32_bf16 v[196:199], a[208:211], a[16:19], v[196:199]
    ds_read_b64_tr_b16 a[206:207], v8 offset:18432
    v_add_f32 v119, v119, v123
    v_mfma_f32_16x16x32_bf16 v[192:195], a[184:187], a[48:51], v[192:195]
    ds_read_b64_tr_b16 a[208:209], v9 offset:20480
    v_cvt_pk_bf16_f32 v116, 0, v116
    v_mfma_f32_16x16x32_bf16 v[192:195], a[188:191], a[64:67], v[192:195]
    buffer_load_dwordx4 v[134:137], v14, s[24:27], s73 offen offset:1024 sc1
    v_mfma_f32_16x16x32_bf16 v[200:203], a[188:191], a[68:71], v[200:203]
    ds_read_b64_tr_b16 a[210:211], v9 offset:22528
    v_cvt_pk_bf16_f32 v117, 0, v117
    v_mfma_f32_16x16x32_bf16 v[200:203], a[184:187], a[52:55], v[200:203]
    ds_read_b64_tr_b16 a[212:213], v9 offset:16384
    v_cvt_pk_bf16_f32 v118, 0, v118
    v_mfma_f32_16x16x32_bf16 v[208:211], a[184:187], a[56:59], v[208:211]
    s_waitcnt lgkmcnt(6)
    ds_read_b64_tr_b16 a[214:215], v9 offset:18432
    v_cvt_pk_bf16_f32 v119, 0, v119
    v_mfma_f32_16x16x32_bf16 v[208:211], a[188:191], a[72:75], v[208:211]
    buffer_load_dwordx2 v[128:129], v39, s[24:27], s73 offen offset:2048 sc1
    v_mfma_f32_16x16x32_bf16 v[216:219], a[188:191], a[76:79], v[216:219]
    v_mul_f32 v116, v116, v54
    v_mul_f32 v117, v117, v54
    v_mfma_f32_16x16x32_bf16 v[216:219], a[184:187], a[60:63], v[216:219]
    ds_read_b64_tr_b16 a[184:185], v8 offset:12288
    v_mul_f32 v118, v118, v54
    v_mfma_f32_16x16x32_bf16 v[220:223], a[192:195], a[60:63], v[220:223]
    ds_read_b64_tr_b16 a[186:187], v8 offset:14336
    v_mul_f32 v119, v119, v54
    v_mfma_f32_16x16x32_bf16 v[220:223], a[196:199], a[76:79], v[220:223]
    ds_read_b64_tr_b16 a[188:189], v8 offset:8192
    v_cvt_pk_bf16_f32 v116, 0, v116
    v_mfma_f32_16x16x32_bf16 v[212:215], a[196:199], a[72:75], v[212:215]
    ds_read_b64_tr_b16 a[190:191], v8 offset:10240
    v_cvt_pk_bf16_f32 v117, 0, v117
    v_mfma_f32_16x16x32_bf16 v[212:215], a[192:195], a[56:59], v[212:215]
    s_waitcnt lgkmcnt(6)
    v_cvt_pk_bf16_f32 v118, 0, v118
    v_cvt_pk_bf16_f32 v119, 0, v119
    v_mfma_f32_16x16x32_bf16 v[204:207], a[192:195], a[52:55], v[204:207]
    v_add_f32 v116, v116, v50
    v_add_f32 v117, v117, v51
    v_mfma_f32_16x16x32_bf16 v[204:207], a[196:199], a[68:71], v[204:207]
    v_add_f32 v118, v118, v52
    v_add_f32 v119, v119, v53
    v_mfma_f32_16x16x32_bf16 v[196:199], a[196:199], a[64:67], v[196:199]
    v_cvt_pk_bf16_f32 v116, 0, v116
    v_cvt_pk_bf16_f32 v117, 0, v117
    v_mfma_f32_16x16x32_bf16 v[196:199], a[192:195], a[48:51], v[196:199]
    s_or_b64 s[88:89], s[28:29], s[30:31]
    ds_read_b64_tr_b16 a[192:193], v9 offset:12288
    v_cvt_pk_bf16_f32 v118, 0, v118
    v_mfma_f32_16x16x32_bf16 v[192:195], a[200:203], a[216:219], v[192:195]
    s_or_b64 s[88:89], s[88:89], s[32:33]
    ds_read_b64_tr_b16 a[194:195], v9 offset:14336
    v_cvt_pk_bf16_f32 v119, 0, v119
    v_mfma_f32_16x16x32_bf16 v[192:195], a[204:207], a[232:235], v[192:195]
    s_or_b64 s[88:89], s[88:89], s[34:35]
    ds_read_b64_tr_b16 a[196:197], v9 offset:8192
    v_mul_f32 v120, s92, v116
    v_mfma_f32_16x16x32_bf16 v[200:203], a[204:207], a[236:239], v[200:203]
    s_or_b32 s66, s88, s89
    ds_read_b64_tr_b16 a[198:199], v9 offset:10240
    v_mul_f32 v121, s92, v117
    v_mfma_f32_16x16x32_bf16 v[200:203], a[200:203], a[220:223], v[200:203]
    v_exp_f32 v120, v120
    v_mfma_f32_16x16x32_bf16 v[208:211], a[200:203], a[224:227], v[208:211]
    v_exp_f32 v121, v121
    v_mfma_f32_16x16x32_bf16 v[208:211], a[204:207], a[240:243], v[208:211]
    s_andn2_b32 s69, s66, s80
    s_cselect_b32 s65, s59, 0x70000000
    v_mul_f32 v122, s92, v118
    v_mfma_f32_16x16x32_bf16 v[216:219], a[204:207], a[244:247], v[216:219]
    s_waitcnt lgkmcnt(5)
    v_exp_f32 v122, v122
    v_mfma_f32_16x16x32_bf16 v[216:219], a[200:203], a[228:231], v[216:219]
    s_ff1_i32_b32 s69, s69
    ds_read_b64_tr_b16 a[200:201], v8 offset:4096
    v_mul_f32 v123, s92, v119
    v_mfma_f32_16x16x32_bf16 v[220:223], a[208:211], a[228:231], v[220:223]
    s_xor_b32 s81, s53, s69
    ds_read_b64_tr_b16 a[202:203], v8 offset:6144
    v_add_f32 v120, 1.0, v120
    v_mfma_f32_16x16x32_bf16 v[220:223], a[212:215], a[244:247], v[220:223]
    s_mul_i32 s81, s81, 20480
    ds_read_b64_tr_b16 a[204:205], v8 offset:0
    v_add_f32 v121, 1.0, v121
    v_mfma_f32_16x16x32_bf16 v[212:215], a[212:215], a[240:243], v[212:215]
    s_add_u32 s81, s81, s65
    ds_read_b64_tr_b16 a[206:207], v8 offset:2048
    v_add_f32 v122, 1.0, v122
    v_mfma_f32_16x16x32_bf16 v[212:215], a[208:211], a[224:227], v[212:215]
    s_bitset1_b32 s80, s69
    v_exp_f32 v123, v123
    v_mfma_f32_16x16x32_bf16 v[204:207], a[208:211], a[220:223], v[204:207]
    v_rcp_f32 v120, v120
    v_mfma_f32_16x16x32_bf16 v[204:207], a[212:215], a[236:239], v[204:207]
    v_rcp_f32 v121, v121
    v_mfma_f32_16x16x32_bf16 v[196:199], a[212:215], a[232:235], v[196:199]
    s_waitcnt lgkmcnt(5)
    v_rcp_f32 v122, v122
    v_mfma_f32_16x16x32_bf16 v[196:199], a[208:211], a[216:219], v[196:199]
    ds_read_b64_tr_b16 a[208:209], v9 offset:4096
    v_add_f32 v123, 1.0, v123
    v_mfma_f32_16x16x32_bf16 v[192:195], a[184:187], a[152:155], v[192:195]
    ds_read_b64_tr_b16 a[210:211], v9 offset:6144
    v_mul_f32 v116, v116, v120
    v_mfma_f32_16x16x32_bf16 v[192:195], a[188:191], a[168:171], v[192:195]
    buffer_load_dwordx4 v[140:143], v14, s[24:27], s81 offen sc1
    v_mfma_f32_16x16x32_bf16 v[200:203], a[188:191], a[172:175], v[200:203]
    ds_read_b64_tr_b16 a[212:213], v9 offset:0
    v_mul_f32 v117, v117, v121
    v_mfma_f32_16x16x32_bf16 v[200:203], a[184:187], a[156:159], v[200:203]
    s_waitcnt vmcnt(4)
    ds_read_b64_tr_b16 a[214:215], v9 offset:2048
    v_mul_f32 v118, v118, v122
    v_mfma_f32_16x16x32_bf16 v[208:211], a[184:187], a[160:163], v[208:211]
    buffer_store_dword v16, v7, s[24:27], s77 offen offset:16 sc1
    v_mfma_f32_16x16x32_bf16 v[208:211], a[188:191], a[176:179], v[208:211]
    buffer_load_dwordx4 v[144:147], v14, s[24:27], s81 offen offset:1024 sc1
    v_mfma_f32_16x16x32_bf16 v[216:219], a[188:191], a[180:183], v[216:219]
    s_waitcnt lgkmcnt(3)
    v_lshlrev_b32 v16, 0, v2
    v_cvt_pk_bf16_f32 v116, v116, v117
    v_mfma_f32_16x16x32_bf16 v[216:219], a[184:187], a[164:167], v[216:219]
    buffer_load_dwordx2 v[138:139], v39, s[24:27], s81 offen offset:2048 sc1
    v_mfma_f32_16x16x32_bf16 v[220:223], a[192:195], a[164:167], v[220:223]
    s_xor_b32 s77, s50, 0
    ds_read_b64_tr_b16 a[184:185], v10 offset:45056
    v_xor_b32 v20, 16, v5
    v_mfma_f32_16x16x32_bf16 v[220:223], a[196:199], a[180:183], v[220:223]
    s_lshl_b32 s77, s77, 10
    ds_read_b64_tr_b16 a[186:187], v10 offset:47104
    v_cmp_eq_u32 s[10:11], s39, v20
    v_mfma_f32_16x16x32_bf16 v[212:215], a[196:199], a[176:179], v[212:215]
    s_add_u32 s77, s61, s77
    ds_read_b64_tr_b16 a[188:189], v10 offset:40960
    v_cmp_eq_u32 s[22:23], s40, v20
    v_mfma_f32_16x16x32_bf16 v[212:215], a[192:195], a[160:163], v[212:215]
    s_or_b64 s[10:11], s[10:11], s[22:23]
    ds_read_b64_tr_b16 a[190:191], v10 offset:43008
    v_lshrrev_b32 v21, 4, v1
    v_mfma_f32_16x16x32_bf16 v[204:207], a[192:195], a[156:159], v[204:207]
    v_rcp_f32 v123, v123
    v_mfma_f32_16x16x32_bf16 v[204:207], a[196:199], a[172:175], v[204:207]
    v_mul_f32 v119, v119, v123
    v_cvt_pk_bf16_f32 v117, v118, v119
    v_mfma_f32_16x16x32_bf16 v[196:199], a[196:199], a[168:171], v[196:199]
    ds_write_b64 v12, v[116:117]
    v_mfma_f32_16x16x32_bf16 v[196:199], a[192:195], a[152:155], v[196:199]
    ds_read_b64_tr_b16 a[192:193], v11 offset:45056
    v_lshl_add_u32 v21, v21, 3, s56
    v_mfma_f32_16x16x32_bf16 v[192:195], a[200:203], a[80:83], v[192:195]
    ds_read_b64_tr_b16 a[194:195], v11 offset:47104
    v_add_u32 v20, 256, v21
    v_mfma_f32_16x16x32_bf16 v[192:195], a[204:207], a[96:99], v[192:195]
    ds_read_b64_tr_b16 a[196:197], v11 offset:40960
    v_cndmask_b32 v22, v21, v20, s[20:21]
    v_mfma_f32_16x16x32_bf16 v[200:203], a[204:207], a[100:103], v[200:203]
    s_waitcnt lgkmcnt(4)
    s_mov_b64 exec, s[8:9]
    ds_read2_b64 v[40:43], v22 offset0:0 offset1:4
    s_mov_b64 exec, -1
    v_mfma_f32_16x16x32_bf16 v[200:203], a[200:203], a[84:87], v[200:203]
    ds_read_b64_tr_b16 a[198:199], v11 offset:43008
    v_cvt_pk_bf16_f32 v192, v192, v193
    v_mfma_f32_16x16x32_bf16 v[208:211], a[200:203], a[88:91], v[208:211]
    v_cvt_pk_bf16_f32 v193, v194, v195
    v_cndmask_b32 v23, v21, v20, s[22:23]
    v_mfma_f32_16x16x32_bf16 v[208:211], a[204:207], a[104:107], v[208:211]
    s_mov_b64 exec, s[10:11]
    ds_read2_b64 v[44:47], v23 offset0:0 offset1:4
    s_mov_b64 exec, -1
    v_mfma_f32_16x16x32_bf16 v[216:219], a[204:207], a[108:111], v[216:219]
    s_xor_b32 s78, s53, 3
    v_cvt_pk_bf16_f32 v200, v200, v201
    v_cvt_pk_bf16_f32 v201, v202, v203
    v_mfma_f32_16x16x32_bf16 v[216:219], a[200:203], a[92:95], v[216:219]
    s_mul_i32 s78, s78, 2560
    ds_read_b64_tr_b16 a[200:201], v10 offset:36864
    v_cvt_pk_bf16_f32 v208, v208, v209
    v_mfma_f32_16x16x32_bf16 v[220:223], a[208:211], a[92:95], v[220:223]
    s_add_u32 s78, s78, s60
    ds_read_b64_tr_b16 a[202:203], v10 offset:38912
    v_cvt_pk_bf16_f32 v209, v210, v211
    v_mfma_f32_16x16x32_bf16 v[220:223], a[212:215], a[108:111], v[220:223]
    s_xor_b32 s79, s53, 2
    ds_read_b64_tr_b16 a[204:205], v10 offset:32768
    v_cvt_pk_bf16_f32 v216, v216, v217
    v_mfma_f32_16x16x32_bf16 v[212:215], a[212:215], a[104:107], v[212:215]
    s_mul_i32 s79, s79, 2560
    ds_read_b64_tr_b16 a[206:207], v10 offset:34816
    v_cvt_pk_bf16_f32 v217, v218, v219
    v_mfma_f32_16x16x32_bf16 v[212:215], a[208:211], a[88:91], v[212:215]
    s_waitcnt lgkmcnt(5)
    v_cvt_pk_bf16_f32 v218, v220, v221
    v_cvt_pk_bf16_f32 v219, v222, v223
    v_mfma_f32_16x16x32_bf16 v[204:207], a[208:211], a[84:87], v[204:207]
    s_add_u32 s79, s79, s60
    v_cmp_eq_u32 s[20:21], s39, v37
    v_cmp_eq_u32 s[22:23], s40, v37
    v_mfma_f32_16x16x32_bf16 v[204:207], a[212:215], a[100:103], v[204:207]
    s_or_b64 s[20:21], s[20:21], s[22:23]
    v_cvt_pk_bf16_f32 v210, v212, v213
    v_cvt_pk_bf16_f32 v211, v214, v215
    v_mfma_f32_16x16x32_bf16 v[196:199], a[212:215], a[96:99], v[196:199]
    s_waitcnt lgkmcnt(3)
    v_cndmask_b32 v13, v21, v20, s[22:23]
    v_and_b32 v20, 8, v39
    v_mfma_f32_16x16x32_bf16 v[196:199], a[208:211], a[80:83], v[196:199]
    s_load_dwordx8 s[28:35], s[86:87], s93 glc
    ds_read_b64_tr_b16 a[208:209], v11 offset:36864
    v_cvt_pk_bf16_f32 v202, v204, v205
    v_mfma_f32_16x16x32_bf16 v[224:227], a[184:187], a[128:131], v[224:227]
    ds_read_b64_tr_b16 a[210:211], v11 offset:38912
    v_cvt_pk_bf16_f32 v203, v206, v207
    v_mfma_f32_16x16x32_bf16 v[224:227], a[188:191], a[0:3], v[224:227]
    ds_read_b64_tr_b16 a[212:213], v11 offset:32768
    v_cvt_pk_bf16_f32 v194, v196, v197
    v_mfma_f32_16x16x32_bf16 v[232:235], a[188:191], a[4:7], v[232:235]
    ds_read_b64_tr_b16 a[214:215], v11 offset:34816
    v_cvt_pk_bf16_f32 v195, v198, v199
    v_mfma_f32_16x16x32_bf16 v[232:235], a[184:187], a[132:135], v[232:235]
    buffer_store_dwordx4 v[192:195], v14, s[24:27], s78 offen offset:1024 sc1
    v_lshl_add_u32 v13, v20, 2, v13
    v_mfma_f32_16x16x32_bf16 v[236:239], a[192:195], a[132:135], v[236:239]
    s_mov_b64 exec, s[20:21]
    ds_read_b64 v[48:49], v13 offset:64
    s_mov_b64 exec, -1
    v_mfma_f32_16x16x32_bf16 v[236:239], a[196:199], a[4:7], v[236:239]
    s_waitcnt lgkmcnt(7)
    ds_read_b64_tr_b16 a[184:185], v10 offset:28672
    v_bfe_u32 v20, v1, 2, 2
    v_mfma_f32_16x16x32_bf16 v[228:231], a[196:199], a[0:3], v[228:231]
    s_waitcnt lgkmcnt(6)
    ds_read_b64_tr_b16 a[186:187], v10 offset:30720
    v_lshrrev_b32 v21, 4, v1
    v_mfma_f32_16x16x32_bf16 v[228:231], a[192:195], a[128:131], v[228:231]
    buffer_store_dwordx4 v[200:203], v14, s[24:27], s78 offen offset:0 sc1
    v_cmp_eq_u32 vcc, v20, v21
    v_mfma_f32_16x16x32_bf16 v[224:227], a[200:203], a[16:19], v[224:227]
    ds_read_b64_tr_b16 a[188:189], v10 offset:24576
    v_and_b32 v20, 1, v1
    v_mfma_f32_16x16x32_bf16 v[224:227], a[204:207], a[32:35], v[224:227]
    s_waitcnt lgkmcnt(6)
    ds_read_b64_tr_b16 a[190:191], v10 offset:26624
    v_lshlrev_b32 v20, 4, v20
    v_mfma_f32_16x16x32_bf16 v[232:235], a[204:207], a[36:39], v[232:235]
    s_waitcnt lgkmcnt(5)
    ds_read_b64_tr_b16 a[192:193], v11 offset:28672
    v_mov_b32 v21, 0x3f80
    v_mfma_f32_16x16x32_bf16 v[232:235], a[200:203], a[20:23], v[232:235]
    s_waitcnt lgkmcnt(5)
    ds_read_b64_tr_b16 a[194:195], v11 offset:30720
    v_lshlrev_b32 v20, v20, v21
    v_mfma_f32_16x16x32_bf16 v[236:239], a[208:211], a[20:23], v[236:239]
    ds_read_b64_tr_b16 a[196:197], v11 offset:24576
    v_cndmask_b32 v20, 0, v20, vcc
    v_mfma_f32_16x16x32_bf16 v[236:239], a[212:215], a[36:39], v[236:239]
    s_waitcnt lgkmcnt(5)
    ds_read_b64_tr_b16 a[198:199], v11 offset:26624
    v_and_b32 v21, 2, v1
    v_mfma_f32_16x16x32_bf16 v[228:231], a[212:215], a[32:35], v[228:231]
    ds_read_b64_tr_b16 a[200:201], v10 offset:20480
    v_cmp_eq_u32 vcc, 0, v21
    v_mfma_f32_16x16x32_bf16 v[228:231], a[208:211], a[16:19], v[228:231]
    buffer_store_dwordx4 v[208:211], v14, s[24:27], s79 offen offset:1024 sc1
    v_cndmask_b32 v184, 0, v20, vcc
    v_mfma_f32_16x16x32_bf16 v[224:227], a[184:187], a[48:51], v[224:227]
    s_waitcnt lgkmcnt(5)
    ds_read_b64_tr_b16 a[202:203], v10 offset:22528
    v_sub_u32 v185, v20, v184
    v_mfma_f32_16x16x32_bf16 v[224:227], a[188:191], a[64:67], v[224:227]
pg_last:
    s_cbranch_execz pg_back2
    ds_read_b64_tr_b16 a[204:205], v10 offset:16384
    v_mov_b32 v186, v184
    v_mfma_f32_16x16x32_bf16 v[232:235], a[188:191], a[68:71], v[232:235]
    s_waitcnt lgkmcnt(5)
    ds_read_b64_tr_b16 a[206:207], v10 offset:18432
    v_mov_b32 v187, v185
    v_mfma_f32_16x16x32_bf16 v[232:235], a[184:187], a[52:55], v[232:235]
    ds_read_b64_tr_b16 a[208:209], v11 offset:20480
    v_mov_b32 v188, 0
    v_mfma_f32_16x16x32_bf16 v[236:239], a[192:195], a[52:55], v[236:239]
    s_waitcnt lgkmcnt(5)
    ds_read_b64_tr_b16 a[210:211], v11 offset:22528
    v_mov_b32 v189, 0
    v_mfma_f32_16x16x32_bf16 v[236:239], a[196:199], a[68:71], v[236:239]
    ds_read_b64_tr_b16 a[212:213], v11 offset:16384
    v_mov_b32 v190, v184
    v_mfma_f32_16x16x32_bf16 v[228:231], a[196:199], a[64:67], v[228:231]
    ds_read_b64_tr_b16 a[214:215], v11 offset:18432
    v_mov_b32 v191, v185
    v_mfma_f32_16x16x32_bf16 v[228:231], a[192:195], a[48:51], v[228:231]
    s_waitcnt lgkmcnt(6)
    buffer_store_dwordx4 v[216:219], v14, s[24:27], s79 offen offset:0 sc1
    v_lshlrev_b32 v192, 16, v24
    v_mfma_f32_16x16x32_bf16 v[224:227], a[200:203], a[216:219], v[224:227]
    s_waitcnt lgkmcnt(4)
    ds_read_b64_tr_b16 a[184:185], v10 offset:12288
    v_and_b32 v193, 0xffff0000, v24
    v_mfma_f32_16x16x32_bf16 v[224:227], a[204:207], a[232:235], v[224:227]
    ds_read_b64_tr_b16 a[186:187], v10 offset:14336
    v_lshlrev_b32 v208, 16, v40
    ds_read_b64_tr_b16 a[188:189], v10 offset:8192
    v_mfma_f32_16x16x32_bf16 v[232:235], a[204:207], a[236:239], v[232:235]
    ds_read_b64_tr_b16 a[190:191], v10 offset:10240
    v_and_b32 v209, 0xffff0000, v40
    v_mfma_f32_16x16x32_bf16 v[232:235], a[200:203], a[220:223], v[232:235]
    s_waitcnt lgkmcnt(6)
    ds_read_b64_tr_b16 a[192:193], v11 offset:12288
    v_lshlrev_b32 v194, 16, v25
    v_mfma_f32_16x16x32_bf16 v[236:239], a[208:211], a[220:223], v[236:239]
    s_waitcnt lgkmcnt(5)
    ds_read_b64_tr_b16 a[194:195], v11 offset:14336
    v_and_b32 v195, 0xffff0000, v25
    v_mfma_f32_16x16x32_bf16 v[236:239], a[212:215], a[236:239], v[236:239]
    ds_read_b64_tr_b16 a[196:197], v11 offset:8192
    v_lshlrev_b32 v210, 16, v41
    v_mfma_f32_16x16x32_bf16 v[228:231], a[212:215], a[232:235], v[228:231]
    ds_read_b64_tr_b16 a[198:199], v11 offset:10240
    v_and_b32 v211, 0xffff0000, v41
    v_mfma_f32_16x16x32_bf16 v[228:231], a[208:211], a[216:219], v[228:231]
    s_waitcnt lgkmcnt(6)
    ds_read_b64_tr_b16 a[200:201], v10 offset:4096
    v_lshlrev_b32 v196, 16, v26
    v_mfma_f32_16x16x32_bf16 v[224:227], a[184:187], a[152:155], v[224:227]
    s_waitcnt lgkmcnt(5)
    ds_read_b64_tr_b16 a[202:203], v10 offset:6144
    v_and_b32 v197, 0xffff0000, v26
    v_mfma_f32_16x16x32_bf16 v[224:227], a[188:191], a[168:171], v[224:227]
    ds_read_b64_tr_b16 a[204:205], v10 offset:0
    v_lshlrev_b32 v212, 16, v42
    v_mfma_f32_16x16x32_bf16 v[232:235], a[188:191], a[172:175], v[232:235]
    ds_read_b64_tr_b16 a[206:207], v10 offset:2048
    v_and_b32 v213, 0xffff0000, v42
    v_mfma_f32_16x16x32_bf16 v[232:235], a[184:187], a[156:159], v[232:235]
    s_waitcnt lgkmcnt(6)
    ds_read_b64_tr_b16 a[208:209], v11 offset:4096
    v_lshlrev_b32 v198, 16, v27
    v_mfma_f32_16x16x32_bf16 v[236:239], a[192:195], a[156:159], v[236:239]
    s_waitcnt lgkmcnt(5)
    ds_read_b64_tr_b16 a[210:211], v11 offset:6144
    v_and_b32 v199, 0xffff0000, v27
    v_mfma_f32_16x16x32_bf16 v[236:239], a[196:199], a[172:175], v[236:239]
    s_xor_b32 s78, s53, 1
    ds_read_b64_tr_b16 a[212:213], v11 offset:0
    v_lshlrev_b32 v214, 16, v43
    v_mfma_f32_16x16x32_bf16 v[228:231], a[196:199], a[168:171], v[228:231]
    s_mul_i32 s78, s78, 2560
    ds_read_b64_tr_b16 a[214:215], v11 offset:2048
    v_and_b32 v215, 0xffff0000, v43
    v_mfma_f32_16x16x32_bf16 v[228:231], a[192:195], a[152:155], v[228:231]
    s_waitcnt lgkmcnt(6)
    ds_read_b64_tr_b16 a[184:185], v10 offset:45056
    v_lshlrev_b32 v200, 16, v28
    v_mfma_f32_16x16x32_bf16 v[224:227], a[200:203], a[80:83], v[224:227]
    s_waitcnt lgkmcnt(5)
    ds_read_b64_tr_b16 a[186:187], v10 offset:47104
    v_and_b32 v201, 0xffff0000, v28
    v_mfma_f32_16x16x32_bf16 v[224:227], a[204:207], a[96:99], v[224:227]
    s_add_u32 s78, s78, s60
    ds_read_b64_tr_b16 a[188:189], v10 offset:40960
    v_lshlrev_b32 v216, 16, v44
    v_mfma_f32_16x16x32_bf16 v[232:235], a[204:207], a[100:103], v[232:235]
    s_or_b64 s[88:89], s[28:29], s[30:31]
    ds_read_b64_tr_b16 a[190:191], v10 offset:43008
    v_and_b32 v217, 0xffff0000, v44
    v_mfma_f32_16x16x32_bf16 v[232:235], a[200:203], a[84:87], v[232:235]
    s_waitcnt lgkmcnt(6)
    ds_read_b64_tr_b16 a[192:193], v11 offset:45056
    v_cvt_pk_bf16_f32 v224, v224, v225
    v_mfma_f32_16x16x32_bf16 v[236:239], a[208:211], a[84:87], v[236:239]
    s_waitcnt lgkmcnt(5)
    ds_read_b64_tr_b16 a[194:195], v11 offset:47104
    v_cvt_pk_bf16_f32 v225, v226, v227
    v_mfma_f32_16x16x32_bf16 v[236:239], a[212:215], a[100:103], v[236:239]
    s_or_b64 s[88:89], s[88:89], s[32:33]
    ds_read_b64_tr_b16 a[196:197], v11 offset:40960
    v_cvt_pk_bf16_f32 v232, v232, v233
    v_mfma_f32_16x16x32_bf16 v[228:231], a[212:215], a[96:99], v[228:231]
    s_or_b64 s[88:89], s[88:89], s[34:35]
    ds_read_b64_tr_b16 a[198:199], v11 offset:43008
    v_cvt_pk_bf16_f32 v233, v234, v235
    v_mfma_f32_16x16x32_bf16 v[228:231], a[208:211], a[80:83], v[228:231]
    s_waitcnt lgkmcnt(6)
    ds_read_b64_tr_b16 a[200:201], v10 offset:36864
    v_cvt_pk_bf16_f32 v234, v236, v237
    v_mfma_f32_16x16x32_bf16 v[240:243], a[184:187], a[136:139], v[240:243]
    s_waitcnt lgkmcnt(5)
    ds_read_b64_tr_b16 a[202:203], v10 offset:38912
    v_cvt_pk_bf16_f32 v235, v238, v239
    v_mfma_f32_16x16x32_bf16 v[240:243], a[188:191], a[8:11], v[240:243]
    s_or_b32 s66, s88, s89
    ds_read_b64_tr_b16 a[204:205], v10 offset:32768
    v_cvt_pk_bf16_f32 v226, v228, v229
    v_mfma_f32_16x16x32_bf16 v[248:251], a[188:191], a[12:15], v[248:251]
    s_andn2_b32 s69, s66, s80
    s_cselect_b32 s65, s59, 0x70000000
    v_cvt_pk_bf16_f32 v227, v230, v231
    ds_read_b64_tr_b16 a[206:207], v10 offset:34816
    v_mfma_f32_16x16x32_bf16 v[248:251], a[184:187], a[140:143], v[248:251]
    s_waitcnt lgkmcnt(6)
    buffer_store_dwordx4 v[224:227], v14, s[24:27], s78 offen offset:0 sc1
    v_lshlrev_b32 v202, 16, v29
    v_mfma_f32_16x16x32_bf16 v[252:255], a[192:195], a[140:143], v[252:255]
    s_waitcnt lgkmcnt(4)
    buffer_store_dwordx4 v[232:235], v14, s[24:27], s78 offen offset:1024 sc1
    v_and_b32 v203, 0xffff0000, v29
    v_mfma_f32_16x16x32_bf16 v[252:255], a[196:199], a[12:15], v[252:255]
    s_ff1_i32_b32 s69, s69
    ds_read_b64_tr_b16 a[208:209], v11 offset:36864
    v_lshlrev_b32 v218, 16, v45
    ds_read_b64_tr_b16 a[210:211], v11 offset:38912
    v_mfma_f32_16x16x32_bf16 v[244:247], a[196:199], a[8:11], v[244:247]
    s_xor_b32 s72, s53, s69
    ds_read_b64_tr_b16 a[212:213], v11 offset:32768
    v_and_b32 v219, 0xffff0000, v45
    ds_read_b64_tr_b16 a[214:215], v11 offset:34816
    v_mfma_f32_16x16x32_bf16 v[244:247], a[192:195], a[136:139], v[244:247]
    s_waitcnt lgkmcnt(6)
    ds_read_b64_tr_b16 a[184:185], v10 offset:28672
    v_lshlrev_b32 v204, 16, v30
    v_mfma_f32_16x16x32_bf16 v[240:243], a[200:203], a[24:27], v[240:243]
    s_waitcnt lgkmcnt(5)
    ds_read_b64_tr_b16 a[186:187], v10 offset:30720
    v_and_b32 v205, 0xffff0000, v30
    v_mfma_f32_16x16x32_bf16 v[240:243], a[204:207], a[40:43], v[240:243]
    s_mul_i32 s72, s72, 20480
    ds_read_b64_tr_b16 a[188:189], v10 offset:24576
    v_lshlrev_b32 v220, 16, v46
    v_mfma_f32_16x16x32_bf16 v[248:251], a[204:207], a[44:47], v[248:251]
    s_add_u32 s72, s72, s65
    ds_read_b64_tr_b16 a[190:191], v10 offset:26624
    v_and_b32 v221, 0xffff0000, v46
    v_mfma_f32_16x16x32_bf16 v[248:251], a[200:203], a[28:31], v[248:251]
    s_waitcnt lgkmcnt(6)
    ds_read_b64_tr_b16 a[192:193], v11 offset:28672
    v_lshlrev_b32 v206, 16, v31
    v_mfma_f32_16x16x32_bf16 v[252:255], a[208:211], a[28:31], v[252:255]
    s_waitcnt lgkmcnt(5)
    ds_read_b64_tr_b16 a[194:195], v11 offset:30720
    v_and_b32 v207, 0xffff0000, v31
    v_mfma_f32_16x16x32_bf16 v[252:255], a[212:215], a[44:47], v[252:255]
    s_bitset1_b32 s80, s69
    ds_read_b64_tr_b16 a[196:197], v11 offset:24576
    v_lshlrev_b32 v222, 16, v47
    v_mfma_f32_16x16x32_bf16 v[244:247], a[212:215], a[40:43], v[244:247]
    s_andn2_b32 s69, s66, s80
    s_cselect_b32 s65, s59, 0x70000000
    v_and_b32 v223, 0xffff0000, v47
    ds_read_b64_tr_b16 a[198:199], v11 offset:26624
    v_mfma_f32_16x16x32_bf16 v[244:247], a[208:211], a[24:27], v[244:247]
    s_waitcnt lgkmcnt(6)
    ds_read_b64_tr_b16 a[200:201], v10 offset:20480
    v_lshlrev_b32 v50, 16, v32
    v_mfma_f32_16x16x32_bf16 v[240:243], a[184:187], a[56:59], v[240:243]
    s_waitcnt lgkmcnt(5)
    ds_read_b64_tr_b16 a[202:203], v10 offset:22528
    v_and_b32 v51, 0xffff0000, v32
    v_mfma_f32_16x16x32_bf16 v[240:243], a[188:191], a[72:75], v[240:243]
    buffer_load_dwordx4 v[58:61], v14, s[24:27], s72 offen sc1
    ds_read_b64_tr_b16 a[204:205], v10 offset:16384
    v_mfma_f32_16x16x32_bf16 v[248:251], a[188:191], a[76:79], v[248:251]
    s_ff1_i32_b32 s69, s69
    ds_read_b64_tr_b16 a[206:207], v10 offset:18432
    v_lshlrev_b32 v116, 16, v48
    v_mfma_f32_16x16x32_bf16 v[248:251], a[184:187], a[60:63], v[248:251]
    s_waitcnt lgkmcnt(6)
    ds_read_b64_tr_b16 a[208:209], v11 offset:20480
    v_and_b32 v117, 0xffff0000, v48
    v_mfma_f32_16x16x32_bf16 v[252:255], a[192:195], a[60:63], v[252:255]
    s_waitcnt lgkmcnt(5)
    buffer_load_dwordx4 v[62:65], v14, s[24:27], s72 offen offset:1024 sc1
    v_mfma_f32_16x16x32_bf16 v[252:255], a[196:199], a[76:79], v[252:255]
    s_xor_b32 s73, s53, s69
    ds_read_b64_tr_b16 a[210:211], v11 offset:22528
    v_lshlrev_b32 v52, 16, v33
    ds_read_b64_tr_b16 a[212:213], v11 offset:16384
    v_mfma_f32_16x16x32_bf16 v[244:247], a[196:199], a[72:75], v[244:247]
    s_mul_i32 s73, s73, 20480
    ds_read_b64_tr_b16 a[214:215], v11 offset:18432
    v_and_b32 v53, 0xffff0000, v33
    v_mfma_f32_16x16x32_bf16 v[244:247], a[192:195], a[56:59], v[244:247]
    s_waitcnt lgkmcnt(6)
    buffer_load_dwordx2 v[56:57], v39, s[24:27], s72 offen offset:2048 sc1
    v_mfma_f32_16x16x32_bf16 v[240:243], a[200:203], a[224:227], v[240:243]
    s_waitcnt lgkmcnt(4)
    ds_read_b64_tr_b16 a[184:185], v10 offset:12288
    v_lshlrev_b32 v118, 16, v49
    v_mfma_f32_16x16x32_bf16 v[240:243], a[204:207], a[240:243], v[240:243]
    s_waitcnt vmcnt(5)
    ds_read_b64_tr_b16 a[186:187], v10 offset:14336
    v_and_b32 v119, 0xffff0000, v49
    ds_read_b64_tr_b16 a[188:189], v10 offset:8192
    v_mfma_f32_16x16x32_bf16 v[248:251], a[204:207], a[244:247], v[248:251]
    buffer_store_dword v17, v7, s[24:27], s67 offen offset:8 sc1
    ds_read_b64_tr_b16 a[190:191], v10 offset:10240
    v_mfma_f32_16x16x32_bf16 v[248:251], a[200:203], a[228:231], v[248:251]
    s_waitcnt lgkmcnt(6)
    ds_read_b64_tr_b16 a[192:193], v11 offset:12288
    s_add_u32 s73, s73, s65
    v_mfma_f32_16x16x32_bf16 v[252:255], a[208:211], a[228:231], v[252:255]
    s_waitcnt lgkmcnt(5)
    ds_read_b64_tr_b16 a[194:195], v11 offset:14336
    s_bitset1_b32 s80, s69
    v_mfma_f32_16x16x32_bf16 v[252:255], a[212:215], a[244:247], v[252:255]
    ds_read_b64_tr_b16 a[196:197], v11 offset:8192
    v_mfma_f32_16x16x32_bf16 v[244:247], a[212:215], a[240:243], v[244:247]
    ds_read_b64_tr_b16 a[198:199], v11 offset:10240
    v_mfma_f32_16x16x32_bf16 v[244:247], a[208:211], a[224:227], v[244:247]
    s_waitcnt lgkmcnt(6)
    ds_read_b64_tr_b16 a[200:201], v10 offset:4096
    v_mfma_f32_16x16x32_bf16 v[240:243], a[184:187], a[160:163], v[240:243]
    s_waitcnt lgkmcnt(5)
    ds_read_b64_tr_b16 a[202:203], v10 offset:6144
    v_mfma_f32_16x16x32_bf16 v[240:243], a[188:191], a[176:179], v[240:243]
    ds_read_b64_tr_b16 a[204:205], v10 offset:0
    v_mfma_f32_16x16x32_bf16 v[248:251], a[188:191], a[180:183], v[248:251]
    ds_read_b64_tr_b16 a[206:207], v10 offset:2048
    v_mfma_f32_16x16x32_bf16 v[248:251], a[184:187], a[164:167], v[248:251]
    s_waitcnt lgkmcnt(6)
    ds_read_b64_tr_b16 a[208:209], v11 offset:4096
    v_mfma_f32_16x16x32_bf16 v[252:255], a[192:195], a[164:167], v[252:255]
    s_waitcnt lgkmcnt(5)
    ds_read_b64_tr_b16 a[210:211], v11 offset:6144
    v_mfma_f32_16x16x32_bf16 v[252:255], a[196:199], a[180:183], v[252:255]
    buffer_load_dwordx4 v[68:71], v14, s[24:27], s73 offen sc1
    ds_read_b64_tr_b16 a[212:213], v11 offset:0
    v_mfma_f32_16x16x32_bf16 v[244:247], a[196:199], a[176:179], v[244:247]
    ds_read_b64_tr_b16 a[214:215], v11 offset:2048
    v_mfma_f32_16x16x32_bf16 v[244:247], a[192:195], a[160:163], v[244:247]
    s_waitcnt lgkmcnt(6)
    v_mfma_f32_16x16x32_bf16 v[240:243], a[200:203], a[88:91], v[240:243]
    s_waitcnt lgkmcnt(4)
    buffer_load_dwordx4 v[72:75], v14, s[24:27], s73 offen offset:1024 sc1
    v_mfma_f32_16x16x32_bf16 v[240:243], a[204:207], a[104:107], v[240:243]
    buffer_load_dwordx2 v[66:67], v39, s[24:27], s73 offen offset:2048 sc1
    v_mfma_f32_16x16x32_bf16 v[248:251], a[204:207], a[108:111], v[248:251]
    v_mfma_f32_16x16x32_bf16 v[248:251], a[200:203], a[92:95], v[248:251]
    s_waitcnt lgkmcnt(2)
    v_mfma_f32_16x16x32_bf16 v[252:255], a[208:211], a[92:95], v[252:255]
    s_waitcnt lgkmcnt(0)
    v_mfma_f32_16x16x32_bf16 v[252:255], a[212:215], a[108:111], v[252:255]
    s_waitcnt vmcnt(7)
    s_load_dwordx8 s[28:35], s[86:87], s93 glc
    v_mfma_f32_16x16x32_bf16 v[244:247], a[212:215], a[104:107], v[244:247]
    buffer_store_dword v16, v7, s[24:27], s77 offen offset:0 sc1
    v_mfma_f32_16x16x32_bf16 v[244:247], a[208:211], a[88:91], v[244:247]
    v_mfma_f32_16x16x32_bf16 v[124:127], v[186:189], v[96:99], v[124:127]
    v_mfma_f32_16x16x32_bf16 v[240:243], v[186:189], v[98:101], v[240:243]
    v_mfma_f32_16x16x32_bf16 v[244:247], v[188:191], v[98:101], v[244:247]
    v_mfma_f32_16x16x32_bf16 v[252:255], v[188:191], v[102:105], v[252:255]
    v_mfma_f32_16x16x32_bf16 v[248:251], v[186:189], v[102:105], v[248:251]
    v_mfma_f32_16x16x32_bf16 v[124:127], v[186:189], v[106:109], v[124:127]
    v_mfma_f32_16x16x32_bf16 v[240:243], v[186:189], v[108:111], v[240:243]
    v_mfma_f32_16x16x32_bf16 v[244:247], v[188:191], v[108:111], v[244:247]
    v_mfma_f32_16x16x32_bf16 v[252:255], v[188:191], v[112:115], v[252:255]
    v_mfma_f32_16x16x32_bf16 v[248:251], v[186:189], v[112:115], v[248:251]
    v_mfma_f32_16x16x32_bf16 v[124:127], v[186:189], v[128:131], v[124:127]
    v_mfma_f32_16x16x32_bf16 v[240:243], v[186:189], v[130:133], v[240:243]
    v_mfma_f32_16x16x32_bf16 v[244:247], v[188:191], v[130:133], v[244:247]
    v_mfma_f32_16x16x32_bf16 v[252:255], v[188:191], v[134:137], v[252:255]
    v_mfma_f32_16x16x32_bf16 v[248:251], v[186:189], v[134:137], v[248:251]
    v_mfma_f32_16x16x32_bf16 v[124:127], v[186:189], v[138:141], v[124:127]
    v_mfma_f32_16x16x32_bf16 v[240:243], v[186:189], v[140:143], v[240:243]
    v_mfma_f32_16x16x32_bf16 v[244:247], v[188:191], v[140:143], v[244:247]
    v_mfma_f32_16x16x32_bf16 v[252:255], v[188:191], v[144:147], v[252:255]
    v_mfma_f32_16x16x32_bf16 v[248:251], v[186:189], v[144:147], v[248:251]
post_code:
    s_cmp_eq_u32 s80, -1
    s_cbranch_scc1 ev_st
    s_or_b64 s[88:89], s[28:29], s[30:31]
    s_or_b64 s[88:89], s[88:89], s[32:33]
    s_or_b64 s[88:89], s[88:89], s[34:35]
    s_or_b32 s66, s88, s89
    s_andn2_b32 s69, s66, s80
    s_cbranch_scc1 ev_i2
    s_branch ev_w2
ev_st:
    s_waitcnt vmcnt(1)
    v_mfma_f32_16x16x32_bf16 v[124:127], v[186:189], v[56:59], v[124:127]
    v_mfma_f32_16x16x32_bf16 v[240:243], v[186:189], v[58:61], v[240:243]
    v_mfma_f32_16x16x32_bf16 v[244:247], v[188:191], v[58:61], v[244:247]
    v_mfma_f32_16x16x32_bf16 v[252:255], v[188:191], v[62:65], v[252:255]
    v_mfma_f32_16x16x32_bf16 v[248:251], v[186:189], v[62:65], v[248:251]
    v_mfma_f32_16x16x32_bf16 v[124:127], v[186:189], v[66:69], v[124:127]
    v_mfma_f32_16x16x32_bf16 v[240:243], v[186:189], v[68:71], v[240:243]
    v_mfma_f32_16x16x32_bf16 v[244:247], v[188:191], v[68:71], v[244:247]
    v_mfma_f32_16x16x32_bf16 v[252:255], v[188:191], v[72:75], v[252:255]
    v_mfma_f32_16x16x32_bf16 v[248:251], v[186:189], v[72:75], v[248:251]
    s_branch ev_sum
ev_w0:
    s_waitcnt lgkmcnt(0)
    s_load_dwordx8 s[28:35], s[86:87], s93 glc
    s_add_u32 s101, s101, 1
    s_cmp_gt_u32 s101, 0x2000000
    s_cbranch_scc1 ev_done
    s_or_b64 s[88:89], s[28:29], s[30:31]
    s_or_b64 s[88:89], s[88:89], s[32:33]
    s_or_b64 s[88:89], s[88:89], s[34:35]
    s_or_b32 s66, s88, s89
    s_andn2_b32 s69, s66, s80
    s_cbranch_scc0 ev_w0
ev_i0:
    s_ff1_i32_b32 s69, s69
    s_xor_b32 s81, s53, s69
    s_mul_i32 s81, s81, 20480
    s_add_u32 s81, s81, s59
    s_bitset1_b32 s80, s69
    s_cmp_eq_u32 s80, -1
    s_cbranch_scc0 ev_n0
    buffer_load_dwordx4 a[122:125], v14, s[24:27], s81 offen sc1
    buffer_load_dwordx4 a[126:129], v14, s[24:27], s81 offen offset:1024 sc1
    buffer_load_dwordx2 a[120:121], v39, s[24:27], s81 offen offset:2048 sc1
    s_branch ev_z
ev_n0:
    buffer_load_dwordx4 v[58:61], v14, s[24:27], s81 offen sc1
    buffer_load_dwordx4 v[62:65], v14, s[24:27], s81 offen offset:1024 sc1
    buffer_load_dwordx2 v[56:57], v39, s[24:27], s81 offen offset:2048 sc1
    s_andn2_b32 s69, s66, s80
    s_cbranch_scc0 ev_w1
ev_i1:
    s_ff1_i32_b32 s69, s69
    s_xor_b32 s81, s53, s69
    s_mul_i32 s81, s81, 20480
    s_add_u32 s81, s81, s59
    s_bitset1_b32 s80, s69
    s_cmp_eq_u32 s80, -1
    s_cbranch_scc1 ev_l1
    buffer_load_dwordx4 v[68:71], v14, s[24:27], s81 offen sc1
    buffer_load_dwordx4 v[72:75], v14, s[24:27], s81 offen offset:1024 sc1
    buffer_load_dwordx2 v[66:67], v39, s[24:27], s81 offen offset:2048 sc1
    s_andn2_b32 s69, s66, s80
    s_cbranch_scc0 ev_w2
ev_i2:
    s_ff1_i32_b32 s69, s69
    s_xor_b32 s81, s53, s69
    s_mul_i32 s81, s81, 20480
    s_add_u32 s81, s81, s59
    s_bitset1_b32 s80, s69
    s_cmp_eq_u32 s80, -1
    s_cbranch_scc1 ev_l2
    buffer_load_dwordx4 a[2:5], v14, s[24:27], s81 offen sc1
    buffer_load_dwordx4 a[6:9], v14, s[24:27], s81 offen offset:1024 sc1
    buffer_load_dwordx2 a[0:1], v39, s[24:27], s81 offen offset:2048 sc1
    s_andn2_b32 s69, s66, s80
    s_cbranch_scc0 ev_w3
ev_i3:
    s_ff1_i32_b32 s69, s69
    s_xor_b32 s81, s53, s69
    s_mul_i32 s81, s81, 20480
    s_add_u32 s81, s81, s59
    s_bitset1_b32 s80, s69
    s_cmp_eq_u32 s80, -1
    s_cbranch_scc1 ev_l3
    buffer_load_dwordx4 a[12:15], v14, s[24:27], s81 offen sc1
    buffer_load_dwordx4 a[16:19], v14, s[24:27], s81 offen offset:1024 sc1
    buffer_load_dwordx2 a[10:11], v39, s[24:27], s81 offen offset:2048 sc1
    s_andn2_b32 s69, s66, s80
    s_cbranch_scc0 ev_w4
ev_i4:
    s_ff1_i32_b32 s69, s69
    s_xor_b32 s81, s53, s69
    s_mul_i32 s81, s81, 20480
    s_add_u32 s81, s81, s59
    s_bitset1_b32 s80, s69
    s_cmp_eq_u32 s80, -1
    s_cbranch_scc1 ev_l4
    buffer_load_dwordx4 a[22:25], v14, s[24:27], s81 offen sc1
    buffer_load_dwordx4 a[26:29], v14, s[24:27], s81 offen offset:1024 sc1
    buffer_load_dwordx2 a[20:21], v39, s[24:27], s81 offen offset:2048 sc1
    s_andn2_b32 s69, s66, s80
    s_cbranch_scc0 ev_w5
ev_i5:
    s_ff1_i32_b32 s69, s69
    s_xor_b32 s81, s53, s69
    s_mul_i32 s81, s81, 20480
    s_add_u32 s81, s81, s59
    s_bitset1_b32 s80, s69
    s_cmp_eq_u32 s80, -1
    s_cbranch_scc1 ev_l5
    buffer_load_dwordx4 a[32:35], v14, s[24:27], s81 offen sc1
    buffer_load_dwordx4 a[36:39], v14, s[24:27], s81 offen offset:1024 sc1
    buffer_load_dwordx2 a[30:31], v39, s[24:27], s81 offen offset:2048 sc1
    s_waitcnt vmcnt(0)
ev_c6:
    v_mfma_f32_16x16x32_bf16 v[124:127], v[186:189], a[30:33], v[124:127]
    v_mfma_f32_16x16x32_bf16 v[240:243], v[186:189], a[32:35], v[240:243]
    v_mfma_f32_16x16x32_bf16 v[244:247], v[188:191], a[32:35], v[244:247]
    v_mfma_f32_16x16x32_bf16 v[252:255], v[188:191], a[36:39], v[252:255]
    v_mfma_f32_16x16x32_bf16 v[248:251], v[186:189], a[36:39], v[248:251]
ev_c5:
    v_mfma_f32_16x16x32_bf16 v[124:127], v[186:189], a[20:23], v[124:127]
    v_mfma_f32_16x16x32_bf16 v[240:243], v[186:189], a[22:25], v[240:243]
    v_mfma_f32_16x16x32_bf16 v[244:247], v[188:191], a[22:25], v[244:247]
    v_mfma_f32_16x16x32_bf16 v[252:255], v[188:191], a[26:29], v[252:255]
    v_mfma_f32_16x16x32_bf16 v[248:251], v[186:189], a[26:29], v[248:251]
ev_c4:
    v_mfma_f32_16x16x32_bf16 v[124:127], v[186:189], a[10:13], v[124:127]
    v_mfma_f32_16x16x32_bf16 v[240:243], v[186:189], a[12:15], v[240:243]
    v_mfma_f32_16x16x32_bf16 v[244:247], v[188:191], a[12:15], v[244:247]
    v_mfma_f32_16x16x32_bf16 v[252:255], v[188:191], a[16:19], v[252:255]
    v_mfma_f32_16x16x32_bf16 v[248:251], v[186:189], a[16:19], v[248:251]
ev_c3:
    v_mfma_f32_16x16x32_bf16 v[124:127], v[186:189], a[0:3], v[124:127]
    v_mfma_f32_16x16x32_bf16 v[240:243], v[186:189], a[2:5], v[240:243]
    v_mfma_f32_16x16x32_bf16 v[244:247], v[188:191], a[2:5], v[244:247]
    v_mfma_f32_16x16x32_bf16 v[252:255], v[188:191], a[6:9], v[252:255]
    v_mfma_f32_16x16x32_bf16 v[248:251], v[186:189], a[6:9], v[248:251]
ev_c2:
    v_mfma_f32_16x16x32_bf16 v[124:127], v[186:189], v[66:69], v[124:127]
    v_mfma_f32_16x16x32_bf16 v[240:243], v[186:189], v[68:71], v[240:243]
    v_mfma_f32_16x16x32_bf16 v[244:247], v[188:191], v[68:71], v[244:247]
    v_mfma_f32_16x16x32_bf16 v[252:255], v[188:191], v[72:75], v[252:255]
    v_mfma_f32_16x16x32_bf16 v[248:251], v[186:189], v[72:75], v[248:251]
ev_c1:
    v_mfma_f32_16x16x32_bf16 v[124:127], v[186:189], v[56:59], v[124:127]
    v_mfma_f32_16x16x32_bf16 v[240:243], v[186:189], v[58:61], v[240:243]
    v_mfma_f32_16x16x32_bf16 v[244:247], v[188:191], v[58:61], v[244:247]
    v_mfma_f32_16x16x32_bf16 v[252:255], v[188:191], v[62:65], v[252:255]
    v_mfma_f32_16x16x32_bf16 v[248:251], v[186:189], v[62:65], v[248:251]
    s_cmp_lg_u32 s80, -1
    s_cbranch_scc1 ev_w0
ev_z:
    s_waitcnt vmcnt(0)
    v_mfma_f32_16x16x32_bf16 v[124:127], v[186:189], a[120:123], v[124:127]
    v_mfma_f32_16x16x32_bf16 v[240:243], v[186:189], a[122:125], v[240:243]
    v_mfma_f32_16x16x32_bf16 v[244:247], v[188:191], a[122:125], v[244:247]
    v_mfma_f32_16x16x32_bf16 v[252:255], v[188:191], a[126:129], v[252:255]
    v_mfma_f32_16x16x32_bf16 v[248:251], v[186:189], a[126:129], v[248:251]
ev_sum:
    s_nop 4
    v_pk_fma_f32 v[124:125], v[124:125], v[116:117], v[50:51]
    v_pk_fma_f32 v[126:127], v[126:127], v[118:119], v[52:53]
    v_cvt_pk_bf16_f32 v124, v124, v125
    v_cvt_pk_bf16_f32 v125, v126, v127
    buffer_store_dwordx2 v[124:125], v35, s[16:19], s68 offen sc1
    v_pk_fma_f32 v[240:241], v[240:241], v[208:209], v[192:193]
    v_pk_fma_f32 v[242:243], v[242:243], v[210:211], v[194:195]
    v_pk_fma_f32 v[244:245], v[244:245], v[212:213], v[196:197]
    v_pk_fma_f32 v[246:247], v[246:247], v[214:215], v[198:199]
    v_cvt_pk_bf16_f32 v240, v240, v241
    v_cvt_pk_bf16_f32 v241, v242, v243
    v_cvt_pk_bf16_f32 v242, v244, v245
    v_cvt_pk_bf16_f32 v243, v246, v247
    s_nop 1
    v_permlane16_swap_b32 v240, v242
    v_permlane16_swap_b32 v241, v243
    buffer_store_dwordx4 v[240:243], v4, s[16:19], s64 offen sc1
    v_pk_fma_f32 v[248:249], v[248:249], v[216:217], v[200:201]
    v_pk_fma_f32 v[250:251], v[250:251], v[218:219], v[202:203]
    v_pk_fma_f32 v[252:253], v[252:253], v[220:221], v[204:205]
    v_pk_fma_f32 v[254:255], v[254:255], v[222:223], v[206:207]
    v_cvt_pk_bf16_f32 v248, v248, v249
    v_cvt_pk_bf16_f32 v249, v250, v251
    v_cvt_pk_bf16_f32 v250, v252, v253
    v_cvt_pk_bf16_f32 v251, v254, v255
    s_nop 1
    v_permlane16_swap_b32 v248, v250
    v_permlane16_swap_b32 v249, v251
    buffer_store_dwordx4 v[248:251], v34, s[16:19], s64 offen sc1
ev_done:
    s_or_b32 s56, s2, s3
    s_cmp_eq_u32 s56, 0
    s_cselect_b32 s56, 0, 0x7ffffff0
    s_add_u32 s56, s56, 3203072
    buffer_store_dword v6, v15, s[24:27], s56 offen
main_fin:
main_end:
    s_endpgm
ev_w1:
    s_getreg_b32 s56, hwreg(HW_REG_IB_STS, 0, 4)
    s_cmp_eq_u32 s56, 0
    s_cbranch_scc1 ev_d1
    s_waitcnt lgkmcnt(0)
    s_load_dwordx8 s[28:35], s[86:87], s93 glc
    s_add_u32 s101, s101, 1
    s_cmp_gt_u32 s101, 0x2000000
    s_cbranch_scc1 ev_done
    s_or_b64 s[88:89], s[28:29], s[30:31]
    s_or_b64 s[88:89], s[88:89], s[32:33]
    s_or_b64 s[88:89], s[88:89], s[34:35]
    s_or_b32 s66, s88, s89
    s_andn2_b32 s69, s66, s80
    s_cbranch_scc0 ev_w1
    s_branch ev_i1
ev_d1:
    s_waitcnt vmcnt(0)
    s_branch ev_c1
ev_l1:
    buffer_load_dwordx4 a[122:125], v14, s[24:27], s81 offen sc1
    buffer_load_dwordx4 a[126:129], v14, s[24:27], s81 offen offset:1024 sc1
    buffer_load_dwordx2 a[120:121], v39, s[24:27], s81 offen offset:2048 sc1
    s_waitcnt vmcnt(3)
    s_branch ev_c1
ev_w2:
    s_getreg_b32 s56, hwreg(HW_REG_IB_STS, 0, 4)
    s_cmp_eq_u32 s56, 0
    s_cbranch_scc1 ev_d2
    s_waitcnt lgkmcnt(0)
    s_load_dwordx8 s[28:35], s[86:87], s93 glc
    s_add_u32 s101, s101, 1
    s_cmp_gt_u32 s101, 0x2000000
    s_cbranch_scc1 ev_done
    s_or_b64 s[88:89], s[28:29], s[30:31]
    s_or_b64 s[88:89], s[88:89], s[32:33]
    s_or_b64 s[88:89], s[88:89], s[34:35]
    s_or_b32 s66, s88, s89
    s_andn2_b32 s69, s66, s80
    s_cbranch_scc0 ev_w2
    s_branch ev_i2
ev_d2:
    s_waitcnt vmcnt(0)
    s_branch ev_c2
ev_l2:
    buffer_load_dwordx4 a[122:125], v14, s[24:27], s81 offen sc1
    buffer_load_dwordx4 a[126:129], v14, s[24:27], s81 offen offset:1024 sc1
    buffer_load_dwordx2 a[120:121], v39, s[24:27], s81 offen offset:2048 sc1
    s_waitcnt vmcnt(3)
    s_branch ev_c2
ev_w3:
    s_getreg_b32 s56, hwreg(HW_REG_IB_STS, 0, 4)
    s_cmp_eq_u32 s56, 0
    s_cbranch_scc1 ev_d3
    s_waitcnt lgkmcnt(0)
    s_load_dwordx8 s[28:35], s[86:87], s93 glc
    s_add_u32 s101, s101, 1
    s_cmp_gt_u32 s101, 0x2000000
    s_cbranch_scc1 ev_done
    s_or_b64 s[88:89], s[28:29], s[30:31]
    s_or_b64 s[88:89], s[88:89], s[32:33]
    s_or_b64 s[88:89], s[88:89], s[34:35]
    s_or_b32 s66, s88, s89
    s_andn2_b32 s69, s66, s80
    s_cbranch_scc0 ev_w3
    s_branch ev_i3
ev_d3:
    s_waitcnt vmcnt(0)
    s_branch ev_c3
ev_l3:
    buffer_load_dwordx4 a[122:125], v14, s[24:27], s81 offen sc1
    buffer_load_dwordx4 a[126:129], v14, s[24:27], s81 offen offset:1024 sc1
    buffer_load_dwordx2 a[120:121], v39, s[24:27], s81 offen offset:2048 sc1
    s_waitcnt vmcnt(3)
    s_branch ev_c3
ev_w4:
    s_getreg_b32 s56, hwreg(HW_REG_IB_STS, 0, 4)
    s_cmp_eq_u32 s56, 0
    s_cbranch_scc1 ev_d4
    s_waitcnt lgkmcnt(0)
    s_load_dwordx8 s[28:35], s[86:87], s93 glc
    s_add_u32 s101, s101, 1
    s_cmp_gt_u32 s101, 0x2000000
    s_cbranch_scc1 ev_done
    s_or_b64 s[88:89], s[28:29], s[30:31]
    s_or_b64 s[88:89], s[88:89], s[32:33]
    s_or_b64 s[88:89], s[88:89], s[34:35]
    s_or_b32 s66, s88, s89
    s_andn2_b32 s69, s66, s80
    s_cbranch_scc0 ev_w4
    s_branch ev_i4
ev_d4:
    s_waitcnt vmcnt(0)
    s_branch ev_c4
ev_l4:
    buffer_load_dwordx4 a[122:125], v14, s[24:27], s81 offen sc1
    buffer_load_dwordx4 a[126:129], v14, s[24:27], s81 offen offset:1024 sc1
    buffer_load_dwordx2 a[120:121], v39, s[24:27], s81 offen offset:2048 sc1
    s_waitcnt vmcnt(3)
    s_branch ev_c4
ev_w5:
    s_getreg_b32 s56, hwreg(HW_REG_IB_STS, 0, 4)
    s_cmp_eq_u32 s56, 0
    s_cbranch_scc1 ev_d5
    s_waitcnt lgkmcnt(0)
    s_load_dwordx8 s[28:35], s[86:87], s93 glc
    s_add_u32 s101, s101, 1
    s_cmp_gt_u32 s101, 0x2000000
    s_cbranch_scc1 ev_done
    s_or_b64 s[88:89], s[28:29], s[30:31]
    s_or_b64 s[88:89], s[88:89], s[32:33]
    s_or_b64 s[88:89], s[88:89], s[34:35]
    s_or_b32 s66, s88, s89
    s_andn2_b32 s69, s66, s80
    s_cbranch_scc0 ev_w5
    s_branch ev_i5
ev_d5:
    s_waitcnt vmcnt(0)
    s_branch ev_c5
ev_l5:
    buffer_load_dwordx4 a[122:125], v14, s[24:27], s81 offen sc1
    buffer_load_dwordx4 a[126:129], v14, s[24:27], s81 offen offset:1024 sc1
    buffer_load_dwordx2 a[120:121], v39, s[24:27], s81 offen offset:2048 sc1
    s_waitcnt vmcnt(3)
    s_branch ev_c5
spin_o0:
    s_load_dwordx4 s[72:75], s[86:87], s5 glc
    s_add_u32 s101, s101, 1
    s_cmp_gt_u32 s101, 0x2000000
    s_waitcnt lgkmcnt(0)
    s_cbranch_scc1 spin_o0_ret
    s_sub_u32 s78, s72, s77
    s_sub_u32 s79, s73, s77
    s_max_u32 s78, s78, s79
    s_sub_u32 s79, s74, s77
    s_max_u32 s78, s78, s79
    s_sub_u32 s79, s75, s77
    s_max_u32 s78, s78, s79
    s_cmp_gt_u32 s78, 5
    s_cbranch_scc1 spin_o0
    s_branch spin_o0_ret
spin_o1:
    s_load_dwordx4 s[72:75], s[86:87], s5 glc
    s_add_u32 s101, s101, 1
    s_cmp_gt_u32 s101, 0x2000000
    s_waitcnt lgkmcnt(0)
    s_cbranch_scc1 spin_o1_ret
    s_sub_u32 s78, s72, s77
    s_sub_u32 s79, s73, s77
    s_max_u32 s78, s78, s79
    s_sub_u32 s79, s74, s77
    s_max_u32 s78, s78, s79
    s_sub_u32 s79, s75, s77
    s_max_u32 s78, s78, s79
    s_cmp_gt_u32 s78, 4
    s_cbranch_scc1 spin_o1
    s_branch spin_o1_ret
spin_o2:
    s_load_dwordx4 s[72:75], s[86:87], s5 glc
    s_add_u32 s101, s101, 1
    s_cmp_gt_u32 s101, 0x2000000
    s_waitcnt lgkmcnt(0)
    s_cbranch_scc1 spin_o2_ret
    s_sub_u32 s78, s72, s77
    s_sub_u32 s79, s73, s77
    s_max_u32 s78, s78, s79
    s_sub_u32 s79, s74, s77
    s_max_u32 s78, s78, s79
    s_sub_u32 s79, s75, s77
    s_max_u32 s78, s78, s79
    s_cmp_gt_u32 s78, 3
    s_cbranch_scc1 spin_o2
    s_branch spin_o2_ret
spin_o3:
    s_load_dwordx4 s[72:75], s[86:87], s5 glc
    s_add_u32 s101, s101, 1
    s_cmp_gt_u32 s101, 0x2000000
    s_waitcnt lgkmcnt(0)
    s_cbranch_scc1 spin_o3_ret
    s_sub_u32 s78, s72, s77
    s_sub_u32 s79, s73, s77
    s_max_u32 s78, s78, s79
    s_sub_u32 s79, s74, s77
    s_max_u32 s78, s78, s79
    s_sub_u32 s79, s75, s77
    s_max_u32 s78, s78, s79
    s_cmp_gt_u32 s78, 2
    s_cbranch_scc1 spin_o3
    s_branch spin_o3_ret
spin_o4:
    s_load_dwordx4 s[72:75], s[86:87], s5 glc
    s_add_u32 s101, s101, 1
    s_cmp_gt_u32 s101, 0x2000000
    s_waitcnt lgkmcnt(0)
    s_cbranch_scc1 spin_o4_ret
    s_sub_u32 s78, s72, s77
    s_sub_u32 s79, s73, s77
    s_max_u32 s78, s78, s79
    s_sub_u32 s79, s74, s77
    s_max_u32 s78, s78, s79
    s_sub_u32 s79, s75, s77
    s_max_u32 s78, s78, s79
    s_cmp_gt_u32 s78, 1
    s_cbranch_scc1 spin_o4
    s_branch spin_o4_ret
spin_o5:
    s_load_dwordx4 s[72:75], s[86:87], s5 glc
    s_add_u32 s101, s101, 1
    s_cmp_gt_u32 s101, 0x2000000
    s_waitcnt lgkmcnt(0)
    s_cbranch_scc1 spin_o5_ret
    s_sub_u32 s78, s72, s77
    s_sub_u32 s79, s73, s77
    s_max_u32 s78, s78, s79
    s_sub_u32 s79, s74, s77
    s_max_u32 s78, s78, s79
    s_sub_u32 s79, s75, s77
    s_max_u32 s78, s78, s79
    s_cmp_gt_u32 s78, 0
    s_cbranch_scc1 spin_o5
    s_branch spin_o5_ret
ln_exact:
    v_mov_b32 v146, 0
    v_lshlrev_b32 v156, 16, v64
    v_and_b32 v157, s42, v64
    v_sub_f32 v156, v156, v150
    v_sub_f32 v157, v157, v150
    v_fmac_f32 v146, v156, v156
    v_fmac_f32 v146, v157, v157
    v_lshlrev_b32 v156, 16, v65
    v_and_b32 v157, s42, v65
    v_sub_f32 v156, v156, v150
    v_sub_f32 v157, v157, v150
    v_fmac_f32 v146, v156, v156
    v_fmac_f32 v146, v157, v157
    v_lshlrev_b32 v156, 16, v66
    v_and_b32 v157, s42, v66
    v_sub_f32 v156, v156, v150
    v_sub_f32 v157, v157, v150
    v_fmac_f32 v146, v156, v156
    v_fmac_f32 v146, v157, v157
    v_lshlrev_b32 v156, 16, v67
    v_and_b32 v157, s42, v67
    v_sub_f32 v156, v156, v150
    v_sub_f32 v157, v157, v150
    v_fmac_f32 v146, v156, v156
    v_fmac_f32 v146, v157, v157
    v_lshlrev_b32 v156, 16, v68
    v_and_b32 v157, s42, v68
    v_sub_f32 v156, v156, v150
    v_sub_f32 v157, v157, v150
    v_fmac_f32 v146, v156, v156
    v_fmac_f32 v146, v157, v157
    v_lshlrev_b32 v156, 16, v69
    v_and_b32 v157, s42, v69
    v_sub_f32 v156, v156, v150
    v_sub_f32 v157, v157, v150
    v_fmac_f32 v146, v156, v156
    v_fmac_f32 v146, v157, v157
    v_lshlrev_b32 v156, 16, v70
    v_and_b32 v157, s42, v70
    v_sub_f32 v156, v156, v150
    v_sub_f32 v157, v157, v150
    v_fmac_f32 v146, v156, v156
    v_fmac_f32 v146, v157, v157
    v_lshlrev_b32 v156, 16, v71
    v_and_b32 v157, s42, v71
    v_sub_f32 v156, v156, v150
    v_sub_f32 v157, v157, v150
    v_fmac_f32 v146, v156, v156
    v_fmac_f32 v146, v157, v157
    v_lshlrev_b32 v156, 16, v72
    v_and_b32 v157, s42, v72
    v_sub_f32 v156, v156, v150
    v_sub_f32 v157, v157, v150
    v_fmac_f32 v146, v156, v156
    v_fmac_f32 v146, v157, v157
    v_lshlrev_b32 v156, 16, v73
    v_and_b32 v157, s42, v73
    v_sub_f32 v156, v156, v150
    v_sub_f32 v157, v157, v150
    v_fmac_f32 v146, v156, v156
    v_fmac_f32 v146, v157, v157
    v_lshlrev_b32 v156, 16, v74
    v_and_b32 v157, s42, v74
    v_sub_f32 v156, v156, v150
    v_sub_f32 v157, v157, v150
    v_fmac_f32 v146, v156, v156
    v_fmac_f32 v146, v157, v157
    v_lshlrev_b32 v156, 16, v75
    v_and_b32 v157, s42, v75
    v_sub_f32 v156, v156, v150
    v_sub_f32 v157, v157, v150
    v_fmac_f32 v146, v156, v156
    v_fmac_f32 v146, v157, v157
    v_lshlrev_b32 v156, 16, v76
    v_and_b32 v157, s42, v76
    v_sub_f32 v156, v156, v150
    v_sub_f32 v157, v157, v150
    v_fmac_f32 v146, v156, v156
    v_fmac_f32 v146, v157, v157
    v_lshlrev_b32 v156, 16, v77
    v_and_b32 v157, s42, v77
    v_sub_f32 v156, v156, v150
    v_sub_f32 v157, v157, v150
    v_fmac_f32 v146, v156, v156
    v_fmac_f32 v146, v157, v157
    v_lshlrev_b32 v156, 16, v78
    v_and_b32 v157, s42, v78
    v_sub_f32 v156, v156, v150
    v_sub_f32 v157, v157, v150
    v_fmac_f32 v146, v156, v156
    v_fmac_f32 v146, v157, v157
    v_lshlrev_b32 v156, 16, v79
    v_and_b32 v157, s42, v79
    v_sub_f32 v156, v156, v150
    v_sub_f32 v157, v157, v150
    v_fmac_f32 v146, v156, v156
    v_fmac_f32 v146, v157, v157
    v_lshlrev_b32 v156, 16, v80
    v_and_b32 v157, s42, v80
    v_sub_f32 v156, v156, v150
    v_sub_f32 v157, v157, v150
    v_fmac_f32 v146, v156, v156
    v_fmac_f32 v146, v157, v157
    v_lshlrev_b32 v156, 16, v81
    v_and_b32 v157, s42, v81
    v_sub_f32 v156, v156, v150
    v_sub_f32 v157, v157, v150
    v_fmac_f32 v146, v156, v156
    v_fmac_f32 v146, v157, v157
    v_lshlrev_b32 v156, 16, v82
    v_and_b32 v157, s42, v82
    v_sub_f32 v156, v156, v150
    v_sub_f32 v157, v157, v150
    v_fmac_f32 v146, v156, v156
    v_fmac_f32 v146, v157, v157
    v_lshlrev_b32 v156, 16, v83
    v_and_b32 v157, s42, v83
    v_sub_f32 v156, v156, v150
    v_sub_f32 v157, v157, v150
    v_fmac_f32 v146, v156, v156
    v_fmac_f32 v146, v157, v157
    s_nop 0
    s_nop 0
    v_add_f32_dpp v146, v146, v146 quad_perm:[1,0,3,2] row_mask:0xf bank_mask:0xf
    s_nop 0
    s_nop 0
    v_add_f32_dpp v146, v146, v146 row_ror:8 row_mask:0xf bank_mask:0xf
    v_mov_b32 v148, v146
    s_nop 0
    s_nop 0
    v_permlane16_swap_b32 v146, v148
    s_nop 0
    s_nop 0
    v_add_f32 v146, v146, v148
    v_mov_b32 v148, v146
    s_nop 0
    s_nop 0
    v_permlane32_swap_b32 v146, v148
    s_nop 0
    s_nop 0
    v_add_f32 v146, v146, v148
    v_mul_f32 v154, s38, v146
    s_branch ln_back
spin_y:
    s_add_u32 s101, s101, 1
    s_cmp_gt_u32 s101, 0x2000000
    s_cbranch_scc1 spin_y_x
    buffer_load_dword v58, v65, s[24:27], s41 offen sc1
    buffer_load_dword v59, v65, s[24:27], s42 offen sc1
    s_waitcnt vmcnt(0)
    v_xor_b32 v58, s58, v58
    v_xor_b32 v59, s58, v59
    v_or_b32 v58, v58, v59
    v_cmp_ne_u32 vcc, 0, v58
    s_cbranch_vccnz spin_y
spin_y_x:
    s_branch spin_y_ret
spin_rec:
    s_add_u32 s101, s101, 1
    s_cmp_gt_u32 s101, 0x2000000
    s_cbranch_scc1 spin_rec_x
    buffer_load_dwordx4 v[32:35], v17, s[24:27], s47 offen offset:0 sc1
    buffer_load_dwordx4 v[36:39], v17, s[24:27], s47 offen offset:1024 sc1
    buffer_load_dwordx4 v[40:43], v17, s[24:27], s47 offen offset:2048 sc1
    buffer_load_dwordx4 v[44:47], v17, s[24:27], s47 offen offset:3072 sc1
    s_waitcnt vmcnt(0)
    v_xor_b32 v34, s7, v34
    v_xor_b32 v38, s7, v38
    v_xor_b32 v42, s7, v42
    v_xor_b32 v46, s7, v46
    v_or3_b32 v34, v34, v38, v42
    v_or_b32 v34, v34, v46
    v_cmp_ne_u32 vcc, 0, v34
    s_cbranch_vccnz spin_rec
spin_rec_x:
    s_branch spin_rec_ret
spin_gu:
    s_add_u32 s101, s101, 1
    s_cmp_gt_u32 s101, 0x2000000
    s_cbranch_scc1 spin_gu_x
    buffer_load_dword v23, v22, s[24:27], s42 offen sc1
    s_waitcnt vmcnt(0)
    v_cmp_ne_u32 vcc, s7, v23
    s_cbranch_vccnz spin_gu
spin_gu_x:
    s_branch spin_gu_ret
rare:
    s_nop 7
    s_nop 7
    v_and_b32 v21, 15, v1
    v_mul_u32_u24 v21, 384, v21
    v_bfe_u32 v22, v1, 4, 1
    v_bfe_u32 v23, v1, 5, 1
    v_lshl_add_u32 v22, v22, 1, v23
    v_lshl_add_u32 v21, v22, 4, v21
    v_mov_b32 v24, 0
    v_mov_b32 v25, 0
    v_mov_b32 v26, 0
    v_mov_b32 v27, 0
    v_mov_b32 v28, 0
    v_mov_b32 v29, 0
    v_mov_b32 v30, 0
    v_mov_b32 v31, 0
    v_mov_b32 v32, 0
    v_mov_b32 v33, 0
    v_mov_b32 v34, 0
    v_mov_b32 v35, 0
    v_mov_b32 v36, 0
    v_mov_b32 v37, 0
    v_mov_b32 v38, 0
    v_mov_b32 v39, 0
    v_mov_b32 v16, 0xff800000
    v_mov_b32 v17, 0xff800000
    v_mov_b32 v18, 0xff800000
    v_mov_b32 v19, 0xff800000
    s_mov_b32 s78, 0
rare_pass:
    s_mov_b32 s77, 0
rare_loop:
    buffer_load_dwordx4 a[216:219], v21, s[12:15], s77 offen offset:0
    buffer_load_dwordx4 a[220:223], v21, s[12:15], s77 offen offset:64
    buffer_load_dwordx4 a[224:227], v21, s[12:15], s77 offen offset:128
    buffer_load_dwordx4 a[228:231], v21, s[12:15], s77 offen offset:192
    buffer_load_dwordx4 a[232:235], v21, s[12:15], s77 offen offset:256
    buffer_load_dwordx4 a[236:239], v21, s[12:15], s77 offen offset:320
    s_waitcnt vmcnt(0)
    v_mfma_f32_16x16x32_bf16 v[40:43], a[216:219], a[0:3], v[24:27]
    v_mfma_f32_16x16x32_bf16 v[44:47], a[216:219], a[4:7], v[28:31]
    v_mfma_f32_16x16x32_bf16 v[48:51], a[216:219], a[8:11], v[32:35]
    v_mfma_f32_16x16x32_bf16 v[52:55], a[216:219], a[12:15], v[36:39]
    v_mfma_f32_16x16x32_bf16 v[40:43], a[220:223], a[16:19], v[40:43]
    v_mfma_f32_16x16x32_bf16 v[44:47], a[220:223], a[20:23], v[44:47]
    v_mfma_f32_16x16x32_bf16 v[48:51], a[220:223], a[24:27], v[48:51]
    v_mfma_f32_16x16x32_bf16 v[52:55], a[220:223], a[28:31], v[52:55]
    v_mfma_f32_16x16x32_bf16 v[40:43], a[224:227], a[32:35], v[40:43]
    v_mfma_f32_16x16x32_bf16 v[44:47], a[224:227], a[36:39], v[44:47]
    v_mfma_f32_16x16x32_bf16 v[48:51], a[224:227], a[40:43], v[48:51]
    v_mfma_f32_16x16x32_bf16 v[52:55], a[224:227], a[44:47], v[52:55]
    v_mfma_f32_16x16x32_bf16 v[40:43], a[228:231], a[48:51], v[40:43]
    v_mfma_f32_16x16x32_bf16 v[44:47], a[228:231], a[52:55], v[44:47]
    v_mfma_f32_16x16x32_bf16 v[48:51], a[228:231], a[56:59], v[48:51]
    v_mfma_f32_16x16x32_bf16 v[52:55], a[228:231], a[60:63], v[52:55]
    v_mfma_f32_16x16x32_bf16 v[40:43], a[232:235], a[64:67], v[40:43]
    v_mfma_f32_16x16x32_bf16 v[44:47], a[232:235], a[68:71], v[44:47]
    v_mfma_f32_16x16x32_bf16 v[48:51], a[232:235], a[72:75], v[48:51]
    v_mfma_f32_16x16x32_bf16 v[52:55], a[232:235], a[76:79], v[52:55]
    v_mfma_f32_16x16x32_bf16 v[40:43], a[236:239], a[80:83], v[40:43]
    v_mfma_f32_16x16x32_bf16 v[44:47], a[236:239], a[84:87], v[44:47]
    v_mfma_f32_16x16x32_bf16 v[48:51], a[236:239], a[88:91], v[48:51]
    v_mfma_f32_16x16x32_bf16 v[52:55], a[236:239], a[92:95], v[52:55]
    s_nop 7
    s_cmp_eq_u32 s78, 0
    s_cbranch_scc0 rare_p2
    v_max3_f32 v16, v16, v40, v41
    v_max3_f32 v16, v16, v42, v43
    v_max3_f32 v17, v17, v44, v45
    v_max3_f32 v17, v17, v46, v47
    v_max3_f32 v18, v18, v48, v49
    v_max3_f32 v18, v18, v50, v51
    v_max3_f32 v19, v19, v52, v53
    v_max3_f32 v19, v19, v54, v55
    s_add_u32 s77, s77, 6144
    s_cmp_lt_u32 s77, 196608
    s_cbranch_scc1 rare_loop
    v_mov_b32 v22, v16
    s_nop 1
    v_permlane16_swap_b32 v16, v22
    s_nop 1
    v_max_f32 v16, v16, v22
    v_mov_b32 v22, v16
    s_nop 1
    v_permlane32_swap_b32 v16, v22
    s_nop 1
    v_max_f32 v16, v16, v22
    v_sub_f32 v24, 0, v16
    v_sub_f32 v25, 0, v16
    v_sub_f32 v26, 0, v16
    v_sub_f32 v27, 0, v16
    v_mov_b32 v22, v17
    s_nop 1
    v_permlane16_swap_b32 v17, v22
    s_nop 1
    v_max_f32 v17, v17, v22
    v_mov_b32 v22, v17
    s_nop 1
    v_permlane32_swap_b32 v17, v22
    s_nop 1
    v_max_f32 v17, v17, v22
    v_sub_f32 v28, 0, v17
    v_sub_f32 v29, 0, v17
    v_sub_f32 v30, 0, v17
    v_sub_f32 v31, 0, v17
    v_mov_b32 v22, v18
    s_nop 1
    v_permlane16_swap_b32 v18, v22
    s_nop 1
    v_max_f32 v18, v18, v22
    v_mov_b32 v22, v18
    s_nop 1
    v_permlane32_swap_b32 v18, v22
    s_nop 1
    v_max_f32 v18, v18, v22
    v_sub_f32 v32, 0, v18
    v_sub_f32 v33, 0, v18
    v_sub_f32 v34, 0, v18
    v_sub_f32 v35, 0, v18
    v_mov_b32 v22, v19
    s_nop 1
    v_permlane16_swap_b32 v19, v22
    s_nop 1
    v_max_f32 v19, v19, v22
    v_mov_b32 v22, v19
    s_nop 1
    v_permlane32_swap_b32 v19, v22
    s_nop 1
    v_max_f32 v19, v19, v22
    v_sub_f32 v36, 0, v19
    v_sub_f32 v37, 0, v19
    v_sub_f32 v38, 0, v19
    v_sub_f32 v39, 0, v19
    s_mov_b32 s78, 1
    s_branch rare_pass
rare_p2:
    v_exp_f32 v40, v40
    v_exp_f32 v41, v41
    v_exp_f32 v42, v42
    v_exp_f32 v43, v43
    v_exp_f32 v44, v44
    v_exp_f32 v45, v45
    v_exp_f32 v46, v46
    v_exp_f32 v47, v47
    v_exp_f32 v48, v48
    v_exp_f32 v49, v49
    v_exp_f32 v50, v50
    v_exp_f32 v51, v51
    v_exp_f32 v52, v52
    v_exp_f32 v53, v53
    v_exp_f32 v54, v54
    v_exp_f32 v55, v55
    s_cmp_eq_u32 s77, 0
    s_cbranch_scc0 rare_d0
    v_cvt_pk_bf16_f32 v22, v40, v41
    v_cvt_pk_bf16_f32 v23, v42, v43
    v_accvgpr_write_b32 a96, v22
    v_accvgpr_write_b32 a97, v23
    v_cvt_pk_bf16_f32 v22, v44, v45
    v_cvt_pk_bf16_f32 v23, v46, v47
    v_accvgpr_write_b32 a104, v22
    v_accvgpr_write_b32 a105, v23
    v_cvt_pk_bf16_f32 v22, v48, v49
    v_cvt_pk_bf16_f32 v23, v50, v51
    v_accvgpr_write_b32 a112, v22
    v_accvgpr_write_b32 a113, v23
    v_cvt_pk_bf16_f32 v22, v52, v53
    v_cvt_pk_bf16_f32 v23, v54, v55
    v_accvgpr_write_b32 a120, v22
    v_accvgpr_write_b32 a121, v23
rare_d0:
    s_cmp_eq_u32 s77, 6144
    s_cbranch_scc0 rare_d1
    v_cvt_pk_bf16_f32 v22, v40, v41
    v_cvt_pk_bf16_f32 v23, v42, v43
    v_accvgpr_write_b32 a98, v22
    v_accvgpr_write_b32 a99, v23
    v_cvt_pk_bf16_f32 v22, v44, v45
    v_cvt_pk_bf16_f32 v23, v46, v47
    v_accvgpr_write_b32 a106, v22
    v_accvgpr_write_b32 a107, v23
    v_cvt_pk_bf16_f32 v22, v48, v49
    v_cvt_pk_bf16_f32 v23, v50, v51
    v_accvgpr_write_b32 a114, v22
    v_accvgpr_write_b32 a115, v23
    v_cvt_pk_bf16_f32 v22, v52, v53
    v_cvt_pk_bf16_f32 v23, v54, v55
    v_accvgpr_write_b32 a122, v22
    v_accvgpr_write_b32 a123, v23
rare_d1:
    s_cmp_eq_u32 s77, 12288
    s_cbranch_scc0 rare_d2
    v_cvt_pk_bf16_f32 v22, v40, v41
    v_cvt_pk_bf16_f32 v23, v42, v43
    v_accvgpr_write_b32 a100, v22
    v_accvgpr_write_b32 a101, v23
    v_cvt_pk_bf16_f32 v22, v44, v45
    v_cvt_pk_bf16_f32 v23, v46, v47
    v_accvgpr_write_b32 a108, v22
    v_accvgpr_write_b32 a109, v23
    v_cvt_pk_bf16_f32 v22, v48, v49
    v_cvt_pk_bf16_f32 v23, v50, v51
    v_accvgpr_write_b32 a116, v22
    v_accvgpr_write_b32 a117, v23
    v_cvt_pk_bf16_f32 v22, v52, v53
    v_cvt_pk_bf16_f32 v23, v54, v55
    v_accvgpr_write_b32 a124, v22
    v_accvgpr_write_b32 a125, v23
rare_d2:
    s_cmp_eq_u32 s77, 18432
    s_cbranch_scc0 rare_d3
    v_cvt_pk_bf16_f32 v22, v40, v41
    v_cvt_pk_bf16_f32 v23, v42, v43
    v_accvgpr_write_b32 a102, v22
    v_accvgpr_write_b32 a103, v23
    v_cvt_pk_bf16_f32 v22, v44, v45
    v_cvt_pk_bf16_f32 v23, v46, v47
    v_accvgpr_write_b32 a110, v22
    v_accvgpr_write_b32 a111, v23
    v_cvt_pk_bf16_f32 v22, v48, v49
    v_cvt_pk_bf16_f32 v23, v50, v51
    v_accvgpr_write_b32 a118, v22
    v_accvgpr_write_b32 a119, v23
    v_cvt_pk_bf16_f32 v22, v52, v53
    v_cvt_pk_bf16_f32 v23, v54, v55
    v_accvgpr_write_b32 a126, v22
    v_accvgpr_write_b32 a127, v23
rare_d3:
    s_cmp_eq_u32 s77, 24576
    s_cbranch_scc0 rare_d4
    v_cvt_pk_bf16_f32 v22, v40, v41
    v_cvt_pk_bf16_f32 v23, v42, v43
    v_accvgpr_write_b32 a128, v22
    v_accvgpr_write_b32 a129, v23
    v_cvt_pk_bf16_f32 v22, v44, v45
    v_cvt_pk_bf16_f32 v23, v46, v47
    v_accvgpr_write_b32 a136, v22
    v_accvgpr_write_b32 a137, v23
    v_cvt_pk_bf16_f32 v22, v48, v49
    v_cvt_pk_bf16_f32 v23, v50, v51
    v_accvgpr_write_b32 a144, v22
    v_accvgpr_write_b32 a145, v23
    v_cvt_pk_bf16_f32 v120, v52, v53
    v_cvt_pk_bf16_f32 v121, v54, v55
rare_d4:
    s_cmp_eq_u32 s77, 30720
    s_cbranch_scc0 rare_d5
    v_cvt_pk_bf16_f32 v22, v40, v41
    v_cvt_pk_bf16_f32 v23, v42, v43
    v_accvgpr_write_b32 a130, v22
    v_accvgpr_write_b32 a131, v23
    v_cvt_pk_bf16_f32 v22, v44, v45
    v_cvt_pk_bf16_f32 v23, v46, v47
    v_accvgpr_write_b32 a138, v22
    v_accvgpr_write_b32 a139, v23
    v_cvt_pk_bf16_f32 v22, v48, v49
    v_cvt_pk_bf16_f32 v23, v50, v51
    v_accvgpr_write_b32 a146, v22
    v_accvgpr_write_b32 a147, v23
    v_cvt_pk_bf16_f32 v122, v52, v53
    v_cvt_pk_bf16_f32 v123, v54, v55
rare_d5:
    s_cmp_eq_u32 s77, 36864
    s_cbranch_scc0 rare_d6
    v_cvt_pk_bf16_f32 v22, v40, v41
    v_cvt_pk_bf16_f32 v23, v42, v43
    v_accvgpr_write_b32 a132, v22
    v_accvgpr_write_b32 a133, v23
    v_cvt_pk_bf16_f32 v22, v44, v45
    v_cvt_pk_bf16_f32 v23, v46, v47
    v_accvgpr_write_b32 a140, v22
    v_accvgpr_write_b32 a141, v23
    v_cvt_pk_bf16_f32 v22, v48, v49
    v_cvt_pk_bf16_f32 v23, v50, v51
    v_accvgpr_write_b32 a148, v22
    v_accvgpr_write_b32 a149, v23
    v_cvt_pk_bf16_f32 v124, v52, v53
    v_cvt_pk_bf16_f32 v125, v54, v55
rare_d6:
    s_cmp_eq_u32 s77, 43008
    s_cbranch_scc0 rare_d7
    v_cvt_pk_bf16_f32 v22, v40, v41
    v_cvt_pk_bf16_f32 v23, v42, v43
    v_accvgpr_write_b32 a134, v22
    v_accvgpr_write_b32 a135, v23
    v_cvt_pk_bf16_f32 v22, v44, v45
    v_cvt_pk_bf16_f32 v23, v46, v47
    v_accvgpr_write_b32 a142, v22
    v_accvgpr_write_b32 a143, v23
    v_cvt_pk_bf16_f32 v22, v48, v49
    v_cvt_pk_bf16_f32 v23, v50, v51
    v_accvgpr_write_b32 a150, v22
    v_accvgpr_write_b32 a151, v23
    v_cvt_pk_bf16_f32 v126, v52, v53
    v_cvt_pk_bf16_f32 v127, v54, v55
rare_d7:
    s_cmp_eq_u32 s77, 49152
    s_cbranch_scc0 rare_d8
    v_cvt_pk_bf16_f32 v128, v40, v41
    v_cvt_pk_bf16_f32 v129, v42, v43
    v_cvt_pk_bf16_f32 v136, v44, v45
    v_cvt_pk_bf16_f32 v137, v46, v47
    v_cvt_pk_bf16_f32 v144, v48, v49
    v_cvt_pk_bf16_f32 v145, v50, v51
    v_cvt_pk_bf16_f32 v152, v52, v53
    v_cvt_pk_bf16_f32 v153, v54, v55
rare_d8:
    s_cmp_eq_u32 s77, 55296
    s_cbranch_scc0 rare_d9
    v_cvt_pk_bf16_f32 v130, v40, v41
    v_cvt_pk_bf16_f32 v131, v42, v43
    v_cvt_pk_bf16_f32 v138, v44, v45
    v_cvt_pk_bf16_f32 v139, v46, v47
    v_cvt_pk_bf16_f32 v146, v48, v49
    v_cvt_pk_bf16_f32 v147, v50, v51
    v_cvt_pk_bf16_f32 v154, v52, v53
    v_cvt_pk_bf16_f32 v155, v54, v55
rare_d9:
    s_cmp_eq_u32 s77, 61440
    s_cbranch_scc0 rare_d10
    v_cvt_pk_bf16_f32 v132, v40, v41
    v_cvt_pk_bf16_f32 v133, v42, v43
    v_cvt_pk_bf16_f32 v140, v44, v45
    v_cvt_pk_bf16_f32 v141, v46, v47
    v_cvt_pk_bf16_f32 v148, v48, v49
    v_cvt_pk_bf16_f32 v149, v50, v51
    v_cvt_pk_bf16_f32 v156, v52, v53
    v_cvt_pk_bf16_f32 v157, v54, v55
rare_d10:
    s_cmp_eq_u32 s77, 67584
    s_cbranch_scc0 rare_d11
    v_cvt_pk_bf16_f32 v134, v40, v41
    v_cvt_pk_bf16_f32 v135, v42, v43
    v_cvt_pk_bf16_f32 v142, v44, v45
    v_cvt_pk_bf16_f32 v143, v46, v47
    v_cvt_pk_bf16_f32 v150, v48, v49
    v_cvt_pk_bf16_f32 v151, v50, v51
    v_cvt_pk_bf16_f32 v158, v52, v53
    v_cvt_pk_bf16_f32 v159, v54, v55
rare_d11:
    s_cmp_eq_u32 s77, 73728
    s_cbranch_scc0 rare_d12
    v_cvt_pk_bf16_f32 v160, v40, v41
    v_cvt_pk_bf16_f32 v161, v42, v43
    v_cvt_pk_bf16_f32 v168, v44, v45
    v_cvt_pk_bf16_f32 v169, v46, v47
    v_cvt_pk_bf16_f32 v176, v48, v49
    v_cvt_pk_bf16_f32 v177, v50, v51
    v_cvt_pk_bf16_f32 v184, v52, v53
    v_cvt_pk_bf16_f32 v185, v54, v55
rare_d12:
    s_cmp_eq_u32 s77, 79872
    s_cbranch_scc0 rare_d13
    v_cvt_pk_bf16_f32 v162, v40, v41
    v_cvt_pk_bf16_f32 v163, v42, v43
    v_cvt_pk_bf16_f32 v170, v44, v45
    v_cvt_pk_bf16_f32 v171, v46, v47
    v_cvt_pk_bf16_f32 v178, v48, v49
    v_cvt_pk_bf16_f32 v179, v50, v51
    v_cvt_pk_bf16_f32 v186, v52, v53
    v_cvt_pk_bf16_f32 v187, v54, v55
rare_d13:
    s_cmp_eq_u32 s77, 86016
    s_cbranch_scc0 rare_d14
    v_cvt_pk_bf16_f32 v164, v40, v41
    v_cvt_pk_bf16_f32 v165, v42, v43
    v_cvt_pk_bf16_f32 v172, v44, v45
    v_cvt_pk_bf16_f32 v173, v46, v47
    v_cvt_pk_bf16_f32 v180, v48, v49
    v_cvt_pk_bf16_f32 v181, v50, v51
    v_cvt_pk_bf16_f32 v188, v52, v53
    v_cvt_pk_bf16_f32 v189, v54, v55
rare_d14:
    s_cmp_eq_u32 s77, 92160
    s_cbranch_scc0 rare_d15
    v_cvt_pk_bf16_f32 v166, v40, v41
    v_cvt_pk_bf16_f32 v167, v42, v43
    v_cvt_pk_bf16_f32 v174, v44, v45
    v_cvt_pk_bf16_f32 v175, v46, v47
    v_cvt_pk_bf16_f32 v182, v48, v49
    v_cvt_pk_bf16_f32 v183, v50, v51
    v_cvt_pk_bf16_f32 v190, v52, v53
    v_cvt_pk_bf16_f32 v191, v54, v55
rare_d15:
    s_cmp_eq_u32 s77, 98304
    s_cbranch_scc0 rare_d16
    v_cvt_pk_bf16_f32 v192, v40, v41
    v_cvt_pk_bf16_f32 v193, v42, v43
    v_cvt_pk_bf16_f32 v200, v44, v45
    v_cvt_pk_bf16_f32 v201, v46, v47
    v_cvt_pk_bf16_f32 v208, v48, v49
    v_cvt_pk_bf16_f32 v209, v50, v51
    v_cvt_pk_bf16_f32 v216, v52, v53
    v_cvt_pk_bf16_f32 v217, v54, v55
rare_d16:
    s_cmp_eq_u32 s77, 104448
    s_cbranch_scc0 rare_d17
    v_cvt_pk_bf16_f32 v194, v40, v41
    v_cvt_pk_bf16_f32 v195, v42, v43
    v_cvt_pk_bf16_f32 v202, v44, v45
    v_cvt_pk_bf16_f32 v203, v46, v47
    v_cvt_pk_bf16_f32 v210, v48, v49
    v_cvt_pk_bf16_f32 v211, v50, v51
    v_cvt_pk_bf16_f32 v218, v52, v53
    v_cvt_pk_bf16_f32 v219, v54, v55
rare_d17:
    s_cmp_eq_u32 s77, 110592
    s_cbranch_scc0 rare_d18
    v_cvt_pk_bf16_f32 v196, v40, v41
    v_cvt_pk_bf16_f32 v197, v42, v43
    v_cvt_pk_bf16_f32 v204, v44, v45
    v_cvt_pk_bf16_f32 v205, v46, v47
    v_cvt_pk_bf16_f32 v212, v48, v49
    v_cvt_pk_bf16_f32 v213, v50, v51
    v_cvt_pk_bf16_f32 v220, v52, v53
    v_cvt_pk_bf16_f32 v221, v54, v55
rare_d18:
    s_cmp_eq_u32 s77, 116736
    s_cbranch_scc0 rare_d19
    v_cvt_pk_bf16_f32 v198, v40, v41
    v_cvt_pk_bf16_f32 v199, v42, v43
    v_cvt_pk_bf16_f32 v206, v44, v45
    v_cvt_pk_bf16_f32 v207, v46, v47
    v_cvt_pk_bf16_f32 v214, v48, v49
    v_cvt_pk_bf16_f32 v215, v50, v51
    v_cvt_pk_bf16_f32 v222, v52, v53
    v_cvt_pk_bf16_f32 v223, v54, v55
rare_d19:
    s_cmp_eq_u32 s77, 122880
    s_cbranch_scc0 rare_d20
    v_cvt_pk_bf16_f32 v224, v40, v41
    v_cvt_pk_bf16_f32 v225, v42, v43
    v_cvt_pk_bf16_f32 v232, v44, v45
    v_cvt_pk_bf16_f32 v233, v46, v47
    v_cvt_pk_bf16_f32 v240, v48, v49
    v_cvt_pk_bf16_f32 v241, v50, v51
    v_cvt_pk_bf16_f32 v248, v52, v53
    v_cvt_pk_bf16_f32 v249, v54, v55
rare_d20:
    s_cmp_eq_u32 s77, 129024
    s_cbranch_scc0 rare_d21
    v_cvt_pk_bf16_f32 v226, v40, v41
    v_cvt_pk_bf16_f32 v227, v42, v43
    v_cvt_pk_bf16_f32 v234, v44, v45
    v_cvt_pk_bf16_f32 v235, v46, v47
    v_cvt_pk_bf16_f32 v242, v48, v49
    v_cvt_pk_bf16_f32 v243, v50, v51
    v_cvt_pk_bf16_f32 v250, v52, v53
    v_cvt_pk_bf16_f32 v251, v54, v55
rare_d21:
    s_cmp_eq_u32 s77, 135168
    s_cbranch_scc0 rare_d22
    v_cvt_pk_bf16_f32 v228, v40, v41
    v_cvt_pk_bf16_f32 v229, v42, v43
    v_cvt_pk_bf16_f32 v236, v44, v45
    v_cvt_pk_bf16_f32 v237, v46, v47
    v_cvt_pk_bf16_f32 v244, v48, v49
    v_cvt_pk_bf16_f32 v245, v50, v51
    v_cvt_pk_bf16_f32 v252, v52, v53
    v_cvt_pk_bf16_f32 v253, v54, v55
rare_d22:
    s_cmp_eq_u32 s77, 141312
    s_cbranch_scc0 rare_d23
    v_cvt_pk_bf16_f32 v230, v40, v41
    v_cvt_pk_bf16_f32 v231, v42, v43
    v_cvt_pk_bf16_f32 v238, v44, v45
    v_cvt_pk_bf16_f32 v239, v46, v47
    v_cvt_pk_bf16_f32 v246, v48, v49
    v_cvt_pk_bf16_f32 v247, v50, v51
    v_cvt_pk_bf16_f32 v254, v52, v53
    v_cvt_pk_bf16_f32 v255, v54, v55
rare_d23:
    s_cmp_eq_u32 s77, 147456
    s_cbranch_scc0 rare_d24
    v_cvt_pk_bf16_f32 v56, v40, v41
    v_cvt_pk_bf16_f32 v57, v42, v43
    v_cvt_pk_bf16_f32 v64, v44, v45
    v_cvt_pk_bf16_f32 v65, v46, v47
    v_cvt_pk_bf16_f32 v72, v48, v49
    v_cvt_pk_bf16_f32 v73, v50, v51
    v_cvt_pk_bf16_f32 v80, v52, v53
    v_cvt_pk_bf16_f32 v81, v54, v55
rare_d24:
    s_cmp_eq_u32 s77, 153600
    s_cbranch_scc0 rare_d25
    v_cvt_pk_bf16_f32 v58, v40, v41
    v_cvt_pk_bf16_f32 v59, v42, v43
    v_cvt_pk_bf16_f32 v66, v44, v45
    v_cvt_pk_bf16_f32 v67, v46, v47
    v_cvt_pk_bf16_f32 v74, v48, v49
    v_cvt_pk_bf16_f32 v75, v50, v51
    v_cvt_pk_bf16_f32 v82, v52, v53
    v_cvt_pk_bf16_f32 v83, v54, v55
rare_d25:
    s_cmp_eq_u32 s77, 159744
    s_cbranch_scc0 rare_d26
    v_cvt_pk_bf16_f32 v60, v40, v41
    v_cvt_pk_bf16_f32 v61, v42, v43
    v_cvt_pk_bf16_f32 v68, v44, v45
    v_cvt_pk_bf16_f32 v69, v46, v47
    v_cvt_pk_bf16_f32 v76, v48, v49
    v_cvt_pk_bf16_f32 v77, v50, v51
    v_cvt_pk_bf16_f32 v84, v52, v53
    v_cvt_pk_bf16_f32 v85, v54, v55
rare_d26:
    s_cmp_eq_u32 s77, 165888
    s_cbranch_scc0 rare_d27
    v_cvt_pk_bf16_f32 v62, v40, v41
    v_cvt_pk_bf16_f32 v63, v42, v43
    v_cvt_pk_bf16_f32 v70, v44, v45
    v_cvt_pk_bf16_f32 v71, v46, v47
    v_cvt_pk_bf16_f32 v78, v48, v49
    v_cvt_pk_bf16_f32 v79, v50, v51
    v_cvt_pk_bf16_f32 v86, v52, v53
    v_cvt_pk_bf16_f32 v87, v54, v55
rare_d27:
    s_cmp_eq_u32 s77, 172032
    s_cbranch_scc0 rare_d28
    v_cvt_pk_bf16_f32 v88, v40, v41
    v_cvt_pk_bf16_f32 v89, v42, v43
    v_cvt_pk_bf16_f32 v96, v44, v45
    v_cvt_pk_bf16_f32 v97, v46, v47
    v_cvt_pk_bf16_f32 v104, v48, v49
    v_cvt_pk_bf16_f32 v105, v50, v51
    v_cvt_pk_bf16_f32 v112, v52, v53
    v_cvt_pk_bf16_f32 v113, v54, v55
rare_d28:
    s_cmp_eq_u32 s77, 178176
    s_cbranch_scc0 rare_d29
    v_cvt_pk_bf16_f32 v90, v40, v41
    v_cvt_pk_bf16_f32 v91, v42, v43
    v_cvt_pk_bf16_f32 v98, v44, v45
    v_cvt_pk_bf16_f32 v99, v46, v47
    v_cvt_pk_bf16_f32 v106, v48, v49
    v_cvt_pk_bf16_f32 v107, v50, v51
    v_cvt_pk_bf16_f32 v114, v52, v53
    v_cvt_pk_bf16_f32 v115, v54, v55
rare_d29:
    s_cmp_eq_u32 s77, 184320
    s_cbranch_scc0 rare_d30
    v_cvt_pk_bf16_f32 v92, v40, v41
    v_cvt_pk_bf16_f32 v93, v42, v43
    v_cvt_pk_bf16_f32 v100, v44, v45
    v_cvt_pk_bf16_f32 v101, v46, v47
    v_cvt_pk_bf16_f32 v108, v48, v49
    v_cvt_pk_bf16_f32 v109, v50, v51
    v_cvt_pk_bf16_f32 v116, v52, v53
    v_cvt_pk_bf16_f32 v117, v54, v55
rare_d30:
    s_cmp_eq_u32 s77, 190464
    s_cbranch_scc0 rare_d31
    v_cvt_pk_bf16_f32 v94, v40, v41
    v_cvt_pk_bf16_f32 v95, v42, v43
    v_cvt_pk_bf16_f32 v102, v44, v45
    v_cvt_pk_bf16_f32 v103, v46, v47
    v_cvt_pk_bf16_f32 v110, v48, v49
    v_cvt_pk_bf16_f32 v111, v50, v51
    v_cvt_pk_bf16_f32 v118, v52, v53
    v_cvt_pk_bf16_f32 v119, v54, v55
rare_d31:
    s_add_u32 s77, s77, 6144
    s_cmp_lt_u32 s77, 196608
    s_cbranch_scc1 rare_loop
    ds_read_b64_tr_b16 a[216:217], v8 offset:0
    ds_read_b64_tr_b16 a[218:219], v8 offset:2048
    ds_read_b64_tr_b16 a[220:221], v9 offset:0
    ds_read_b64_tr_b16 a[222:223], v9 offset:2048
    s_waitcnt lgkmcnt(0)
    v_mfma_f32_16x16x32_bf16 a[152:155], a[216:219], a[96:99], 0
    v_mfma_f32_16x16x32_bf16 a[156:159], a[216:219], a[104:107], 0
    v_mfma_f32_16x16x32_bf16 a[160:163], a[216:219], a[112:115], 0
    v_mfma_f32_16x16x32_bf16 a[164:167], a[216:219], a[120:123], 0
    v_mfma_f32_16x16x32_bf16 a[168:171], a[220:223], a[96:99], 0
    v_mfma_f32_16x16x32_bf16 a[172:175], a[220:223], a[104:107], 0
    v_mfma_f32_16x16x32_bf16 a[176:179], a[220:223], a[112:115], 0
    v_mfma_f32_16x16x32_bf16 a[180:183], a[220:223], a[120:123], 0
    ds_read_b64_tr_b16 a[216:217], v8 offset:4096
    ds_read_b64_tr_b16 a[218:219], v8 offset:6144
    ds_read_b64_tr_b16 a[220:221], v9 offset:4096
    ds_read_b64_tr_b16 a[222:223], v9 offset:6144
    s_waitcnt lgkmcnt(0)
    v_mfma_f32_16x16x32_bf16 a[152:155], a[216:219], a[100:103], a[152:155]
    v_mfma_f32_16x16x32_bf16 a[156:159], a[216:219], a[108:111], a[156:159]
    v_mfma_f32_16x16x32_bf16 a[160:163], a[216:219], a[116:119], a[160:163]
    v_mfma_f32_16x16x32_bf16 a[164:167], a[216:219], a[124:127], a[164:167]
    v_mfma_f32_16x16x32_bf16 a[168:171], a[220:223], a[100:103], a[168:171]
    v_mfma_f32_16x16x32_bf16 a[172:175], a[220:223], a[108:111], a[172:175]
    v_mfma_f32_16x16x32_bf16 a[176:179], a[220:223], a[116:119], a[176:179]
    v_mfma_f32_16x16x32_bf16 a[180:183], a[220:223], a[124:127], a[180:183]
    ds_read_b64_tr_b16 a[216:217], v8 offset:8192
    ds_read_b64_tr_b16 a[218:219], v8 offset:10240
    ds_read_b64_tr_b16 a[220:221], v9 offset:8192
    ds_read_b64_tr_b16 a[222:223], v9 offset:10240
    s_waitcnt lgkmcnt(0)
    v_mfma_f32_16x16x32_bf16 a[152:155], a[216:219], a[128:131], a[152:155]
    v_mfma_f32_16x16x32_bf16 a[156:159], a[216:219], a[136:139], a[156:159]
    v_mfma_f32_16x16x32_bf16 a[160:163], a[216:219], a[144:147], a[160:163]
    v_mfma_f32_16x16x32_bf16 a[164:167], a[216:219], v[120:123], a[164:167]
    v_mfma_f32_16x16x32_bf16 a[168:171], a[220:223], a[128:131], a[168:171]
    v_mfma_f32_16x16x32_bf16 a[172:175], a[220:223], a[136:139], a[172:175]
    v_mfma_f32_16x16x32_bf16 a[176:179], a[220:223], a[144:147], a[176:179]
    v_mfma_f32_16x16x32_bf16 a[180:183], a[220:223], v[120:123], a[180:183]
    ds_read_b64_tr_b16 a[216:217], v8 offset:12288
    ds_read_b64_tr_b16 a[218:219], v8 offset:14336
    ds_read_b64_tr_b16 a[220:221], v9 offset:12288
    ds_read_b64_tr_b16 a[222:223], v9 offset:14336
    s_waitcnt lgkmcnt(0)
    v_mfma_f32_16x16x32_bf16 a[152:155], a[216:219], a[132:135], a[152:155]
    v_mfma_f32_16x16x32_bf16 a[156:159], a[216:219], a[140:143], a[156:159]
    v_mfma_f32_16x16x32_bf16 a[160:163], a[216:219], a[148:151], a[160:163]
    v_mfma_f32_16x16x32_bf16 a[164:167], a[216:219], v[124:127], a[164:167]
    v_mfma_f32_16x16x32_bf16 a[168:171], a[220:223], a[132:135], a[168:171]
    v_mfma_f32_16x16x32_bf16 a[172:175], a[220:223], a[140:143], a[172:175]
    v_mfma_f32_16x16x32_bf16 a[176:179], a[220:223], a[148:151], a[176:179]
    v_mfma_f32_16x16x32_bf16 a[180:183], a[220:223], v[124:127], a[180:183]
    ds_read_b64_tr_b16 a[216:217], v8 offset:16384
    ds_read_b64_tr_b16 a[218:219], v8 offset:18432
    ds_read_b64_tr_b16 a[220:221], v9 offset:16384
    ds_read_b64_tr_b16 a[222:223], v9 offset:18432
    s_waitcnt lgkmcnt(0)
    v_mfma_f32_16x16x32_bf16 a[152:155], a[216:219], v[128:131], a[152:155]
    v_mfma_f32_16x16x32_bf16 a[156:159], a[216:219], v[136:139], a[156:159]
    v_mfma_f32_16x16x32_bf16 a[160:163], a[216:219], v[144:147], a[160:163]
    v_mfma_f32_16x16x32_bf16 a[164:167], a[216:219], v[152:155], a[164:167]
    v_mfma_f32_16x16x32_bf16 a[168:171], a[220:223], v[128:131], a[168:171]
    v_mfma_f32_16x16x32_bf16 a[172:175], a[220:223], v[136:139], a[172:175]
    v_mfma_f32_16x16x32_bf16 a[176:179], a[220:223], v[144:147], a[176:179]
    v_mfma_f32_16x16x32_bf16 a[180:183], a[220:223], v[152:155], a[180:183]
    ds_read_b64_tr_b16 a[216:217], v8 offset:20480
    ds_read_b64_tr_b16 a[218:219], v8 offset:22528
    ds_read_b64_tr_b16 a[220:221], v9 offset:20480
    ds_read_b64_tr_b16 a[222:223], v9 offset:22528
    s_waitcnt lgkmcnt(0)
    v_mfma_f32_16x16x32_bf16 a[152:155], a[216:219], v[132:135], a[152:155]
    v_mfma_f32_16x16x32_bf16 a[156:159], a[216:219], v[140:143], a[156:159]
    v_mfma_f32_16x16x32_bf16 a[160:163], a[216:219], v[148:151], a[160:163]
    v_mfma_f32_16x16x32_bf16 a[164:167], a[216:219], v[156:159], a[164:167]
    v_mfma_f32_16x16x32_bf16 a[168:171], a[220:223], v[132:135], a[168:171]
    v_mfma_f32_16x16x32_bf16 a[172:175], a[220:223], v[140:143], a[172:175]
    v_mfma_f32_16x16x32_bf16 a[176:179], a[220:223], v[148:151], a[176:179]
    v_mfma_f32_16x16x32_bf16 a[180:183], a[220:223], v[156:159], a[180:183]
    ds_read_b64_tr_b16 a[216:217], v8 offset:24576
    ds_read_b64_tr_b16 a[218:219], v8 offset:26624
    ds_read_b64_tr_b16 a[220:221], v9 offset:24576
    ds_read_b64_tr_b16 a[222:223], v9 offset:26624
    s_waitcnt lgkmcnt(0)
    v_mfma_f32_16x16x32_bf16 a[152:155], a[216:219], v[160:163], a[152:155]
    v_mfma_f32_16x16x32_bf16 a[156:159], a[216:219], v[168:171], a[156:159]
    v_mfma_f32_16x16x32_bf16 a[160:163], a[216:219], v[176:179], a[160:163]
    v_mfma_f32_16x16x32_bf16 a[164:167], a[216:219], v[184:187], a[164:167]
    v_mfma_f32_16x16x32_bf16 a[168:171], a[220:223], v[160:163], a[168:171]
    v_mfma_f32_16x16x32_bf16 a[172:175], a[220:223], v[168:171], a[172:175]
    v_mfma_f32_16x16x32_bf16 a[176:179], a[220:223], v[176:179], a[176:179]
    v_mfma_f32_16x16x32_bf16 a[180:183], a[220:223], v[184:187], a[180:183]
    ds_read_b64_tr_b16 a[216:217], v8 offset:28672
    ds_read_b64_tr_b16 a[218:219], v8 offset:30720
    ds_read_b64_tr_b16 a[220:221], v9 offset:28672
    ds_read_b64_tr_b16 a[222:223], v9 offset:30720
    s_waitcnt lgkmcnt(0)
    v_mfma_f32_16x16x32_bf16 a[152:155], a[216:219], v[164:167], a[152:155]
    v_mfma_f32_16x16x32_bf16 a[156:159], a[216:219], v[172:175], a[156:159]
    v_mfma_f32_16x16x32_bf16 a[160:163], a[216:219], v[180:183], a[160:163]
    v_mfma_f32_16x16x32_bf16 a[164:167], a[216:219], v[188:191], a[164:167]
    v_mfma_f32_16x16x32_bf16 a[168:171], a[220:223], v[164:167], a[168:171]
    v_mfma_f32_16x16x32_bf16 a[172:175], a[220:223], v[172:175], a[172:175]
    v_mfma_f32_16x16x32_bf16 a[176:179], a[220:223], v[180:183], a[176:179]
    v_mfma_f32_16x16x32_bf16 a[180:183], a[220:223], v[188:191], a[180:183]
    ds_read_b64_tr_b16 a[216:217], v8 offset:32768
    ds_read_b64_tr_b16 a[218:219], v8 offset:34816
    ds_read_b64_tr_b16 a[220:221], v9 offset:32768
    ds_read_b64_tr_b16 a[222:223], v9 offset:34816
    s_waitcnt lgkmcnt(0)
    v_mfma_f32_16x16x32_bf16 a[152:155], a[216:219], v[192:195], a[152:155]
    v_mfma_f32_16x16x32_bf16 a[156:159], a[216:219], v[200:203], a[156:159]
    v_mfma_f32_16x16x32_bf16 a[160:163], a[216:219], v[208:211], a[160:163]
    v_mfma_f32_16x16x32_bf16 a[164:167], a[216:219], v[216:219], a[164:167]
    v_mfma_f32_16x16x32_bf16 a[168:171], a[220:223], v[192:195], a[168:171]
    v_mfma_f32_16x16x32_bf16 a[172:175], a[220:223], v[200:203], a[172:175]
    v_mfma_f32_16x16x32_bf16 a[176:179], a[220:223], v[208:211], a[176:179]
    v_mfma_f32_16x16x32_bf16 a[180:183], a[220:223], v[216:219], a[180:183]
    ds_read_b64_tr_b16 a[216:217], v8 offset:36864
    ds_read_b64_tr_b16 a[218:219], v8 offset:38912
    ds_read_b64_tr_b16 a[220:221], v9 offset:36864
    ds_read_b64_tr_b16 a[222:223], v9 offset:38912
    s_waitcnt lgkmcnt(0)
    v_mfma_f32_16x16x32_bf16 a[152:155], a[216:219], v[196:199], a[152:155]
    v_mfma_f32_16x16x32_bf16 a[156:159], a[216:219], v[204:207], a[156:159]
    v_mfma_f32_16x16x32_bf16 a[160:163], a[216:219], v[212:215], a[160:163]
    v_mfma_f32_16x16x32_bf16 a[164:167], a[216:219], v[220:223], a[164:167]
    v_mfma_f32_16x16x32_bf16 a[168:171], a[220:223], v[196:199], a[168:171]
    v_mfma_f32_16x16x32_bf16 a[172:175], a[220:223], v[204:207], a[172:175]
    v_mfma_f32_16x16x32_bf16 a[176:179], a[220:223], v[212:215], a[176:179]
    v_mfma_f32_16x16x32_bf16 a[180:183], a[220:223], v[220:223], a[180:183]
    ds_read_b64_tr_b16 a[216:217], v8 offset:40960
    ds_read_b64_tr_b16 a[218:219], v8 offset:43008
    ds_read_b64_tr_b16 a[220:221], v9 offset:40960
    ds_read_b64_tr_b16 a[222:223], v9 offset:43008
    s_waitcnt lgkmcnt(0)
    v_mfma_f32_16x16x32_bf16 a[152:155], a[216:219], v[224:227], a[152:155]
    v_mfma_f32_16x16x32_bf16 a[156:159], a[216:219], v[232:235], a[156:159]
    v_mfma_f32_16x16x32_bf16 a[160:163], a[216:219], v[240:243], a[160:163]
    v_mfma_f32_16x16x32_bf16 a[164:167], a[216:219], v[248:251], a[164:167]
    v_mfma_f32_16x16x32_bf16 a[168:171], a[220:223], v[224:227], a[168:171]
    v_mfma_f32_16x16x32_bf16 a[172:175], a[220:223], v[232:235], a[172:175]
    v_mfma_f32_16x16x32_bf16 a[176:179], a[220:223], v[240:243], a[176:179]
    v_mfma_f32_16x16x32_bf16 a[180:183], a[220:223], v[248:251], a[180:183]
    ds_read_b64_tr_b16 a[216:217], v8 offset:45056
    ds_read_b64_tr_b16 a[218:219], v8 offset:47104
    ds_read_b64_tr_b16 a[220:221], v9 offset:45056
    ds_read_b64_tr_b16 a[222:223], v9 offset:47104
    s_waitcnt lgkmcnt(0)
    v_mfma_f32_16x16x32_bf16 a[152:155], a[216:219], v[228:231], a[152:155]
    v_mfma_f32_16x16x32_bf16 a[156:159], a[216:219], v[236:239], a[156:159]
    v_mfma_f32_16x16x32_bf16 a[160:163], a[216:219], v[244:247], a[160:163]
    v_mfma_f32_16x16x32_bf16 a[164:167], a[216:219], v[252:255], a[164:167]
    v_mfma_f32_16x16x32_bf16 a[168:171], a[220:223], v[228:231], a[168:171]
    v_mfma_f32_16x16x32_bf16 a[172:175], a[220:223], v[236:239], a[172:175]
    v_mfma_f32_16x16x32_bf16 a[176:179], a[220:223], v[244:247], a[176:179]
    v_mfma_f32_16x16x32_bf16 a[180:183], a[220:223], v[252:255], a[180:183]
    ds_read_b64_tr_b16 a[216:217], v8 offset:49152
    ds_read_b64_tr_b16 a[218:219], v8 offset:51200
    ds_read_b64_tr_b16 a[220:221], v9 offset:49152
    ds_read_b64_tr_b16 a[222:223], v9 offset:51200
    s_waitcnt lgkmcnt(0)
    v_mfma_f32_16x16x32_bf16 a[152:155], a[216:219], v[56:59], a[152:155]
    v_mfma_f32_16x16x32_bf16 a[156:159], a[216:219], v[64:67], a[156:159]
    v_mfma_f32_16x16x32_bf16 a[160:163], a[216:219], v[72:75], a[160:163]
    v_mfma_f32_16x16x32_bf16 a[164:167], a[216:219], v[80:83], a[164:167]
    v_mfma_f32_16x16x32_bf16 a[168:171], a[220:223], v[56:59], a[168:171]
    v_mfma_f32_16x16x32_bf16 a[172:175], a[220:223], v[64:67], a[172:175]
    v_mfma_f32_16x16x32_bf16 a[176:179], a[220:223], v[72:75], a[176:179]
    v_mfma_f32_16x16x32_bf16 a[180:183], a[220:223], v[80:83], a[180:183]
    ds_read_b64_tr_b16 a[216:217], v8 offset:53248
    ds_read_b64_tr_b16 a[218:219], v8 offset:55296
    ds_read_b64_tr_b16 a[220:221], v9 offset:53248
    ds_read_b64_tr_b16 a[222:223], v9 offset:55296
    s_waitcnt lgkmcnt(0)
    v_mfma_f32_16x16x32_bf16 a[152:155], a[216:219], v[60:63], a[152:155]
    v_mfma_f32_16x16x32_bf16 a[156:159], a[216:219], v[68:71], a[156:159]
    v_mfma_f32_16x16x32_bf16 a[160:163], a[216:219], v[76:79], a[160:163]
    v_mfma_f32_16x16x32_bf16 a[164:167], a[216:219], v[84:87], a[164:167]
    v_mfma_f32_16x16x32_bf16 a[168:171], a[220:223], v[60:63], a[168:171]
    v_mfma_f32_16x16x32_bf16 a[172:175], a[220:223], v[68:71], a[172:175]
    v_mfma_f32_16x16x32_bf16 a[176:179], a[220:223], v[76:79], a[176:179]
    v_mfma_f32_16x16x32_bf16 a[180:183], a[220:223], v[84:87], a[180:183]
    ds_read_b64_tr_b16 a[216:217], v8 offset:57344
    ds_read_b64_tr_b16 a[218:219], v8 offset:59392
    ds_read_b64_tr_b16 a[220:221], v9 offset:57344
    ds_read_b64_tr_b16 a[222:223], v9 offset:59392
    s_waitcnt lgkmcnt(0)
    v_mfma_f32_16x16x32_bf16 a[152:155], a[216:219], v[88:91], a[152:155]
    v_mfma_f32_16x16x32_bf16 a[156:159], a[216:219], v[96:99], a[156:159]
    v_mfma_f32_16x16x32_bf16 a[160:163], a[216:219], v[104:107], a[160:163]
    v_mfma_f32_16x16x32_bf16 a[164:167], a[216:219], v[112:115], a[164:167]
    v_mfma_f32_16x16x32_bf16 a[168:171], a[220:223], v[88:91], a[168:171]
    v_mfma_f32_16x16x32_bf16 a[172:175], a[220:223], v[96:99], a[172:175]
    v_mfma_f32_16x16x32_bf16 a[176:179], a[220:223], v[104:107], a[176:179]
    v_mfma_f32_16x16x32_bf16 a[180:183], a[220:223], v[112:115], a[180:183]
    ds_read_b64_tr_b16 a[216:217], v8 offset:61440
    ds_read_b64_tr_b16 a[218:219], v8 offset:63488
    ds_read_b64_tr_b16 a[220:221], v9 offset:61440
    ds_read_b64_tr_b16 a[222:223], v9 offset:63488
    s_waitcnt lgkmcnt(0)
    v_mfma_f32_16x16x32_bf16 a[152:155], a[216:219], v[92:95], a[152:155]
    v_mfma_f32_16x16x32_bf16 a[156:159], a[216:219], v[100:103], a[156:159]
    v_mfma_f32_16x16x32_bf16 a[160:163], a[216:219], v[108:111], a[160:163]
    v_mfma_f32_16x16x32_bf16 a[164:167], a[216:219], v[116:119], a[164:167]
    v_mfma_f32_16x16x32_bf16 a[168:171], a[220:223], v[92:95], a[168:171]
    v_mfma_f32_16x16x32_bf16 a[172:175], a[220:223], v[100:103], a[172:175]
    v_mfma_f32_16x16x32_bf16 a[176:179], a[220:223], v[108:111], a[176:179]
    v_mfma_f32_16x16x32_bf16 a[180:183], a[220:223], v[116:119], a[180:183]
    v_mov_b32 v24, 0
    v_mov_b32 v25, 0
    v_mov_b32 v26, 0
    v_mov_b32 v27, 0
    v_mov_b32 v28, 0
    v_mov_b32 v29, 0
    v_mov_b32 v30, 0
    v_mov_b32 v31, 0
    v_mov_b32 v32, 0
    v_mov_b32 v33, 0
    v_mov_b32 v34, 0
    v_mov_b32 v35, 0
    v_mov_b32 v36, 0
    v_mov_b32 v37, 0
    v_mov_b32 v38, 0
    v_mov_b32 v39, 0
    s_nop 1
    v_smfmac_f32_16x16x64_bf16 v[24:27], a[248:251], a[96:103], v20
    v_smfmac_f32_16x16x64_bf16 v[28:31], a[248:251], a[104:111], v20
    v_smfmac_f32_16x16x64_bf16 v[32:35], a[248:251], a[112:119], v20
    v_smfmac_f32_16x16x64_bf16 v[36:39], a[248:251], a[120:127], v20
    v_smfmac_f32_16x16x64_bf16 v[24:27], a[248:251], a[128:135], v20
    v_smfmac_f32_16x16x64_bf16 v[28:31], a[248:251], a[136:143], v20
    v_smfmac_f32_16x16x64_bf16 v[32:35], a[248:251], a[144:151], v20
    v_smfmac_f32_16x16x64_bf16 v[36:39], a[248:251], v[120:127], v20
    v_smfmac_f32_16x16x64_bf16 v[24:27], a[248:251], v[128:135], v20
    v_smfmac_f32_16x16x64_bf16 v[28:31], a[248:251], v[136:143], v20
    v_smfmac_f32_16x16x64_bf16 v[32:35], a[248:251], v[144:151], v20
    v_smfmac_f32_16x16x64_bf16 v[36:39], a[248:251], v[152:159], v20
    v_smfmac_f32_16x16x64_bf16 v[24:27], a[248:251], v[160:167], v20
    v_smfmac_f32_16x16x64_bf16 v[28:31], a[248:251], v[168:175], v20
    v_smfmac_f32_16x16x64_bf16 v[32:35], a[248:251], v[176:183], v20
    v_smfmac_f32_16x16x64_bf16 v[36:39], a[248:251], v[184:191], v20
    v_smfmac_f32_16x16x64_bf16 v[24:27], a[248:251], v[192:199], v20
    v_smfmac_f32_16x16x64_bf16 v[28:31], a[248:251], v[200:207], v20
    v_smfmac_f32_16x16x64_bf16 v[32:35], a[248:251], v[208:215], v20
    v_smfmac_f32_16x16x64_bf16 v[36:39], a[248:251], v[216:223], v20
    v_smfmac_f32_16x16x64_bf16 v[24:27], a[248:251], v[224:231], v20
    v_smfmac_f32_16x16x64_bf16 v[28:31], a[248:251], v[232:239], v20
    v_smfmac_f32_16x16x64_bf16 v[32:35], a[248:251], v[240:247], v20
    v_smfmac_f32_16x16x64_bf16 v[36:39], a[248:251], v[248:255], v20
    v_smfmac_f32_16x16x64_bf16 v[24:27], a[248:251], v[56:63], v20
    v_smfmac_f32_16x16x64_bf16 v[28:31], a[248:251], v[64:71], v20
    v_smfmac_f32_16x16x64_bf16 v[32:35], a[248:251], v[72:79], v20
    v_smfmac_f32_16x16x64_bf16 v[36:39], a[248:251], v[80:87], v20
    v_smfmac_f32_16x16x64_bf16 v[24:27], a[248:251], v[88:95], v20
    v_smfmac_f32_16x16x64_bf16 v[28:31], a[248:251], v[96:103], v20
    v_smfmac_f32_16x16x64_bf16 v[32:35], a[248:251], v[104:111], v20
    v_smfmac_f32_16x16x64_bf16 v[36:39], a[248:251], v[112:119], v20
    s_nop 15
    v_add_f32 v24, v24, v25
    v_add_f32 v28, v28, v29
    v_add_f32 v32, v32, v33
    v_add_f32 v36, v36, v37
    v_rcp_f32 v16, v24
    v_rcp_f32 v17, v28
    v_rcp_f32 v18, v32
    v_rcp_f32 v19, v36
    s_nop 1
    s_branch rare_ret
code_end:
    s_endpgm
.section .rodata,"a"
.p2align 6
.amdhsa_kernel recurrent_scan__sliding_block_cached__moe_arch_mod__prompt_kernel
  .amdhsa_next_free_vgpr 512
  .amdhsa_next_free_sgpr 102
  .amdhsa_accum_offset 256
  .amdhsa_group_segment_fixed_size 0
  .amdhsa_kernarg_size 104
  .amdhsa_user_sgpr_count 2
  .amdhsa_user_sgpr_kernarg_segment_ptr 1
  .amdhsa_system_sgpr_workgroup_id_x 1
  .amdhsa_float_denorm_mode_32 3
.end_amdhsa_kernel
```

```asm
; @launch grid=(256,1,1) block=(256,1,1) lds=163840
.amdgcn_target "amdgcn-amd-amdhsa--gfx950"
.text
.globl recurrent_scan__sliding_block_cached__moe_arch_mod__prompt_kernel
.p2align 12
.p2align 8
.type recurrent_scan__sliding_block_cached__moe_arch_mod__prompt_kernel,@function
recurrent_scan__sliding_block_cached__moe_arch_mod__prompt_kernel:
    s_cmp_ge_u32 s2, 256
    s_cbranch_scc1 main_end
    s_load_dwordx16 s[64:79], s[0:1], 0
    s_load_dwordx4 s[80:83], s[0:1], 64
    s_load_dwordx2 s[84:85], s[0:1], 80
    s_load_dwordx2 s[86:87], s[0:1], 96
    s_lshr_b32 s56, s2, 3
    s_lshl_b32 s56, s56, 10
    v_lshrrev_b32 v18, 5, v0
    v_lshlrev_b32 v18, 7, v18
    v_add_u32 v18, s56, v18
    s_getpc_b64 s[88:89]
code0:
    v_and_b32 v19, 3, v0
    v_lshl_add_u32 v19, v19, 15, v18
    v_min_u32 v19, code_end-code0-4, v19
    global_load_dword a252, v19, s[88:89]
    v_lshrrev_b32 v17, 6, v0
    v_lshlrev_b32 v17, 12, v17
    v_and_b32 v1, 63, v0
    v_lshl_add_u32 v17, v1, 4, v17
    v_lshrrev_b32 v29, 6, v0
    v_mov_b32 v16, v0
    v_readfirstlane_b32 s3, v29
    s_and_b32 s53, s2, 7
    s_lshr_b32 s52, s2, 5
    s_bfe_u32 s51, s2, 0x20003
    s_lshl_b32 s50, s53, 2
    s_add_u32 s50, s50, s51
    s_lshl_b32 s60, s2, 3
    s_lshl2_add_u32 s60, s3, s60
    v_bfe_u32 v240, v1, 1, 2
    v_add_u32 v240, s60, v240
    v_lshrrev_b32 v241, 3, v1
    v_lshlrev_b32 v241, 5, v241
    v_and_b32 v29, 1, v1
    v_lshl_add_u32 v241, v29, 4, v241
    v_mul_u32_u24 v242, 1280, v240
    v_add_u32 v242, v242, v241
    s_cmp_lt_u32 s3, 2
    s_cselect_b32 s44, 0, 0x70000000
    v_lshrrev_b32 v29, 4, v1
    v_lshlrev_b32 v29, 1, v29
    v_and_b32 v7, 7, v1
    v_xor_b32 v7, v7, v29
    v_lshlrev_b32 v7, 4, v7
    v_lshrrev_b32 v29, 5, v1
    v_lshlrev_b32 v29, 3, v29
    v_bfe_u32 v5, v1, 3, 2
    v_add_u32 v5, v5, v29
    v_mul_u32_u24 v2, 12288, v5
    v_add_u32 v2, v2, v7
    v_add_u32 v3, 196608, v2
    s_lshl_b32 s54, s52, 2
    s_add_u32 s54, s54, s3
    s_mul_i32 s49, s3, 6144
    s_lshr_b32 s59, s3, 1
    s_lshl_b32 s59, s59, 5
    s_and_b32 s56, s3, 1
    s_lshl_b32 s56, s56, 2
    s_add_u32 s59, s59, s56
    s_mul_i32 s36, s59, 12288
    s_mov_b32 s37, 786432
    s_add_u32 s45, s51, s52
    s_and_b32 s45, s45, 3
    s_lshl_b32 s45, s45, 2
    s_lshr_b32 s45, 0x5050, s45
    s_and_b32 s45, s45, 15
    s_mul_i32 s56, s45, 786432
    s_add_u32 s36, s36, s56
    s_lshl_b32 s45, s45, 13
    s_andn2_b32 s56, 2, s2
    s_lshl_b32 s56, s56, 9
    s_add_u32 s45, s45, s56
    s_mul_i32 s56, s50, 384
    s_sub_u32 s57, 7864320, s56
    s_waitcnt lgkmcnt(0)
    s_mov_b32 s12, s64
    s_and_b32 s13, s65, 0xffff
    s_mov_b32 s14, 2621440
    s_mov_b32 s15, 0x00020000
    s_mov_b32 s16, s76
    s_and_b32 s17, s77, 0xffff
    s_mov_b32 s18, 1280
    s_mov_b32 s19, 0x00020000
    s_cmp_lt_u32 s3, 2
    s_cbranch_scc0 no_lx
    buffer_load_dwordx4 v[64:67], v242, s[12:15], 0 offen offset:0
    buffer_load_dwordx4 v[68:71], v242, s[12:15], 0 offen offset:256
    buffer_load_dwordx4 v[72:75], v242, s[12:15], 0 offen offset:512
    buffer_load_dwordx4 v[76:79], v242, s[12:15], 0 offen offset:768
    buffer_load_dwordx4 v[80:83], v242, s[12:15], 0 offen offset:1024
no_lx:
    v_mov_b32 v25, 3203072
    global_load_dword v26, v25, s[86:87] sc1
    s_lshr_b32 s47, s2, 3
    s_lshl_b32 s47, s47, 7
    s_add_u32 s47, s47, 4128768
    s_load_dword s93, s[86:87], s47 glc
    s_add_u32 s8, s70, s56
    s_addc_u32 s9, s71, 0
    s_and_b32 s9, s9, 0xffff
    s_mov_b32 s10, s57
    s_mov_b32 s11, 0x00020000
    s_cmp_lt_u32 s3, 2
    s_cbranch_scc1 no_w0
    s_sub_u32 s47, s36, 393216
    s_add_u32 m0, s49, 36864
    s_nop 0
    buffer_load_dwordx4 v2, s[8:11], s47 offen offset:0 lds
    s_add_u32 m0, s49, 37760
    s_nop 0
    buffer_load_dwordx4 v2, s[8:11], s47 offen offset:128 lds
    s_add_u32 m0, s49, 38656
    s_nop 0
    buffer_load_dwordx4 v2, s[8:11], s47 offen offset:256 lds
    s_add_u32 m0, s49, 39936
    s_nop 0
    buffer_load_dwordx4 v3, s[8:11], s47 offen offset:0 lds
    s_add_u32 m0, s49, 40832
    s_nop 0
    buffer_load_dwordx4 v3, s[8:11], s47 offen offset:128 lds
    s_add_u32 m0, s49, 41728
    s_nop 0
    buffer_load_dwordx4 v3, s[8:11], s47 offen offset:256 lds
    s_add_u32 m0, s49, 49152
    s_nop 0
    buffer_load_dwordx4 v2, s[8:11], s36 offen offset:0 lds
    s_add_u32 m0, s49, 50048
    s_nop 0
    buffer_load_dwordx4 v2, s[8:11], s36 offen offset:128 lds
    s_add_u32 m0, s49, 50944
    s_nop 0
    buffer_load_dwordx4 v2, s[8:11], s36 offen offset:256 lds
    s_add_u32 m0, s49, 52224
    s_nop 0
    buffer_load_dwordx4 v3, s[8:11], s36 offen offset:0 lds
    s_add_u32 m0, s49, 53120
    s_nop 0
    buffer_load_dwordx4 v3, s[8:11], s36 offen offset:128 lds
    s_add_u32 m0, s49, 54016
    s_nop 0
    buffer_load_dwordx4 v3, s[8:11], s36 offen offset:256 lds
    s_add_u32 s36, s36, s37
    s_sub_u32 s55, s36, 7864320
    s_min_u32 s36, s36, s55
no_w0:
    s_mov_b32 s24, s86
    s_and_b32 s25, s87, 0xffff
    s_mov_b32 s26, 268435456
    s_mov_b32 s27, 0x00020000
    s_lshr_b32 s56, s60, 6
    s_mul_i32 s41, s56, 81920
    s_and_b32 s56, s60, 63
    s_lshl_b32 s56, s56, 6
    s_add_u32 s41, s41, s56
    v_lshrrev_b32 v29, 4, v1
    v_and_b32 v243, 15, v1
    v_lshlrev_b32 v243, 4, v243
    v_lshl_add_u32 v243, v29, 12, v243
    s_mov_b32 s38, 0x3acccccd
    s_mov_b32 s42, 0xffff0000
    s_mov_b32 s43, 0x3f803f80
    v_bfe_u32 v29, v1, 2, 3
    v_lshlrev_b32 v8, 7, v29
    v_lshrrev_b32 v29, 1, v29
    v_xor_b32 v29, 0, v29
    v_lshl_add_u32 v8, v29, 5, v8
    v_and_b32 v29, 3, v1
    v_lshl_add_u32 v8, v29, 3, v8
    v_lshrrev_b32 v29, 5, v1
    v_mul_u32_u24 v29, 3072, v29
    v_add_u32 v8, v8, v29
    v_add_u32 v8, 49152, v8
    v_xor_b32 v9, 32, v8
    v_xor_b32 v10, 64, v8
    v_xor_b32 v11, 96, v8
    v_and_b32 v15, 12, v1
    v_lshlrev_b32 v15, 6, v15
    v_and_b32 v29, 3, v1
    v_lshl_add_u32 v15, v29, 5, v15
    v_and_b32 v29, 16, v1
    v_add_u32 v15, v15, v29
    v_and_b32 v29, 32, v1
    v_lshl_add_u32 v15, v29, 2, v15
    s_and_b32 s56, s2, 1
    s_lshl_b32 s56, s56, 11
    v_add_u32 v15, s56, v15
    v_xor_b32 v14, 2048, v15
    s_mul_i32 s56, s54, 81920
    s_add_u32 s56, s56, 0
    s_add_u32 s20, s86, s56
    s_addc_u32 s21, s87, 0
    s_and_b32 s21, s21, 0xffff
    s_mov_b32 s22, 81920
    s_mov_b32 s23, 0x00020000
    s_lshl_b32 s46, s54, 7
    s_add_u32 s46, s46, 4128768
    s_mov_b32 s101, 0
    s_lshl_b32 s56, s53, 12
    s_add_u32 s46, s46, s56
    s_load_dword s92, s[86:87], s46 glc
    s_lshr_b32 s6, s2, 3
    s_lshl_b32 s6, s6, 7
    s_lshl_b32 s56, s53, 2
    s_add_u32 s6, s6, s56
    s_add_u32 s6, s6, 4128768
    v_lshlrev_b32 v20, 12, v1
    s_cmp_eq_u32 s3, 0
    s_cselect_b32 s6, s6, 0x70000000
    v_mov_b32 v144, 0
    v_mov_b32 v145, 0
    v_mov_b32 v146, 0
    v_mov_b32 v147, 0
    s_cmp_lt_u32 s3, 2
    s_cbranch_scc1 ln_go
no_ln:
    s_mov_b64 exec, 0
    s_cmp_eq_u32 s3, 2
    s_cbranch_scc1 pg_0
    s_branch pg_1
pg_back:
    s_mov_b64 exec, -1
    s_barrier
    s_sub_u32 s47, s36, 393216
    s_add_u32 m0, s49, 61440
    s_nop 0
    buffer_load_dwordx4 v2, s[8:11], s47 offen offset:0 lds
    s_add_u32 m0, s49, 62336
    s_nop 0
    buffer_load_dwordx4 v2, s[8:11], s47 offen offset:128 lds
    s_add_u32 m0, s49, 63232
    s_nop 0
    buffer_load_dwordx4 v2, s[8:11], s47 offen offset:256 lds
    s_add_u32 m0, s49, 64512
    s_nop 0
    buffer_load_dwordx4 v3, s[8:11], s47 offen offset:0 lds
    s_add_u32 m0, s49, 65408
    s_nop 0
    buffer_load_dwordx4 v3, s[8:11], s47 offen offset:128 lds
    s_add_u32 m0, s49, 66304
    s_nop 0
    buffer_load_dwordx4 v3, s[8:11], s47 offen offset:256 lds
    s_add_u32 m0, s49, 73728
    s_nop 0
    buffer_load_dwordx4 v2, s[8:11], s36 offen offset:0 lds
    s_add_u32 m0, s49, 74624
    s_nop 0
    buffer_load_dwordx4 v2, s[8:11], s36 offen offset:128 lds
    s_add_u32 m0, s49, 75520
    s_nop 0
    buffer_load_dwordx4 v2, s[8:11], s36 offen offset:256 lds
    s_add_u32 m0, s49, 76800
    s_nop 0
    buffer_load_dwordx4 v3, s[8:11], s36 offen offset:0 lds
    s_add_u32 m0, s49, 77696
    s_nop 0
    buffer_load_dwordx4 v3, s[8:11], s36 offen offset:128 lds
    s_add_u32 m0, s49, 78592
    s_nop 0
    buffer_load_dwordx4 v3, s[8:11], s36 offen offset:256 lds
    s_add_u32 s36, s36, s37
    s_sub_u32 s55, s36, 7864320
    s_min_u32 s36, s36, s55
    s_waitcnt vmcnt(24)
    v_readfirstlane_b32 s7, v26
    s_lshr_b32 s7, s7, 4
    s_mul_i32 s7, s7, 0x2c9277b5
    s_add_u32 s7, s7, 0x6c564b05
    s_lshl_b32 s7, s7, 4
    s_branch ln_join
ln_go:
    s_waitcnt vmcnt(5)
    v_dot2c_f32_bf16 v144, s43, v64
    v_dot2c_f32_bf16 v146, v64, v64
    v_dot2c_f32_bf16 v145, s43, v65
    v_dot2c_f32_bf16 v147, v65, v65
    v_dot2c_f32_bf16 v144, s43, v66
    v_dot2c_f32_bf16 v146, v66, v66
    v_dot2c_f32_bf16 v145, s43, v67
    v_dot2c_f32_bf16 v147, v67, v67
    v_lshlrev_b32 v104, 16, v64
    v_and_b32 v105, s42, v64
    v_lshlrev_b32 v106, 16, v65
    v_and_b32 v107, s42, v65
    v_lshlrev_b32 v108, 16, v66
    v_and_b32 v109, s42, v66
    v_lshlrev_b32 v110, 16, v67
    s_waitcnt vmcnt(4)
    v_dot2c_f32_bf16 v144, s43, v68
    v_dot2c_f32_bf16 v146, v68, v68
    v_dot2c_f32_bf16 v145, s43, v69
    v_dot2c_f32_bf16 v147, v69, v69
    v_dot2c_f32_bf16 v144, s43, v70
    v_dot2c_f32_bf16 v146, v70, v70
    v_dot2c_f32_bf16 v145, s43, v71
    v_dot2c_f32_bf16 v147, v71, v71
    v_and_b32 v111, s42, v67
    v_lshlrev_b32 v112, 16, v68
    v_and_b32 v113, s42, v68
    v_lshlrev_b32 v114, 16, v69
    v_and_b32 v115, s42, v69
    v_lshlrev_b32 v116, 16, v70
    v_and_b32 v117, s42, v70
    s_waitcnt vmcnt(3)
    v_dot2c_f32_bf16 v144, s43, v72
    v_dot2c_f32_bf16 v146, v72, v72
    v_dot2c_f32_bf16 v145, s43, v73
    v_dot2c_f32_bf16 v147, v73, v73
    v_dot2c_f32_bf16 v144, s43, v74
    v_dot2c_f32_bf16 v146, v74, v74
    v_dot2c_f32_bf16 v145, s43, v75
    v_dot2c_f32_bf16 v147, v75, v75
    v_lshlrev_b32 v118, 16, v71
    v_and_b32 v119, s42, v71
    v_lshlrev_b32 v120, 16, v72
    v_and_b32 v121, s42, v72
    v_lshlrev_b32 v122, 16, v73
    v_and_b32 v123, s42, v73
    v_lshlrev_b32 v124, 16, v74
    s_waitcnt vmcnt(2)
    v_dot2c_f32_bf16 v144, s43, v76
    v_dot2c_f32_bf16 v146, v76, v76
    v_dot2c_f32_bf16 v145, s43, v77
    v_dot2c_f32_bf16 v147, v77, v77
    v_dot2c_f32_bf16 v144, s43, v78
    v_dot2c_f32_bf16 v146, v78, v78
    v_dot2c_f32_bf16 v145, s43, v79
    v_dot2c_f32_bf16 v147, v79, v79
    v_and_b32 v125, s42, v74
    v_lshlrev_b32 v126, 16, v75
    v_and_b32 v127, s42, v75
    v_lshlrev_b32 v128, 16, v76
    v_and_b32 v129, s42, v76
    v_lshlrev_b32 v130, 16, v77
    v_and_b32 v131, s42, v77
    s_waitcnt vmcnt(1)
    v_dot2c_f32_bf16 v144, s43, v80
    v_dot2c_f32_bf16 v146, v80, v80
    v_dot2c_f32_bf16 v145, s43, v81
    v_dot2c_f32_bf16 v147, v81, v81
    v_dot2c_f32_bf16 v144, s43, v82
    v_dot2c_f32_bf16 v146, v82, v82
    v_dot2c_f32_bf16 v145, s43, v83
    v_dot2c_f32_bf16 v147, v83, v83
    v_lshlrev_b32 v132, 16, v78
    v_and_b32 v133, s42, v78
    v_lshlrev_b32 v134, 16, v79
    v_add_f32 v144, v144, v145
    v_add_f32 v146, v146, v147
    v_and_b32 v135, s42, v79
    v_add_f32_dpp v144, v144, v144 quad_perm:[1,0,3,2] row_mask:0xf bank_mask:0xf
    v_add_f32_dpp v146, v146, v146 quad_perm:[1,0,3,2] row_mask:0xf bank_mask:0xf
    v_lshlrev_b32 v136, 16, v80
    v_add_f32_dpp v144, v144, v144 row_ror:8 row_mask:0xf bank_mask:0xf
    v_add_f32_dpp v146, v146, v146 row_ror:8 row_mask:0xf bank_mask:0xf
    v_mov_b32 v148, v144
    v_mov_b32 v149, v146
    v_and_b32 v137, s42, v80
    v_permlane16_swap_b32 v144, v148
    v_permlane16_swap_b32 v146, v149
    v_lshlrev_b32 v138, 16, v81
    v_add_f32 v144, v144, v148
    v_add_f32 v146, v146, v149
    v_mov_b32 v148, v144
    v_mov_b32 v149, v146
    v_and_b32 v139, s42, v81
    v_permlane32_swap_b32 v144, v148
    v_permlane32_swap_b32 v146, v149
    v_lshlrev_b32 v140, 16, v82
    v_add_f32 v144, v144, v148
    v_add_f32 v146, v146, v149
    v_mul_f32 v150, s38, v144
    v_mul_f32 v146, s38, v146
    v_fma_f32 v154, -v150, v150, v146
    v_mul_f32 v146, 0x3d800000, v146
    v_cmp_nge_f32 vcc, v154, v146
    s_cbranch_vccnz ln_exact
ln_back:
    v_cvt_pk_bf16_f32 v154, 0, v154
    v_cvt_pk_bf16_f32 v150, 0, v150
    v_add_f32 v154, 0x3727c5ac, v154
    v_cvt_pk_bf16_f32 v154, 0, v154
    v_sqrt_f32 v154, v154
    v_and_b32 v141, s42, v82
    v_cvt_pk_bf16_f32 v154, 0, v154
    v_rcp_f32 v151, v154
    v_lshlrev_b32 v142, 16, v83
    v_mul_f32 v144, 0x3dd53b95, v151
    v_mul_f32 v146, -v150, v144
    v_pk_fma_f32 v[156:157], v[104:105], v[144:145], v[146:147] op_sel_hi:[1,0,0]
    v_cvt_pk_bf16_f32 v160, v156, v157
    v_pk_fma_f32 v[158:159], v[106:107], v[144:145], v[146:147] op_sel_hi:[1,0,0]
    v_cvt_pk_bf16_f32 v161, v158, v159
    v_pk_fma_f32 v[156:157], v[108:109], v[144:145], v[146:147] op_sel_hi:[1,0,0]
    v_cvt_pk_bf16_f32 v162, v156, v157
    v_pk_fma_f32 v[158:159], v[110:111], v[144:145], v[146:147] op_sel_hi:[1,0,0]
    v_cvt_pk_bf16_f32 v163, v158, v159
    buffer_store_dwordx4 v[160:163], v243, s[24:27], s41 offen sc1
    s_addk_i32 s41, 16384
    v_pk_fma_f32 v[156:157], v[112:113], v[144:145], v[146:147] op_sel_hi:[1,0,0]
    v_cvt_pk_bf16_f32 v164, v156, v157
    v_pk_fma_f32 v[158:159], v[114:115], v[144:145], v[146:147] op_sel_hi:[1,0,0]
    v_cvt_pk_bf16_f32 v165, v158, v159
    v_pk_fma_f32 v[156:157], v[116:117], v[144:145], v[146:147] op_sel_hi:[1,0,0]
    v_cvt_pk_bf16_f32 v166, v156, v157
    v_pk_fma_f32 v[158:159], v[118:119], v[144:145], v[146:147] op_sel_hi:[1,0,0]
    v_cvt_pk_bf16_f32 v167, v158, v159
    buffer_store_dwordx4 v[164:167], v243, s[24:27], s41 offen sc1
    s_addk_i32 s41, 16384
    v_pk_fma_f32 v[156:157], v[120:121], v[144:145], v[146:147] op_sel_hi:[1,0,0]
    v_cvt_pk_bf16_f32 v168, v156, v157
    v_pk_fma_f32 v[158:159], v[122:123], v[144:145], v[146:147] op_sel_hi:[1,0,0]
    v_cvt_pk_bf16_f32 v169, v158, v159
    v_pk_fma_f32 v[156:157], v[124:125], v[144:145], v[146:147] op_sel_hi:[1,0,0]
    v_cvt_pk_bf16_f32 v170, v156, v157
    v_pk_fma_f32 v[158:159], v[126:127], v[144:145], v[146:147] op_sel_hi:[1,0,0]
    v_cvt_pk_bf16_f32 v171, v158, v159
    buffer_store_dwordx4 v[168:171], v243, s[24:27], s41 offen sc1
    s_addk_i32 s41, 16384
    v_pk_fma_f32 v[156:157], v[128:129], v[144:145], v[146:147] op_sel_hi:[1,0,0]
    v_cvt_pk_bf16_f32 v172, v156, v157
    v_pk_fma_f32 v[158:159], v[130:131], v[144:145], v[146:147] op_sel_hi:[1,0,0]
    v_cvt_pk_bf16_f32 v173, v158, v159
    v_pk_fma_f32 v[156:157], v[132:133], v[144:145], v[146:147] op_sel_hi:[1,0,0]
    v_cvt_pk_bf16_f32 v174, v156, v157
    v_pk_fma_f32 v[158:159], v[134:135], v[144:145], v[146:147] op_sel_hi:[1,0,0]
    v_cvt_pk_bf16_f32 v175, v158, v159
    buffer_store_dwordx4 v[172:175], v243, s[24:27], s41 offen sc1
    s_addk_i32 s41, 16384
    v_pk_fma_f32 v[156:157], v[136:137], v[144:145], v[146:147] op_sel_hi:[1,0,0]
    v_cvt_pk_bf16_f32 v176, v156, v157
    v_pk_fma_f32 v[158:159], v[138:139], v[144:145], v[146:147] op_sel_hi:[1,0,0]
    v_cvt_pk_bf16_f32 v177, v158, v159
    v_pk_fma_f32 v[156:157], v[140:141], v[144:145], v[146:147] op_sel_hi:[1,0,0]
    v_cvt_pk_bf16_f32 v178, v156, v157
    v_and_b32 v143, s42, v83
    v_pk_fma_f32 v[158:159], v[142:143], v[144:145], v[146:147] op_sel_hi:[1,0,0]
    v_cvt_pk_bf16_f32 v179, v158, v159
    buffer_store_dwordx4 v[176:179], v243, s[24:27], s41 offen sc1
    s_barrier
    buffer_load_dwordx4 v[84:87], v241, s[16:19], 0 offen offset:0
    buffer_load_dwordx4 v[88:91], v241, s[16:19], 0 offen offset:256
    buffer_load_dwordx4 v[92:95], v241, s[16:19], 0 offen offset:512
    buffer_load_dwordx4 v[96:99], v241, s[16:19], 0 offen offset:768
    buffer_load_dwordx4 v[100:103], v241, s[16:19], 0 offen offset:1024
    s_waitcnt vmcnt(10)
    v_readfirstlane_b32 s7, v26
    s_lshr_b32 s7, s7, 4
    s_mul_i32 s7, s7, 0x2c9277b5
    s_add_u32 s7, s7, 0x6c564b05
    s_lshl_b32 s7, s7, 4
    s_add_u32 s36, s36, s37
    s_sub_u32 s55, s36, 7864320
    s_min_u32 s36, s36, s55
    s_add_u32 s36, s36, s37
    s_sub_u32 s55, s36, 7864320
    s_min_u32 s36, s36, s55
    s_mov_b64 exec, 0
    s_cmp_eq_u32 s3, 0
    s_cbranch_scc1 pg_2
    s_branch pg_3
pg_backL:
    s_mov_b64 exec, -1
    s_waitcnt vmcnt(5)
ln_join:
    s_waitcnt lgkmcnt(0)
    s_barrier
    v_mov_b32 v21, s7
    s_mov_b64 exec, 0xff
    buffer_store_dword v21, v20, s[24:27], s6 offen sc1
    s_mov_b64 exec, 0x55
    v_lshlrev_b32 v29, 3, v240
    s_add_u32 s56, s44, 3211264
    buffer_store_dwordx2 v[150:151], v29, s[24:27], s56 offen sc1
    s_mov_b64 exec, -1
    s_add_u32 m0, s49, 98304
    s_nop 0
    buffer_load_dwordx4 v2, s[8:11], s36 offen offset:0 lds
    s_add_u32 m0, s49, 99200
    s_nop 0
    buffer_load_dwordx4 v2, s[8:11], s36 offen offset:128 lds
    s_add_u32 m0, s49, 100096
    s_nop 0
    buffer_load_dwordx4 v2, s[8:11], s36 offen offset:256 lds
    s_add_u32 m0, s49, 101376
    s_nop 0
    buffer_load_dwordx4 v3, s[8:11], s36 offen offset:0 lds
    s_add_u32 m0, s49, 102272
    s_nop 0
    buffer_load_dwordx4 v3, s[8:11], s36 offen offset:128 lds
    s_add_u32 m0, s49, 103168
    s_nop 0
    buffer_load_dwordx4 v3, s[8:11], s36 offen offset:256 lds
    s_add_u32 s36, s36, s37
    s_sub_u32 s55, s36, 7864320
    s_min_u32 s36, s36, s55
    v_mov_b32 v144, 0
    v_mov_b32 v145, 0
    s_waitcnt vmcnt(8)
    v_pk_add_f32 v[104:105], v[104:105], v[150:151] op_sel_hi:[1,0] neg_lo:[0,1] neg_hi:[0,1]
    v_cvt_pk_bf16_f32 v104, 0, v104
    v_cvt_pk_bf16_f32 v105, 0, v105
    v_pk_mul_f32 v[104:105], v[104:105], v[150:151] op_sel:[0,1]
    v_cvt_pk_bf16_f32 v104, v104, v105
    v_dot2c_f32_bf16 v144, v104, v84
    v_pk_add_f32 v[106:107], v[106:107], v[150:151] op_sel_hi:[1,0] neg_lo:[0,1] neg_hi:[0,1]
    v_cvt_pk_bf16_f32 v106, 0, v106
    v_cvt_pk_bf16_f32 v107, 0, v107
    v_pk_mul_f32 v[106:107], v[106:107], v[150:151] op_sel:[0,1]
    v_cvt_pk_bf16_f32 v106, v106, v107
    v_dot2c_f32_bf16 v145, v106, v85
    v_pk_add_f32 v[108:109], v[108:109], v[150:151] op_sel_hi:[1,0] neg_lo:[0,1] neg_hi:[0,1]
    v_cvt_pk_bf16_f32 v108, 0, v108
    v_cvt_pk_bf16_f32 v109, 0, v109
    v_pk_mul_f32 v[108:109], v[108:109], v[150:151] op_sel:[0,1]
    v_cvt_pk_bf16_f32 v108, v108, v109
    v_dot2c_f32_bf16 v144, v108, v86
    v_pk_add_f32 v[110:111], v[110:111], v[150:151] op_sel_hi:[1,0] neg_lo:[0,1] neg_hi:[0,1]
    v_cvt_pk_bf16_f32 v110, 0, v110
    v_cvt_pk_bf16_f32 v111, 0, v111
    v_pk_mul_f32 v[110:111], v[110:111], v[150:151] op_sel:[0,1]
    v_cvt_pk_bf16_f32 v110, v110, v111
    v_dot2c_f32_bf16 v145, v110, v87
    v_pk_add_f32 v[112:113], v[112:113], v[150:151] op_sel_hi:[1,0] neg_lo:[0,1] neg_hi:[0,1]
    v_cvt_pk_bf16_f32 v112, 0, v112
    v_cvt_pk_bf16_f32 v113, 0, v113
    v_pk_mul_f32 v[112:113], v[112:113], v[150:151] op_sel:[0,1]
    v_cvt_pk_bf16_f32 v112, v112, v113
    v_dot2c_f32_bf16 v144, v112, v88
    v_pk_add_f32 v[114:115], v[114:115], v[150:151] op_sel_hi:[1,0] neg_lo:[0,1] neg_hi:[0,1]
    v_cvt_pk_bf16_f32 v114, 0, v114
    v_cvt_pk_bf16_f32 v115, 0, v115
    v_pk_mul_f32 v[114:115], v[114:115], v[150:151] op_sel:[0,1]
    v_cvt_pk_bf16_f32 v114, v114, v115
    v_dot2c_f32_bf16 v145, v114, v89
    v_pk_add_f32 v[116:117], v[116:117], v[150:151] op_sel_hi:[1,0] neg_lo:[0,1] neg_hi:[0,1]
    v_cvt_pk_bf16_f32 v116, 0, v116
    v_cvt_pk_bf16_f32 v117, 0, v117
    v_pk_mul_f32 v[116:117], v[116:117], v[150:151] op_sel:[0,1]
    v_cvt_pk_bf16_f32 v116, v116, v117
    v_dot2c_f32_bf16 v144, v116, v90
    v_pk_add_f32 v[118:119], v[118:119], v[150:151] op_sel_hi:[1,0] neg_lo:[0,1] neg_hi:[0,1]
    v_cvt_pk_bf16_f32 v118, 0, v118
    v_cvt_pk_bf16_f32 v119, 0, v119
    v_pk_mul_f32 v[118:119], v[118:119], v[150:151] op_sel:[0,1]
    v_cvt_pk_bf16_f32 v118, v118, v119
    v_dot2c_f32_bf16 v145, v118, v91
    v_pk_add_f32 v[120:121], v[120:121], v[150:151] op_sel_hi:[1,0] neg_lo:[0,1] neg_hi:[0,1]
    v_cvt_pk_bf16_f32 v120, 0, v120
    v_cvt_pk_bf16_f32 v121, 0, v121
    v_pk_mul_f32 v[120:121], v[120:121], v[150:151] op_sel:[0,1]
    v_cvt_pk_bf16_f32 v120, v120, v121
    v_dot2c_f32_bf16 v144, v120, v92
    v_pk_add_f32 v[122:123], v[122:123], v[150:151] op_sel_hi:[1,0] neg_lo:[0,1] neg_hi:[0,1]
    v_cvt_pk_bf16_f32 v122, 0, v122
    v_cvt_pk_bf16_f32 v123, 0, v123
    v_pk_mul_f32 v[122:123], v[122:123], v[150:151] op_sel:[0,1]
    v_cvt_pk_bf16_f32 v122, v122, v123
    v_dot2c_f32_bf16 v145, v122, v93
    v_pk_add_f32 v[124:125], v[124:125], v[150:151] op_sel_hi:[1,0] neg_lo:[0,1] neg_hi:[0,1]
    v_cvt_pk_bf16_f32 v124, 0, v124
    v_cvt_pk_bf16_f32 v125, 0, v125
    v_pk_mul_f32 v[124:125], v[124:125], v[150:151] op_sel:[0,1]
    v_cvt_pk_bf16_f32 v124, v124, v125
    v_dot2c_f32_bf16 v144, v124, v94
    v_pk_add_f32 v[126:127], v[126:127], v[150:151] op_sel_hi:[1,0] neg_lo:[0,1] neg_hi:[0,1]
    v_cvt_pk_bf16_f32 v126, 0, v126
    v_cvt_pk_bf16_f32 v127, 0, v127
    v_pk_mul_f32 v[126:127], v[126:127], v[150:151] op_sel:[0,1]
    v_cvt_pk_bf16_f32 v126, v126, v127
    v_dot2c_f32_bf16 v145, v126, v95
    s_branch page0
    .p2align 12
    .fill 32, 4, 0xbf810000
page0:
pg_0:
    s_cbranch_execz pg_4
    v_pk_add_f32 v[128:129], v[128:129], v[150:151] op_sel_hi:[1,0] neg_lo:[0,1] neg_hi:[0,1]
    v_cvt_pk_bf16_f32 v128, 0, v128
    v_cvt_pk_bf16_f32 v129, 0, v129
    v_pk_mul_f32 v[128:129], v[128:129], v[150:151] op_sel:[0,1]
    v_cvt_pk_bf16_f32 v128, v128, v129
    v_dot2c_f32_bf16 v144, v128, v96
    v_pk_add_f32 v[130:131], v[130:131], v[150:151] op_sel_hi:[1,0] neg_lo:[0,1] neg_hi:[0,1]
    v_cvt_pk_bf16_f32 v130, 0, v130
    v_cvt_pk_bf16_f32 v131, 0, v131
    v_pk_mul_f32 v[130:131], v[130:131], v[150:151] op_sel:[0,1]
    v_cvt_pk_bf16_f32 v130, v130, v131
    v_dot2c_f32_bf16 v145, v130, v97
    v_pk_add_f32 v[132:133], v[132:133], v[150:151] op_sel_hi:[1,0] neg_lo:[0,1] neg_hi:[0,1]
    v_cvt_pk_bf16_f32 v132, 0, v132
    v_cvt_pk_bf16_f32 v133, 0, v133
    v_pk_mul_f32 v[132:133], v[132:133], v[150:151] op_sel:[0,1]
    v_cvt_pk_bf16_f32 v132, v132, v133
    v_dot2c_f32_bf16 v144, v132, v98
    v_pk_add_f32 v[134:135], v[134:135], v[150:151] op_sel_hi:[1,0] neg_lo:[0,1] neg_hi:[0,1]
    v_cvt_pk_bf16_f32 v134, 0, v134
    v_cvt_pk_bf16_f32 v135, 0, v135
    v_pk_mul_f32 v[134:135], v[134:135], v[150:151] op_sel:[0,1]
    v_cvt_pk_bf16_f32 v134, v134, v135
    v_dot2c_f32_bf16 v145, v134, v99
    s_mov_b32 s4, s7
    s_mov_b32 s5, s7
    s_add_u32 s47, s46, 32
spin_ln:
    s_load_dwordx8 s[28:35], s[86:87], s46 glc
    s_add_u32 s101, s101, 1
    s_cmp_gt_u32 s101, 0x2000000
    s_cselect_b32 s57, 0, -1
    s_waitcnt lgkmcnt(0)
    s_xor_b64 s[28:29], s[28:29], s[4:5]
    s_xor_b64 s[30:31], s[30:31], s[4:5]
    s_xor_b64 s[32:33], s[32:33], s[4:5]
    s_xor_b64 s[34:35], s[34:35], s[4:5]
    s_or_b64 s[28:29], s[28:29], s[30:31]
    s_or_b64 s[28:29], s[28:29], s[32:33]
    s_or_b64 s[28:29], s[28:29], s[34:35]
    s_or_b32 s56, s28, s29
    s_and_b32 s56, s56, s57
    s_cbranch_scc1 spin_ln
    s_add_u32 s46, s45, 0
    s_sub_u32 s77, s46, 81920
    s_min_u32 s46, s46, s77
    s_xor_b32 s77, s46, 1024
    buffer_load_dwordx4 a[160:163], v14, s[20:23], s46 offen sc1
    buffer_load_dwordx4 a[164:167], v14, s[20:23], s77 offen sc1
    buffer_load_dwordx4 a[168:171], v15, s[20:23], s46 offen sc1
    buffer_load_dwordx4 a[172:175], v15, s[20:23], s77 offen sc1
    s_add_u32 s46, s45, 4096
    s_sub_u32 s77, s46, 81920
    s_min_u32 s46, s46, s77
    s_xor_b32 s77, s46, 1024
    buffer_load_dwordx4 a[176:179], v14, s[20:23], s46 offen sc1
    buffer_load_dwordx4 a[180:183], v14, s[20:23], s77 offen sc1
    buffer_load_dwordx4 a[184:187], v15, s[20:23], s46 offen sc1
    buffer_load_dwordx4 a[188:191], v15, s[20:23], s77 offen sc1
    v_pk_add_f32 v[136:137], v[136:137], v[150:151] op_sel_hi:[1,0] neg_lo:[0,1] neg_hi:[0,1]
    v_cvt_pk_bf16_f32 v136, 0, v136
    v_cvt_pk_bf16_f32 v137, 0, v137
    v_pk_mul_f32 v[136:137], v[136:137], v[150:151] op_sel:[0,1]
    v_cvt_pk_bf16_f32 v136, v136, v137
    v_dot2c_f32_bf16 v144, v136, v100
    v_pk_add_f32 v[138:139], v[138:139], v[150:151] op_sel_hi:[1,0] neg_lo:[0,1] neg_hi:[0,1]
    v_cvt_pk_bf16_f32 v138, 0, v138
    v_cvt_pk_bf16_f32 v139, 0, v139
    v_pk_mul_f32 v[138:139], v[138:139], v[150:151] op_sel:[0,1]
    v_cvt_pk_bf16_f32 v138, v138, v139
    v_dot2c_f32_bf16 v145, v138, v101
    v_pk_add_f32 v[140:141], v[140:141], v[150:151] op_sel_hi:[1,0] neg_lo:[0,1] neg_hi:[0,1]
    v_cvt_pk_bf16_f32 v140, 0, v140
    v_cvt_pk_bf16_f32 v141, 0, v141
    v_pk_mul_f32 v[140:141], v[140:141], v[150:151] op_sel:[0,1]
    v_cvt_pk_bf16_f32 v140, v140, v141
    v_dot2c_f32_bf16 v144, v140, v102
    v_pk_add_f32 v[142:143], v[142:143], v[150:151] op_sel_hi:[1,0] neg_lo:[0,1] neg_hi:[0,1]
    v_cvt_pk_bf16_f32 v142, 0, v142
    v_cvt_pk_bf16_f32 v143, 0, v143
    v_pk_mul_f32 v[142:143], v[142:143], v[150:151] op_sel:[0,1]
    v_cvt_pk_bf16_f32 v142, v142, v143
    v_dot2c_f32_bf16 v145, v142, v103
    s_nop 2
    v_add_f32 v144, v144, v145
    s_nop 0
    s_nop 0
    v_add_f32_dpp v144, v144, v144 quad_perm:[1,0,3,2] row_mask:0xf bank_mask:0xf
    s_nop 0
    s_nop 0
    v_add_f32_dpp v144, v144, v144 row_ror:8 row_mask:0xf bank_mask:0xf
    v_mov_b32 v148, v144
    s_nop 0
    s_nop 0
    v_permlane16_swap_b32 v144, v148
    s_nop 0
    s_nop 0
    v_add_f32 v144, v144, v148
    v_mov_b32 v148, v144
    s_nop 0
    s_nop 0
    v_permlane32_swap_b32 v144, v148
    s_nop 0
    s_nop 0
    v_add_f32 v144, v144, v148
    v_cvt_pk_bf16_f32 v144, 0, v144
    v_ashrrev_i32 v146, 31, v144
    v_or_b32 v146, 0x80000000, v146
    v_xor_b32 v144, v144, v146
    v_and_b32 v144, s42, v144
    v_sub_u32 v146, 2047, v240
    v_or_b32 v144, v144, v146
    s_cmp_lt_u32 s3, 2
    s_cselect_b32 s56, -1, 0
    v_and_b32 v144, s56, v144
    v_mov_b32 v34, s7
    v_mov_b32 v35, s7
    v_max_u32_dpp v32, v144, v144 quad_perm:[2,3,0,1] row_mask:0xf bank_mask:0xf
    v_min_u32_dpp v33, v144, v144 quad_perm:[2,3,0,1] row_mask:0xf bank_mask:0xf
    s_nop 0
    v_min_u32_dpp v146, v32, v32 row_ror:4 row_mask:0xf bank_mask:0xf
    v_max_u32_dpp v33, v33, v33 row_ror:4 row_mask:0xf bank_mask:0xf
    v_max_u32_dpp v32, v32, v32 row_ror:4 row_mask:0xf bank_mask:0xf
    v_max_u32 v33, v33, v146
    s_waitcnt vmcnt(8)
head_code:
    s_waitcnt vmcnt(26)
    s_barrier
    ds_read_b64_tr_b16 a[224:225], v8 offset:0
    ds_read_b64_tr_b16 a[226:227], v8 offset:6144
    ds_read_b64_tr_b16 a[228:229], v8 offset:12288
    ds_read_b64_tr_b16 a[230:231], v8 offset:18432
    ds_read_b64_tr_b16 a[232:233], v9 offset:0
    ds_read_b64_tr_b16 a[234:235], v9 offset:6144
    ds_read_b64_tr_b16 a[236:237], v9 offset:12288
    ds_read_b64_tr_b16 a[238:239], v9 offset:18432
    ds_read_b64_tr_b16 a[240:241], v10 offset:0
    ds_read_b64_tr_b16 a[242:243], v10 offset:6144
    ds_read_b64_tr_b16 a[244:245], v10 offset:12288
    ds_read_b64_tr_b16 a[246:247], v10 offset:18432
    s_waitcnt vmcnt(7) lgkmcnt(10)
    v_mfma_f32_16x16x32_bf16 v[64:67], a[224:227], a[160:163], 0
    s_waitcnt vmcnt(2) lgkmcnt(8)
    v_min_u32 v36, 1, v1
    v_lshlrev_b32 v36, 30, v36
    v_mfma_f32_16x16x32_bf16 v[64:67], a[228:231], a[176:179], v[64:67]
    s_add_u32 s46, s45, 8192
    v_and_b32 v37, 31, v1
    v_lshlrev_b32 v37, 2, v37
    v_mfma_f32_16x16x32_bf16 v[72:75], a[228:231], a[180:183], 0
    s_waitcnt vmcnt(1)
    v_mov_b32 v38, 0
    s_sub_u32 s77, s46, 81920
    v_mfma_f32_16x16x32_bf16 v[72:75], a[224:227], a[164:167], v[72:75]
    s_waitcnt vmcnt(0)
    s_min_u32 s46, s46, s77
    s_xor_b32 s77, s46, 1024
    v_mfma_f32_16x16x32_bf16 v[80:83], a[224:227], a[168:171], 0
    buffer_load_dwordx4 a[96:99], v14, s[20:23], s46 offen sc1
    v_mfma_f32_16x16x32_bf16 v[80:83], a[228:231], a[184:187], v[80:83]
    s_lshl2_add_u32 s6, s2, s3
    s_lshl_b32 s6, s6, 4
    s_add_u32 s6, s6, 3162112
    v_mfma_f32_16x16x32_bf16 v[88:91], a[228:231], a[188:191], 0
    s_waitcnt lgkmcnt(0)
    s_lshl2_add_u32 s93, s2, s3
    s_lshl_b32 s93, s93, 7
    v_mfma_f32_16x16x32_bf16 v[88:91], a[224:227], a[172:175], v[88:91]
    s_add_u32 s93, s93, 4194304
    ds_read_b64_tr_b16 a[224:225], v11 offset:0
    v_mfma_f32_16x16x32_bf16 v[92:95], a[232:235], a[172:175], 0
    buffer_store_dword v38, v37, s[24:27], s93 offen sc1
    v_mfma_f32_16x16x32_bf16 v[92:95], a[236:239], a[188:191], v[92:95]
    buffer_load_dwordx4 a[100:103], v14, s[20:23], s77 offen sc1
    v_mfma_f32_16x16x32_bf16 v[84:87], a[236:239], a[184:187], 0
    s_mul_i32 s56, s50, 786432
    ds_read_b64_tr_b16 a[226:227], v11 offset:6144
    v_mul_u32_u24 v56, 3072, v5
    v_mfma_f32_16x16x32_bf16 v[84:87], a[232:235], a[168:171], v[84:87]
    s_add_u32 s56, s56, 589824
    ds_read_b64_tr_b16 a[228:229], v11 offset:12288
    v_add_u32 v56, v56, v7
    v_mfma_f32_16x16x32_bf16 v[76:79], a[232:235], a[164:167], 0
    s_add_u32 s12, s66, s56
    s_addc_u32 s13, s67, 0
    v_add_u32 v57, 49152, v56
    v_mfma_f32_16x16x32_bf16 v[76:79], a[236:239], a[180:183], v[76:79]
    s_and_b32 s13, s13, 0xffff
    ds_read_b64_tr_b16 a[230:231], v11 offset:18432
    v_lshrrev_b32 v29, 3, v1
    v_mfma_f32_16x16x32_bf16 v[68:71], a[236:239], a[176:179], 0
    buffer_load_dwordx4 a[104:107], v15, s[20:23], s46 offen sc1
    v_mfma_f32_16x16x32_bf16 v[68:71], a[232:235], a[160:163], v[68:71]
    s_mov_b32 s14, 196608
    ds_read_b64_tr_b16 a[232:233], v8 offset:1024
    v_mul_u32_u24 v31, 384, v29
    v_mfma_f32_16x16x32_bf16 v[96:99], a[240:243], a[160:163], 0
    s_mov_b32 s15, 0x00020000
    ds_read_b64_tr_b16 a[234:235], v8 offset:7168
    v_add_u32 v6, v31, v7
    v_mfma_f32_16x16x32_bf16 v[96:99], a[244:247], a[176:179], v[96:99]
    s_add_u32 s16, s68, s56
    s_addc_u32 s17, s69, 0
    v_bfe_u32 v29, v1, 4, 1
    v_mfma_f32_16x16x32_bf16 v[104:107], a[244:247], a[180:183], 0
    s_and_b32 s17, s17, 0xffff
    ds_read_b64_tr_b16 a[236:237], v8 offset:13312
    v_bfe_u32 v30, v1, 5, 1
    v_mfma_f32_16x16x32_bf16 v[104:107], a[240:243], a[164:167], v[104:107]
    s_mov_b32 s18, 196608
    ds_read_b64_tr_b16 a[238:239], v8 offset:19456
    v_lshl_add_u32 v29, v29, 1, v30
    v_mfma_f32_16x16x32_bf16 v[112:115], a[240:243], a[168:171], 0
    buffer_load_dwordx4 a[108:111], v15, s[20:23], s77 offen sc1
    v_mfma_f32_16x16x32_bf16 v[112:115], a[244:247], a[184:187], v[112:115]
    s_waitcnt lgkmcnt(4)
    v_and_b32 v30, 7, v1
    v_xor_b32 v30, v30, v29
    v_mfma_f32_16x16x32_bf16 v[120:123], a[244:247], a[188:191], 0
    s_add_u32 s46, s45, 12288
    v_lshl_add_u32 v4, v30, 4, v31
    v_xor_b32 v30, 4, v30
    v_mfma_f32_16x16x32_bf16 v[120:123], a[240:243], a[172:175], v[120:123]
    s_sub_u32 s77, s46, 81920
    ds_read_b64_tr_b16 a[240:241], v9 offset:1024
    v_lshl_add_u32 v5, v30, 4, v31
    v_mfma_f32_16x16x32_bf16 v[124:127], a[224:227], a[172:175], 0
    s_min_u32 s46, s46, s77
    ds_read_b64_tr_b16 a[242:243], v9 offset:7168
    v_add_u32 v5, 3072, v5
    v_mfma_f32_16x16x32_bf16 v[124:127], a[228:231], a[188:191], v[124:127]
    s_xor_b32 s77, s46, 1024
    ds_read_b64_tr_b16 a[244:245], v9 offset:13312
    v_bfe_u32 v30, v1, 1, 1
    v_mfma_f32_16x16x32_bf16 v[116:119], a[228:231], a[184:187], 0
    buffer_load_dwordx4 a[112:115], v14, s[20:23], s46 offen sc1
    v_mfma_f32_16x16x32_bf16 v[116:119], a[224:227], a[168:171], v[116:119]
    s_mov_b32 s19, 0x00020000
    ds_read_b64_tr_b16 a[246:247], v9 offset:19456
    v_bfe_u32 v31, v1, 2, 1
    v_mfma_f32_16x16x32_bf16 v[108:111], a[224:227], a[164:167], 0
    s_mov_b32 s28, s78
    v_lshl_add_u32 v30, v30, 1, v31
    v_bfe_u32 v31, v1, 3, 1
    v_mfma_f32_16x16x32_bf16 v[108:111], a[228:231], a[180:183], v[108:111]
    s_waitcnt lgkmcnt(4)
    v_lshl_add_u32 v30, v31, 2, v30
    v_xor_b32 v30, v30, v29
    v_mfma_f32_16x16x32_bf16 v[100:103], a[228:231], a[176:179], 0
    s_and_b32 s29, s79, 0xffff
    v_lshlrev_b32 v30, 4, v30
    v_mul_u32_u24 v31, 3072, v31
    v_mfma_f32_16x16x32_bf16 v[100:103], a[224:227], a[160:163], v[100:103]
    s_mov_b32 s30, 1966080
    ds_read_b64_tr_b16 a[224:225], v10 offset:1024
    v_and_b32 v29, 7, v1
    v_mfma_f32_16x16x32_bf16 v[128:131], a[232:235], a[160:163], 0
    buffer_load_dwordx4 a[116:119], v14, s[20:23], s77 offen sc1
    v_mfma_f32_16x16x32_bf16 v[128:131], a[236:239], a[176:179], v[128:131]
    s_mov_b32 s31, 0x00020000
    ds_read_b64_tr_b16 a[226:227], v10 offset:7168
    v_lshl_add_u32 v31, v29, 7, v31
    v_mfma_f32_16x16x32_bf16 v[136:139], a[236:239], a[180:183], 0
    s_mov_b32 s32, s80
    ds_read_b64_tr_b16 a[228:229], v10 offset:13312
    v_add_u32 v12, v31, v30
    v_mfma_f32_16x16x32_bf16 v[136:139], a[232:235], a[164:167], v[136:139]
    s_and_b32 s33, s81, 0xffff
    ds_read_b64_tr_b16 a[230:231], v10 offset:19456
    v_xor_b32 v30, 64, v30
    v_mfma_f32_16x16x32_bf16 v[144:147], a[232:235], a[168:171], 0
    s_mov_b32 s34, 1966080
    v_add_u32 v13, v31, v30
    v_lshrrev_b32 v19, 5, v1
    v_mfma_f32_16x16x32_bf16 v[144:147], a[236:239], a[184:187], v[144:147]
    s_waitcnt lgkmcnt(4)
    v_lshlrev_b32 v19, 11, v19
    v_sub_u32 v19, 0xffffa000, v19
    v_mfma_f32_16x16x32_bf16 v[152:155], a[236:239], a[188:191], 0
    buffer_load_dwordx4 a[120:123], v15, s[20:23], s46 offen sc1
    v_mfma_f32_16x16x32_bf16 v[152:155], a[232:235], a[172:175], v[152:155]
    s_mov_b32 s35, 0x00020000
    ds_read_b64_tr_b16 a[232:233], v11 offset:1024
    s_min_u32 s58, s2, 239
    v_mfma_f32_16x16x32_bf16 v[156:159], a[240:243], a[172:175], 0
    s_mul_hi_u32 s56, s58, 178956971
    ds_read_b64_tr_b16 a[234:235], v11 offset:7168
    s_mul_i32 s57, s56, 24
    v_mfma_f32_16x16x32_bf16 v[156:159], a[244:247], a[188:191], v[156:159]
    s_sub_u32 s57, s58, s57
    ds_read_b64_tr_b16 a[236:237], v11 offset:13312
    s_lshl_b32 s60, s56, 6
    v_mfma_f32_16x16x32_bf16 v[148:151], a[244:247], a[184:187], 0
    s_add_u32 s60, s60, s59
    ds_read_b64_tr_b16 a[238:239], v11 offset:19456
    s_mul_i32 s60, s60, 3072
    v_mfma_f32_16x16x32_bf16 v[148:151], a[240:243], a[168:171], v[148:151]
    s_lshl_b32 s44, s57, 7
    s_add_u32 s60, s60, s44
    s_lshl_b32 s61, s56, 7
    v_mfma_f32_16x16x32_bf16 v[140:143], a[240:243], a[164:167], 0
    buffer_load_dwordx4 a[124:127], v15, s[20:23], s77 offen sc1
    v_mfma_f32_16x16x32_bf16 v[140:143], a[244:247], a[180:183], v[140:143]
    s_waitcnt lgkmcnt(4)
    s_add_u32 m0, s49, 122880
    s_mul_i32 s62, s56, 1536
    v_mfma_f32_16x16x32_bf16 v[132:135], a[244:247], a[176:179], 0
    s_lshl_b32 s44, s57, 6
    s_add_u32 s62, s62, s44
    s_lshl_b32 s44, s3, 4
    v_mfma_f32_16x16x32_bf16 v[132:135], a[240:243], a[160:163], v[132:135]
    s_add_u32 s62, s62, s44
    ds_read_b64_tr_b16 a[240:241], v8 offset:2048
    s_lshl_b32 s62, s62, 4
    v_mfma_f32_16x16x32_bf16 v[160:163], a[224:227], a[160:163], 0
    s_add_u32 s62, s62, 3276800
    ds_read_b64_tr_b16 a[242:243], v8 offset:8192
    s_lshl_b32 s4, s2, 8
    v_mfma_f32_16x16x32_bf16 v[160:163], a[228:231], a[176:179], v[160:163]
    s_lshl_b32 s44, s3, 2
    ds_read_b64_tr_b16 a[244:245], v8 offset:14336
    s_add_u32 s4, s4, s44
    v_mfma_f32_16x16x32_bf16 v[168:171], a[228:231], a[180:183], 0
    buffer_load_dwordx4 v2, s[8:11], s36 offen offset:0 lds
    v_mfma_f32_16x16x32_bf16 v[168:171], a[224:227], a[164:167], v[168:171]
    s_addk_i32 m0, 896
    ds_read_b64_tr_b16 a[246:247], v8 offset:20480
    s_add_u32 s4, s4, 3932160
    v_mfma_f32_16x16x32_bf16 v[176:179], a[224:227], a[168:171], 0
    s_lshl_b32 s5, s52, 3
    s_add_u32 s5, s5, s53
    s_lshl_b32 s5, s5, 2
    v_mfma_f32_16x16x32_bf16 v[176:179], a[228:231], a[184:187], v[176:179]
    s_waitcnt lgkmcnt(4)
    s_add_u32 s5, s5, s3
    s_lshl_b32 s5, s5, 7
    v_mfma_f32_16x16x32_bf16 v[184:187], a[228:231], a[188:191], 0
    s_add_u32 s5, s5, 4096000
    s_lshl_b32 s76, s51, 2
    s_add_u32 s76, s76, s5
    v_mfma_f32_16x16x32_bf16 v[184:187], a[224:227], a[172:175], v[184:187]
    s_mov_b32 s92, 0xbfb8aa3b
    ds_read_b64_tr_b16 a[224:225], v9 offset:2048
    s_lshl_b32 s44, s3, 12
    v_mfma_f32_16x16x32_bf16 v[188:191], a[232:235], a[172:175], 0
    buffer_load_dwordx4 v2, s[8:11], s36 offen offset:128 lds
    v_mfma_f32_16x16x32_bf16 v[188:191], a[236:239], a[188:191], v[188:191]
    s_addk_i32 m0, 896
    ds_read_b64_tr_b16 a[226:227], v9 offset:8192
    s_mov_b32 s38, s49
    v_mfma_f32_16x16x32_bf16 v[180:183], a[236:239], a[184:187], 0
    s_mul_i32 s40, s3, 3072
    ds_read_b64_tr_b16 a[228:229], v9 offset:14336
    s_mov_b32 s47, 3162112
    v_mfma_f32_16x16x32_bf16 v[180:183], a[232:235], a[168:171], v[180:183]
    s_lshl_b32 s63, s3, 10
    ds_read_b64_tr_b16 a[230:231], v9 offset:20480
    v_mfma_f32_16x16x32_bf16 v[172:175], a[232:235], a[164:167], 0
    s_mov_b32 s80, 0xffffff01
    v_mfma_f32_16x16x32_bf16 v[172:175], a[236:239], a[180:183], v[172:175]
    s_waitcnt lgkmcnt(4)
    v_mfma_f32_16x16x32_bf16 v[164:167], a[236:239], a[176:179], 0
    buffer_load_dwordx4 v2, s[8:11], s36 offen offset:256 lds
    v_mfma_f32_16x16x32_bf16 v[164:167], a[232:235], a[160:163], v[164:167]
    s_addk_i32 m0, 1280
    ds_read_b64_tr_b16 a[232:233], v10 offset:2048
    v_mfma_f32_16x16x32_bf16 v[192:195], a[240:243], a[160:163], 0
    ds_read_b64_tr_b16 a[234:235], v10 offset:8192
    v_mfma_f32_16x16x32_bf16 v[192:195], a[244:247], a[176:179], v[192:195]
    ds_read_b64_tr_b16 a[236:237], v10 offset:14336
    v_mfma_f32_16x16x32_bf16 v[200:203], a[244:247], a[180:183], 0
    ds_read_b64_tr_b16 a[238:239], v10 offset:20480
    v_mfma_f32_16x16x32_bf16 v[200:203], a[240:243], a[164:167], v[200:203]
    v_mfma_f32_16x16x32_bf16 v[208:211], a[240:243], a[168:171], 0
    buffer_load_dwordx4 v3, s[8:11], s36 offen offset:0 lds
    v_mfma_f32_16x16x32_bf16 v[208:211], a[244:247], a[184:187], v[208:211]
    s_waitcnt lgkmcnt(4)
    s_addk_i32 m0, 896
    v_mfma_f32_16x16x32_bf16 v[216:219], a[244:247], a[188:191], 0
    v_mfma_f32_16x16x32_bf16 v[216:219], a[240:243], a[172:175], v[216:219]
    ds_read_b64_tr_b16 a[240:241], v11 offset:2048
    ds_read_b64_tr_b16 a[242:243], v11 offset:8192
    ds_read_b64_tr_b16 a[244:245], v11 offset:14336
    v_mfma_f32_16x16x32_bf16 v[220:223], a[224:227], a[172:175], 0
    ds_read_b64_tr_b16 a[246:247], v11 offset:20480
    v_mfma_f32_16x16x32_bf16 v[220:223], a[228:231], a[188:191], v[220:223]
    v_mfma_f32_16x16x32_bf16 v[212:215], a[228:231], a[184:187], 0
    buffer_load_dwordx4 v3, s[8:11], s36 offen offset:128 lds
    s_cmp_lg_u32 s3, 0
    s_cselect_b64 exec, -1, 0
    s_cbranch_execz pg_last
pg_back2:
    s_mov_b64 exec, -1
    v_mfma_f32_16x16x32_bf16 v[212:215], a[224:227], a[168:171], v[212:215]
    s_addk_i32 m0, 896
    v_mfma_f32_16x16x32_bf16 v[204:207], a[224:227], a[164:167], 0
    v_mfma_f32_16x16x32_bf16 v[204:207], a[228:231], a[180:183], v[204:207]
    s_waitcnt lgkmcnt(4)
    v_mfma_f32_16x16x32_bf16 v[196:199], a[228:231], a[176:179], 0
    s_waitcnt lgkmcnt(0)
    s_barrier
    v_mfma_f32_16x16x32_bf16 v[196:199], a[224:227], a[160:163], v[196:199]
    s_waitcnt vmcnt(12)
    ds_read_b64_tr_b16 a[224:225], v8 offset:24576
    v_mfma_f32_16x16x32_bf16 v[224:227], a[232:235], a[160:163], 0
    buffer_store_dwordx4 v[32:35], v36, s[24:27], s6 offen sc1
    v_mfma_f32_16x16x32_bf16 v[224:227], a[236:239], a[176:179], v[224:227]
    buffer_load_dwordx4 v3, s[8:11], s36 offen offset:256 lds
    v_mfma_f32_16x16x32_bf16 v[232:235], a[236:239], a[180:183], 0
    s_add_u32 s36, s36, s37
    ds_read_b64_tr_b16 a[226:227], v8 offset:30720
    s_sub_u32 s55, s36, 7864320
    v_mfma_f32_16x16x32_bf16 v[232:235], a[232:235], a[164:167], v[232:235]
    s_min_u32 s36, s36, s55
    ds_read_b64_tr_b16 a[228:229], v8 offset:36864
    s_add_u32 m0, s49, 0
    v_mfma_f32_16x16x32_bf16 v[240:243], a[232:235], a[168:171], 0
    ds_read_b64_tr_b16 a[230:231], v8 offset:43008
    v_mfma_f32_16x16x32_bf16 v[240:243], a[236:239], a[184:187], v[240:243]
    v_mfma_f32_16x16x32_bf16 v[248:251], a[236:239], a[188:191], 0
    buffer_load_dwordx4 v2, s[8:11], s36 offen offset:0 lds
    v_mfma_f32_16x16x32_bf16 v[248:251], a[232:235], a[172:175], v[248:251]
    s_addk_i32 m0, 896
    ds_read_b64_tr_b16 a[232:233], v9 offset:24576
    v_mfma_f32_16x16x32_bf16 v[252:255], a[240:243], a[172:175], 0
    ds_read_b64_tr_b16 a[234:235], v9 offset:30720
    v_mfma_f32_16x16x32_bf16 v[252:255], a[244:247], a[188:191], v[252:255]
    ds_read_b64_tr_b16 a[236:237], v9 offset:36864
    v_mfma_f32_16x16x32_bf16 v[244:247], a[244:247], a[184:187], 0
    ds_read_b64_tr_b16 a[238:239], v9 offset:43008
    v_mfma_f32_16x16x32_bf16 v[244:247], a[240:243], a[168:171], v[244:247]
    v_mfma_f32_16x16x32_bf16 v[236:239], a[240:243], a[164:167], 0
    buffer_load_dwordx4 v2, s[8:11], s36 offen offset:128 lds
    v_mfma_f32_16x16x32_bf16 v[236:239], a[244:247], a[180:183], v[236:239]
    s_waitcnt lgkmcnt(4)
    s_addk_i32 m0, 896
    v_mfma_f32_16x16x32_bf16 v[228:231], a[244:247], a[176:179], 0
    s_waitcnt vmcnt(12)
    v_mfma_f32_16x16x32_bf16 v[228:231], a[240:243], a[160:163], v[228:231]
    s_waitcnt vmcnt(11)
    ds_read_b64_tr_b16 a[240:241], v10 offset:24576
    v_mfma_f32_16x16x32_bf16 v[64:67], a[224:227], a[96:99], v[64:67]
    ds_read_b64_tr_b16 a[242:243], v10 offset:30720
    v_mfma_f32_16x16x32_bf16 v[64:67], a[228:231], a[112:115], v[64:67]
    ds_read_b64_tr_b16 a[244:245], v10 offset:36864
    v_mfma_f32_16x16x32_bf16 v[72:75], a[228:231], a[116:119], v[72:75]
    buffer_load_dwordx4 v2, s[8:11], s36 offen offset:256 lds
    v_mfma_f32_16x16x32_bf16 v[72:75], a[224:227], a[100:103], v[72:75]
    s_waitcnt vmcnt(10)
    ds_read_b64_tr_b16 a[246:247], v10 offset:43008
    s_addk_i32 m0, 1280
    v_mfma_f32_16x16x32_bf16 v[80:83], a[224:227], a[104:107], v[80:83]
    v_mfma_f32_16x16x32_bf16 v[80:83], a[228:231], a[120:123], v[80:83]
    s_waitcnt lgkmcnt(4)
    v_mfma_f32_16x16x32_bf16 v[88:91], a[228:231], a[124:127], v[88:91]
    v_mfma_f32_16x16x32_bf16 v[88:91], a[224:227], a[108:111], v[88:91]
    ds_read_b64_tr_b16 a[224:225], v11 offset:24576
    v_mfma_f32_16x16x32_bf16 v[92:95], a[232:235], a[108:111], v[92:95]
    buffer_load_dwordx4 v3, s[8:11], s36 offen offset:0 lds
    v_mfma_f32_16x16x32_bf16 v[92:95], a[236:239], a[124:127], v[92:95]
    s_addk_i32 m0, 896
    ds_read_b64_tr_b16 a[226:227], v11 offset:30720
    v_mfma_f32_16x16x32_bf16 v[84:87], a[236:239], a[120:123], v[84:87]
    ds_read_b64_tr_b16 a[228:229], v11 offset:36864
    v_mfma_f32_16x16x32_bf16 v[84:87], a[232:235], a[104:107], v[84:87]
    ds_read_b64_tr_b16 a[230:231], v11 offset:43008
    v_mfma_f32_16x16x32_bf16 v[76:79], a[232:235], a[100:103], v[76:79]
    v_mfma_f32_16x16x32_bf16 v[76:79], a[236:239], a[116:119], v[76:79]
    s_waitcnt lgkmcnt(4)
    v_mfma_f32_16x16x32_bf16 v[68:71], a[236:239], a[112:115], v[68:71]
    buffer_load_dwordx4 v3, s[8:11], s36 offen offset:128 lds
    v_mfma_f32_16x16x32_bf16 v[68:71], a[232:235], a[96:99], v[68:71]
    s_addk_i32 m0, 896
    ds_read_b64_tr_b16 a[232:233], v8 offset:25600
    v_mfma_f32_16x16x32_bf16 v[96:99], a[240:243], a[96:99], v[96:99]
    ds_read_b64_tr_b16 a[234:235], v8 offset:31744
    v_mfma_f32_16x16x32_bf16 v[96:99], a[244:247], a[112:115], v[96:99]
    ds_read_b64_tr_b16 a[236:237], v8 offset:37888
    v_mfma_f32_16x16x32_bf16 v[104:107], a[244:247], a[116:119], v[104:107]
    ds_read_b64_tr_b16 a[238:239], v8 offset:44032
    v_mfma_f32_16x16x32_bf16 v[104:107], a[240:243], a[100:103], v[104:107]
    v_mfma_f32_16x16x32_bf16 v[112:115], a[240:243], a[104:107], v[112:115]
    buffer_load_dwordx4 v3, s[8:11], s36 offen offset:256 lds
    v_mfma_f32_16x16x32_bf16 v[112:115], a[244:247], a[120:123], v[112:115]
    s_waitcnt lgkmcnt(4)
    s_add_u32 s36, s36, s37
    s_sub_u32 s55, s36, 7864320
    v_mfma_f32_16x16x32_bf16 v[120:123], a[244:247], a[124:127], v[120:123]
    s_min_u32 s36, s36, s55
    s_add_u32 s46, s45, 16384
    s_sub_u32 s77, s46, 81920
    v_mfma_f32_16x16x32_bf16 v[120:123], a[240:243], a[108:111], v[120:123]
    s_min_u32 s46, s46, s77
    ds_read_b64_tr_b16 a[240:241], v9 offset:25600
    s_xor_b32 s77, s46, 1024
    v_mfma_f32_16x16x32_bf16 v[124:127], a[224:227], a[108:111], v[124:127]
    ds_read_b64_tr_b16 a[242:243], v9 offset:31744
    v_mfma_f32_16x16x32_bf16 v[124:127], a[228:231], a[124:127], v[124:127]
    ds_read_b64_tr_b16 a[244:245], v9 offset:37888
    v_mfma_f32_16x16x32_bf16 v[116:119], a[228:231], a[120:123], v[116:119]
    buffer_load_dwordx4 a[128:131], v14, s[20:23], s46 offen sc1
    v_mfma_f32_16x16x32_bf16 v[116:119], a[224:227], a[104:107], v[116:119]
    ds_read_b64_tr_b16 a[246:247], v9 offset:44032
    v_mfma_f32_16x16x32_bf16 v[108:111], a[224:227], a[100:103], v[108:111]
    v_mfma_f32_16x16x32_bf16 v[108:111], a[228:231], a[116:119], v[108:111]
    s_waitcnt lgkmcnt(4)
    v_mfma_f32_16x16x32_bf16 v[100:103], a[228:231], a[112:115], v[100:103]
    v_mfma_f32_16x16x32_bf16 v[100:103], a[224:227], a[96:99], v[100:103]
    ds_read_b64_tr_b16 a[224:225], v10 offset:25600
    v_mfma_f32_16x16x32_bf16 v[128:131], a[232:235], a[96:99], v[128:131]
    buffer_load_dwordx4 a[132:135], v14, s[20:23], s77 offen sc1
    v_mfma_f32_16x16x32_bf16 v[128:131], a[236:239], a[112:115], v[128:131]
    ds_read_b64_tr_b16 a[226:227], v10 offset:31744
    v_mfma_f32_16x16x32_bf16 v[136:139], a[236:239], a[116:119], v[136:139]
    ds_read_b64_tr_b16 a[228:229], v10 offset:37888
    v_mfma_f32_16x16x32_bf16 v[136:139], a[232:235], a[100:103], v[136:139]
    ds_read_b64_tr_b16 a[230:231], v10 offset:44032
    v_mfma_f32_16x16x32_bf16 v[144:147], a[232:235], a[104:107], v[144:147]
    v_mfma_f32_16x16x32_bf16 v[144:147], a[236:239], a[120:123], v[144:147]
    s_waitcnt lgkmcnt(4)
    v_mfma_f32_16x16x32_bf16 v[152:155], a[236:239], a[124:127], v[152:155]
    buffer_load_dwordx4 a[136:139], v15, s[20:23], s46 offen sc1
    v_mfma_f32_16x16x32_bf16 v[152:155], a[232:235], a[108:111], v[152:155]
    ds_read_b64_tr_b16 a[232:233], v11 offset:25600
    v_mfma_f32_16x16x32_bf16 v[156:159], a[240:243], a[108:111], v[156:159]
    ds_read_b64_tr_b16 a[234:235], v11 offset:31744
    v_mfma_f32_16x16x32_bf16 v[156:159], a[244:247], a[124:127], v[156:159]
    ds_read_b64_tr_b16 a[236:237], v11 offset:37888
    v_mfma_f32_16x16x32_bf16 v[148:151], a[244:247], a[120:123], v[148:151]
    ds_read_b64_tr_b16 a[238:239], v11 offset:44032
    v_mfma_f32_16x16x32_bf16 v[148:151], a[240:243], a[104:107], v[148:151]
    v_mfma_f32_16x16x32_bf16 v[140:143], a[240:243], a[100:103], v[140:143]
    buffer_load_dwordx4 a[140:143], v15, s[20:23], s77 offen sc1
    v_mfma_f32_16x16x32_bf16 v[140:143], a[244:247], a[116:119], v[140:143]
    s_waitcnt lgkmcnt(4)
    s_add_u32 s46, s45, 20480
    s_sub_u32 s77, s46, 81920
    v_mfma_f32_16x16x32_bf16 v[132:135], a[244:247], a[112:115], v[132:135]
    s_min_u32 s46, s46, s77
    s_xor_b32 s77, s46, 1024
    v_mfma_f32_16x16x32_bf16 v[132:135], a[240:243], a[96:99], v[132:135]
    ds_read_b64_tr_b16 a[240:241], v8 offset:26624
    v_mfma_f32_16x16x32_bf16 v[160:163], a[224:227], a[96:99], v[160:163]
    ds_read_b64_tr_b16 a[242:243], v8 offset:32768
    v_mfma_f32_16x16x32_bf16 v[160:163], a[228:231], a[112:115], v[160:163]
    ds_read_b64_tr_b16 a[244:245], v8 offset:38912
    v_mfma_f32_16x16x32_bf16 v[168:171], a[228:231], a[116:119], v[168:171]
    buffer_load_dwordx4 a[144:147], v14, s[20:23], s46 offen sc1
    v_mfma_f32_16x16x32_bf16 v[168:171], a[224:227], a[100:103], v[168:171]
    ds_read_b64_tr_b16 a[246:247], v8 offset:45056
    v_mfma_f32_16x16x32_bf16 v[176:179], a[224:227], a[104:107], v[176:179]
    v_add_u32 v8, 49152, v8
    v_mfma_f32_16x16x32_bf16 v[176:179], a[228:231], a[120:123], v[176:179]
    s_waitcnt lgkmcnt(4)
    v_mfma_f32_16x16x32_bf16 v[184:187], a[228:231], a[124:127], v[184:187]
    v_mfma_f32_16x16x32_bf16 v[184:187], a[224:227], a[108:111], v[184:187]
    ds_read_b64_tr_b16 a[224:225], v9 offset:26624
    v_mfma_f32_16x16x32_bf16 v[188:191], a[232:235], a[108:111], v[188:191]
    buffer_load_dwordx4 a[148:151], v14, s[20:23], s77 offen sc1
    v_mfma_f32_16x16x32_bf16 v[188:191], a[236:239], a[124:127], v[188:191]
    ds_read_b64_tr_b16 a[226:227], v9 offset:32768
    v_mfma_f32_16x16x32_bf16 v[180:183], a[236:239], a[120:123], v[180:183]
    ds_read_b64_tr_b16 a[228:229], v9 offset:38912
    v_mfma_f32_16x16x32_bf16 v[180:183], a[232:235], a[104:107], v[180:183]
    ds_read_b64_tr_b16 a[230:231], v9 offset:45056
    v_mfma_f32_16x16x32_bf16 v[172:175], a[232:235], a[100:103], v[172:175]
    v_add_u32 v9, 49152, v9
    v_mfma_f32_16x16x32_bf16 v[172:175], a[236:239], a[116:119], v[172:175]
    s_waitcnt lgkmcnt(4)
    v_mfma_f32_16x16x32_bf16 v[164:167], a[236:239], a[112:115], v[164:167]
    buffer_load_dwordx4 a[152:155], v15, s[20:23], s46 offen sc1
    v_mfma_f32_16x16x32_bf16 v[164:167], a[232:235], a[96:99], v[164:167]
    ds_read_b64_tr_b16 a[232:233], v10 offset:26624
    v_mfma_f32_16x16x32_bf16 v[192:195], a[240:243], a[96:99], v[192:195]
    ds_read_b64_tr_b16 a[234:235], v10 offset:32768
    v_mfma_f32_16x16x32_bf16 v[192:195], a[244:247], a[112:115], v[192:195]
    ds_read_b64_tr_b16 a[236:237], v10 offset:38912
    v_mfma_f32_16x16x32_bf16 v[200:203], a[244:247], a[116:119], v[200:203]
    ds_read_b64_tr_b16 a[238:239], v10 offset:45056
    v_mfma_f32_16x16x32_bf16 v[200:203], a[240:243], a[100:103], v[200:203]
    v_add_u32 v10, 49152, v10
    v_mfma_f32_16x16x32_bf16 v[208:211], a[240:243], a[104:107], v[208:211]
pg_1:
    s_cbranch_execz pg_5
    buffer_load_dwordx4 a[156:159], v15, s[20:23], s77 offen sc1
    v_mfma_f32_16x16x32_bf16 v[208:211], a[244:247], a[120:123], v[208:211]
    s_waitcnt lgkmcnt(4)
    s_addk_i32 m0, 19712
    v_mfma_f32_16x16x32_bf16 v[216:219], a[244:247], a[124:127], v[216:219]
    v_mfma_f32_16x16x32_bf16 v[216:219], a[240:243], a[108:111], v[216:219]
    ds_read_b64_tr_b16 a[240:241], v11 offset:26624
    ds_read_b64_tr_b16 a[242:243], v11 offset:32768
    ds_read_b64_tr_b16 a[244:245], v11 offset:38912
    v_mfma_f32_16x16x32_bf16 v[220:223], a[224:227], a[108:111], v[220:223]
    ds_read_b64_tr_b16 a[246:247], v11 offset:45056
    v_mfma_f32_16x16x32_bf16 v[220:223], a[228:231], a[124:127], v[220:223]
    v_add_u32 v11, 49152, v11
    v_mfma_f32_16x16x32_bf16 v[212:215], a[228:231], a[120:123], v[212:215]
    buffer_load_dwordx4 v2, s[8:11], s36 offen offset:0 lds
    v_mfma_f32_16x16x32_bf16 v[212:215], a[224:227], a[104:107], v[212:215]
    s_addk_i32 m0, 896
    v_mfma_f32_16x16x32_bf16 v[204:207], a[224:227], a[100:103], v[204:207]
    v_mfma_f32_16x16x32_bf16 v[204:207], a[228:231], a[116:119], v[204:207]
    s_waitcnt lgkmcnt(4)
    v_mfma_f32_16x16x32_bf16 v[196:199], a[228:231], a[112:115], v[196:199]
    s_waitcnt lgkmcnt(0)
    s_barrier
    v_mfma_f32_16x16x32_bf16 v[196:199], a[224:227], a[96:99], v[196:199]
    ds_read_b64_tr_b16 a[224:225], v8 offset:0
    v_mfma_f32_16x16x32_bf16 v[224:227], a[232:235], a[96:99], v[224:227]
    buffer_load_dwordx4 v2, s[8:11], s36 offen offset:128 lds
    v_mfma_f32_16x16x32_bf16 v[224:227], a[236:239], a[112:115], v[224:227]
    s_addk_i32 m0, 896
    ds_read_b64_tr_b16 a[226:227], v8 offset:6144
    v_mfma_f32_16x16x32_bf16 v[232:235], a[236:239], a[116:119], v[232:235]
    ds_read_b64_tr_b16 a[228:229], v8 offset:12288
    v_mfma_f32_16x16x32_bf16 v[232:235], a[232:235], a[100:103], v[232:235]
    ds_read_b64_tr_b16 a[230:231], v8 offset:18432
    v_mfma_f32_16x16x32_bf16 v[240:243], a[232:235], a[104:107], v[240:243]
    v_mfma_f32_16x16x32_bf16 v[240:243], a[236:239], a[120:123], v[240:243]
    v_mfma_f32_16x16x32_bf16 v[248:251], a[236:239], a[124:127], v[248:251]
    buffer_load_dwordx4 v2, s[8:11], s36 offen offset:256 lds
    v_mfma_f32_16x16x32_bf16 v[248:251], a[232:235], a[108:111], v[248:251]
    s_addk_i32 m0, 1280
    ds_read_b64_tr_b16 a[232:233], v9 offset:0
    v_mfma_f32_16x16x32_bf16 v[252:255], a[240:243], a[108:111], v[252:255]
    ds_read_b64_tr_b16 a[234:235], v9 offset:6144
    v_mfma_f32_16x16x32_bf16 v[252:255], a[244:247], a[124:127], v[252:255]
    ds_read_b64_tr_b16 a[236:237], v9 offset:12288
    v_mfma_f32_16x16x32_bf16 v[244:247], a[244:247], a[120:123], v[244:247]
    ds_read_b64_tr_b16 a[238:239], v9 offset:18432
    v_mfma_f32_16x16x32_bf16 v[244:247], a[240:243], a[104:107], v[244:247]
    v_mfma_f32_16x16x32_bf16 v[236:239], a[240:243], a[100:103], v[236:239]
    buffer_load_dwordx4 v3, s[8:11], s36 offen offset:0 lds
    v_mfma_f32_16x16x32_bf16 v[236:239], a[244:247], a[116:119], v[236:239]
    s_waitcnt vmcnt(11) lgkmcnt(4)
    s_addk_i32 m0, 896
    v_mfma_f32_16x16x32_bf16 v[228:231], a[244:247], a[112:115], v[228:231]
    s_waitcnt vmcnt(7)
    v_and_b32 v22, 1, v1
    v_mfma_f32_16x16x32_bf16 v[228:231], a[240:243], a[96:99], v[228:231]
    s_waitcnt vmcnt(6)
    ds_read_b64_tr_b16 a[240:241], v10 offset:0
    s_sub_u32 s56, s5, s4
    v_mfma_f32_16x16x32_bf16 v[64:67], a[224:227], a[128:131], v[64:67]
    s_sub_u32 s56, s56, 128
    ds_read_b64_tr_b16 a[242:243], v10 offset:6144
    v_mul_lo_u32 v22, v22, s56
    v_mfma_f32_16x16x32_bf16 v[64:67], a[228:231], a[144:147], v[64:67]
    buffer_load_dword a252, v22, s[24:27], s4 offen offset:128 sc1
    v_mfma_f32_16x16x32_bf16 v[72:75], a[228:231], a[148:151], v[72:75]
    buffer_load_dwordx4 v3, s[8:11], s36 offen offset:128 lds
    v_mfma_f32_16x16x32_bf16 v[72:75], a[224:227], a[132:135], v[72:75]
    s_waitcnt vmcnt(6)
    ds_read_b64_tr_b16 a[244:245], v10 offset:12288
    s_addk_i32 m0, 896
    v_mfma_f32_16x16x32_bf16 v[80:83], a[224:227], a[136:139], v[80:83]
    ds_read_b64_tr_b16 a[246:247], v10 offset:18432
    v_mfma_f32_16x16x32_bf16 v[80:83], a[228:231], a[152:155], v[80:83]
    s_waitcnt lgkmcnt(4)
    v_mfma_f32_16x16x32_bf16 v[88:91], a[228:231], a[156:159], v[88:91]
    v_mfma_f32_16x16x32_bf16 v[88:91], a[224:227], a[140:143], v[88:91]
    ds_read_b64_tr_b16 a[224:225], v11 offset:0
    v_mfma_f32_16x16x32_bf16 v[92:95], a[232:235], a[140:143], v[92:95]
    buffer_load_dwordx4 v3, s[8:11], s36 offen offset:256 lds
    v_mfma_f32_16x16x32_bf16 v[92:95], a[236:239], a[156:159], v[92:95]
    s_add_u32 s36, s36, s37
    ds_read_b64_tr_b16 a[226:227], v11 offset:6144
    s_sub_u32 s55, s36, 7864320
    v_mfma_f32_16x16x32_bf16 v[84:87], a[236:239], a[152:155], v[84:87]
    s_min_u32 s36, s36, s55
    ds_read_b64_tr_b16 a[228:229], v11 offset:12288
    s_add_u32 s46, s45, 24576
    v_mfma_f32_16x16x32_bf16 v[84:87], a[232:235], a[136:139], v[84:87]
    s_sub_u32 s77, s46, 81920
    ds_read_b64_tr_b16 a[230:231], v11 offset:18432
    s_min_u32 s46, s46, s77
    v_mfma_f32_16x16x32_bf16 v[76:79], a[232:235], a[132:135], v[76:79]
    s_xor_b32 s77, s46, 1024
    v_mfma_f32_16x16x32_bf16 v[76:79], a[236:239], a[148:151], v[76:79]
    s_waitcnt lgkmcnt(4)
    v_mfma_f32_16x16x32_bf16 v[68:71], a[236:239], a[144:147], v[68:71]
    buffer_load_dwordx4 a[192:195], v14, s[20:23], s46 offen sc1
    v_mfma_f32_16x16x32_bf16 v[68:71], a[232:235], a[128:131], v[68:71]
    ds_read_b64_tr_b16 a[232:233], v8 offset:1024
    v_mfma_f32_16x16x32_bf16 v[96:99], a[240:243], a[128:131], v[96:99]
    ds_read_b64_tr_b16 a[234:235], v8 offset:7168
    v_mfma_f32_16x16x32_bf16 v[96:99], a[244:247], a[144:147], v[96:99]
    ds_read_b64_tr_b16 a[236:237], v8 offset:13312
    v_mfma_f32_16x16x32_bf16 v[104:107], a[244:247], a[148:151], v[104:107]
    ds_read_b64_tr_b16 a[238:239], v8 offset:19456
    v_mfma_f32_16x16x32_bf16 v[104:107], a[240:243], a[132:135], v[104:107]
    v_mfma_f32_16x16x32_bf16 v[112:115], a[240:243], a[136:139], v[112:115]
    buffer_load_dwordx4 a[196:199], v14, s[20:23], s77 offen sc1
    v_mfma_f32_16x16x32_bf16 v[112:115], a[244:247], a[152:155], v[112:115]
    s_waitcnt lgkmcnt(4)
    v_mfma_f32_16x16x32_bf16 v[120:123], a[244:247], a[156:159], v[120:123]
    v_mfma_f32_16x16x32_bf16 v[120:123], a[240:243], a[140:143], v[120:123]
    ds_read_b64_tr_b16 a[240:241], v9 offset:1024
    v_mfma_f32_16x16x32_bf16 v[124:127], a[224:227], a[140:143], v[124:127]
    ds_read_b64_tr_b16 a[242:243], v9 offset:7168
    v_mfma_f32_16x16x32_bf16 v[124:127], a[228:231], a[156:159], v[124:127]
    ds_read_b64_tr_b16 a[244:245], v9 offset:13312
    v_mfma_f32_16x16x32_bf16 v[116:119], a[228:231], a[152:155], v[116:119]
    buffer_load_dwordx4 a[200:203], v15, s[20:23], s46 offen sc1
    v_mfma_f32_16x16x32_bf16 v[116:119], a[224:227], a[136:139], v[116:119]
    ds_read_b64_tr_b16 a[246:247], v9 offset:19456
    v_mfma_f32_16x16x32_bf16 v[108:111], a[224:227], a[132:135], v[108:111]
    v_mfma_f32_16x16x32_bf16 v[108:111], a[228:231], a[148:151], v[108:111]
    s_waitcnt lgkmcnt(4)
    v_mfma_f32_16x16x32_bf16 v[100:103], a[228:231], a[144:147], v[100:103]
    v_mfma_f32_16x16x32_bf16 v[100:103], a[224:227], a[128:131], v[100:103]
    ds_read_b64_tr_b16 a[224:225], v10 offset:1024
    v_mfma_f32_16x16x32_bf16 v[128:131], a[232:235], a[128:131], v[128:131]
    buffer_load_dwordx4 a[204:207], v15, s[20:23], s77 offen sc1
    v_mfma_f32_16x16x32_bf16 v[128:131], a[236:239], a[144:147], v[128:131]
    s_add_u32 s46, s45, 28672
    ds_read_b64_tr_b16 a[226:227], v10 offset:7168
    s_sub_u32 s77, s46, 81920
    v_mfma_f32_16x16x32_bf16 v[136:139], a[236:239], a[148:151], v[136:139]
    s_min_u32 s46, s46, s77
    ds_read_b64_tr_b16 a[228:229], v10 offset:13312
    s_xor_b32 s77, s46, 1024
    v_mfma_f32_16x16x32_bf16 v[136:139], a[232:235], a[132:135], v[136:139]
    ds_read_b64_tr_b16 a[230:231], v10 offset:19456
    v_mfma_f32_16x16x32_bf16 v[144:147], a[232:235], a[136:139], v[144:147]
    v_mfma_f32_16x16x32_bf16 v[144:147], a[236:239], a[152:155], v[144:147]
    s_waitcnt lgkmcnt(4)
    v_mfma_f32_16x16x32_bf16 v[152:155], a[236:239], a[156:159], v[152:155]
    buffer_load_dwordx4 v[32:35], v17, s[24:27], s47 offen offset:0 sc1
    v_mfma_f32_16x16x32_bf16 v[152:155], a[232:235], a[140:143], v[152:155]
    buffer_load_dwordx4 a[208:211], v14, s[20:23], s46 offen sc1
    v_mfma_f32_16x16x32_bf16 v[156:159], a[240:243], a[140:143], v[156:159]
    ds_read_b64_tr_b16 a[232:233], v11 offset:1024
    v_mfma_f32_16x16x32_bf16 v[156:159], a[244:247], a[156:159], v[156:159]
    ds_read_b64_tr_b16 a[234:235], v11 offset:7168
    v_mfma_f32_16x16x32_bf16 v[148:151], a[244:247], a[152:155], v[148:151]
    ds_read_b64_tr_b16 a[236:237], v11 offset:13312
    v_mfma_f32_16x16x32_bf16 v[148:151], a[240:243], a[136:139], v[148:151]
    ds_read_b64_tr_b16 a[238:239], v11 offset:19456
    v_mfma_f32_16x16x32_bf16 v[140:143], a[240:243], a[132:135], v[140:143]
    buffer_load_dwordx4 a[212:215], v14, s[20:23], s77 offen sc1
    v_mfma_f32_16x16x32_bf16 v[140:143], a[244:247], a[148:151], v[140:143]
    s_waitcnt lgkmcnt(4)
    v_mfma_f32_16x16x32_bf16 v[132:135], a[244:247], a[144:147], v[132:135]
    v_mfma_f32_16x16x32_bf16 v[132:135], a[240:243], a[128:131], v[132:135]
    ds_read_b64_tr_b16 a[240:241], v8 offset:2048
    v_mfma_f32_16x16x32_bf16 v[160:163], a[224:227], a[128:131], v[160:163]
    ds_read_b64_tr_b16 a[242:243], v8 offset:8192
    v_mfma_f32_16x16x32_bf16 v[160:163], a[228:231], a[144:147], v[160:163]
    ds_read_b64_tr_b16 a[244:245], v8 offset:14336
    v_mfma_f32_16x16x32_bf16 v[168:171], a[228:231], a[148:151], v[168:171]
    buffer_load_dwordx4 a[216:219], v15, s[20:23], s46 offen sc1
    v_mfma_f32_16x16x32_bf16 v[168:171], a[224:227], a[132:135], v[168:171]
    ds_read_b64_tr_b16 a[246:247], v8 offset:20480
    v_mfma_f32_16x16x32_bf16 v[176:179], a[224:227], a[136:139], v[176:179]
    buffer_load_dwordx4 v[36:39], v17, s[24:27], s47 offen offset:1024 sc1
    v_mfma_f32_16x16x32_bf16 v[176:179], a[228:231], a[152:155], v[176:179]
    s_waitcnt lgkmcnt(4)
    v_mfma_f32_16x16x32_bf16 v[184:187], a[228:231], a[156:159], v[184:187]
    v_mfma_f32_16x16x32_bf16 v[184:187], a[224:227], a[140:143], v[184:187]
    ds_read_b64_tr_b16 a[224:225], v9 offset:2048
    v_mfma_f32_16x16x32_bf16 v[188:191], a[232:235], a[140:143], v[188:191]
    buffer_load_dwordx4 a[220:223], v15, s[20:23], s77 offen sc1
    v_mfma_f32_16x16x32_bf16 v[188:191], a[236:239], a[156:159], v[188:191]
    s_addk_i32 m0, 19712
    ds_read_b64_tr_b16 a[226:227], v9 offset:8192
    v_mfma_f32_16x16x32_bf16 v[180:183], a[236:239], a[152:155], v[180:183]
    ds_read_b64_tr_b16 a[228:229], v9 offset:14336
    v_mfma_f32_16x16x32_bf16 v[180:183], a[232:235], a[136:139], v[180:183]
    ds_read_b64_tr_b16 a[230:231], v9 offset:20480
    v_mfma_f32_16x16x32_bf16 v[172:175], a[232:235], a[132:135], v[172:175]
    v_mfma_f32_16x16x32_bf16 v[172:175], a[236:239], a[148:151], v[172:175]
    s_waitcnt lgkmcnt(4)
    v_mfma_f32_16x16x32_bf16 v[164:167], a[236:239], a[144:147], v[164:167]
    buffer_load_dwordx4 v2, s[8:11], s36 offen offset:0 lds
    v_mfma_f32_16x16x32_bf16 v[164:167], a[232:235], a[128:131], v[164:167]
    s_addk_i32 m0, 896
    ds_read_b64_tr_b16 a[232:233], v10 offset:2048
    v_mfma_f32_16x16x32_bf16 v[192:195], a[240:243], a[128:131], v[192:195]
    ds_read_b64_tr_b16 a[234:235], v10 offset:8192
    v_mfma_f32_16x16x32_bf16 v[192:195], a[244:247], a[144:147], v[192:195]
    ds_read_b64_tr_b16 a[236:237], v10 offset:14336
    v_mfma_f32_16x16x32_bf16 v[200:203], a[244:247], a[148:151], v[200:203]
    buffer_load_dwordx4 v[40:43], v17, s[24:27], s47 offen offset:2048 sc1
    v_mfma_f32_16x16x32_bf16 v[200:203], a[240:243], a[132:135], v[200:203]
    ds_read_b64_tr_b16 a[238:239], v10 offset:20480
    v_mfma_f32_16x16x32_bf16 v[208:211], a[240:243], a[136:139], v[208:211]
    buffer_load_dwordx4 v2, s[8:11], s36 offen offset:128 lds
    v_mfma_f32_16x16x32_bf16 v[208:211], a[244:247], a[152:155], v[208:211]
    s_waitcnt lgkmcnt(4)
    s_addk_i32 m0, 896
    v_mfma_f32_16x16x32_bf16 v[216:219], a[244:247], a[156:159], v[216:219]
    v_mfma_f32_16x16x32_bf16 v[216:219], a[240:243], a[140:143], v[216:219]
    ds_read_b64_tr_b16 a[240:241], v11 offset:2048
    ds_read_b64_tr_b16 a[242:243], v11 offset:8192
    ds_read_b64_tr_b16 a[244:245], v11 offset:14336
    v_mfma_f32_16x16x32_bf16 v[220:223], a[224:227], a[140:143], v[220:223]
    ds_read_b64_tr_b16 a[246:247], v11 offset:20480
    v_mfma_f32_16x16x32_bf16 v[220:223], a[228:231], a[156:159], v[220:223]
    v_mfma_f32_16x16x32_bf16 v[212:215], a[228:231], a[152:155], v[212:215]
    buffer_load_dwordx4 v2, s[8:11], s36 offen offset:256 lds
    v_mfma_f32_16x16x32_bf16 v[212:215], a[224:227], a[136:139], v[212:215]
    s_addk_i32 m0, 1280
    v_mfma_f32_16x16x32_bf16 v[204:207], a[224:227], a[132:135], v[204:207]
    v_mfma_f32_16x16x32_bf16 v[204:207], a[228:231], a[148:151], v[204:207]
    s_waitcnt lgkmcnt(4)
    v_mfma_f32_16x16x32_bf16 v[196:199], a[228:231], a[144:147], v[196:199]
    s_waitcnt lgkmcnt(0)
    s_barrier
    v_mfma_f32_16x16x32_bf16 v[196:199], a[224:227], a[128:131], v[196:199]
    ds_read_b64_tr_b16 a[224:225], v8 offset:24576
    v_mfma_f32_16x16x32_bf16 v[224:227], a[232:235], a[128:131], v[224:227]
    buffer_load_dwordx4 v[44:47], v17, s[24:27], s47 offen offset:3072 sc1
    v_mfma_f32_16x16x32_bf16 v[224:227], a[236:239], a[144:147], v[224:227]
    buffer_load_dwordx4 v3, s[8:11], s36 offen offset:0 lds
    v_mfma_f32_16x16x32_bf16 v[232:235], a[236:239], a[148:151], v[232:235]
    s_addk_i32 m0, 896
    ds_read_b64_tr_b16 a[226:227], v8 offset:30720
    v_mfma_f32_16x16x32_bf16 v[232:235], a[232:235], a[132:135], v[232:235]
    ds_read_b64_tr_b16 a[228:229], v8 offset:36864
    v_mfma_f32_16x16x32_bf16 v[240:243], a[232:235], a[136:139], v[240:243]
    ds_read_b64_tr_b16 a[230:231], v8 offset:43008
    v_mfma_f32_16x16x32_bf16 v[240:243], a[236:239], a[152:155], v[240:243]
    v_mfma_f32_16x16x32_bf16 v[248:251], a[236:239], a[156:159], v[248:251]
    buffer_load_dwordx4 v3, s[8:11], s36 offen offset:128 lds
    v_mfma_f32_16x16x32_bf16 v[248:251], a[232:235], a[140:143], v[248:251]
    s_addk_i32 m0, 896
    ds_read_b64_tr_b16 a[232:233], v9 offset:24576
    v_mfma_f32_16x16x32_bf16 v[252:255], a[240:243], a[140:143], v[252:255]
    ds_read_b64_tr_b16 a[234:235], v9 offset:30720
    v_mfma_f32_16x16x32_bf16 v[252:255], a[244:247], a[156:159], v[252:255]
    ds_read_b64_tr_b16 a[236:237], v9 offset:36864
    v_mfma_f32_16x16x32_bf16 v[244:247], a[244:247], a[152:155], v[244:247]
    ds_read_b64_tr_b16 a[238:239], v9 offset:43008
    v_mfma_f32_16x16x32_bf16 v[244:247], a[240:243], a[136:139], v[244:247]
    v_mfma_f32_16x16x32_bf16 v[236:239], a[240:243], a[132:135], v[236:239]
    buffer_load_dwordx4 v3, s[8:11], s36 offen offset:256 lds
    v_mfma_f32_16x16x32_bf16 v[236:239], a[244:247], a[148:151], v[236:239]
    s_waitcnt vmcnt(17) lgkmcnt(4)
    s_add_u32 s36, s36, s37
    s_sub_u32 s55, s36, 7864320
    v_mfma_f32_16x16x32_bf16 v[228:231], a[244:247], a[144:147], v[228:231]
    s_waitcnt vmcnt(12)
    s_min_u32 s36, s36, s55
    s_add_u32 s46, s45, 32768
    v_mfma_f32_16x16x32_bf16 v[228:231], a[240:243], a[128:131], v[228:231]
    s_waitcnt vmcnt(11)
    ds_read_b64_tr_b16 a[240:241], v10 offset:24576
    s_sub_u32 s77, s46, 81920
    v_mfma_f32_16x16x32_bf16 v[64:67], a[224:227], a[192:195], v[64:67]
    s_min_u32 s46, s46, s77
    ds_read_b64_tr_b16 a[242:243], v10 offset:30720
    s_xor_b32 s77, s46, 1024
    v_mfma_f32_16x16x32_bf16 v[64:67], a[228:231], a[208:211], v[64:67]
    ds_read_b64_tr_b16 a[244:245], v10 offset:36864
    v_mfma_f32_16x16x32_bf16 v[72:75], a[228:231], a[212:215], v[72:75]
    buffer_load_dwordx4 a[0:3], v14, s[20:23], s46 offen sc1
    v_mfma_f32_16x16x32_bf16 v[72:75], a[224:227], a[196:199], v[72:75]
    s_waitcnt vmcnt(9)
    ds_read_b64_tr_b16 a[246:247], v10 offset:43008
    v_mfma_f32_16x16x32_bf16 v[80:83], a[224:227], a[200:203], v[80:83]
    v_mfma_f32_16x16x32_bf16 v[80:83], a[228:231], a[216:219], v[80:83]
    s_waitcnt lgkmcnt(4)
    v_mfma_f32_16x16x32_bf16 v[88:91], a[228:231], a[220:223], v[88:91]
    v_mfma_f32_16x16x32_bf16 v[88:91], a[224:227], a[204:207], v[88:91]
    ds_read_b64_tr_b16 a[224:225], v11 offset:24576
    v_mfma_f32_16x16x32_bf16 v[92:95], a[232:235], a[204:207], v[92:95]
    buffer_load_dwordx4 a[4:7], v14, s[20:23], s77 offen sc1
    v_mfma_f32_16x16x32_bf16 v[92:95], a[236:239], a[220:223], v[92:95]
    ds_read_b64_tr_b16 a[226:227], v11 offset:30720
    v_mfma_f32_16x16x32_bf16 v[84:87], a[236:239], a[216:219], v[84:87]
    ds_read_b64_tr_b16 a[228:229], v11 offset:36864
    v_mfma_f32_16x16x32_bf16 v[84:87], a[232:235], a[200:203], v[84:87]
    ds_read_b64_tr_b16 a[230:231], v11 offset:43008
    v_mfma_f32_16x16x32_bf16 v[76:79], a[232:235], a[196:199], v[76:79]
    v_mfma_f32_16x16x32_bf16 v[76:79], a[236:239], a[212:215], v[76:79]
    s_waitcnt lgkmcnt(4)
    v_mfma_f32_16x16x32_bf16 v[68:71], a[236:239], a[208:211], v[68:71]
    buffer_load_dwordx4 a[8:11], v15, s[20:23], s46 offen sc1
    v_mfma_f32_16x16x32_bf16 v[68:71], a[232:235], a[192:195], v[68:71]
    ds_read_b64_tr_b16 a[232:233], v8 offset:25600
    v_mfma_f32_16x16x32_bf16 v[96:99], a[240:243], a[192:195], v[96:99]
    ds_read_b64_tr_b16 a[234:235], v8 offset:31744
    v_mfma_f32_16x16x32_bf16 v[96:99], a[244:247], a[208:211], v[96:99]
    ds_read_b64_tr_b16 a[236:237], v8 offset:37888
    v_mfma_f32_16x16x32_bf16 v[104:107], a[244:247], a[212:215], v[104:107]
    ds_read_b64_tr_b16 a[238:239], v8 offset:44032
    v_mfma_f32_16x16x32_bf16 v[104:107], a[240:243], a[196:199], v[104:107]
    v_mfma_f32_16x16x32_bf16 v[112:115], a[240:243], a[200:203], v[112:115]
    buffer_load_dwordx4 a[12:15], v15, s[20:23], s77 offen sc1
    v_mfma_f32_16x16x32_bf16 v[112:115], a[244:247], a[216:219], v[112:115]
    s_waitcnt lgkmcnt(4)
    s_add_u32 s46, s45, 36864
    s_sub_u32 s77, s46, 81920
    v_mfma_f32_16x16x32_bf16 v[120:123], a[244:247], a[220:223], v[120:123]
    s_min_u32 s46, s46, s77
    s_xor_b32 s77, s46, 1024
    v_mfma_f32_16x16x32_bf16 v[120:123], a[240:243], a[204:207], v[120:123]
    ds_read_b64_tr_b16 a[240:241], v9 offset:25600
    v_mfma_f32_16x16x32_bf16 v[124:127], a[224:227], a[204:207], v[124:127]
    ds_read_b64_tr_b16 a[242:243], v9 offset:31744
    v_mfma_f32_16x16x32_bf16 v[124:127], a[228:231], a[220:223], v[124:127]
    ds_read_b64_tr_b16 a[244:245], v9 offset:37888
    v_mfma_f32_16x16x32_bf16 v[116:119], a[228:231], a[216:219], v[116:119]
    buffer_load_dwordx4 a[16:19], v14, s[20:23], s46 offen sc1
    v_mfma_f32_16x16x32_bf16 v[116:119], a[224:227], a[200:203], v[116:119]
    ds_read_b64_tr_b16 a[246:247], v9 offset:44032
    v_mfma_f32_16x16x32_bf16 v[108:111], a[224:227], a[196:199], v[108:111]
    v_mfma_f32_16x16x32_bf16 v[108:111], a[228:231], a[212:215], v[108:111]
    s_waitcnt lgkmcnt(4)
    v_mfma_f32_16x16x32_bf16 v[100:103], a[228:231], a[208:211], v[100:103]
    v_mfma_f32_16x16x32_bf16 v[100:103], a[224:227], a[192:195], v[100:103]
    ds_read_b64_tr_b16 a[224:225], v10 offset:25600
    v_mfma_f32_16x16x32_bf16 v[128:131], a[232:235], a[192:195], v[128:131]
    buffer_load_dwordx4 a[20:23], v14, s[20:23], s77 offen sc1
    v_mfma_f32_16x16x32_bf16 v[128:131], a[236:239], a[208:211], v[128:131]
    ds_read_b64_tr_b16 a[226:227], v10 offset:31744
    v_mfma_f32_16x16x32_bf16 v[136:139], a[236:239], a[212:215], v[136:139]
    ds_read_b64_tr_b16 a[228:229], v10 offset:37888
    v_mfma_f32_16x16x32_bf16 v[136:139], a[232:235], a[196:199], v[136:139]
    ds_read_b64_tr_b16 a[230:231], v10 offset:44032
    v_mfma_f32_16x16x32_bf16 v[144:147], a[232:235], a[200:203], v[144:147]
    v_mfma_f32_16x16x32_bf16 v[144:147], a[236:239], a[216:219], v[144:147]
    s_waitcnt lgkmcnt(4)
    v_mfma_f32_16x16x32_bf16 v[152:155], a[236:239], a[220:223], v[152:155]
    buffer_load_dwordx4 a[24:27], v15, s[20:23], s46 offen sc1
    v_mfma_f32_16x16x32_bf16 v[152:155], a[232:235], a[204:207], v[152:155]
    ds_read_b64_tr_b16 a[232:233], v11 offset:25600
    v_mfma_f32_16x16x32_bf16 v[156:159], a[240:243], a[204:207], v[156:159]
    ds_read_b64_tr_b16 a[234:235], v11 offset:31744
    v_mfma_f32_16x16x32_bf16 v[156:159], a[244:247], a[220:223], v[156:159]
    ds_read_b64_tr_b16 a[236:237], v11 offset:37888
    v_mfma_f32_16x16x32_bf16 v[148:151], a[244:247], a[216:219], v[148:151]
    ds_read_b64_tr_b16 a[238:239], v11 offset:44032
    v_mfma_f32_16x16x32_bf16 v[148:151], a[240:243], a[200:203], v[148:151]
    v_mfma_f32_16x16x32_bf16 v[140:143], a[240:243], a[196:199], v[140:143]
    buffer_load_dwordx4 a[28:31], v15, s[20:23], s77 offen sc1
    v_mfma_f32_16x16x32_bf16 v[140:143], a[244:247], a[212:215], v[140:143]
    s_waitcnt lgkmcnt(4)
    s_addk_i32 m0, 19712
    v_mfma_f32_16x16x32_bf16 v[132:135], a[244:247], a[208:211], v[132:135]
    v_mfma_f32_16x16x32_bf16 v[132:135], a[240:243], a[192:195], v[132:135]
    ds_read_b64_tr_b16 a[240:241], v8 offset:26624
    v_mfma_f32_16x16x32_bf16 v[160:163], a[224:227], a[192:195], v[160:163]
    ds_read_b64_tr_b16 a[242:243], v8 offset:32768
    v_mfma_f32_16x16x32_bf16 v[160:163], a[228:231], a[208:211], v[160:163]
    ds_read_b64_tr_b16 a[244:245], v8 offset:38912
    v_mfma_f32_16x16x32_bf16 v[168:171], a[228:231], a[212:215], v[168:171]
    buffer_load_dwordx4 v2, s[8:11], s36 offen offset:0 lds
    v_mfma_f32_16x16x32_bf16 v[168:171], a[224:227], a[196:199], v[168:171]
    s_addk_i32 m0, 896
    ds_read_b64_tr_b16 a[246:247], v8 offset:45056
    v_mfma_f32_16x16x32_bf16 v[176:179], a[224:227], a[200:203], v[176:179]
    v_subrev_u32 v8, 98304, v8
    v_mfma_f32_16x16x32_bf16 v[176:179], a[228:231], a[216:219], v[176:179]
    s_waitcnt lgkmcnt(4)
    v_mfma_f32_16x16x32_bf16 v[184:187], a[228:231], a[220:223], v[184:187]
    v_mfma_f32_16x16x32_bf16 v[184:187], a[224:227], a[204:207], v[184:187]
    ds_read_b64_tr_b16 a[224:225], v9 offset:26624
    v_mfma_f32_16x16x32_bf16 v[188:191], a[232:235], a[204:207], v[188:191]
    buffer_load_dwordx4 v2, s[8:11], s36 offen offset:128 lds
    v_mfma_f32_16x16x32_bf16 v[188:191], a[236:239], a[220:223], v[188:191]
    s_addk_i32 m0, 896
    ds_read_b64_tr_b16 a[226:227], v9 offset:32768
    v_mfma_f32_16x16x32_bf16 v[180:183], a[236:239], a[216:219], v[180:183]
    ds_read_b64_tr_b16 a[228:229], v9 offset:38912
    v_mfma_f32_16x16x32_bf16 v[180:183], a[232:235], a[200:203], v[180:183]
    ds_read_b64_tr_b16 a[230:231], v9 offset:45056
    v_mfma_f32_16x16x32_bf16 v[172:175], a[232:235], a[196:199], v[172:175]
    v_subrev_u32 v9, 98304, v9
    v_mfma_f32_16x16x32_bf16 v[172:175], a[236:239], a[212:215], v[172:175]
    s_waitcnt lgkmcnt(4)
    v_mfma_f32_16x16x32_bf16 v[164:167], a[236:239], a[208:211], v[164:167]
    buffer_load_dwordx4 v2, s[8:11], s36 offen offset:256 lds
    v_mfma_f32_16x16x32_bf16 v[164:167], a[232:235], a[192:195], v[164:167]
    s_addk_i32 m0, 1280
    ds_read_b64_tr_b16 a[232:233], v10 offset:26624
    v_xor_b32 v34, s7, v34
    v_mfma_f32_16x16x32_bf16 v[192:195], a[240:243], a[192:195], v[192:195]
    s_waitcnt vmcnt(17)
    ds_read_b64_tr_b16 a[234:235], v10 offset:32768
    v_xor_b32 v38, s7, v38
    v_mfma_f32_16x16x32_bf16 v[192:195], a[244:247], a[208:211], v[192:195]
    s_waitcnt vmcnt(14)
    ds_read_b64_tr_b16 a[236:237], v10 offset:38912
    v_xor_b32 v42, s7, v42
    v_mfma_f32_16x16x32_bf16 v[200:203], a[244:247], a[212:215], v[200:203]
    s_lshl_b32 s56, s3, 3
    ds_read_b64_tr_b16 a[238:239], v10 offset:45056
    v_xor_b32 v46, s7, v46
    v_mfma_f32_16x16x32_bf16 v[200:203], a[240:243], a[196:199], v[200:203]
    s_add_u32 s56, s56, 147456
    v_or3_b32 v34, v34, v38, v42
    v_or_b32 v34, v34, v46
    v_mfma_f32_16x16x32_bf16 v[208:211], a[240:243], a[200:203], v[208:211]
    buffer_load_dwordx4 v3, s[8:11], s36 offen offset:0 lds
    v_mfma_f32_16x16x32_bf16 v[208:211], a[244:247], a[216:219], v[208:211]
    s_waitcnt lgkmcnt(4)
    v_cmp_ne_u32 vcc, 0, v34
    s_addk_i32 m0, 896
    v_mfma_f32_16x16x32_bf16 v[216:219], a[244:247], a[220:223], v[216:219]
    s_cbranch_vccnz spin_rec
spin_rec_ret:
    v_max_u32 v20, v32, v33
    v_mfma_f32_16x16x32_bf16 v[216:219], a[240:243], a[204:207], v[216:219]
    ds_read_b64_tr_b16 a[240:241], v11 offset:26624
    v_min_u32 v21, v32, v33
    ds_read_b64_tr_b16 a[242:243], v11 offset:32768
    v_mfma_f32_16x16x32_bf16 v[220:223], a[224:227], a[204:207], v[220:223]
    ds_read_b64_tr_b16 a[244:245], v11 offset:38912
    v_med3_u32 v21, v20, v21, v36
    ds_read_b64_tr_b16 a[246:247], v11 offset:45056
    v_mfma_f32_16x16x32_bf16 v[220:223], a[228:231], a[220:223], v[220:223]
    v_max_u32 v20, v20, v36
    v_med3_u32 v21, v20, v21, v37
    v_mfma_f32_16x16x32_bf16 v[212:215], a[228:231], a[216:219], v[212:215]
    buffer_load_dwordx4 v3, s[8:11], s36 offen offset:128 lds
    v_mfma_f32_16x16x32_bf16 v[212:215], a[224:227], a[200:203], v[212:215]
    s_addk_i32 m0, 896
    v_max_u32 v20, v20, v37
    v_med3_u32 v21, v20, v21, v40
    v_mfma_f32_16x16x32_bf16 v[204:207], a[224:227], a[196:199], v[204:207]
    v_max_u32 v20, v20, v40
    v_med3_u32 v21, v20, v21, v41
    v_mfma_f32_16x16x32_bf16 v[204:207], a[228:231], a[212:215], v[204:207]
    s_waitcnt lgkmcnt(4)
    v_max_u32 v20, v20, v41
    v_med3_u32 v21, v20, v21, v44
    v_mfma_f32_16x16x32_bf16 v[196:199], a[228:231], a[208:211], v[196:199]
    s_waitcnt lgkmcnt(0)
    s_barrier
    v_mfma_f32_16x16x32_bf16 v[196:199], a[224:227], a[192:195], v[196:199]
    ds_read_b64_tr_b16 a[224:225], v8 offset:0
    v_max_u32 v20, v20, v44
    v_mfma_f32_16x16x32_bf16 v[224:227], a[232:235], a[192:195], v[224:227]
    buffer_load_dwordx4 v3, s[8:11], s36 offen offset:256 lds
    v_mfma_f32_16x16x32_bf16 v[224:227], a[236:239], a[208:211], v[224:227]
    s_add_u32 s36, s36, s37
    ds_read_b64_tr_b16 a[226:227], v8 offset:6144
    v_med3_u32 v21, v20, v21, v45
    v_mfma_f32_16x16x32_bf16 v[232:235], a[236:239], a[212:215], v[232:235]
    s_sub_u32 s55, s36, 7864320
    ds_read_b64_tr_b16 a[228:229], v8 offset:12288
    v_max_u32 v20, v20, v45
    v_mfma_f32_16x16x32_bf16 v[232:235], a[232:235], a[196:199], v[232:235]
    s_min_u32 s36, s36, s55
    ds_read_b64_tr_b16 a[230:231], v8 offset:18432
    v_mov_b32_dpp v22, v20 row_ror:8 row_mask:0xf bank_mask:0xf
    v_mfma_f32_16x16x32_bf16 v[240:243], a[232:235], a[200:203], v[240:243]
    s_add_u32 s46, s45, 40960
    v_mov_b32_dpp v23, v21 row_ror:8 row_mask:0xf bank_mask:0xf
    v_min_u32 v24, v20, v22
    v_mfma_f32_16x16x32_bf16 v[240:243], a[236:239], a[216:219], v[240:243]
    s_sub_u32 s77, s46, 81920
    v_max_u32 v20, v20, v22
    v_max3_u32 v21, v24, v21, v23
    v_mfma_f32_16x16x32_bf16 v[248:251], a[236:239], a[220:223], v[248:251]
    s_min_u32 s46, s46, s77
    v_mov_b32_dpp v22, v20 row_ror:4 row_mask:0xf bank_mask:0xf
    v_mov_b32_dpp v23, v21 row_ror:4 row_mask:0xf bank_mask:0xf
    v_mfma_f32_16x16x32_bf16 v[248:251], a[232:235], a[204:207], v[248:251]
    buffer_load_dwordx4 a[32:35], v14, s[20:23], s46 offen sc1
    v_mfma_f32_16x16x32_bf16 v[252:255], a[240:243], a[204:207], v[252:255]
    s_xor_b32 s77, s46, 1024
    ds_read_b64_tr_b16 a[232:233], v9 offset:0
    v_min_u32 v24, v20, v22
    v_mfma_f32_16x16x32_bf16 v[252:255], a[244:247], a[220:223], v[252:255]
    ds_read_b64_tr_b16 a[234:235], v9 offset:6144
    v_max_u32 v20, v20, v22
    v_mfma_f32_16x16x32_bf16 v[244:247], a[244:247], a[216:219], v[244:247]
    ds_read_b64_tr_b16 a[236:237], v9 offset:12288
    v_max3_u32 v21, v24, v21, v23
    v_mfma_f32_16x16x32_bf16 v[244:247], a[240:243], a[200:203], v[244:247]
    ds_read_b64_tr_b16 a[238:239], v9 offset:18432
    v_mov_b32_dpp v22, v20 row_ror:2 row_mask:0xf bank_mask:0xf
    v_mfma_f32_16x16x32_bf16 v[236:239], a[240:243], a[196:199], v[236:239]
    buffer_load_dwordx4 a[36:39], v14, s[20:23], s77 offen sc1
    v_mfma_f32_16x16x32_bf16 v[236:239], a[244:247], a[212:215], v[236:239]
    s_waitcnt vmcnt(15) lgkmcnt(4)
    v_mov_b32_dpp v23, v21 row_ror:2 row_mask:0xf bank_mask:0xf
    v_min_u32 v24, v20, v22
    v_mfma_f32_16x16x32_bf16 v[228:231], a[244:247], a[208:211], v[228:231]
    s_waitcnt vmcnt(11)
    v_max_u32 v20, v20, v22
    v_max3_u32 v21, v24, v21, v23
    v_mfma_f32_16x16x32_bf16 v[228:231], a[240:243], a[192:195], v[228:231]
    s_waitcnt vmcnt(10)
    v_mov_b32_dpp v22, v20 row_ror:1 row_mask:0xf bank_mask:0xf
    v_mov_b32_dpp v23, v21 row_ror:1 row_mask:0xf bank_mask:0xf
    v_mfma_f32_16x16x32_bf16 v[64:67], a[224:227], a[0:3], v[64:67]
    v_min_u32 v24, v20, v22
    v_max_u32 v20, v20, v22
    v_mfma_f32_16x16x32_bf16 v[64:67], a[228:231], a[16:19], v[64:67]
    v_max3_u32 v21, v24, v21, v23
    v_mov_b32 v22, v20
    v_mfma_f32_16x16x32_bf16 v[72:75], a[228:231], a[20:23], v[72:75]
    buffer_load_dwordx4 a[40:43], v15, s[20:23], s46 offen sc1
    v_mfma_f32_16x16x32_bf16 v[72:75], a[224:227], a[4:7], v[72:75]
    s_waitcnt vmcnt(9)
    v_permlane16_swap_b32 v20, v22
    v_mfma_f32_16x16x32_bf16 v[80:83], a[224:227], a[8:11], v[80:83]
    v_mov_b32 v23, v21
    v_min_u32 v24, v20, v22
    v_mfma_f32_16x16x32_bf16 v[80:83], a[228:231], a[24:27], v[80:83]
    s_waitcnt lgkmcnt(0)
    v_permlane16_swap_b32 v21, v23
    v_mfma_f32_16x16x32_bf16 v[88:91], a[228:231], a[28:31], v[88:91]
    v_max_u32 v20, v20, v22
    v_max3_u32 v21, v24, v21, v23
    v_subrev_u32 v10, 98304, v10
    v_mfma_f32_16x16x32_bf16 v[88:91], a[224:227], a[12:15], v[88:91]
    ds_read_b64_tr_b16 a[240:241], v10 offset:0
    v_mov_b32 v22, v20
    v_mfma_f32_16x16x32_bf16 v[92:95], a[232:235], a[12:15], v[92:95]
    s_add_u32 s46, s45, 45056
    ds_read_b64_tr_b16 a[242:243], v10 offset:6144
    v_mov_b32 v23, v21
    v_mfma_f32_16x16x32_bf16 v[92:95], a[236:239], a[28:31], v[92:95]
    ds_read_b64_tr_b16 a[244:245], v10 offset:12288
    v_subrev_u32 v11, 98304, v11
    v_mfma_f32_16x16x32_bf16 v[84:87], a[236:239], a[24:27], v[84:87]
    ds_read_b64_tr_b16 a[246:247], v10 offset:18432
    v_mfma_f32_16x16x32_bf16 v[84:87], a[232:235], a[8:11], v[84:87]
    buffer_load_dwordx4 a[44:47], v15, s[20:23], s77 offen sc1
    v_mfma_f32_16x16x32_bf16 v[76:79], a[232:235], a[4:7], v[76:79]
    s_sub_u32 s77, s46, 81920
    ds_read_b64_tr_b16 a[224:225], v11 offset:0
    s_min_u32 s46, s46, s77
    v_mfma_f32_16x16x32_bf16 v[76:79], a[236:239], a[20:23], v[76:79]
    s_xor_b32 s77, s46, 1024
    ds_read_b64_tr_b16 a[226:227], v11 offset:6144
    v_mfma_f32_16x16x32_bf16 v[68:71], a[236:239], a[16:19], v[68:71]
    buffer_load_dwordx4 a[48:51], v14, s[20:23], s46 offen sc1
    v_mfma_f32_16x16x32_bf16 v[68:71], a[232:235], a[0:3], v[68:71]
    s_waitcnt lgkmcnt(4)
    ds_read_b64_tr_b16 a[228:229], v11 offset:12288
    v_mfma_f32_16x16x32_bf16 v[96:99], a[240:243], a[0:3], v[96:99]
    s_waitcnt lgkmcnt(3)
    ds_read_b64_tr_b16 a[230:231], v11 offset:18432
    v_mfma_f32_16x16x32_bf16 v[96:99], a[244:247], a[16:19], v[96:99]
    ds_read_b64_tr_b16 a[232:233], v8 offset:1024
    v_mfma_f32_16x16x32_bf16 v[104:107], a[244:247], a[20:23], v[104:107]
    ds_read_b64_tr_b16 a[234:235], v8 offset:7168
    v_mfma_f32_16x16x32_bf16 v[104:107], a[240:243], a[4:7], v[104:107]
    ds_read_b64_tr_b16 a[236:237], v8 offset:13312
    v_mfma_f32_16x16x32_bf16 v[112:115], a[240:243], a[8:11], v[112:115]
    buffer_load_dwordx4 a[52:55], v14, s[20:23], s77 offen sc1
    v_mfma_f32_16x16x32_bf16 v[112:115], a[244:247], a[24:27], v[112:115]
    s_waitcnt lgkmcnt(5)
    ds_read_b64_tr_b16 a[238:239], v8 offset:19456
    v_mfma_f32_16x16x32_bf16 v[120:123], a[244:247], a[28:31], v[120:123]
pg_2:
    s_cbranch_execz pg_6
    v_permlane32_swap_b32 v20, v22
    v_mfma_f32_16x16x32_bf16 v[120:123], a[240:243], a[12:15], v[120:123]
    s_waitcnt lgkmcnt(4)
    ds_read_b64_tr_b16 a[240:241], v9 offset:1024
    v_min_u32 v24, v20, v22
    v_mfma_f32_16x16x32_bf16 v[124:127], a[224:227], a[12:15], v[124:127]
    ds_read_b64_tr_b16 a[242:243], v9 offset:7168
    v_max_u32 v20, v20, v22
    v_mfma_f32_16x16x32_bf16 v[124:127], a[228:231], a[28:31], v[124:127]
    ds_read_b64_tr_b16 a[244:245], v9 offset:13312
    v_mov_b32 v22, s56
    v_mfma_f32_16x16x32_bf16 v[116:119], a[228:231], a[24:27], v[116:119]
    buffer_load_dwordx4 a[56:59], v15, s[20:23], s46 offen sc1
    v_mfma_f32_16x16x32_bf16 v[116:119], a[224:227], a[8:11], v[116:119]
    ds_read_b64_tr_b16 a[246:247], v9 offset:19456
    v_mfma_f32_16x16x32_bf16 v[108:111], a[224:227], a[4:7], v[108:111]
    v_permlane32_swap_b32 v21, v23
    v_mfma_f32_16x16x32_bf16 v[108:111], a[228:231], a[20:23], v[108:111]
    s_waitcnt lgkmcnt(4)
    v_max3_u32 v21, v24, v21, v23
    v_mov_b32 v23, 147456
    v_mfma_f32_16x16x32_bf16 v[100:103], a[228:231], a[16:19], v[100:103]
    ds_write_b64 v22, v[20:21]
    v_mfma_f32_16x16x32_bf16 v[100:103], a[224:227], a[0:3], v[100:103]
    ds_read_b64_tr_b16 a[224:225], v10 offset:1024
    v_mfma_f32_16x16x32_bf16 v[128:131], a[232:235], a[0:3], v[128:131]
    buffer_load_dwordx4 a[60:63], v15, s[20:23], s77 offen sc1
    v_mfma_f32_16x16x32_bf16 v[128:131], a[236:239], a[16:19], v[128:131]
    s_addk_i32 m0, 19712
    ds_read_b64_tr_b16 a[226:227], v10 offset:7168
    v_mfma_f32_16x16x32_bf16 v[136:139], a[236:239], a[20:23], v[136:139]
    ds_read_b64_tr_b16 a[228:229], v10 offset:13312
    v_mfma_f32_16x16x32_bf16 v[136:139], a[232:235], a[4:7], v[136:139]
    ds_read_b64_tr_b16 a[230:231], v10 offset:19456
    v_mfma_f32_16x16x32_bf16 v[144:147], a[232:235], a[8:11], v[144:147]
    v_mfma_f32_16x16x32_bf16 v[144:147], a[236:239], a[24:27], v[144:147]
    s_waitcnt lgkmcnt(4)
    v_mfma_f32_16x16x32_bf16 v[152:155], a[236:239], a[28:31], v[152:155]
    buffer_load_dwordx4 v2, s[8:11], s36 offen offset:0 lds
    v_mfma_f32_16x16x32_bf16 v[152:155], a[232:235], a[12:15], v[152:155]
    s_addk_i32 m0, 896
    ds_read_b64_tr_b16 a[232:233], v11 offset:1024
    v_mfma_f32_16x16x32_bf16 v[156:159], a[240:243], a[12:15], v[156:159]
    ds_read_b64_tr_b16 a[234:235], v11 offset:7168
    v_mfma_f32_16x16x32_bf16 v[156:159], a[244:247], a[28:31], v[156:159]
    ds_read_b64_tr_b16 a[236:237], v11 offset:13312
    v_mfma_f32_16x16x32_bf16 v[148:151], a[244:247], a[24:27], v[148:151]
    ds_read_b64_tr_b16 a[238:239], v11 offset:19456
    v_mfma_f32_16x16x32_bf16 v[148:151], a[240:243], a[8:11], v[148:151]
    v_mfma_f32_16x16x32_bf16 v[140:143], a[240:243], a[4:7], v[140:143]
    buffer_load_dwordx4 v2, s[8:11], s36 offen offset:128 lds
    v_mfma_f32_16x16x32_bf16 v[140:143], a[244:247], a[20:23], v[140:143]
    s_waitcnt lgkmcnt(4)
    s_addk_i32 m0, 896
    v_mfma_f32_16x16x32_bf16 v[132:135], a[244:247], a[16:19], v[132:135]
    v_mfma_f32_16x16x32_bf16 v[132:135], a[240:243], a[0:3], v[132:135]
    ds_read_b64_tr_b16 a[240:241], v8 offset:2048
    v_mfma_f32_16x16x32_bf16 v[160:163], a[224:227], a[0:3], v[160:163]
    ds_read_b64_tr_b16 a[242:243], v8 offset:8192
    v_mfma_f32_16x16x32_bf16 v[160:163], a[228:231], a[16:19], v[160:163]
    ds_read_b64_tr_b16 a[244:245], v8 offset:14336
    v_mfma_f32_16x16x32_bf16 v[168:171], a[228:231], a[20:23], v[168:171]
    buffer_load_dwordx4 v2, s[8:11], s36 offen offset:256 lds
    v_mfma_f32_16x16x32_bf16 v[168:171], a[224:227], a[4:7], v[168:171]
    s_addk_i32 m0, 1280
    ds_read_b64_tr_b16 a[246:247], v8 offset:20480
    v_mfma_f32_16x16x32_bf16 v[176:179], a[224:227], a[8:11], v[176:179]
    v_mfma_f32_16x16x32_bf16 v[176:179], a[228:231], a[24:27], v[176:179]
    s_waitcnt lgkmcnt(4)
    v_mfma_f32_16x16x32_bf16 v[184:187], a[228:231], a[28:31], v[184:187]
    v_mfma_f32_16x16x32_bf16 v[184:187], a[224:227], a[12:15], v[184:187]
    ds_read_b64_tr_b16 a[224:225], v9 offset:2048
    v_mfma_f32_16x16x32_bf16 v[188:191], a[232:235], a[12:15], v[188:191]
    buffer_load_dwordx4 v3, s[8:11], s36 offen offset:0 lds
    v_mfma_f32_16x16x32_bf16 v[188:191], a[236:239], a[28:31], v[188:191]
    s_addk_i32 m0, 896
    ds_read_b64_tr_b16 a[226:227], v9 offset:8192
    v_mfma_f32_16x16x32_bf16 v[180:183], a[236:239], a[24:27], v[180:183]
    ds_read_b64_tr_b16 a[228:229], v9 offset:14336
    v_mfma_f32_16x16x32_bf16 v[180:183], a[232:235], a[8:11], v[180:183]
    ds_read_b64_tr_b16 a[230:231], v9 offset:20480
    v_mfma_f32_16x16x32_bf16 v[172:175], a[232:235], a[4:7], v[172:175]
    v_mfma_f32_16x16x32_bf16 v[172:175], a[236:239], a[20:23], v[172:175]
    s_waitcnt lgkmcnt(4)
    v_mfma_f32_16x16x32_bf16 v[164:167], a[236:239], a[16:19], v[164:167]
    buffer_load_dwordx4 v3, s[8:11], s36 offen offset:128 lds
    v_mfma_f32_16x16x32_bf16 v[164:167], a[232:235], a[0:3], v[164:167]
    s_addk_i32 m0, 896
    ds_read_b64_tr_b16 a[232:233], v10 offset:2048
    v_mfma_f32_16x16x32_bf16 v[192:195], a[240:243], a[0:3], v[192:195]
    ds_read_b64_tr_b16 a[234:235], v10 offset:8192
    v_mfma_f32_16x16x32_bf16 v[192:195], a[244:247], a[16:19], v[192:195]
    ds_read_b64_tr_b16 a[236:237], v10 offset:14336
    v_mfma_f32_16x16x32_bf16 v[200:203], a[244:247], a[20:23], v[200:203]
    ds_read_b64_tr_b16 a[238:239], v10 offset:20480
    v_mfma_f32_16x16x32_bf16 v[200:203], a[240:243], a[4:7], v[200:203]
    v_mfma_f32_16x16x32_bf16 v[208:211], a[240:243], a[8:11], v[208:211]
    buffer_load_dwordx4 v3, s[8:11], s36 offen offset:256 lds
    v_mfma_f32_16x16x32_bf16 v[208:211], a[244:247], a[24:27], v[208:211]
    s_waitcnt lgkmcnt(4)
    s_add_u32 s36, s36, s37
    s_sub_u32 s55, s36, 7864320
    v_mfma_f32_16x16x32_bf16 v[216:219], a[244:247], a[28:31], v[216:219]
    s_min_u32 s36, s36, s55
    s_add_u32 s46, s45, 49152
    s_sub_u32 s77, s46, 81920
    v_mfma_f32_16x16x32_bf16 v[216:219], a[240:243], a[12:15], v[216:219]
    s_min_u32 s46, s46, s77
    ds_read_b64_tr_b16 a[240:241], v11 offset:2048
    s_xor_b32 s77, s46, 1024
    ds_read_b64_tr_b16 a[242:243], v11 offset:8192
    v_mfma_f32_16x16x32_bf16 v[220:223], a[224:227], a[12:15], v[220:223]
    ds_read_b64_tr_b16 a[244:245], v11 offset:14336
    ds_read_b64_tr_b16 a[246:247], v11 offset:20480
    v_mfma_f32_16x16x32_bf16 v[220:223], a[228:231], a[28:31], v[220:223]
    v_mfma_f32_16x16x32_bf16 v[212:215], a[228:231], a[24:27], v[212:215]
    buffer_load_dwordx4 a[64:67], v14, s[20:23], s46 offen sc1
    v_mfma_f32_16x16x32_bf16 v[212:215], a[224:227], a[8:11], v[212:215]
    v_mfma_f32_16x16x32_bf16 v[204:207], a[224:227], a[4:7], v[204:207]
    v_mfma_f32_16x16x32_bf16 v[204:207], a[228:231], a[20:23], v[204:207]
    s_waitcnt lgkmcnt(4)
    v_mfma_f32_16x16x32_bf16 v[196:199], a[228:231], a[16:19], v[196:199]
    s_waitcnt lgkmcnt(0)
    s_barrier
    v_mfma_f32_16x16x32_bf16 v[196:199], a[224:227], a[0:3], v[196:199]
    ds_read_b128 v[32:35], v23 offset:0
    v_mfma_f32_16x16x32_bf16 v[224:227], a[232:235], a[0:3], v[224:227]
    buffer_load_dwordx4 a[68:71], v14, s[20:23], s77 offen sc1
    v_mfma_f32_16x16x32_bf16 v[224:227], a[236:239], a[16:19], v[224:227]
    ds_read_b128 v[36:39], v23 offset:16
    v_and_b32 v22, 1, v1
    v_mfma_f32_16x16x32_bf16 v[232:235], a[236:239], a[20:23], v[232:235]
    ds_read_b64_tr_b16 a[224:225], v8 offset:24576
    v_cmp_eq_u32 vcc, 1, v22
    v_mfma_f32_16x16x32_bf16 v[232:235], a[232:235], a[4:7], v[232:235]
    ds_read_b64_tr_b16 a[226:227], v8 offset:30720
    v_lshrrev_b32 v24, 4, v1
    v_mfma_f32_16x16x32_bf16 v[240:243], a[232:235], a[8:11], v[240:243]
    ds_read_b64_tr_b16 a[228:229], v8 offset:36864
    v_bfe_u32 v26, v1, 2, 3
    v_mfma_f32_16x16x32_bf16 v[240:243], a[236:239], a[24:27], v[240:243]
    ds_read_b64_tr_b16 a[230:231], v8 offset:43008
    v_lshlrev_b32 v25, 7, v26
    v_mfma_f32_16x16x32_bf16 v[248:251], a[236:239], a[28:31], v[248:251]
    buffer_load_dwordx4 a[72:75], v15, s[20:23], s46 offen sc1
    v_mfma_f32_16x16x32_bf16 v[248:251], a[232:235], a[12:15], v[248:251]
    s_waitcnt lgkmcnt(5)
    ds_read_b64_tr_b16 a[232:233], v9 offset:24576
    v_max_u32 v20, v32, v33
    v_mfma_f32_16x16x32_bf16 v[252:255], a[240:243], a[12:15], v[252:255]
    ds_read_b64_tr_b16 a[234:235], v9 offset:30720
    v_min_u32 v21, v32, v33
    v_mfma_f32_16x16x32_bf16 v[252:255], a[244:247], a[28:31], v[252:255]
    ds_read_b64_tr_b16 a[236:237], v9 offset:36864
    v_med3_u32 v21, v20, v21, v34
    v_mfma_f32_16x16x32_bf16 v[244:247], a[244:247], a[24:27], v[244:247]
    ds_read_b64_tr_b16 a[238:239], v9 offset:43008
    v_max_u32 v20, v20, v34
    v_mfma_f32_16x16x32_bf16 v[244:247], a[240:243], a[8:11], v[244:247]
    v_med3_u32 v21, v20, v21, v35
    v_max_u32 v20, v20, v35
    v_mfma_f32_16x16x32_bf16 v[236:239], a[240:243], a[4:7], v[236:239]
    buffer_load_dwordx4 a[76:79], v15, s[20:23], s77 offen sc1
    v_mfma_f32_16x16x32_bf16 v[236:239], a[244:247], a[20:23], v[236:239]
    s_waitcnt vmcnt(17) lgkmcnt(4)
    v_med3_u32 v21, v20, v21, v36
    v_max_u32 v20, v20, v36
    v_mfma_f32_16x16x32_bf16 v[228:231], a[244:247], a[16:19], v[228:231]
    s_waitcnt vmcnt(13)
    v_med3_u32 v21, v20, v21, v37
    v_max_u32 v20, v20, v37
    v_mfma_f32_16x16x32_bf16 v[228:231], a[240:243], a[0:3], v[228:231]
    s_waitcnt vmcnt(12)
    ds_read_b64_tr_b16 a[240:241], v10 offset:24576
    v_med3_u32 v21, v20, v21, v38
    v_mfma_f32_16x16x32_bf16 v[64:67], a[224:227], a[32:35], v[64:67]
    s_add_u32 s46, s45, 53248
    ds_read_b64_tr_b16 a[242:243], v10 offset:30720
    v_max_u32 v20, v20, v38
    v_mfma_f32_16x16x32_bf16 v[64:67], a[228:231], a[48:51], v[64:67]
    s_sub_u32 s77, s46, 81920
    ds_read_b64_tr_b16 a[244:245], v10 offset:36864
    v_med3_u32 v21, v20, v21, v39
    v_mfma_f32_16x16x32_bf16 v[72:75], a[228:231], a[52:55], v[72:75]
    s_waitcnt vmcnt(11)
    ds_read_b64_tr_b16 a[246:247], v10 offset:43008
    v_max_u32 v20, v20, v39
    v_mfma_f32_16x16x32_bf16 v[72:75], a[224:227], a[36:39], v[72:75]
    s_waitcnt vmcnt(10)
    v_readfirstlane_b32 s70, v20
    v_readfirstlane_b32 s71, v21
    v_mfma_f32_16x16x32_bf16 v[80:83], a[224:227], a[40:43], v[80:83]
    s_min_u32 s46, s46, s77
    v_cndmask_b32 v22, v20, v21, vcc
    v_and_b32 v22, 0x7ff, v22
    v_mfma_f32_16x16x32_bf16 v[80:83], a[228:231], a[56:59], v[80:83]
    buffer_load_dwordx4 a[80:83], v14, s[20:23], s46 offen sc1
    v_mfma_f32_16x16x32_bf16 v[88:91], a[228:231], a[60:63], v[88:91]
    s_waitcnt lgkmcnt(3)
    v_sub_u32 v22, 2047, v22
    v_mul_u32_u24 v23, 1280, v22
    v_mfma_f32_16x16x32_bf16 v[88:91], a[224:227], a[44:47], v[88:91]
    s_xor_b32 s77, s46, 1024
    ds_read_b64_tr_b16 a[224:225], v11 offset:24576
    v_lshl_add_u32 v23, v24, 4, v23
    v_mfma_f32_16x16x32_bf16 v[92:95], a[232:235], a[44:47], v[92:95]
    buffer_load_dwordx4 a[84:87], v14, s[20:23], s77 offen sc1
    v_mfma_f32_16x16x32_bf16 v[92:95], a[236:239], a[60:63], v[92:95]
    ds_read_b64_tr_b16 a[226:227], v11 offset:30720
    v_add_u32 v23, s61, v23
    v_mfma_f32_16x16x32_bf16 v[84:87], a[236:239], a[56:59], v[84:87]
    ds_read_b64_tr_b16 a[228:229], v11 offset:36864
    v_lshlrev_b32 v24, 3, v22
    v_mfma_f32_16x16x32_bf16 v[84:87], a[232:235], a[40:43], v[84:87]
    ds_read_b64_tr_b16 a[230:231], v11 offset:43008
    v_add_u32 v24, 3211264, v24
    v_mfma_f32_16x16x32_bf16 v[76:79], a[232:235], a[36:39], v[76:79]
    v_lshrrev_b32 v26, 1, v26
    v_xor_b32 v26, s3, v26
    v_mfma_f32_16x16x32_bf16 v[76:79], a[236:239], a[52:55], v[76:79]
    s_waitcnt lgkmcnt(4)
    v_lshl_add_u32 v25, v26, 5, v25
    v_and_b32 v26, 3, v1
    v_mfma_f32_16x16x32_bf16 v[68:71], a[236:239], a[48:51], v[68:71]
    buffer_load_dwordx4 a[88:91], v15, s[20:23], s46 offen sc1
    v_mfma_f32_16x16x32_bf16 v[68:71], a[232:235], a[32:35], v[68:71]
    ds_read_b64_tr_b16 a[232:233], v8 offset:25600
    v_lshl_add_u32 v25, v26, 3, v25
    v_mfma_f32_16x16x32_bf16 v[96:99], a[240:243], a[32:35], v[96:99]
    ds_read_b64_tr_b16 a[234:235], v8 offset:31744
    v_lshrrev_b32 v26, 5, v1
    v_mfma_f32_16x16x32_bf16 v[96:99], a[244:247], a[48:51], v[96:99]
    ds_read_b64_tr_b16 a[236:237], v8 offset:37888
    v_mul_u32_u24 v26, 2048, v26
    v_mfma_f32_16x16x32_bf16 v[104:107], a[244:247], a[52:55], v[104:107]
    ds_read_b64_tr_b16 a[238:239], v8 offset:44032
    v_add_u32 v25, v25, v26
    v_mfma_f32_16x16x32_bf16 v[104:107], a[240:243], a[36:39], v[104:107]
    v_add_u32 v25, 147456, v25
    v_lshlrev_b32 v26, 4, v1
    v_mfma_f32_16x16x32_bf16 v[112:115], a[240:243], a[40:43], v[112:115]
    buffer_load_dwordx4 a[92:95], v15, s[20:23], s77 offen sc1
    v_mfma_f32_16x16x32_bf16 v[112:115], a[244:247], a[56:59], v[112:115]
    s_waitcnt lgkmcnt(4)
    v_cmp_gt_u32 vcc, 16, v1
    v_mov_b32 v27, 0x7ffffff0
    v_mfma_f32_16x16x32_bf16 v[120:123], a[244:247], a[60:63], v[120:123]
    s_addk_i32 m0, 19712
    v_cndmask_b32 v26, v27, v26, vcc
    v_mfma_f32_16x16x32_bf16 v[120:123], a[240:243], a[44:47], v[120:123]
    ds_read_b64_tr_b16 a[240:241], v9 offset:25600
    v_mfma_f32_16x16x32_bf16 v[124:127], a[224:227], a[44:47], v[124:127]
    ds_read_b64_tr_b16 a[242:243], v9 offset:31744
    v_mfma_f32_16x16x32_bf16 v[124:127], a[228:231], a[60:63], v[124:127]
    ds_read_b64_tr_b16 a[244:245], v9 offset:37888
    v_mfma_f32_16x16x32_bf16 v[116:119], a[228:231], a[56:59], v[116:119]
    buffer_load_dwordx4 v2, s[8:11], s36 offen offset:0 lds
    v_mfma_f32_16x16x32_bf16 v[116:119], a[224:227], a[40:43], v[116:119]
    s_addk_i32 m0, 896
    ds_read_b64_tr_b16 a[246:247], v9 offset:44032
    v_mfma_f32_16x16x32_bf16 v[108:111], a[224:227], a[36:39], v[108:111]
    v_min_u32 v27, 1, v1
    v_mfma_f32_16x16x32_bf16 v[108:111], a[228:231], a[52:55], v[108:111]
    s_waitcnt lgkmcnt(4)
    v_lshlrev_b32 v27, 30, v27
    v_mfma_f32_16x16x32_bf16 v[100:103], a[228:231], a[48:51], v[100:103]
    v_mfma_f32_16x16x32_bf16 v[100:103], a[224:227], a[32:35], v[100:103]
    ds_read_b64_tr_b16 a[224:225], v10 offset:25600
    v_mfma_f32_16x16x32_bf16 v[128:131], a[232:235], a[32:35], v[128:131]
    buffer_load_dwordx4 v2, s[8:11], s36 offen offset:128 lds
    v_mfma_f32_16x16x32_bf16 v[128:131], a[236:239], a[48:51], v[128:131]
    s_addk_i32 m0, 896
    ds_read_b64_tr_b16 a[226:227], v10 offset:31744
    v_mfma_f32_16x16x32_bf16 v[136:139], a[236:239], a[52:55], v[136:139]
    ds_read_b64_tr_b16 a[228:229], v10 offset:37888
    v_mfma_f32_16x16x32_bf16 v[136:139], a[232:235], a[36:39], v[136:139]
    ds_read_b64_tr_b16 a[230:231], v10 offset:44032
    v_mfma_f32_16x16x32_bf16 v[144:147], a[232:235], a[40:43], v[144:147]
    v_mfma_f32_16x16x32_bf16 v[144:147], a[236:239], a[56:59], v[144:147]
    s_waitcnt lgkmcnt(4)
    v_mfma_f32_16x16x32_bf16 v[152:155], a[236:239], a[60:63], v[152:155]
    buffer_load_dwordx4 v2, s[8:11], s36 offen offset:256 lds
    v_mfma_f32_16x16x32_bf16 v[152:155], a[232:235], a[44:47], v[152:155]
    s_addk_i32 m0, 1280
    ds_read_b64_tr_b16 a[232:233], v11 offset:25600
    v_mfma_f32_16x16x32_bf16 v[156:159], a[240:243], a[44:47], v[156:159]
    ds_read_b64_tr_b16 a[234:235], v11 offset:31744
    v_mfma_f32_16x16x32_bf16 v[156:159], a[244:247], a[60:63], v[156:159]
    ds_read_b64_tr_b16 a[236:237], v11 offset:37888
    v_mfma_f32_16x16x32_bf16 v[148:151], a[244:247], a[56:59], v[148:151]
    ds_read_b64_tr_b16 a[238:239], v11 offset:44032
    v_mfma_f32_16x16x32_bf16 v[148:151], a[240:243], a[40:43], v[148:151]
    v_mfma_f32_16x16x32_bf16 v[140:143], a[240:243], a[36:39], v[140:143]
    buffer_load_dwordx4 v3, s[8:11], s36 offen offset:0 lds
    v_mfma_f32_16x16x32_bf16 v[140:143], a[244:247], a[52:55], v[140:143]
    s_waitcnt lgkmcnt(4)
    s_addk_i32 m0, 896
    v_mfma_f32_16x16x32_bf16 v[132:135], a[244:247], a[48:51], v[132:135]
    v_mfma_f32_16x16x32_bf16 v[132:135], a[240:243], a[32:35], v[132:135]
    ds_read_b64_tr_b16 a[240:241], v8 offset:26624
    v_mfma_f32_16x16x32_bf16 v[160:163], a[224:227], a[32:35], v[160:163]
    ds_read_b64_tr_b16 a[242:243], v8 offset:32768
    v_mfma_f32_16x16x32_bf16 v[160:163], a[228:231], a[48:51], v[160:163]
    ds_read_b64_tr_b16 a[244:245], v8 offset:38912
    v_mfma_f32_16x16x32_bf16 v[168:171], a[228:231], a[52:55], v[168:171]
    global_load_dwordx4 v[48:51], v23, s[64:65]
    v_mfma_f32_16x16x32_bf16 v[168:171], a[224:227], a[36:39], v[168:171]
    global_load_dwordx4 v[52:55], v23, s[64:65] offset:64
    v_mfma_f32_16x16x32_bf16 v[176:179], a[224:227], a[40:43], v[176:179]
    buffer_load_dwordx2 v[40:41], v24, s[24:27], 0 offen sc1
    v_mfma_f32_16x16x32_bf16 v[176:179], a[228:231], a[56:59], v[176:179]
    buffer_load_dwordx4 v3, s[8:11], s36 offen offset:128 lds
    v_mfma_f32_16x16x32_bf16 v[184:187], a[228:231], a[60:63], v[184:187]
    s_waitcnt lgkmcnt(2)
    ds_read_b64_tr_b16 a[246:247], v8 offset:45056
    s_addk_i32 m0, 896
    v_mfma_f32_16x16x32_bf16 v[184:187], a[224:227], a[44:47], v[184:187]
    ds_read_b64_tr_b16 a[224:225], v9 offset:26624
    v_mfma_f32_16x16x32_bf16 v[188:191], a[232:235], a[44:47], v[188:191]
    buffer_load_dwordx4 v3, s[8:11], s36 offen offset:256 lds
    v_mfma_f32_16x16x32_bf16 v[188:191], a[236:239], a[60:63], v[188:191]
    s_add_u32 s36, s36, s37
    ds_read_b64_tr_b16 a[226:227], v9 offset:32768
    s_sub_u32 s55, s36, 7864320
    v_mfma_f32_16x16x32_bf16 v[180:183], a[236:239], a[56:59], v[180:183]
    s_min_u32 s36, s36, s55
    ds_read_b64_tr_b16 a[228:229], v9 offset:38912
    s_add_u32 s46, s45, 57344
    v_mfma_f32_16x16x32_bf16 v[180:183], a[232:235], a[40:43], v[180:183]
    s_sub_u32 s77, s46, 81920
    ds_read_b64_tr_b16 a[230:231], v9 offset:45056
    s_min_u32 s46, s46, s77
    v_mfma_f32_16x16x32_bf16 v[172:175], a[232:235], a[36:39], v[172:175]
    s_xor_b32 s77, s46, 1024
    v_add_u32 v8, 49152, v8
    v_mfma_f32_16x16x32_bf16 v[172:175], a[236:239], a[52:55], v[172:175]
    s_waitcnt lgkmcnt(4)
    v_add_u32 v9, 49152, v9
    v_mfma_f32_16x16x32_bf16 v[164:167], a[236:239], a[48:51], v[164:167]
    buffer_load_dwordx4 a[160:163], v14, s[20:23], s46 offen sc1
    v_mfma_f32_16x16x32_bf16 v[164:167], a[232:235], a[32:35], v[164:167]
    ds_read_b64_tr_b16 a[232:233], v10 offset:26624
    v_mfma_f32_16x16x32_bf16 v[192:195], a[240:243], a[32:35], v[192:195]
    ds_read_b64_tr_b16 a[234:235], v10 offset:32768
    v_mfma_f32_16x16x32_bf16 v[192:195], a[244:247], a[48:51], v[192:195]
    ds_read_b64_tr_b16 a[236:237], v10 offset:38912
    v_mfma_f32_16x16x32_bf16 v[200:203], a[244:247], a[52:55], v[200:203]
    ds_read_b64_tr_b16 a[238:239], v10 offset:45056
    v_mfma_f32_16x16x32_bf16 v[200:203], a[240:243], a[36:39], v[200:203]
    v_add_u32 v10, 49152, v10
    v_mfma_f32_16x16x32_bf16 v[208:211], a[240:243], a[40:43], v[208:211]
    buffer_load_dwordx4 a[164:167], v14, s[20:23], s77 offen sc1
    v_mfma_f32_16x16x32_bf16 v[208:211], a[244:247], a[56:59], v[208:211]
    s_waitcnt lgkmcnt(4)
    v_mfma_f32_16x16x32_bf16 v[216:219], a[244:247], a[60:63], v[216:219]
    v_mfma_f32_16x16x32_bf16 v[216:219], a[240:243], a[44:47], v[216:219]
    ds_read_b64_tr_b16 a[240:241], v11 offset:26624
    ds_read_b64_tr_b16 a[242:243], v11 offset:32768
    ds_read_b64_tr_b16 a[244:245], v11 offset:38912
    v_mfma_f32_16x16x32_bf16 v[220:223], a[224:227], a[44:47], v[220:223]
    ds_read_b64_tr_b16 a[246:247], v11 offset:45056
    v_mfma_f32_16x16x32_bf16 v[220:223], a[228:231], a[60:63], v[220:223]
    v_add_u32 v11, 49152, v11
    v_mfma_f32_16x16x32_bf16 v[212:215], a[228:231], a[56:59], v[212:215]
    buffer_load_dwordx4 a[168:171], v15, s[20:23], s46 offen sc1
    v_mfma_f32_16x16x32_bf16 v[212:215], a[224:227], a[40:43], v[212:215]
    v_mfma_f32_16x16x32_bf16 v[204:207], a[224:227], a[36:39], v[204:207]
    v_mfma_f32_16x16x32_bf16 v[204:207], a[228:231], a[52:55], v[204:207]
    s_waitcnt lgkmcnt(4)
    v_mfma_f32_16x16x32_bf16 v[196:199], a[228:231], a[48:51], v[196:199]
    s_waitcnt lgkmcnt(0)
    s_barrier
    v_mfma_f32_16x16x32_bf16 v[196:199], a[224:227], a[32:35], v[196:199]
    ds_read_b64_tr_b16 a[224:225], v8 offset:0
    v_mfma_f32_16x16x32_bf16 v[224:227], a[232:235], a[32:35], v[224:227]
    buffer_load_dwordx4 a[172:175], v15, s[20:23], s77 offen sc1
    v_mfma_f32_16x16x32_bf16 v[224:227], a[236:239], a[48:51], v[224:227]
    s_add_u32 m0, s44, 147456
    ds_read_b64_tr_b16 a[226:227], v8 offset:6144
    v_mfma_f32_16x16x32_bf16 v[232:235], a[236:239], a[52:55], v[232:235]
    ds_read_b64_tr_b16 a[228:229], v8 offset:12288
    v_mfma_f32_16x16x32_bf16 v[232:235], a[232:235], a[36:39], v[232:235]
    ds_read_b64_tr_b16 a[230:231], v8 offset:18432
    v_mfma_f32_16x16x32_bf16 v[240:243], a[232:235], a[40:43], v[240:243]
    v_mfma_f32_16x16x32_bf16 v[240:243], a[236:239], a[56:59], v[240:243]
    v_mfma_f32_16x16x32_bf16 v[248:251], a[236:239], a[60:63], v[248:251]
    buffer_load_dwordx4 v56, s[28:31], s60 offen lds
    v_mfma_f32_16x16x32_bf16 v[248:251], a[232:235], a[44:47], v[248:251]
    s_addk_i32 m0, 1024
    ds_read_b64_tr_b16 a[232:233], v9 offset:0
    v_mfma_f32_16x16x32_bf16 v[252:255], a[240:243], a[44:47], v[252:255]
    ds_read_b64_tr_b16 a[234:235], v9 offset:6144
    v_mfma_f32_16x16x32_bf16 v[252:255], a[244:247], a[60:63], v[252:255]
    ds_read_b64_tr_b16 a[236:237], v9 offset:12288
    v_mfma_f32_16x16x32_bf16 v[244:247], a[244:247], a[56:59], v[244:247]
    ds_read_b64_tr_b16 a[238:239], v9 offset:18432
    v_mfma_f32_16x16x32_bf16 v[244:247], a[240:243], a[40:43], v[244:247]
    v_mfma_f32_16x16x32_bf16 v[236:239], a[240:243], a[36:39], v[236:239]
    buffer_load_dwordx4 v56, s[32:35], s60 offen lds
    v_mfma_f32_16x16x32_bf16 v[236:239], a[244:247], a[52:55], v[236:239]
    s_waitcnt vmcnt(22) lgkmcnt(4)
    s_addk_i32 m0, 1024
    v_mfma_f32_16x16x32_bf16 v[228:231], a[244:247], a[48:51], v[228:231]
    s_waitcnt vmcnt(18)
    v_mfma_f32_16x16x32_bf16 v[228:231], a[240:243], a[32:35], v[228:231]
    s_waitcnt vmcnt(17)
    ds_read_b64_tr_b16 a[240:241], v10 offset:0
    v_mfma_f32_16x16x32_bf16 v[64:67], a[224:227], a[64:67], v[64:67]
    ds_read_b64_tr_b16 a[242:243], v10 offset:6144
    v_mfma_f32_16x16x32_bf16 v[64:67], a[228:231], a[80:83], v[64:67]
    ds_read_b64_tr_b16 a[244:245], v10 offset:12288
    v_mfma_f32_16x16x32_bf16 v[72:75], a[228:231], a[84:87], v[72:75]
    buffer_load_dwordx4 v57, s[28:31], s60 offen lds
    v_mfma_f32_16x16x32_bf16 v[72:75], a[224:227], a[68:71], v[72:75]
    s_waitcnt vmcnt(16)
    ds_read_b64_tr_b16 a[246:247], v10 offset:18432
    s_addk_i32 m0, 1024
    v_mfma_f32_16x16x32_bf16 v[80:83], a[224:227], a[72:75], v[80:83]
    v_mfma_f32_16x16x32_bf16 v[80:83], a[228:231], a[88:91], v[80:83]
    s_waitcnt lgkmcnt(4)
    v_mfma_f32_16x16x32_bf16 v[88:91], a[228:231], a[92:95], v[88:91]
    v_mfma_f32_16x16x32_bf16 v[88:91], a[224:227], a[76:79], v[88:91]
    ds_read_b64_tr_b16 a[224:225], v11 offset:0
    v_mfma_f32_16x16x32_bf16 v[92:95], a[232:235], a[76:79], v[92:95]
    buffer_load_dwordx4 v57, s[32:35], s60 offen lds
    v_mfma_f32_16x16x32_bf16 v[92:95], a[236:239], a[92:95], v[92:95]
    s_add_u32 s46, s45, 61440
    ds_read_b64_tr_b16 a[226:227], v11 offset:6144
    s_sub_u32 s77, s46, 81920
    v_mfma_f32_16x16x32_bf16 v[84:87], a[236:239], a[88:91], v[84:87]
    s_min_u32 s46, s46, s77
    ds_read_b64_tr_b16 a[228:229], v11 offset:12288
    s_xor_b32 s77, s46, 1024
    v_mfma_f32_16x16x32_bf16 v[84:87], a[232:235], a[72:75], v[84:87]
    ds_read_b64_tr_b16 a[230:231], v11 offset:18432
    v_mfma_f32_16x16x32_bf16 v[76:79], a[232:235], a[68:71], v[76:79]
    v_mfma_f32_16x16x32_bf16 v[76:79], a[236:239], a[84:87], v[76:79]
    s_waitcnt lgkmcnt(4)
    v_mfma_f32_16x16x32_bf16 v[68:71], a[236:239], a[80:83], v[68:71]
    buffer_load_dwordx4 a[176:179], v14, s[20:23], s46 offen sc1
    v_mfma_f32_16x16x32_bf16 v[68:71], a[232:235], a[64:67], v[68:71]
    ds_read_b64_tr_b16 a[232:233], v8 offset:1024
    v_mfma_f32_16x16x32_bf16 v[96:99], a[240:243], a[64:67], v[96:99]
    ds_read_b64_tr_b16 a[234:235], v8 offset:7168
    v_mfma_f32_16x16x32_bf16 v[96:99], a[244:247], a[80:83], v[96:99]
    ds_read_b64_tr_b16 a[236:237], v8 offset:13312
    v_mfma_f32_16x16x32_bf16 v[104:107], a[244:247], a[84:87], v[104:107]
    ds_read_b64_tr_b16 a[238:239], v8 offset:19456
    v_mfma_f32_16x16x32_bf16 v[104:107], a[240:243], a[68:71], v[104:107]
    v_mfma_f32_16x16x32_bf16 v[112:115], a[240:243], a[72:75], v[112:115]
    buffer_load_dwordx4 a[180:183], v14, s[20:23], s77 offen sc1
    v_mfma_f32_16x16x32_bf16 v[112:115], a[244:247], a[88:91], v[112:115]
    s_waitcnt lgkmcnt(4)
    v_mfma_f32_16x16x32_bf16 v[120:123], a[244:247], a[92:95], v[120:123]
    s_add_u32 s88, s88, 32768
    s_addc_u32 s89, s89, 0
    v_mfma_f32_16x16x32_bf16 v[120:123], a[240:243], a[76:79], v[120:123]
    ds_read_b64_tr_b16 a[240:241], v9 offset:1024
    v_mfma_f32_16x16x32_bf16 v[124:127], a[224:227], a[76:79], v[124:127]
    global_load_dword a252, v18, s[88:89]
    v_mfma_f32_16x16x32_bf16 v[124:127], a[228:231], a[92:95], v[124:127]
    ds_read_b64_tr_b16 a[242:243], v9 offset:7168
    v_mfma_f32_16x16x32_bf16 v[116:119], a[228:231], a[88:91], v[116:119]
    buffer_load_dwordx4 a[184:187], v15, s[20:23], s46 offen sc1
    v_mfma_f32_16x16x32_bf16 v[116:119], a[224:227], a[72:75], v[116:119]
    ds_read_b64_tr_b16 a[244:245], v9 offset:13312
    v_mfma_f32_16x16x32_bf16 v[108:111], a[224:227], a[68:71], v[108:111]
    ds_read_b64_tr_b16 a[246:247], v9 offset:19456
    v_mfma_f32_16x16x32_bf16 v[108:111], a[228:231], a[84:87], v[108:111]
    s_waitcnt lgkmcnt(4)
    v_mfma_f32_16x16x32_bf16 v[100:103], a[228:231], a[80:83], v[100:103]
    v_mfma_f32_16x16x32_bf16 v[100:103], a[224:227], a[64:67], v[100:103]
    ds_read_b64_tr_b16 a[224:225], v10 offset:1024
    v_mfma_f32_16x16x32_bf16 v[128:131], a[232:235], a[64:67], v[128:131]
    buffer_load_dwordx4 a[188:191], v15, s[20:23], s77 offen sc1
    v_mfma_f32_16x16x32_bf16 v[128:131], a[236:239], a[80:83], v[128:131]
    s_add_u32 s46, s45, 65536
    ds_read_b64_tr_b16 a[226:227], v10 offset:7168
    s_sub_u32 s77, s46, 81920
    v_mfma_f32_16x16x32_bf16 v[136:139], a[236:239], a[84:87], v[136:139]
    s_min_u32 s46, s46, s77
    ds_read_b64_tr_b16 a[228:229], v10 offset:13312
    s_xor_b32 s77, s46, 1024
    v_mfma_f32_16x16x32_bf16 v[136:139], a[232:235], a[68:71], v[136:139]
    ds_read_b64_tr_b16 a[230:231], v10 offset:19456
    v_mfma_f32_16x16x32_bf16 v[144:147], a[232:235], a[72:75], v[144:147]
    v_mfma_f32_16x16x32_bf16 v[144:147], a[236:239], a[88:91], v[144:147]
    s_waitcnt lgkmcnt(4)
    v_mfma_f32_16x16x32_bf16 v[152:155], a[236:239], a[92:95], v[152:155]
    buffer_load_dwordx4 a[96:99], v14, s[20:23], s46 offen sc1
    v_mfma_f32_16x16x32_bf16 v[152:155], a[232:235], a[76:79], v[152:155]
    ds_read_b64_tr_b16 a[232:233], v11 offset:1024
    v_mfma_f32_16x16x32_bf16 v[156:159], a[240:243], a[76:79], v[156:159]
    ds_read_b64_tr_b16 a[234:235], v11 offset:7168
    v_mfma_f32_16x16x32_bf16 v[156:159], a[244:247], a[92:95], v[156:159]
    ds_read_b64_tr_b16 a[236:237], v11 offset:13312
    v_mfma_f32_16x16x32_bf16 v[148:151], a[244:247], a[88:91], v[148:151]
    ds_read_b64_tr_b16 a[238:239], v11 offset:19456
    v_mfma_f32_16x16x32_bf16 v[148:151], a[240:243], a[72:75], v[148:151]
    v_mfma_f32_16x16x32_bf16 v[140:143], a[240:243], a[68:71], v[140:143]
    buffer_load_dwordx4 a[100:103], v14, s[20:23], s77 offen sc1
    v_mfma_f32_16x16x32_bf16 v[140:143], a[244:247], a[84:87], v[140:143]
    s_waitcnt lgkmcnt(4)
    v_mfma_f32_16x16x32_bf16 v[132:135], a[244:247], a[80:83], v[132:135]
    v_mfma_f32_16x16x32_bf16 v[132:135], a[240:243], a[64:67], v[132:135]
    ds_read_b64_tr_b16 a[240:241], v8 offset:2048
    v_mfma_f32_16x16x32_bf16 v[160:163], a[224:227], a[64:67], v[160:163]
    ds_read_b64_tr_b16 a[242:243], v8 offset:8192
    v_mfma_f32_16x16x32_bf16 v[160:163], a[228:231], a[80:83], v[160:163]
    ds_read_b64_tr_b16 a[244:245], v8 offset:14336
    v_mfma_f32_16x16x32_bf16 v[168:171], a[228:231], a[84:87], v[168:171]
    buffer_load_dwordx4 a[104:107], v15, s[20:23], s46 offen sc1
    v_mfma_f32_16x16x32_bf16 v[168:171], a[224:227], a[68:71], v[168:171]
    ds_read_b64_tr_b16 a[246:247], v8 offset:20480
    v_mfma_f32_16x16x32_bf16 v[176:179], a[224:227], a[72:75], v[176:179]
    v_mfma_f32_16x16x32_bf16 v[176:179], a[228:231], a[88:91], v[176:179]
    s_waitcnt lgkmcnt(4)
    v_mfma_f32_16x16x32_bf16 v[184:187], a[228:231], a[92:95], v[184:187]
    s_waitcnt vmcnt(20)
    v_lshlrev_b32 v42, 16, v48
    v_and_b32 v43, 0xffff0000, v48
    v_mfma_f32_16x16x32_bf16 v[184:187], a[224:227], a[76:79], v[184:187]
    ds_read_b64_tr_b16 a[224:225], v9 offset:2048
    v_mfma_f32_16x16x32_bf16 v[188:191], a[232:235], a[76:79], v[188:191]
    buffer_load_dwordx4 a[108:111], v15, s[20:23], s77 offen sc1
    v_mfma_f32_16x16x32_bf16 v[188:191], a[236:239], a[92:95], v[188:191]
    s_add_u32 s46, s45, 69632
    ds_read_b64_tr_b16 a[226:227], v9 offset:8192
    s_sub_u32 s77, s46, 81920
    v_mfma_f32_16x16x32_bf16 v[180:183], a[236:239], a[88:91], v[180:183]
    s_min_u32 s46, s46, s77
    ds_read_b64_tr_b16 a[228:229], v9 offset:14336
    s_xor_b32 s77, s46, 1024
    v_mfma_f32_16x16x32_bf16 v[180:183], a[232:235], a[72:75], v[180:183]
    s_waitcnt vmcnt(19)
    ds_read_b64_tr_b16 a[230:231], v9 offset:20480
    v_sub_f32 v42, v42, v40
    v_mfma_f32_16x16x32_bf16 v[172:175], a[232:235], a[68:71], v[172:175]
    v_sub_f32 v43, v43, v40
    v_cvt_pk_bf16_f32 v42, 0, v42
    v_mfma_f32_16x16x32_bf16 v[172:175], a[236:239], a[84:87], v[172:175]
    s_waitcnt lgkmcnt(4)
    v_cvt_pk_bf16_f32 v43, 0, v43
    v_mul_f32 v42, v42, v41
    v_mfma_f32_16x16x32_bf16 v[164:167], a[236:239], a[80:83], v[164:167]
    buffer_load_dwordx4 a[112:115], v14, s[20:23], s46 offen sc1
    v_mfma_f32_16x16x32_bf16 v[164:167], a[232:235], a[64:67], v[164:167]
    ds_read_b64_tr_b16 a[232:233], v10 offset:2048
    v_mul_f32 v43, v43, v41
    v_mfma_f32_16x16x32_bf16 v[192:195], a[240:243], a[64:67], v[192:195]
    ds_read_b64_tr_b16 a[234:235], v10 offset:8192
    v_cvt_pk_bf16_f32 v48, v42, v43
    v_mfma_f32_16x16x32_bf16 v[192:195], a[244:247], a[80:83], v[192:195]
    ds_read_b64_tr_b16 a[236:237], v10 offset:14336
    v_lshlrev_b32 v42, 16, v49
    v_mfma_f32_16x16x32_bf16 v[200:203], a[244:247], a[84:87], v[200:203]
    ds_read_b64_tr_b16 a[238:239], v10 offset:20480
    v_and_b32 v43, 0xffff0000, v49
    v_mfma_f32_16x16x32_bf16 v[200:203], a[240:243], a[68:71], v[200:203]
    v_sub_f32 v42, v42, v40
    v_sub_f32 v43, v43, v40
    v_mfma_f32_16x16x32_bf16 v[208:211], a[240:243], a[72:75], v[208:211]
    buffer_load_dwordx4 a[116:119], v14, s[20:23], s77 offen sc1
    v_mfma_f32_16x16x32_bf16 v[208:211], a[244:247], a[88:91], v[208:211]
    s_waitcnt lgkmcnt(4)
    v_cvt_pk_bf16_f32 v42, 0, v42
    v_cvt_pk_bf16_f32 v43, 0, v43
    v_mfma_f32_16x16x32_bf16 v[216:219], a[244:247], a[92:95], v[216:219]
pg_3:
    s_cbranch_execz pg_7
    v_mul_f32 v42, v42, v41
    v_mul_f32 v43, v43, v41
    v_mfma_f32_16x16x32_bf16 v[216:219], a[240:243], a[76:79], v[216:219]
    ds_read_b64_tr_b16 a[240:241], v11 offset:2048
    v_cvt_pk_bf16_f32 v49, v42, v43
    ds_read_b64_tr_b16 a[242:243], v11 offset:8192
    v_mfma_f32_16x16x32_bf16 v[220:223], a[224:227], a[76:79], v[220:223]
    ds_read_b64_tr_b16 a[244:245], v11 offset:14336
    v_lshlrev_b32 v42, 16, v50
    ds_read_b64_tr_b16 a[246:247], v11 offset:20480
    v_mfma_f32_16x16x32_bf16 v[220:223], a[228:231], a[92:95], v[220:223]
    v_and_b32 v43, 0xffff0000, v50
    v_sub_f32 v42, v42, v40
    v_mfma_f32_16x16x32_bf16 v[212:215], a[228:231], a[88:91], v[212:215]
    buffer_load_dwordx4 a[120:123], v15, s[20:23], s46 offen sc1
    v_mfma_f32_16x16x32_bf16 v[212:215], a[224:227], a[72:75], v[212:215]
    v_sub_f32 v43, v43, v40
    v_cvt_pk_bf16_f32 v42, 0, v42
    v_mfma_f32_16x16x32_bf16 v[204:207], a[224:227], a[68:71], v[204:207]
    v_cvt_pk_bf16_f32 v43, 0, v43
    v_mul_f32 v42, v42, v41
    v_mfma_f32_16x16x32_bf16 v[204:207], a[228:231], a[84:87], v[204:207]
    s_waitcnt lgkmcnt(4)
    v_mul_f32 v43, v43, v41
    v_cvt_pk_bf16_f32 v50, v42, v43
    v_mfma_f32_16x16x32_bf16 v[196:199], a[228:231], a[80:83], v[196:199]
    s_waitcnt vmcnt(12) lgkmcnt(0)
    s_barrier
    v_mfma_f32_16x16x32_bf16 v[196:199], a[224:227], a[64:67], v[196:199]
    ds_read_b64_tr_b16 a[224:225], v8 offset:24576
    v_lshlrev_b32 v42, 16, v51
    v_mfma_f32_16x16x32_bf16 v[224:227], a[232:235], a[64:67], v[224:227]
    buffer_load_dwordx4 a[124:127], v15, s[20:23], s77 offen sc1
    v_mfma_f32_16x16x32_bf16 v[224:227], a[236:239], a[80:83], v[224:227]
    s_add_u32 s46, s45, 73728
    ds_read_b64_tr_b16 a[226:227], v8 offset:30720
    v_and_b32 v43, 0xffff0000, v51
    v_mfma_f32_16x16x32_bf16 v[232:235], a[236:239], a[84:87], v[232:235]
    s_sub_u32 s77, s46, 81920
    ds_read_b64_tr_b16 a[228:229], v8 offset:36864
    v_sub_f32 v42, v42, v40
    v_mfma_f32_16x16x32_bf16 v[232:235], a[232:235], a[68:71], v[232:235]
    s_min_u32 s46, s46, s77
    ds_read_b64_tr_b16 a[230:231], v8 offset:43008
    v_sub_f32 v43, v43, v40
    v_mfma_f32_16x16x32_bf16 v[240:243], a[232:235], a[72:75], v[240:243]
    s_xor_b32 s77, s46, 1024
    v_cvt_pk_bf16_f32 v42, 0, v42
    v_cvt_pk_bf16_f32 v43, 0, v43
    v_mfma_f32_16x16x32_bf16 v[240:243], a[236:239], a[88:91], v[240:243]
    v_mul_f32 v42, v42, v41
    v_mul_f32 v43, v43, v41
    v_mfma_f32_16x16x32_bf16 v[248:251], a[236:239], a[92:95], v[248:251]
    buffer_load_dwordx4 a[128:131], v14, s[20:23], s46 offen sc1
    v_mfma_f32_16x16x32_bf16 v[248:251], a[232:235], a[76:79], v[248:251]
    ds_read_b64_tr_b16 a[232:233], v9 offset:24576
    v_cvt_pk_bf16_f32 v51, v42, v43
    v_mfma_f32_16x16x32_bf16 v[252:255], a[240:243], a[76:79], v[252:255]
    ds_read_b64_tr_b16 a[234:235], v9 offset:30720
    v_lshlrev_b32 v42, 16, v52
    v_mfma_f32_16x16x32_bf16 v[252:255], a[244:247], a[92:95], v[252:255]
    ds_read_b64_tr_b16 a[236:237], v9 offset:36864
    v_and_b32 v43, 0xffff0000, v52
    v_mfma_f32_16x16x32_bf16 v[244:247], a[244:247], a[88:91], v[244:247]
    ds_read_b64_tr_b16 a[238:239], v9 offset:43008
    v_sub_f32 v42, v42, v40
    v_mfma_f32_16x16x32_bf16 v[244:247], a[240:243], a[72:75], v[244:247]
    v_sub_f32 v43, v43, v40
    v_cvt_pk_bf16_f32 v42, 0, v42
    v_mfma_f32_16x16x32_bf16 v[236:239], a[240:243], a[68:71], v[236:239]
    buffer_load_dwordx4 a[132:135], v14, s[20:23], s77 offen sc1
    v_mfma_f32_16x16x32_bf16 v[236:239], a[244:247], a[84:87], v[236:239]
    s_waitcnt lgkmcnt(4)
    v_cvt_pk_bf16_f32 v43, 0, v43
    v_mul_f32 v42, v42, v41
    v_mfma_f32_16x16x32_bf16 v[228:231], a[244:247], a[80:83], v[228:231]
    s_waitcnt vmcnt(14)
    v_mul_f32 v43, v43, v41
    v_cvt_pk_bf16_f32 v52, v42, v43
    v_mfma_f32_16x16x32_bf16 v[228:231], a[240:243], a[64:67], v[228:231]
    s_waitcnt vmcnt(13)
    ds_read_b64_tr_b16 a[240:241], v10 offset:24576
    v_lshlrev_b32 v42, 16, v53
    v_mfma_f32_16x16x32_bf16 v[64:67], a[224:227], a[160:163], v[64:67]
    ds_read_b64_tr_b16 a[242:243], v10 offset:30720
    v_and_b32 v43, 0xffff0000, v53
    v_mfma_f32_16x16x32_bf16 v[64:67], a[228:231], a[176:179], v[64:67]
    ds_read_b64_tr_b16 a[244:245], v10 offset:36864
    v_sub_f32 v42, v42, v40
    v_mfma_f32_16x16x32_bf16 v[72:75], a[228:231], a[180:183], v[72:75]
    buffer_load_dwordx4 a[136:139], v15, s[20:23], s46 offen sc1
    v_mfma_f32_16x16x32_bf16 v[72:75], a[224:227], a[164:167], v[72:75]
    s_waitcnt vmcnt(11)
    ds_read_b64_tr_b16 a[246:247], v10 offset:43008
    v_sub_f32 v43, v43, v40
    v_mfma_f32_16x16x32_bf16 v[80:83], a[224:227], a[168:171], v[80:83]
    v_cvt_pk_bf16_f32 v42, 0, v42
    v_cvt_pk_bf16_f32 v43, 0, v43
    v_mfma_f32_16x16x32_bf16 v[80:83], a[228:231], a[184:187], v[80:83]
    s_waitcnt lgkmcnt(4)
    v_mul_f32 v42, v42, v41
    v_mul_f32 v43, v43, v41
    v_mfma_f32_16x16x32_bf16 v[88:91], a[228:231], a[188:191], v[88:91]
    v_cvt_pk_bf16_f32 v53, v42, v43
    v_lshlrev_b32 v42, 16, v54
    v_mfma_f32_16x16x32_bf16 v[88:91], a[224:227], a[172:175], v[88:91]
    ds_read_b64_tr_b16 a[224:225], v11 offset:24576
    v_and_b32 v43, 0xffff0000, v54
    v_mfma_f32_16x16x32_bf16 v[92:95], a[232:235], a[172:175], v[92:95]
    buffer_load_dwordx4 a[140:143], v15, s[20:23], s77 offen sc1
    v_mfma_f32_16x16x32_bf16 v[92:95], a[236:239], a[188:191], v[92:95]
    s_add_u32 s46, s45, 77824
    ds_read_b64_tr_b16 a[226:227], v11 offset:30720
    v_sub_f32 v42, v42, v40
    v_mfma_f32_16x16x32_bf16 v[84:87], a[236:239], a[184:187], v[84:87]
    s_sub_u32 s77, s46, 81920
    ds_read_b64_tr_b16 a[228:229], v11 offset:36864
    v_sub_f32 v43, v43, v40
    v_mfma_f32_16x16x32_bf16 v[84:87], a[232:235], a[168:171], v[84:87]
    s_min_u32 s46, s46, s77
    ds_read_b64_tr_b16 a[230:231], v11 offset:43008
    v_cvt_pk_bf16_f32 v42, 0, v42
    v_mfma_f32_16x16x32_bf16 v[76:79], a[232:235], a[164:167], v[76:79]
    s_xor_b32 s77, s46, 1024
    v_cvt_pk_bf16_f32 v43, 0, v43
    v_mul_f32 v42, v42, v41
    v_mfma_f32_16x16x32_bf16 v[76:79], a[236:239], a[180:183], v[76:79]
    s_waitcnt lgkmcnt(4)
    v_mul_f32 v43, v43, v41
    v_cvt_pk_bf16_f32 v54, v42, v43
    v_mfma_f32_16x16x32_bf16 v[68:71], a[236:239], a[176:179], v[68:71]
    buffer_load_dwordx4 a[144:147], v14, s[20:23], s46 offen sc1
    v_mfma_f32_16x16x32_bf16 v[68:71], a[232:235], a[160:163], v[68:71]
    ds_read_b64_tr_b16 a[232:233], v8 offset:25600
    v_lshlrev_b32 v42, 16, v55
    v_mfma_f32_16x16x32_bf16 v[96:99], a[240:243], a[160:163], v[96:99]
    ds_read_b64_tr_b16 a[234:235], v8 offset:31744
    v_and_b32 v43, 0xffff0000, v55
    v_mfma_f32_16x16x32_bf16 v[96:99], a[244:247], a[176:179], v[96:99]
    ds_read_b64_tr_b16 a[236:237], v8 offset:37888
    v_sub_f32 v42, v42, v40
    v_mfma_f32_16x16x32_bf16 v[104:107], a[244:247], a[180:183], v[104:107]
    ds_read_b64_tr_b16 a[238:239], v8 offset:44032
    v_sub_f32 v43, v43, v40
    v_mfma_f32_16x16x32_bf16 v[104:107], a[240:243], a[164:167], v[104:107]
    v_cvt_pk_bf16_f32 v42, 0, v42
    v_cvt_pk_bf16_f32 v43, 0, v43
    v_mfma_f32_16x16x32_bf16 v[112:115], a[240:243], a[168:171], v[112:115]
    buffer_load_dwordx4 a[148:151], v14, s[20:23], s77 offen sc1
    v_mfma_f32_16x16x32_bf16 v[112:115], a[244:247], a[184:187], v[112:115]
    s_waitcnt lgkmcnt(4)
    v_mul_f32 v42, v42, v41
    v_mul_f32 v43, v43, v41
    v_mfma_f32_16x16x32_bf16 v[120:123], a[244:247], a[188:191], v[120:123]
    v_cvt_pk_bf16_f32 v55, v42, v43
    v_mfma_f32_16x16x32_bf16 v[120:123], a[240:243], a[172:175], v[120:123]
    ds_read_b64_tr_b16 a[240:241], v9 offset:25600
    v_mfma_f32_16x16x32_bf16 v[124:127], a[224:227], a[172:175], v[124:127]
    ds_read_b64_tr_b16 a[242:243], v9 offset:31744
    v_mfma_f32_16x16x32_bf16 v[124:127], a[228:231], a[188:191], v[124:127]
    ds_read_b64_tr_b16 a[244:245], v9 offset:37888
    v_mfma_f32_16x16x32_bf16 v[116:119], a[228:231], a[184:187], v[116:119]
    buffer_load_dwordx4 a[152:155], v15, s[20:23], s46 offen sc1
    v_mfma_f32_16x16x32_bf16 v[116:119], a[224:227], a[168:171], v[116:119]
    ds_read_b64_tr_b16 a[246:247], v9 offset:44032
    v_mfma_f32_16x16x32_bf16 v[108:111], a[224:227], a[164:167], v[108:111]
    v_mfma_f32_16x16x32_bf16 v[108:111], a[228:231], a[180:183], v[108:111]
    s_waitcnt lgkmcnt(4)
    v_mfma_f32_16x16x32_bf16 v[100:103], a[228:231], a[176:179], v[100:103]
    v_mfma_f32_16x16x32_bf16 v[100:103], a[224:227], a[160:163], v[100:103]
    ds_read_b64_tr_b16 a[224:225], v10 offset:25600
    v_mfma_f32_16x16x32_bf16 v[128:131], a[232:235], a[160:163], v[128:131]
    buffer_load_dwordx4 a[156:159], v15, s[20:23], s77 offen sc1
    v_mfma_f32_16x16x32_bf16 v[128:131], a[236:239], a[176:179], v[128:131]
    s_add_u32 m0, s49, 0
    ds_read_b64_tr_b16 a[226:227], v10 offset:31744
    v_mfma_f32_16x16x32_bf16 v[136:139], a[236:239], a[180:183], v[136:139]
    ds_read_b64_tr_b16 a[228:229], v10 offset:37888
    v_mfma_f32_16x16x32_bf16 v[136:139], a[232:235], a[164:167], v[136:139]
    ds_read_b64_tr_b16 a[230:231], v10 offset:44032
    v_mfma_f32_16x16x32_bf16 v[144:147], a[232:235], a[168:171], v[144:147]
    v_mfma_f32_16x16x32_bf16 v[144:147], a[236:239], a[184:187], v[144:147]
    s_waitcnt lgkmcnt(4)
    v_mfma_f32_16x16x32_bf16 v[152:155], a[236:239], a[188:191], v[152:155]
    buffer_load_dwordx4 v4, s[12:15], s38 offen offset:0 lds
    v_mfma_f32_16x16x32_bf16 v[152:155], a[232:235], a[172:175], v[152:155]
    s_addk_i32 m0, 896
    ds_read_b64_tr_b16 a[232:233], v11 offset:25600
    v_mfma_f32_16x16x32_bf16 v[156:159], a[240:243], a[172:175], v[156:159]
    ds_read_b64_tr_b16 a[234:235], v11 offset:31744
    v_mfma_f32_16x16x32_bf16 v[156:159], a[244:247], a[188:191], v[156:159]
    ds_read_b64_tr_b16 a[236:237], v11 offset:37888
    v_mfma_f32_16x16x32_bf16 v[148:151], a[244:247], a[184:187], v[148:151]
    ds_read_b64_tr_b16 a[238:239], v11 offset:44032
    v_mfma_f32_16x16x32_bf16 v[148:151], a[240:243], a[168:171], v[148:151]
    v_mfma_f32_16x16x32_bf16 v[140:143], a[240:243], a[164:167], v[140:143]
    buffer_load_dwordx4 v4, s[12:15], s38 offen offset:128 lds
    v_mfma_f32_16x16x32_bf16 v[140:143], a[244:247], a[180:183], v[140:143]
    s_waitcnt lgkmcnt(4)
    s_addk_i32 m0, 896
    v_mfma_f32_16x16x32_bf16 v[132:135], a[244:247], a[176:179], v[132:135]
    v_mfma_f32_16x16x32_bf16 v[132:135], a[240:243], a[160:163], v[132:135]
    ds_read_b64_tr_b16 a[240:241], v8 offset:26624
    v_mfma_f32_16x16x32_bf16 v[160:163], a[224:227], a[160:163], v[160:163]
    ds_read_b64_tr_b16 a[242:243], v8 offset:32768
    v_mfma_f32_16x16x32_bf16 v[160:163], a[228:231], a[176:179], v[160:163]
    ds_read_b64_tr_b16 a[244:245], v8 offset:38912
    v_mfma_f32_16x16x32_bf16 v[168:171], a[228:231], a[180:183], v[168:171]
    buffer_load_dwordx4 v4, s[12:15], s38 offen offset:256 lds
    v_mfma_f32_16x16x32_bf16 v[168:171], a[224:227], a[164:167], v[168:171]
    s_addk_i32 m0, 1280
    ds_read_b64_tr_b16 a[246:247], v8 offset:45056
    v_mfma_f32_16x16x32_bf16 v[176:179], a[224:227], a[168:171], v[176:179]
    ds_read_b64_tr_b16 v[32:33], v25 offset:0
    v_mfma_f32_16x16x32_bf16 v[176:179], a[228:231], a[184:187], v[176:179]
    s_waitcnt lgkmcnt(5)
    ds_read_b64_tr_b16 v[34:35], v25 offset:4096
    v_mfma_f32_16x16x32_bf16 v[184:187], a[228:231], a[188:191], v[184:187]
    ds_read_b64_tr_b16 v[36:37], v25 offset:1024
    v_mfma_f32_16x16x32_bf16 v[184:187], a[224:227], a[172:175], v[184:187]
    ds_read_b64_tr_b16 v[38:39], v25 offset:5120
    v_mfma_f32_16x16x32_bf16 v[188:191], a[232:235], a[172:175], v[188:191]
    buffer_load_dwordx4 v5, s[12:15], s38 offen offset:0 lds
    v_mfma_f32_16x16x32_bf16 v[188:191], a[236:239], a[188:191], v[188:191]
    s_addk_i32 m0, 896
    ds_read_b64_tr_b16 v[40:41], v25 offset:8192
    v_mfma_f32_16x16x32_bf16 v[180:183], a[236:239], a[184:187], v[180:183]
    ds_read_b64_tr_b16 v[42:43], v25 offset:12288
    v_mfma_f32_16x16x32_bf16 v[180:183], a[232:235], a[168:171], v[180:183]
    ds_read_b64_tr_b16 v[44:45], v25 offset:9216
    v_mfma_f32_16x16x32_bf16 v[172:175], a[232:235], a[164:167], v[172:175]
    s_waitcnt lgkmcnt(5)
    ds_read_b64_tr_b16 v[46:47], v25 offset:13312
    ds_read_b64_tr_b16 a[224:225], v9 offset:26624
    v_mfma_f32_16x16x32_bf16 v[172:175], a[236:239], a[180:183], v[172:175]
    ds_read_b64_tr_b16 a[226:227], v9 offset:32768
    v_mfma_f32_16x16x32_bf16 v[164:167], a[236:239], a[176:179], v[164:167]
    ds_read_b64_tr_b16 a[228:229], v9 offset:38912
    v_mfma_f32_16x16x32_bf16 v[164:167], a[232:235], a[160:163], v[164:167]
    ds_read_b64_tr_b16 a[230:231], v9 offset:45056
    v_mfma_f32_16x16x32_bf16 v[192:195], a[240:243], a[160:163], v[192:195]
    ds_read_b64_tr_b16 a[232:233], v10 offset:26624
    v_mfma_f32_16x16x32_bf16 v[192:195], a[244:247], a[176:179], v[192:195]
    s_waitcnt lgkmcnt(7)
    ds_read_b64_tr_b16 a[234:235], v10 offset:32768
    v_mfma_f32_16x16x32_bf16 v[200:203], a[244:247], a[180:183], v[200:203]
    ds_read_b64_tr_b16 a[236:237], v10 offset:38912
    v_mfma_f32_16x16x32_bf16 v[200:203], a[240:243], a[164:167], v[200:203]
    ds_read_b64_tr_b16 a[238:239], v10 offset:45056
    v_mfma_f32_16x16x32_bf16 v[208:211], a[240:243], a[168:171], v[208:211]
    buffer_load_dwordx4 v5, s[12:15], s38 offen offset:128 lds
    v_mfma_f32_16x16x32_bf16 v[208:211], a[244:247], a[184:187], v[208:211]
    s_waitcnt lgkmcnt(5)
    v_add_u32 v8, 49152, v8
    s_addk_i32 m0, 896
    v_mfma_f32_16x16x32_bf16 v[216:219], a[244:247], a[188:191], v[216:219]
    buffer_load_dwordx4 v5, s[12:15], s38 offen offset:256 lds
    v_mfma_f32_16x16x32_bf16 v[216:219], a[240:243], a[172:175], v[216:219]
    s_waitcnt lgkmcnt(3)
    ds_read_b64_tr_b16 a[240:241], v11 offset:26624
    s_add_u32 s38, s38, 24576
    ds_read_b64_tr_b16 a[242:243], v11 offset:32768
    v_mfma_f32_16x16x32_bf16 v[220:223], a[224:227], a[172:175], v[220:223]
    s_addk_i32 m0, 19712
    ds_read_b64_tr_b16 a[244:245], v11 offset:38912
    ds_read_b64_tr_b16 a[246:247], v11 offset:45056
    v_mfma_f32_16x16x32_bf16 v[220:223], a[228:231], a[188:191], v[220:223]
    v_add_u32 v9, 49152, v9
    v_mfma_f32_16x16x32_bf16 v[212:215], a[228:231], a[184:187], v[212:215]
    buffer_load_dwordx4 v4, s[12:15], s38 offen offset:0 lds
    v_mfma_f32_16x16x32_bf16 v[212:215], a[224:227], a[168:171], v[212:215]
    s_addk_i32 m0, 896
    v_add_u32 v10, 49152, v10
    v_mfma_f32_16x16x32_bf16 v[204:207], a[224:227], a[164:167], v[204:207]
    v_add_u32 v11, 49152, v11
    v_mfma_f32_16x16x32_bf16 v[204:207], a[228:231], a[180:183], v[204:207]
    s_waitcnt lgkmcnt(4)
    v_mfma_f32_16x16x32_bf16 v[196:199], a[228:231], a[176:179], v[196:199]
    s_waitcnt lgkmcnt(0)
    s_barrier
    v_mfma_f32_16x16x32_bf16 v[196:199], a[224:227], a[160:163], v[196:199]
    ds_read_b64_tr_b16 a[224:225], v8 offset:0
    v_mfma_f32_16x16x32_bf16 v[224:227], a[232:235], a[160:163], v[224:227]
    buffer_load_dwordx4 v4, s[12:15], s38 offen offset:128 lds
    v_mfma_f32_16x16x32_bf16 v[224:227], a[236:239], a[176:179], v[224:227]
    s_addk_i32 m0, 896
    ds_read_b64_tr_b16 a[226:227], v8 offset:6144
    v_mfma_f32_16x16x32_bf16 v[232:235], a[236:239], a[180:183], v[232:235]
    ds_read_b64_tr_b16 a[228:229], v8 offset:12288
    v_mfma_f32_16x16x32_bf16 v[232:235], a[232:235], a[164:167], v[232:235]
    ds_read_b64_tr_b16 a[230:231], v8 offset:18432
    v_mfma_f32_16x16x32_bf16 v[240:243], a[232:235], a[168:171], v[240:243]
    v_mfma_f32_16x16x32_bf16 v[240:243], a[236:239], a[184:187], v[240:243]
    v_mfma_f32_16x16x32_bf16 v[248:251], a[236:239], a[188:191], v[248:251]
    buffer_load_dwordx4 v4, s[12:15], s38 offen offset:256 lds
    v_mfma_f32_16x16x32_bf16 v[248:251], a[232:235], a[172:175], v[248:251]
    s_addk_i32 m0, 1280
    ds_read_b64_tr_b16 a[232:233], v8 offset:24576
    v_mfma_f32_16x16x32_bf16 v[20:23], v[48:51], v[32:35], 0
    ds_read_b64_tr_b16 a[234:235], v8 offset:30720
    v_mfma_f32_16x16x32_bf16 v[58:61], v[48:51], v[36:39], 0
    ds_read_b64_tr_b16 a[236:237], v8 offset:36864
    v_mfma_f32_16x16x32_bf16 v[20:23], v[52:55], v[40:43], v[20:23]
    ds_read_b64_tr_b16 a[238:239], v8 offset:43008
    v_mfma_f32_16x16x32_bf16 v[58:61], v[52:55], v[44:47], v[58:61]
    v_mfma_f32_16x16x32_bf16 v[252:255], a[240:243], a[172:175], v[252:255]
    buffer_load_dwordx4 v5, s[12:15], s38 offen offset:0 lds
    v_mfma_f32_16x16x32_bf16 v[252:255], a[244:247], a[188:191], v[252:255]
    s_addk_i32 m0, 896
    v_lshlrev_b32 v14, 4, v1
    v_min_u32 v15, 1, v1
    v_mfma_f32_16x16x32_bf16 v[244:247], a[244:247], a[184:187], v[244:247]
    s_mul_i32 s56, s53, 983040
    v_mov_b32 v22, v58
    v_mov_b32 v23, v59
    v_mfma_f32_16x16x32_bf16 v[244:247], a[240:243], a[168:171], v[244:247]
    buffer_store_dwordx4 v[20:23], v26, s[24:27], s62 offen sc1
    v_mov_b32 v26, s7
    v_mfma_f32_16x16x32_bf16 v[236:239], a[240:243], a[164:167], v[236:239]
    s_mul_i32 s57, s51, 320
    v_lshrrev_b32 v21, 3, v1
    v_mul_u32_u24 v21, 1280, v21
    v_mfma_f32_16x16x32_bf16 v[236:239], a[244:247], a[180:183], v[236:239]
    s_waitcnt vmcnt(26) lgkmcnt(0)
    v_and_b32 v22, 16, v1
    v_lshlrev_b32 v22, 1, v22
    v_mfma_f32_16x16x32_bf16 v[228:231], a[244:247], a[176:179], v[228:231]
    buffer_load_dwordx4 v5, s[12:15], s38 offen offset:128 lds
    v_mfma_f32_16x16x32_bf16 v[228:231], a[240:243], a[160:163], v[228:231]
    s_waitcnt vmcnt(22)
    ds_read_b64_tr_b16 a[240:241], v9 offset:0
    v_lshlrev_b32 v15, 30, v15
    v_mfma_f32_16x16x32_bf16 v[64:67], a[224:227], a[96:99], v[64:67]
    s_addk_i32 m0, 896
    ds_read_b64_tr_b16 a[242:243], v9 offset:6144
    v_and_b32 v20, 1, v1
    v_mfma_f32_16x16x32_bf16 v[64:67], a[228:231], a[112:115], v[64:67]
    s_add_u32 s56, s56, s57
    ds_read_b64_tr_b16 a[244:245], v9 offset:12288
    v_mul_u32_u24 v20, 0xaaaa, v20
    v_mfma_f32_16x16x32_bf16 v[72:75], a[228:231], a[116:119], v[72:75]
    s_waitcnt vmcnt(21)
    ds_read_b64_tr_b16 a[246:247], v9 offset:18432
    v_add_u32 v20, 0x4444, v20
    v_mfma_f32_16x16x32_bf16 v[72:75], a[224:227], a[100:103], v[72:75]
    s_waitcnt vmcnt(20)
    s_add_u32 s39, s40, 0
    s_sub_u32 s57, 7864320, s56
    v_mfma_f32_16x16x32_bf16 v[80:83], a[224:227], a[104:107], v[80:83]
    buffer_load_dwordx4 v5, s[12:15], s38 offen offset:256 lds
    v_mfma_f32_16x16x32_bf16 v[80:83], a[228:231], a[120:123], v[80:83]
    s_waitcnt vmcnt(17)
    s_add_u32 s38, s38, 24576
    s_add_u32 m0, s63, 73728
    v_mfma_f32_16x16x32_bf16 v[88:91], a[228:231], a[124:127], v[88:91]
    s_waitcnt vmcnt(13)
    s_mov_b32 s10, s57
    s_mov_b32 s11, 0x00020000
    v_mfma_f32_16x16x32_bf16 v[88:91], a[224:227], a[108:111], v[88:91]
    s_add_u32 s8, s72, s56
    s_addc_u32 s9, s73, 0
    s_and_b32 s9, s9, 0xffff
    v_mfma_f32_16x16x32_bf16 v[88:91], a[232:235], a[140:143], v[88:91]
    s_mul_i32 s56, s53, 983040
    ds_read_b64_tr_b16 a[224:225], v9 offset:24576
    s_mov_b32 s34, 983040
    v_mfma_f32_16x16x32_bf16 v[88:91], a[236:239], a[156:159], v[88:91]
    s_add_u32 s32, s72, s56
    s_addc_u32 s33, s73, 0
    s_and_b32 s33, s33, 0xffff
    v_mfma_f32_16x16x32_bf16 v[80:83], a[236:239], a[152:155], v[80:83]
    buffer_load_dwordx4 v6, s[16:19], s39 offen lds
    v_mfma_f32_16x16x32_bf16 v[80:83], a[232:235], a[136:139], v[80:83]
    s_add_u32 s39, s40, 12288
    ds_read_b64_tr_b16 a[226:227], v9 offset:30720
    v_cvt_pk_bf16_f32 v88, v88, v89
    v_mfma_f32_16x16x32_bf16 v[72:75], a[232:235], a[132:135], v[72:75]
    s_addk_i32 m0, 4096
    ds_read_b64_tr_b16 a[228:229], v9 offset:36864
    v_cvt_pk_bf16_f32 v89, v90, v91
    v_mfma_f32_16x16x32_bf16 v[72:75], a[236:239], a[148:151], v[72:75]
    s_waitcnt lgkmcnt(3)
    ds_read_b64_tr_b16 a[230:231], v9 offset:43008
    v_cvt_pk_bf16_f32 v80, v80, v81
    v_mfma_f32_16x16x32_bf16 v[64:67], a[236:239], a[144:147], v[64:67]
    s_mov_b32 s35, 0x00020000
    v_cvt_pk_bf16_f32 v81, v82, v83
    s_mul_i32 s56, s53, 3145728
    v_mfma_f32_16x16x32_bf16 v[64:67], a[232:235], a[128:131], v[64:67]
    s_add_u32 s56, s56, 16777216
    ds_read_b64_tr_b16 a[232:233], v10 offset:0
    v_cvt_pk_bf16_f32 v72, v72, v73
    v_mfma_f32_16x16x32_bf16 v[68:71], a[240:243], a[96:99], v[68:71]
    buffer_load_dwordx4 v6, s[16:19], s39 offen lds
    v_mfma_f32_16x16x32_bf16 v[68:71], a[244:247], a[112:115], v[68:71]
    s_add_u32 s39, s40, 24576
    ds_read_b64_tr_b16 a[234:235], v10 offset:6144
    v_cvt_pk_bf16_f32 v64, v64, v65
    v_mfma_f32_16x16x32_bf16 v[76:79], a[244:247], a[116:119], v[76:79]
    s_addk_i32 m0, 4096
    ds_read_b64_tr_b16 a[236:237], v10 offset:12288
    v_cvt_pk_bf16_f32 v65, v66, v67
    v_mfma_f32_16x16x32_bf16 v[76:79], a[240:243], a[100:103], v[76:79]
    s_add_u32 s20, s86, s56
    s_addc_u32 s21, s87, 0
    v_cvt_pk_bf16_f32 v73, v74, v75
    v_mfma_f32_16x16x32_bf16 v[84:87], a[240:243], a[104:107], v[84:87]
    s_and_b32 s21, s21, 0xffff
    ds_read_b64_tr_b16 a[238:239], v10 offset:18432
    s_mov_b32 s22, 3145728
    v_mfma_f32_16x16x32_bf16 v[84:87], a[244:247], a[120:123], v[84:87]
    s_waitcnt lgkmcnt(4)
    s_mov_b32 s23, 0x00020000
    s_lshl_b32 s55, s51, 5
    v_mfma_f32_16x16x32_bf16 v[92:95], a[244:247], a[124:127], v[92:95]
    buffer_load_dwordx4 v6, s[16:19], s39 offen lds
    v_mfma_f32_16x16x32_bf16 v[92:95], a[240:243], a[108:111], v[92:95]
    s_add_u32 s39, s40, 36864
    ds_read_b64_tr_b16 a[240:241], v10 offset:24576
    s_addk_i32 m0, 4096
    v_mfma_f32_16x16x32_bf16 v[92:95], a[224:227], a[140:143], v[92:95]
    s_add_u32 s55, s55, s54
    ds_read_b64_tr_b16 a[242:243], v10 offset:30720
    s_mul_i32 s55, s55, 24576
    v_mfma_f32_16x16x32_bf16 v[92:95], a[228:231], a[156:159], v[92:95]
    s_lshr_b32 s50, s53, 1
    ds_read_b64_tr_b16 a[244:245], v10 offset:36864
    s_xor_b32 s67, s50, 3
    v_mfma_f32_16x16x32_bf16 v[84:87], a[228:231], a[152:155], v[84:87]
    s_lshl_b32 s67, s67, 10
    ds_read_b64_tr_b16 a[246:247], v10 offset:43008
    s_add_u32 s56, s51, 0
    v_mfma_f32_16x16x32_bf16 v[84:87], a[224:227], a[136:139], v[84:87]
    s_and_b32 s56, s56, 3
    v_cvt_pk_bf16_f32 v90, v92, v93
    v_cvt_pk_bf16_f32 v91, v94, v95
    v_mfma_f32_16x16x32_bf16 v[76:79], a[224:227], a[132:135], v[76:79]
    buffer_load_dwordx4 v6, s[16:19], s39 offen lds
    v_mfma_f32_16x16x32_bf16 v[76:79], a[228:231], a[148:151], v[76:79]
    s_waitcnt lgkmcnt(4)
    v_permlane16_swap_b32 v88, v90
    v_mfma_f32_16x16x32_bf16 v[68:71], a[228:231], a[144:147], v[68:71]
    s_mul_i32 s44, s56, 245760
    v_permlane16_swap_b32 v89, v91
    v_mfma_f32_16x16x32_bf16 v[68:71], a[224:227], a[128:131], v[68:71]
    s_add_u32 s56, s51, 1
    ds_read_b64_tr_b16 a[224:225], v11 offset:0
    v_cvt_pk_bf16_f32 v74, v76, v77
    v_mfma_f32_16x16x32_bf16 v[96:99], a[232:235], a[96:99], v[96:99]
    s_and_b32 s56, s56, 3
    ds_read_b64_tr_b16 a[226:227], v11 offset:6144
    v_cvt_pk_bf16_f32 v75, v78, v79
    v_mfma_f32_16x16x32_bf16 v[96:99], a[236:239], a[112:115], v[96:99]
    s_mul_i32 s45, s56, 245760
    ds_read_b64_tr_b16 a[228:229], v11 offset:12288
    v_cvt_pk_bf16_f32 v66, v68, v69
    v_mfma_f32_16x16x32_bf16 v[104:107], a[236:239], a[116:119], v[104:107]
    s_lshl_b32 s56, s56, 5
    ds_read_b64_tr_b16 a[230:231], v11 offset:18432
    v_cvt_pk_bf16_f32 v67, v70, v71
    v_mfma_f32_16x16x32_bf16 v[104:107], a[232:235], a[100:103], v[104:107]
    s_add_u32 s56, s56, s54
    v_permlane16_swap_b32 v64, v66
    v_mfma_f32_16x16x32_bf16 v[112:115], a[232:235], a[104:107], v[112:115]
    s_mul_i32 s59, s56, 24576
    v_permlane16_swap_b32 v65, v67
    v_mfma_f32_16x16x32_bf16 v[112:115], a[236:239], a[120:123], v[112:115]
    s_waitcnt lgkmcnt(4)
    v_permlane16_swap_b32 v72, v74
    v_mfma_f32_16x16x32_bf16 v[120:123], a[236:239], a[124:127], v[120:123]
    s_add_u32 s56, s51, 2
    v_permlane16_swap_b32 v73, v75
    v_mfma_f32_16x16x32_bf16 v[120:123], a[232:235], a[108:111], v[120:123]
    s_and_b32 s56, s56, 3
    ds_read_b64_tr_b16 a[232:233], v11 offset:24576
    v_cvt_pk_bf16_f32 v82, v84, v85
    v_mfma_f32_16x16x32_bf16 v[120:123], a[240:243], a[140:143], v[120:123]
    s_mul_i32 s46, s56, 245760
    ds_read_b64_tr_b16 a[234:235], v11 offset:30720
    v_cvt_pk_bf16_f32 v83, v86, v87
    v_mfma_f32_16x16x32_bf16 v[120:123], a[244:247], a[156:159], v[120:123]
    s_lshl_b32 s56, s56, 5
    ds_read_b64_tr_b16 a[236:237], v11 offset:36864
    v_accvgpr_write_b32 a0, v64
    v_mfma_f32_16x16x32_bf16 v[112:115], a[244:247], a[152:155], v[112:115]
    s_add_u32 s56, s56, s54
    ds_read_b64_tr_b16 a[238:239], v11 offset:43008
    v_accvgpr_write_b32 a1, v65
    v_mfma_f32_16x16x32_bf16 v[112:115], a[240:243], a[136:139], v[112:115]
    s_mul_i32 s60, s56, 24576
    v_permlane16_swap_b32 v80, v82
    v_mfma_f32_16x16x32_bf16 v[104:107], a[240:243], a[132:135], v[104:107]
    s_add_u32 s56, s51, 3
    v_permlane16_swap_b32 v81, v83
    v_mfma_f32_16x16x32_bf16 v[104:107], a[244:247], a[148:151], v[104:107]
    s_waitcnt lgkmcnt(4)
    v_accvgpr_write_b32 a2, v66
    v_accvgpr_write_b32 a3, v67
    v_mfma_f32_16x16x32_bf16 v[96:99], a[244:247], a[144:147], v[96:99]
    s_and_b32 s56, s56, 3
    v_accvgpr_write_b32 a4, v72
    v_accvgpr_write_b32 a5, v73
    v_mfma_f32_16x16x32_bf16 v[96:99], a[240:243], a[128:131], v[96:99]
    s_mul_i32 s47, s56, 245760
    ds_read_b64_tr_b16 a[240:241], v8 offset:1024
    v_accvgpr_write_b32 a6, v74
    v_mfma_f32_16x16x32_bf16 v[100:103], a[224:227], a[96:99], v[100:103]
    s_lshl_b32 s56, s56, 5
    ds_read_b64_tr_b16 a[242:243], v8 offset:7168
    v_accvgpr_write_b32 a7, v75
    v_mfma_f32_16x16x32_bf16 v[100:103], a[228:231], a[112:115], v[100:103]
    s_add_u32 s56, s56, s54
    ds_read_b64_tr_b16 a[244:245], v8 offset:13312
    v_accvgpr_write_b32 a8, v80
    v_mfma_f32_16x16x32_bf16 v[108:111], a[228:231], a[116:119], v[108:111]
    s_mul_i32 s61, s56, 24576
    ds_read_b64_tr_b16 a[246:247], v8 offset:19456
    v_accvgpr_write_b32 a9, v81
    v_mfma_f32_16x16x32_bf16 v[108:111], a[224:227], a[100:103], v[108:111]
    s_mov_b32 s72, s7
    v_accvgpr_write_b32 a10, v82
    v_accvgpr_write_b32 a11, v83
    v_mfma_f32_16x16x32_bf16 v[116:119], a[224:227], a[104:107], v[116:119]
    s_mov_b32 s73, s7
    v_accvgpr_write_b32 a12, v88
    v_accvgpr_write_b32 a13, v89
    v_mfma_f32_16x16x32_bf16 v[116:119], a[228:231], a[120:123], v[116:119]
    s_waitcnt lgkmcnt(4)
    v_accvgpr_write_b32 a14, v90
    v_accvgpr_write_b32 a15, v91
    v_mfma_f32_16x16x32_bf16 v[124:127], a[228:231], a[124:127], v[124:127]
    s_mov_b32 s74, s7
    v_cvt_pk_bf16_f32 v96, v96, v97
    v_cvt_pk_bf16_f32 v97, v98, v99
    v_mfma_f32_16x16x32_bf16 v[124:127], a[224:227], a[108:111], v[124:127]
    s_mov_b32 s75, s7
    ds_read_b64_tr_b16 a[224:225], v8 offset:25600
    v_cvt_pk_bf16_f32 v104, v104, v105
    v_mfma_f32_16x16x32_bf16 v[124:127], a[232:235], a[140:143], v[124:127]
    s_lshl_b32 s56, s50, 6
    ds_read_b64_tr_b16 a[226:227], v8 offset:31744
    v_cvt_pk_bf16_f32 v105, v106, v107
    v_mfma_f32_16x16x32_bf16 v[124:127], a[236:239], a[156:159], v[124:127]
    s_xor_b32 s56, s56, 192
    ds_read_b64_tr_b16 a[228:229], v8 offset:37888
    v_xor_b32 v2, s56, v7
    v_mfma_f32_16x16x32_bf16 v[116:119], a[236:239], a[152:155], v[116:119]
    s_and_b32 s56, s51, 1
    ds_read_b64_tr_b16 a[230:231], v8 offset:44032
    v_xor_b32 v3, 128, v2
    v_mfma_f32_16x16x32_bf16 v[116:119], a[232:235], a[136:139], v[116:119]
    s_lshl_b32 s56, s56, 6
    v_cvt_pk_bf16_f32 v112, v112, v113
    v_cvt_pk_bf16_f32 v113, v114, v115
    v_mfma_f32_16x16x32_bf16 v[108:111], a[232:235], a[132:135], v[108:111]
    s_mul_i32 s57, s3, 10240
    v_cvt_pk_bf16_f32 v120, v120, v121
    v_cvt_pk_bf16_f32 v121, v122, v123
    v_mfma_f32_16x16x32_bf16 v[108:111], a[236:239], a[148:151], v[108:111]
    s_waitcnt lgkmcnt(4)
    v_cvt_pk_bf16_f32 v114, v116, v117
    v_cvt_pk_bf16_f32 v115, v118, v119
    v_mfma_f32_16x16x32_bf16 v[100:103], a[236:239], a[144:147], v[100:103]
    s_add_u32 s56, s56, s57
    v_permlane16_swap_b32 v112, v114
    v_mfma_f32_16x16x32_bf16 v[100:103], a[232:235], a[128:131], v[100:103]
    s_and_b32 s57, s3, 1
    ds_read_b64_tr_b16 a[232:233], v9 offset:1024
    v_add_u32 v21, s56, v21
    v_mfma_f32_16x16x32_bf16 v[128:131], a[240:243], a[96:99], v[128:131]
    s_and_b32 s56, s51, 1
    ds_read_b64_tr_b16 a[234:235], v9 offset:7168
    v_add_u32 v2, v2, v21
    v_mfma_f32_16x16x32_bf16 v[128:131], a[244:247], a[112:115], v[128:131]
    s_xor_b32 s56, s56, 1
    ds_read_b64_tr_b16 a[236:237], v9 offset:13312
    v_add_u32 v3, v3, v21
    v_mfma_f32_16x16x32_bf16 v[136:139], a[244:247], a[116:119], v[136:139]
    s_lshl_b32 s56, s56, 8
    ds_read_b64_tr_b16 a[238:239], v9 offset:19456
    v_and_b32 v21, 3, v1
    v_mfma_f32_16x16x32_bf16 v[136:139], a[240:243], a[100:103], v[136:139]
pg_4:
    s_cbranch_execz pg_8
    s_mul_i32 s57, s57, 20480
    v_lshlrev_b32 v21, 4, v21
    v_xor_b32 v21, v21, v22
    v_mfma_f32_16x16x32_bf16 v[144:147], a[240:243], a[104:107], v[144:147]
    s_add_u32 s56, s56, s57
    v_lshrrev_b32 v22, 2, v1
    v_mul_u32_u24 v22, 1280, v22
    v_mfma_f32_16x16x32_bf16 v[144:147], a[244:247], a[120:123], v[144:147]
    s_waitcnt lgkmcnt(4)
    v_add_u32 v21, v21, v22
    v_add_u32 v7, s56, v21
    v_mfma_f32_16x16x32_bf16 v[152:155], a[244:247], a[124:127], v[152:155]
    s_lshr_b32 s42, s2, 3
    v_mov_b32 v21, 0x3f803f80
    v_accvgpr_write_b32 a248, v21
    v_mfma_f32_16x16x32_bf16 v[152:155], a[240:243], a[108:111], v[152:155]
    s_lshl_b32 s42, s42, 2
    ds_read_b64_tr_b16 a[240:241], v9 offset:25600
    v_accvgpr_write_b32 a249, v21
    v_mfma_f32_16x16x32_bf16 v[152:155], a[224:227], a[140:143], v[152:155]
    s_add_u32 s42, s42, s3
    ds_read_b64_tr_b16 a[242:243], v9 offset:31744
    v_accvgpr_write_b32 a250, v21
    v_mfma_f32_16x16x32_bf16 v[152:155], a[228:231], a[156:159], v[152:155]
    s_mul_i32 s42, s42, 7680
    ds_read_b64_tr_b16 a[244:245], v9 offset:37888
    v_accvgpr_write_b32 a251, v21
    v_mfma_f32_16x16x32_bf16 v[144:147], a[228:231], a[152:155], v[144:147]
    ds_read_b64_tr_b16 a[246:247], v9 offset:44032
    v_min_u32 v22, 11, v1
    v_mfma_f32_16x16x32_bf16 v[144:147], a[224:227], a[136:139], v[144:147]
    v_lshlrev_b32 v22, 7, v22
    v_cvt_pk_bf16_f32 v98, v100, v101
    v_mfma_f32_16x16x32_bf16 v[136:139], a[224:227], a[132:135], v[136:139]
    v_permlane16_swap_b32 v113, v115
    v_mfma_f32_16x16x32_bf16 v[136:139], a[228:231], a[148:151], v[136:139]
    s_waitcnt lgkmcnt(4)
    v_permlane16_swap_b32 v96, v98
    v_mfma_f32_16x16x32_bf16 v[128:131], a[228:231], a[144:147], v[128:131]
    v_cvt_pk_bf16_f32 v99, v102, v103
    v_cvt_pk_bf16_f32 v106, v108, v109
    v_mfma_f32_16x16x32_bf16 v[128:131], a[224:227], a[128:131], v[128:131]
    ds_read_b64_tr_b16 a[224:225], v10 offset:1024
    v_cvt_pk_bf16_f32 v107, v110, v111
    v_mfma_f32_16x16x32_bf16 v[132:135], a[232:235], a[96:99], v[132:135]
    ds_read_b64_tr_b16 a[226:227], v10 offset:7168
    v_accvgpr_write_b32 a16, v96
    v_mfma_f32_16x16x32_bf16 v[132:135], a[236:239], a[112:115], v[132:135]
    ds_read_b64_tr_b16 a[228:229], v10 offset:13312
    v_accvgpr_write_b32 a18, v98
    v_mfma_f32_16x16x32_bf16 v[140:143], a[236:239], a[116:119], v[140:143]
    ds_read_b64_tr_b16 a[230:231], v10 offset:19456
    v_cvt_pk_bf16_f32 v122, v124, v125
    v_mfma_f32_16x16x32_bf16 v[140:143], a[232:235], a[100:103], v[140:143]
    v_permlane16_swap_b32 v97, v99
    v_mfma_f32_16x16x32_bf16 v[148:151], a[232:235], a[104:107], v[148:151]
    v_permlane16_swap_b32 v104, v106
    v_mfma_f32_16x16x32_bf16 v[148:151], a[236:239], a[120:123], v[148:151]
    s_waitcnt lgkmcnt(4)
    v_permlane16_swap_b32 v105, v107
    v_mfma_f32_16x16x32_bf16 v[156:159], a[236:239], a[124:127], v[156:159]
    s_waitcnt vmcnt(6)
    v_permlane16_swap_b32 v120, v122
    v_mfma_f32_16x16x32_bf16 v[156:159], a[232:235], a[108:111], v[156:159]
    buffer_store_dword v26, v27, s[24:27], s4 offen offset:144 sc1
    v_mfma_f32_16x16x32_bf16 v[156:159], a[240:243], a[140:143], v[156:159]
    ds_read_b64_tr_b16 a[232:233], v10 offset:25600
    v_accvgpr_write_b32 a17, v97
    v_mfma_f32_16x16x32_bf16 v[156:159], a[244:247], a[156:159], v[156:159]
    ds_read_b64_tr_b16 a[234:235], v10 offset:31744
    v_accvgpr_write_b32 a19, v99
    v_mfma_f32_16x16x32_bf16 v[148:151], a[244:247], a[152:155], v[148:151]
    ds_read_b64_tr_b16 a[236:237], v10 offset:37888
    v_cvt_pk_bf16_f32 v123, v126, v127
    v_mfma_f32_16x16x32_bf16 v[148:151], a[240:243], a[136:139], v[148:151]
    ds_read_b64_tr_b16 a[238:239], v10 offset:44032
    v_accvgpr_write_b32 a20, v104
    v_mfma_f32_16x16x32_bf16 v[140:143], a[240:243], a[132:135], v[140:143]
    v_permlane16_swap_b32 v121, v123
    v_mfma_f32_16x16x32_bf16 v[140:143], a[244:247], a[148:151], v[140:143]
    s_waitcnt lgkmcnt(4)
    v_accvgpr_write_b32 a21, v105
    v_accvgpr_write_b32 a22, v106
    v_mfma_f32_16x16x32_bf16 v[132:135], a[244:247], a[144:147], v[132:135]
    v_accvgpr_write_b32 a23, v107
    v_accvgpr_write_b32 a24, v112
    v_mfma_f32_16x16x32_bf16 v[132:135], a[240:243], a[128:131], v[132:135]
    ds_read_b64_tr_b16 a[240:241], v11 offset:1024
    v_accvgpr_write_b32 a25, v113
    v_mfma_f32_16x16x32_bf16 v[160:163], a[224:227], a[96:99], v[160:163]
    ds_read_b64_tr_b16 a[242:243], v11 offset:7168
    v_accvgpr_write_b32 a26, v114
    v_mfma_f32_16x16x32_bf16 v[160:163], a[228:231], a[112:115], v[160:163]
    ds_read_b64_tr_b16 a[244:245], v11 offset:13312
    v_accvgpr_write_b32 a27, v115
    v_mfma_f32_16x16x32_bf16 v[168:171], a[228:231], a[116:119], v[168:171]
    ds_read_b64_tr_b16 a[246:247], v11 offset:19456
    v_accvgpr_write_b32 a28, v120
    v_mfma_f32_16x16x32_bf16 v[168:171], a[224:227], a[100:103], v[168:171]
    v_accvgpr_write_b32 a29, v121
    v_accvgpr_write_b32 a30, v122
    v_mfma_f32_16x16x32_bf16 v[176:179], a[224:227], a[104:107], v[176:179]
    v_accvgpr_write_b32 a31, v123
    v_cvt_pk_bf16_f32 v128, v128, v129
    v_mfma_f32_16x16x32_bf16 v[176:179], a[228:231], a[120:123], v[176:179]
    s_waitcnt lgkmcnt(4)
    v_cvt_pk_bf16_f32 v129, v130, v131
    v_cvt_pk_bf16_f32 v130, v132, v133
    v_mfma_f32_16x16x32_bf16 v[184:187], a[228:231], a[124:127], v[184:187]
    v_cvt_pk_bf16_f32 v131, v134, v135
    v_cvt_pk_bf16_f32 v136, v136, v137
    v_mfma_f32_16x16x32_bf16 v[184:187], a[224:227], a[108:111], v[184:187]
    ds_read_b64_tr_b16 a[224:225], v11 offset:25600
    v_cvt_pk_bf16_f32 v137, v138, v139
    v_mfma_f32_16x16x32_bf16 v[184:187], a[232:235], a[140:143], v[184:187]
    ds_read_b64_tr_b16 a[226:227], v11 offset:31744
    v_cvt_pk_bf16_f32 v138, v140, v141
    v_mfma_f32_16x16x32_bf16 v[184:187], a[236:239], a[156:159], v[184:187]
    ds_read_b64_tr_b16 a[228:229], v11 offset:37888
    v_cvt_pk_bf16_f32 v139, v142, v143
    v_mfma_f32_16x16x32_bf16 v[176:179], a[236:239], a[152:155], v[176:179]
    ds_read_b64_tr_b16 a[230:231], v11 offset:44032
    v_cvt_pk_bf16_f32 v144, v144, v145
    v_mfma_f32_16x16x32_bf16 v[176:179], a[232:235], a[136:139], v[176:179]
    v_permlane16_swap_b32 v128, v130
    v_mfma_f32_16x16x32_bf16 v[168:171], a[232:235], a[132:135], v[168:171]
    v_permlane16_swap_b32 v129, v131
    v_mfma_f32_16x16x32_bf16 v[168:171], a[236:239], a[148:151], v[168:171]
    s_waitcnt lgkmcnt(4)
    v_permlane16_swap_b32 v136, v138
    v_mfma_f32_16x16x32_bf16 v[160:163], a[236:239], a[144:147], v[160:163]
    v_permlane16_swap_b32 v137, v139
    v_mfma_f32_16x16x32_bf16 v[160:163], a[232:235], a[128:131], v[160:163]
    ds_read_b64_tr_b16 a[232:233], v8 offset:2048
    v_cvt_pk_bf16_f32 v145, v146, v147
    v_mfma_f32_16x16x32_bf16 v[164:167], a[240:243], a[96:99], v[164:167]
    ds_read_b64_tr_b16 a[234:235], v8 offset:8192
    v_cvt_pk_bf16_f32 v146, v148, v149
    v_mfma_f32_16x16x32_bf16 v[164:167], a[244:247], a[112:115], v[164:167]
    ds_read_b64_tr_b16 a[236:237], v8 offset:14336
    v_cvt_pk_bf16_f32 v147, v150, v151
    v_mfma_f32_16x16x32_bf16 v[172:175], a[244:247], a[116:119], v[172:175]
    ds_read_b64_tr_b16 a[238:239], v8 offset:20480
    v_accvgpr_write_b32 a32, v128
    v_mfma_f32_16x16x32_bf16 v[172:175], a[240:243], a[100:103], v[172:175]
    v_permlane16_swap_b32 v144, v146
    v_mfma_f32_16x16x32_bf16 v[180:183], a[240:243], a[104:107], v[180:183]
    v_permlane16_swap_b32 v145, v147
    v_mfma_f32_16x16x32_bf16 v[180:183], a[244:247], a[120:123], v[180:183]
    s_waitcnt lgkmcnt(4)
    v_accvgpr_write_b32 a33, v129
    v_accvgpr_write_b32 a34, v130
    v_mfma_f32_16x16x32_bf16 v[188:191], a[244:247], a[124:127], v[188:191]
    v_accvgpr_write_b32 a35, v131
    v_cvt_pk_bf16_f32 v152, v152, v153
    v_mfma_f32_16x16x32_bf16 v[188:191], a[240:243], a[108:111], v[188:191]
    ds_read_b64_tr_b16 a[240:241], v8 offset:26624
    v_cvt_pk_bf16_f32 v153, v154, v155
    v_mfma_f32_16x16x32_bf16 v[188:191], a[224:227], a[140:143], v[188:191]
    ds_read_b64_tr_b16 a[242:243], v8 offset:32768
    v_cvt_pk_bf16_f32 v154, v156, v157
    v_mfma_f32_16x16x32_bf16 v[188:191], a[228:231], a[156:159], v[188:191]
    ds_read_b64_tr_b16 a[244:245], v8 offset:38912
    v_cvt_pk_bf16_f32 v155, v158, v159
    v_mfma_f32_16x16x32_bf16 v[180:183], a[228:231], a[152:155], v[180:183]
    ds_read_b64_tr_b16 a[246:247], v8 offset:45056
    v_accvgpr_write_b32 a36, v136
    v_mfma_f32_16x16x32_bf16 v[180:183], a[224:227], a[136:139], v[180:183]
    v_permlane16_swap_b32 v152, v154
    v_mfma_f32_16x16x32_bf16 v[172:175], a[224:227], a[132:135], v[172:175]
    s_add_u32 s88, s88, code_end-code0-65536
    s_addc_u32 s89, s89, 0
    v_accvgpr_write_b32 a37, v137
    v_mfma_f32_16x16x32_bf16 v[172:175], a[228:231], a[148:151], v[172:175]
    s_waitcnt lgkmcnt(4)
    v_permlane16_swap_b32 v153, v155
    v_mfma_f32_16x16x32_bf16 v[164:167], a[228:231], a[144:147], v[164:167]
    v_accvgpr_write_b32 a38, v138
    v_accvgpr_write_b32 a39, v139
    v_mfma_f32_16x16x32_bf16 v[164:167], a[224:227], a[128:131], v[164:167]
    ds_read_b64_tr_b16 a[224:225], v9 offset:2048
    v_accvgpr_write_b32 a40, v144
    v_mfma_f32_16x16x32_bf16 v[192:195], a[232:235], a[96:99], v[192:195]
    global_load_dword a252, v18, s[88:89]
    v_mfma_f32_16x16x32_bf16 v[192:195], a[236:239], a[112:115], v[192:195]
    ds_read_b64_tr_b16 a[226:227], v9 offset:8192
    v_accvgpr_write_b32 a41, v145
    v_mfma_f32_16x16x32_bf16 v[200:203], a[236:239], a[116:119], v[200:203]
    ds_read_b64_tr_b16 a[228:229], v9 offset:14336
    v_accvgpr_write_b32 a42, v146
    v_mfma_f32_16x16x32_bf16 v[200:203], a[232:235], a[100:103], v[200:203]
    ds_read_b64_tr_b16 a[230:231], v9 offset:20480
    v_accvgpr_write_b32 a43, v147
    v_mfma_f32_16x16x32_bf16 v[208:211], a[232:235], a[104:107], v[208:211]
    v_accvgpr_write_b32 a44, v152
    v_accvgpr_write_b32 a45, v153
    v_mfma_f32_16x16x32_bf16 v[208:211], a[236:239], a[120:123], v[208:211]
    s_waitcnt lgkmcnt(4)
    v_accvgpr_write_b32 a46, v154
    v_accvgpr_write_b32 a47, v155
    v_mfma_f32_16x16x32_bf16 v[216:219], a[236:239], a[124:127], v[216:219]
    v_cvt_pk_bf16_f32 v160, v160, v161
    v_cvt_pk_bf16_f32 v161, v162, v163
    v_mfma_f32_16x16x32_bf16 v[216:219], a[232:235], a[108:111], v[216:219]
    ds_read_b64_tr_b16 a[232:233], v9 offset:26624
    v_cvt_pk_bf16_f32 v162, v164, v165
    v_mfma_f32_16x16x32_bf16 v[216:219], a[240:243], a[140:143], v[216:219]
    ds_read_b64_tr_b16 a[234:235], v9 offset:32768
    v_cvt_pk_bf16_f32 v163, v166, v167
    v_mfma_f32_16x16x32_bf16 v[216:219], a[244:247], a[156:159], v[216:219]
    ds_read_b64_tr_b16 a[236:237], v9 offset:38912
    v_cvt_pk_bf16_f32 v168, v168, v169
    v_mfma_f32_16x16x32_bf16 v[208:211], a[244:247], a[152:155], v[208:211]
    ds_read_b64_tr_b16 a[238:239], v9 offset:45056
    v_cvt_pk_bf16_f32 v169, v170, v171
    v_mfma_f32_16x16x32_bf16 v[208:211], a[240:243], a[136:139], v[208:211]
    v_permlane16_swap_b32 v160, v162
    v_mfma_f32_16x16x32_bf16 v[200:203], a[240:243], a[132:135], v[200:203]
    v_permlane16_swap_b32 v161, v163
    v_mfma_f32_16x16x32_bf16 v[200:203], a[244:247], a[148:151], v[200:203]
    s_waitcnt lgkmcnt(4)
    v_cvt_pk_bf16_f32 v170, v172, v173
    v_cvt_pk_bf16_f32 v171, v174, v175
    v_mfma_f32_16x16x32_bf16 v[192:195], a[244:247], a[144:147], v[192:195]
    v_permlane16_swap_b32 v168, v170
    v_mfma_f32_16x16x32_bf16 v[192:195], a[240:243], a[128:131], v[192:195]
    ds_read_b64_tr_b16 a[240:241], v10 offset:2048
    v_cvt_pk_bf16_f32 v176, v176, v177
    v_mfma_f32_16x16x32_bf16 v[196:199], a[224:227], a[96:99], v[196:199]
    ds_read_b64_tr_b16 a[242:243], v10 offset:8192
    v_cvt_pk_bf16_f32 v177, v178, v179
    v_mfma_f32_16x16x32_bf16 v[196:199], a[228:231], a[112:115], v[196:199]
    ds_read_b64_tr_b16 a[244:245], v10 offset:14336
    v_cvt_pk_bf16_f32 v178, v180, v181
    v_mfma_f32_16x16x32_bf16 v[204:207], a[228:231], a[116:119], v[204:207]
    ds_read_b64_tr_b16 a[246:247], v10 offset:20480
    v_cvt_pk_bf16_f32 v179, v182, v183
    v_mfma_f32_16x16x32_bf16 v[204:207], a[224:227], a[100:103], v[204:207]
    v_permlane16_swap_b32 v169, v171
    v_mfma_f32_16x16x32_bf16 v[212:215], a[224:227], a[104:107], v[212:215]
    v_permlane16_swap_b32 v176, v178
    v_mfma_f32_16x16x32_bf16 v[212:215], a[228:231], a[120:123], v[212:215]
    s_waitcnt lgkmcnt(4)
    v_permlane16_swap_b32 v177, v179
    v_mfma_f32_16x16x32_bf16 v[220:223], a[228:231], a[124:127], v[220:223]
    v_accvgpr_write_b32 a48, v160
    v_accvgpr_write_b32 a49, v161
    v_mfma_f32_16x16x32_bf16 v[220:223], a[224:227], a[108:111], v[220:223]
    ds_read_b64_tr_b16 a[224:225], v10 offset:26624
    v_accvgpr_write_b32 a50, v162
    v_mfma_f32_16x16x32_bf16 v[220:223], a[232:235], a[140:143], v[220:223]
    ds_read_b64_tr_b16 a[226:227], v10 offset:32768
    v_accvgpr_write_b32 a51, v163
    v_mfma_f32_16x16x32_bf16 v[220:223], a[236:239], a[156:159], v[220:223]
    ds_read_b64_tr_b16 a[228:229], v10 offset:38912
    v_cvt_pk_bf16_f32 v184, v184, v185
    v_mfma_f32_16x16x32_bf16 v[212:215], a[236:239], a[152:155], v[212:215]
    ds_read_b64_tr_b16 a[230:231], v10 offset:45056
    v_cvt_pk_bf16_f32 v185, v186, v187
    v_mfma_f32_16x16x32_bf16 v[212:215], a[232:235], a[136:139], v[212:215]
    v_cvt_pk_bf16_f32 v186, v188, v189
    v_cvt_pk_bf16_f32 v187, v190, v191
    v_mfma_f32_16x16x32_bf16 v[204:207], a[232:235], a[132:135], v[204:207]
    v_permlane16_swap_b32 v184, v186
    v_mfma_f32_16x16x32_bf16 v[204:207], a[236:239], a[148:151], v[204:207]
    s_waitcnt lgkmcnt(4)
    v_permlane16_swap_b32 v185, v187
    v_mfma_f32_16x16x32_bf16 v[196:199], a[236:239], a[144:147], v[196:199]
    v_accvgpr_write_b32 a52, v168
    v_accvgpr_write_b32 a53, v169
    v_mfma_f32_16x16x32_bf16 v[196:199], a[232:235], a[128:131], v[196:199]
    ds_read_b64_tr_b16 a[232:233], v11 offset:2048
    v_accvgpr_write_b32 a54, v170
    ds_read_b64_tr_b16 a[234:235], v11 offset:8192
    v_mfma_f32_16x16x32_bf16 v[224:227], a[240:243], a[96:99], v[224:227]
    ds_read_b64_tr_b16 a[236:237], v11 offset:14336
    v_accvgpr_write_b32 a55, v171
    ds_read_b64_tr_b16 a[238:239], v11 offset:20480
    v_mfma_f32_16x16x32_bf16 v[224:227], a[244:247], a[112:115], v[224:227]
    v_accvgpr_write_b32 a56, v176
    v_accvgpr_write_b32 a57, v177
    v_mfma_f32_16x16x32_bf16 v[232:235], a[244:247], a[116:119], v[232:235]
    v_accvgpr_write_b32 a58, v178
    v_accvgpr_write_b32 a59, v179
    v_mfma_f32_16x16x32_bf16 v[232:235], a[240:243], a[100:103], v[232:235]
    v_accvgpr_write_b32 a60, v184
    v_accvgpr_write_b32 a61, v185
    v_mfma_f32_16x16x32_bf16 v[240:243], a[240:243], a[104:107], v[240:243]
    v_accvgpr_write_b32 a62, v186
    v_accvgpr_write_b32 a63, v187
    v_mfma_f32_16x16x32_bf16 v[240:243], a[244:247], a[120:123], v[240:243]
    s_waitcnt lgkmcnt(4)
    v_cvt_pk_bf16_f32 v192, v192, v193
    v_cvt_pk_bf16_f32 v193, v194, v195
    v_mfma_f32_16x16x32_bf16 v[248:251], a[244:247], a[124:127], v[248:251]
    s_waitcnt lgkmcnt(0)
    s_barrier
    v_mfma_f32_16x16x32_bf16 v[248:251], a[240:243], a[108:111], v[248:251]
    s_add_u32 m0, s49, 49152
    ds_read_b128 a[184:187], v12 offset:0
    v_cvt_pk_bf16_f32 v194, v196, v197
    v_mfma_f32_16x16x32_bf16 v[248:251], a[224:227], a[140:143], v[248:251]
    ds_read_b128 a[188:191], v13 offset:0
    v_cvt_pk_bf16_f32 v195, v198, v199
    v_mfma_f32_16x16x32_bf16 v[248:251], a[228:231], a[156:159], v[248:251]
    ds_read_b128 a[192:195], v12 offset:1024
    v_cvt_pk_bf16_f32 v200, v200, v201
    v_mfma_f32_16x16x32_bf16 v[240:243], a[228:231], a[152:155], v[240:243]
    ds_read_b128 a[196:199], v13 offset:1024
    v_cvt_pk_bf16_f32 v201, v202, v203
    v_mfma_f32_16x16x32_bf16 v[240:243], a[224:227], a[136:139], v[240:243]
    ds_read_b128 a[200:203], v12 offset:2048
    v_cvt_pk_bf16_f32 v202, v204, v205
    v_mfma_f32_16x16x32_bf16 v[232:235], a[224:227], a[132:135], v[232:235]
    buffer_load_dwordx4 v4, s[12:15], s38 offen offset:0 lds
    v_mfma_f32_16x16x32_bf16 v[232:235], a[228:231], a[148:151], v[232:235]
    ds_read_b64_tr_b16 a[240:241], v11 offset:26624
    v_cvt_pk_bf16_f32 v203, v206, v207
    v_mfma_f32_16x16x32_bf16 v[224:227], a[228:231], a[144:147], v[224:227]
    ds_read_b64_tr_b16 a[242:243], v11 offset:32768
    v_cvt_pk_bf16_f32 v208, v208, v209
    v_mfma_f32_16x16x32_bf16 v[224:227], a[224:227], a[128:131], v[224:227]
    ds_read_b64_tr_b16 a[244:245], v11 offset:38912
    v_cvt_pk_bf16_f32 v209, v210, v211
    v_mfma_f32_16x16x32_bf16 v[228:231], a[232:235], a[96:99], v[228:231]
    ds_read_b64_tr_b16 a[246:247], v11 offset:45056
    v_cvt_pk_bf16_f32 v210, v212, v213
    v_mfma_f32_16x16x32_bf16 v[228:231], a[236:239], a[112:115], v[228:231]
    v_permlane16_swap_b32 v192, v194
    v_mfma_f32_16x16x32_bf16 v[236:239], a[236:239], a[116:119], v[236:239]
    s_addk_i32 m0, 896
    v_permlane16_swap_b32 v193, v195
    v_mfma_f32_16x16x32_bf16 v[236:239], a[232:235], a[100:103], v[236:239]
    v_permlane16_swap_b32 v200, v202
    v_mfma_f32_16x16x32_bf16 v[244:247], a[232:235], a[104:107], v[244:247]
    v_permlane16_swap_b32 v201, v203
    v_mfma_f32_16x16x32_bf16 v[244:247], a[236:239], a[120:123], v[244:247]
    s_waitcnt lgkmcnt(2)
    v_permlane16_swap_b32 v208, v210
    v_mfma_f32_16x16x32_bf16 v[252:255], a[236:239], a[124:127], v[252:255]
    ds_read_b128 a[204:207], v13 offset:2048
    v_cvt_pk_bf16_f32 v211, v214, v215
    v_mfma_f32_16x16x32_bf16 v[252:255], a[232:235], a[108:111], v[252:255]
    s_waitcnt lgkmcnt(1)
    v_permlane16_swap_b32 v209, v211
    v_mfma_f32_16x16x32_bf16 v[252:255], a[240:243], a[140:143], v[252:255]
    buffer_load_dwordx4 v4, s[12:15], s38 offen offset:128 lds
    v_mfma_f32_16x16x32_bf16 v[252:255], a[244:247], a[156:159], v[252:255]
    v_accvgpr_write_b32 a64, v192
    v_accvgpr_write_b32 a65, v193
    v_mfma_f32_16x16x32_bf16 v[244:247], a[244:247], a[152:155], v[244:247]
    ds_read_b128 a[208:211], v12 offset:6144
    v_accvgpr_write_b32 a66, v194
    v_mfma_f32_16x16x32_bf16 v[244:247], a[240:243], a[136:139], v[244:247]
    ds_read_b128 a[212:215], v13 offset:6144
    v_accvgpr_write_b32 a67, v195
    v_mfma_f32_16x16x32_bf16 v[236:239], a[240:243], a[132:135], v[236:239]
    ds_read_b128 a[216:219], v12 offset:7168
    v_cvt_pk_bf16_f32 v216, v216, v217
    v_mfma_f32_16x16x32_bf16 v[236:239], a[244:247], a[148:151], v[236:239]
    ds_read_b128 a[220:223], v13 offset:7168
    v_cvt_pk_bf16_f32 v217, v218, v219
    v_mfma_f32_16x16x32_bf16 v[228:231], a[244:247], a[144:147], v[228:231]
    s_addk_i32 m0, 896
    ds_read_b128 a[224:227], v12 offset:8192
    v_cvt_pk_bf16_f32 v218, v220, v221
    v_mfma_f32_16x16x32_bf16 v[228:231], a[240:243], a[128:131], v[228:231]
    ds_read_b128 a[228:231], v13 offset:8192
    v_cvt_pk_bf16_f32 v219, v222, v223
    v_mfma_f32_16x16x32_bf16 v[64:67], a[184:187], a[0:3], 0
    v_permlane16_swap_b32 v216, v218
    v_mfma_f32_16x16x32_bf16 v[64:67], a[188:191], a[16:19], v[64:67]
    v_permlane16_swap_b32 v217, v219
    v_mfma_f32_16x16x32_bf16 v[64:67], a[192:195], a[32:35], v[64:67]
    v_accvgpr_write_b32 a68, v200
    v_accvgpr_write_b32 a69, v201
    v_mfma_f32_16x16x32_bf16 v[64:67], a[196:199], a[48:51], v[64:67]
    v_accvgpr_write_b32 a70, v202
    v_accvgpr_write_b32 a71, v203
    v_mfma_f32_16x16x32_bf16 v[64:67], a[200:203], a[64:67], v[64:67]
    buffer_load_dwordx4 v4, s[12:15], s38 offen offset:256 lds
    v_mfma_f32_16x16x32_bf16 v[72:75], a[200:203], a[68:71], 0
    v_accvgpr_write_b32 a72, v208
    v_accvgpr_write_b32 a73, v209
    v_mfma_f32_16x16x32_bf16 v[72:75], a[196:199], a[52:55], v[72:75]
    v_accvgpr_write_b32 a74, v210
    v_accvgpr_write_b32 a75, v211
    v_mfma_f32_16x16x32_bf16 v[72:75], a[192:195], a[36:39], v[72:75]
    v_accvgpr_write_b32 a76, v216
    v_accvgpr_write_b32 a77, v217
    v_mfma_f32_16x16x32_bf16 v[72:75], a[188:191], a[20:23], v[72:75]
    v_accvgpr_write_b32 a78, v218
    v_accvgpr_write_b32 a79, v219
    v_mfma_f32_16x16x32_bf16 v[72:75], a[184:187], a[4:7], v[72:75]
    v_cvt_pk_bf16_f32 v224, v224, v225
    v_cvt_pk_bf16_f32 v225, v226, v227
    v_mfma_f32_16x16x32_bf16 v[80:83], a[184:187], a[8:11], 0
    s_addk_i32 m0, 1280
    v_cvt_pk_bf16_f32 v226, v228, v229
    v_cvt_pk_bf16_f32 v227, v230, v231
    v_mfma_f32_16x16x32_bf16 v[80:83], a[188:191], a[24:27], v[80:83]
    v_permlane16_swap_b32 v224, v226
    v_mfma_f32_16x16x32_bf16 v[80:83], a[192:195], a[40:43], v[80:83]
    v_permlane16_swap_b32 v225, v227
    v_mfma_f32_16x16x32_bf16 v[80:83], a[196:199], a[56:59], v[80:83]
    v_cvt_pk_bf16_f32 v232, v232, v233
    v_cvt_pk_bf16_f32 v233, v234, v235
    v_mfma_f32_16x16x32_bf16 v[80:83], a[200:203], a[72:75], v[80:83]
    v_cvt_pk_bf16_f32 v234, v236, v237
    v_cvt_pk_bf16_f32 v235, v238, v239
    v_mfma_f32_16x16x32_bf16 v[88:91], a[200:203], a[76:79], 0
    v_permlane16_swap_b32 v232, v234
    v_mfma_f32_16x16x32_bf16 v[88:91], a[196:199], a[60:63], v[88:91]
    buffer_load_dwordx4 v5, s[12:15], s38 offen offset:0 lds
    v_mfma_f32_16x16x32_bf16 v[88:91], a[192:195], a[44:47], v[88:91]
    s_waitcnt lgkmcnt(0)
    v_permlane16_swap_b32 v233, v235
    v_mfma_f32_16x16x32_bf16 v[88:91], a[188:191], a[28:31], v[88:91]
    v_cvt_pk_bf16_f32 v240, v240, v241
    v_cvt_pk_bf16_f32 v241, v242, v243
    v_mfma_f32_16x16x32_bf16 v[88:91], a[184:187], a[12:15], v[88:91]
    ds_read_b128 a[184:187], v12 offset:12288
    v_cvt_pk_bf16_f32 v242, v244, v245
    v_mfma_f32_16x16x32_bf16 v[64:67], a[204:207], v[224:227], v[64:67]
    ds_read_b128 a[188:191], v13 offset:12288
    v_cvt_pk_bf16_f32 v243, v246, v247
    v_cvt_pk_bf16_f32 v248, v248, v249
    v_cvt_pk_bf16_f32 v249, v250, v251
    v_mfma_f32_16x16x32_bf16 v[72:75], a[204:207], v[232:235], v[72:75]
    ds_read_b128 a[192:195], v12 offset:13312
    v_cvt_pk_bf16_f32 v250, v252, v253
    v_permlane16_swap_b32 v240, v242
    v_permlane16_swap_b32 v241, v243
    s_nop 1
    v_mfma_f32_16x16x32_bf16 v[80:83], a[204:207], v[240:243], v[80:83]
    s_addk_i32 m0, 896
    ds_read_b128 a[196:199], v13 offset:13312
    v_cvt_pk_bf16_f32 v251, v254, v255
    v_permlane16_swap_b32 v248, v250
    v_accvgpr_write_b32 a80, v224
    v_permlane16_swap_b32 v249, v251
    s_nop 1
    v_mfma_f32_16x16x32_bf16 v[88:91], a[204:207], v[248:251], v[88:91]
    ds_read_b128 a[200:203], v12 offset:14336
    v_accvgpr_write_b32 a81, v225
    v_mfma_f32_16x16x32_bf16 v[24:27], a[208:211], a[0:3], 0
    ds_read_b128 a[204:207], v13 offset:14336
    v_accvgpr_write_b32 a82, v226
    v_mfma_f32_16x16x32_bf16 v[24:27], a[212:215], a[16:19], v[24:27]
    v_exp_f32 v64, v64
    v_mfma_f32_16x16x32_bf16 v[24:27], a[216:219], a[32:35], v[24:27]
    v_exp_f32 v65, v65
    v_mfma_f32_16x16x32_bf16 v[24:27], a[220:223], a[48:51], v[24:27]
    v_exp_f32 v66, v66
    v_mfma_f32_16x16x32_bf16 v[24:27], a[224:227], a[64:67], v[24:27]
    buffer_load_dwordx4 v5, s[12:15], s38 offen offset:128 lds
    v_accvgpr_write_b32 a83, v227
    s_nop 1
    v_mfma_f32_16x16x32_bf16 v[24:27], a[228:231], a[80:83], v[24:27]
    v_exp_f32 v67, v67
    v_accvgpr_write_b32 a84, v232
    v_accvgpr_write_b32 a85, v233
    v_accvgpr_write_b32 a86, v234
    v_accvgpr_write_b32 a87, v235
    s_nop 1
    v_mfma_f32_16x16x32_bf16 v[28:31], a[228:231], a[84:87], 0
    v_exp_f32 v72, v72
    v_mfma_f32_16x16x32_bf16 v[28:31], a[224:227], a[68:71], v[28:31]
    v_exp_f32 v73, v73
    v_mfma_f32_16x16x32_bf16 v[28:31], a[220:223], a[52:55], v[28:31]
    v_exp_f32 v74, v74
    v_mfma_f32_16x16x32_bf16 v[28:31], a[216:219], a[36:39], v[28:31]
    v_exp_f32 v75, v75
    v_mfma_f32_16x16x32_bf16 v[28:31], a[212:215], a[20:23], v[28:31]
    s_addk_i32 m0, 896
    v_exp_f32 v80, v80
    v_mfma_f32_16x16x32_bf16 v[28:31], a[208:211], a[4:7], v[28:31]
    v_exp_f32 v81, v81
    v_mfma_f32_16x16x32_bf16 v[32:35], a[208:211], a[8:11], 0
    v_exp_f32 v82, v82
    v_mfma_f32_16x16x32_bf16 v[32:35], a[212:215], a[24:27], v[32:35]
    v_exp_f32 v83, v83
    v_mfma_f32_16x16x32_bf16 v[32:35], a[216:219], a[40:43], v[32:35]
    v_exp_f32 v88, v88
    v_mfma_f32_16x16x32_bf16 v[32:35], a[220:223], a[56:59], v[32:35]
    v_exp_f32 v89, v89
    v_mfma_f32_16x16x32_bf16 v[32:35], a[224:227], a[72:75], v[32:35]
    buffer_load_dwordx4 v5, s[12:15], s38 offen offset:256 lds
    v_accvgpr_write_b32 a88, v240
    v_accvgpr_write_b32 a89, v241
    v_accvgpr_write_b32 a90, v242
    v_accvgpr_write_b32 a91, v243
    s_nop 1
    v_mfma_f32_16x16x32_bf16 v[32:35], a[228:231], a[88:91], v[32:35]
    s_add_u32 s38, s38, 24576
    v_exp_f32 v90, v90
    v_accvgpr_write_b32 a92, v248
    v_accvgpr_write_b32 a93, v249
    v_accvgpr_write_b32 a94, v250
    v_accvgpr_write_b32 a95, v251
    s_nop 1
    v_mfma_f32_16x16x32_bf16 v[36:39], a[228:231], a[92:95], 0
    v_exp_f32 v91, v91
    v_mfma_f32_16x16x32_bf16 v[36:39], a[224:227], a[76:79], v[36:39]
    v_cvt_pk_bf16_f32 v64, v64, v65
    v_cvt_pk_bf16_f32 v65, v66, v67
    v_mfma_f32_16x16x32_bf16 v[36:39], a[220:223], a[60:63], v[36:39]
    s_add_u32 s39, s40, 49152
    v_exp_f32 v24, v24
    v_mfma_f32_16x16x32_bf16 v[36:39], a[216:219], a[44:47], v[36:39]
    s_waitcnt lgkmcnt(0)
    v_exp_f32 v25, v25
    v_mfma_f32_16x16x32_bf16 v[36:39], a[212:215], a[28:31], v[36:39]
    s_add_u32 m0, s63, 90112
    ds_read_b128 a[212:215], v13 offset:18432
    v_cvt_pk_bf16_f32 v72, v72, v73
    v_mfma_f32_16x16x32_bf16 v[36:39], a[208:211], a[12:15], v[36:39]
    ds_read_b128 a[220:223], v13 offset:19456
    v_cvt_pk_bf16_f32 v73, v74, v75
    v_mfma_f32_16x16x32_bf16 v[68:71], a[184:187], a[0:3], 0
    ds_read_b128 a[208:211], v12 offset:18432
    v_cvt_pk_bf16_f32 v80, v80, v81
    v_mfma_f32_16x16x32_bf16 v[68:71], a[188:191], a[16:19], v[68:71]
    ds_read_b128 a[216:219], v12 offset:19456
    v_cvt_pk_bf16_f32 v81, v82, v83
    v_mfma_f32_16x16x32_bf16 v[68:71], a[192:195], a[32:35], v[68:71]
    ds_read_b128 a[224:227], v12 offset:20480
    v_cvt_pk_bf16_f32 v88, v88, v89
    v_mfma_f32_16x16x32_bf16 v[68:71], a[196:199], a[48:51], v[68:71]
    ds_read_b128 a[228:231], v13 offset:20480
    v_cvt_pk_bf16_f32 v89, v90, v91
    v_mfma_f32_16x16x32_bf16 v[68:71], a[200:203], a[64:67], v[68:71]
    buffer_load_dwordx4 v6, s[16:19], s39 offen lds
    v_mfma_f32_16x16x32_bf16 v[68:71], a[204:207], a[80:83], v[68:71]
    v_exp_f32 v26, v26
    v_mfma_f32_16x16x32_bf16 v[76:79], a[204:207], a[84:87], 0
    v_exp_f32 v27, v27
    v_mfma_f32_16x16x32_bf16 v[76:79], a[200:203], a[68:71], v[76:79]
    v_exp_f32 v28, v28
    v_mfma_f32_16x16x32_bf16 v[76:79], a[196:199], a[52:55], v[76:79]
    s_add_u32 s39, s40, 61440
    v_exp_f32 v29, v29
    v_mfma_f32_16x16x32_bf16 v[76:79], a[192:195], a[36:39], v[76:79]
    v_exp_f32 v30, v30
    v_mfma_f32_16x16x32_bf16 v[76:79], a[188:191], a[20:23], v[76:79]
    s_addk_i32 m0, 4096
    v_exp_f32 v31, v31
    v_mfma_f32_16x16x32_bf16 v[76:79], a[184:187], a[4:7], v[76:79]
    v_cvt_pk_bf16_f32 v66, v24, v25
    v_cvt_pk_bf16_f32 v67, v26, v27
    v_mfma_f32_16x16x32_bf16 v[84:87], a[184:187], a[8:11], 0
    v_exp_f32 v32, v32
    v_mfma_f32_16x16x32_bf16 v[84:87], a[188:191], a[24:27], v[84:87]
    v_exp_f32 v33, v33
    v_mfma_f32_16x16x32_bf16 v[84:87], a[192:195], a[40:43], v[84:87]
    v_exp_f32 v34, v34
    v_mfma_f32_16x16x32_bf16 v[84:87], a[196:199], a[56:59], v[84:87]
    v_exp_f32 v35, v35
    v_mfma_f32_16x16x32_bf16 v[84:87], a[200:203], a[72:75], v[84:87]
    buffer_load_dwordx4 v6, s[16:19], s39 offen lds
    v_mfma_f32_16x16x32_bf16 v[84:87], a[204:207], a[88:91], v[84:87]
    v_cvt_pk_bf16_f32 v74, v28, v29
    v_cvt_pk_bf16_f32 v75, v30, v31
    v_mfma_f32_16x16x32_bf16 v[92:95], a[204:207], a[92:95], 0
    v_exp_f32 v36, v36
    v_mfma_f32_16x16x32_bf16 v[92:95], a[200:203], a[76:79], v[92:95]
    v_exp_f32 v37, v37
    v_mfma_f32_16x16x32_bf16 v[92:95], a[196:199], a[60:63], v[92:95]
pg_5:
    s_cbranch_execz pg_9
    v_exp_f32 v38, v38
    v_mfma_f32_16x16x32_bf16 v[92:95], a[192:195], a[44:47], v[92:95]
    s_waitcnt lgkmcnt(0)
    v_exp_f32 v39, v39
    v_mfma_f32_16x16x32_bf16 v[92:95], a[188:191], a[28:31], v[92:95]
    s_add_u32 m0, s49, 0
    v_add_u32 v8, v19, v8
    v_add_u32 v9, v19, v9
    v_mfma_f32_16x16x32_bf16 v[92:95], a[184:187], a[12:15], v[92:95]
    v_add_u32 v10, v19, v10
    v_add_u32 v11, v19, v11
    v_mfma_f32_16x16x32_bf16 v[40:43], a[208:211], a[0:3], 0
    s_waitcnt vmcnt(13)
    v_cvt_pk_bf16_f32 v82, v32, v33
    v_cvt_pk_bf16_f32 v83, v34, v35
    v_mfma_f32_16x16x32_bf16 v[40:43], a[212:215], a[16:19], v[40:43]
    s_barrier
    v_mfma_f32_16x16x32_bf16 v[40:43], a[216:219], a[32:35], v[40:43]
    ds_read_b128 a[184:187], v12 offset:24576
    v_cvt_pk_bf16_f32 v90, v36, v37
    v_mfma_f32_16x16x32_bf16 v[40:43], a[220:223], a[48:51], v[40:43]
    ds_read_b128 a[188:191], v13 offset:24576
    v_cvt_pk_bf16_f32 v91, v38, v39
    v_mfma_f32_16x16x32_bf16 v[40:43], a[224:227], a[64:67], v[40:43]
    buffer_load_dwordx4 v4, s[12:15], s38 offen offset:0 lds
    v_mfma_f32_16x16x32_bf16 v[40:43], a[228:231], a[80:83], v[40:43]
    v_exp_f32 v68, v68
    v_mfma_f32_16x16x32_bf16 v[44:47], a[228:231], a[84:87], 0
    v_exp_f32 v69, v69
    v_mfma_f32_16x16x32_bf16 v[44:47], a[224:227], a[68:71], v[44:47]
    ds_read_b128 a[192:195], v12 offset:25600
    v_cvt_pk_bf16_f32 v68, v68, v69
    v_mfma_f32_16x16x32_bf16 v[44:47], a[220:223], a[52:55], v[44:47]
    v_exp_f32 v70, v70
    v_mfma_f32_16x16x32_bf16 v[44:47], a[216:219], a[36:39], v[44:47]
    v_exp_f32 v71, v71
    v_mfma_f32_16x16x32_bf16 v[44:47], a[212:215], a[20:23], v[44:47]
    s_addk_i32 m0, 896
    ds_read_b128 a[196:199], v13 offset:25600
    v_cvt_pk_bf16_f32 v69, v70, v71
    v_mfma_f32_16x16x32_bf16 v[44:47], a[208:211], a[4:7], v[44:47]
    v_exp_f32 v76, v76
    v_mfma_f32_16x16x32_bf16 v[48:51], a[208:211], a[8:11], 0
    buffer_load_dword a252, v22, s[32:35], s42 offen offset:0
    v_mfma_f32_16x16x32_bf16 v[48:51], a[212:215], a[24:27], v[48:51]
    v_exp_f32 v77, v77
    v_mfma_f32_16x16x32_bf16 v[48:51], a[216:219], a[40:43], v[48:51]
    ds_read_b128 a[200:203], v12 offset:26624
    v_cvt_pk_bf16_f32 v76, v76, v77
    v_mfma_f32_16x16x32_bf16 v[48:51], a[220:223], a[56:59], v[48:51]
    v_exp_f32 v78, v78
    v_mfma_f32_16x16x32_bf16 v[48:51], a[224:227], a[72:75], v[48:51]
    buffer_load_dwordx4 v4, s[12:15], s38 offen offset:128 lds
    v_mfma_f32_16x16x32_bf16 v[48:51], a[228:231], a[88:91], v[48:51]
    v_exp_f32 v79, v79
    v_mfma_f32_16x16x32_bf16 v[52:55], a[228:231], a[92:95], 0
    ds_read_b128 a[204:207], v13 offset:26624
    v_cvt_pk_bf16_f32 v77, v78, v79
    v_mfma_f32_16x16x32_bf16 v[52:55], a[224:227], a[76:79], v[52:55]
    v_exp_f32 v84, v84
    v_mfma_f32_16x16x32_bf16 v[52:55], a[220:223], a[60:63], v[52:55]
    v_exp_f32 v85, v85
    v_mfma_f32_16x16x32_bf16 v[52:55], a[216:219], a[44:47], v[52:55]
    s_waitcnt lgkmcnt(1)
    v_exp_f32 v86, v86
    v_mfma_f32_16x16x32_bf16 v[52:55], a[212:215], a[28:31], v[52:55]
    s_addk_i32 m0, 896
    ds_read_b128 a[212:215], v13 offset:30720
    v_cvt_pk_bf16_f32 v84, v84, v85
    v_mfma_f32_16x16x32_bf16 v[52:55], a[208:211], a[12:15], v[52:55]
    v_exp_f32 v87, v87
    v_mfma_f32_16x16x32_bf16 v[96:99], a[184:187], a[0:3], 0
    ds_read_b128 a[220:223], v13 offset:31744
    v_cvt_pk_bf16_f32 v85, v86, v87
    v_mfma_f32_16x16x32_bf16 v[96:99], a[188:191], a[16:19], v[96:99]
    v_exp_f32 v92, v92
    v_mfma_f32_16x16x32_bf16 v[96:99], a[192:195], a[32:35], v[96:99]
    s_waitcnt lgkmcnt(2)
    v_exp_f32 v93, v93
    v_mfma_f32_16x16x32_bf16 v[96:99], a[196:199], a[48:51], v[96:99]
    ds_read_b128 a[208:211], v12 offset:30720
    v_cvt_pk_bf16_f32 v92, v92, v93
    v_mfma_f32_16x16x32_bf16 v[96:99], a[200:203], a[64:67], v[96:99]
    buffer_load_dwordx4 v4, s[12:15], s38 offen offset:256 lds
    v_mfma_f32_16x16x32_bf16 v[96:99], a[204:207], a[80:83], v[96:99]
    v_exp_f32 v94, v94
    v_mfma_f32_16x16x32_bf16 v[104:107], a[204:207], a[84:87], 0
    v_exp_f32 v95, v95
    v_mfma_f32_16x16x32_bf16 v[104:107], a[200:203], a[68:71], v[104:107]
    ds_read_b128 a[216:219], v12 offset:31744
    v_cvt_pk_bf16_f32 v93, v94, v95
    v_mfma_f32_16x16x32_bf16 v[104:107], a[196:199], a[52:55], v[104:107]
    v_exp_f32 v40, v40
    v_mfma_f32_16x16x32_bf16 v[104:107], a[192:195], a[36:39], v[104:107]
    v_exp_f32 v41, v41
    v_mfma_f32_16x16x32_bf16 v[104:107], a[188:191], a[20:23], v[104:107]
    s_addk_i32 m0, 1280
    ds_read_b128 a[224:227], v12 offset:32768
    v_cvt_pk_bf16_f32 v70, v40, v41
    v_mfma_f32_16x16x32_bf16 v[104:107], a[184:187], a[4:7], v[104:107]
    v_exp_f32 v42, v42
    v_mfma_f32_16x16x32_bf16 v[112:115], a[184:187], a[8:11], 0
    v_exp_f32 v43, v43
    v_mfma_f32_16x16x32_bf16 v[112:115], a[188:191], a[24:27], v[112:115]
    ds_read_b128 a[228:231], v13 offset:32768
    v_cvt_pk_bf16_f32 v71, v42, v43
    v_mfma_f32_16x16x32_bf16 v[112:115], a[192:195], a[40:43], v[112:115]
    v_exp_f32 v44, v44
    v_mfma_f32_16x16x32_bf16 v[112:115], a[196:199], a[56:59], v[112:115]
    v_exp_f32 v45, v45
    v_mfma_f32_16x16x32_bf16 v[112:115], a[200:203], a[72:75], v[112:115]
    buffer_load_dwordx4 v5, s[12:15], s38 offen offset:0 lds
    v_mfma_f32_16x16x32_bf16 v[112:115], a[204:207], a[88:91], v[112:115]
    v_exp_f32 v46, v46
    v_mfma_f32_16x16x32_bf16 v[120:123], a[204:207], a[92:95], 0
    ds_read_b64_tr_b16 a[232:233], v8 offset:0
    v_cvt_pk_bf16_f32 v78, v44, v45
    v_mfma_f32_16x16x32_bf16 v[120:123], a[200:203], a[76:79], v[120:123]
    v_exp_f32 v47, v47
    v_mfma_f32_16x16x32_bf16 v[120:123], a[196:199], a[60:63], v[120:123]
    ds_read_b64_tr_b16 a[234:235], v8 offset:2048
    v_cvt_pk_bf16_f32 v79, v46, v47
    v_mfma_f32_16x16x32_bf16 v[120:123], a[192:195], a[44:47], v[120:123]
    s_waitcnt lgkmcnt(2)
    v_exp_f32 v48, v48
    v_mfma_f32_16x16x32_bf16 v[120:123], a[188:191], a[28:31], v[120:123]
    s_addk_i32 m0, 896
    v_exp_f32 v49, v49
    v_mfma_f32_16x16x32_bf16 v[120:123], a[184:187], a[12:15], v[120:123]
    ds_read_b64_tr_b16 a[236:237], v9 offset:0
    v_cvt_pk_bf16_f32 v86, v48, v49
    v_mfma_f32_16x16x32_bf16 v[24:27], a[208:211], a[0:3], 0
    v_exp_f32 v50, v50
    v_mfma_f32_16x16x32_bf16 v[24:27], a[212:215], a[16:19], v[24:27]
    v_exp_f32 v51, v51
    v_mfma_f32_16x16x32_bf16 v[24:27], a[216:219], a[32:35], v[24:27]
    ds_read_b64_tr_b16 a[238:239], v9 offset:2048
    v_cvt_pk_bf16_f32 v87, v50, v51
    v_mfma_f32_16x16x32_bf16 v[24:27], a[220:223], a[48:51], v[24:27]
    v_exp_f32 v52, v52
    v_mfma_f32_16x16x32_bf16 v[24:27], a[224:227], a[64:67], v[24:27]
    buffer_load_dwordx4 v5, s[12:15], s38 offen offset:128 lds
    v_mfma_f32_16x16x32_bf16 v[24:27], a[228:231], a[80:83], v[24:27]
    v_exp_f32 v53, v53
    v_mfma_f32_16x16x32_bf16 v[28:31], a[228:231], a[84:87], 0
    ds_read_b128 a[184:187], v12 offset:36864
    v_cvt_pk_bf16_f32 v94, v52, v53
    v_mfma_f32_16x16x32_bf16 v[28:31], a[224:227], a[68:71], v[28:31]
    v_exp_f32 v54, v54
    v_mfma_f32_16x16x32_bf16 v[28:31], a[220:223], a[52:55], v[28:31]
    v_exp_f32 v55, v55
    v_mfma_f32_16x16x32_bf16 v[28:31], a[216:219], a[36:39], v[28:31]
    ds_read_b128 a[188:191], v13 offset:36864
    v_cvt_pk_bf16_f32 v95, v54, v55
    v_mfma_f32_16x16x32_bf16 v[28:31], a[212:215], a[20:23], v[28:31]
    s_addk_i32 m0, 896
    v_exp_f32 v96, v96
    v_mfma_f32_16x16x32_bf16 v[28:31], a[208:211], a[4:7], v[28:31]
    v_exp_f32 v97, v97
    v_mfma_f32_16x16x32_bf16 v[32:35], a[208:211], a[8:11], 0
    ds_read_b128 a[192:195], v12 offset:37888
    v_cvt_pk_bf16_f32 v96, v96, v97
    v_mfma_f32_16x16x32_bf16 v[32:35], a[212:215], a[24:27], v[32:35]
    v_exp_f32 v98, v98
    v_mfma_f32_16x16x32_bf16 v[32:35], a[216:219], a[40:43], v[32:35]
    v_exp_f32 v99, v99
    v_mfma_f32_16x16x32_bf16 v[32:35], a[220:223], a[56:59], v[32:35]
    ds_read_b128 a[196:199], v13 offset:37888
    v_cvt_pk_bf16_f32 v97, v98, v99
    v_mfma_f32_16x16x32_bf16 v[32:35], a[224:227], a[72:75], v[32:35]
    buffer_load_dwordx4 v5, s[12:15], s38 offen offset:256 lds
    v_mfma_f32_16x16x32_bf16 v[32:35], a[228:231], a[88:91], v[32:35]
    s_add_u32 s38, s38, 24576
    v_exp_f32 v104, v104
    v_mfma_f32_16x16x32_bf16 v[36:39], a[228:231], a[92:95], 0
    v_exp_f32 v105, v105
    v_mfma_f32_16x16x32_bf16 v[36:39], a[224:227], a[76:79], v[36:39]
    ds_read_b128 a[200:203], v12 offset:38912
    v_cvt_pk_bf16_f32 v104, v104, v105
    v_mfma_f32_16x16x32_bf16 v[36:39], a[220:223], a[60:63], v[36:39]
    s_add_u32 s39, s40, 73728
    v_exp_f32 v106, v106
    v_mfma_f32_16x16x32_bf16 v[36:39], a[216:219], a[44:47], v[36:39]
    s_waitcnt lgkmcnt(2)
    v_exp_f32 v107, v107
    v_mfma_f32_16x16x32_bf16 v[36:39], a[212:215], a[28:31], v[36:39]
    s_add_u32 m0, s63, 98304
    ds_read_b128 a[204:207], v13 offset:38912
    v_cvt_pk_bf16_f32 v105, v106, v107
    v_mfma_f32_16x16x32_bf16 v[36:39], a[208:211], a[12:15], v[36:39]
    v_exp_f32 v112, v112
    v_mfma_f32_16x16x32_bf16 a[152:155], a[232:235], v[64:67], 0
    v_exp_f32 v113, v113
    v_mfma_f32_16x16x32_bf16 a[168:171], a[236:239], v[64:67], 0
    v_exp_f32 v114, v114
    v_mfma_f32_16x16x32_bf16 a[172:175], a[236:239], v[72:75], 0
    ds_read_b128 a[208:211], v12 offset:43008
    v_cvt_pk_bf16_f32 v112, v112, v113
    v_mfma_f32_16x16x32_bf16 a[156:159], a[232:235], v[72:75], 0
    v_exp_f32 v115, v115
    v_mfma_f32_16x16x32_bf16 a[160:163], a[232:235], v[80:83], 0
    buffer_load_dwordx4 v6, s[16:19], s39 offen lds
    v_mfma_f32_16x16x32_bf16 a[176:179], a[236:239], v[80:83], 0
    ds_read_b128 a[212:215], v13 offset:43008
    v_cvt_pk_bf16_f32 v113, v114, v115
    v_mfma_f32_16x16x32_bf16 a[180:183], a[236:239], v[88:91], 0
    v_exp_f32 v120, v120
    v_mfma_f32_16x16x32_bf16 a[164:167], a[232:235], v[88:91], 0
    v_exp_f32 v121, v121
    v_mfma_f32_16x16x32_bf16 v[100:103], a[184:187], a[0:3], 0
    s_waitcnt lgkmcnt(2)
    ds_read_b128 a[216:219], v12 offset:44032
    v_cvt_pk_bf16_f32 v120, v120, v121
    v_mfma_f32_16x16x32_bf16 v[100:103], a[188:191], a[16:19], v[100:103]
    s_add_u32 s39, s40, 86016
    v_exp_f32 v122, v122
    v_mfma_f32_16x16x32_bf16 v[100:103], a[192:195], a[32:35], v[100:103]
    s_addk_i32 m0, 4096
    v_exp_f32 v123, v123
    v_mfma_f32_16x16x32_bf16 v[100:103], a[196:199], a[48:51], v[100:103]
    ds_read_b128 a[220:223], v13 offset:44032
    v_cvt_pk_bf16_f32 v121, v122, v123
    v_mfma_f32_16x16x32_bf16 v[100:103], a[200:203], a[64:67], v[100:103]
    v_exp_f32 v24, v24
    v_mfma_f32_16x16x32_bf16 v[100:103], a[204:207], a[80:83], v[100:103]
    v_exp_f32 v25, v25
    v_mfma_f32_16x16x32_bf16 v[108:111], a[204:207], a[84:87], 0
    ds_read_b128 a[224:227], v12 offset:45056
    v_cvt_pk_bf16_f32 v98, v24, v25
    v_mfma_f32_16x16x32_bf16 v[108:111], a[200:203], a[68:71], v[108:111]
    v_exp_f32 v26, v26
    v_mfma_f32_16x16x32_bf16 v[108:111], a[196:199], a[52:55], v[108:111]
    buffer_load_dwordx4 v6, s[16:19], s39 offen lds
    v_mfma_f32_16x16x32_bf16 v[108:111], a[192:195], a[36:39], v[108:111]
    v_exp_f32 v27, v27
    v_mfma_f32_16x16x32_bf16 v[108:111], a[188:191], a[20:23], v[108:111]
    ds_read_b128 a[228:231], v13 offset:45056
    v_cvt_pk_bf16_f32 v99, v26, v27
    v_mfma_f32_16x16x32_bf16 v[108:111], a[184:187], a[4:7], v[108:111]
    v_exp_f32 v28, v28
    v_mfma_f32_16x16x32_bf16 v[116:119], a[184:187], a[8:11], 0
    v_exp_f32 v29, v29
    v_mfma_f32_16x16x32_bf16 v[116:119], a[188:191], a[24:27], v[116:119]
    v_exp_f32 v30, v30
    v_mfma_f32_16x16x32_bf16 v[116:119], a[192:195], a[40:43], v[116:119]
    v_exp_f32 v31, v31
    v_mfma_f32_16x16x32_bf16 v[116:119], a[196:199], a[56:59], v[116:119]
    v_exp_f32 v32, v32
    v_mfma_f32_16x16x32_bf16 v[116:119], a[200:203], a[72:75], v[116:119]
    v_exp_f32 v33, v33
    v_mfma_f32_16x16x32_bf16 v[116:119], a[204:207], a[88:91], v[116:119]
    v_exp_f32 v34, v34
    v_mfma_f32_16x16x32_bf16 v[124:127], a[204:207], a[92:95], 0
    v_exp_f32 v35, v35
    v_mfma_f32_16x16x32_bf16 v[124:127], a[200:203], a[76:79], v[124:127]
    v_cvt_pk_bf16_f32 v106, v28, v29
    v_cvt_pk_bf16_f32 v107, v30, v31
    v_mfma_f32_16x16x32_bf16 v[124:127], a[196:199], a[60:63], v[124:127]
    s_add_u32 m0, s49, 24576
    v_exp_f32 v36, v36
    v_mfma_f32_16x16x32_bf16 v[124:127], a[192:195], a[44:47], v[124:127]
    s_waitcnt lgkmcnt(0)
    v_exp_f32 v37, v37
    v_mfma_f32_16x16x32_bf16 v[124:127], a[188:191], a[28:31], v[124:127]
    v_exp_f32 v38, v38
    v_mfma_f32_16x16x32_bf16 v[124:127], a[184:187], a[12:15], v[124:127]
    v_exp_f32 v39, v39
    v_mfma_f32_16x16x32_bf16 v[40:43], a[208:211], a[0:3], 0
    s_waitcnt vmcnt(11)
    v_cvt_pk_bf16_f32 v114, v32, v33
    v_cvt_pk_bf16_f32 v115, v34, v35
    v_mfma_f32_16x16x32_bf16 v[40:43], a[212:215], a[16:19], v[40:43]
    s_barrier
    v_mfma_f32_16x16x32_bf16 v[40:43], a[216:219], a[32:35], v[40:43]
    buffer_load_dwordx4 v4, s[12:15], s38 offen offset:0 lds
    v_mfma_f32_16x16x32_bf16 v[40:43], a[220:223], a[48:51], v[40:43]
    ds_read_b64_tr_b16 a[240:241], v8 offset:4096
    v_cvt_pk_bf16_f32 v122, v36, v37
    v_mfma_f32_16x16x32_bf16 v[40:43], a[224:227], a[64:67], v[40:43]
    ds_read_b64_tr_b16 a[242:243], v8 offset:6144
    v_cvt_pk_bf16_f32 v123, v38, v39
    v_mfma_f32_16x16x32_bf16 v[40:43], a[228:231], a[80:83], v[40:43]
    v_exp_f32 v100, v100
    v_mfma_f32_16x16x32_bf16 v[44:47], a[228:231], a[84:87], 0
    v_exp_f32 v101, v101
    v_mfma_f32_16x16x32_bf16 v[44:47], a[224:227], a[68:71], v[44:47]
    ds_read_b64_tr_b16 a[244:245], v9 offset:4096
    v_cvt_pk_bf16_f32 v100, v100, v101
    v_mfma_f32_16x16x32_bf16 v[44:47], a[220:223], a[52:55], v[44:47]
    s_addk_i32 m0, 896
    v_exp_f32 v102, v102
    v_mfma_f32_16x16x32_bf16 v[44:47], a[216:219], a[36:39], v[44:47]
    v_exp_f32 v103, v103
    v_mfma_f32_16x16x32_bf16 v[44:47], a[212:215], a[20:23], v[44:47]
    ds_read_b64_tr_b16 a[246:247], v9 offset:6144
    v_cvt_pk_bf16_f32 v101, v102, v103
    v_mfma_f32_16x16x32_bf16 v[44:47], a[208:211], a[4:7], v[44:47]
    v_exp_f32 v108, v108
    v_mfma_f32_16x16x32_bf16 v[48:51], a[208:211], a[8:11], 0
    buffer_load_dword a252, v22, s[32:35], s42 offen offset:1536
    s_add_u32 s42, s42, 3072
    v_mfma_f32_16x16x32_bf16 v[48:51], a[212:215], a[24:27], v[48:51]
    v_exp_f32 v109, v109
    v_mfma_f32_16x16x32_bf16 v[48:51], a[216:219], a[40:43], v[48:51]
    buffer_load_dwordx4 v4, s[12:15], s38 offen offset:128 lds
    v_mfma_f32_16x16x32_bf16 v[48:51], a[220:223], a[56:59], v[48:51]
    ds_read_b128 a[184:187], v12 offset:49152
    v_cvt_pk_bf16_f32 v108, v108, v109
    v_mfma_f32_16x16x32_bf16 v[48:51], a[224:227], a[72:75], v[48:51]
    v_exp_f32 v110, v110
    v_mfma_f32_16x16x32_bf16 v[48:51], a[228:231], a[88:91], v[48:51]
    v_exp_f32 v111, v111
    v_mfma_f32_16x16x32_bf16 v[52:55], a[228:231], a[92:95], 0
    ds_read_b128 a[188:191], v13 offset:49152
    v_cvt_pk_bf16_f32 v109, v110, v111
    v_mfma_f32_16x16x32_bf16 v[52:55], a[224:227], a[76:79], v[52:55]
    v_exp_f32 v116, v116
    v_mfma_f32_16x16x32_bf16 v[52:55], a[220:223], a[60:63], v[52:55]
    s_addk_i32 m0, 896
    ds_read_b128 a[192:195], v12 offset:50176
    v_accvgpr_write_b32 a96, v64
    v_mfma_f32_16x16x32_bf16 v[52:55], a[216:219], a[44:47], v[52:55]
    s_waitcnt lgkmcnt(3)
    v_exp_f32 v117, v117
    v_mfma_f32_16x16x32_bf16 v[52:55], a[212:215], a[28:31], v[52:55]
    ds_read_b128 a[196:199], v13 offset:50176
    v_cvt_pk_bf16_f32 v116, v116, v117
    v_mfma_f32_16x16x32_bf16 v[52:55], a[208:211], a[12:15], v[52:55]
    v_exp_f32 v118, v118
    v_mfma_f32_16x16x32_bf16 a[164:167], a[240:243], v[92:95], a[164:167]
    v_exp_f32 v119, v119
    v_mfma_f32_16x16x32_bf16 a[180:183], a[244:247], v[92:95], a[180:183]
    ds_read_b128 a[200:203], v12 offset:51200
    v_cvt_pk_bf16_f32 v117, v118, v119
    v_mfma_f32_16x16x32_bf16 a[176:179], a[244:247], v[84:87], a[176:179]
    buffer_load_dwordx4 v4, s[12:15], s38 offen offset:256 lds
    v_mfma_f32_16x16x32_bf16 a[160:163], a[240:243], v[84:87], a[160:163]
    ds_read_b128 a[204:207], v13 offset:51200
    v_accvgpr_write_b32 a97, v65
    v_mfma_f32_16x16x32_bf16 a[156:159], a[240:243], v[76:79], a[156:159]
    v_exp_f32 v124, v124
    v_mfma_f32_16x16x32_bf16 a[172:175], a[244:247], v[76:79], a[172:175]
    s_waitcnt lgkmcnt(2)
    v_exp_f32 v125, v125
    v_mfma_f32_16x16x32_bf16 a[168:171], a[244:247], v[68:71], a[168:171]
    ds_read_b128 a[208:211], v12 offset:55296
    v_cvt_pk_bf16_f32 v124, v124, v125
    v_mfma_f32_16x16x32_bf16 a[152:155], a[240:243], v[68:71], a[152:155]
    v_exp_f32 v126, v126
    v_mfma_f32_16x16x32_bf16 v[128:131], a[184:187], a[0:3], 0
    s_addk_i32 m0, 1280
    v_exp_f32 v127, v127
    v_mfma_f32_16x16x32_bf16 v[128:131], a[188:191], a[16:19], v[128:131]
    s_waitcnt lgkmcnt(2)
    ds_read_b128 a[212:215], v13 offset:55296
    v_cvt_pk_bf16_f32 v125, v126, v127
    v_mfma_f32_16x16x32_bf16 v[128:131], a[192:195], a[32:35], v[128:131]
    s_waitcnt lgkmcnt(2)
    v_exp_f32 v40, v40
    v_mfma_f32_16x16x32_bf16 v[128:131], a[196:199], a[48:51], v[128:131]
    ds_read_b128 a[216:219], v12 offset:56320
    v_accvgpr_write_b32 a98, v66
    v_mfma_f32_16x16x32_bf16 v[128:131], a[200:203], a[64:67], v[128:131]
    v_exp_f32 v41, v41
    v_mfma_f32_16x16x32_bf16 v[128:131], a[204:207], a[80:83], v[128:131]
    ds_read_b128 a[220:223], v13 offset:56320
    v_cvt_pk_bf16_f32 v102, v40, v41
    v_mfma_f32_16x16x32_bf16 v[136:139], a[204:207], a[84:87], 0
    buffer_load_dwordx4 v5, s[12:15], s38 offen offset:0 lds
    v_mfma_f32_16x16x32_bf16 v[136:139], a[200:203], a[68:71], v[136:139]
    v_exp_f32 v42, v42
    v_mfma_f32_16x16x32_bf16 v[136:139], a[196:199], a[52:55], v[136:139]
    v_exp_f32 v43, v43
    v_mfma_f32_16x16x32_bf16 v[136:139], a[192:195], a[36:39], v[136:139]
    ds_read_b128 a[224:227], v12 offset:57344
    v_cvt_pk_bf16_f32 v103, v42, v43
    v_mfma_f32_16x16x32_bf16 v[136:139], a[188:191], a[20:23], v[136:139]
    v_exp_f32 v44, v44
    v_mfma_f32_16x16x32_bf16 v[136:139], a[184:187], a[4:7], v[136:139]
    ds_read_b128 a[228:231], v13 offset:57344
    v_accvgpr_write_b32 a99, v67
    v_mfma_f32_16x16x32_bf16 v[144:147], a[184:187], a[8:11], 0
    s_addk_i32 m0, 896
    v_exp_f32 v45, v45
    v_mfma_f32_16x16x32_bf16 v[144:147], a[188:191], a[24:27], v[144:147]
    v_exp_f32 v46, v46
    v_mfma_f32_16x16x32_bf16 v[144:147], a[192:195], a[40:43], v[144:147]
    v_exp_f32 v47, v47
    v_mfma_f32_16x16x32_bf16 v[144:147], a[196:199], a[56:59], v[144:147]
    v_exp_f32 v48, v48
    v_mfma_f32_16x16x32_bf16 v[144:147], a[200:203], a[72:75], v[144:147]
    v_exp_f32 v49, v49
    v_mfma_f32_16x16x32_bf16 v[144:147], a[204:207], a[88:91], v[144:147]
    v_exp_f32 v50, v50
    v_mfma_f32_16x16x32_bf16 v[152:155], a[204:207], a[92:95], 0
    buffer_load_dwordx4 v5, s[12:15], s38 offen offset:128 lds
    v_mfma_f32_16x16x32_bf16 v[152:155], a[200:203], a[76:79], v[152:155]
    ds_read_b64_tr_b16 a[232:233], v8 offset:8192
    v_cvt_pk_bf16_f32 v110, v44, v45
    v_mfma_f32_16x16x32_bf16 v[152:155], a[196:199], a[60:63], v[152:155]
    ds_read_b64_tr_b16 a[234:235], v8 offset:10240
    v_cvt_pk_bf16_f32 v111, v46, v47
    v_mfma_f32_16x16x32_bf16 v[152:155], a[192:195], a[44:47], v[152:155]
    s_waitcnt lgkmcnt(2)
    ds_read_b64_tr_b16 a[236:237], v9 offset:8192
    v_cvt_pk_bf16_f32 v118, v48, v49
    v_mfma_f32_16x16x32_bf16 v[152:155], a[188:191], a[28:31], v[152:155]
    ds_read_b64_tr_b16 a[238:239], v9 offset:10240
    v_accvgpr_write_b32 a100, v68
    v_mfma_f32_16x16x32_bf16 v[152:155], a[184:187], a[12:15], v[152:155]
    v_exp_f32 v51, v51
    v_mfma_f32_16x16x32_bf16 v[24:27], a[208:211], a[0:3], 0
    s_addk_i32 m0, 896
    v_exp_f32 v52, v52
    v_mfma_f32_16x16x32_bf16 v[24:27], a[212:215], a[16:19], v[24:27]
    v_exp_f32 v53, v53
    v_mfma_f32_16x16x32_bf16 v[24:27], a[216:219], a[32:35], v[24:27]
    ds_read_b128 a[184:187], v12 offset:61440
    v_cvt_pk_bf16_f32 v119, v50, v51
    v_mfma_f32_16x16x32_bf16 v[24:27], a[220:223], a[48:51], v[24:27]
    ds_read_b128 a[188:191], v13 offset:61440
    v_cvt_pk_bf16_f32 v126, v52, v53
    v_mfma_f32_16x16x32_bf16 v[24:27], a[224:227], a[64:67], v[24:27]
    ds_read_b128 a[192:195], v12 offset:62464
    v_accvgpr_write_b32 a101, v69
    v_mfma_f32_16x16x32_bf16 v[24:27], a[228:231], a[80:83], v[24:27]
    v_exp_f32 v54, v54
    v_mfma_f32_16x16x32_bf16 v[28:31], a[228:231], a[84:87], 0
    buffer_load_dwordx4 v5, s[12:15], s38 offen offset:256 lds
    v_mfma_f32_16x16x32_bf16 v[28:31], a[224:227], a[68:71], v[28:31]
    s_add_u32 s38, s38, 24576
    v_exp_f32 v55, v55
    v_mfma_f32_16x16x32_bf16 v[28:31], a[220:223], a[52:55], v[28:31]
    ds_read_b128 a[196:199], v13 offset:62464
    v_cvt_pk_bf16_f32 v127, v54, v55
    v_mfma_f32_16x16x32_bf16 v[28:31], a[216:219], a[36:39], v[28:31]
    v_exp_f32 v128, v128
    v_mfma_f32_16x16x32_bf16 v[28:31], a[212:215], a[20:23], v[28:31]
    s_add_u32 s39, s40, 98304
    ds_read_b128 a[200:203], v12 offset:63488
    v_add_u32 v12, 67584, v12
    v_mfma_f32_16x16x32_bf16 v[28:31], a[208:211], a[4:7], v[28:31]
    ds_read_b128 a[204:207], v13 offset:63488
    v_add_u32 v13, 67584, v13
    v_mfma_f32_16x16x32_bf16 v[32:35], a[208:211], a[8:11], 0
    s_add_u32 m0, s63, 106496
    v_exp_f32 v129, v129
    v_mfma_f32_16x16x32_bf16 v[32:35], a[212:215], a[24:27], v[32:35]
    v_exp_f32 v130, v130
    v_mfma_f32_16x16x32_bf16 v[32:35], a[216:219], a[40:43], v[32:35]
    v_exp_f32 v131, v131
    v_mfma_f32_16x16x32_bf16 v[32:35], a[220:223], a[56:59], v[32:35]
    v_exp_f32 v136, v136
    v_mfma_f32_16x16x32_bf16 v[32:35], a[224:227], a[72:75], v[32:35]
    v_exp_f32 v137, v137
    v_mfma_f32_16x16x32_bf16 v[32:35], a[228:231], a[88:91], v[32:35]
    v_exp_f32 v138, v138
    v_mfma_f32_16x16x32_bf16 v[36:39], a[228:231], a[92:95], 0
    buffer_load_dwordx4 v6, s[16:19], s39 offen lds
    v_mfma_f32_16x16x32_bf16 v[36:39], a[224:227], a[76:79], v[36:39]
    v_exp_f32 v139, v139
    v_mfma_f32_16x16x32_bf16 v[36:39], a[220:223], a[60:63], v[36:39]
    v_cvt_pk_bf16_f32 v128, v128, v129
    v_cvt_pk_bf16_f32 v129, v130, v131
    v_mfma_f32_16x16x32_bf16 v[36:39], a[216:219], a[44:47], v[36:39]
    s_waitcnt lgkmcnt(0)
    v_exp_f32 v144, v144
    v_mfma_f32_16x16x32_bf16 v[36:39], a[212:215], a[28:31], v[36:39]
    s_add_u32 s39, s40, 110592
    v_exp_f32 v145, v145
    v_mfma_f32_16x16x32_bf16 v[36:39], a[208:211], a[12:15], v[36:39]
    v_exp_f32 v146, v146
    v_mfma_f32_16x16x32_bf16 a[152:155], a[232:235], v[96:99], a[152:155]
    s_addk_i32 m0, 4096
    v_exp_f32 v147, v147
    v_mfma_f32_16x16x32_bf16 a[168:171], a[236:239], v[96:99], a[168:171]
    v_cvt_pk_bf16_f32 v136, v136, v137
    v_cvt_pk_bf16_f32 v137, v138, v139
    v_mfma_f32_16x16x32_bf16 a[172:175], a[236:239], v[104:107], a[172:175]
    ds_read_b128 a[208:211], v12 offset:0
    v_cvt_pk_bf16_f32 v144, v144, v145
    v_mfma_f32_16x16x32_bf16 a[156:159], a[232:235], v[104:107], a[156:159]
    ds_read_b128 a[212:215], v13 offset:0
    v_cvt_pk_bf16_f32 v145, v146, v147
    v_mfma_f32_16x16x32_bf16 a[160:163], a[232:235], v[112:115], a[160:163]
    ds_read_b128 a[216:219], v12 offset:1024
    v_accvgpr_write_b32 a102, v70
    v_mfma_f32_16x16x32_bf16 a[176:179], a[236:239], v[112:115], a[176:179]
    ds_read_b128 a[220:223], v13 offset:1024
    v_accvgpr_write_b32 a103, v71
    v_mfma_f32_16x16x32_bf16 a[180:183], a[236:239], v[120:123], a[180:183]
    buffer_load_dwordx4 v6, s[16:19], s39 offen lds
    v_mfma_f32_16x16x32_bf16 a[164:167], a[232:235], v[120:123], a[164:167]
    ds_read_b128 a[224:227], v12 offset:2048
    v_accvgpr_write_b32 a104, v72
    v_mfma_f32_16x16x32_bf16 v[132:135], a[184:187], a[0:3], 0
    ds_read_b128 a[228:231], v13 offset:2048
    v_subrev_u32 v12, 67584, v12
    v_mfma_f32_16x16x32_bf16 v[132:135], a[188:191], a[16:19], v[132:135]
    v_exp_f32 v152, v152
    v_mfma_f32_16x16x32_bf16 v[132:135], a[192:195], a[32:35], v[132:135]
    v_exp_f32 v153, v153
    v_mfma_f32_16x16x32_bf16 v[132:135], a[196:199], a[48:51], v[132:135]
    v_exp_f32 v154, v154
    v_mfma_f32_16x16x32_bf16 v[132:135], a[200:203], a[64:67], v[132:135]
    v_exp_f32 v155, v155
    v_mfma_f32_16x16x32_bf16 v[132:135], a[204:207], a[80:83], v[132:135]
    v_exp_f32 v24, v24
    v_mfma_f32_16x16x32_bf16 v[140:143], a[204:207], a[84:87], 0
    v_exp_f32 v25, v25
    v_mfma_f32_16x16x32_bf16 v[140:143], a[200:203], a[68:71], v[140:143]
    v_exp_f32 v26, v26
    v_mfma_f32_16x16x32_bf16 v[140:143], a[196:199], a[52:55], v[140:143]
    v_exp_f32 v27, v27
    v_mfma_f32_16x16x32_bf16 v[140:143], a[192:195], a[36:39], v[140:143]
    v_cvt_pk_bf16_f32 v152, v152, v153
    v_cvt_pk_bf16_f32 v153, v154, v155
    v_mfma_f32_16x16x32_bf16 v[140:143], a[188:191], a[20:23], v[140:143]
    v_exp_f32 v28, v28
    v_mfma_f32_16x16x32_bf16 v[140:143], a[184:187], a[4:7], v[140:143]
    v_exp_f32 v29, v29
    v_mfma_f32_16x16x32_bf16 v[148:151], a[184:187], a[8:11], 0
    v_exp_f32 v30, v30
    v_mfma_f32_16x16x32_bf16 v[148:151], a[188:191], a[24:27], v[148:151]
    v_exp_f32 v31, v31
    v_mfma_f32_16x16x32_bf16 v[148:151], a[192:195], a[40:43], v[148:151]
    v_cvt_pk_bf16_f32 v130, v24, v25
    v_cvt_pk_bf16_f32 v131, v26, v27
    v_mfma_f32_16x16x32_bf16 v[148:151], a[196:199], a[56:59], v[148:151]
    v_exp_f32 v32, v32
    v_mfma_f32_16x16x32_bf16 v[148:151], a[200:203], a[72:75], v[148:151]
    v_exp_f32 v33, v33
    v_mfma_f32_16x16x32_bf16 v[148:151], a[204:207], a[88:91], v[148:151]
    v_exp_f32 v34, v34
    v_mfma_f32_16x16x32_bf16 v[156:159], a[204:207], a[92:95], 0
    v_exp_f32 v35, v35
    v_mfma_f32_16x16x32_bf16 v[156:159], a[200:203], a[76:79], v[156:159]
    v_cvt_pk_bf16_f32 v138, v28, v29
    v_cvt_pk_bf16_f32 v139, v30, v31
    v_mfma_f32_16x16x32_bf16 v[156:159], a[196:199], a[60:63], v[156:159]
    s_add_u32 m0, s49, 49152
    v_exp_f32 v36, v36
    v_mfma_f32_16x16x32_bf16 v[156:159], a[192:195], a[44:47], v[156:159]
    s_waitcnt lgkmcnt(0)
    v_exp_f32 v37, v37
    v_mfma_f32_16x16x32_bf16 v[156:159], a[188:191], a[28:31], v[156:159]
    v_exp_f32 v38, v38
    v_mfma_f32_16x16x32_bf16 v[156:159], a[184:187], a[12:15], v[156:159]
    v_exp_f32 v39, v39
    v_mfma_f32_16x16x32_bf16 v[40:43], a[208:211], a[0:3], 0
    s_waitcnt vmcnt(11)
    v_cvt_pk_bf16_f32 v146, v32, v33
    v_cvt_pk_bf16_f32 v147, v34, v35
    v_mfma_f32_16x16x32_bf16 v[40:43], a[212:215], a[16:19], v[40:43]
    s_barrier
    v_mfma_f32_16x16x32_bf16 v[40:43], a[216:219], a[32:35], v[40:43]
    buffer_load_dwordx4 v4, s[12:15], s38 offen offset:0 lds
    v_mfma_f32_16x16x32_bf16 v[40:43], a[220:223], a[48:51], v[40:43]
    ds_read_b64_tr_b16 a[240:241], v8 offset:12288
    v_cvt_pk_bf16_f32 v154, v36, v37
    v_mfma_f32_16x16x32_bf16 v[40:43], a[224:227], a[64:67], v[40:43]
    ds_read_b64_tr_b16 a[242:243], v8 offset:14336
    v_cvt_pk_bf16_f32 v155, v38, v39
    v_mfma_f32_16x16x32_bf16 v[40:43], a[228:231], a[80:83], v[40:43]
    ds_read_b64_tr_b16 a[244:245], v9 offset:12288
    v_accvgpr_write_b32 a105, v73
    v_mfma_f32_16x16x32_bf16 v[44:47], a[228:231], a[84:87], 0
    ds_read_b64_tr_b16 a[246:247], v9 offset:14336
    v_subrev_u32 v13, 67584, v13
    v_mfma_f32_16x16x32_bf16 v[44:47], a[224:227], a[68:71], v[44:47]
    ds_read_b128 a[184:187], v12 offset:0
    v_accvgpr_write_b32 a106, v74
    v_mfma_f32_16x16x32_bf16 v[44:47], a[220:223], a[52:55], v[44:47]
    s_addk_i32 m0, 896
    ds_read_b128 a[188:191], v13 offset:0
    v_accvgpr_write_b32 a107, v75
    v_mfma_f32_16x16x32_bf16 v[44:47], a[216:219], a[36:39], v[44:47]
    ds_read_b128 a[192:195], v12 offset:1024
    v_accvgpr_write_b32 a108, v76
    v_mfma_f32_16x16x32_bf16 v[44:47], a[212:215], a[20:23], v[44:47]
    ds_read_b128 a[196:199], v13 offset:1024
    v_accvgpr_write_b32 a109, v77
    v_mfma_f32_16x16x32_bf16 v[44:47], a[208:211], a[4:7], v[44:47]
    v_exp_f32 v132, v132
    v_mfma_f32_16x16x32_bf16 v[48:51], a[208:211], a[8:11], 0
    buffer_load_dword a252, v22, s[32:35], s42 offen offset:0
    v_mfma_f32_16x16x32_bf16 v[48:51], a[212:215], a[24:27], v[48:51]
    v_exp_f32 v133, v133
    v_mfma_f32_16x16x32_bf16 v[48:51], a[216:219], a[40:43], v[48:51]
    buffer_load_dwordx4 v4, s[12:15], s38 offen offset:128 lds
    v_mfma_f32_16x16x32_bf16 v[48:51], a[220:223], a[56:59], v[48:51]
    ds_read_b128 a[200:203], v12 offset:2048
    v_cvt_pk_bf16_f32 v132, v132, v133
    v_mfma_f32_16x16x32_bf16 v[48:51], a[224:227], a[72:75], v[48:51]
    v_exp_f32 v134, v134
    v_mfma_f32_16x16x32_bf16 v[48:51], a[228:231], a[88:91], v[48:51]
    ds_read_b128 a[204:207], v13 offset:2048
    v_accvgpr_write_b32 a110, v78
    v_mfma_f32_16x16x32_bf16 v[52:55], a[228:231], a[92:95], 0
pg_6:
    s_cbranch_execz pg_10
    v_exp_f32 v135, v135
    v_mfma_f32_16x16x32_bf16 v[52:55], a[224:227], a[76:79], v[52:55]
    v_exp_f32 v140, v140
    v_mfma_f32_16x16x32_bf16 v[52:55], a[220:223], a[60:63], v[52:55]
    s_addk_i32 m0, 896
    v_exp_f32 v141, v141
    v_mfma_f32_16x16x32_bf16 v[52:55], a[216:219], a[44:47], v[52:55]
    s_waitcnt lgkmcnt(2)
    v_exp_f32 v142, v142
    v_mfma_f32_16x16x32_bf16 v[52:55], a[212:215], a[28:31], v[52:55]
    v_exp_f32 v143, v143
    v_mfma_f32_16x16x32_bf16 v[52:55], a[208:211], a[12:15], v[52:55]
    v_exp_f32 v148, v148
    v_mfma_f32_16x16x32_bf16 a[164:167], a[240:243], v[124:127], a[164:167]
    v_exp_f32 v149, v149
    v_mfma_f32_16x16x32_bf16 a[180:183], a[244:247], v[124:127], a[180:183]
    v_cvt_pk_bf16_f32 v133, v134, v135
    v_cvt_pk_bf16_f32 v140, v140, v141
    v_mfma_f32_16x16x32_bf16 a[176:179], a[244:247], v[116:119], a[176:179]
    buffer_load_dwordx4 v4, s[12:15], s38 offen offset:256 lds
    v_mfma_f32_16x16x32_bf16 a[160:163], a[240:243], v[116:119], a[160:163]
    ds_read_b128 a[208:211], v12 offset:6144
    v_cvt_pk_bf16_f32 v141, v142, v143
    v_mfma_f32_16x16x32_bf16 a[156:159], a[240:243], v[108:111], a[156:159]
    ds_read_b128 a[212:215], v13 offset:6144
    v_cvt_pk_bf16_f32 v148, v148, v149
    v_mfma_f32_16x16x32_bf16 a[172:175], a[244:247], v[108:111], a[172:175]
    ds_read_b128 a[216:219], v12 offset:7168
    v_accvgpr_write_b32 a111, v79
    v_mfma_f32_16x16x32_bf16 a[168:171], a[244:247], v[100:103], a[168:171]
    v_exp_f32 v150, v150
    v_mfma_f32_16x16x32_bf16 a[152:155], a[240:243], v[100:103], a[152:155]
    v_exp_f32 v151, v151
    v_mfma_f32_16x16x32_bf16 v[160:163], a[184:187], a[0:3], 0
    s_addk_i32 m0, 1280
    ds_read_b128 a[220:223], v13 offset:7168
    v_cvt_pk_bf16_f32 v149, v150, v151
    v_mfma_f32_16x16x32_bf16 v[160:163], a[188:191], a[16:19], v[160:163]
    s_waitcnt lgkmcnt(4)
    ds_read_b128 a[224:227], v12 offset:8192
    v_accvgpr_write_b32 a112, v80
    v_mfma_f32_16x16x32_bf16 v[160:163], a[192:195], a[32:35], v[160:163]
    v_exp_f32 v156, v156
    v_mfma_f32_16x16x32_bf16 v[160:163], a[196:199], a[48:51], v[160:163]
    v_exp_f32 v157, v157
    v_mfma_f32_16x16x32_bf16 v[160:163], a[200:203], a[64:67], v[160:163]
    ds_read_b128 a[228:231], v13 offset:8192
    v_cvt_pk_bf16_f32 v156, v156, v157
    v_mfma_f32_16x16x32_bf16 v[160:163], a[204:207], a[80:83], v[160:163]
    v_exp_f32 v158, v158
    v_mfma_f32_16x16x32_bf16 v[168:171], a[204:207], a[84:87], 0
    buffer_load_dwordx4 v5, s[12:15], s38 offen offset:0 lds
    v_mfma_f32_16x16x32_bf16 v[168:171], a[200:203], a[68:71], v[168:171]
    v_exp_f32 v159, v159
    v_mfma_f32_16x16x32_bf16 v[168:171], a[196:199], a[52:55], v[168:171]
    v_exp_f32 v40, v40
    v_mfma_f32_16x16x32_bf16 v[168:171], a[192:195], a[36:39], v[168:171]
    v_exp_f32 v41, v41
    v_mfma_f32_16x16x32_bf16 v[168:171], a[188:191], a[20:23], v[168:171]
    v_exp_f32 v42, v42
    v_mfma_f32_16x16x32_bf16 v[168:171], a[184:187], a[4:7], v[168:171]
    v_exp_f32 v43, v43
    v_mfma_f32_16x16x32_bf16 v[176:179], a[184:187], a[8:11], 0
    s_addk_i32 m0, 896
    v_cvt_pk_bf16_f32 v157, v158, v159
    v_cvt_pk_bf16_f32 v134, v40, v41
    v_mfma_f32_16x16x32_bf16 v[176:179], a[188:191], a[24:27], v[176:179]
    v_exp_f32 v44, v44
    v_mfma_f32_16x16x32_bf16 v[176:179], a[192:195], a[40:43], v[176:179]
    v_exp_f32 v45, v45
    v_mfma_f32_16x16x32_bf16 v[176:179], a[196:199], a[56:59], v[176:179]
    v_exp_f32 v46, v46
    v_mfma_f32_16x16x32_bf16 v[176:179], a[200:203], a[72:75], v[176:179]
    v_exp_f32 v47, v47
    v_mfma_f32_16x16x32_bf16 v[176:179], a[204:207], a[88:91], v[176:179]
    v_cvt_pk_bf16_f32 v135, v42, v43
    v_cvt_pk_bf16_f32 v142, v44, v45
    v_mfma_f32_16x16x32_bf16 v[184:187], a[204:207], a[92:95], 0
    buffer_load_dwordx4 v5, s[12:15], s38 offen offset:128 lds
    v_mfma_f32_16x16x32_bf16 v[184:187], a[200:203], a[76:79], v[184:187]
    ds_read_b64_tr_b16 a[232:233], v8 offset:16384
    v_cvt_pk_bf16_f32 v143, v46, v47
    v_mfma_f32_16x16x32_bf16 v[184:187], a[196:199], a[60:63], v[184:187]
    ds_read_b64_tr_b16 a[234:235], v8 offset:18432
    v_accvgpr_write_b32 a113, v81
    v_mfma_f32_16x16x32_bf16 v[184:187], a[192:195], a[44:47], v[184:187]
    s_waitcnt lgkmcnt(2)
    ds_read_b64_tr_b16 a[236:237], v9 offset:16384
    v_accvgpr_write_b32 a114, v82
    v_mfma_f32_16x16x32_bf16 v[184:187], a[188:191], a[28:31], v[184:187]
    v_exp_f32 v48, v48
    v_mfma_f32_16x16x32_bf16 v[184:187], a[184:187], a[12:15], v[184:187]
    v_exp_f32 v49, v49
    v_mfma_f32_16x16x32_bf16 v[24:27], a[208:211], a[0:3], 0
    s_addk_i32 m0, 896
    ds_read_b64_tr_b16 a[238:239], v9 offset:18432
    v_cvt_pk_bf16_f32 v150, v48, v49
    v_mfma_f32_16x16x32_bf16 v[24:27], a[212:215], a[16:19], v[24:27]
    v_exp_f32 v50, v50
    v_mfma_f32_16x16x32_bf16 v[24:27], a[216:219], a[32:35], v[24:27]
    ds_read_b128 a[184:187], v12 offset:12288
    v_accvgpr_write_b32 a115, v83
    v_mfma_f32_16x16x32_bf16 v[24:27], a[220:223], a[48:51], v[24:27]
    v_exp_f32 v51, v51
    v_mfma_f32_16x16x32_bf16 v[24:27], a[224:227], a[64:67], v[24:27]
    ds_read_b128 a[188:191], v13 offset:12288
    v_cvt_pk_bf16_f32 v151, v50, v51
    v_mfma_f32_16x16x32_bf16 v[24:27], a[228:231], a[80:83], v[24:27]
    v_exp_f32 v52, v52
    v_mfma_f32_16x16x32_bf16 v[28:31], a[228:231], a[84:87], 0
    buffer_load_dwordx4 v5, s[12:15], s38 offen offset:256 lds
    v_mfma_f32_16x16x32_bf16 v[28:31], a[224:227], a[68:71], v[28:31]
    s_add_u32 s38, s38, 24576
    v_exp_f32 v53, v53
    v_mfma_f32_16x16x32_bf16 v[28:31], a[220:223], a[52:55], v[28:31]
    ds_read_b128 a[192:195], v12 offset:13312
    v_cvt_pk_bf16_f32 v158, v52, v53
    v_mfma_f32_16x16x32_bf16 v[28:31], a[216:219], a[36:39], v[28:31]
    ds_read_b128 a[196:199], v13 offset:13312
    v_accvgpr_write_b32 a116, v84
    v_mfma_f32_16x16x32_bf16 v[28:31], a[212:215], a[20:23], v[28:31]
    s_add_u32 s39, s40, 122880
    v_exp_f32 v54, v54
    v_mfma_f32_16x16x32_bf16 v[28:31], a[208:211], a[4:7], v[28:31]
    v_exp_f32 v55, v55
    v_mfma_f32_16x16x32_bf16 v[32:35], a[208:211], a[8:11], 0
    s_add_u32 m0, s63, 114688
    ds_read_b128 a[200:203], v12 offset:14336
    v_cvt_pk_bf16_f32 v159, v54, v55
    v_mfma_f32_16x16x32_bf16 v[32:35], a[212:215], a[24:27], v[32:35]
    v_exp_f32 v160, v160
    v_mfma_f32_16x16x32_bf16 v[32:35], a[216:219], a[40:43], v[32:35]
    v_exp_f32 v161, v161
    v_mfma_f32_16x16x32_bf16 v[32:35], a[220:223], a[56:59], v[32:35]
    ds_read_b128 a[204:207], v13 offset:14336
    v_cvt_pk_bf16_f32 v160, v160, v161
    v_mfma_f32_16x16x32_bf16 v[32:35], a[224:227], a[72:75], v[32:35]
    v_exp_f32 v162, v162
    v_mfma_f32_16x16x32_bf16 v[32:35], a[228:231], a[88:91], v[32:35]
    v_exp_f32 v163, v163
    v_mfma_f32_16x16x32_bf16 v[36:39], a[228:231], a[92:95], 0
    buffer_load_dwordx4 v6, s[16:19], s39 offen lds
    v_mfma_f32_16x16x32_bf16 v[36:39], a[224:227], a[76:79], v[36:39]
    v_exp_f32 v168, v168
    v_mfma_f32_16x16x32_bf16 v[36:39], a[220:223], a[60:63], v[36:39]
    v_exp_f32 v169, v169
    v_mfma_f32_16x16x32_bf16 v[36:39], a[216:219], a[44:47], v[36:39]
    s_waitcnt lgkmcnt(1)
    v_exp_f32 v170, v170
    v_mfma_f32_16x16x32_bf16 v[36:39], a[212:215], a[28:31], v[36:39]
    s_add_u32 s39, s40, 135168
    v_exp_f32 v171, v171
    v_mfma_f32_16x16x32_bf16 v[36:39], a[208:211], a[12:15], v[36:39]
    v_exp_f32 v176, v176
    v_mfma_f32_16x16x32_bf16 a[152:155], a[232:235], v[128:131], a[152:155]
    s_addk_i32 m0, 4096
    v_cvt_pk_bf16_f32 v161, v162, v163
    v_cvt_pk_bf16_f32 v168, v168, v169
    v_mfma_f32_16x16x32_bf16 a[168:171], a[236:239], v[128:131], a[168:171]
    v_exp_f32 v177, v177
    v_mfma_f32_16x16x32_bf16 a[172:175], a[236:239], v[136:139], a[172:175]
    ds_read_b128 a[208:211], v12 offset:18432
    v_cvt_pk_bf16_f32 v169, v170, v171
    v_mfma_f32_16x16x32_bf16 a[156:159], a[232:235], v[136:139], a[156:159]
    ds_read_b128 a[212:215], v13 offset:18432
    v_cvt_pk_bf16_f32 v176, v176, v177
    v_mfma_f32_16x16x32_bf16 a[160:163], a[232:235], v[144:147], a[160:163]
    ds_read_b128 a[216:219], v12 offset:19456
    v_accvgpr_write_b32 a117, v85
    v_mfma_f32_16x16x32_bf16 a[176:179], a[236:239], v[144:147], a[176:179]
    ds_read_b128 a[220:223], v13 offset:19456
    v_accvgpr_write_b32 a118, v86
    v_mfma_f32_16x16x32_bf16 a[180:183], a[236:239], v[152:155], a[180:183]
    buffer_load_dwordx4 v6, s[16:19], s39 offen lds
    v_mfma_f32_16x16x32_bf16 a[164:167], a[232:235], v[152:155], a[164:167]
    ds_read_b128 a[224:227], v12 offset:20480
    v_accvgpr_write_b32 a119, v87
    v_mfma_f32_16x16x32_bf16 v[164:167], a[184:187], a[0:3], 0
    v_exp_f32 v178, v178
    v_mfma_f32_16x16x32_bf16 v[164:167], a[188:191], a[16:19], v[164:167]
    v_exp_f32 v179, v179
    v_mfma_f32_16x16x32_bf16 v[164:167], a[192:195], a[32:35], v[164:167]
    s_waitcnt lgkmcnt(3)
    ds_read_b128 a[228:231], v13 offset:20480
    v_cvt_pk_bf16_f32 v177, v178, v179
    v_mfma_f32_16x16x32_bf16 v[164:167], a[196:199], a[48:51], v[164:167]
    v_exp_f32 v184, v184
    v_mfma_f32_16x16x32_bf16 v[164:167], a[200:203], a[64:67], v[164:167]
    v_exp_f32 v185, v185
    v_mfma_f32_16x16x32_bf16 v[164:167], a[204:207], a[80:83], v[164:167]
    v_exp_f32 v186, v186
    v_mfma_f32_16x16x32_bf16 v[172:175], a[204:207], a[84:87], 0
    v_exp_f32 v187, v187
    v_mfma_f32_16x16x32_bf16 v[172:175], a[200:203], a[68:71], v[172:175]
    v_exp_f32 v24, v24
    v_mfma_f32_16x16x32_bf16 v[172:175], a[196:199], a[52:55], v[172:175]
    v_exp_f32 v25, v25
    v_mfma_f32_16x16x32_bf16 v[172:175], a[192:195], a[36:39], v[172:175]
    v_exp_f32 v26, v26
    v_mfma_f32_16x16x32_bf16 v[172:175], a[188:191], a[20:23], v[172:175]
    v_exp_f32 v27, v27
    v_mfma_f32_16x16x32_bf16 v[172:175], a[184:187], a[4:7], v[172:175]
    v_cvt_pk_bf16_f32 v184, v184, v185
    v_cvt_pk_bf16_f32 v185, v186, v187
    v_mfma_f32_16x16x32_bf16 v[180:183], a[184:187], a[8:11], 0
    v_exp_f32 v28, v28
    v_mfma_f32_16x16x32_bf16 v[180:183], a[188:191], a[24:27], v[180:183]
    v_exp_f32 v29, v29
    v_mfma_f32_16x16x32_bf16 v[180:183], a[192:195], a[40:43], v[180:183]
    v_exp_f32 v30, v30
    v_mfma_f32_16x16x32_bf16 v[180:183], a[196:199], a[56:59], v[180:183]
    v_exp_f32 v31, v31
    v_mfma_f32_16x16x32_bf16 v[180:183], a[200:203], a[72:75], v[180:183]
    v_cvt_pk_bf16_f32 v162, v24, v25
    v_cvt_pk_bf16_f32 v163, v26, v27
    v_mfma_f32_16x16x32_bf16 v[180:183], a[204:207], a[88:91], v[180:183]
    v_exp_f32 v32, v32
    v_mfma_f32_16x16x32_bf16 v[188:191], a[204:207], a[92:95], 0
    v_exp_f32 v33, v33
    v_mfma_f32_16x16x32_bf16 v[188:191], a[200:203], a[76:79], v[188:191]
    v_exp_f32 v34, v34
    v_mfma_f32_16x16x32_bf16 v[188:191], a[196:199], a[60:63], v[188:191]
    s_add_u32 m0, s49, 0
    v_exp_f32 v35, v35
    v_mfma_f32_16x16x32_bf16 v[188:191], a[192:195], a[44:47], v[188:191]
    v_cvt_pk_bf16_f32 v170, v28, v29
    v_cvt_pk_bf16_f32 v171, v30, v31
    v_mfma_f32_16x16x32_bf16 v[188:191], a[188:191], a[28:31], v[188:191]
    v_exp_f32 v36, v36
    v_mfma_f32_16x16x32_bf16 v[188:191], a[184:187], a[12:15], v[188:191]
    s_waitcnt lgkmcnt(0)
    v_exp_f32 v37, v37
    v_mfma_f32_16x16x32_bf16 v[40:43], a[208:211], a[0:3], 0
    s_waitcnt vmcnt(11)
    v_exp_f32 v38, v38
    v_mfma_f32_16x16x32_bf16 v[40:43], a[212:215], a[16:19], v[40:43]
    s_barrier
    v_mfma_f32_16x16x32_bf16 v[40:43], a[216:219], a[32:35], v[40:43]
    buffer_load_dwordx4 v4, s[12:15], s38 offen offset:0 lds
    v_mfma_f32_16x16x32_bf16 v[40:43], a[220:223], a[48:51], v[40:43]
    ds_read_b64_tr_b16 a[240:241], v8 offset:20480
    v_cvt_pk_bf16_f32 v178, v32, v33
    v_mfma_f32_16x16x32_bf16 v[40:43], a[224:227], a[64:67], v[40:43]
    ds_read_b64_tr_b16 a[242:243], v8 offset:22528
    v_cvt_pk_bf16_f32 v179, v34, v35
    v_mfma_f32_16x16x32_bf16 v[40:43], a[228:231], a[80:83], v[40:43]
    ds_read_b64_tr_b16 a[244:245], v9 offset:20480
    v_cvt_pk_bf16_f32 v186, v36, v37
    v_mfma_f32_16x16x32_bf16 v[44:47], a[228:231], a[84:87], 0
    ds_read_b64_tr_b16 a[246:247], v9 offset:22528
    v_accvgpr_write_b32 a120, v88
    v_mfma_f32_16x16x32_bf16 v[44:47], a[224:227], a[68:71], v[44:47]
    ds_read_b128 a[184:187], v12 offset:24576
    v_accvgpr_write_b32 a121, v89
    v_mfma_f32_16x16x32_bf16 v[44:47], a[220:223], a[52:55], v[44:47]
    s_addk_i32 m0, 896
    ds_read_b128 a[188:191], v13 offset:24576
    v_accvgpr_write_b32 a122, v90
    v_mfma_f32_16x16x32_bf16 v[44:47], a[216:219], a[36:39], v[44:47]
    ds_read_b128 a[192:195], v12 offset:25600
    v_accvgpr_write_b32 a123, v91
    v_mfma_f32_16x16x32_bf16 v[44:47], a[212:215], a[20:23], v[44:47]
    v_exp_f32 v39, v39
    v_mfma_f32_16x16x32_bf16 v[44:47], a[208:211], a[4:7], v[44:47]
    ds_read_b128 a[196:199], v13 offset:25600
    v_cvt_pk_bf16_f32 v187, v38, v39
    v_mfma_f32_16x16x32_bf16 v[48:51], a[208:211], a[8:11], 0
    buffer_load_dword a252, v22, s[32:35], s42 offen offset:1536
    s_add_u32 s42, s42, 3072
    v_mfma_f32_16x16x32_bf16 v[48:51], a[212:215], a[24:27], v[48:51]
    v_exp_f32 v164, v164
    v_mfma_f32_16x16x32_bf16 v[48:51], a[216:219], a[40:43], v[48:51]
    buffer_load_dwordx4 v4, s[12:15], s38 offen offset:128 lds
    v_mfma_f32_16x16x32_bf16 v[48:51], a[220:223], a[56:59], v[48:51]
    ds_read_b128 a[200:203], v12 offset:26624
    v_accvgpr_write_b32 a124, v92
    v_mfma_f32_16x16x32_bf16 v[48:51], a[224:227], a[72:75], v[48:51]
    v_exp_f32 v165, v165
    v_mfma_f32_16x16x32_bf16 v[48:51], a[228:231], a[88:91], v[48:51]
    ds_read_b128 a[204:207], v13 offset:26624
    v_cvt_pk_bf16_f32 v164, v164, v165
    v_mfma_f32_16x16x32_bf16 v[52:55], a[228:231], a[92:95], 0
    v_exp_f32 v166, v166
    v_mfma_f32_16x16x32_bf16 v[52:55], a[224:227], a[76:79], v[52:55]
    v_exp_f32 v167, v167
    v_mfma_f32_16x16x32_bf16 v[52:55], a[220:223], a[60:63], v[52:55]
    s_addk_i32 m0, 896
    v_exp_f32 v172, v172
    v_mfma_f32_16x16x32_bf16 v[52:55], a[216:219], a[44:47], v[52:55]
    s_waitcnt lgkmcnt(2)
    v_exp_f32 v173, v173
    v_mfma_f32_16x16x32_bf16 v[52:55], a[212:215], a[28:31], v[52:55]
    v_exp_f32 v174, v174
    v_mfma_f32_16x16x32_bf16 v[52:55], a[208:211], a[12:15], v[52:55]
    v_exp_f32 v175, v175
    v_mfma_f32_16x16x32_bf16 a[164:167], a[240:243], v[156:159], a[164:167]
    v_exp_f32 v180, v180
    v_mfma_f32_16x16x32_bf16 a[180:183], a[244:247], v[156:159], a[180:183]
    v_exp_f32 v181, v181
    v_mfma_f32_16x16x32_bf16 a[176:179], a[244:247], v[148:151], a[176:179]
    buffer_load_dwordx4 v4, s[12:15], s38 offen offset:256 lds
    v_mfma_f32_16x16x32_bf16 a[160:163], a[240:243], v[148:151], a[160:163]
    ds_read_b128 a[208:211], v12 offset:30720
    v_cvt_pk_bf16_f32 v165, v166, v167
    v_mfma_f32_16x16x32_bf16 a[156:159], a[240:243], v[140:143], a[156:159]
    ds_read_b128 a[212:215], v13 offset:30720
    v_cvt_pk_bf16_f32 v172, v172, v173
    v_mfma_f32_16x16x32_bf16 a[172:175], a[244:247], v[140:143], a[172:175]
    ds_read_b128 a[216:219], v12 offset:31744
    v_cvt_pk_bf16_f32 v173, v174, v175
    v_mfma_f32_16x16x32_bf16 a[168:171], a[244:247], v[132:135], a[168:171]
    ds_read_b128 a[220:223], v13 offset:31744
    v_cvt_pk_bf16_f32 v180, v180, v181
    v_mfma_f32_16x16x32_bf16 a[152:155], a[240:243], v[132:135], a[152:155]
    ds_read_b128 a[224:227], v12 offset:32768
    v_accvgpr_write_b32 a125, v93
    v_mfma_f32_16x16x32_bf16 v[192:195], a[184:187], a[0:3], 0
    s_addk_i32 m0, 1280
    ds_read_b128 a[228:231], v13 offset:32768
    v_accvgpr_write_b32 a126, v94
    v_mfma_f32_16x16x32_bf16 v[192:195], a[188:191], a[16:19], v[192:195]
    s_waitcnt lgkmcnt(6)
    v_exp_f32 v182, v182
    v_mfma_f32_16x16x32_bf16 v[192:195], a[192:195], a[32:35], v[192:195]
    v_exp_f32 v183, v183
    v_mfma_f32_16x16x32_bf16 v[192:195], a[196:199], a[48:51], v[192:195]
    v_exp_f32 v188, v188
    v_mfma_f32_16x16x32_bf16 v[192:195], a[200:203], a[64:67], v[192:195]
    v_exp_f32 v189, v189
    v_mfma_f32_16x16x32_bf16 v[192:195], a[204:207], a[80:83], v[192:195]
    v_exp_f32 v190, v190
    v_mfma_f32_16x16x32_bf16 v[200:203], a[204:207], a[84:87], 0
    buffer_load_dwordx4 v5, s[12:15], s38 offen offset:0 lds
    v_mfma_f32_16x16x32_bf16 v[200:203], a[200:203], a[68:71], v[200:203]
    v_exp_f32 v191, v191
    v_mfma_f32_16x16x32_bf16 v[200:203], a[196:199], a[52:55], v[200:203]
    v_exp_f32 v40, v40
    v_mfma_f32_16x16x32_bf16 v[200:203], a[192:195], a[36:39], v[200:203]
    v_exp_f32 v41, v41
    v_mfma_f32_16x16x32_bf16 v[200:203], a[188:191], a[20:23], v[200:203]
    v_cvt_pk_bf16_f32 v181, v182, v183
    v_cvt_pk_bf16_f32 v188, v188, v189
    v_mfma_f32_16x16x32_bf16 v[200:203], a[184:187], a[4:7], v[200:203]
    v_exp_f32 v42, v42
    v_mfma_f32_16x16x32_bf16 v[208:211], a[184:187], a[8:11], 0
    s_addk_i32 m0, 896
    v_exp_f32 v43, v43
    v_mfma_f32_16x16x32_bf16 v[208:211], a[188:191], a[24:27], v[208:211]
    v_cvt_pk_bf16_f32 v189, v190, v191
    v_cvt_pk_bf16_f32 v166, v40, v41
    v_mfma_f32_16x16x32_bf16 v[208:211], a[192:195], a[40:43], v[208:211]
    v_exp_f32 v44, v44
    v_mfma_f32_16x16x32_bf16 v[208:211], a[196:199], a[56:59], v[208:211]
    v_exp_f32 v45, v45
    v_mfma_f32_16x16x32_bf16 v[208:211], a[200:203], a[72:75], v[208:211]
    v_exp_f32 v46, v46
    v_mfma_f32_16x16x32_bf16 v[208:211], a[204:207], a[88:91], v[208:211]
    v_exp_f32 v47, v47
    v_mfma_f32_16x16x32_bf16 v[216:219], a[204:207], a[92:95], 0
    buffer_load_dwordx4 v5, s[12:15], s38 offen offset:128 lds
    v_mfma_f32_16x16x32_bf16 v[216:219], a[200:203], a[76:79], v[216:219]
    ds_read_b64_tr_b16 a[232:233], v8 offset:24576
    v_cvt_pk_bf16_f32 v167, v42, v43
    v_mfma_f32_16x16x32_bf16 v[216:219], a[196:199], a[60:63], v[216:219]
    ds_read_b64_tr_b16 a[234:235], v8 offset:26624
    v_cvt_pk_bf16_f32 v174, v44, v45
    v_mfma_f32_16x16x32_bf16 v[216:219], a[192:195], a[44:47], v[216:219]
    s_waitcnt lgkmcnt(2)
    ds_read_b64_tr_b16 a[236:237], v9 offset:24576
    v_cvt_pk_bf16_f32 v175, v46, v47
    v_mfma_f32_16x16x32_bf16 v[216:219], a[188:191], a[28:31], v[216:219]
    ds_read_b64_tr_b16 a[238:239], v9 offset:26624
    v_accvgpr_write_b32 a127, v95
    v_mfma_f32_16x16x32_bf16 v[216:219], a[184:187], a[12:15], v[216:219]
    v_exp_f32 v48, v48
    v_mfma_f32_16x16x32_bf16 v[24:27], a[208:211], a[0:3], 0
    s_addk_i32 m0, 896
    v_exp_f32 v49, v49
    v_mfma_f32_16x16x32_bf16 v[24:27], a[212:215], a[16:19], v[24:27]
    v_exp_f32 v50, v50
    v_mfma_f32_16x16x32_bf16 v[24:27], a[216:219], a[32:35], v[24:27]
    ds_read_b128 a[184:187], v12 offset:36864
    v_cvt_pk_bf16_f32 v182, v48, v49
    v_mfma_f32_16x16x32_bf16 v[24:27], a[220:223], a[48:51], v[24:27]
    ds_read_b128 a[188:191], v13 offset:36864
    v_accvgpr_write_b32 a128, v96
    v_mfma_f32_16x16x32_bf16 v[24:27], a[224:227], a[64:67], v[24:27]
    ds_read_b128 a[192:195], v12 offset:37888
    v_accvgpr_write_b32 a129, v97
    v_mfma_f32_16x16x32_bf16 v[24:27], a[228:231], a[80:83], v[24:27]
    ds_read_b128 a[196:199], v13 offset:37888
    v_accvgpr_write_b32 a130, v98
    v_mfma_f32_16x16x32_bf16 v[28:31], a[228:231], a[84:87], 0
    buffer_load_dwordx4 v5, s[12:15], s38 offen offset:256 lds
    v_mfma_f32_16x16x32_bf16 v[28:31], a[224:227], a[68:71], v[28:31]
    s_add_u32 s38, s38, 24576
    v_exp_f32 v51, v51
    v_mfma_f32_16x16x32_bf16 v[28:31], a[220:223], a[52:55], v[28:31]
    ds_read_b128 a[200:203], v12 offset:38912
    v_cvt_pk_bf16_f32 v183, v50, v51
    v_mfma_f32_16x16x32_bf16 v[28:31], a[216:219], a[36:39], v[28:31]
    v_exp_f32 v52, v52
    v_mfma_f32_16x16x32_bf16 v[28:31], a[212:215], a[20:23], v[28:31]
    s_add_u32 s39, s40, 147456
    v_exp_f32 v53, v53
    v_mfma_f32_16x16x32_bf16 v[28:31], a[208:211], a[4:7], v[28:31]
    ds_read_b128 a[204:207], v13 offset:38912
    v_cvt_pk_bf16_f32 v190, v52, v53
    v_mfma_f32_16x16x32_bf16 v[32:35], a[208:211], a[8:11], 0
    s_add_u32 m0, s63, 122880
    v_exp_f32 v54, v54
    v_mfma_f32_16x16x32_bf16 v[32:35], a[212:215], a[24:27], v[32:35]
    v_exp_f32 v55, v55
    v_mfma_f32_16x16x32_bf16 v[32:35], a[216:219], a[40:43], v[32:35]
    v_exp_f32 v192, v192
    v_mfma_f32_16x16x32_bf16 v[32:35], a[220:223], a[56:59], v[32:35]
    v_exp_f32 v193, v193
    v_mfma_f32_16x16x32_bf16 v[32:35], a[224:227], a[72:75], v[32:35]
    v_exp_f32 v194, v194
    v_mfma_f32_16x16x32_bf16 v[32:35], a[228:231], a[88:91], v[32:35]
    v_exp_f32 v195, v195
    v_mfma_f32_16x16x32_bf16 v[36:39], a[228:231], a[92:95], 0
    buffer_load_dwordx4 v6, s[16:19], s39 offen lds
    v_mfma_f32_16x16x32_bf16 v[36:39], a[224:227], a[76:79], v[36:39]
    v_exp_f32 v200, v200
    v_mfma_f32_16x16x32_bf16 v[36:39], a[220:223], a[60:63], v[36:39]
    v_exp_f32 v201, v201
    v_mfma_f32_16x16x32_bf16 v[36:39], a[216:219], a[44:47], v[36:39]
    s_waitcnt lgkmcnt(0)
    v_cvt_pk_bf16_f32 v191, v54, v55
    v_cvt_pk_bf16_f32 v192, v192, v193
    v_mfma_f32_16x16x32_bf16 v[36:39], a[212:215], a[28:31], v[36:39]
    s_add_u32 s39, s40, 159744
    v_exp_f32 v202, v202
    v_mfma_f32_16x16x32_bf16 v[36:39], a[208:211], a[12:15], v[36:39]
    v_exp_f32 v203, v203
    v_mfma_f32_16x16x32_bf16 a[152:155], a[232:235], v[160:163], a[152:155]
    s_addk_i32 m0, 4096
    v_cvt_pk_bf16_f32 v193, v194, v195
    v_cvt_pk_bf16_f32 v200, v200, v201
    v_mfma_f32_16x16x32_bf16 a[168:171], a[236:239], v[160:163], a[168:171]
    v_exp_f32 v208, v208
    v_mfma_f32_16x16x32_bf16 a[172:175], a[236:239], v[168:171], a[172:175]
    ds_read_b128 a[208:211], v12 offset:43008
    v_cvt_pk_bf16_f32 v201, v202, v203
    v_mfma_f32_16x16x32_bf16 a[156:159], a[232:235], v[168:171], a[156:159]
    ds_read_b128 a[212:215], v13 offset:43008
    v_accvgpr_write_b32 a131, v99
    v_mfma_f32_16x16x32_bf16 a[160:163], a[232:235], v[176:179], a[160:163]
    ds_read_b128 a[216:219], v12 offset:44032
    v_accvgpr_write_b32 a132, v100
    v_mfma_f32_16x16x32_bf16 a[176:179], a[236:239], v[176:179], a[176:179]
    ds_read_b128 a[220:223], v13 offset:44032
    v_accvgpr_write_b32 a133, v101
    v_mfma_f32_16x16x32_bf16 a[180:183], a[236:239], v[184:187], a[180:183]
    buffer_load_dwordx4 v6, s[16:19], s39 offen lds
    v_mfma_f32_16x16x32_bf16 a[164:167], a[232:235], v[184:187], a[164:167]
    v_exp_f32 v209, v209
    v_mfma_f32_16x16x32_bf16 v[196:199], a[184:187], a[0:3], 0
    ds_read_b128 a[224:227], v12 offset:45056
    v_cvt_pk_bf16_f32 v208, v208, v209
    v_mfma_f32_16x16x32_bf16 v[196:199], a[188:191], a[16:19], v[196:199]
    v_exp_f32 v210, v210
    v_mfma_f32_16x16x32_bf16 v[196:199], a[192:195], a[32:35], v[196:199]
    v_exp_f32 v211, v211
    v_mfma_f32_16x16x32_bf16 v[196:199], a[196:199], a[48:51], v[196:199]
    ds_read_b128 a[228:231], v13 offset:45056
    v_cvt_pk_bf16_f32 v209, v210, v211
    v_mfma_f32_16x16x32_bf16 v[196:199], a[200:203], a[64:67], v[196:199]
    v_exp_f32 v216, v216
    v_mfma_f32_16x16x32_bf16 v[196:199], a[204:207], a[80:83], v[196:199]
    v_exp_f32 v217, v217
    v_mfma_f32_16x16x32_bf16 v[204:207], a[204:207], a[84:87], 0
    v_exp_f32 v218, v218
    v_mfma_f32_16x16x32_bf16 v[204:207], a[200:203], a[68:71], v[204:207]
    v_exp_f32 v219, v219
    v_mfma_f32_16x16x32_bf16 v[204:207], a[196:199], a[52:55], v[204:207]
    v_exp_f32 v24, v24
    v_mfma_f32_16x16x32_bf16 v[204:207], a[192:195], a[36:39], v[204:207]
    v_exp_f32 v25, v25
    v_mfma_f32_16x16x32_bf16 v[204:207], a[188:191], a[20:23], v[204:207]
    v_exp_f32 v26, v26
    v_mfma_f32_16x16x32_bf16 v[204:207], a[184:187], a[4:7], v[204:207]
    v_exp_f32 v27, v27
    v_mfma_f32_16x16x32_bf16 v[212:215], a[184:187], a[8:11], 0
    v_cvt_pk_bf16_f32 v216, v216, v217
    v_cvt_pk_bf16_f32 v217, v218, v219
    v_mfma_f32_16x16x32_bf16 v[212:215], a[188:191], a[24:27], v[212:215]
    v_exp_f32 v28, v28
    v_mfma_f32_16x16x32_bf16 v[212:215], a[192:195], a[40:43], v[212:215]
    v_exp_f32 v29, v29
    v_mfma_f32_16x16x32_bf16 v[212:215], a[196:199], a[56:59], v[212:215]
    v_exp_f32 v30, v30
    v_mfma_f32_16x16x32_bf16 v[212:215], a[200:203], a[72:75], v[212:215]
    v_exp_f32 v31, v31
    v_mfma_f32_16x16x32_bf16 v[212:215], a[204:207], a[88:91], v[212:215]
    v_cvt_pk_bf16_f32 v194, v24, v25
    v_cvt_pk_bf16_f32 v195, v26, v27
    v_mfma_f32_16x16x32_bf16 v[220:223], a[204:207], a[92:95], 0
    v_exp_f32 v32, v32
    v_mfma_f32_16x16x32_bf16 v[220:223], a[200:203], a[76:79], v[220:223]
    v_exp_f32 v33, v33
    v_mfma_f32_16x16x32_bf16 v[220:223], a[196:199], a[60:63], v[220:223]
    s_add_u32 m0, s49, 24576
    v_exp_f32 v34, v34
    v_mfma_f32_16x16x32_bf16 v[220:223], a[192:195], a[44:47], v[220:223]
    s_waitcnt lgkmcnt(0)
    v_exp_f32 v35, v35
    v_mfma_f32_16x16x32_bf16 v[220:223], a[188:191], a[28:31], v[220:223]
    v_cvt_pk_bf16_f32 v202, v28, v29
    v_cvt_pk_bf16_f32 v203, v30, v31
    v_mfma_f32_16x16x32_bf16 v[220:223], a[184:187], a[12:15], v[220:223]
    v_exp_f32 v36, v36
    v_mfma_f32_16x16x32_bf16 v[40:43], a[208:211], a[0:3], 0
    s_waitcnt vmcnt(11)
    v_exp_f32 v37, v37
    v_mfma_f32_16x16x32_bf16 v[40:43], a[212:215], a[16:19], v[40:43]
    s_barrier
    v_mfma_f32_16x16x32_bf16 v[40:43], a[216:219], a[32:35], v[40:43]
    buffer_load_dwordx4 v4, s[12:15], s38 offen offset:0 lds
    v_mfma_f32_16x16x32_bf16 v[40:43], a[220:223], a[48:51], v[40:43]
    ds_read_b64_tr_b16 a[240:241], v8 offset:28672
    v_cvt_pk_bf16_f32 v210, v32, v33
    v_mfma_f32_16x16x32_bf16 v[40:43], a[224:227], a[64:67], v[40:43]
    ds_read_b64_tr_b16 a[242:243], v8 offset:30720
    v_cvt_pk_bf16_f32 v211, v34, v35
    v_mfma_f32_16x16x32_bf16 v[40:43], a[228:231], a[80:83], v[40:43]
    ds_read_b64_tr_b16 a[244:245], v9 offset:28672
    v_cvt_pk_bf16_f32 v218, v36, v37
    v_mfma_f32_16x16x32_bf16 v[44:47], a[228:231], a[84:87], 0
    ds_read_b64_tr_b16 a[246:247], v9 offset:30720
    v_accvgpr_write_b32 a134, v102
    v_mfma_f32_16x16x32_bf16 v[44:47], a[224:227], a[68:71], v[44:47]
    ds_read_b128 a[184:187], v12 offset:49152
    v_accvgpr_write_b32 a135, v103
    v_mfma_f32_16x16x32_bf16 v[44:47], a[220:223], a[52:55], v[44:47]
    s_addk_i32 m0, 896
    ds_read_b128 a[188:191], v13 offset:49152
    v_accvgpr_write_b32 a136, v104
    v_mfma_f32_16x16x32_bf16 v[44:47], a[216:219], a[36:39], v[44:47]
    ds_read_b128 a[192:195], v12 offset:50176
    v_accvgpr_write_b32 a137, v105
    v_mfma_f32_16x16x32_bf16 v[44:47], a[212:215], a[20:23], v[44:47]
    v_exp_f32 v38, v38
    v_mfma_f32_16x16x32_bf16 v[44:47], a[208:211], a[4:7], v[44:47]
    v_exp_f32 v39, v39
    v_mfma_f32_16x16x32_bf16 v[48:51], a[208:211], a[8:11], 0
    buffer_load_dword a252, v22, s[32:35], s42 offen offset:0
    v_mfma_f32_16x16x32_bf16 v[48:51], a[212:215], a[24:27], v[48:51]
    ds_read_b128 a[196:199], v13 offset:50176
    v_cvt_pk_bf16_f32 v219, v38, v39
    v_mfma_f32_16x16x32_bf16 v[48:51], a[216:219], a[40:43], v[48:51]
    buffer_load_dwordx4 v4, s[12:15], s38 offen offset:128 lds
    v_mfma_f32_16x16x32_bf16 v[48:51], a[220:223], a[56:59], v[48:51]
    ds_read_b128 a[200:203], v12 offset:51200
    v_accvgpr_write_b32 a138, v106
    v_mfma_f32_16x16x32_bf16 v[48:51], a[224:227], a[72:75], v[48:51]
    v_exp_f32 v196, v196
    v_mfma_f32_16x16x32_bf16 v[48:51], a[228:231], a[88:91], v[48:51]
    v_exp_f32 v197, v197
    v_mfma_f32_16x16x32_bf16 v[52:55], a[228:231], a[92:95], 0
    ds_read_b128 a[204:207], v13 offset:51200
    v_cvt_pk_bf16_f32 v196, v196, v197
    v_mfma_f32_16x16x32_bf16 v[52:55], a[224:227], a[76:79], v[52:55]
    v_exp_f32 v198, v198
    v_mfma_f32_16x16x32_bf16 v[52:55], a[220:223], a[60:63], v[52:55]
    s_addk_i32 m0, 896
    v_exp_f32 v199, v199
    v_mfma_f32_16x16x32_bf16 v[52:55], a[216:219], a[44:47], v[52:55]
    s_waitcnt lgkmcnt(2)
    v_exp_f32 v204, v204
    v_mfma_f32_16x16x32_bf16 v[52:55], a[212:215], a[28:31], v[52:55]
    v_exp_f32 v205, v205
    v_mfma_f32_16x16x32_bf16 v[52:55], a[208:211], a[12:15], v[52:55]
    v_exp_f32 v206, v206
    v_mfma_f32_16x16x32_bf16 a[164:167], a[240:243], v[188:191], a[164:167]
    v_exp_f32 v207, v207
    v_mfma_f32_16x16x32_bf16 a[180:183], a[244:247], v[188:191], a[180:183]
    v_exp_f32 v212, v212
    v_mfma_f32_16x16x32_bf16 a[176:179], a[244:247], v[180:183], a[176:179]
    buffer_load_dwordx4 v4, s[12:15], s38 offen offset:256 lds
    v_mfma_f32_16x16x32_bf16 a[160:163], a[240:243], v[180:183], a[160:163]
    ds_read_b128 a[208:211], v12 offset:55296
    v_cvt_pk_bf16_f32 v197, v198, v199
    v_mfma_f32_16x16x32_bf16 a[156:159], a[240:243], v[172:175], a[156:159]
    ds_read_b128 a[212:215], v13 offset:55296
    v_cvt_pk_bf16_f32 v204, v204, v205
    v_mfma_f32_16x16x32_bf16 a[172:175], a[244:247], v[172:175], a[172:175]
    ds_read_b128 a[216:219], v12 offset:56320
    v_cvt_pk_bf16_f32 v205, v206, v207
    v_mfma_f32_16x16x32_bf16 a[168:171], a[244:247], v[164:167], a[168:171]
    ds_read_b128 a[220:223], v13 offset:56320
    v_accvgpr_write_b32 a139, v107
    v_mfma_f32_16x16x32_bf16 a[152:155], a[240:243], v[164:167], a[152:155]
pg_7:
    s_cbranch_execz pg_11
    ds_read_b128 a[224:227], v12 offset:57344
    v_accvgpr_write_b32 a140, v108
    v_mfma_f32_16x16x32_bf16 v[224:227], a[184:187], a[0:3], 0
    s_addk_i32 m0, 1280
    v_exp_f32 v213, v213
    v_mfma_f32_16x16x32_bf16 v[224:227], a[188:191], a[16:19], v[224:227]
    s_waitcnt lgkmcnt(5)
    ds_read_b128 a[228:231], v13 offset:57344
    v_cvt_pk_bf16_f32 v212, v212, v213
    v_mfma_f32_16x16x32_bf16 v[224:227], a[192:195], a[32:35], v[224:227]
    v_exp_f32 v214, v214
    v_mfma_f32_16x16x32_bf16 v[224:227], a[196:199], a[48:51], v[224:227]
    v_exp_f32 v215, v215
    v_mfma_f32_16x16x32_bf16 v[224:227], a[200:203], a[64:67], v[224:227]
    v_exp_f32 v220, v220
    v_mfma_f32_16x16x32_bf16 v[224:227], a[204:207], a[80:83], v[224:227]
    v_exp_f32 v221, v221
    v_mfma_f32_16x16x32_bf16 v[232:235], a[204:207], a[84:87], 0
    buffer_load_dwordx4 v5, s[12:15], s38 offen offset:0 lds
    v_mfma_f32_16x16x32_bf16 v[232:235], a[200:203], a[68:71], v[232:235]
    v_exp_f32 v222, v222
    v_mfma_f32_16x16x32_bf16 v[232:235], a[196:199], a[52:55], v[232:235]
    v_exp_f32 v223, v223
    v_mfma_f32_16x16x32_bf16 v[232:235], a[192:195], a[36:39], v[232:235]
    v_exp_f32 v40, v40
    v_mfma_f32_16x16x32_bf16 v[232:235], a[188:191], a[20:23], v[232:235]
    v_exp_f32 v41, v41
    v_mfma_f32_16x16x32_bf16 v[232:235], a[184:187], a[4:7], v[232:235]
    v_cvt_pk_bf16_f32 v213, v214, v215
    v_cvt_pk_bf16_f32 v220, v220, v221
    v_mfma_f32_16x16x32_bf16 v[240:243], a[184:187], a[8:11], 0
    s_addk_i32 m0, 896
    v_exp_f32 v42, v42
    v_mfma_f32_16x16x32_bf16 v[240:243], a[188:191], a[24:27], v[240:243]
    v_exp_f32 v43, v43
    v_mfma_f32_16x16x32_bf16 v[240:243], a[192:195], a[40:43], v[240:243]
    v_cvt_pk_bf16_f32 v221, v222, v223
    v_cvt_pk_bf16_f32 v198, v40, v41
    v_mfma_f32_16x16x32_bf16 v[240:243], a[196:199], a[56:59], v[240:243]
    v_exp_f32 v44, v44
    v_mfma_f32_16x16x32_bf16 v[240:243], a[200:203], a[72:75], v[240:243]
    v_exp_f32 v45, v45
    v_mfma_f32_16x16x32_bf16 v[240:243], a[204:207], a[88:91], v[240:243]
    v_exp_f32 v46, v46
    v_mfma_f32_16x16x32_bf16 v[248:251], a[204:207], a[92:95], 0
    buffer_load_dwordx4 v5, s[12:15], s38 offen offset:128 lds
    v_mfma_f32_16x16x32_bf16 v[248:251], a[200:203], a[76:79], v[248:251]
    ds_read_b64_tr_b16 a[232:233], v8 offset:32768
    v_cvt_pk_bf16_f32 v199, v42, v43
    v_mfma_f32_16x16x32_bf16 v[248:251], a[196:199], a[60:63], v[248:251]
    ds_read_b64_tr_b16 a[234:235], v8 offset:34816
    v_cvt_pk_bf16_f32 v206, v44, v45
    v_mfma_f32_16x16x32_bf16 v[248:251], a[192:195], a[44:47], v[248:251]
    s_waitcnt lgkmcnt(2)
    ds_read_b64_tr_b16 a[236:237], v9 offset:32768
    v_accvgpr_write_b32 a141, v109
    v_mfma_f32_16x16x32_bf16 v[248:251], a[188:191], a[28:31], v[248:251]
    ds_read_b64_tr_b16 a[238:239], v9 offset:34816
    v_accvgpr_write_b32 a142, v110
    v_mfma_f32_16x16x32_bf16 v[248:251], a[184:187], a[12:15], v[248:251]
    v_exp_f32 v47, v47
    v_mfma_f32_16x16x32_bf16 v[24:27], a[208:211], a[0:3], 0
    s_addk_i32 m0, 896
    v_exp_f32 v48, v48
    v_mfma_f32_16x16x32_bf16 v[24:27], a[212:215], a[16:19], v[24:27]
    v_exp_f32 v49, v49
    v_mfma_f32_16x16x32_bf16 v[24:27], a[216:219], a[32:35], v[24:27]
    ds_read_b128 a[184:187], v12 offset:61440
    v_cvt_pk_bf16_f32 v207, v46, v47
    v_mfma_f32_16x16x32_bf16 v[24:27], a[220:223], a[48:51], v[24:27]
    ds_read_b128 a[188:191], v13 offset:61440
    v_cvt_pk_bf16_f32 v214, v48, v49
    v_mfma_f32_16x16x32_bf16 v[24:27], a[224:227], a[64:67], v[24:27]
    ds_read_b128 a[192:195], v12 offset:62464
    v_accvgpr_write_b32 a143, v111
    v_mfma_f32_16x16x32_bf16 v[24:27], a[228:231], a[80:83], v[24:27]
    ds_read_b128 a[196:199], v13 offset:62464
    v_accvgpr_write_b32 a144, v112
    v_mfma_f32_16x16x32_bf16 v[28:31], a[228:231], a[84:87], 0
    buffer_load_dwordx4 v5, s[12:15], s38 offen offset:256 lds
    v_mfma_f32_16x16x32_bf16 v[28:31], a[224:227], a[68:71], v[28:31]
    s_add_u32 s38, s38, 24576
    v_exp_f32 v50, v50
    v_mfma_f32_16x16x32_bf16 v[28:31], a[220:223], a[52:55], v[28:31]
    v_exp_f32 v51, v51
    v_mfma_f32_16x16x32_bf16 v[28:31], a[216:219], a[36:39], v[28:31]
    ds_read_b128 a[200:203], v12 offset:63488
    v_cvt_pk_bf16_f32 v215, v50, v51
    v_mfma_f32_16x16x32_bf16 v[28:31], a[212:215], a[20:23], v[28:31]
    s_add_u32 s39, s40, 172032
    ds_read_b128 a[204:207], v13 offset:63488
    v_add_u32 v12, 67584, v12
    v_mfma_f32_16x16x32_bf16 v[28:31], a[208:211], a[4:7], v[28:31]
    v_exp_f32 v52, v52
    v_mfma_f32_16x16x32_bf16 v[32:35], a[208:211], a[8:11], 0
    s_add_u32 m0, s63, 131072
    v_exp_f32 v53, v53
    v_mfma_f32_16x16x32_bf16 v[32:35], a[212:215], a[24:27], v[32:35]
    v_exp_f32 v54, v54
    v_mfma_f32_16x16x32_bf16 v[32:35], a[216:219], a[40:43], v[32:35]
    v_exp_f32 v55, v55
    v_mfma_f32_16x16x32_bf16 v[32:35], a[220:223], a[56:59], v[32:35]
    v_cvt_pk_bf16_f32 v222, v52, v53
    v_cvt_pk_bf16_f32 v223, v54, v55
    v_mfma_f32_16x16x32_bf16 v[32:35], a[224:227], a[72:75], v[32:35]
    v_exp_f32 v224, v224
    v_mfma_f32_16x16x32_bf16 v[32:35], a[228:231], a[88:91], v[32:35]
    v_exp_f32 v225, v225
    v_mfma_f32_16x16x32_bf16 v[36:39], a[228:231], a[92:95], 0
    buffer_load_dwordx4 v6, s[16:19], s39 offen lds
    v_mfma_f32_16x16x32_bf16 v[36:39], a[224:227], a[76:79], v[36:39]
    v_exp_f32 v226, v226
    v_mfma_f32_16x16x32_bf16 v[36:39], a[220:223], a[60:63], v[36:39]
    v_exp_f32 v227, v227
    v_mfma_f32_16x16x32_bf16 v[36:39], a[216:219], a[44:47], v[36:39]
    s_waitcnt lgkmcnt(0)
    v_exp_f32 v232, v232
    v_mfma_f32_16x16x32_bf16 v[36:39], a[212:215], a[28:31], v[36:39]
    s_add_u32 s39, s40, 184320
    v_exp_f32 v233, v233
    v_mfma_f32_16x16x32_bf16 v[36:39], a[208:211], a[12:15], v[36:39]
    v_exp_f32 v234, v234
    v_mfma_f32_16x16x32_bf16 a[152:155], a[232:235], v[192:195], a[152:155]
    s_addk_i32 m0, 4096
    v_exp_f32 v235, v235
    v_mfma_f32_16x16x32_bf16 a[168:171], a[236:239], v[192:195], a[168:171]
    v_cvt_pk_bf16_f32 v224, v224, v225
    v_cvt_pk_bf16_f32 v225, v226, v227
    v_mfma_f32_16x16x32_bf16 a[172:175], a[236:239], v[200:203], a[172:175]
    ds_read_b128 a[208:211], v12 offset:0
    v_cvt_pk_bf16_f32 v232, v232, v233
    v_mfma_f32_16x16x32_bf16 a[156:159], a[232:235], v[200:203], a[156:159]
    v_exp_f32 v240, v240
    v_mfma_f32_16x16x32_bf16 a[160:163], a[232:235], v[208:211], a[160:163]
    v_exp_f32 v241, v241
    v_mfma_f32_16x16x32_bf16 a[176:179], a[236:239], v[208:211], a[176:179]
    v_exp_f32 v242, v242
    v_mfma_f32_16x16x32_bf16 a[180:183], a[236:239], v[216:219], a[180:183]
    buffer_load_dwordx4 v6, s[16:19], s39 offen lds
    v_mfma_f32_16x16x32_bf16 a[164:167], a[232:235], v[216:219], a[164:167]
    v_exp_f32 v243, v243
    v_mfma_f32_16x16x32_bf16 v[228:231], a[184:187], a[0:3], 0
    v_cvt_pk_bf16_f32 v233, v234, v235
    v_cvt_pk_bf16_f32 v240, v240, v241
    v_mfma_f32_16x16x32_bf16 v[228:231], a[188:191], a[16:19], v[228:231]
    v_exp_f32 v248, v248
    v_mfma_f32_16x16x32_bf16 v[228:231], a[192:195], a[32:35], v[228:231]
    v_exp_f32 v249, v249
    v_mfma_f32_16x16x32_bf16 v[228:231], a[196:199], a[48:51], v[228:231]
    v_exp_f32 v250, v250
    v_mfma_f32_16x16x32_bf16 v[228:231], a[200:203], a[64:67], v[228:231]
    v_exp_f32 v251, v251
    v_mfma_f32_16x16x32_bf16 v[228:231], a[204:207], a[80:83], v[228:231]
    v_cvt_pk_bf16_f32 v241, v242, v243
    v_cvt_pk_bf16_f32 v248, v248, v249
    v_mfma_f32_16x16x32_bf16 v[236:239], a[204:207], a[84:87], 0
    v_exp_f32 v24, v24
    v_mfma_f32_16x16x32_bf16 v[236:239], a[200:203], a[68:71], v[236:239]
    v_exp_f32 v25, v25
    v_mfma_f32_16x16x32_bf16 v[236:239], a[196:199], a[52:55], v[236:239]
    v_exp_f32 v26, v26
    v_mfma_f32_16x16x32_bf16 v[236:239], a[192:195], a[36:39], v[236:239]
    v_exp_f32 v27, v27
    v_mfma_f32_16x16x32_bf16 v[236:239], a[188:191], a[20:23], v[236:239]
    v_cvt_pk_bf16_f32 v249, v250, v251
    v_cvt_pk_bf16_f32 v226, v24, v25
    v_mfma_f32_16x16x32_bf16 v[236:239], a[184:187], a[4:7], v[236:239]
    v_exp_f32 v28, v28
    v_mfma_f32_16x16x32_bf16 v[244:247], a[184:187], a[8:11], 0
    v_exp_f32 v29, v29
    v_mfma_f32_16x16x32_bf16 v[244:247], a[188:191], a[24:27], v[244:247]
    v_exp_f32 v30, v30
    v_add_u32 v13, 67584, v13
    v_mfma_f32_16x16x32_bf16 v[244:247], a[192:195], a[40:43], v[244:247]
    ds_read_b128 a[212:215], v13 offset:0
    v_cvt_pk_bf16_f32 v227, v26, v27
    v_mfma_f32_16x16x32_bf16 v[244:247], a[196:199], a[56:59], v[244:247]
    ds_read_b128 a[216:219], v12 offset:1024
    v_cvt_pk_bf16_f32 v234, v28, v29
    v_mfma_f32_16x16x32_bf16 v[244:247], a[200:203], a[72:75], v[244:247]
    ds_read_b128 a[220:223], v13 offset:1024
    v_accvgpr_write_b32 a145, v113
    v_mfma_f32_16x16x32_bf16 v[244:247], a[204:207], a[88:91], v[244:247]
    ds_read_b128 a[224:227], v12 offset:2048
    v_accvgpr_write_b32 a146, v114
    v_mfma_f32_16x16x32_bf16 v[252:255], a[204:207], a[92:95], 0
    s_add_u32 s39, s40, 128
    ds_read_b128 a[228:231], v13 offset:2048
    v_accvgpr_write_b32 a147, v115
    v_mfma_f32_16x16x32_bf16 v[252:255], a[200:203], a[76:79], v[252:255]
    v_exp_f32 v31, v31
    v_mfma_f32_16x16x32_bf16 v[252:255], a[196:199], a[60:63], v[252:255]
    s_add_u32 m0, s63, 49152
    v_exp_f32 v32, v32
    v_mfma_f32_16x16x32_bf16 v[252:255], a[192:195], a[44:47], v[252:255]
    s_waitcnt lgkmcnt(4)
    v_exp_f32 v33, v33
    v_mfma_f32_16x16x32_bf16 v[252:255], a[188:191], a[28:31], v[252:255]
    v_exp_f32 v34, v34
    v_mfma_f32_16x16x32_bf16 v[252:255], a[184:187], a[12:15], v[252:255]
    s_waitcnt lgkmcnt(2)
    v_exp_f32 v35, v35
    v_mfma_f32_16x16x32_bf16 v[40:43], a[208:211], a[0:3], 0
    s_waitcnt vmcnt(11) lgkmcnt(0)
    v_cvt_pk_bf16_f32 v235, v30, v31
    v_cvt_pk_bf16_f32 v242, v32, v33
    v_mfma_f32_16x16x32_bf16 v[40:43], a[212:215], a[16:19], v[40:43]
    s_barrier
    v_mfma_f32_16x16x32_bf16 v[40:43], a[216:219], a[32:35], v[40:43]
    buffer_load_dwordx4 v6, s[16:19], s39 offen lds
    v_mfma_f32_16x16x32_bf16 v[40:43], a[220:223], a[48:51], v[40:43]
    ds_read_b64_tr_b16 a[240:241], v8 offset:36864
    v_cvt_pk_bf16_f32 v243, v34, v35
    v_mfma_f32_16x16x32_bf16 v[40:43], a[224:227], a[64:67], v[40:43]
    ds_read_b64_tr_b16 a[242:243], v8 offset:38912
    v_subrev_u32 v12, 67584, v12
    v_mfma_f32_16x16x32_bf16 v[40:43], a[228:231], a[80:83], v[40:43]
    ds_read_b64_tr_b16 a[244:245], v9 offset:36864
    v_accvgpr_write_b32 a148, v116
    v_mfma_f32_16x16x32_bf16 v[44:47], a[228:231], a[84:87], 0
    s_add_u32 s39, s40, 12416
    ds_read_b64_tr_b16 a[246:247], v9 offset:38912
    v_subrev_u32 v13, 67584, v13
    v_mfma_f32_16x16x32_bf16 v[44:47], a[224:227], a[68:71], v[44:47]
    ds_read_b128 a[184:187], v12 offset:0
    v_accvgpr_write_b32 a149, v117
    v_mfma_f32_16x16x32_bf16 v[44:47], a[220:223], a[52:55], v[44:47]
    s_addk_i32 m0, 4096
    ds_read_b128 a[188:191], v13 offset:0
    v_accvgpr_write_b32 a150, v118
    v_mfma_f32_16x16x32_bf16 v[44:47], a[216:219], a[36:39], v[44:47]
    ds_read_b128 a[192:195], v12 offset:1024
    v_accvgpr_write_b32 a151, v119
    v_mfma_f32_16x16x32_bf16 v[44:47], a[212:215], a[20:23], v[44:47]
    v_exp_f32 v36, v36
    v_mfma_f32_16x16x32_bf16 v[44:47], a[208:211], a[4:7], v[44:47]
    v_exp_f32 v37, v37
    v_mfma_f32_16x16x32_bf16 v[48:51], a[208:211], a[8:11], 0
    s_lshl_b32 s42, s54, 4
    ds_read_b128 a[196:199], v13 offset:1024
    v_cvt_pk_bf16_f32 v250, v36, v37
    v_mfma_f32_16x16x32_bf16 v[48:51], a[212:215], a[24:27], v[48:51]
    s_mul_i32 s42, s42, 384
    ds_read_b128 a[200:203], v12 offset:2048
    v_and_b32 v22, 15, v1
    v_mfma_f32_16x16x32_bf16 v[48:51], a[216:219], a[40:43], v[48:51]
    buffer_load_dwordx4 v6, s[16:19], s39 offen lds
    v_mfma_f32_16x16x32_bf16 v[48:51], a[220:223], a[56:59], v[48:51]
    ds_read_b128 a[204:207], v13 offset:2048
    v_mul_u32_u24 v22, 384, v22
    v_mfma_f32_16x16x32_bf16 v[48:51], a[224:227], a[72:75], v[48:51]
    buffer_load_dword a252, v22, s[16:19], s42 offen offset:256
    v_mfma_f32_16x16x32_bf16 v[48:51], a[228:231], a[88:91], v[48:51]
    v_exp_f32 v38, v38
    v_mfma_f32_16x16x32_bf16 v[52:55], a[228:231], a[92:95], 0
    s_add_u32 s39, s40, 24704
    v_exp_f32 v39, v39
    v_mfma_f32_16x16x32_bf16 v[52:55], a[224:227], a[76:79], v[52:55]
    v_exp_f32 v228, v228
    v_mfma_f32_16x16x32_bf16 v[52:55], a[220:223], a[60:63], v[52:55]
    s_addk_i32 m0, 4096
    v_exp_f32 v229, v229
    v_mfma_f32_16x16x32_bf16 v[52:55], a[216:219], a[44:47], v[52:55]
    s_waitcnt lgkmcnt(1)
    v_exp_f32 v230, v230
    v_mfma_f32_16x16x32_bf16 v[52:55], a[212:215], a[28:31], v[52:55]
    v_exp_f32 v231, v231
    v_mfma_f32_16x16x32_bf16 v[52:55], a[208:211], a[12:15], v[52:55]
    v_exp_f32 v236, v236
    v_mfma_f32_16x16x32_bf16 a[164:167], a[240:243], v[220:223], a[164:167]
    v_exp_f32 v237, v237
    v_mfma_f32_16x16x32_bf16 a[180:183], a[244:247], v[220:223], a[180:183]
    v_exp_f32 v238, v238
    v_mfma_f32_16x16x32_bf16 a[176:179], a[244:247], v[212:215], a[176:179]
    buffer_load_dwordx4 v6, s[16:19], s39 offen lds
    v_mfma_f32_16x16x32_bf16 a[160:163], a[240:243], v[212:215], a[160:163]
    ds_read_b128 a[208:211], v12 offset:6144
    v_cvt_pk_bf16_f32 v251, v38, v39
    v_mfma_f32_16x16x32_bf16 a[156:159], a[240:243], v[204:207], a[156:159]
    ds_read_b128 a[212:215], v13 offset:6144
    v_cvt_pk_bf16_f32 v228, v228, v229
    v_mfma_f32_16x16x32_bf16 a[172:175], a[244:247], v[204:207], a[172:175]
    ds_read_b128 a[216:219], v12 offset:7168
    v_cvt_pk_bf16_f32 v229, v230, v231
    v_mfma_f32_16x16x32_bf16 a[168:171], a[244:247], v[196:199], a[168:171]
    s_add_u32 s39, s40, 36992
    ds_read_b128 a[220:223], v13 offset:7168
    v_cvt_pk_bf16_f32 v236, v236, v237
    v_mfma_f32_16x16x32_bf16 a[152:155], a[240:243], v[196:199], a[152:155]
    v_exp_f32 v239, v239
    v_mfma_f32_16x16x32_bf16 v[56:59], a[184:187], a[0:3], 0
    s_addk_i32 m0, 4096
    ds_read_b128 a[224:227], v12 offset:8192
    v_cvt_pk_bf16_f32 v237, v238, v239
    v_mfma_f32_16x16x32_bf16 v[56:59], a[188:191], a[16:19], v[56:59]
    v_exp_f32 v244, v244
    v_mfma_f32_16x16x32_bf16 v[56:59], a[192:195], a[32:35], v[56:59]
    s_waitcnt lgkmcnt(4)
    v_exp_f32 v245, v245
    v_mfma_f32_16x16x32_bf16 v[56:59], a[196:199], a[48:51], v[56:59]
    ds_read_b128 a[228:231], v13 offset:8192
    v_cvt_pk_bf16_f32 v244, v244, v245
    v_mfma_f32_16x16x32_bf16 v[56:59], a[200:203], a[64:67], v[56:59]
    v_exp_f32 v246, v246
    v_mfma_f32_16x16x32_bf16 v[56:59], a[204:207], a[80:83], v[56:59]
    v_exp_f32 v247, v247
    v_mfma_f32_16x16x32_bf16 v[64:67], a[204:207], a[84:87], 0
    buffer_load_dwordx4 v6, s[16:19], s39 offen lds
    v_mfma_f32_16x16x32_bf16 v[64:67], a[200:203], a[68:71], v[64:67]
    v_exp_f32 v252, v252
    v_mfma_f32_16x16x32_bf16 v[64:67], a[196:199], a[52:55], v[64:67]
    v_exp_f32 v253, v253
    v_mfma_f32_16x16x32_bf16 v[64:67], a[192:195], a[36:39], v[64:67]
    v_exp_f32 v254, v254
    v_mfma_f32_16x16x32_bf16 v[64:67], a[188:191], a[20:23], v[64:67]
    v_exp_f32 v255, v255
    v_mfma_f32_16x16x32_bf16 v[64:67], a[184:187], a[4:7], v[64:67]
    v_exp_f32 v40, v40
    v_mfma_f32_16x16x32_bf16 v[72:75], a[184:187], a[8:11], 0
    v_exp_f32 v41, v41
    v_mfma_f32_16x16x32_bf16 v[72:75], a[188:191], a[24:27], v[72:75]
    v_exp_f32 v42, v42
    v_mfma_f32_16x16x32_bf16 v[72:75], a[192:195], a[40:43], v[72:75]
    v_exp_f32 v43, v43
    v_mfma_f32_16x16x32_bf16 v[72:75], a[196:199], a[56:59], v[72:75]
    v_cvt_pk_bf16_f32 v245, v246, v247
    v_cvt_pk_bf16_f32 v252, v252, v253
    v_mfma_f32_16x16x32_bf16 v[72:75], a[200:203], a[72:75], v[72:75]
    v_exp_f32 v44, v44
    v_mfma_f32_16x16x32_bf16 v[72:75], a[204:207], a[88:91], v[72:75]
    v_exp_f32 v45, v45
    v_mfma_f32_16x16x32_bf16 v[80:83], a[204:207], a[92:95], 0
    ds_read_b64_tr_b16 a[232:233], v8 offset:40960
    v_cvt_pk_bf16_f32 v253, v254, v255
    v_mfma_f32_16x16x32_bf16 v[80:83], a[200:203], a[76:79], v[80:83]
    ds_read_b64_tr_b16 a[234:235], v8 offset:43008
    v_cvt_pk_bf16_f32 v230, v40, v41
    v_mfma_f32_16x16x32_bf16 v[80:83], a[196:199], a[60:63], v[80:83]
    ds_read_b64_tr_b16 a[236:237], v9 offset:40960
    v_cvt_pk_bf16_f32 v231, v42, v43
    v_mfma_f32_16x16x32_bf16 v[80:83], a[192:195], a[44:47], v[80:83]
    ds_read_b64_tr_b16 a[238:239], v9 offset:43008
    v_cvt_pk_bf16_f32 v238, v44, v45
    v_mfma_f32_16x16x32_bf16 v[80:83], a[188:191], a[28:31], v[80:83]
    s_waitcnt lgkmcnt(4)
    v_exp_f32 v46, v46
    v_mfma_f32_16x16x32_bf16 v[80:83], a[184:187], a[12:15], v[80:83]
    v_exp_f32 v47, v47
    v_mfma_f32_16x16x32_bf16 v[24:27], a[208:211], a[0:3], 0
    v_exp_f32 v48, v48
    v_mfma_f32_16x16x32_bf16 v[24:27], a[212:215], a[16:19], v[24:27]
    v_exp_f32 v49, v49
    v_mfma_f32_16x16x32_bf16 v[24:27], a[216:219], a[32:35], v[24:27]
    ds_read_b128 a[184:187], v12 offset:12288
    v_cvt_pk_bf16_f32 v239, v46, v47
    v_mfma_f32_16x16x32_bf16 v[24:27], a[220:223], a[48:51], v[24:27]
    ds_read_b128 a[188:191], v13 offset:12288
    v_cvt_pk_bf16_f32 v246, v48, v49
    v_mfma_f32_16x16x32_bf16 v[24:27], a[224:227], a[64:67], v[24:27]
    v_exp_f32 v50, v50
    v_mfma_f32_16x16x32_bf16 v[24:27], a[228:231], a[80:83], v[24:27]
    v_exp_f32 v51, v51
    v_mfma_f32_16x16x32_bf16 v[28:31], a[228:231], a[84:87], 0
    ds_read_b128 a[192:195], v12 offset:13312
    v_cvt_pk_bf16_f32 v247, v50, v51
    v_mfma_f32_16x16x32_bf16 v[28:31], a[224:227], a[68:71], v[28:31]
    v_exp_f32 v52, v52
    v_mfma_f32_16x16x32_bf16 v[28:31], a[220:223], a[52:55], v[28:31]
    v_exp_f32 v53, v53
    v_mfma_f32_16x16x32_bf16 v[28:31], a[216:219], a[36:39], v[28:31]
    ds_read_b128 a[196:199], v13 offset:13312
    v_cvt_pk_bf16_f32 v254, v52, v53
    v_mfma_f32_16x16x32_bf16 v[28:31], a[212:215], a[20:23], v[28:31]
    v_exp_f32 v54, v54
    v_mfma_f32_16x16x32_bf16 v[28:31], a[208:211], a[4:7], v[28:31]
    v_exp_f32 v55, v55
    v_mfma_f32_16x16x32_bf16 v[32:35], a[208:211], a[8:11], 0
    ds_read_b128 a[200:203], v12 offset:14336
    v_cvt_pk_bf16_f32 v255, v54, v55
    v_mfma_f32_16x16x32_bf16 v[32:35], a[212:215], a[24:27], v[32:35]
    v_exp_f32 v56, v56
    v_mfma_f32_16x16x32_bf16 v[32:35], a[216:219], a[40:43], v[32:35]
    v_exp_f32 v57, v57
    v_mfma_f32_16x16x32_bf16 v[32:35], a[220:223], a[56:59], v[32:35]
    ds_read_b128 a[204:207], v13 offset:14336
    v_cvt_pk_bf16_f32 v56, v56, v57
    v_mfma_f32_16x16x32_bf16 v[32:35], a[224:227], a[72:75], v[32:35]
    v_exp_f32 v58, v58
    v_mfma_f32_16x16x32_bf16 v[32:35], a[228:231], a[88:91], v[32:35]
    v_exp_f32 v59, v59
    v_mfma_f32_16x16x32_bf16 v[36:39], a[228:231], a[92:95], 0
    v_exp_f32 v64, v64
    v_mfma_f32_16x16x32_bf16 v[36:39], a[224:227], a[76:79], v[36:39]
    v_exp_f32 v65, v65
    v_mfma_f32_16x16x32_bf16 v[36:39], a[220:223], a[60:63], v[36:39]
    v_exp_f32 v66, v66
    v_mfma_f32_16x16x32_bf16 v[36:39], a[216:219], a[44:47], v[36:39]
    s_waitcnt lgkmcnt(1)
    v_exp_f32 v67, v67
    v_mfma_f32_16x16x32_bf16 v[36:39], a[212:215], a[28:31], v[36:39]
    v_exp_f32 v72, v72
    v_mfma_f32_16x16x32_bf16 v[36:39], a[208:211], a[12:15], v[36:39]
    v_exp_f32 v73, v73
    v_mfma_f32_16x16x32_bf16 a[152:155], a[232:235], v[224:227], a[152:155]
    v_exp_f32 v74, v74
    v_mfma_f32_16x16x32_bf16 a[168:171], a[236:239], v[224:227], a[168:171]
    v_exp_f32 v75, v75
    v_mfma_f32_16x16x32_bf16 a[172:175], a[236:239], v[232:235], a[172:175]
    ds_read_b128 a[208:211], v12 offset:18432
    v_cvt_pk_bf16_f32 v57, v58, v59
    v_mfma_f32_16x16x32_bf16 a[156:159], a[232:235], v[232:235], a[156:159]
    ds_read_b128 a[212:215], v13 offset:18432
    v_cvt_pk_bf16_f32 v64, v64, v65
    v_mfma_f32_16x16x32_bf16 a[160:163], a[232:235], v[240:243], a[160:163]
    ds_read_b128 a[216:219], v12 offset:19456
    v_cvt_pk_bf16_f32 v65, v66, v67
    v_mfma_f32_16x16x32_bf16 a[176:179], a[236:239], v[240:243], a[176:179]
    ds_read_b128 a[220:223], v13 offset:19456
    v_cvt_pk_bf16_f32 v72, v72, v73
    v_mfma_f32_16x16x32_bf16 a[180:183], a[236:239], v[248:251], a[180:183]
    ds_read_b128 a[224:227], v12 offset:20480
    v_cvt_pk_bf16_f32 v73, v74, v75
    v_mfma_f32_16x16x32_bf16 a[164:167], a[232:235], v[248:251], a[164:167]
    v_exp_f32 v80, v80
    v_mfma_f32_16x16x32_bf16 v[60:63], a[184:187], a[0:3], 0
    v_exp_f32 v81, v81
    v_mfma_f32_16x16x32_bf16 v[60:63], a[188:191], a[16:19], v[60:63]
    ds_read_b128 a[228:231], v13 offset:20480
    v_cvt_pk_bf16_f32 v80, v80, v81
    v_mfma_f32_16x16x32_bf16 v[60:63], a[192:195], a[32:35], v[60:63]
    s_waitcnt lgkmcnt(4)
    v_exp_f32 v82, v82
    v_mfma_f32_16x16x32_bf16 v[60:63], a[196:199], a[48:51], v[60:63]
    v_exp_f32 v83, v83
    v_mfma_f32_16x16x32_bf16 v[60:63], a[200:203], a[64:67], v[60:63]
    v_exp_f32 v24, v24
    v_mfma_f32_16x16x32_bf16 v[60:63], a[204:207], a[80:83], v[60:63]
    v_exp_f32 v25, v25
    v_mfma_f32_16x16x32_bf16 v[68:71], a[204:207], a[84:87], 0
    v_exp_f32 v26, v26
    v_mfma_f32_16x16x32_bf16 v[68:71], a[200:203], a[68:71], v[68:71]
    v_exp_f32 v27, v27
    v_mfma_f32_16x16x32_bf16 v[68:71], a[196:199], a[52:55], v[68:71]
    v_exp_f32 v28, v28
    v_mfma_f32_16x16x32_bf16 v[68:71], a[192:195], a[36:39], v[68:71]
    v_exp_f32 v29, v29
    v_mfma_f32_16x16x32_bf16 v[68:71], a[188:191], a[20:23], v[68:71]
    v_cvt_pk_bf16_f32 v81, v82, v83
    v_cvt_pk_bf16_f32 v58, v24, v25
    v_mfma_f32_16x16x32_bf16 v[68:71], a[184:187], a[4:7], v[68:71]
    v_exp_f32 v30, v30
    v_mfma_f32_16x16x32_bf16 v[76:79], a[184:187], a[8:11], 0
    v_exp_f32 v31, v31
    v_mfma_f32_16x16x32_bf16 v[76:79], a[188:191], a[24:27], v[76:79]
    v_exp_f32 v32, v32
    v_mfma_f32_16x16x32_bf16 v[76:79], a[192:195], a[40:43], v[76:79]
    v_exp_f32 v33, v33
    v_mfma_f32_16x16x32_bf16 v[76:79], a[196:199], a[56:59], v[76:79]
    v_cvt_pk_bf16_f32 v59, v26, v27
    v_cvt_pk_bf16_f32 v66, v28, v29
    v_mfma_f32_16x16x32_bf16 v[76:79], a[200:203], a[72:75], v[76:79]
    v_exp_f32 v34, v34
    v_mfma_f32_16x16x32_bf16 v[76:79], a[204:207], a[88:91], v[76:79]
    v_exp_f32 v35, v35
    v_mfma_f32_16x16x32_bf16 v[84:87], a[204:207], a[92:95], 0
    s_add_u32 s39, s40, 49280
    v_exp_f32 v36, v36
    v_mfma_f32_16x16x32_bf16 v[84:87], a[200:203], a[76:79], v[84:87]
    v_exp_f32 v37, v37
    v_mfma_f32_16x16x32_bf16 v[84:87], a[196:199], a[60:63], v[84:87]
    s_add_u32 m0, s63, 0
    v_cvt_pk_bf16_f32 v67, v30, v31
    v_cvt_pk_bf16_f32 v74, v32, v33
    v_mfma_f32_16x16x32_bf16 v[84:87], a[192:195], a[44:47], v[84:87]
    v_exp_f32 v38, v38
    v_mfma_f32_16x16x32_bf16 v[84:87], a[188:191], a[28:31], v[84:87]
    v_exp_f32 v39, v39
    v_mfma_f32_16x16x32_bf16 v[84:87], a[184:187], a[12:15], v[84:87]
    s_waitcnt lgkmcnt(0)
    v_exp_f32 v60, v60
    v_mfma_f32_16x16x32_bf16 v[40:43], a[208:211], a[0:3], 0
    s_waitcnt vmcnt(7)
    v_exp_f32 v61, v61
    v_mfma_f32_16x16x32_bf16 v[40:43], a[212:215], a[16:19], v[40:43]
    s_barrier
    v_mfma_f32_16x16x32_bf16 v[40:43], a[216:219], a[32:35], v[40:43]
    buffer_load_dwordx4 v6, s[16:19], s39 offen lds
    v_mfma_f32_16x16x32_bf16 v[40:43], a[220:223], a[48:51], v[40:43]
    ds_read_b64_tr_b16 a[240:241], v8 offset:45056
    v_cvt_pk_bf16_f32 v75, v34, v35
    v_mfma_f32_16x16x32_bf16 v[40:43], a[224:227], a[64:67], v[40:43]
    ds_read_b64_tr_b16 a[242:243], v8 offset:47104
    v_cvt_pk_bf16_f32 v82, v36, v37
    v_mfma_f32_16x16x32_bf16 v[40:43], a[228:231], a[80:83], v[40:43]
    ds_read_b64_tr_b16 a[244:245], v9 offset:45056
    v_cvt_pk_bf16_f32 v83, v38, v39
    v_mfma_f32_16x16x32_bf16 v[44:47], a[228:231], a[84:87], 0
    s_add_u32 s39, s40, 61568
    ds_read_b64_tr_b16 a[246:247], v9 offset:47104
    v_cvt_pk_bf16_f32 v60, v60, v61
    v_mfma_f32_16x16x32_bf16 v[44:47], a[224:227], a[68:71], v[44:47]
    v_exp_f32 v62, v62
    v_mfma_f32_16x16x32_bf16 v[44:47], a[220:223], a[52:55], v[44:47]
    s_addk_i32 m0, 4096
    v_exp_f32 v63, v63
    v_mfma_f32_16x16x32_bf16 v[44:47], a[216:219], a[36:39], v[44:47]
    ds_read_b128 a[184:187], v12 offset:24576
    v_cvt_pk_bf16_f32 v61, v62, v63
    v_mfma_f32_16x16x32_bf16 v[44:47], a[212:215], a[20:23], v[44:47]
    v_exp_f32 v68, v68
    v_mfma_f32_16x16x32_bf16 v[44:47], a[208:211], a[4:7], v[44:47]
    v_exp_f32 v69, v69
    v_mfma_f32_16x16x32_bf16 v[48:51], a[208:211], a[8:11], 0
    s_mov_b32 s28, s82
    ds_read_b128 a[188:191], v13 offset:24576
    v_cvt_pk_bf16_f32 v68, v68, v69
    v_mfma_f32_16x16x32_bf16 v[48:51], a[212:215], a[24:27], v[48:51]
    s_and_b32 s29, s83, 0xffff
    ds_read_b128 a[192:195], v12 offset:25600
    v_and_b32 v22, 15, v1
    v_mfma_f32_16x16x32_bf16 v[48:51], a[216:219], a[40:43], v[48:51]
    buffer_load_dwordx4 v6, s[16:19], s39 offen lds
    v_mfma_f32_16x16x32_bf16 v[48:51], a[220:223], a[56:59], v[48:51]
    s_mov_b32 s30, 1966080
    ds_read_b128 a[196:199], v13 offset:25600
    v_mul_u32_u24 v22, 1280, v22
    v_mfma_f32_16x16x32_bf16 v[48:51], a[224:227], a[72:75], v[48:51]
    s_mov_b32 s31, 0x00020000
    v_exp_f32 v70, v70
    v_mfma_f32_16x16x32_bf16 v[48:51], a[228:231], a[88:91], v[48:51]
    s_mul_hi_u32 s48, s58, 429496730
    v_exp_f32 v71, v71
    v_mfma_f32_16x16x32_bf16 v[52:55], a[228:231], a[92:95], 0
    s_add_u32 s39, s40, 73856
    ds_read_b128 a[200:203], v12 offset:26624
    v_cvt_pk_bf16_f32 v69, v70, v71
    v_mfma_f32_16x16x32_bf16 v[52:55], a[224:227], a[76:79], v[52:55]
    s_mul_i32 s42, s48, 80640
    v_exp_f32 v76, v76
    v_mfma_f32_16x16x32_bf16 v[52:55], a[220:223], a[60:63], v[52:55]
    s_addk_i32 m0, 4096
    v_exp_f32 v77, v77
    v_mfma_f32_16x16x32_bf16 v[52:55], a[216:219], a[44:47], v[52:55]
    s_waitcnt lgkmcnt(2)
    ds_read_b128 a[204:207], v13 offset:26624
    v_cvt_pk_bf16_f32 v76, v76, v77
    v_mfma_f32_16x16x32_bf16 v[52:55], a[212:215], a[28:31], v[52:55]
    s_lshl_b32 s56, s58, 7
    v_exp_f32 v78, v78
    v_mfma_f32_16x16x32_bf16 v[52:55], a[208:211], a[12:15], v[52:55]
    s_add_u32 s42, s42, s56
    v_exp_f32 v79, v79
    v_mfma_f32_16x16x32_bf16 a[164:167], a[240:243], v[252:255], a[164:167]
    s_mul_i32 s56, s3, 20480
    v_exp_f32 v84, v84
    v_mfma_f32_16x16x32_bf16 a[180:183], a[244:247], v[252:255], a[180:183]
    s_add_u32 s42, s42, s56
    v_exp_f32 v85, v85
    v_mfma_f32_16x16x32_bf16 a[176:179], a[244:247], v[244:247], a[176:179]
    buffer_load_dword a252, v22, s[28:31], s42 offen
    v_mfma_f32_16x16x32_bf16 a[160:163], a[240:243], v[244:247], a[160:163]
    buffer_load_dwordx4 v6, s[16:19], s39 offen lds
    v_mfma_f32_16x16x32_bf16 a[156:159], a[240:243], v[236:239], a[156:159]
    s_add_u32 s56, s7, 1
    ds_read_b128 a[208:211], v12 offset:30720
    v_cvt_pk_bf16_f32 v77, v78, v79
    v_mfma_f32_16x16x32_bf16 a[172:175], a[244:247], v[236:239], a[172:175]
    ds_read_b128 a[212:215], v13 offset:30720
    v_cvt_pk_bf16_f32 v84, v84, v85
    v_mfma_f32_16x16x32_bf16 a[168:171], a[244:247], v[228:231], a[168:171]
    s_add_u32 s39, s40, 86144
    ds_read_b128 a[216:219], v12 offset:31744
    v_mov_b32 v4, s56
    v_mfma_f32_16x16x32_bf16 a[152:155], a[240:243], v[228:231], a[152:155]
    s_add_u32 s56, s7, 2
    v_exp_f32 v86, v86
    v_mfma_f32_16x16x32_bf16 v[88:91], a[184:187], a[0:3], 0
    s_waitcnt lgkmcnt(3)
    v_exp_f32 v87, v87
    v_mfma_f32_16x16x32_bf16 v[88:91], a[188:191], a[16:19], v[88:91]
    s_addk_i32 m0, 4096
    ds_read_b128 a[220:223], v13 offset:31744
    v_cvt_pk_bf16_f32 v85, v86, v87
    v_mfma_f32_16x16x32_bf16 v[88:91], a[192:195], a[32:35], v[88:91]
    v_exp_f32 v40, v40
    v_mfma_f32_16x16x32_bf16 v[88:91], a[196:199], a[48:51], v[88:91]
    v_exp_f32 v41, v41
    v_mfma_f32_16x16x32_bf16 v[88:91], a[200:203], a[64:67], v[88:91]
    ds_read_b128 a[224:227], v12 offset:32768
    v_cvt_pk_bf16_f32 v62, v40, v41
    v_mfma_f32_16x16x32_bf16 v[88:91], a[204:207], a[80:83], v[88:91]
    v_exp_f32 v42, v42
    v_mfma_f32_16x16x32_bf16 v[96:99], a[204:207], a[84:87], 0
    buffer_load_dwordx4 v6, s[16:19], s39 offen lds
    v_mfma_f32_16x16x32_bf16 v[96:99], a[200:203], a[68:71], v[96:99]
    v_exp_f32 v43, v43
    v_mfma_f32_16x16x32_bf16 v[96:99], a[196:199], a[52:55], v[96:99]
    ds_read_b128 a[228:231], v13 offset:32768
    v_cvt_pk_bf16_f32 v63, v42, v43
    v_mfma_f32_16x16x32_bf16 v[96:99], a[192:195], a[36:39], v[96:99]
pg_8:
    s_cbranch_execz pg_12
    v_exp_f32 v44, v44
    v_mfma_f32_16x16x32_bf16 v[96:99], a[188:191], a[20:23], v[96:99]
    s_add_u32 s39, s40, 98432
    v_exp_f32 v45, v45
    v_mfma_f32_16x16x32_bf16 v[96:99], a[184:187], a[4:7], v[96:99]
    v_exp_f32 v46, v46
    v_mfma_f32_16x16x32_bf16 v[104:107], a[184:187], a[8:11], 0
    s_addk_i32 m0, 4096
    v_exp_f32 v47, v47
    v_mfma_f32_16x16x32_bf16 v[104:107], a[188:191], a[24:27], v[104:107]
    v_exp_f32 v48, v48
    v_mfma_f32_16x16x32_bf16 v[104:107], a[192:195], a[40:43], v[104:107]
    v_exp_f32 v49, v49
    v_mfma_f32_16x16x32_bf16 v[104:107], a[196:199], a[56:59], v[104:107]
    v_exp_f32 v50, v50
    v_mfma_f32_16x16x32_bf16 v[104:107], a[200:203], a[72:75], v[104:107]
    v_exp_f32 v51, v51
    v_mfma_f32_16x16x32_bf16 v[104:107], a[204:207], a[88:91], v[104:107]
    v_cvt_pk_bf16_f32 v70, v44, v45
    v_cvt_pk_bf16_f32 v71, v46, v47
    v_mfma_f32_16x16x32_bf16 v[112:115], a[204:207], a[92:95], 0
    buffer_load_dwordx4 v6, s[16:19], s39 offen lds
    v_mfma_f32_16x16x32_bf16 v[112:115], a[200:203], a[76:79], v[112:115]
    ds_read_b64_tr_b16 a[232:233], v8 offset:49152
    v_cvt_pk_bf16_f32 v78, v48, v49
    v_mfma_f32_16x16x32_bf16 v[112:115], a[196:199], a[60:63], v[112:115]
    ds_read_b64_tr_b16 a[234:235], v8 offset:51200
    v_cvt_pk_bf16_f32 v79, v50, v51
    v_mfma_f32_16x16x32_bf16 v[112:115], a[192:195], a[44:47], v[112:115]
    s_waitcnt lgkmcnt(2)
    v_exp_f32 v52, v52
    v_mfma_f32_16x16x32_bf16 v[112:115], a[188:191], a[28:31], v[112:115]
    s_add_u32 s39, s40, 110720
    v_exp_f32 v53, v53
    v_mfma_f32_16x16x32_bf16 v[112:115], a[184:187], a[12:15], v[112:115]
    ds_read_b64_tr_b16 a[236:237], v9 offset:49152
    v_cvt_pk_bf16_f32 v86, v52, v53
    v_mfma_f32_16x16x32_bf16 v[24:27], a[208:211], a[0:3], 0
    s_addk_i32 m0, 4096
    v_exp_f32 v54, v54
    v_mfma_f32_16x16x32_bf16 v[24:27], a[212:215], a[16:19], v[24:27]
    v_exp_f32 v55, v55
    v_mfma_f32_16x16x32_bf16 v[24:27], a[216:219], a[32:35], v[24:27]
    ds_read_b64_tr_b16 a[238:239], v9 offset:51200
    v_cvt_pk_bf16_f32 v87, v54, v55
    v_mfma_f32_16x16x32_bf16 v[24:27], a[220:223], a[48:51], v[24:27]
    v_exp_f32 v88, v88
    v_mfma_f32_16x16x32_bf16 v[24:27], a[224:227], a[64:67], v[24:27]
    v_exp_f32 v89, v89
    v_mfma_f32_16x16x32_bf16 v[24:27], a[228:231], a[80:83], v[24:27]
    ds_read_b128 a[184:187], v12 offset:36864
    v_cvt_pk_bf16_f32 v88, v88, v89
    v_mfma_f32_16x16x32_bf16 v[28:31], a[228:231], a[84:87], 0
    buffer_load_dwordx4 v6, s[16:19], s39 offen lds
    v_mfma_f32_16x16x32_bf16 v[28:31], a[224:227], a[68:71], v[28:31]
    v_exp_f32 v90, v90
    v_mfma_f32_16x16x32_bf16 v[28:31], a[220:223], a[52:55], v[28:31]
    v_exp_f32 v91, v91
    v_mfma_f32_16x16x32_bf16 v[28:31], a[216:219], a[36:39], v[28:31]
    ds_read_b128 a[188:191], v13 offset:36864
    v_cvt_pk_bf16_f32 v89, v90, v91
    v_mfma_f32_16x16x32_bf16 v[28:31], a[212:215], a[20:23], v[28:31]
    v_exp_f32 v96, v96
    v_mfma_f32_16x16x32_bf16 v[28:31], a[208:211], a[4:7], v[28:31]
    v_exp_f32 v97, v97
    v_mfma_f32_16x16x32_bf16 v[32:35], a[208:211], a[8:11], 0
    ds_read_b128 a[192:195], v12 offset:37888
    v_cvt_pk_bf16_f32 v96, v96, v97
    v_mfma_f32_16x16x32_bf16 v[32:35], a[212:215], a[24:27], v[32:35]
    v_exp_f32 v98, v98
    v_mfma_f32_16x16x32_bf16 v[32:35], a[216:219], a[40:43], v[32:35]
    v_exp_f32 v99, v99
    v_mfma_f32_16x16x32_bf16 v[32:35], a[220:223], a[56:59], v[32:35]
    ds_read_b128 a[196:199], v13 offset:37888
    v_cvt_pk_bf16_f32 v97, v98, v99
    v_mfma_f32_16x16x32_bf16 v[32:35], a[224:227], a[72:75], v[32:35]
    v_exp_f32 v104, v104
    v_mfma_f32_16x16x32_bf16 v[32:35], a[228:231], a[88:91], v[32:35]
    v_exp_f32 v105, v105
    v_mfma_f32_16x16x32_bf16 v[36:39], a[228:231], a[92:95], 0
    ds_read_b128 a[200:203], v12 offset:38912
    v_cvt_pk_bf16_f32 v104, v104, v105
    v_mfma_f32_16x16x32_bf16 v[36:39], a[224:227], a[76:79], v[36:39]
    v_exp_f32 v106, v106
    v_mfma_f32_16x16x32_bf16 v[36:39], a[220:223], a[60:63], v[36:39]
    v_exp_f32 v107, v107
    v_mfma_f32_16x16x32_bf16 v[36:39], a[216:219], a[44:47], v[36:39]
    s_waitcnt lgkmcnt(2)
    ds_read_b128 a[204:207], v13 offset:38912
    v_cvt_pk_bf16_f32 v105, v106, v107
    v_mfma_f32_16x16x32_bf16 v[36:39], a[212:215], a[28:31], v[36:39]
    v_exp_f32 v112, v112
    v_mfma_f32_16x16x32_bf16 v[36:39], a[208:211], a[12:15], v[36:39]
    v_exp_f32 v113, v113
    v_mfma_f32_16x16x32_bf16 a[152:155], a[232:235], v[56:59], a[152:155]
    v_exp_f32 v114, v114
    v_mfma_f32_16x16x32_bf16 a[168:171], a[236:239], v[56:59], a[168:171]
    v_exp_f32 v115, v115
    v_mfma_f32_16x16x32_bf16 a[172:175], a[236:239], v[64:67], a[172:175]
    ds_read_b128 a[208:211], v12 offset:43008
    v_cvt_pk_bf16_f32 v112, v112, v113
    v_mfma_f32_16x16x32_bf16 a[156:159], a[232:235], v[64:67], a[156:159]
    ds_read_b128 a[212:215], v13 offset:43008
    v_cvt_pk_bf16_f32 v113, v114, v115
    v_mfma_f32_16x16x32_bf16 a[160:163], a[232:235], v[72:75], a[160:163]
    v_exp_f32 v24, v24
    v_mfma_f32_16x16x32_bf16 a[176:179], a[236:239], v[72:75], a[176:179]
    v_exp_f32 v25, v25
    v_mfma_f32_16x16x32_bf16 a[180:183], a[236:239], v[80:83], a[180:183]
    ds_read_b128 a[216:219], v12 offset:44032
    v_cvt_pk_bf16_f32 v90, v24, v25
    v_mfma_f32_16x16x32_bf16 a[164:167], a[232:235], v[80:83], a[164:167]
    ds_read_b128 a[220:223], v13 offset:44032
    v_mov_b32 v24, 0
    v_mfma_f32_16x16x32_bf16 v[92:95], a[184:187], a[0:3], 0
    s_waitcnt lgkmcnt(4)
    ds_read_b128 a[224:227], v12 offset:45056
    v_mov_b32 v25, 0
    v_mfma_f32_16x16x32_bf16 v[92:95], a[188:191], a[16:19], v[92:95]
    v_exp_f32 v26, v26
    v_mfma_f32_16x16x32_bf16 v[92:95], a[192:195], a[32:35], v[92:95]
    v_exp_f32 v27, v27
    v_mfma_f32_16x16x32_bf16 v[92:95], a[196:199], a[48:51], v[92:95]
    ds_read_b128 a[228:231], v13 offset:45056
    v_cvt_pk_bf16_f32 v91, v26, v27
    v_mfma_f32_16x16x32_bf16 v[92:95], a[200:203], a[64:67], v[92:95]
    v_exp_f32 v28, v28
    v_mfma_f32_16x16x32_bf16 v[92:95], a[204:207], a[80:83], v[92:95]
    v_exp_f32 v29, v29
    v_mfma_f32_16x16x32_bf16 v[100:103], a[204:207], a[84:87], 0
    v_exp_f32 v30, v30
    v_mfma_f32_16x16x32_bf16 v[100:103], a[200:203], a[68:71], v[100:103]
    v_exp_f32 v31, v31
    v_mfma_f32_16x16x32_bf16 v[100:103], a[196:199], a[52:55], v[100:103]
    v_exp_f32 v32, v32
    v_mfma_f32_16x16x32_bf16 v[100:103], a[192:195], a[36:39], v[100:103]
    v_exp_f32 v33, v33
    v_mfma_f32_16x16x32_bf16 v[100:103], a[188:191], a[20:23], v[100:103]
    v_exp_f32 v34, v34
    v_mfma_f32_16x16x32_bf16 v[100:103], a[184:187], a[4:7], v[100:103]
    v_exp_f32 v35, v35
    v_mfma_f32_16x16x32_bf16 v[108:111], a[184:187], a[8:11], 0
    v_cvt_pk_bf16_f32 v98, v28, v29
    v_cvt_pk_bf16_f32 v99, v30, v31
    v_mfma_f32_16x16x32_bf16 v[108:111], a[188:191], a[24:27], v[108:111]
    v_exp_f32 v36, v36
    v_mfma_f32_16x16x32_bf16 v[108:111], a[192:195], a[40:43], v[108:111]
    v_exp_f32 v37, v37
    v_mfma_f32_16x16x32_bf16 v[108:111], a[196:199], a[56:59], v[108:111]
    v_exp_f32 v38, v38
    v_mfma_f32_16x16x32_bf16 v[108:111], a[200:203], a[72:75], v[108:111]
    v_exp_f32 v39, v39
    v_mfma_f32_16x16x32_bf16 v[108:111], a[204:207], a[88:91], v[108:111]
    v_cvt_pk_bf16_f32 v106, v32, v33
    v_cvt_pk_bf16_f32 v107, v34, v35
    v_mfma_f32_16x16x32_bf16 v[116:119], a[204:207], a[92:95], 0
    s_add_u32 s39, s40, 123008
    v_cvt_pk_bf16_f32 v114, v36, v37
    v_cvt_pk_bf16_f32 v115, v38, v39
    v_mfma_f32_16x16x32_bf16 v[116:119], a[200:203], a[76:79], v[116:119]
    v_exp_f32 v92, v92
    v_mfma_f32_16x16x32_bf16 v[116:119], a[196:199], a[60:63], v[116:119]
    s_addk_i32 m0, 4096
    v_exp_f32 v93, v93
    v_mfma_f32_16x16x32_bf16 v[116:119], a[192:195], a[44:47], v[116:119]
    s_waitcnt lgkmcnt(0)
    v_exp_f32 v94, v94
    v_mfma_f32_16x16x32_bf16 v[116:119], a[188:191], a[28:31], v[116:119]
    v_exp_f32 v95, v95
    v_mfma_f32_16x16x32_bf16 v[116:119], a[184:187], a[12:15], v[116:119]
    v_exp_f32 v100, v100
    v_mfma_f32_16x16x32_bf16 v[40:43], a[208:211], a[0:3], 0
    s_waitcnt vmcnt(12)
    v_exp_f32 v101, v101
    v_mfma_f32_16x16x32_bf16 v[40:43], a[212:215], a[16:19], v[40:43]
    s_barrier
    v_mfma_f32_16x16x32_bf16 v[40:43], a[216:219], a[32:35], v[40:43]
    buffer_load_dwordx4 v6, s[16:19], s39 offen lds
    v_mfma_f32_16x16x32_bf16 v[40:43], a[220:223], a[48:51], v[40:43]
    s_add_u32 s39, s40, 135296
    ds_read_b64_tr_b16 a[240:241], v8 offset:53248
    v_cvt_pk_bf16_f32 v92, v92, v93
    v_mfma_f32_16x16x32_bf16 v[40:43], a[224:227], a[64:67], v[40:43]
    s_addk_i32 m0, 4096
    ds_read_b64_tr_b16 a[242:243], v8 offset:55296
    v_cvt_pk_bf16_f32 v93, v94, v95
    v_mfma_f32_16x16x32_bf16 v[40:43], a[228:231], a[80:83], v[40:43]
    ds_read_b64_tr_b16 a[244:245], v9 offset:53248
    v_cvt_pk_bf16_f32 v100, v100, v101
    v_mfma_f32_16x16x32_bf16 v[44:47], a[228:231], a[84:87], 0
    ds_read_b64_tr_b16 a[246:247], v9 offset:55296
    v_mov_b32 v28, 0
    v_mfma_f32_16x16x32_bf16 v[44:47], a[224:227], a[68:71], v[44:47]
    v_exp_f32 v102, v102
    v_mfma_f32_16x16x32_bf16 v[44:47], a[220:223], a[52:55], v[44:47]
    v_exp_f32 v103, v103
    v_mfma_f32_16x16x32_bf16 v[44:47], a[216:219], a[36:39], v[44:47]
    v_exp_f32 v108, v108
    v_mfma_f32_16x16x32_bf16 v[44:47], a[212:215], a[20:23], v[44:47]
    buffer_load_dwordx4 v6, s[16:19], s39 offen lds
    v_mfma_f32_16x16x32_bf16 v[44:47], a[208:211], a[4:7], v[44:47]
    s_add_u32 s39, s40, 147584
    v_exp_f32 v109, v109
    v_mfma_f32_16x16x32_bf16 v[48:51], a[208:211], a[8:11], 0
    s_addk_i32 m0, 4096
    v_exp_f32 v110, v110
    v_mfma_f32_16x16x32_bf16 v[48:51], a[212:215], a[24:27], v[48:51]
    v_exp_f32 v111, v111
    v_mfma_f32_16x16x32_bf16 v[48:51], a[216:219], a[40:43], v[48:51]
    v_cvt_pk_bf16_f32 v101, v102, v103
    v_cvt_pk_bf16_f32 v108, v108, v109
    v_mfma_f32_16x16x32_bf16 v[48:51], a[220:223], a[56:59], v[48:51]
    v_exp_f32 v116, v116
    v_mfma_f32_16x16x32_bf16 v[48:51], a[224:227], a[72:75], v[48:51]
    v_exp_f32 v117, v117
    v_mfma_f32_16x16x32_bf16 v[48:51], a[228:231], a[88:91], v[48:51]
    v_exp_f32 v118, v118
    v_mfma_f32_16x16x32_bf16 v[52:55], a[228:231], a[92:95], 0
    buffer_load_dwordx4 v6, s[16:19], s39 offen lds
    v_mfma_f32_16x16x32_bf16 v[52:55], a[224:227], a[76:79], v[52:55]
    s_add_u32 s39, s40, 159872
    v_exp_f32 v119, v119
    v_mfma_f32_16x16x32_bf16 v[52:55], a[220:223], a[60:63], v[52:55]
    s_addk_i32 m0, 4096
    v_cvt_pk_bf16_f32 v109, v110, v111
    v_cvt_pk_bf16_f32 v116, v116, v117
    v_mfma_f32_16x16x32_bf16 v[52:55], a[216:219], a[44:47], v[52:55]
    s_waitcnt lgkmcnt(0)
    v_exp_f32 v40, v40
    v_mfma_f32_16x16x32_bf16 v[52:55], a[212:215], a[28:31], v[52:55]
    v_exp_f32 v41, v41
    v_mfma_f32_16x16x32_bf16 v[52:55], a[208:211], a[12:15], v[52:55]
    v_exp_f32 v42, v42
    v_mfma_f32_16x16x32_bf16 a[164:167], a[240:243], v[84:87], a[164:167]
    v_exp_f32 v43, v43
    v_mfma_f32_16x16x32_bf16 a[180:183], a[244:247], v[84:87], a[180:183]
    v_cvt_pk_bf16_f32 v117, v118, v119
    v_cvt_pk_bf16_f32 v94, v40, v41
    v_mfma_f32_16x16x32_bf16 a[176:179], a[244:247], v[76:79], a[176:179]
    buffer_load_dwordx4 v6, s[16:19], s39 offen lds
    v_mfma_f32_16x16x32_bf16 a[160:163], a[240:243], v[76:79], a[160:163]
    s_add_u32 s39, s40, 172160
    v_exp_f32 v44, v44
    v_mfma_f32_16x16x32_bf16 a[156:159], a[240:243], v[68:71], a[156:159]
    s_addk_i32 m0, 4096
    v_exp_f32 v45, v45
    v_mfma_f32_16x16x32_bf16 a[172:175], a[244:247], v[68:71], a[172:175]
    v_exp_f32 v46, v46
    v_mfma_f32_16x16x32_bf16 a[168:171], a[244:247], v[60:63], a[168:171]
    v_exp_f32 v47, v47
    v_mfma_f32_16x16x32_bf16 a[152:155], a[240:243], v[60:63], a[152:155]
    v_cvt_pk_bf16_f32 v95, v42, v43
    v_cvt_pk_bf16_f32 v102, v44, v45
    v_smfmac_f32_16x16x64_bf16 v[24:27], a[248:251], a[96:103], v20
    v_cvt_pk_bf16_f32 v103, v46, v47
    v_mov_b32 v29, 0
    s_nop 1
    v_smfmac_f32_16x16x64_bf16 v[28:31], a[248:251], a[104:111], v20
    v_mov_b32 v32, 0
    v_mov_b32 v33, 0
    s_nop 1
    v_smfmac_f32_16x16x64_bf16 v[32:35], a[248:251], a[112:119], v20
    buffer_load_dwordx4 v6, s[16:19], s39 offen lds
    v_mov_b32 v36, 0
    v_mov_b32 v37, 0
    s_nop 1
    v_smfmac_f32_16x16x64_bf16 v[36:39], a[248:251], a[120:127], v20
    s_add_u32 s39, s40, 184448
    ds_read_b64_tr_b16 a[232:233], v8 offset:57344
    v_smfmac_f32_16x16x64_bf16 v[24:27], a[248:251], a[128:135], v20
    s_addk_i32 m0, 4096
    ds_read_b64_tr_b16 a[234:235], v8 offset:59392
    v_smfmac_f32_16x16x64_bf16 v[28:31], a[248:251], a[136:143], v20
    ds_read_b64_tr_b16 a[236:237], v9 offset:57344
    v_smfmac_f32_16x16x64_bf16 v[32:35], a[248:251], a[144:151], v20
    ds_read_b64_tr_b16 a[238:239], v9 offset:59392
    v_smfmac_f32_16x16x64_bf16 v[36:39], a[248:251], v[120:127], v20
    v_smfmac_f32_16x16x64_bf16 v[24:27], a[248:251], v[128:135], v20
    v_smfmac_f32_16x16x64_bf16 v[28:31], a[248:251], v[136:143], v20
    v_smfmac_f32_16x16x64_bf16 v[32:35], a[248:251], v[144:151], v20
    buffer_load_dwordx4 v6, s[16:19], s39 offen lds
    v_smfmac_f32_16x16x64_bf16 v[36:39], a[248:251], v[152:159], v20
    s_add_u32 s38, s44, 0
    ds_read_b64_tr_b16 a[240:241], v8 offset:61440
    s_add_u32 s36, s44, 40960
    v_smfmac_f32_16x16x64_bf16 v[24:27], a[248:251], v[160:167], v20
    s_cmp_lt_u32 s3, 2
    s_cselect_b32 s38, s38, s36
    s_add_u32 m0, s63, 155648
    v_smfmac_f32_16x16x64_bf16 v[28:31], a[248:251], v[168:175], v20
    ds_read_b64_tr_b16 a[242:243], v8 offset:63488
    v_smfmac_f32_16x16x64_bf16 v[32:35], a[248:251], v[176:183], v20
    ds_read_b64_tr_b16 a[244:245], v9 offset:61440
    v_smfmac_f32_16x16x64_bf16 v[36:39], a[248:251], v[184:191], v20
    ds_read_b64_tr_b16 a[246:247], v9 offset:63488
    v_smfmac_f32_16x16x64_bf16 v[24:27], a[248:251], v[192:199], v20
    v_smfmac_f32_16x16x64_bf16 v[28:31], a[248:251], v[200:207], v20
    v_smfmac_f32_16x16x64_bf16 v[32:35], a[248:251], v[208:215], v20
    buffer_load_dwordx4 v7, s[8:11], s38 offen lds
    v_smfmac_f32_16x16x64_bf16 v[36:39], a[248:251], v[216:223], v20
    s_add_u32 s38, s44, 0
    ds_read_b64_tr_b16 a[184:185], v10 offset:0
    v_smfmac_f32_16x16x64_bf16 v[24:27], a[248:251], v[224:231], v20
    s_addk_i32 m0, -16384
    ds_read_b64_tr_b16 a[186:187], v10 offset:2048
    v_smfmac_f32_16x16x64_bf16 v[28:31], a[248:251], v[232:239], v20
    ds_read_b64_tr_b16 a[188:189], v10 offset:4096
    v_smfmac_f32_16x16x64_bf16 v[32:35], a[248:251], v[240:247], v20
    s_waitcnt lgkmcnt(3)
    ds_read_b64_tr_b16 a[190:191], v10 offset:6144
    v_smfmac_f32_16x16x64_bf16 v[36:39], a[248:251], v[248:255], v20
    v_smfmac_f32_16x16x64_bf16 v[24:27], a[248:251], v[56:63], v20
    v_smfmac_f32_16x16x64_bf16 v[28:31], a[248:251], v[64:71], v20
    v_smfmac_f32_16x16x64_bf16 v[32:35], a[248:251], v[72:79], v20
    buffer_load_dwordx4 v2, s[8:11], s38 offen lds
    v_smfmac_f32_16x16x64_bf16 v[36:39], a[248:251], v[80:87], v20
    s_add_u32 s38, s44, 0
    ds_read_b64_tr_b16 a[192:193], v10 offset:8192
    v_smfmac_f32_16x16x64_bf16 v[24:27], a[248:251], v[88:95], v20
    s_addk_i32 m0, 4096
    ds_read_b64_tr_b16 a[194:195], v10 offset:10240
    v_smfmac_f32_16x16x64_bf16 v[28:31], a[248:251], v[96:103], v20
    ds_read_b64_tr_b16 a[196:197], v10 offset:12288
    v_exp_f32 v48, v48
    v_exp_f32 v49, v49
    v_exp_f32 v50, v50
    v_exp_f32 v51, v51
    v_cvt_pk_bf16_f32 v110, v48, v49
    v_cvt_pk_bf16_f32 v111, v50, v51
    s_nop 1
    v_smfmac_f32_16x16x64_bf16 v[32:35], a[248:251], v[104:111], v20
    ds_read_b64_tr_b16 a[198:199], v10 offset:14336
    v_add_f32 v24, v24, v25
    v_exp_f32 v52, v52
    v_exp_f32 v53, v53
    v_exp_f32 v54, v54
    v_exp_f32 v55, v55
    v_cvt_pk_bf16_f32 v118, v52, v53
    v_cvt_pk_bf16_f32 v119, v54, v55
    s_nop 1
    v_smfmac_f32_16x16x64_bf16 v[36:39], a[248:251], v[112:119], v20
    v_add_f32 v28, v28, v29
    v_mfma_f32_16x16x32_bf16 a[152:155], a[232:235], v[88:91], a[152:155]
    v_rcp_f32 v16, v24
    v_mfma_f32_16x16x32_bf16 a[168:171], a[236:239], v[88:91], a[168:171]
    v_rcp_f32 v17, v28
    v_mfma_f32_16x16x32_bf16 a[172:175], a[236:239], v[96:99], a[172:175]
    buffer_load_dwordx4 v3, s[8:11], s38 offen lds
    v_mfma_f32_16x16x32_bf16 a[156:159], a[232:235], v[96:99], a[156:159]
    s_add_u32 s38, s44, 40960
    ds_read_b64_tr_b16 a[200:201], v10 offset:16384
    v_add_f32 v32, v32, v33
    v_mfma_f32_16x16x32_bf16 a[160:163], a[232:235], v[104:107], a[160:163]
    s_addk_i32 m0, 4096
    ds_read_b64_tr_b16 a[202:203], v10 offset:18432
    v_add_f32 v36, v36, v37
    v_mfma_f32_16x16x32_bf16 a[176:179], a[236:239], v[104:107], a[176:179]
    ds_read_b64_tr_b16 a[204:205], v10 offset:20480
    v_max3_f32 v21, v24, v28, v32
    v_mfma_f32_16x16x32_bf16 a[180:183], a[236:239], v[112:115], a[180:183]
    s_waitcnt lgkmcnt(3)
    ds_read_b64_tr_b16 a[206:207], v10 offset:22528
    v_max3_f32 v21, v21, v36, v16
    v_mfma_f32_16x16x32_bf16 a[164:167], a[232:235], v[112:115], a[164:167]
    v_rcp_f32 v18, v32
    v_mfma_f32_16x16x32_bf16 a[164:167], a[240:243], v[116:119], a[164:167]
    v_rcp_f32 v19, v36
    v_mfma_f32_16x16x32_bf16 a[180:183], a[244:247], v[116:119], a[180:183]
    v_max3_f32 v21, v21, v17, v18
    v_max_f32 v21, v21, v19
    v_mfma_f32_16x16x32_bf16 a[176:179], a[244:247], v[108:111], a[176:179]
    buffer_load_dwordx4 v2, s[8:11], s38 offen lds
    v_mfma_f32_16x16x32_bf16 a[160:163], a[240:243], v[108:111], a[160:163]
    s_add_u32 s38, s44, 40960
    ds_read_b64_tr_b16 a[208:209], v10 offset:24576
    v_cmp_nge_f32 vcc, 0x5f800000, v21
    v_mfma_f32_16x16x32_bf16 a[156:159], a[240:243], v[100:103], a[156:159]
    s_addk_i32 m0, 4096
    ds_read_b64_tr_b16 a[210:211], v10 offset:26624
    v_mfma_f32_16x16x32_bf16 a[172:175], a[244:247], v[100:103], a[172:175]
    ds_read_b64_tr_b16 a[212:213], v10 offset:28672
    v_mfma_f32_16x16x32_bf16 a[168:171], a[244:247], v[92:95], a[168:171]
    ds_read_b64_tr_b16 a[214:215], v10 offset:30720
    v_mfma_f32_16x16x32_bf16 a[152:155], a[240:243], v[92:95], a[152:155]
    s_cbranch_vccnz rare
rare_ret:
    v_mfma_f32_16x16x32_bf16 v[40:43], a[184:187], a[96:99], 0
    v_subrev_u32 v8, 73728, v8
    v_subrev_u32 v9, 73728, v9
    v_mfma_f32_16x16x32_bf16 v[40:43], a[188:191], a[100:103], v[40:43]
    v_mfma_f32_16x16x32_bf16 v[44:47], a[188:191], a[108:111], 0
    s_barrier
    v_mfma_f32_16x16x32_bf16 v[44:47], a[184:187], a[104:107], v[44:47]
    buffer_load_dwordx4 v3, s[8:11], s38 offen lds
    v_mfma_f32_16x16x32_bf16 v[48:51], a[184:187], a[112:115], 0
    v_accvgpr_read_b32 v21, a152
    v_accvgpr_read_b32 v22, a153
    v_mfma_f32_16x16x32_bf16 v[48:51], a[188:191], a[116:119], v[48:51]
    v_accvgpr_read_b32 v23, a154
    v_accvgpr_read_b32 v5, a155
    v_mfma_f32_16x16x32_bf16 v[52:55], a[188:191], a[124:127], 0
    v_mul_f32 v21, v16, v21
    v_mul_f32 v22, v16, v22
    v_mfma_f32_16x16x32_bf16 v[52:55], a[184:187], a[120:123], v[52:55]
    ds_read_b64_tr_b16 a[184:185], v10 offset:32768
    v_mul_f32 v23, v16, v23
    v_mfma_f32_16x16x32_bf16 v[52:55], a[192:195], v[120:123], v[52:55]
    ds_read_b64_tr_b16 a[186:187], v10 offset:34816
    v_mul_f32 v5, v16, v5
    v_mfma_f32_16x16x32_bf16 v[52:55], a[196:199], v[124:127], v[52:55]
    ds_read_b64_tr_b16 a[188:189], v10 offset:36864
    v_cvt_pk_bf16_f32 v21, v21, v22
    v_mfma_f32_16x16x32_bf16 v[48:51], a[196:199], a[148:151], v[48:51]
    s_waitcnt lgkmcnt(3)
    ds_read_b64_tr_b16 a[190:191], v10 offset:38912
    v_cvt_pk_bf16_f32 v22, v23, v5
    v_mfma_f32_16x16x32_bf16 v[48:51], a[192:195], a[144:147], v[48:51]
    v_accvgpr_write_b32 a0, v21
    v_accvgpr_write_b32 a1, v22
    v_mfma_f32_16x16x32_bf16 v[44:47], a[192:195], a[136:139], v[44:47]
    v_accvgpr_read_b32 v21, a168
    v_accvgpr_read_b32 v22, a169
    v_mfma_f32_16x16x32_bf16 v[44:47], a[196:199], a[140:143], v[44:47]
    v_accvgpr_read_b32 v23, a170
    v_accvgpr_read_b32 v5, a171
    v_mfma_f32_16x16x32_bf16 v[40:43], a[196:199], a[132:135], v[40:43]
    v_mul_f32 v21, v16, v21
    v_mul_f32 v22, v16, v22
    v_mfma_f32_16x16x32_bf16 v[40:43], a[192:195], a[128:131], v[40:43]
    ds_read_b64_tr_b16 a[192:193], v10 offset:40960
    v_mul_f32 v23, v16, v23
    v_mfma_f32_16x16x32_bf16 v[40:43], a[200:203], v[128:131], v[40:43]
    ds_read_b64_tr_b16 a[194:195], v10 offset:43008
    v_mul_f32 v5, v16, v5
    v_mfma_f32_16x16x32_bf16 v[40:43], a[204:207], v[132:135], v[40:43]
    ds_read_b64_tr_b16 a[196:197], v10 offset:45056
    v_cvt_pk_bf16_f32 v21, v21, v22
    v_mfma_f32_16x16x32_bf16 v[44:47], a[204:207], v[140:143], v[44:47]
    ds_read_b64_tr_b16 a[198:199], v10 offset:47104
    v_cvt_pk_bf16_f32 v22, v23, v5
    v_mfma_f32_16x16x32_bf16 v[44:47], a[200:203], v[136:139], v[44:47]
    v_accvgpr_write_b32 a2, v21
    v_accvgpr_write_b32 a3, v22
    v_mfma_f32_16x16x32_bf16 v[48:51], a[200:203], v[144:147], v[48:51]
    buffer_store_dwordx4 a[0:3], v14, s[20:23], s55 offen offset:0 sc1
    v_accvgpr_read_b32 v21, a156
    v_mfma_f32_16x16x32_bf16 v[48:51], a[204:207], v[148:151], v[48:51]
    v_accvgpr_read_b32 v22, a157
    v_accvgpr_read_b32 v23, a158
    v_mfma_f32_16x16x32_bf16 v[52:55], a[204:207], v[156:159], v[52:55]
    v_accvgpr_read_b32 v5, a159
    v_mul_f32 v21, v17, v21
    v_mfma_f32_16x16x32_bf16 v[52:55], a[200:203], v[152:155], v[52:55]
    ds_read_b64_tr_b16 a[200:201], v10 offset:49152
    v_mul_f32 v22, v17, v22
    v_mfma_f32_16x16x32_bf16 v[52:55], a[208:211], v[184:187], v[52:55]
    ds_read_b64_tr_b16 a[202:203], v10 offset:51200
    v_mul_f32 v23, v17, v23
    v_mfma_f32_16x16x32_bf16 v[52:55], a[212:215], v[188:191], v[52:55]
    ds_read_b64_tr_b16 a[204:205], v10 offset:53248
    v_mul_f32 v5, v17, v5
    v_mfma_f32_16x16x32_bf16 v[48:51], a[212:215], v[180:183], v[48:51]
    s_waitcnt lgkmcnt(3)
    ds_read_b64_tr_b16 a[206:207], v10 offset:55296
    v_cvt_pk_bf16_f32 v21, v21, v22
    v_mfma_f32_16x16x32_bf16 v[48:51], a[208:211], v[176:179], v[48:51]
    v_cvt_pk_bf16_f32 v22, v23, v5
    v_accvgpr_write_b32 a4, v21
    v_mfma_f32_16x16x32_bf16 v[44:47], a[208:211], v[168:171], v[44:47]
    v_accvgpr_write_b32 a5, v22
    v_accvgpr_read_b32 v21, a172
    v_mfma_f32_16x16x32_bf16 v[44:47], a[212:215], v[172:175], v[44:47]
    v_accvgpr_read_b32 v22, a173
    v_accvgpr_read_b32 v23, a174
    v_mfma_f32_16x16x32_bf16 v[40:43], a[212:215], v[164:167], v[40:43]
    v_accvgpr_read_b32 v5, a175
    v_mul_f32 v21, v17, v21
    v_mfma_f32_16x16x32_bf16 v[40:43], a[208:211], v[160:163], v[40:43]
    ds_read_b64_tr_b16 a[208:209], v10 offset:57344
    v_mul_f32 v22, v17, v22
    v_mfma_f32_16x16x32_bf16 v[40:43], a[184:187], v[192:195], v[40:43]
    ds_read_b64_tr_b16 a[210:211], v10 offset:59392
    v_mul_f32 v23, v17, v23
    v_mfma_f32_16x16x32_bf16 v[40:43], a[188:191], v[196:199], v[40:43]
    ds_read_b64_tr_b16 a[212:213], v10 offset:61440
    v_mul_f32 v5, v17, v5
    v_mfma_f32_16x16x32_bf16 v[44:47], a[188:191], v[204:207], v[44:47]
    ds_read_b64_tr_b16 a[214:215], v10 offset:63488
    v_subrev_u32 v10, 73728, v10
    v_mfma_f32_16x16x32_bf16 v[44:47], a[184:187], v[200:203], v[44:47]
    v_cvt_pk_bf16_f32 v21, v21, v22
    v_cvt_pk_bf16_f32 v22, v23, v5
    v_mfma_f32_16x16x32_bf16 v[48:51], a[184:187], v[208:211], v[48:51]
    v_accvgpr_write_b32 a6, v21
    v_accvgpr_write_b32 a7, v22
    v_mfma_f32_16x16x32_bf16 v[48:51], a[188:191], v[212:215], v[48:51]
    buffer_store_dwordx4 a[4:7], v14, s[20:23], s55 offen offset:1024 sc1
    v_accvgpr_read_b32 v21, a160
    v_mfma_f32_16x16x32_bf16 v[52:55], a[188:191], v[220:223], v[52:55]
    v_accvgpr_read_b32 v22, a161
    v_accvgpr_read_b32 v23, a162
    v_mfma_f32_16x16x32_bf16 v[52:55], a[184:187], v[216:219], v[52:55]
    ds_read_b64_tr_b16 a[184:185], v11 offset:0
    v_accvgpr_read_b32 v5, a163
    v_mfma_f32_16x16x32_bf16 v[52:55], a[192:195], v[248:251], v[52:55]
    ds_read_b64_tr_b16 a[186:187], v11 offset:2048
    v_mul_f32 v21, v18, v21
    v_mfma_f32_16x16x32_bf16 v[52:55], a[196:199], v[252:255], v[52:55]
    ds_read_b64_tr_b16 a[188:189], v11 offset:4096
    v_mul_f32 v22, v18, v22
    v_mfma_f32_16x16x32_bf16 v[48:51], a[196:199], v[244:247], v[48:51]
    s_waitcnt lgkmcnt(3)
    ds_read_b64_tr_b16 a[190:191], v11 offset:6144
    v_mul_f32 v23, v18, v23
    v_mfma_f32_16x16x32_bf16 v[48:51], a[192:195], v[240:243], v[48:51]
    v_mul_f32 v5, v18, v5
    v_cvt_pk_bf16_f32 v21, v21, v22
    v_mfma_f32_16x16x32_bf16 v[44:47], a[192:195], v[232:235], v[44:47]
    v_cvt_pk_bf16_f32 v22, v23, v5
    v_accvgpr_write_b32 a8, v21
    v_mfma_f32_16x16x32_bf16 v[44:47], a[196:199], v[236:239], v[44:47]
    v_accvgpr_write_b32 a9, v22
    v_accvgpr_read_b32 v21, a176
    v_mfma_f32_16x16x32_bf16 v[40:43], a[196:199], v[228:231], v[40:43]
    v_accvgpr_read_b32 v22, a177
    v_accvgpr_read_b32 v23, a178
    v_mfma_f32_16x16x32_bf16 v[40:43], a[192:195], v[224:227], v[40:43]
    ds_read_b64_tr_b16 a[192:193], v11 offset:8192
    v_accvgpr_read_b32 v5, a179
    v_mfma_f32_16x16x32_bf16 v[40:43], a[200:203], v[56:59], v[40:43]
    ds_read_b64_tr_b16 a[194:195], v11 offset:10240
    v_mul_f32 v21, v18, v21
    v_mfma_f32_16x16x32_bf16 v[40:43], a[204:207], v[60:63], v[40:43]
    ds_read_b64_tr_b16 a[196:197], v11 offset:12288
    v_mul_f32 v22, v18, v22
    v_mfma_f32_16x16x32_bf16 v[44:47], a[204:207], v[68:71], v[44:47]
    ds_read_b64_tr_b16 a[198:199], v11 offset:14336
    v_mul_f32 v23, v18, v23
    v_mfma_f32_16x16x32_bf16 v[44:47], a[200:203], v[64:67], v[44:47]
    v_mul_f32 v5, v18, v5
    v_cvt_pk_bf16_f32 v21, v21, v22
    v_mfma_f32_16x16x32_bf16 v[48:51], a[200:203], v[72:75], v[48:51]
    v_cvt_pk_bf16_f32 v22, v23, v5
    v_accvgpr_write_b32 a10, v21
    v_mfma_f32_16x16x32_bf16 v[48:51], a[204:207], v[76:79], v[48:51]
    v_accvgpr_write_b32 a11, v22
    v_accvgpr_read_b32 v21, a164
    v_mfma_f32_16x16x32_bf16 v[52:55], a[204:207], v[84:87], v[52:55]
    buffer_store_dwordx4 a[8:11], v14, s[20:23], s55 offen offset:2048 sc1
    v_accvgpr_read_b32 v22, a165
    v_mfma_f32_16x16x32_bf16 v[52:55], a[200:203], v[80:83], v[52:55]
    ds_read_b64_tr_b16 a[200:201], v11 offset:16384
    v_accvgpr_read_b32 v23, a166
    v_mfma_f32_16x16x32_bf16 v[52:55], a[208:211], v[112:115], v[52:55]
    ds_read_b64_tr_b16 a[202:203], v11 offset:18432
    v_accvgpr_read_b32 v5, a167
    v_mfma_f32_16x16x32_bf16 v[52:55], a[212:215], v[116:119], v[52:55]
    ds_read_b64_tr_b16 a[204:205], v11 offset:20480
    v_mul_f32 v21, v19, v21
    v_mfma_f32_16x16x32_bf16 v[48:51], a[212:215], v[108:111], v[48:51]
    s_waitcnt lgkmcnt(3)
    ds_read_b64_tr_b16 a[206:207], v11 offset:22528
    v_mul_f32 v22, v19, v22
    v_mfma_f32_16x16x32_bf16 v[48:51], a[208:211], v[104:107], v[48:51]
    v_mul_f32 v23, v19, v23
    v_mul_f32 v5, v19, v5
    v_mfma_f32_16x16x32_bf16 v[44:47], a[208:211], v[96:99], v[44:47]
    v_cvt_pk_bf16_f32 v21, v21, v22
    v_cvt_pk_bf16_f32 v22, v23, v5
    v_mfma_f32_16x16x32_bf16 v[44:47], a[212:215], v[100:103], v[44:47]
    v_accvgpr_write_b32 a12, v21
    v_accvgpr_write_b32 a13, v22
    v_mfma_f32_16x16x32_bf16 v[40:43], a[212:215], v[92:95], v[40:43]
    v_accvgpr_read_b32 v21, a180
    v_accvgpr_read_b32 v22, a181
    v_mfma_f32_16x16x32_bf16 v[40:43], a[208:211], v[88:91], v[40:43]
    ds_read_b64_tr_b16 a[208:209], v11 offset:24576
    v_accvgpr_read_b32 v23, a182
    v_mfma_f32_16x16x32_bf16 v[24:27], a[184:187], a[96:99], 0
    ds_read_b64_tr_b16 a[210:211], v11 offset:26624
    v_accvgpr_read_b32 v5, a183
    v_mfma_f32_16x16x32_bf16 v[24:27], a[188:191], a[100:103], v[24:27]
    ds_read_b64_tr_b16 a[212:213], v11 offset:28672
    v_mul_f32 v21, v19, v21
    v_mfma_f32_16x16x32_bf16 v[28:31], a[188:191], a[108:111], 0
    ds_read_b64_tr_b16 a[214:215], v11 offset:30720
    v_mul_f32 v22, v19, v22
    v_mfma_f32_16x16x32_bf16 v[28:31], a[184:187], a[104:107], v[28:31]
    v_mul_f32 v23, v19, v23
    v_mul_f32 v5, v19, v5
    v_mfma_f32_16x16x32_bf16 v[32:35], a[184:187], a[112:115], 0
pg_9:
    s_cbranch_execz pg_13
    v_cvt_pk_bf16_f32 v21, v21, v22
    v_cvt_pk_bf16_f32 v22, v23, v5
    v_mfma_f32_16x16x32_bf16 v[32:35], a[188:191], a[116:119], v[32:35]
    v_accvgpr_write_b32 a14, v21
    v_accvgpr_write_b32 a15, v22
    v_mfma_f32_16x16x32_bf16 v[36:39], a[188:191], a[124:127], 0
    buffer_store_dwordx4 a[12:15], v14, s[20:23], s55 offen offset:3072 sc1
    v_mul_f32 v40, v16, v40
    v_mfma_f32_16x16x32_bf16 v[36:39], a[184:187], a[120:123], v[36:39]
    s_add_u32 s55, s55, 4096
    ds_read_b64_tr_b16 a[184:185], v11 offset:32768
    v_mul_f32 v41, v16, v41
    v_mfma_f32_16x16x32_bf16 v[36:39], a[192:195], v[120:123], v[36:39]
    ds_read_b64_tr_b16 a[186:187], v11 offset:34816
    v_mul_f32 v42, v16, v42
    v_mfma_f32_16x16x32_bf16 v[36:39], a[196:199], v[124:127], v[36:39]
    ds_read_b64_tr_b16 a[188:189], v11 offset:36864
    v_mul_f32 v43, v16, v43
    v_mfma_f32_16x16x32_bf16 v[32:35], a[196:199], a[148:151], v[32:35]
    s_waitcnt lgkmcnt(3)
    ds_read_b64_tr_b16 a[190:191], v11 offset:38912
    v_cvt_pk_bf16_f32 v40, v40, v41
    v_mfma_f32_16x16x32_bf16 v[32:35], a[192:195], a[144:147], v[32:35]
    v_cvt_pk_bf16_f32 v41, v42, v43
    v_accvgpr_write_b32 a16, v40
    v_mfma_f32_16x16x32_bf16 v[28:31], a[192:195], a[136:139], v[28:31]
    v_accvgpr_write_b32 a17, v41
    v_mul_f32 v44, v17, v44
    v_mfma_f32_16x16x32_bf16 v[28:31], a[196:199], a[140:143], v[28:31]
    v_mul_f32 v45, v17, v45
    v_mul_f32 v46, v17, v46
    v_mfma_f32_16x16x32_bf16 v[24:27], a[196:199], a[132:135], v[24:27]
    v_mul_f32 v47, v17, v47
    v_cvt_pk_bf16_f32 v44, v44, v45
    v_mfma_f32_16x16x32_bf16 v[24:27], a[192:195], a[128:131], v[24:27]
    ds_read_b64_tr_b16 a[192:193], v11 offset:40960
    v_cvt_pk_bf16_f32 v45, v46, v47
    v_mfma_f32_16x16x32_bf16 v[24:27], a[200:203], v[128:131], v[24:27]
    ds_read_b64_tr_b16 a[194:195], v11 offset:43008
    v_accvgpr_write_b32 a20, v44
    v_mfma_f32_16x16x32_bf16 v[24:27], a[204:207], v[132:135], v[24:27]
    ds_read_b64_tr_b16 a[196:197], v11 offset:45056
    v_accvgpr_write_b32 a21, v45
    v_mfma_f32_16x16x32_bf16 v[28:31], a[204:207], v[140:143], v[28:31]
    ds_read_b64_tr_b16 a[198:199], v11 offset:47104
    v_mul_f32 v48, v18, v48
    v_mfma_f32_16x16x32_bf16 v[28:31], a[200:203], v[136:139], v[28:31]
    v_mul_f32 v49, v18, v49
    v_mul_f32 v50, v18, v50
    v_mfma_f32_16x16x32_bf16 v[32:35], a[200:203], v[144:147], v[32:35]
    v_mul_f32 v51, v18, v51
    v_cvt_pk_bf16_f32 v48, v48, v49
    v_mfma_f32_16x16x32_bf16 v[32:35], a[204:207], v[148:151], v[32:35]
    v_cvt_pk_bf16_f32 v49, v50, v51
    v_accvgpr_write_b32 a24, v48
    v_mfma_f32_16x16x32_bf16 v[36:39], a[204:207], v[156:159], v[36:39]
    v_accvgpr_write_b32 a25, v49
    v_mul_f32 v52, v19, v52
    v_mfma_f32_16x16x32_bf16 v[36:39], a[200:203], v[152:155], v[36:39]
    ds_read_b64_tr_b16 a[200:201], v11 offset:49152
    v_mul_f32 v53, v19, v53
    v_mfma_f32_16x16x32_bf16 v[36:39], a[208:211], v[184:187], v[36:39]
    ds_read_b64_tr_b16 a[202:203], v11 offset:51200
    v_mul_f32 v54, v19, v54
    v_mfma_f32_16x16x32_bf16 v[36:39], a[212:215], v[188:191], v[36:39]
    ds_read_b64_tr_b16 a[204:205], v11 offset:53248
    v_mul_f32 v55, v19, v55
    v_mfma_f32_16x16x32_bf16 v[32:35], a[212:215], v[180:183], v[32:35]
    s_waitcnt lgkmcnt(3)
    ds_read_b64_tr_b16 a[206:207], v11 offset:55296
    v_cvt_pk_bf16_f32 v52, v52, v53
    v_mfma_f32_16x16x32_bf16 v[32:35], a[208:211], v[176:179], v[32:35]
    v_cvt_pk_bf16_f32 v53, v54, v55
    v_accvgpr_write_b32 a28, v52
    v_mfma_f32_16x16x32_bf16 v[28:31], a[208:211], v[168:171], v[28:31]
    v_accvgpr_write_b32 a29, v53
    v_mfma_f32_16x16x32_bf16 v[28:31], a[212:215], v[172:175], v[28:31]
    v_mfma_f32_16x16x32_bf16 v[24:27], a[212:215], v[164:167], v[24:27]
    v_mfma_f32_16x16x32_bf16 v[24:27], a[208:211], v[160:163], v[24:27]
    ds_read_b64_tr_b16 a[208:209], v11 offset:57344
    v_mfma_f32_16x16x32_bf16 v[24:27], a[184:187], v[192:195], v[24:27]
    ds_read_b64_tr_b16 a[210:211], v11 offset:59392
    v_mfma_f32_16x16x32_bf16 v[24:27], a[188:191], v[196:199], v[24:27]
    ds_read_b64_tr_b16 a[212:213], v11 offset:61440
    v_mfma_f32_16x16x32_bf16 v[28:31], a[188:191], v[204:207], v[28:31]
    ds_read_b64_tr_b16 a[214:215], v11 offset:63488
    v_subrev_u32 v11, 73728, v11
    v_mfma_f32_16x16x32_bf16 v[28:31], a[184:187], v[200:203], v[28:31]
    s_add_u32 s39, s40, 256
    v_mfma_f32_16x16x32_bf16 v[32:35], a[184:187], v[208:211], v[32:35]
    v_mfma_f32_16x16x32_bf16 v[32:35], a[188:191], v[212:215], v[32:35]
    s_add_u32 m0, s63, 73728
    v_mfma_f32_16x16x32_bf16 v[36:39], a[188:191], v[220:223], v[36:39]
    v_mfma_f32_16x16x32_bf16 v[36:39], a[184:187], v[216:219], v[36:39]
    v_mfma_f32_16x16x32_bf16 v[36:39], a[192:195], v[248:251], v[36:39]
    v_mfma_f32_16x16x32_bf16 v[36:39], a[196:199], v[252:255], v[36:39]
    s_waitcnt vmcnt(17) lgkmcnt(0)
    v_mfma_f32_16x16x32_bf16 v[32:35], a[196:199], v[244:247], v[32:35]
    s_barrier
    v_mfma_f32_16x16x32_bf16 v[32:35], a[192:195], v[240:243], v[32:35]
    buffer_load_dwordx4 v6, s[16:19], s39 offen lds
    v_mfma_f32_16x16x32_bf16 v[28:31], a[192:195], v[232:235], v[28:31]
    s_add_u32 s39, s40, 12544
    ds_read_b64_tr_b16 a[184:185], v8 offset:49152
    v_mfma_f32_16x16x32_bf16 v[28:31], a[196:199], v[236:239], v[28:31]
    ds_read_b64_tr_b16 a[186:187], v8 offset:51200
    v_mfma_f32_16x16x32_bf16 v[24:27], a[196:199], v[228:231], v[24:27]
    s_addk_i32 m0, 4096
    ds_read_b64_tr_b16 a[188:189], v8 offset:53248
    v_mfma_f32_16x16x32_bf16 v[24:27], a[192:195], v[224:227], v[24:27]
    ds_read_b64_tr_b16 a[190:191], v8 offset:55296
    v_mfma_f32_16x16x32_bf16 v[24:27], a[200:203], v[56:59], v[24:27]
    ds_read_b64_tr_b16 a[192:193], v8 offset:57344
    v_mfma_f32_16x16x32_bf16 v[24:27], a[204:207], v[60:63], v[24:27]
    ds_read_b64_tr_b16 a[194:195], v8 offset:59392
    v_mfma_f32_16x16x32_bf16 v[28:31], a[204:207], v[68:71], v[28:31]
    ds_read_b64_tr_b16 a[196:197], v8 offset:61440
    v_mfma_f32_16x16x32_bf16 v[28:31], a[200:203], v[64:67], v[28:31]
    ds_read_b64_tr_b16 a[198:199], v8 offset:63488
    v_mfma_f32_16x16x32_bf16 v[32:35], a[200:203], v[72:75], v[32:35]
    buffer_load_dwordx4 v6, s[16:19], s39 offen lds
    v_mfma_f32_16x16x32_bf16 v[32:35], a[204:207], v[76:79], v[32:35]
    s_add_u32 s39, s40, 24832
    v_mfma_f32_16x16x32_bf16 v[36:39], a[204:207], v[84:87], v[36:39]
    v_mfma_f32_16x16x32_bf16 v[36:39], a[200:203], v[80:83], v[36:39]
    s_addk_i32 m0, 4096
    ds_read_b64_tr_b16 a[200:201], v8 offset:0
    v_mfma_f32_16x16x32_bf16 v[36:39], a[208:211], v[112:115], v[36:39]
    ds_read_b64_tr_b16 a[202:203], v8 offset:2048
    v_mfma_f32_16x16x32_bf16 v[36:39], a[212:215], v[116:119], v[36:39]
    ds_read_b64_tr_b16 a[204:205], v8 offset:4096
    v_mfma_f32_16x16x32_bf16 v[32:35], a[212:215], v[108:111], v[32:35]
    s_waitcnt lgkmcnt(3)
    ds_read_b64_tr_b16 a[206:207], v8 offset:6144
    v_mfma_f32_16x16x32_bf16 v[32:35], a[208:211], v[104:107], v[32:35]
    v_mfma_f32_16x16x32_bf16 v[28:31], a[208:211], v[96:99], v[28:31]
    v_mfma_f32_16x16x32_bf16 v[28:31], a[212:215], v[100:103], v[28:31]
    buffer_load_dwordx4 v6, s[16:19], s39 offen lds
    v_mfma_f32_16x16x32_bf16 v[24:27], a[212:215], v[92:95], v[24:27]
    s_add_u32 s39, s40, 37120
    v_mul_f32 v36, v19, v36
    v_mfma_f32_16x16x32_bf16 v[24:27], a[208:211], v[88:91], v[24:27]
    ds_read_b64_tr_b16 a[208:209], v8 offset:8192
    v_mul_f32 v32, v18, v32
    v_mfma_f32_16x16x32_bf16 v[40:43], a[184:187], a[96:99], 0
    s_addk_i32 m0, 4096
    ds_read_b64_tr_b16 a[210:211], v8 offset:10240
    v_mul_f32 v28, v17, v28
    v_mfma_f32_16x16x32_bf16 v[40:43], a[188:191], a[100:103], v[40:43]
    ds_read_b64_tr_b16 a[212:213], v8 offset:12288
    v_mul_f32 v24, v16, v24
    v_mfma_f32_16x16x32_bf16 v[44:47], a[188:191], a[108:111], 0
    s_waitcnt vmcnt(3)
    ds_read_b64_tr_b16 a[214:215], v8 offset:14336
    v_mul_f32 v25, v16, v25
    v_mfma_f32_16x16x32_bf16 v[44:47], a[184:187], a[104:107], v[44:47]
    buffer_store_dword v4, v15, s[24:27], s76 offen sc1
    v_mfma_f32_16x16x32_bf16 v[48:51], a[184:187], a[112:115], 0
    v_mov_b32 v4, s56
    v_mul_f32 v26, v16, v26
    v_mfma_f32_16x16x32_bf16 v[48:51], a[188:191], a[116:119], v[48:51]
    s_add_u32 s56, s7, 3
    v_mul_f32 v27, v16, v27
    v_cvt_pk_bf16_f32 v24, v24, v25
    v_mfma_f32_16x16x32_bf16 v[52:55], a[188:191], a[124:127], 0
    buffer_load_dwordx4 v6, s[16:19], s39 offen lds
    v_mfma_f32_16x16x32_bf16 v[52:55], a[184:187], a[120:123], v[52:55]
    s_add_u32 s39, s40, 49408
    v_cvt_pk_bf16_f32 v25, v26, v27
    v_accvgpr_write_b32 a18, v24
    v_mfma_f32_16x16x32_bf16 v[52:55], a[192:195], v[120:123], v[52:55]
    v_accvgpr_write_b32 a19, v25
    v_mul_f32 v29, v17, v29
    v_mfma_f32_16x16x32_bf16 v[52:55], a[196:199], v[124:127], v[52:55]
    buffer_store_dwordx4 a[16:19], v14, s[20:23], s55 offen offset:0 sc1
    v_mul_f32 v30, v17, v30
    v_mfma_f32_16x16x32_bf16 v[48:51], a[196:199], a[148:151], v[48:51]
    s_addk_i32 m0, 4096
    v_mul_f32 v31, v17, v31
    v_cvt_pk_bf16_f32 v28, v28, v29
    v_mfma_f32_16x16x32_bf16 v[48:51], a[192:195], a[144:147], v[48:51]
    v_cvt_pk_bf16_f32 v29, v30, v31
    v_accvgpr_write_b32 a22, v28
    v_mfma_f32_16x16x32_bf16 v[44:47], a[192:195], a[136:139], v[44:47]
    v_accvgpr_write_b32 a23, v29
    v_mfma_f32_16x16x32_bf16 v[44:47], a[196:199], a[140:143], v[44:47]
    buffer_store_dwordx4 a[20:23], v14, s[20:23], s55 offen offset:1024 sc1
    v_mul_f32 v33, v18, v33
    v_mfma_f32_16x16x32_bf16 v[40:43], a[196:199], a[132:135], v[40:43]
    s_waitcnt lgkmcnt(0)
    v_mul_f32 v34, v18, v34
    v_mul_f32 v35, v18, v35
    v_mfma_f32_16x16x32_bf16 v[40:43], a[192:195], a[128:131], v[40:43]
    buffer_load_dwordx4 v6, s[16:19], s39 offen lds
    v_mfma_f32_16x16x32_bf16 v[40:43], a[200:203], v[128:131], v[40:43]
    s_add_u32 s39, s40, 61696
    v_cvt_pk_bf16_f32 v32, v32, v33
    v_cvt_pk_bf16_f32 v33, v34, v35
    v_mfma_f32_16x16x32_bf16 v[40:43], a[204:207], v[132:135], v[40:43]
    v_accvgpr_write_b32 a26, v32
    v_accvgpr_write_b32 a27, v33
    v_mfma_f32_16x16x32_bf16 v[44:47], a[204:207], v[140:143], v[44:47]
    buffer_store_dwordx4 a[24:27], v14, s[20:23], s55 offen offset:2048 sc1
    v_mul_f32 v37, v19, v37
    v_mfma_f32_16x16x32_bf16 v[44:47], a[200:203], v[136:139], v[44:47]
    s_addk_i32 m0, 4096
    v_mul_f32 v38, v19, v38
    v_mfma_f32_16x16x32_bf16 v[48:51], a[200:203], v[144:147], v[48:51]
    s_barrier
    v_mfma_f32_16x16x32_bf16 v[48:51], a[204:207], v[148:151], v[48:51]
    ds_read_b64_tr_b16 a[184:185], v8 offset:16384
    v_mul_f32 v39, v19, v39
    v_mfma_f32_16x16x32_bf16 v[52:55], a[204:207], v[156:159], v[52:55]
    ds_read_b64_tr_b16 a[186:187], v8 offset:18432
    v_cvt_pk_bf16_f32 v36, v36, v37
    v_mfma_f32_16x16x32_bf16 v[52:55], a[200:203], v[152:155], v[52:55]
    ds_read_b64_tr_b16 a[188:189], v8 offset:20480
    v_cvt_pk_bf16_f32 v37, v38, v39
    v_mfma_f32_16x16x32_bf16 v[52:55], a[208:211], v[184:187], v[52:55]
    buffer_load_dwordx4 v6, s[16:19], s39 offen lds
    v_mfma_f32_16x16x32_bf16 v[52:55], a[212:215], v[188:191], v[52:55]
    s_add_u32 s39, s40, 73984
    ds_read_b64_tr_b16 a[190:191], v8 offset:22528
    v_accvgpr_write_b32 a30, v36
    v_mfma_f32_16x16x32_bf16 v[48:51], a[212:215], v[180:183], v[48:51]
    ds_read_b64_tr_b16 a[192:193], v8 offset:24576
    v_accvgpr_write_b32 a31, v37
    v_mfma_f32_16x16x32_bf16 v[48:51], a[208:211], v[176:179], v[48:51]
    buffer_store_dwordx4 a[28:31], v14, s[20:23], s55 offen offset:3072 sc1
    v_mfma_f32_16x16x32_bf16 v[44:47], a[208:211], v[168:171], v[44:47]
    s_addk_i32 m0, 4096
    ds_read_b64_tr_b16 a[194:195], v8 offset:26624
    s_add_u32 s55, s55, 4096
    v_mfma_f32_16x16x32_bf16 v[44:47], a[212:215], v[172:175], v[44:47]
    s_waitcnt lgkmcnt(4)
    ds_read_b64_tr_b16 a[196:197], v8 offset:28672
    v_mfma_f32_16x16x32_bf16 v[40:43], a[212:215], v[164:167], v[40:43]
    ds_read_b64_tr_b16 a[198:199], v8 offset:30720
    v_mfma_f32_16x16x32_bf16 v[40:43], a[208:211], v[160:163], v[40:43]
    ds_read_b64_tr_b16 a[200:201], v8 offset:32768
    v_mfma_f32_16x16x32_bf16 v[40:43], a[184:187], v[192:195], v[40:43]
    s_waitcnt lgkmcnt(5)
    ds_read_b64_tr_b16 a[202:203], v8 offset:34816
    v_mfma_f32_16x16x32_bf16 v[40:43], a[188:191], v[196:199], v[40:43]
    buffer_load_dwordx4 v6, s[16:19], s39 offen lds
    v_mfma_f32_16x16x32_bf16 v[44:47], a[188:191], v[204:207], v[44:47]
    s_add_u32 s39, s40, 86272
    ds_read_b64_tr_b16 a[204:205], v8 offset:36864
    v_mfma_f32_16x16x32_bf16 v[44:47], a[184:187], v[200:203], v[44:47]
    ds_read_b64_tr_b16 a[206:207], v8 offset:38912
    v_mfma_f32_16x16x32_bf16 v[48:51], a[184:187], v[208:211], v[48:51]
    s_addk_i32 m0, 4096
    ds_read_b64_tr_b16 a[208:209], v8 offset:40960
    v_mfma_f32_16x16x32_bf16 v[48:51], a[188:191], v[212:215], v[48:51]
    s_waitcnt lgkmcnt(5)
    ds_read_b64_tr_b16 a[210:211], v8 offset:43008
    v_mfma_f32_16x16x32_bf16 v[52:55], a[188:191], v[220:223], v[52:55]
    ds_read_b64_tr_b16 a[212:213], v8 offset:45056
    v_mfma_f32_16x16x32_bf16 v[52:55], a[184:187], v[216:219], v[52:55]
    ds_read_b64_tr_b16 a[214:215], v8 offset:47104
    v_add_u32 v8, 73728, v8
    v_mfma_f32_16x16x32_bf16 v[52:55], a[192:195], v[248:251], v[52:55]
    ds_read_b64_tr_b16 a[184:185], v9 offset:49152
    v_mfma_f32_16x16x32_bf16 v[52:55], a[196:199], v[252:255], v[52:55]
    ds_read_b64_tr_b16 a[186:187], v9 offset:51200
    v_mfma_f32_16x16x32_bf16 v[48:51], a[196:199], v[244:247], v[48:51]
    buffer_load_dwordx4 v6, s[16:19], s39 offen lds
    v_mfma_f32_16x16x32_bf16 v[48:51], a[192:195], v[240:243], v[48:51]
    s_add_u32 s39, s40, 98560
    ds_read_b64_tr_b16 a[188:189], v9 offset:53248
    v_mfma_f32_16x16x32_bf16 v[44:47], a[192:195], v[232:235], v[44:47]
    s_waitcnt lgkmcnt(5)
    ds_read_b64_tr_b16 a[190:191], v9 offset:55296
    v_mfma_f32_16x16x32_bf16 v[44:47], a[196:199], v[236:239], v[44:47]
    s_addk_i32 m0, 4096
    v_mfma_f32_16x16x32_bf16 v[40:43], a[196:199], v[228:231], v[40:43]
    v_mfma_f32_16x16x32_bf16 v[40:43], a[192:195], v[224:227], v[40:43]
    ds_read_b64_tr_b16 a[192:193], v9 offset:57344
    v_mfma_f32_16x16x32_bf16 v[40:43], a[200:203], v[56:59], v[40:43]
    ds_read_b64_tr_b16 a[194:195], v9 offset:59392
    v_mfma_f32_16x16x32_bf16 v[40:43], a[204:207], v[60:63], v[40:43]
    ds_read_b64_tr_b16 a[196:197], v9 offset:61440
    v_mfma_f32_16x16x32_bf16 v[44:47], a[204:207], v[68:71], v[44:47]
    ds_read_b64_tr_b16 a[198:199], v9 offset:63488
    v_mfma_f32_16x16x32_bf16 v[44:47], a[200:203], v[64:67], v[44:47]
    buffer_load_dwordx4 v6, s[16:19], s39 offen lds
    v_mfma_f32_16x16x32_bf16 v[48:51], a[200:203], v[72:75], v[48:51]
    s_add_u32 s39, s40, 110848
    v_mfma_f32_16x16x32_bf16 v[48:51], a[204:207], v[76:79], v[48:51]
    v_mfma_f32_16x16x32_bf16 v[52:55], a[204:207], v[84:87], v[52:55]
    s_waitcnt lgkmcnt(3)
    s_addk_i32 m0, 4096
    v_mfma_f32_16x16x32_bf16 v[52:55], a[200:203], v[80:83], v[52:55]
    ds_read_b64_tr_b16 a[200:201], v9 offset:0
    v_mfma_f32_16x16x32_bf16 v[52:55], a[208:211], v[112:115], v[52:55]
    ds_read_b64_tr_b16 a[202:203], v9 offset:2048
    v_mfma_f32_16x16x32_bf16 v[52:55], a[212:215], v[116:119], v[52:55]
    ds_read_b64_tr_b16 a[204:205], v9 offset:4096
    v_mfma_f32_16x16x32_bf16 v[48:51], a[212:215], v[108:111], v[48:51]
    ds_read_b64_tr_b16 a[206:207], v9 offset:6144
    v_mfma_f32_16x16x32_bf16 v[48:51], a[208:211], v[104:107], v[48:51]
    v_mfma_f32_16x16x32_bf16 v[44:47], a[208:211], v[96:99], v[44:47]
    buffer_load_dwordx4 v6, s[16:19], s39 offen lds
    v_mfma_f32_16x16x32_bf16 v[44:47], a[212:215], v[100:103], v[44:47]
    s_add_u32 s39, s40, 123136
    v_mul_f32 v52, v19, v52
    v_mfma_f32_16x16x32_bf16 v[40:43], a[212:215], v[92:95], v[40:43]
    v_mul_f32 v53, v19, v53
    v_mfma_f32_16x16x32_bf16 v[40:43], a[208:211], v[88:91], v[40:43]
    s_addk_i32 m0, 4096
    ds_read_b64_tr_b16 a[208:209], v9 offset:8192
    v_mul_f32 v48, v18, v48
    v_mfma_f32_16x16x32_bf16 v[24:27], a[184:187], a[96:99], 0
    ds_read_b64_tr_b16 a[210:211], v9 offset:10240
    v_mul_f32 v44, v17, v44
    v_mfma_f32_16x16x32_bf16 v[24:27], a[188:191], a[100:103], v[24:27]
    ds_read_b64_tr_b16 a[212:213], v9 offset:12288
    v_mul_f32 v40, v16, v40
    v_mfma_f32_16x16x32_bf16 v[28:31], a[188:191], a[108:111], 0
    ds_read_b64_tr_b16 a[214:215], v9 offset:14336
    v_mul_f32 v41, v16, v41
    v_mfma_f32_16x16x32_bf16 v[28:31], a[184:187], a[104:107], v[28:31]
    s_waitcnt lgkmcnt(4)
    v_mul_f32 v42, v16, v42
    v_mul_f32 v43, v16, v43
    v_mfma_f32_16x16x32_bf16 v[32:35], a[184:187], a[112:115], 0
    v_cvt_pk_bf16_f32 v40, v40, v41
    v_cvt_pk_bf16_f32 v41, v42, v43
    v_mfma_f32_16x16x32_bf16 v[32:35], a[188:191], a[116:119], v[32:35]
    buffer_load_dwordx4 v6, s[16:19], s39 offen lds
    v_mfma_f32_16x16x32_bf16 v[36:39], a[188:191], a[124:127], 0
    s_add_u32 s39, s40, 135424
    v_accvgpr_write_b32 a32, v40
    v_accvgpr_write_b32 a33, v41
    v_mfma_f32_16x16x32_bf16 v[36:39], a[184:187], a[120:123], v[36:39]
    ds_read_b64_tr_b16 a[184:185], v9 offset:16384
    v_mul_f32 v45, v17, v45
    v_mfma_f32_16x16x32_bf16 v[36:39], a[192:195], v[120:123], v[36:39]
    s_addk_i32 m0, 4096
    ds_read_b64_tr_b16 a[186:187], v9 offset:18432
    v_mul_f32 v46, v17, v46
    v_mfma_f32_16x16x32_bf16 v[36:39], a[196:199], v[124:127], v[36:39]
    ds_read_b64_tr_b16 a[188:189], v9 offset:20480
    v_mul_f32 v47, v17, v47
    v_mfma_f32_16x16x32_bf16 v[32:35], a[196:199], a[148:151], v[32:35]
    ds_read_b64_tr_b16 a[190:191], v9 offset:22528
    v_cvt_pk_bf16_f32 v44, v44, v45
    v_mfma_f32_16x16x32_bf16 v[32:35], a[192:195], a[144:147], v[32:35]
    v_cvt_pk_bf16_f32 v45, v46, v47
    v_accvgpr_write_b32 a36, v44
    v_mfma_f32_16x16x32_bf16 v[28:31], a[192:195], a[136:139], v[28:31]
    v_accvgpr_write_b32 a37, v45
    v_mfma_f32_16x16x32_bf16 v[28:31], a[196:199], a[140:143], v[28:31]
    v_mul_f32 v49, v18, v49
    v_mfma_f32_16x16x32_bf16 v[24:27], a[196:199], a[132:135], v[24:27]
    buffer_load_dwordx4 v6, s[16:19], s39 offen lds
    v_mfma_f32_16x16x32_bf16 v[24:27], a[192:195], a[128:131], v[24:27]
    s_add_u32 s39, s40, 147712
    ds_read_b64_tr_b16 a[192:193], v9 offset:24576
    v_mul_f32 v50, v18, v50
    v_mfma_f32_16x16x32_bf16 v[24:27], a[200:203], v[128:131], v[24:27]
    ds_read_b64_tr_b16 a[194:195], v9 offset:26624
    v_mul_f32 v51, v18, v51
    v_mfma_f32_16x16x32_bf16 v[24:27], a[204:207], v[132:135], v[24:27]
    s_addk_i32 m0, 4096
    ds_read_b64_tr_b16 a[196:197], v9 offset:28672
    v_cvt_pk_bf16_f32 v48, v48, v49
    v_mfma_f32_16x16x32_bf16 v[28:31], a[204:207], v[140:143], v[28:31]
    s_waitcnt lgkmcnt(3)
    ds_read_b64_tr_b16 a[198:199], v9 offset:30720
    v_cvt_pk_bf16_f32 v49, v50, v51
    v_mfma_f32_16x16x32_bf16 v[28:31], a[200:203], v[136:139], v[28:31]
    v_accvgpr_write_b32 a40, v48
    v_accvgpr_write_b32 a41, v49
    v_mfma_f32_16x16x32_bf16 v[32:35], a[200:203], v[144:147], v[32:35]
    v_mul_f32 v54, v19, v54
    v_mul_f32 v55, v19, v55
    v_mfma_f32_16x16x32_bf16 v[32:35], a[204:207], v[148:151], v[32:35]
    v_cvt_pk_bf16_f32 v52, v52, v53
    v_cvt_pk_bf16_f32 v53, v54, v55
    v_mfma_f32_16x16x32_bf16 v[36:39], a[204:207], v[156:159], v[36:39]
    v_accvgpr_write_b32 a44, v52
    v_accvgpr_write_b32 a45, v53
    v_mfma_f32_16x16x32_bf16 v[36:39], a[200:203], v[152:155], v[36:39]
    buffer_load_dwordx4 v6, s[16:19], s39 offen lds
    v_mfma_f32_16x16x32_bf16 v[36:39], a[208:211], v[184:187], v[36:39]
    s_add_u32 s39, s40, 160000
    ds_read_b64_tr_b16 a[200:201], v9 offset:32768
    v_mfma_f32_16x16x32_bf16 v[36:39], a[212:215], v[188:191], v[36:39]
    s_waitcnt vmcnt(7)
    ds_read_b64_tr_b16 a[202:203], v9 offset:34816
    v_mfma_f32_16x16x32_bf16 v[32:35], a[212:215], v[180:183], v[32:35]
    buffer_store_dword v4, v15, s[24:27], s76 offen sc1
    v_mfma_f32_16x16x32_bf16 v[32:35], a[208:211], v[176:179], v[32:35]
    s_addk_i32 m0, 4096
    ds_read_b64_tr_b16 a[204:205], v9 offset:36864
    v_mfma_f32_16x16x32_bf16 v[28:31], a[208:211], v[168:171], v[28:31]
    ds_read_b64_tr_b16 a[206:207], v9 offset:38912
    v_mfma_f32_16x16x32_bf16 v[28:31], a[212:215], v[172:175], v[28:31]
    v_mov_b32 v4, s56
    v_mfma_f32_16x16x32_bf16 v[24:27], a[212:215], v[164:167], v[24:27]
    s_add_u32 s56, s7, 4
    v_mfma_f32_16x16x32_bf16 v[24:27], a[208:211], v[160:163], v[24:27]
    ds_read_b64_tr_b16 a[208:209], v9 offset:40960
    v_mfma_f32_16x16x32_bf16 v[24:27], a[184:187], v[192:195], v[24:27]
    buffer_load_dwordx4 v6, s[16:19], s39 offen lds
    v_mfma_f32_16x16x32_bf16 v[24:27], a[188:191], v[196:199], v[24:27]
    s_load_dwordx4 s[72:75], s[86:87], s5 glc
    ds_read_b64_tr_b16 a[210:211], v9 offset:43008
    s_add_u32 s39, s40, 172288
    v_mfma_f32_16x16x32_bf16 v[28:31], a[188:191], v[204:207], v[28:31]
    ds_read_b64_tr_b16 a[212:213], v9 offset:45056
    v_mfma_f32_16x16x32_bf16 v[28:31], a[184:187], v[200:203], v[28:31]
    s_waitcnt lgkmcnt(5)
    ds_read_b64_tr_b16 a[214:215], v9 offset:47104
    v_add_u32 v9, 73728, v9
    v_mfma_f32_16x16x32_bf16 v[32:35], a[184:187], v[208:211], v[32:35]
    s_add_u32 m0, s63, 131072
    v_mfma_f32_16x16x32_bf16 v[32:35], a[188:191], v[212:215], v[32:35]
    v_mfma_f32_16x16x32_bf16 v[36:39], a[188:191], v[220:223], v[36:39]
    v_mfma_f32_16x16x32_bf16 v[36:39], a[184:187], v[216:219], v[36:39]
    ds_read_b64_tr_b16 a[184:185], v10 offset:49152
    v_mfma_f32_16x16x32_bf16 v[36:39], a[192:195], v[248:251], v[36:39]
    ds_read_b64_tr_b16 a[186:187], v10 offset:51200
    v_mfma_f32_16x16x32_bf16 v[36:39], a[196:199], v[252:255], v[36:39]
    buffer_load_dwordx4 v6, s[16:19], s39 offen lds
    v_mfma_f32_16x16x32_bf16 v[32:35], a[196:199], v[244:247], v[32:35]
    s_add_u32 s39, s40, 184576
    ds_read_b64_tr_b16 a[188:189], v10 offset:53248
    v_mfma_f32_16x16x32_bf16 v[32:35], a[192:195], v[240:243], v[32:35]
    ds_read_b64_tr_b16 a[190:191], v10 offset:55296
    v_mfma_f32_16x16x32_bf16 v[28:31], a[192:195], v[232:235], v[28:31]
    s_addk_i32 m0, 4096
    v_mfma_f32_16x16x32_bf16 v[28:31], a[196:199], v[236:239], v[28:31]
    v_mfma_f32_16x16x32_bf16 v[24:27], a[196:199], v[228:231], v[24:27]
    s_waitcnt lgkmcnt(5)
    v_mfma_f32_16x16x32_bf16 v[24:27], a[192:195], v[224:227], v[24:27]
    ds_read_b64_tr_b16 a[192:193], v10 offset:57344
    v_mfma_f32_16x16x32_bf16 v[24:27], a[200:203], v[56:59], v[24:27]
    ds_read_b64_tr_b16 a[194:195], v10 offset:59392
    v_mfma_f32_16x16x32_bf16 v[24:27], a[204:207], v[60:63], v[24:27]
    ds_read_b64_tr_b16 a[196:197], v10 offset:61440
    v_mfma_f32_16x16x32_bf16 v[28:31], a[204:207], v[68:71], v[28:31]
    buffer_load_dwordx4 v6, s[16:19], s39 offen lds
    v_mfma_f32_16x16x32_bf16 v[28:31], a[200:203], v[64:67], v[28:31]
    ds_read_b64_tr_b16 a[198:199], v10 offset:63488
    v_mfma_f32_16x16x32_bf16 v[32:35], a[200:203], v[72:75], v[32:35]
    v_mov_b32 v6, s7
    v_mfma_f32_16x16x32_bf16 v[32:35], a[204:207], v[76:79], v[32:35]
    v_mfma_f32_16x16x32_bf16 v[36:39], a[204:207], v[84:87], v[36:39]
    s_waitcnt lgkmcnt(5)
    v_mfma_f32_16x16x32_bf16 v[36:39], a[200:203], v[80:83], v[36:39]
    ds_read_b64_tr_b16 a[200:201], v10 offset:0
    v_mfma_f32_16x16x32_bf16 v[36:39], a[208:211], v[112:115], v[36:39]
    ds_read_b64_tr_b16 a[202:203], v10 offset:2048
    v_mfma_f32_16x16x32_bf16 v[36:39], a[212:215], v[116:119], v[36:39]
    ds_read_b64_tr_b16 a[204:205], v10 offset:4096
    v_mfma_f32_16x16x32_bf16 v[32:35], a[212:215], v[108:111], v[32:35]
    s_add_u32 s77, s7, 1
    ds_read_b64_tr_b16 a[206:207], v10 offset:6144
    v_mfma_f32_16x16x32_bf16 v[32:35], a[208:211], v[104:107], v[32:35]
    v_mfma_f32_16x16x32_bf16 v[28:31], a[208:211], v[96:99], v[28:31]
    v_mfma_f32_16x16x32_bf16 v[28:31], a[212:215], v[100:103], v[28:31]
    v_mfma_f32_16x16x32_bf16 v[24:27], a[212:215], v[92:95], v[24:27]
    s_waitcnt lgkmcnt(5)
    v_mul_f32 v36, v19, v36
    v_mfma_f32_16x16x32_bf16 v[24:27], a[208:211], v[88:91], v[24:27]
    ds_read_b64_tr_b16 a[208:209], v10 offset:8192
    v_mfma_f32_16x16x32_bf16 v[40:43], a[184:187], a[96:99], 0
    s_lshl_b32 s42, s48, 8
    ds_read_b64_tr_b16 a[210:211], v10 offset:10240
    v_lshrrev_b32 v22, 2, v1
    v_mfma_f32_16x16x32_bf16 v[40:43], a[188:191], a[100:103], v[40:43]
    s_add_u32 s42, s42, 3932304
    ds_read_b64_tr_b16 a[212:213], v10 offset:12288
    v_min_u32 v22, 9, v22
    v_mfma_f32_16x16x32_bf16 v[44:47], a[188:191], a[108:111], 0
    ds_read_b64_tr_b16 a[214:215], v10 offset:14336
    v_mul_u32_u24 v22, 6144, v22
    v_mfma_f32_16x16x32_bf16 v[44:47], a[184:187], a[104:107], v[44:47]
    v_and_b32 v23, 3, v1
    v_lshl_add_u32 v22, v23, 2, v22
    v_mfma_f32_16x16x32_bf16 v[48:51], a[184:187], a[112:115], 0
    buffer_load_dword v23, v22, s[24:27], s42 offen sc1
    v_mfma_f32_16x16x32_bf16 v[48:51], a[188:191], a[116:119], v[48:51]
    v_mul_f32 v24, v16, v24
    v_mul_f32 v25, v16, v25
    v_mfma_f32_16x16x32_bf16 v[52:55], a[188:191], a[124:127], 0
    s_waitcnt lgkmcnt(5)
    v_mul_f32 v26, v16, v26
    v_mul_f32 v27, v16, v27
    v_mfma_f32_16x16x32_bf16 v[52:55], a[184:187], a[120:123], v[52:55]
    ds_read_b64_tr_b16 a[184:185], v10 offset:16384
    v_cvt_pk_bf16_f32 v24, v24, v25
    v_mfma_f32_16x16x32_bf16 v[52:55], a[192:195], v[120:123], v[52:55]
    ds_read_b64_tr_b16 a[186:187], v10 offset:18432
    v_cvt_pk_bf16_f32 v25, v26, v27
    v_mfma_f32_16x16x32_bf16 v[52:55], a[196:199], v[124:127], v[52:55]
    ds_read_b64_tr_b16 a[188:189], v10 offset:20480
    v_accvgpr_write_b32 a34, v24
    v_mfma_f32_16x16x32_bf16 v[48:51], a[196:199], a[148:151], v[48:51]
    ds_read_b64_tr_b16 a[190:191], v10 offset:22528
    v_accvgpr_write_b32 a35, v25
    v_mfma_f32_16x16x32_bf16 v[48:51], a[192:195], a[144:147], v[48:51]
    buffer_store_dwordx4 a[32:35], v14, s[20:23], s55 offen offset:0 sc1
    v_mul_f32 v28, v17, v28
    v_mfma_f32_16x16x32_bf16 v[44:47], a[192:195], a[136:139], v[44:47]
    v_mul_f32 v29, v17, v29
    v_mul_f32 v30, v17, v30
    v_mfma_f32_16x16x32_bf16 v[44:47], a[196:199], a[140:143], v[44:47]
    v_mul_f32 v31, v17, v31
    v_cvt_pk_bf16_f32 v28, v28, v29
    v_mfma_f32_16x16x32_bf16 v[40:43], a[196:199], a[132:135], v[40:43]
    s_waitcnt lgkmcnt(5)
    v_cvt_pk_bf16_f32 v29, v30, v31
    v_accvgpr_write_b32 a38, v28
    v_mfma_f32_16x16x32_bf16 v[40:43], a[192:195], a[128:131], v[40:43]
    s_sub_u32 s78, s72, s77
    ds_read_b64_tr_b16 a[192:193], v10 offset:24576
    v_accvgpr_write_b32 a39, v29
    v_mfma_f32_16x16x32_bf16 v[40:43], a[200:203], v[128:131], v[40:43]
    buffer_store_dwordx4 a[36:39], v14, s[20:23], s55 offen offset:1024 sc1
    v_mul_f32 v32, v18, v32
    v_mfma_f32_16x16x32_bf16 v[40:43], a[204:207], v[132:135], v[40:43]
    s_sub_u32 s79, s73, s77
    ds_read_b64_tr_b16 a[194:195], v10 offset:26624
    v_mul_f32 v33, v18, v33
    v_mfma_f32_16x16x32_bf16 v[44:47], a[204:207], v[140:143], v[44:47]
    s_max_u32 s78, s78, s79
    ds_read_b64_tr_b16 a[196:197], v10 offset:28672
    v_mul_f32 v34, v18, v34
    v_mfma_f32_16x16x32_bf16 v[44:47], a[200:203], v[136:139], v[44:47]
    s_sub_u32 s79, s74, s77
    ds_read_b64_tr_b16 a[198:199], v10 offset:30720
    v_mul_f32 v35, v18, v35
    v_mfma_f32_16x16x32_bf16 v[48:51], a[200:203], v[144:147], v[48:51]
    s_max_u32 s78, s78, s79
    v_cvt_pk_bf16_f32 v32, v32, v33
    v_cvt_pk_bf16_f32 v33, v34, v35
    v_mfma_f32_16x16x32_bf16 v[48:51], a[204:207], v[148:151], v[48:51]
    s_sub_u32 s79, s75, s77
    v_accvgpr_write_b32 a42, v32
    v_accvgpr_write_b32 a43, v33
    v_mfma_f32_16x16x32_bf16 v[52:55], a[204:207], v[156:159], v[52:55]
    buffer_store_dwordx4 a[40:43], v14, s[20:23], s55 offen offset:2048 sc1
    v_mul_f32 v37, v19, v37
    v_mfma_f32_16x16x32_bf16 v[52:55], a[200:203], v[152:155], v[52:55]
    s_waitcnt lgkmcnt(3)
    ds_read_b64_tr_b16 a[200:201], v10 offset:32768
    v_mul_f32 v38, v19, v38
    v_mfma_f32_16x16x32_bf16 v[52:55], a[208:211], v[184:187], v[52:55]
    s_max_u32 s78, s78, s79
    ds_read_b64_tr_b16 a[202:203], v10 offset:34816
    v_mul_f32 v39, v19, v39
    v_mfma_f32_16x16x32_bf16 v[52:55], a[212:215], v[188:191], v[52:55]
    s_cmp_gt_u32 s78, 5
    s_cbranch_scc1 spin_o0
spin_o0_ret:
    v_cvt_pk_bf16_f32 v36, v36, v37
    v_mfma_f32_16x16x32_bf16 v[48:51], a[212:215], v[180:183], v[48:51]
    s_add_u32 s37, s59, 0
    ds_read_b64_tr_b16 a[204:205], v10 offset:36864
    v_cvt_pk_bf16_f32 v37, v38, v39
    v_mfma_f32_16x16x32_bf16 v[48:51], a[208:211], v[176:179], v[48:51]
    buffer_load_dwordx4 a[216:219], v14, s[20:23], s37 offen offset:0 sc1
    v_mfma_f32_16x16x32_bf16 v[44:47], a[208:211], v[168:171], v[44:47]
    ds_read_b64_tr_b16 a[206:207], v10 offset:38912
    v_accvgpr_write_b32 a46, v36
    v_mfma_f32_16x16x32_bf16 v[44:47], a[212:215], v[172:175], v[44:47]
    v_accvgpr_write_b32 a47, v37
    v_mfma_f32_16x16x32_bf16 v[40:43], a[212:215], v[164:167], v[40:43]
    buffer_store_dwordx4 a[44:47], v14, s[20:23], s55 offen offset:3072 sc1
    v_mfma_f32_16x16x32_bf16 v[40:43], a[208:211], v[160:163], v[40:43]
pg_10:
    s_cbranch_execz pg_14
    s_add_u32 s55, s55, 4096
    ds_read_b64_tr_b16 a[208:209], v10 offset:40960
    v_mfma_f32_16x16x32_bf16 v[40:43], a[184:187], v[192:195], v[40:43]
    ds_read_b64_tr_b16 a[210:211], v10 offset:43008
    v_mfma_f32_16x16x32_bf16 v[40:43], a[188:191], v[196:199], v[40:43]
    buffer_load_dwordx4 a[220:223], v14, s[20:23], s37 offen offset:1024 sc1
    v_mfma_f32_16x16x32_bf16 v[44:47], a[188:191], v[204:207], v[44:47]
    ds_read_b64_tr_b16 a[212:213], v10 offset:45056
    v_mfma_f32_16x16x32_bf16 v[44:47], a[184:187], v[200:203], v[44:47]
    ds_read_b64_tr_b16 a[214:215], v10 offset:47104
    v_add_u32 v10, 73728, v10
    v_mfma_f32_16x16x32_bf16 v[48:51], a[184:187], v[208:211], v[48:51]
    s_waitcnt lgkmcnt(4)
    v_mfma_f32_16x16x32_bf16 v[48:51], a[188:191], v[212:215], v[48:51]
    v_mfma_f32_16x16x32_bf16 v[52:55], a[188:191], v[220:223], v[52:55]
    v_mfma_f32_16x16x32_bf16 v[52:55], a[184:187], v[216:219], v[52:55]
    ds_read_b64_tr_b16 a[184:185], v11 offset:49152
    v_mfma_f32_16x16x32_bf16 v[52:55], a[192:195], v[248:251], v[52:55]
    ds_read_b64_tr_b16 a[186:187], v11 offset:51200
    v_mfma_f32_16x16x32_bf16 v[52:55], a[196:199], v[252:255], v[52:55]
    ds_read_b64_tr_b16 a[188:189], v11 offset:53248
    v_mfma_f32_16x16x32_bf16 v[48:51], a[196:199], v[244:247], v[48:51]
    buffer_load_dwordx4 a[224:227], v14, s[20:23], s37 offen offset:2048 sc1
    v_mfma_f32_16x16x32_bf16 v[48:51], a[192:195], v[240:243], v[48:51]
    ds_read_b64_tr_b16 a[190:191], v11 offset:55296
    v_mfma_f32_16x16x32_bf16 v[44:47], a[192:195], v[232:235], v[44:47]
    v_mfma_f32_16x16x32_bf16 v[44:47], a[196:199], v[236:239], v[44:47]
    v_mfma_f32_16x16x32_bf16 v[40:43], a[196:199], v[228:231], v[40:43]
    v_mfma_f32_16x16x32_bf16 v[40:43], a[192:195], v[224:227], v[40:43]
    ds_read_b64_tr_b16 a[192:193], v11 offset:57344
    v_mfma_f32_16x16x32_bf16 v[40:43], a[200:203], v[56:59], v[40:43]
    ds_read_b64_tr_b16 a[194:195], v11 offset:59392
    v_mfma_f32_16x16x32_bf16 v[40:43], a[204:207], v[60:63], v[40:43]
    ds_read_b64_tr_b16 a[196:197], v11 offset:61440
    v_mfma_f32_16x16x32_bf16 v[44:47], a[204:207], v[68:71], v[44:47]
    s_waitcnt lgkmcnt(3)
    ds_read_b64_tr_b16 a[198:199], v11 offset:63488
    v_mfma_f32_16x16x32_bf16 v[44:47], a[200:203], v[64:67], v[44:47]
    buffer_load_dwordx4 a[228:231], v14, s[20:23], s37 offen offset:3072 sc1
    v_mfma_f32_16x16x32_bf16 v[48:51], a[200:203], v[72:75], v[48:51]
    v_mfma_f32_16x16x32_bf16 v[48:51], a[204:207], v[76:79], v[48:51]
    v_mfma_f32_16x16x32_bf16 v[52:55], a[204:207], v[84:87], v[52:55]
    v_mfma_f32_16x16x32_bf16 v[52:55], a[200:203], v[80:83], v[52:55]
    ds_read_b64_tr_b16 a[200:201], v11 offset:0
    v_mfma_f32_16x16x32_bf16 v[52:55], a[208:211], v[112:115], v[52:55]
    ds_read_b64_tr_b16 a[202:203], v11 offset:2048
    v_mfma_f32_16x16x32_bf16 v[52:55], a[212:215], v[116:119], v[52:55]
    ds_read_b64_tr_b16 a[204:205], v11 offset:4096
    v_mfma_f32_16x16x32_bf16 v[48:51], a[212:215], v[108:111], v[48:51]
    ds_read_b64_tr_b16 a[206:207], v11 offset:6144
    v_mfma_f32_16x16x32_bf16 v[48:51], a[208:211], v[104:107], v[48:51]
    v_mfma_f32_16x16x32_bf16 v[44:47], a[208:211], v[96:99], v[44:47]
    v_mfma_f32_16x16x32_bf16 v[44:47], a[212:215], v[100:103], v[44:47]
    v_mfma_f32_16x16x32_bf16 v[40:43], a[212:215], v[92:95], v[40:43]
    s_add_u32 s37, s60, 0
    v_mul_f32 v52, v19, v52
    v_mfma_f32_16x16x32_bf16 v[40:43], a[208:211], v[88:91], v[40:43]
    ds_read_b64_tr_b16 a[208:209], v11 offset:8192
    v_mfma_f32_16x16x32_bf16 v[24:27], a[184:187], a[96:99], 0
    s_waitcnt vmcnt(8)
    ds_read_b64_tr_b16 a[210:211], v11 offset:10240
    v_cmp_ne_u32 vcc, s7, v23
    v_mfma_f32_16x16x32_bf16 v[24:27], a[188:191], a[100:103], v[24:27]
    s_cbranch_vccnz spin_gu
spin_gu_ret:
    v_mul_f32 v44, v17, v44
    v_mfma_f32_16x16x32_bf16 v[28:31], a[188:191], a[108:111], 0
    ds_read_b64_tr_b16 a[212:213], v11 offset:12288
    v_mul_f32 v40, v16, v40
    v_mfma_f32_16x16x32_bf16 v[28:31], a[184:187], a[104:107], v[28:31]
    s_waitcnt lgkmcnt(3)
    ds_read_b64_tr_b16 a[214:215], v11 offset:14336
    v_mul_f32 v41, v16, v41
    v_mfma_f32_16x16x32_bf16 v[32:35], a[184:187], a[112:115], 0
    buffer_load_dwordx4 a[232:235], v14, s[20:23], s37 offen offset:0 sc1
    v_mfma_f32_16x16x32_bf16 v[32:35], a[188:191], a[116:119], v[32:35]
    v_mul_f32 v42, v16, v42
    v_mul_f32 v43, v16, v43
    v_mfma_f32_16x16x32_bf16 v[36:39], a[188:191], a[124:127], 0
    v_cvt_pk_bf16_f32 v40, v40, v41
    v_cvt_pk_bf16_f32 v41, v42, v43
    v_mfma_f32_16x16x32_bf16 v[36:39], a[184:187], a[120:123], v[36:39]
    ds_read_b64_tr_b16 a[184:185], v11 offset:16384
    v_accvgpr_write_b32 a48, v40
    v_mfma_f32_16x16x32_bf16 v[36:39], a[192:195], v[120:123], v[36:39]
    ds_read_b64_tr_b16 a[186:187], v11 offset:18432
    v_accvgpr_write_b32 a49, v41
    v_mfma_f32_16x16x32_bf16 v[36:39], a[196:199], v[124:127], v[36:39]
    ds_read_b64_tr_b16 a[188:189], v11 offset:20480
    v_mul_f32 v45, v17, v45
    v_mfma_f32_16x16x32_bf16 v[32:35], a[196:199], a[148:151], v[32:35]
    ds_read_b64_tr_b16 a[190:191], v11 offset:22528
    v_mul_f32 v46, v17, v46
    v_mfma_f32_16x16x32_bf16 v[32:35], a[192:195], a[144:147], v[32:35]
    v_mul_f32 v47, v17, v47
    v_cvt_pk_bf16_f32 v44, v44, v45
    v_mfma_f32_16x16x32_bf16 v[28:31], a[192:195], a[136:139], v[28:31]
    v_cvt_pk_bf16_f32 v45, v46, v47
    v_accvgpr_write_b32 a52, v44
    v_mfma_f32_16x16x32_bf16 v[28:31], a[196:199], a[140:143], v[28:31]
    buffer_load_dwordx4 a[236:239], v14, s[20:23], s37 offen offset:1024 sc1
    v_mfma_f32_16x16x32_bf16 v[24:27], a[196:199], a[132:135], v[24:27]
    v_accvgpr_write_b32 a53, v45
    v_mul_f32 v48, v18, v48
    v_mfma_f32_16x16x32_bf16 v[24:27], a[192:195], a[128:131], v[24:27]
    ds_read_b64_tr_b16 a[192:193], v11 offset:24576
    v_mul_f32 v49, v18, v49
    v_mfma_f32_16x16x32_bf16 v[24:27], a[200:203], v[128:131], v[24:27]
    ds_read_b64_tr_b16 a[194:195], v11 offset:26624
    v_mul_f32 v50, v18, v50
    v_mfma_f32_16x16x32_bf16 v[24:27], a[204:207], v[132:135], v[24:27]
    ds_read_b64_tr_b16 a[196:197], v11 offset:28672
    v_mul_f32 v51, v18, v51
    v_mfma_f32_16x16x32_bf16 v[28:31], a[204:207], v[140:143], v[28:31]
    s_waitcnt lgkmcnt(3)
    ds_read_b64_tr_b16 a[198:199], v11 offset:30720
    v_cvt_pk_bf16_f32 v48, v48, v49
    v_mfma_f32_16x16x32_bf16 v[28:31], a[200:203], v[136:139], v[28:31]
    v_cvt_pk_bf16_f32 v49, v50, v51
    v_accvgpr_write_b32 a56, v48
    v_mfma_f32_16x16x32_bf16 v[32:35], a[200:203], v[144:147], v[32:35]
    v_accvgpr_write_b32 a57, v49
    v_mul_f32 v53, v19, v53
    v_mfma_f32_16x16x32_bf16 v[32:35], a[204:207], v[148:151], v[32:35]
    v_mul_f32 v54, v19, v54
    v_mul_f32 v55, v19, v55
    v_mfma_f32_16x16x32_bf16 v[36:39], a[204:207], v[156:159], v[36:39]
    buffer_load_dwordx4 a[240:243], v14, s[20:23], s37 offen offset:2048 sc1
    v_mfma_f32_16x16x32_bf16 v[36:39], a[200:203], v[152:155], v[36:39]
    ds_read_b64_tr_b16 a[200:201], v11 offset:32768
    v_cvt_pk_bf16_f32 v52, v52, v53
    v_mfma_f32_16x16x32_bf16 v[36:39], a[208:211], v[184:187], v[36:39]
    ds_read_b64_tr_b16 a[202:203], v11 offset:34816
    v_cvt_pk_bf16_f32 v53, v54, v55
    v_mfma_f32_16x16x32_bf16 v[36:39], a[212:215], v[188:191], v[36:39]
    ds_read_b64_tr_b16 a[204:205], v11 offset:36864
    v_accvgpr_write_b32 a60, v52
    v_mfma_f32_16x16x32_bf16 v[32:35], a[212:215], v[180:183], v[32:35]
    s_waitcnt vmcnt(6)
    ds_read_b64_tr_b16 a[206:207], v11 offset:38912
    v_accvgpr_write_b32 a61, v53
    v_mfma_f32_16x16x32_bf16 v[32:35], a[208:211], v[176:179], v[32:35]
    buffer_store_dword v4, v15, s[24:27], s76 offen sc1
    v_mfma_f32_16x16x32_bf16 v[28:31], a[208:211], v[168:171], v[28:31]
    v_mov_b32 v4, s56
    v_mfma_f32_16x16x32_bf16 v[28:31], a[212:215], v[172:175], v[28:31]
    v_cmp_gt_u32 vcc, 16, v1
    v_mfma_f32_16x16x32_bf16 v[24:27], a[212:215], v[164:167], v[24:27]
    v_mfma_f32_16x16x32_bf16 v[24:27], a[208:211], v[160:163], v[24:27]
    buffer_load_dwordx4 a[244:247], v14, s[20:23], s37 offen offset:3072 sc1
    v_mfma_f32_16x16x32_bf16 v[24:27], a[184:187], v[192:195], v[24:27]
    ds_read_b64_tr_b16 a[208:209], v11 offset:40960
    v_mfma_f32_16x16x32_bf16 v[24:27], a[188:191], v[196:199], v[24:27]
    ds_read_b64_tr_b16 a[210:211], v11 offset:43008
    v_mfma_f32_16x16x32_bf16 v[28:31], a[188:191], v[204:207], v[28:31]
    s_add_u32 s37, s61, 0
    ds_read_b64_tr_b16 a[212:213], v11 offset:45056
    v_mfma_f32_16x16x32_bf16 v[28:31], a[184:187], v[200:203], v[28:31]
    s_waitcnt lgkmcnt(3)
    ds_read_b64_tr_b16 a[214:215], v11 offset:47104
    v_add_u32 v11, 73728, v11
    v_mfma_f32_16x16x32_bf16 v[32:35], a[184:187], v[208:211], v[32:35]
    s_add_u32 s38, s44, 81920
    s_add_u32 s36, s44, 122880
    v_mfma_f32_16x16x32_bf16 v[32:35], a[188:191], v[212:215], v[32:35]
    s_cmp_lt_u32 s3, 2
    s_cselect_b32 s38, s38, s36
    s_add_u32 m0, s63, 16384
    v_mfma_f32_16x16x32_bf16 v[36:39], a[188:191], v[220:223], v[36:39]
    v_mfma_f32_16x16x32_bf16 v[36:39], a[184:187], v[216:219], v[36:39]
    v_mfma_f32_16x16x32_bf16 v[36:39], a[192:195], v[248:251], v[36:39]
    buffer_load_dwordx4 a[152:155], v14, s[20:23], s37 offen offset:0 sc1
    v_mfma_f32_16x16x32_bf16 v[36:39], a[196:199], v[252:255], v[36:39]
    s_waitcnt lgkmcnt(0)
    v_mfma_f32_16x16x32_bf16 v[32:35], a[196:199], v[244:247], v[32:35]
    s_barrier
    v_mfma_f32_16x16x32_bf16 v[32:35], a[192:195], v[240:243], v[32:35]
    buffer_load_dwordx4 v7, s[8:11], s38 offen lds
    v_mfma_f32_16x16x32_bf16 v[28:31], a[192:195], v[232:235], v[28:31]
    ds_read_b64_tr_b16 a[184:185], v8 offset:0
    v_mfma_f32_16x16x32_bf16 v[28:31], a[196:199], v[236:239], v[28:31]
    ds_read_b64_tr_b16 a[186:187], v8 offset:2048
    v_mfma_f32_16x16x32_bf16 v[24:27], a[196:199], v[228:231], v[24:27]
    ds_read_b64_tr_b16 a[188:189], v8 offset:4096
    v_mfma_f32_16x16x32_bf16 v[24:27], a[192:195], v[224:227], v[24:27]
    s_add_u32 s38, s44, 81920
    ds_read_b64_tr_b16 a[190:191], v8 offset:6144
    v_mfma_f32_16x16x32_bf16 v[24:27], a[200:203], v[56:59], v[24:27]
    ds_read_b64_tr_b16 a[192:193], v8 offset:8192
    v_mfma_f32_16x16x32_bf16 v[24:27], a[204:207], v[60:63], v[24:27]
    buffer_load_dwordx4 a[156:159], v14, s[20:23], s37 offen offset:1024 sc1
    v_mfma_f32_16x16x32_bf16 v[28:31], a[204:207], v[68:71], v[28:31]
    s_addk_i32 m0, -16384
    ds_read_b64_tr_b16 a[194:195], v8 offset:10240
    v_mfma_f32_16x16x32_bf16 v[28:31], a[200:203], v[64:67], v[28:31]
    ds_read_b64_tr_b16 a[196:197], v8 offset:12288
    v_mfma_f32_16x16x32_bf16 v[32:35], a[200:203], v[72:75], v[32:35]
    ds_read_b64_tr_b16 a[198:199], v8 offset:14336
    v_mfma_f32_16x16x32_bf16 v[32:35], a[204:207], v[76:79], v[32:35]
    v_mfma_f32_16x16x32_bf16 v[36:39], a[204:207], v[84:87], v[36:39]
    v_mfma_f32_16x16x32_bf16 v[36:39], a[200:203], v[80:83], v[36:39]
    buffer_load_dwordx4 v2, s[8:11], s38 offen lds
    v_mfma_f32_16x16x32_bf16 v[36:39], a[208:211], v[112:115], v[36:39]
    ds_read_b64_tr_b16 a[200:201], v8 offset:16384
    v_mfma_f32_16x16x32_bf16 v[36:39], a[212:215], v[116:119], v[36:39]
    ds_read_b64_tr_b16 a[202:203], v8 offset:18432
    v_mfma_f32_16x16x32_bf16 v[32:35], a[212:215], v[108:111], v[32:35]
    buffer_load_dwordx4 a[160:163], v14, s[20:23], s37 offen offset:2048 sc1
    v_mfma_f32_16x16x32_bf16 v[32:35], a[208:211], v[104:107], v[32:35]
    s_load_dwordx4 s[72:75], s[86:87], s5 glc
    ds_read_b64_tr_b16 a[204:205], v8 offset:20480
    s_add_u32 s38, s44, 81920
    v_mfma_f32_16x16x32_bf16 v[28:31], a[208:211], v[96:99], v[28:31]
    s_waitcnt lgkmcnt(5)
    ds_read_b64_tr_b16 a[206:207], v8 offset:22528
    v_mfma_f32_16x16x32_bf16 v[28:31], a[212:215], v[100:103], v[28:31]
    s_add_u32 m0, s63, 4096
    v_mul_f32 v32, v18, v32
    v_mul_f32 v33, v18, v33
    v_mfma_f32_16x16x32_bf16 v[24:27], a[212:215], v[92:95], v[24:27]
    v_mul_f32 v34, v18, v34
    v_mfma_f32_16x16x32_bf16 v[24:27], a[208:211], v[88:91], v[24:27]
    ds_read_b64_tr_b16 a[208:209], v8 offset:24576
    v_mfma_f32_16x16x32_bf16 v[40:43], a[184:187], a[96:99], 0
    ds_read_b64_tr_b16 a[210:211], v8 offset:26624
    v_mul_f32 v28, v17, v28
    v_mfma_f32_16x16x32_bf16 v[40:43], a[188:191], a[100:103], v[40:43]
    ds_read_b64_tr_b16 a[212:213], v8 offset:28672
    v_mul_f32 v29, v17, v29
    v_mfma_f32_16x16x32_bf16 v[44:47], a[188:191], a[108:111], 0
    ds_read_b64_tr_b16 a[214:215], v8 offset:30720
    v_mul_f32 v24, v16, v24
    v_mfma_f32_16x16x32_bf16 v[44:47], a[184:187], a[104:107], v[44:47]
    buffer_load_dwordx4 a[164:167], v14, s[20:23], s37 offen offset:3072 sc1
    v_mfma_f32_16x16x32_bf16 v[48:51], a[184:187], a[112:115], 0
    buffer_load_dwordx4 v3, s[8:11], s38 offen lds
    v_mfma_f32_16x16x32_bf16 v[48:51], a[188:191], a[116:119], v[48:51]
    v_mul_f32 v25, v16, v25
    v_mul_f32 v26, v16, v26
    v_mfma_f32_16x16x32_bf16 v[52:55], a[188:191], a[124:127], 0
    s_waitcnt lgkmcnt(5)
    v_mul_f32 v27, v16, v27
    v_cvt_pk_bf16_f32 v24, v24, v25
    v_mfma_f32_16x16x32_bf16 v[52:55], a[184:187], a[120:123], v[52:55]
    s_add_u32 s38, s44, 122880
    ds_read_b64_tr_b16 a[184:185], v8 offset:32768
    v_cvt_pk_bf16_f32 v25, v26, v27
    v_mfma_f32_16x16x32_bf16 v[52:55], a[192:195], v[120:123], v[52:55]
    ds_read_b64_tr_b16 a[186:187], v8 offset:34816
    v_accvgpr_write_b32 a50, v24
    v_mfma_f32_16x16x32_bf16 v[52:55], a[196:199], v[124:127], v[52:55]
    s_addk_i32 m0, 4096
    ds_read_b64_tr_b16 a[188:189], v8 offset:36864
    v_accvgpr_write_b32 a51, v25
    v_mfma_f32_16x16x32_bf16 v[48:51], a[196:199], a[148:151], v[48:51]
    buffer_store_dwordx4 a[48:51], v14, s[20:23], s55 offen offset:0 sc1
    v_mul_f32 v30, v17, v30
    v_mfma_f32_16x16x32_bf16 v[48:51], a[192:195], a[144:147], v[48:51]
    ds_read_b64_tr_b16 a[190:191], v8 offset:38912
    v_mul_f32 v31, v17, v31
    v_mfma_f32_16x16x32_bf16 v[44:47], a[192:195], a[136:139], v[44:47]
    v_cvt_pk_bf16_f32 v28, v28, v29
    v_cvt_pk_bf16_f32 v29, v30, v31
    v_mfma_f32_16x16x32_bf16 v[44:47], a[196:199], a[140:143], v[44:47]
    v_accvgpr_write_b32 a54, v28
    v_accvgpr_write_b32 a55, v29
    v_mfma_f32_16x16x32_bf16 v[40:43], a[196:199], a[132:135], v[40:43]
    buffer_store_dwordx4 a[52:55], v14, s[20:23], s55 offen offset:1024 sc1
    v_mul_f32 v35, v18, v35
    v_mfma_f32_16x16x32_bf16 v[40:43], a[192:195], a[128:131], v[40:43]
    buffer_load_dwordx4 v2, s[8:11], s38 offen lds
    v_mfma_f32_16x16x32_bf16 v[40:43], a[200:203], v[128:131], v[40:43]
    s_waitcnt lgkmcnt(3)
    ds_read_b64_tr_b16 a[192:193], v8 offset:40960
    v_cvt_pk_bf16_f32 v32, v32, v33
    v_mfma_f32_16x16x32_bf16 v[40:43], a[204:207], v[132:135], v[40:43]
    ds_read_b64_tr_b16 a[194:195], v8 offset:43008
    v_cvt_pk_bf16_f32 v33, v34, v35
    v_mfma_f32_16x16x32_bf16 v[44:47], a[204:207], v[140:143], v[44:47]
    ds_read_b64_tr_b16 a[196:197], v8 offset:45056
    v_accvgpr_write_b32 a58, v32
    v_mfma_f32_16x16x32_bf16 v[44:47], a[200:203], v[136:139], v[44:47]
    s_add_u32 s38, s44, 122880
    ds_read_b64_tr_b16 a[198:199], v8 offset:47104
    v_accvgpr_write_b32 a59, v33
    v_mfma_f32_16x16x32_bf16 v[48:51], a[200:203], v[144:147], v[48:51]
    buffer_store_dwordx4 a[56:59], v14, s[20:23], s55 offen offset:2048 sc1
    v_mul_f32 v36, v19, v36
    v_mfma_f32_16x16x32_bf16 v[48:51], a[204:207], v[148:151], v[48:51]
    s_addk_i32 m0, 4096
    v_mul_f32 v37, v19, v37
    v_mul_f32 v38, v19, v38
    v_mfma_f32_16x16x32_bf16 v[52:55], a[204:207], v[156:159], v[52:55]
    v_mul_f32 v39, v19, v39
    v_cvt_pk_bf16_f32 v36, v36, v37
    v_mfma_f32_16x16x32_bf16 v[52:55], a[200:203], v[152:155], v[52:55]
    ds_read_b64_tr_b16 a[200:201], v8 offset:49152
    v_cvt_pk_bf16_f32 v37, v38, v39
    v_mfma_f32_16x16x32_bf16 v[52:55], a[208:211], v[184:187], v[52:55]
    ds_read_b64_tr_b16 a[202:203], v8 offset:51200
    v_accvgpr_write_b32 a62, v36
    v_mfma_f32_16x16x32_bf16 v[52:55], a[212:215], v[188:191], v[52:55]
    ds_read_b64_tr_b16 a[204:205], v8 offset:53248
    v_accvgpr_write_b32 a63, v37
    v_mfma_f32_16x16x32_bf16 v[48:51], a[212:215], v[180:183], v[48:51]
    buffer_store_dwordx4 a[60:63], v14, s[20:23], s55 offen offset:3072 sc1
    v_mfma_f32_16x16x32_bf16 v[48:51], a[208:211], v[176:179], v[48:51]
    buffer_load_dwordx4 v3, s[8:11], s38 offen lds
    v_mfma_f32_16x16x32_bf16 v[44:47], a[208:211], v[168:171], v[44:47]
    s_add_u32 s55, s55, 4096
    ds_read_b64_tr_b16 a[206:207], v8 offset:55296
    v_mfma_f32_16x16x32_bf16 v[44:47], a[212:215], v[172:175], v[44:47]
    s_waitcnt lgkmcnt(6)
    v_mfma_f32_16x16x32_bf16 v[40:43], a[212:215], v[164:167], v[40:43]
    s_add_u32 s77, s7, 2
    v_mfma_f32_16x16x32_bf16 v[40:43], a[208:211], v[160:163], v[40:43]
    s_add_u32 s38, s44, 163840
    ds_read_b64_tr_b16 a[208:209], v8 offset:57344
    s_add_u32 s36, s45, 0
    v_mfma_f32_16x16x32_bf16 v[40:43], a[184:187], v[192:195], v[40:43]
    s_cmp_lt_u32 s3, 2
    s_cselect_b32 s38, s38, s36
    v_mfma_f32_16x16x32_bf16 v[40:43], a[188:191], v[196:199], v[40:43]
    s_addk_i32 m0, 24576
    ds_read_b64_tr_b16 a[210:211], v8 offset:59392
    v_mfma_f32_16x16x32_bf16 v[44:47], a[188:191], v[204:207], v[44:47]
    ds_read_b64_tr_b16 a[212:213], v8 offset:61440
    v_mfma_f32_16x16x32_bf16 v[44:47], a[184:187], v[200:203], v[44:47]
    ds_read_b64_tr_b16 a[214:215], v8 offset:63488
    v_add_u32 v8, 65536, v8
    v_mfma_f32_16x16x32_bf16 v[48:51], a[184:187], v[208:211], v[48:51]
    v_mfma_f32_16x16x32_bf16 v[48:51], a[188:191], v[212:215], v[48:51]
    v_mfma_f32_16x16x32_bf16 v[52:55], a[188:191], v[220:223], v[52:55]
    s_waitcnt lgkmcnt(5)
    v_mfma_f32_16x16x32_bf16 v[52:55], a[184:187], v[216:219], v[52:55]
    buffer_load_dwordx4 v7, s[8:11], s38 offen lds
    v_mfma_f32_16x16x32_bf16 v[52:55], a[192:195], v[248:251], v[52:55]
    ds_read_b64_tr_b16 a[184:185], v9 offset:0
    v_mfma_f32_16x16x32_bf16 v[52:55], a[196:199], v[252:255], v[52:55]
    ds_read_b64_tr_b16 a[186:187], v9 offset:2048
    v_mfma_f32_16x16x32_bf16 v[48:51], a[196:199], v[244:247], v[48:51]
    ds_read_b64_tr_b16 a[188:189], v9 offset:4096
    v_mfma_f32_16x16x32_bf16 v[48:51], a[192:195], v[240:243], v[48:51]
    s_add_u32 s38, s44, 163840
    ds_read_b64_tr_b16 a[190:191], v9 offset:6144
    v_mfma_f32_16x16x32_bf16 v[44:47], a[192:195], v[232:235], v[44:47]
    v_mfma_f32_16x16x32_bf16 v[44:47], a[196:199], v[236:239], v[44:47]
    s_addk_i32 m0, -16384
    v_mfma_f32_16x16x32_bf16 v[40:43], a[196:199], v[228:231], v[40:43]
    s_waitcnt lgkmcnt(4)
    s_sub_u32 s78, s72, s77
    s_sub_u32 s79, s73, s77
    v_mfma_f32_16x16x32_bf16 v[40:43], a[192:195], v[224:227], v[40:43]
    s_max_u32 s78, s78, s79
    ds_read_b64_tr_b16 a[192:193], v9 offset:8192
    s_sub_u32 s79, s74, s77
    v_mfma_f32_16x16x32_bf16 v[40:43], a[200:203], v[56:59], v[40:43]
    s_max_u32 s78, s78, s79
    ds_read_b64_tr_b16 a[194:195], v9 offset:10240
    s_sub_u32 s79, s75, s77
    v_mfma_f32_16x16x32_bf16 v[40:43], a[204:207], v[60:63], v[40:43]
    s_max_u32 s78, s78, s79
    ds_read_b64_tr_b16 a[196:197], v9 offset:12288
    v_mfma_f32_16x16x32_bf16 v[44:47], a[204:207], v[68:71], v[44:47]
    s_cmp_gt_u32 s78, 4
    s_cbranch_scc1 spin_o1
spin_o1_ret:
    s_add_u32 s37, s59, 4096
    v_mfma_f32_16x16x32_bf16 v[44:47], a[200:203], v[64:67], v[44:47]
    buffer_load_dwordx4 v2, s[8:11], s38 offen lds
    v_mfma_f32_16x16x32_bf16 v[48:51], a[200:203], v[72:75], v[48:51]
    ds_read_b64_tr_b16 a[198:199], v9 offset:14336
    v_mfma_f32_16x16x32_bf16 v[48:51], a[204:207], v[76:79], v[48:51]
    v_mfma_f32_16x16x32_bf16 v[52:55], a[204:207], v[84:87], v[52:55]
    v_mfma_f32_16x16x32_bf16 v[52:55], a[200:203], v[80:83], v[52:55]
    s_add_u32 s38, s44, 163840
    ds_read_b64_tr_b16 a[200:201], v9 offset:16384
    v_mfma_f32_16x16x32_bf16 v[52:55], a[208:211], v[112:115], v[52:55]
    buffer_load_dwordx4 a[168:171], v14, s[20:23], s37 offen offset:0 sc1
    v_mfma_f32_16x16x32_bf16 v[52:55], a[212:215], v[116:119], v[52:55]
    s_addk_i32 m0, 4096
    ds_read_b64_tr_b16 a[202:203], v9 offset:18432
    v_mfma_f32_16x16x32_bf16 v[48:51], a[212:215], v[108:111], v[48:51]
    ds_read_b64_tr_b16 a[204:205], v9 offset:20480
    v_mfma_f32_16x16x32_bf16 v[48:51], a[208:211], v[104:107], v[48:51]
    s_waitcnt lgkmcnt(3)
    ds_read_b64_tr_b16 a[206:207], v9 offset:22528
    v_mfma_f32_16x16x32_bf16 v[44:47], a[208:211], v[96:99], v[44:47]
    v_mul_f32 v52, v19, v52
    v_mfma_f32_16x16x32_bf16 v[44:47], a[212:215], v[100:103], v[44:47]
    v_mul_f32 v53, v19, v53
    v_mfma_f32_16x16x32_bf16 v[40:43], a[212:215], v[92:95], v[40:43]
    v_mul_f32 v54, v19, v54
    v_mfma_f32_16x16x32_bf16 v[40:43], a[208:211], v[88:91], v[40:43]
    buffer_load_dwordx4 v3, s[8:11], s38 offen lds
    v_mfma_f32_16x16x32_bf16 v[24:27], a[184:187], a[96:99], 0
    ds_read_b64_tr_b16 a[208:209], v9 offset:24576
    v_mfma_f32_16x16x32_bf16 v[24:27], a[188:191], a[100:103], v[24:27]
    buffer_load_dwordx4 a[172:175], v14, s[20:23], s37 offen offset:1024 sc1
    v_mfma_f32_16x16x32_bf16 v[28:31], a[188:191], a[108:111], 0
    ds_read_b64_tr_b16 a[210:211], v9 offset:26624
    v_mul_f32 v44, v17, v44
    v_mfma_f32_16x16x32_bf16 v[28:31], a[184:187], a[104:107], v[28:31]
    s_add_u32 s38, s45, 0
    ds_read_b64_tr_b16 a[212:213], v9 offset:28672
    v_mul_f32 v40, v16, v40
    v_mfma_f32_16x16x32_bf16 v[32:35], a[184:187], a[112:115], 0
    ds_read_b64_tr_b16 a[214:215], v9 offset:30720
    v_mul_f32 v41, v16, v41
    v_mfma_f32_16x16x32_bf16 v[32:35], a[188:191], a[116:119], v[32:35]
    s_addk_i32 m0, 4096
    v_mul_f32 v42, v16, v42
    v_mul_f32 v43, v16, v43
    v_mfma_f32_16x16x32_bf16 v[36:39], a[188:191], a[124:127], 0
    v_cvt_pk_bf16_f32 v40, v40, v41
    v_cvt_pk_bf16_f32 v41, v42, v43
    v_mfma_f32_16x16x32_bf16 v[36:39], a[184:187], a[120:123], v[36:39]
    ds_read_b64_tr_b16 a[184:185], v9 offset:32768
    v_accvgpr_write_b32 a64, v40
    v_mfma_f32_16x16x32_bf16 v[36:39], a[192:195], v[120:123], v[36:39]
    ds_read_b64_tr_b16 a[186:187], v9 offset:34816
    v_accvgpr_write_b32 a65, v41
    v_mfma_f32_16x16x32_bf16 v[36:39], a[196:199], v[124:127], v[36:39]
    ds_read_b64_tr_b16 a[188:189], v9 offset:36864
    v_mul_f32 v45, v17, v45
    v_mfma_f32_16x16x32_bf16 v[32:35], a[196:199], a[148:151], v[32:35]
    s_waitcnt lgkmcnt(4)
    ds_read_b64_tr_b16 a[190:191], v9 offset:38912
    v_mul_f32 v46, v17, v46
    v_mfma_f32_16x16x32_bf16 v[32:35], a[192:195], a[144:147], v[32:35]
    buffer_load_dwordx4 a[176:179], v14, s[20:23], s37 offen offset:2048 sc1
    v_mfma_f32_16x16x32_bf16 v[28:31], a[192:195], a[136:139], v[28:31]
    buffer_load_dwordx4 v2, s[8:11], s38 offen lds
    v_mfma_f32_16x16x32_bf16 v[28:31], a[196:199], a[140:143], v[28:31]
    s_mov_b32 s12, s64
    v_mul_f32 v47, v17, v47
    v_cvt_pk_bf16_f32 v44, v44, v45
    v_mfma_f32_16x16x32_bf16 v[24:27], a[196:199], a[132:135], v[24:27]
    s_and_b32 s13, s65, 0xffff
    v_cvt_pk_bf16_f32 v45, v46, v47
    v_accvgpr_write_b32 a68, v44
    v_mfma_f32_16x16x32_bf16 v[24:27], a[192:195], a[128:131], v[24:27]
    s_add_u32 s38, s45, 0
    ds_read_b64_tr_b16 a[192:193], v9 offset:40960
    v_accvgpr_write_b32 a69, v45
    v_mfma_f32_16x16x32_bf16 v[24:27], a[200:203], v[128:131], v[24:27]
    s_mov_b32 s14, 2621440
    ds_read_b64_tr_b16 a[194:195], v9 offset:43008
    v_mul_f32 v48, v18, v48
    v_mfma_f32_16x16x32_bf16 v[24:27], a[204:207], v[132:135], v[24:27]
    s_addk_i32 m0, 4096
    ds_read_b64_tr_b16 a[196:197], v9 offset:45056
    v_mul_f32 v49, v18, v49
    v_mfma_f32_16x16x32_bf16 v[28:31], a[204:207], v[140:143], v[28:31]
    s_mov_b32 s15, 0x00020000
    ds_read_b64_tr_b16 a[198:199], v9 offset:47104
    v_mul_f32 v50, v18, v50
    v_mfma_f32_16x16x32_bf16 v[28:31], a[200:203], v[136:139], v[28:31]
    buffer_load_dwordx4 a[180:183], v14, s[20:23], s37 offen offset:3072 sc1
    v_mfma_f32_16x16x32_bf16 v[32:35], a[200:203], v[144:147], v[32:35]
    s_lshl_b32 s56, s54, 1
    v_mul_f32 v51, v18, v51
    v_cvt_pk_bf16_f32 v48, v48, v49
    v_mfma_f32_16x16x32_bf16 v[32:35], a[204:207], v[148:151], v[32:35]
    s_and_b32 s57, s53, 1
    v_cvt_pk_bf16_f32 v49, v50, v51
    v_accvgpr_write_b32 a72, v48
    v_mfma_f32_16x16x32_bf16 v[36:39], a[204:207], v[156:159], v[36:39]
    s_waitcnt lgkmcnt(3)
    v_accvgpr_write_b32 a73, v49
    v_mul_f32 v55, v19, v55
    v_mfma_f32_16x16x32_bf16 v[36:39], a[200:203], v[152:155], v[36:39]
    buffer_load_dwordx4 v3, s[8:11], s38 offen lds
    v_mfma_f32_16x16x32_bf16 v[36:39], a[208:211], v[184:187], v[36:39]
    s_waitcnt vmcnt(10)
    ds_read_b64_tr_b16 a[200:201], v9 offset:49152
    v_cvt_pk_bf16_f32 v52, v52, v53
    v_mfma_f32_16x16x32_bf16 v[36:39], a[212:215], v[188:191], v[36:39]
    buffer_store_dword v4, v15, s[24:27], s76 offen sc1
    v_mfma_f32_16x16x32_bf16 v[32:35], a[212:215], v[180:183], v[32:35]
    s_add_u32 s56, s56, s57
    ds_read_b64_tr_b16 a[202:203], v9 offset:51200
    v_cvt_pk_bf16_f32 v53, v54, v55
    v_mfma_f32_16x16x32_bf16 v[32:35], a[208:211], v[176:179], v[32:35]
    s_add_u32 s38, s46, 0
    ds_read_b64_tr_b16 a[204:205], v9 offset:53248
    v_accvgpr_write_b32 a76, v52
    v_mfma_f32_16x16x32_bf16 v[28:31], a[208:211], v[168:171], v[28:31]
    s_add_u32 s36, s47, 0
    ds_read_b64_tr_b16 a[206:207], v9 offset:55296
    v_accvgpr_write_b32 a77, v53
    v_mfma_f32_16x16x32_bf16 v[28:31], a[212:215], v[172:175], v[28:31]
    s_cmp_lt_u32 s3, 2
    s_cselect_b32 s38, s38, s36
    s_addk_i32 m0, 24576
    v_mfma_f32_16x16x32_bf16 v[24:27], a[212:215], v[164:167], v[24:27]
    s_lshl_b32 s6, s56, 5
    s_andn2_b32 s56, 2, s53
    s_lshl3_add_u32 s6, s56, s6
    v_mfma_f32_16x16x32_bf16 v[24:27], a[208:211], v[160:163], v[24:27]
    s_mul_i32 s56, s51, 320
    ds_read_b64_tr_b16 a[208:209], v9 offset:57344
    s_and_b32 s57, s51, 1
    v_mfma_f32_16x16x32_bf16 v[24:27], a[184:187], v[192:195], v[24:27]
    s_add_u32 s64, s57, s50
    ds_read_b64_tr_b16 a[210:211], v9 offset:59392
    s_lshl_b32 s64, s64, 6
    v_mfma_f32_16x16x32_bf16 v[24:27], a[188:191], v[196:199], v[24:27]
    s_add_u32 s64, s64, s56
    ds_read_b64_tr_b16 a[212:213], v9 offset:61440
    s_xor_b32 s57, s57, 1
    v_mfma_f32_16x16x32_bf16 v[28:31], a[188:191], v[204:207], v[28:31]
    s_lshl_b32 s57, s57, 8
    ds_read_b64_tr_b16 a[214:215], v9 offset:63488
    v_add_u32 v9, 65536, v9
    v_mfma_f32_16x16x32_bf16 v[28:31], a[184:187], v[200:203], v[28:31]
    s_waitcnt lgkmcnt(4)
    s_add_u32 s68, s56, s57
    v_mfma_f32_16x16x32_bf16 v[32:35], a[184:187], v[208:211], v[32:35]
    buffer_load_dwordx4 v7, s[8:11], s38 offen lds
    v_mfma_f32_16x16x32_bf16 v[32:35], a[188:191], v[212:215], v[32:35]
    s_add_u32 s56, s7, 5
    v_mov_b32 v4, s56
    v_mfma_f32_16x16x32_bf16 v[36:39], a[188:191], v[220:223], v[36:39]
    v_mfma_f32_16x16x32_bf16 v[36:39], a[184:187], v[216:219], v[36:39]
    s_add_u32 s38, s46, 0
    ds_read_b64_tr_b16 a[184:185], v10 offset:0
    v_mfma_f32_16x16x32_bf16 v[36:39], a[192:195], v[248:251], v[36:39]
    ds_read_b64_tr_b16 a[186:187], v10 offset:2048
    v_mfma_f32_16x16x32_bf16 v[36:39], a[196:199], v[252:255], v[36:39]
    s_addk_i32 m0, -16384
    ds_read_b64_tr_b16 a[188:189], v10 offset:4096
    v_mfma_f32_16x16x32_bf16 v[32:35], a[196:199], v[244:247], v[32:35]
    ds_read_b64_tr_b16 a[190:191], v10 offset:6144
    v_mfma_f32_16x16x32_bf16 v[32:35], a[192:195], v[240:243], v[32:35]
    v_mfma_f32_16x16x32_bf16 v[28:31], a[192:195], v[232:235], v[28:31]
    v_mfma_f32_16x16x32_bf16 v[28:31], a[196:199], v[236:239], v[28:31]
    v_mfma_f32_16x16x32_bf16 v[24:27], a[196:199], v[228:231], v[24:27]
    v_mfma_f32_16x16x32_bf16 v[24:27], a[192:195], v[224:227], v[24:27]
    buffer_load_dwordx4 v2, s[8:11], s38 offen lds
    v_mfma_f32_16x16x32_bf16 v[24:27], a[200:203], v[56:59], v[24:27]
    ds_read_b64_tr_b16 a[192:193], v10 offset:8192
    v_mfma_f32_16x16x32_bf16 v[24:27], a[204:207], v[60:63], v[24:27]
    ds_read_b64_tr_b16 a[194:195], v10 offset:10240
    v_mfma_f32_16x16x32_bf16 v[28:31], a[204:207], v[68:71], v[28:31]
    ds_read_b64_tr_b16 a[196:197], v10 offset:12288
    v_mfma_f32_16x16x32_bf16 v[28:31], a[200:203], v[64:67], v[28:31]
    s_waitcnt lgkmcnt(3)
    ds_read_b64_tr_b16 a[198:199], v10 offset:14336
    s_add_u32 s38, s46, 0
    v_mfma_f32_16x16x32_bf16 v[32:35], a[200:203], v[72:75], v[32:35]
    v_mfma_f32_16x16x32_bf16 v[32:35], a[204:207], v[76:79], v[32:35]
    s_addk_i32 m0, 4096
    v_mfma_f32_16x16x32_bf16 v[36:39], a[204:207], v[84:87], v[36:39]
    v_mfma_f32_16x16x32_bf16 v[36:39], a[200:203], v[80:83], v[36:39]
    ds_read_b64_tr_b16 a[200:201], v10 offset:16384
    v_mfma_f32_16x16x32_bf16 v[36:39], a[208:211], v[112:115], v[36:39]
    ds_read_b64_tr_b16 a[202:203], v10 offset:18432
    v_mfma_f32_16x16x32_bf16 v[36:39], a[212:215], v[116:119], v[36:39]
    ds_read_b64_tr_b16 a[204:205], v10 offset:20480
    v_mfma_f32_16x16x32_bf16 v[32:35], a[212:215], v[108:111], v[32:35]
    ds_read_b64_tr_b16 a[206:207], v10 offset:22528
    v_mfma_f32_16x16x32_bf16 v[32:35], a[208:211], v[104:107], v[32:35]
    buffer_load_dwordx4 v3, s[8:11], s38 offen lds
    v_mfma_f32_16x16x32_bf16 v[28:31], a[208:211], v[96:99], v[28:31]
    v_mfma_f32_16x16x32_bf16 v[28:31], a[212:215], v[100:103], v[28:31]
    v_mfma_f32_16x16x32_bf16 v[24:27], a[212:215], v[92:95], v[24:27]
    v_mul_f32 v36, v19, v36
    v_mfma_f32_16x16x32_bf16 v[24:27], a[208:211], v[88:91], v[24:27]
    s_add_u32 s38, s47, 0
    ds_read_b64_tr_b16 a[208:209], v10 offset:24576
    v_mul_f32 v32, v18, v32
    v_mfma_f32_16x16x32_bf16 v[40:43], a[184:187], a[96:99], 0
    s_mul_i32 s57, s48, 10
    ds_read_b64_tr_b16 a[210:211], v10 offset:26624
    v_lshrrev_b32 v5, 5, v1
    v_mfma_f32_16x16x32_bf16 v[40:43], a[188:191], a[100:103], v[40:43]
    s_addk_i32 m0, 4096
    ds_read_b64_tr_b16 a[212:213], v10 offset:28672
    v_lshlrev_b32 v5, 3, v5
    v_mfma_f32_16x16x32_bf16 v[44:47], a[188:191], a[108:111], 0
pg_11:
    s_cbranch_execz pg_15
    s_waitcnt lgkmcnt(3)
    ds_read_b64_tr_b16 a[214:215], v10 offset:30720
    v_bfe_u32 v22, v1, 3, 2
    v_mfma_f32_16x16x32_bf16 v[44:47], a[184:187], a[104:107], v[44:47]
    s_sub_u32 s57, s58, s57
    v_add_u32 v22, v22, v5
    v_mul_u32_u24 v22, 1280, v22
    v_mfma_f32_16x16x32_bf16 v[48:51], a[184:187], a[112:115], 0
    s_mul_i32 s62, s48, 1280
    v_lshrrev_b32 v5, 4, v1
    v_lshlrev_b32 v5, 1, v5
    v_mfma_f32_16x16x32_bf16 v[48:51], a[188:191], a[116:119], v[48:51]
    s_lshl_b32 s56, s57, 6
    v_and_b32 v23, 7, v1
    v_xor_b32 v23, v23, v5
    v_mfma_f32_16x16x32_bf16 v[52:55], a[188:191], a[124:127], 0
    s_add_u32 s62, s62, s56
    v_lshlrev_b32 v23, 4, v23
    v_add_u32 v22, v22, v23
    v_mfma_f32_16x16x32_bf16 v[52:55], a[184:187], a[120:123], v[52:55]
    buffer_load_dwordx4 v2, s[8:11], s38 offen lds
    v_mfma_f32_16x16x32_bf16 v[52:55], a[192:195], v[120:123], v[52:55]
    s_lshl_b32 s56, s3, 4
    ds_read_b64_tr_b16 a[184:185], v10 offset:32768
    v_add_u32 v23, 20480, v22
    v_mfma_f32_16x16x32_bf16 v[52:55], a[196:199], v[124:127], v[52:55]
    s_add_u32 s62, s62, s56
    ds_read_b64_tr_b16 a[186:187], v10 offset:34816
    v_mul_f32 v24, v16, v24
    v_mfma_f32_16x16x32_bf16 v[48:51], a[196:199], a[148:151], v[48:51]
    s_lshl_b32 s62, s62, 2
    ds_read_b64_tr_b16 a[188:189], v10 offset:36864
    v_mul_f32 v25, v16, v25
    v_mfma_f32_16x16x32_bf16 v[48:51], a[192:195], a[144:147], v[48:51]
    s_add_u32 s38, s47, 0
    ds_read_b64_tr_b16 a[190:191], v10 offset:38912
    v_mul_f32 v26, v16, v26
    v_mfma_f32_16x16x32_bf16 v[44:47], a[192:195], a[136:139], v[44:47]
    s_add_u32 s62, s62, 3670016
    v_mul_f32 v27, v16, v27
    v_cvt_pk_bf16_f32 v24, v24, v25
    v_mfma_f32_16x16x32_bf16 v[44:47], a[196:199], a[140:143], v[44:47]
    s_addk_i32 m0, 4096
    v_cvt_pk_bf16_f32 v25, v26, v27
    v_accvgpr_write_b32 a66, v24
    v_mfma_f32_16x16x32_bf16 v[40:43], a[196:199], a[132:135], v[40:43]
    s_lshl_b32 s41, s48, 6
    v_accvgpr_write_b32 a67, v25
    v_mul_f32 v28, v17, v28
    v_mfma_f32_16x16x32_bf16 v[40:43], a[192:195], a[128:131], v[40:43]
    buffer_store_dwordx4 a[64:67], v14, s[20:23], s55 offen offset:0 sc1
    v_mul_f32 v29, v17, v29
    v_mfma_f32_16x16x32_bf16 v[40:43], a[200:203], v[128:131], v[40:43]
    s_lshr_b32 s56, s3, 1
    ds_read_b64_tr_b16 a[192:193], v10 offset:40960
    v_mul_f32 v30, v17, v30
    v_mfma_f32_16x16x32_bf16 v[40:43], a[204:207], v[132:135], v[40:43]
    s_lshl_b32 s56, s56, 5
    ds_read_b64_tr_b16 a[194:195], v10 offset:43008
    v_mul_f32 v31, v17, v31
    v_mfma_f32_16x16x32_bf16 v[44:47], a[204:207], v[140:143], v[44:47]
    s_add_u32 s41, s41, s56
    ds_read_b64_tr_b16 a[196:197], v10 offset:45056
    v_cvt_pk_bf16_f32 v28, v28, v29
    v_mfma_f32_16x16x32_bf16 v[44:47], a[200:203], v[136:139], v[44:47]
    s_waitcnt lgkmcnt(3)
    ds_read_b64_tr_b16 a[198:199], v10 offset:47104
    v_cvt_pk_bf16_f32 v29, v30, v31
    v_mfma_f32_16x16x32_bf16 v[48:51], a[200:203], v[144:147], v[48:51]
    buffer_load_dwordx4 v3, s[8:11], s38 offen lds
    v_mfma_f32_16x16x32_bf16 v[48:51], a[204:207], v[148:151], v[48:51]
    s_and_b32 s56, s3, 1
    v_accvgpr_write_b32 a70, v28
    v_accvgpr_write_b32 a71, v29
    v_mfma_f32_16x16x32_bf16 v[52:55], a[204:207], v[156:159], v[52:55]
    buffer_store_dwordx4 a[68:71], v14, s[20:23], s55 offen offset:1024 sc1
    v_mul_f32 v33, v18, v33
    v_mfma_f32_16x16x32_bf16 v[52:55], a[200:203], v[152:155], v[52:55]
    s_lshl_b32 s56, s56, 2
    ds_read_b64_tr_b16 a[200:201], v10 offset:49152
    v_mul_f32 v34, v18, v34
    v_mfma_f32_16x16x32_bf16 v[52:55], a[208:211], v[184:187], v[52:55]
    s_add_u32 s41, s41, s56
    ds_read_b64_tr_b16 a[202:203], v10 offset:51200
    v_mul_f32 v35, v18, v35
    v_mfma_f32_16x16x32_bf16 v[52:55], a[212:215], v[188:191], v[52:55]
    s_add_u32 s56, s3, 0
    ds_read_b64_tr_b16 a[204:205], v10 offset:53248
    v_cvt_pk_bf16_f32 v32, v32, v33
    v_mfma_f32_16x16x32_bf16 v[48:51], a[212:215], v[180:183], v[48:51]
    s_min_u32 s56, s56, 9
    ds_read_b64_tr_b16 a[206:207], v10 offset:55296
    v_cvt_pk_bf16_f32 v33, v34, v35
    v_mfma_f32_16x16x32_bf16 v[48:51], a[208:211], v[176:179], v[48:51]
    s_mul_i32 s38, s56, 24576
    v_accvgpr_write_b32 a74, v32
    v_accvgpr_write_b32 a75, v33
    v_mfma_f32_16x16x32_bf16 v[44:47], a[208:211], v[168:171], v[44:47]
    buffer_store_dwordx4 a[72:75], v14, s[20:23], s55 offen offset:2048 sc1
    v_mul_f32 v37, v19, v37
    v_mfma_f32_16x16x32_bf16 v[44:47], a[212:215], v[172:175], v[44:47]
    s_lshl_b32 s56, s56, 10
    v_mul_f32 v38, v19, v38
    v_mul_f32 v39, v19, v39
    v_mfma_f32_16x16x32_bf16 v[40:43], a[212:215], v[164:167], v[40:43]
    s_add_u32 m0, s56, 61440
    v_cvt_pk_bf16_f32 v36, v36, v37
    v_cvt_pk_bf16_f32 v37, v38, v39
    v_mfma_f32_16x16x32_bf16 v[40:43], a[208:211], v[160:163], v[40:43]
    s_mul_i32 s41, s41, 1280
    ds_read_b64_tr_b16 a[208:209], v10 offset:57344
    v_accvgpr_write_b32 a78, v36
    v_mfma_f32_16x16x32_bf16 v[40:43], a[184:187], v[192:195], v[40:43]
    s_lshl_b32 s57, s57, 7
    ds_read_b64_tr_b16 a[210:211], v10 offset:59392
    v_accvgpr_write_b32 a79, v37
    v_mfma_f32_16x16x32_bf16 v[40:43], a[188:191], v[196:199], v[40:43]
    buffer_store_dwordx4 a[76:79], v14, s[20:23], s55 offen offset:3072 sc1
    v_mfma_f32_16x16x32_bf16 v[44:47], a[188:191], v[204:207], v[44:47]
    s_add_u32 s56, s3, 4
    ds_read_b64_tr_b16 a[212:213], v10 offset:61440
    s_min_u32 s56, s56, 9
    v_mfma_f32_16x16x32_bf16 v[44:47], a[184:187], v[200:203], v[44:47]
    s_waitcnt lgkmcnt(3)
    ds_read_b64_tr_b16 a[214:215], v10 offset:63488
    v_add_u32 v10, 65536, v10
    v_mfma_f32_16x16x32_bf16 v[48:51], a[184:187], v[208:211], v[48:51]
    s_add_u32 s55, s55, 4096
    s_add_u32 s41, s41, s57
    s_lshl_b32 s57, s48, 10
    v_mfma_f32_16x16x32_bf16 v[48:51], a[188:191], v[212:215], v[48:51]
    s_add_u32 s38, s38, s57
    s_add_u32 s38, s38, 3276800
    s_lshl_b32 s57, s48, 10
    v_mfma_f32_16x16x32_bf16 v[52:55], a[188:191], v[220:223], v[52:55]
    buffer_load_dwordx4 v14, s[24:27], s38 offen sc1 lds
    v_mfma_f32_16x16x32_bf16 v[52:55], a[184:187], v[216:219], v[52:55]
    s_mul_i32 s38, s56, 24576
    ds_read_b64_tr_b16 a[184:185], v11 offset:0
    s_add_u32 s38, s38, s57
    v_mfma_f32_16x16x32_bf16 v[52:55], a[192:195], v[248:251], v[52:55]
    s_add_u32 s38, s38, 3276800
    ds_read_b64_tr_b16 a[186:187], v11 offset:2048
    s_lshl_b32 s56, s56, 10
    v_mfma_f32_16x16x32_bf16 v[52:55], a[196:199], v[252:255], v[52:55]
    s_add_u32 m0, s56, 61440
    ds_read_b64_tr_b16 a[188:189], v11 offset:4096
    s_lshl_b32 s43, s3, 11
    v_mfma_f32_16x16x32_bf16 v[48:51], a[196:199], v[244:247], v[48:51]
    buffer_load_dwordx4 v14, s[24:27], s38 offen sc1 lds
    v_mfma_f32_16x16x32_bf16 v[48:51], a[192:195], v[240:243], v[48:51]
    s_add_u32 s56, s3, 8
    ds_read_b64_tr_b16 a[190:191], v11 offset:6144
    s_min_u32 s56, s56, 9
    v_mfma_f32_16x16x32_bf16 v[44:47], a[192:195], v[232:235], v[44:47]
    s_mul_i32 s38, s56, 24576
    s_lshl_b32 s57, s48, 10
    s_add_u32 s38, s38, s57
    v_mfma_f32_16x16x32_bf16 v[44:47], a[196:199], v[236:239], v[44:47]
    s_add_u32 s38, s38, 3276800
    s_lshl_b32 s56, s56, 10
    s_add_u32 m0, s56, 61440
    v_mfma_f32_16x16x32_bf16 v[40:43], a[196:199], v[228:231], v[40:43]
    s_add_u32 s56, s7, 6
    v_lshrrev_b32 v12, 2, v1
    v_mfma_f32_16x16x32_bf16 v[40:43], a[192:195], v[224:227], v[40:43]
    ds_read_b64_tr_b16 a[192:193], v11 offset:8192
    v_mfma_f32_16x16x32_bf16 v[40:43], a[200:203], v[56:59], v[40:43]
    s_load_dwordx4 s[72:75], s[86:87], s5 glc
    ds_read_b64_tr_b16 a[194:195], v11 offset:10240
    v_mfma_f32_16x16x32_bf16 v[40:43], a[204:207], v[60:63], v[40:43]
    ds_read_b64_tr_b16 a[196:197], v11 offset:12288
    v_mfma_f32_16x16x32_bf16 v[44:47], a[204:207], v[68:71], v[44:47]
    s_waitcnt lgkmcnt(5)
    ds_read_b64_tr_b16 a[198:199], v11 offset:14336
    v_mfma_f32_16x16x32_bf16 v[44:47], a[200:203], v[64:67], v[44:47]
    buffer_load_dwordx4 v14, s[24:27], s38 offen sc1 lds
    v_mfma_f32_16x16x32_bf16 v[48:51], a[200:203], v[72:75], v[48:51]
    v_lshlrev_b32 v12, 6, v12
    v_mfma_f32_16x16x32_bf16 v[48:51], a[204:207], v[76:79], v[48:51]
    v_and_b32 v21, 3, v1
    v_mfma_f32_16x16x32_bf16 v[52:55], a[204:207], v[84:87], v[52:55]
    v_lshl_add_u32 v12, v21, 3, v12
    v_mfma_f32_16x16x32_bf16 v[52:55], a[200:203], v[80:83], v[52:55]
    ds_read_b64_tr_b16 a[200:201], v11 offset:16384
    v_mfma_f32_16x16x32_bf16 v[52:55], a[208:211], v[112:115], v[52:55]
    ds_read_b64_tr_b16 a[202:203], v11 offset:18432
    v_mfma_f32_16x16x32_bf16 v[52:55], a[212:215], v[116:119], v[52:55]
    ds_read_b64_tr_b16 a[204:205], v11 offset:20480
    v_mfma_f32_16x16x32_bf16 v[48:51], a[212:215], v[108:111], v[48:51]
    ds_read_b64_tr_b16 a[206:207], v11 offset:22528
    v_mfma_f32_16x16x32_bf16 v[48:51], a[208:211], v[104:107], v[48:51]
    v_and_b32 v21, 16, v1
    v_mfma_f32_16x16x32_bf16 v[44:47], a[208:211], v[96:99], v[44:47]
    v_lshl_add_u32 v12, v21, 1, v12
    v_mfma_f32_16x16x32_bf16 v[44:47], a[212:215], v[100:103], v[44:47]
    v_mul_f32 v52, v19, v52
    v_mfma_f32_16x16x32_bf16 v[40:43], a[212:215], v[92:95], v[40:43]
    s_waitcnt lgkmcnt(5)
    v_mul_f32 v53, v19, v53
    v_mul_f32 v48, v18, v48
    v_mfma_f32_16x16x32_bf16 v[40:43], a[208:211], v[88:91], v[40:43]
    s_add_u32 s37, s60, 4096
    ds_read_b64_tr_b16 a[208:209], v11 offset:24576
    v_mul_f32 v44, v17, v44
    v_mfma_f32_16x16x32_bf16 v[24:27], a[184:187], a[96:99], 0
    ds_read_b64_tr_b16 a[210:211], v11 offset:26624
    v_mul_f32 v45, v17, v45
    v_mfma_f32_16x16x32_bf16 v[24:27], a[188:191], a[100:103], v[24:27]
    ds_read_b64_tr_b16 a[212:213], v11 offset:28672
    v_mul_f32 v40, v16, v40
    v_mfma_f32_16x16x32_bf16 v[28:31], a[188:191], a[108:111], 0
    ds_read_b64_tr_b16 a[214:215], v11 offset:30720
    v_mul_f32 v41, v16, v41
    v_mfma_f32_16x16x32_bf16 v[28:31], a[184:187], a[104:107], v[28:31]
    v_mul_f32 v42, v16, v42
    v_mul_f32 v43, v16, v43
    v_mfma_f32_16x16x32_bf16 v[32:35], a[184:187], a[112:115], 0
    buffer_load_dwordx4 a[96:99], v14, s[20:23], s37 offen offset:0 sc1
    v_mfma_f32_16x16x32_bf16 v[32:35], a[188:191], a[116:119], v[32:35]
    v_cvt_pk_bf16_f32 v40, v40, v41
    v_cvt_pk_bf16_f32 v41, v42, v43
    v_mfma_f32_16x16x32_bf16 v[36:39], a[188:191], a[124:127], 0
    s_waitcnt lgkmcnt(5)
    v_accvgpr_write_b32 a80, v40
    v_accvgpr_write_b32 a81, v41
    v_mfma_f32_16x16x32_bf16 v[36:39], a[184:187], a[120:123], v[36:39]
    ds_read_b64_tr_b16 a[184:185], v11 offset:32768
    v_mul_f32 v46, v17, v46
    v_mfma_f32_16x16x32_bf16 v[36:39], a[192:195], v[120:123], v[36:39]
    ds_read_b64_tr_b16 a[186:187], v11 offset:34816
    v_mul_f32 v47, v17, v47
    v_mfma_f32_16x16x32_bf16 v[36:39], a[196:199], v[124:127], v[36:39]
    ds_read_b64_tr_b16 a[188:189], v11 offset:36864
    v_cvt_pk_bf16_f32 v44, v44, v45
    v_mfma_f32_16x16x32_bf16 v[32:35], a[196:199], a[148:151], v[32:35]
    ds_read_b64_tr_b16 a[190:191], v11 offset:38912
    v_cvt_pk_bf16_f32 v45, v46, v47
    v_mfma_f32_16x16x32_bf16 v[32:35], a[192:195], a[144:147], v[32:35]
    v_accvgpr_write_b32 a84, v44
    v_accvgpr_write_b32 a85, v45
    v_mfma_f32_16x16x32_bf16 v[28:31], a[192:195], a[136:139], v[28:31]
    v_mul_f32 v49, v18, v49
    v_mul_f32 v50, v18, v50
    v_mfma_f32_16x16x32_bf16 v[28:31], a[196:199], a[140:143], v[28:31]
    v_mul_f32 v51, v18, v51
    v_cvt_pk_bf16_f32 v48, v48, v49
    v_mfma_f32_16x16x32_bf16 v[24:27], a[196:199], a[132:135], v[24:27]
    buffer_load_dwordx4 a[100:103], v14, s[20:23], s37 offen offset:1024 sc1
    v_mfma_f32_16x16x32_bf16 v[24:27], a[192:195], a[128:131], v[24:27]
    s_waitcnt lgkmcnt(4)
    ds_read_b64_tr_b16 a[192:193], v11 offset:40960
    v_cvt_pk_bf16_f32 v49, v50, v51
    v_mfma_f32_16x16x32_bf16 v[24:27], a[200:203], v[128:131], v[24:27]
    ds_read_b64_tr_b16 a[194:195], v11 offset:43008
    v_accvgpr_write_b32 a88, v48
    v_mfma_f32_16x16x32_bf16 v[24:27], a[204:207], v[132:135], v[24:27]
    ds_read_b64_tr_b16 a[196:197], v11 offset:45056
    v_accvgpr_write_b32 a89, v49
    v_mfma_f32_16x16x32_bf16 v[28:31], a[204:207], v[140:143], v[28:31]
    ds_read_b64_tr_b16 a[198:199], v11 offset:47104
    v_mfma_f32_16x16x32_bf16 v[28:31], a[200:203], v[136:139], v[28:31]
    v_mul_f32 v54, v19, v54
    v_mfma_f32_16x16x32_bf16 v[32:35], a[200:203], v[144:147], v[32:35]
    v_mul_f32 v55, v19, v55
    v_cvt_pk_bf16_f32 v52, v52, v53
    v_mfma_f32_16x16x32_bf16 v[32:35], a[204:207], v[148:151], v[32:35]
    v_cvt_pk_bf16_f32 v53, v54, v55
    v_accvgpr_write_b32 a92, v52
    v_mfma_f32_16x16x32_bf16 v[36:39], a[204:207], v[156:159], v[36:39]
    v_accvgpr_write_b32 a93, v53
    v_mfma_f32_16x16x32_bf16 v[36:39], a[200:203], v[152:155], v[36:39]
    ds_read_b64_tr_b16 a[200:201], v11 offset:49152
    v_mfma_f32_16x16x32_bf16 v[36:39], a[208:211], v[184:187], v[36:39]
    buffer_load_dwordx4 a[104:107], v14, s[20:23], s37 offen offset:2048 sc1
    v_mfma_f32_16x16x32_bf16 v[36:39], a[212:215], v[188:191], v[36:39]
    ds_read_b64_tr_b16 a[202:203], v11 offset:51200
    v_mfma_f32_16x16x32_bf16 v[32:35], a[212:215], v[180:183], v[32:35]
    ds_read_b64_tr_b16 a[204:205], v11 offset:53248
    v_mfma_f32_16x16x32_bf16 v[32:35], a[208:211], v[176:179], v[32:35]
    s_waitcnt lgkmcnt(5)
    ds_read_b64_tr_b16 a[206:207], v11 offset:55296
    v_mfma_f32_16x16x32_bf16 v[28:31], a[208:211], v[168:171], v[28:31]
    v_add_u32 v12, 98304, v12
    v_mfma_f32_16x16x32_bf16 v[28:31], a[212:215], v[172:175], v[28:31]
    s_waitcnt vmcnt(6)
    v_lshrrev_b32 v13, 2, v1
    v_mfma_f32_16x16x32_bf16 v[24:27], a[212:215], v[164:167], v[24:27]
    buffer_store_dword v4, v15, s[24:27], s76 offen sc1
    v_mfma_f32_16x16x32_bf16 v[24:27], a[208:211], v[160:163], v[24:27]
    ds_read_b64_tr_b16 a[208:209], v11 offset:57344
    v_mfma_f32_16x16x32_bf16 v[24:27], a[184:187], v[192:195], v[24:27]
    ds_read_b64_tr_b16 a[210:211], v11 offset:59392
    v_mfma_f32_16x16x32_bf16 v[24:27], a[188:191], v[196:199], v[24:27]
    ds_read_b64_tr_b16 a[212:213], v11 offset:61440
    v_mfma_f32_16x16x32_bf16 v[28:31], a[188:191], v[204:207], v[28:31]
    buffer_load_dwordx4 a[108:111], v14, s[20:23], s37 offen offset:3072 sc1
    v_mfma_f32_16x16x32_bf16 v[28:31], a[184:187], v[200:203], v[28:31]
    ds_read_b64_tr_b16 a[214:215], v11 offset:63488
    v_add_u32 v11, 65536, v11
    v_mfma_f32_16x16x32_bf16 v[32:35], a[184:187], v[208:211], v[32:35]
    v_lshlrev_b32 v13, 6, v13
    v_mfma_f32_16x16x32_bf16 v[32:35], a[188:191], v[212:215], v[32:35]
    v_and_b32 v21, 3, v1
    v_mfma_f32_16x16x32_bf16 v[36:39], a[188:191], v[220:223], v[36:39]
    s_waitcnt lgkmcnt(3)
    v_lshl_add_u32 v13, v21, 3, v13
    s_add_u32 s37, s61, 4096
    v_mfma_f32_16x16x32_bf16 v[36:39], a[184:187], v[216:219], v[36:39]
    v_and_b32 v21, 16, v1
    v_mfma_f32_16x16x32_bf16 v[36:39], a[192:195], v[248:251], v[36:39]
    v_lshl_add_u32 v13, v21, 1, v13
    v_mfma_f32_16x16x32_bf16 v[36:39], a[196:199], v[252:255], v[36:39]
    s_waitcnt lgkmcnt(0)
    v_xor_b32 v13, 32, v13
    v_mfma_f32_16x16x32_bf16 v[32:35], a[196:199], v[244:247], v[32:35]
    s_barrier
    v_mfma_f32_16x16x32_bf16 v[32:35], a[192:195], v[240:243], v[32:35]
    ds_read_b64_tr_b16 a[184:185], v12 offset:57344
    v_mfma_f32_16x16x32_bf16 v[28:31], a[192:195], v[232:235], v[28:31]
    buffer_load_dwordx4 a[112:115], v14, s[20:23], s37 offen offset:0 sc1
    v_mfma_f32_16x16x32_bf16 v[28:31], a[196:199], v[236:239], v[28:31]
    ds_read_b64_tr_b16 a[186:187], v12 offset:58368
    v_mfma_f32_16x16x32_bf16 v[24:27], a[196:199], v[228:231], v[24:27]
    ds_read_b64_tr_b16 a[188:189], v12 offset:59392
    v_add_u32 v13, 98304, v13
    v_mfma_f32_16x16x32_bf16 v[24:27], a[192:195], v[224:227], v[24:27]
    ds_read_b64_tr_b16 a[190:191], v12 offset:60416
    v_subrev_u32 v12, 81920, v12
    v_mfma_f32_16x16x32_bf16 v[24:27], a[200:203], v[56:59], v[24:27]
    ds_read_b64_tr_b16 a[192:193], v13 offset:57344
    v_mfma_f32_16x16x32_bf16 v[24:27], a[204:207], v[60:63], v[24:27]
    ds_read_b64_tr_b16 a[194:195], v13 offset:58368
    v_mfma_f32_16x16x32_bf16 v[28:31], a[204:207], v[68:71], v[28:31]
    ds_read_b64_tr_b16 a[196:197], v13 offset:59392
    v_mfma_f32_16x16x32_bf16 v[28:31], a[200:203], v[64:67], v[28:31]
    ds_read_b64_tr_b16 a[198:199], v13 offset:60416
    v_subrev_u32 v13, 81920, v13
    v_mfma_f32_16x16x32_bf16 v[32:35], a[200:203], v[72:75], v[32:35]
    v_mov_b32 v55, s56
    v_mfma_f32_16x16x32_bf16 v[32:35], a[204:207], v[76:79], v[32:35]
    s_lshl_b32 s56, s3, 8
    v_mfma_f32_16x16x32_bf16 v[36:39], a[204:207], v[84:87], v[36:39]
    buffer_load_dwordx4 a[116:119], v14, s[20:23], s37 offen offset:1024 sc1
    v_mfma_f32_16x16x32_bf16 v[36:39], a[200:203], v[80:83], v[36:39]
    s_add_u32 s77, s7, 3
    ds_read_b64_tr_b16 a[200:201], v8 offset:0
    v_mfma_f32_16x16x32_bf16 v[36:39], a[208:211], v[112:115], v[36:39]
    s_add_u32 s56, s56, 71680
    ds_read_b64_tr_b16 a[202:203], v8 offset:2048
    v_mfma_f32_16x16x32_bf16 v[36:39], a[212:215], v[116:119], v[36:39]
    ds_read_b64_tr_b16 a[204:205], v8 offset:8192
    v_mfma_f32_16x16x32_bf16 v[32:35], a[212:215], v[108:111], v[32:35]
    s_waitcnt lgkmcnt(3)
    ds_read_b64_tr_b16 a[206:207], v8 offset:10240
    v_mfma_f32_16x16x32_bf16 v[32:35], a[208:211], v[104:107], v[32:35]
    v_mfma_f32_16x16x32_bf16 v[28:31], a[208:211], v[96:99], v[28:31]
    v_mfma_f32_16x16x32_bf16 v[28:31], a[212:215], v[100:103], v[28:31]
    v_mfma_f32_16x16x32_bf16 v[24:27], a[212:215], v[92:95], v[24:27]
    v_mul_f32 v36, v19, v36
    v_mfma_f32_16x16x32_bf16 v[24:27], a[208:211], v[88:91], v[24:27]
    ds_read_b64_tr_b16 a[208:209], v9 offset:0
    v_mfma_f32_16x16x32_bf16 v[96:99], a[184:187], a[0:3], 0
    buffer_load_dwordx4 a[120:123], v14, s[20:23], s37 offen offset:2048 sc1
    v_mfma_f32_16x16x32_bf16 v[96:99], a[188:191], a[16:19], v[96:99]
    ds_read_b64_tr_b16 a[210:211], v9 offset:2048
    v_mul_f32 v28, v17, v28
    v_mfma_f32_16x16x32_bf16 v[104:107], a[188:191], a[20:23], 0
    ds_read_b64_tr_b16 a[212:213], v9 offset:8192
    v_mul_f32 v24, v16, v24
    v_mfma_f32_16x16x32_bf16 v[104:107], a[184:187], a[4:7], v[104:107]
    ds_read_b64_tr_b16 a[214:215], v9 offset:10240
    v_mul_f32 v25, v16, v25
    v_mfma_f32_16x16x32_bf16 v[112:115], a[184:187], a[8:11], 0
    v_mul_f32 v26, v16, v26
    v_mul_f32 v27, v16, v27
    v_mfma_f32_16x16x32_bf16 v[112:115], a[188:191], a[24:27], v[112:115]
    v_cvt_pk_bf16_f32 v24, v24, v25
    v_cvt_pk_bf16_f32 v25, v26, v27
    v_mfma_f32_16x16x32_bf16 v[120:123], a[188:191], a[28:31], 0
    v_accvgpr_write_b32 a82, v24
    v_accvgpr_write_b32 a83, v25
    v_mfma_f32_16x16x32_bf16 v[120:123], a[184:187], a[12:15], v[120:123]
    buffer_store_dwordx4 a[80:83], v14, s[20:23], s55 offen offset:0 sc1
    v_mul_f32 v29, v17, v29
    v_mfma_f32_16x16x32_bf16 v[124:127], a[192:195], a[12:15], 0
    ds_read_b64_tr_b16 a[184:185], v10 offset:0
    v_mul_f32 v30, v17, v30
    v_mfma_f32_16x16x32_bf16 v[124:127], a[196:199], a[28:31], v[124:127]
    ds_read_b64_tr_b16 a[186:187], v10 offset:2048
    v_mul_f32 v31, v17, v31
    v_mfma_f32_16x16x32_bf16 v[116:119], a[196:199], a[24:27], 0
    buffer_load_dwordx4 a[124:127], v14, s[20:23], s37 offen offset:3072 sc1
    v_mfma_f32_16x16x32_bf16 v[116:119], a[192:195], a[8:11], v[116:119]
    s_sub_u32 s78, s72, s77
    ds_read_b64_tr_b16 a[188:189], v10 offset:8192
    v_cvt_pk_bf16_f32 v28, v28, v29
    v_mfma_f32_16x16x32_bf16 v[108:111], a[192:195], a[4:7], 0
    s_waitcnt lgkmcnt(3)
    ds_read_b64_tr_b16 a[190:191], v10 offset:10240
    v_cvt_pk_bf16_f32 v29, v30, v31
    v_mfma_f32_16x16x32_bf16 v[108:111], a[196:199], a[20:23], v[108:111]
    s_sub_u32 s79, s73, s77
    v_accvgpr_write_b32 a86, v28
    v_accvgpr_write_b32 a87, v29
    v_mfma_f32_16x16x32_bf16 v[100:103], a[196:199], a[16:19], 0
    buffer_store_dwordx4 a[84:87], v14, s[20:23], s55 offen offset:1024 sc1
    v_mul_f32 v32, v18, v32
    v_mfma_f32_16x16x32_bf16 v[100:103], a[192:195], a[0:3], v[100:103]
    s_max_u32 s78, s78, s79
    ds_read_b64_tr_b16 a[192:193], v11 offset:0
    v_mul_f32 v33, v18, v33
    v_mfma_f32_16x16x32_bf16 v[128:131], a[200:203], a[0:3], 0
    s_sub_u32 s79, s74, s77
    ds_read_b64_tr_b16 a[194:195], v11 offset:2048
    v_mul_f32 v34, v18, v34
    v_mfma_f32_16x16x32_bf16 v[128:131], a[204:207], a[16:19], v[128:131]
    s_max_u32 s78, s78, s79
    ds_read_b64_tr_b16 a[196:197], v11 offset:8192
    v_mul_f32 v35, v18, v35
    v_mfma_f32_16x16x32_bf16 v[136:139], a[204:207], a[20:23], 0
    s_sub_u32 s79, s75, s77
    ds_read_b64_tr_b16 a[198:199], v11 offset:10240
    v_cvt_pk_bf16_f32 v32, v32, v33
    v_mfma_f32_16x16x32_bf16 v[136:139], a[200:203], a[4:7], v[136:139]
    s_max_u32 s78, s78, s79
    v_cvt_pk_bf16_f32 v33, v34, v35
    v_accvgpr_write_b32 a90, v32
    v_mfma_f32_16x16x32_bf16 v[144:147], a[200:203], a[8:11], 0
    s_cmp_gt_u32 s78, 3
    s_cbranch_scc1 spin_o2
spin_o2_ret:
    v_accvgpr_write_b32 a91, v33
    v_mfma_f32_16x16x32_bf16 v[144:147], a[204:207], a[24:27], v[144:147]
    buffer_store_dwordx4 a[88:91], v14, s[20:23], s55 offen offset:2048 sc1
    v_mul_f32 v37, v19, v37
    v_mfma_f32_16x16x32_bf16 v[152:155], a[204:207], a[28:31], 0
    s_add_u32 s37, s59, 8192
    v_mul_f32 v38, v19, v38
    v_mul_f32 v39, v19, v39
    v_mfma_f32_16x16x32_bf16 v[152:155], a[200:203], a[12:15], v[152:155]
    buffer_load_dwordx4 a[128:131], v14, s[20:23], s37 offen offset:0 sc1
    v_mfma_f32_16x16x32_bf16 v[156:159], a[208:211], a[12:15], 0
    ds_read_b64_tr_b16 a[200:201], v8 offset:4096
    v_cvt_pk_bf16_f32 v36, v36, v37
    v_mfma_f32_16x16x32_bf16 v[156:159], a[212:215], a[28:31], v[156:159]
    ds_read_b64_tr_b16 a[202:203], v8 offset:6144
    v_cvt_pk_bf16_f32 v37, v38, v39
    v_mfma_f32_16x16x32_bf16 v[148:151], a[212:215], a[24:27], 0
    ds_read_b64_tr_b16 a[204:205], v8 offset:12288
    v_accvgpr_write_b32 a94, v36
    v_mfma_f32_16x16x32_bf16 v[148:151], a[208:211], a[8:11], v[148:151]
    s_waitcnt lgkmcnt(3)
    ds_read_b64_tr_b16 a[206:207], v8 offset:14336
    v_subrev_u32 v8, 139264, v8
    v_mfma_f32_16x16x32_bf16 v[140:143], a[208:211], a[4:7], 0
    v_accvgpr_write_b32 a95, v37
    v_mfma_f32_16x16x32_bf16 v[140:143], a[212:215], a[20:23], v[140:143]
    buffer_store_dwordx4 a[92:95], v14, s[20:23], s55 offen offset:3072 sc1
    v_mfma_f32_16x16x32_bf16 v[132:135], a[212:215], a[16:19], 0
    buffer_load_dwordx4 a[132:135], v14, s[20:23], s37 offen offset:1024 sc1
    v_mfma_f32_16x16x32_bf16 v[132:135], a[208:211], a[0:3], v[132:135]
    s_add_u32 s55, s55, 4096
    ds_read_b64_tr_b16 a[208:209], v9 offset:4096
    v_mfma_f32_16x16x32_bf16 v[160:163], a[184:187], a[0:3], 0
    ds_read_b64_tr_b16 a[210:211], v9 offset:6144
    v_mfma_f32_16x16x32_bf16 v[160:163], a[188:191], a[16:19], v[160:163]
    ds_read_b64_tr_b16 a[212:213], v9 offset:12288
    v_mfma_f32_16x16x32_bf16 v[168:171], a[188:191], a[20:23], 0
    ds_read_b64_tr_b16 a[214:215], v9 offset:14336
    v_subrev_u32 v9, 139264, v9
    v_mfma_f32_16x16x32_bf16 v[168:171], a[184:187], a[4:7], v[168:171]
    v_mfma_f32_16x16x32_bf16 v[176:179], a[184:187], a[8:11], 0
    v_mfma_f32_16x16x32_bf16 v[176:179], a[188:191], a[24:27], v[176:179]
    v_mfma_f32_16x16x32_bf16 v[184:187], a[188:191], a[28:31], 0
    v_mfma_f32_16x16x32_bf16 v[184:187], a[184:187], a[12:15], v[184:187]
    ds_read_b64_tr_b16 a[184:185], v10 offset:4096
    v_mfma_f32_16x16x32_bf16 v[188:191], a[192:195], a[12:15], 0
    buffer_load_dwordx4 a[136:139], v14, s[20:23], s37 offen offset:2048 sc1
    v_mfma_f32_16x16x32_bf16 v[188:191], a[196:199], a[28:31], v[188:191]
    ds_read_b64_tr_b16 a[186:187], v10 offset:6144
    v_mfma_f32_16x16x32_bf16 v[180:183], a[196:199], a[24:27], 0
    ds_read_b64_tr_b16 a[188:189], v10 offset:12288
    v_mfma_f32_16x16x32_bf16 v[180:183], a[192:195], a[8:11], v[180:183]
    s_waitcnt lgkmcnt(3)
    ds_read_b64_tr_b16 a[190:191], v10 offset:14336
    v_subrev_u32 v10, 139264, v10
    v_mfma_f32_16x16x32_bf16 v[172:175], a[192:195], a[4:7], 0
    s_add_u32 m0, s43, 114688
    v_mfma_f32_16x16x32_bf16 v[172:175], a[196:199], a[20:23], v[172:175]
    v_mfma_f32_16x16x32_bf16 v[164:167], a[196:199], a[16:19], 0
    v_mfma_f32_16x16x32_bf16 v[164:167], a[192:195], a[0:3], v[164:167]
    ds_read_b64_tr_b16 a[192:193], v11 offset:4096
    v_mfma_f32_16x16x32_bf16 v[192:195], a[200:203], a[0:3], 0
    ds_read_b64_tr_b16 a[194:195], v11 offset:6144
    v_mfma_f32_16x16x32_bf16 v[192:195], a[204:207], a[16:19], v[192:195]
    ds_read_b64_tr_b16 a[196:197], v11 offset:12288
    v_mfma_f32_16x16x32_bf16 v[200:203], a[204:207], a[20:23], 0
    buffer_load_dwordx4 a[140:143], v14, s[20:23], s37 offen offset:3072 sc1
    v_mfma_f32_16x16x32_bf16 v[200:203], a[200:203], a[4:7], v[200:203]
    ds_read_b64_tr_b16 a[198:199], v11 offset:14336
    v_subrev_u32 v11, 139264, v11
    v_mfma_f32_16x16x32_bf16 v[208:211], a[200:203], a[8:11], 0
    buffer_load_dwordx4 v22, s[28:31], s41 offen lds
    v_mfma_f32_16x16x32_bf16 v[208:211], a[204:207], a[24:27], v[208:211]
    v_mfma_f32_16x16x32_bf16 v[216:219], a[204:207], a[28:31], 0
    v_add_u32 v21, 61440, v14
    v_mfma_f32_16x16x32_bf16 v[216:219], a[200:203], a[12:15], v[216:219]
    v_mfma_f32_16x16x32_bf16 v[220:223], a[208:211], a[12:15], 0
    s_addk_i32 m0, 1024
    v_mfma_f32_16x16x32_bf16 v[220:223], a[212:215], a[28:31], v[220:223]
    s_waitcnt vmcnt(18) lgkmcnt(0)
    v_mfma_f32_16x16x32_bf16 v[212:215], a[212:215], a[24:27], 0
    s_barrier
    v_mfma_f32_16x16x32_bf16 v[212:215], a[208:211], a[8:11], v[212:215]
    ds_read_b64_tr_b16 a[200:201], v12 offset:0
    v_mfma_f32_16x16x32_bf16 v[204:207], a[208:211], a[4:7], 0
    ds_read_b64_tr_b16 a[202:203], v12 offset:1024
    v_mfma_f32_16x16x32_bf16 v[204:207], a[212:215], a[20:23], v[204:207]
    ds_read_b64_tr_b16 a[204:205], v12 offset:2048
    v_mfma_f32_16x16x32_bf16 v[196:199], a[212:215], a[16:19], 0
    buffer_load_dwordx4 v23, s[28:31], s41 offen lds
    v_mfma_f32_16x16x32_bf16 v[196:199], a[208:211], a[0:3], v[196:199]
    s_mov_b64 s[28:29], 0
    ds_read_b64_tr_b16 a[206:207], v12 offset:3072
    v_mfma_f32_16x16x32_bf16 v[224:227], a[184:187], a[0:3], 0
    s_mov_b64 s[30:31], 0
    ds_read_b64_tr_b16 a[208:209], v13 offset:0
    v_mfma_f32_16x16x32_bf16 v[224:227], a[188:191], a[16:19], v[224:227]
    s_mov_b64 s[32:33], 0
    ds_read_b64_tr_b16 a[210:211], v13 offset:1024
    v_mfma_f32_16x16x32_bf16 v[232:235], a[188:191], a[20:23], 0
    s_add_u32 s38, s45, 40960
    ds_read_b64_tr_b16 a[212:213], v13 offset:2048
    s_add_u32 s36, s44, 204800
    v_mfma_f32_16x16x32_bf16 v[232:235], a[184:187], a[4:7], v[232:235]
    s_cmp_lt_u32 s3, 2
    s_cselect_b32 s38, s38, s36
    v_mfma_f32_16x16x32_bf16 v[240:243], a[184:187], a[8:11], 0
    s_add_u32 m0, s63, 90112
    ds_read_b64_tr_b16 a[214:215], v13 offset:3072
    v_mfma_f32_16x16x32_bf16 v[240:243], a[188:191], a[24:27], v[240:243]
    s_mov_b64 s[34:35], 0
    ds_read_b128 v[56:59], v21 offset:0
    v_mfma_f32_16x16x32_bf16 v[248:251], a[188:191], a[28:31], 0
    ds_read_b128 v[60:63], v21 offset:1024
    v_mfma_f32_16x16x32_bf16 v[248:251], a[184:187], a[12:15], v[248:251]
    ds_read_b128 v[64:67], v21 offset:2048
    v_mfma_f32_16x16x32_bf16 v[252:255], a[192:195], a[12:15], 0
    s_waitcnt lgkmcnt(5)
    ds_read_b64_tr_b16 a[184:185], v8 offset:0
    s_load_dwordx4 s[72:75], s[86:87], s5 glc
    v_mfma_f32_16x16x32_bf16 v[252:255], a[196:199], a[28:31], v[252:255]
    ds_read_b64_tr_b16 a[186:187], v8 offset:2048
    v_mfma_f32_16x16x32_bf16 v[244:247], a[196:199], a[24:27], 0
    buffer_load_dwordx4 v7, s[8:11], s38 offen lds
    v_mfma_f32_16x16x32_bf16 v[244:247], a[192:195], a[8:11], v[244:247]
    s_add_u32 s37, s60, 8192
    ds_read_b64_tr_b16 a[188:189], v8 offset:8192
    v_mfma_f32_16x16x32_bf16 v[236:239], a[192:195], a[4:7], 0
    ds_read_b64_tr_b16 a[190:191], v8 offset:10240
    v_mfma_f32_16x16x32_bf16 v[236:239], a[196:199], a[20:23], v[236:239]
    s_waitcnt lgkmcnt(5)
    ds_read_b128 v[68:71], v21 offset:3072
    v_add_f32 v56, v56, v60
    v_mfma_f32_16x16x32_bf16 v[228:231], a[196:199], a[16:19], 0
    s_add_u32 s38, s45, 40960
    ds_read_b128 v[72:75], v21 offset:4096
    v_add_f32 v57, v57, v61
    v_mfma_f32_16x16x32_bf16 v[228:231], a[192:195], a[0:3], v[228:231]
    s_waitcnt lgkmcnt(6)
    ds_read_b128 v[76:79], v21 offset:5120
    v_add_f32 v58, v58, v62
    v_mfma_f32_16x16x32_bf16 v[96:99], a[200:203], a[32:35], v[96:99]
    buffer_load_dwordx4 a[0:3], v14, s[20:23], s37 offen offset:0 sc1
    v_mfma_f32_16x16x32_bf16 v[96:99], a[204:207], a[48:51], v[96:99]
    s_add_u32 m0, s63, 73728
    ds_read_b64_tr_b16 a[192:193], v9 offset:0
    v_add_f32 v59, v59, v63
    v_mfma_f32_16x16x32_bf16 v[104:107], a[204:207], a[52:55], v[104:107]
    ds_read_b64_tr_b16 a[194:195], v9 offset:2048
    v_add_f32 v56, v56, v64
    v_mfma_f32_16x16x32_bf16 v[104:107], a[200:203], a[36:39], v[104:107]
pg_12:
    s_cbranch_execz pg_back
    ds_read_b64_tr_b16 a[196:197], v9 offset:8192
    v_add_f32 v57, v57, v65
    v_mfma_f32_16x16x32_bf16 v[112:115], a[200:203], a[40:43], v[112:115]
    s_waitcnt lgkmcnt(5)
    ds_read_b64_tr_b16 a[198:199], v9 offset:10240
    v_add_f32 v58, v58, v66
    v_mfma_f32_16x16x32_bf16 v[112:115], a[204:207], a[56:59], v[112:115]
    ds_read_b128 v[80:83], v21 offset:6144
    v_add_f32 v59, v59, v67
    v_mfma_f32_16x16x32_bf16 v[120:123], a[204:207], a[60:63], v[120:123]
    buffer_load_dwordx4 v2, s[8:11], s38 offen lds
    v_mfma_f32_16x16x32_bf16 v[120:123], a[200:203], a[44:47], v[120:123]
    ds_read_b128 v[84:87], v21 offset:7168
    v_add_f32 v56, v56, v68
    v_mfma_f32_16x16x32_bf16 v[124:127], a[208:211], a[44:47], v[124:127]
    s_waitcnt lgkmcnt(7)
    ds_read_b64_tr_b16 a[200:201], v10 offset:0
    v_add_f32 v57, v57, v69
    v_mfma_f32_16x16x32_bf16 v[124:127], a[212:215], a[60:63], v[124:127]
    s_waitcnt vmcnt(8)
    ds_read_b64_tr_b16 a[202:203], v10 offset:2048
    v_add_f32 v58, v58, v70
    v_mfma_f32_16x16x32_bf16 v[116:119], a[212:215], a[56:59], v[116:119]
    buffer_store_dword v55, v15, s[24:27], s76 offen sc1
    v_mfma_f32_16x16x32_bf16 v[116:119], a[208:211], a[40:43], v[116:119]
    buffer_load_dwordx4 a[4:7], v14, s[20:23], s37 offen offset:1024 sc1
    v_mfma_f32_16x16x32_bf16 v[108:111], a[208:211], a[36:39], v[108:111]
    s_add_u32 s38, s45, 40960
    ds_read_b64_tr_b16 a[204:205], v10 offset:8192
    v_add_f32 v59, v59, v71
    v_mfma_f32_16x16x32_bf16 v[108:111], a[212:215], a[52:55], v[108:111]
    s_addk_i32 m0, 4096
    ds_read_b64_tr_b16 a[206:207], v10 offset:10240
    v_add_f32 v56, v56, v72
    v_mfma_f32_16x16x32_bf16 v[100:103], a[212:215], a[48:51], v[100:103]
    s_waitcnt lgkmcnt(6)
    ds_read_b128 v[88:91], v21 offset:8192
    v_add_f32 v57, v57, v73
    v_mfma_f32_16x16x32_bf16 v[100:103], a[208:211], a[32:35], v[100:103]
    ds_read_b128 v[92:95], v21 offset:9216
    v_add_f32 v58, v58, v74
    v_mfma_f32_16x16x32_bf16 v[128:131], a[184:187], a[32:35], v[128:131]
    ds_read_b64_tr_b16 a[208:209], v11 offset:0
    v_add_f32 v59, v59, v75
    v_mfma_f32_16x16x32_bf16 v[128:131], a[188:191], a[48:51], v[128:131]
    ds_read_b64_tr_b16 a[210:211], v11 offset:2048
    v_add_f32 v56, v56, v76
    v_mfma_f32_16x16x32_bf16 v[136:139], a[188:191], a[52:55], v[136:139]
    buffer_load_dwordx4 v3, s[8:11], s38 offen lds
    v_mfma_f32_16x16x32_bf16 v[136:139], a[184:187], a[36:39], v[136:139]
    s_waitcnt lgkmcnt(7)
    ds_read_b64_tr_b16 a[212:213], v11 offset:8192
    v_add_f32 v57, v57, v77
    v_mfma_f32_16x16x32_bf16 v[144:147], a[184:187], a[40:43], v[144:147]
    buffer_load_dwordx4 a[8:11], v14, s[20:23], s37 offen offset:2048 sc1
    v_mfma_f32_16x16x32_bf16 v[144:147], a[188:191], a[56:59], v[144:147]
    ds_read_b64_tr_b16 a[214:215], v11 offset:10240
    v_add_f32 v58, v58, v78
    v_mfma_f32_16x16x32_bf16 v[152:155], a[188:191], a[60:63], v[152:155]
    s_add_u32 s38, s44, 204800
    v_add_f32 v59, v59, v79
    v_add_f32 v56, v56, v80
    v_mfma_f32_16x16x32_bf16 v[152:155], a[184:187], a[44:47], v[152:155]
    ds_read_b64_tr_b16 a[184:185], v8 offset:4096
    v_add_f32 v57, v57, v81
    v_mfma_f32_16x16x32_bf16 v[156:159], a[192:195], a[44:47], v[156:159]
    s_addk_i32 m0, 4096
    ds_read_b64_tr_b16 a[186:187], v8 offset:6144
    v_add_f32 v58, v58, v82
    v_mfma_f32_16x16x32_bf16 v[156:159], a[196:199], a[60:63], v[156:159]
    s_waitcnt lgkmcnt(6)
    ds_read_b64_tr_b16 a[188:189], v8 offset:12288
    v_add_f32 v59, v59, v83
    v_mfma_f32_16x16x32_bf16 v[148:151], a[196:199], a[56:59], v[148:151]
    ds_read_b64_tr_b16 a[190:191], v8 offset:14336
    v_add_f32 v56, v56, v84
    v_mfma_f32_16x16x32_bf16 v[148:151], a[192:195], a[40:43], v[148:151]
    v_add_f32 v57, v57, v85
    v_add_f32 v58, v58, v86
    v_mfma_f32_16x16x32_bf16 v[140:143], a[192:195], a[36:39], v[140:143]
    v_add_f32 v59, v59, v87
    v_add_f32 v56, v56, v88
    v_mfma_f32_16x16x32_bf16 v[140:143], a[196:199], a[52:55], v[140:143]
    v_add_f32 v57, v57, v89
    v_add_f32 v58, v58, v90
    v_mfma_f32_16x16x32_bf16 v[132:135], a[196:199], a[48:51], v[132:135]
    buffer_load_dwordx4 a[12:15], v14, s[20:23], s37 offen offset:3072 sc1
    v_mfma_f32_16x16x32_bf16 v[132:135], a[192:195], a[32:35], v[132:135]
    buffer_load_dwordx4 v2, s[8:11], s38 offen lds
    v_mfma_f32_16x16x32_bf16 v[160:163], a[200:203], a[32:35], v[160:163]
    ds_read_b64_tr_b16 a[192:193], v9 offset:4096
    v_add_f32 v59, v59, v91
    v_mfma_f32_16x16x32_bf16 v[160:163], a[204:207], a[48:51], v[160:163]
    ds_read_b64_tr_b16 a[194:195], v9 offset:6144
    v_add_f32 v56, v56, v92
    v_mfma_f32_16x16x32_bf16 v[168:171], a[204:207], a[52:55], v[168:171]
    s_add_u32 s37, s61, 8192
    ds_read_b64_tr_b16 a[196:197], v9 offset:12288
    v_add_f32 v57, v57, v93
    v_mfma_f32_16x16x32_bf16 v[168:171], a[200:203], a[36:39], v[168:171]
    s_waitcnt lgkmcnt(5)
    ds_read_b64_tr_b16 a[198:199], v9 offset:14336
    v_add_f32 v58, v58, v94
    v_mfma_f32_16x16x32_bf16 v[176:179], a[200:203], a[40:43], v[176:179]
    s_add_u32 s38, s44, 204800
    v_add_f32 v59, v59, v95
    v_cvt_pk_bf16_f32 v56, 0, v56
    v_mfma_f32_16x16x32_bf16 v[176:179], a[204:207], a[56:59], v[176:179]
    s_addk_i32 m0, 4096
    v_cvt_pk_bf16_f32 v57, 0, v57
    v_cvt_pk_bf16_f32 v58, 0, v58
    v_mfma_f32_16x16x32_bf16 v[184:187], a[204:207], a[60:63], v[184:187]
    v_cvt_pk_bf16_f32 v59, 0, v59
    v_mul_f32 v60, s92, v56
    v_mfma_f32_16x16x32_bf16 v[184:187], a[200:203], a[44:47], v[184:187]
    ds_read_b64_tr_b16 a[200:201], v10 offset:4096
    v_mul_f32 v61, s92, v57
    v_mfma_f32_16x16x32_bf16 v[188:191], a[208:211], a[44:47], v[188:191]
    buffer_load_dwordx4 a[16:19], v14, s[20:23], s37 offen offset:0 sc1
    v_mfma_f32_16x16x32_bf16 v[188:191], a[212:215], a[60:63], v[188:191]
    ds_read_b64_tr_b16 a[202:203], v10 offset:6144
    v_lshlrev_b32 v64, 1, v1
    v_mfma_f32_16x16x32_bf16 v[180:183], a[212:215], a[56:59], v[180:183]
    buffer_load_dwordx4 v3, s[8:11], s38 offen lds
    v_mfma_f32_16x16x32_bf16 v[180:183], a[208:211], a[40:43], v[180:183]
    ds_read_b64_tr_b16 a[204:205], v10 offset:12288
    v_add_u32 v64, s56, v64
    v_mfma_f32_16x16x32_bf16 v[172:175], a[208:211], a[36:39], v[172:175]
    ds_read_b64_tr_b16 a[206:207], v10 offset:14336
    v_and_b32 v65, 1, v1
    v_mfma_f32_16x16x32_bf16 v[172:175], a[212:215], a[52:55], v[172:175]
    v_exp_f32 v60, v60
    v_mfma_f32_16x16x32_bf16 v[164:167], a[212:215], a[48:51], v[164:167]
    s_waitcnt lgkmcnt(3)
    v_exp_f32 v61, v61
    v_mfma_f32_16x16x32_bf16 v[164:167], a[208:211], a[32:35], v[164:167]
    s_add_u32 s38, s46, 40960
    ds_read_b64_tr_b16 a[208:209], v11 offset:4096
    v_add_f32 v60, 1.0, v60
    v_mfma_f32_16x16x32_bf16 v[192:195], a[184:187], a[32:35], v[192:195]
    s_add_u32 s36, s47, 40960
    ds_read_b64_tr_b16 a[210:211], v11 offset:6144
    v_add_f32 v61, 1.0, v61
    v_mfma_f32_16x16x32_bf16 v[192:195], a[188:191], a[48:51], v[192:195]
    s_cmp_lt_u32 s3, 2
    s_cselect_b32 s38, s38, s36
    v_lshlrev_b32 v65, 7, v65
    v_mfma_f32_16x16x32_bf16 v[200:203], a[188:191], a[52:55], v[200:203]
    s_addk_i32 m0, 24576
    ds_read_b64_tr_b16 a[212:213], v11 offset:12288
    v_lshrrev_b32 v67, 4, v1
    v_mfma_f32_16x16x32_bf16 v[200:203], a[184:187], a[36:39], v[200:203]
    s_add_u32 s77, s7, 4
    ds_read_b64_tr_b16 a[214:215], v11 offset:14336
    v_lshl_add_u32 v65, v67, 4, v65
    v_mfma_f32_16x16x32_bf16 v[208:211], a[184:187], a[40:43], v[208:211]
    buffer_load_dwordx4 a[20:23], v14, s[20:23], s37 offen offset:1024 sc1
    v_mfma_f32_16x16x32_bf16 v[208:211], a[188:191], a[56:59], v[208:211]
    v_rcp_f32 v60, v60
    v_mfma_f32_16x16x32_bf16 v[216:219], a[188:191], a[60:63], v[216:219]
    buffer_load_dwordx4 v7, s[8:11], s38 offen lds
    v_mfma_f32_16x16x32_bf16 v[216:219], a[184:187], a[44:47], v[216:219]
    v_rcp_f32 v61, v61
    v_mfma_f32_16x16x32_bf16 v[220:223], a[192:195], a[44:47], v[220:223]
    v_mul_f32 v56, v56, v60
    v_cvt_pk_bf16_f32 v56, 0, v56
    v_mfma_f32_16x16x32_bf16 v[220:223], a[196:199], a[60:63], v[220:223]
    s_waitcnt lgkmcnt(0)
    v_mul_f32 v56, v56, v58
    v_mul_f32 v57, v57, v61
    v_mfma_f32_16x16x32_bf16 v[212:215], a[196:199], a[56:59], v[212:215]
    s_barrier
    v_mfma_f32_16x16x32_bf16 v[212:215], a[192:195], a[40:43], v[212:215]
    s_add_u32 s38, s46, 40960
    ds_read_b64_tr_b16 a[184:185], v12 offset:20480
    v_cvt_pk_bf16_f32 v57, 0, v57
    v_mfma_f32_16x16x32_bf16 v[204:207], a[192:195], a[36:39], v[204:207]
    buffer_load_dwordx4 a[24:27], v14, s[20:23], s37 offen offset:2048 sc1
    v_mfma_f32_16x16x32_bf16 v[204:207], a[196:199], a[52:55], v[204:207]
    s_addk_i32 m0, -16384
    ds_read_b64_tr_b16 a[186:187], v12 offset:21504
    v_mul_f32 v57, v57, v59
    v_mfma_f32_16x16x32_bf16 v[196:199], a[196:199], a[48:51], v[196:199]
    ds_read_b64_tr_b16 a[188:189], v12 offset:22528
    v_cvt_pk_bf16_f32 v56, v56, v57
    v_mfma_f32_16x16x32_bf16 v[196:199], a[192:195], a[32:35], v[196:199]
    ds_write_b16 v64, v56
    v_mfma_f32_16x16x32_bf16 v[224:227], a[200:203], a[32:35], v[224:227]
    ds_write_b16_d16_hi v64, v56 offset:128
    v_mfma_f32_16x16x32_bf16 v[224:227], a[204:207], a[48:51], v[224:227]
    ds_read_b64_tr_b16 a[190:191], v12 offset:23552
    v_add_u32 v65, s56, v65
    v_mfma_f32_16x16x32_bf16 v[232:235], a[204:207], a[52:55], v[232:235]
    buffer_load_dwordx4 v2, s[8:11], s38 offen lds
    v_mfma_f32_16x16x32_bf16 v[232:235], a[200:203], a[36:39], v[232:235]
    ds_read_b128 v[68:71], v65
    v_bfe_u32 v67, v1, 2, 3
    v_mfma_f32_16x16x32_bf16 v[240:243], a[200:203], a[40:43], v[240:243]
    ds_read_b128 v[72:75], v65 offset:64
    v_lshlrev_b32 v66, 7, v67
    v_mfma_f32_16x16x32_bf16 v[240:243], a[204:207], a[56:59], v[240:243]
    ds_read_b64_tr_b16 a[192:193], v13 offset:20480
    v_lshrrev_b32 v67, 1, v67
    v_mfma_f32_16x16x32_bf16 v[248:251], a[204:207], a[60:63], v[248:251]
    buffer_load_dwordx4 a[28:31], v14, s[20:23], s37 offen offset:3072 sc1
    v_mfma_f32_16x16x32_bf16 v[248:251], a[200:203], a[44:47], v[248:251]
    s_add_u32 s38, s46, 40960
    ds_read_b64_tr_b16 a[194:195], v13 offset:21504
    v_xor_b32 v67, s3, v67
    v_mfma_f32_16x16x32_bf16 v[252:255], a[208:211], a[44:47], v[252:255]
    s_addk_i32 m0, 4096
    ds_read_b64_tr_b16 a[196:197], v13 offset:22528
    v_lshl_add_u32 v66, v67, 5, v66
    v_mfma_f32_16x16x32_bf16 v[252:255], a[212:215], a[60:63], v[252:255]
    s_waitcnt lgkmcnt(5)
    ds_read_b64_tr_b16 a[198:199], v13 offset:23552
    v_and_b32 v67, 3, v1
    v_mfma_f32_16x16x32_bf16 v[244:247], a[212:215], a[56:59], v[244:247]
    s_sub_u32 s78, s72, s77
    ds_read_b64_tr_b16 a[200:201], v8 offset:20480
    v_lshl_add_u32 v66, v67, 3, v66
    v_mfma_f32_16x16x32_bf16 v[244:247], a[208:211], a[40:43], v[244:247]
    s_sub_u32 s79, s73, s77
    ds_read_b64_tr_b16 a[202:203], v8 offset:22528
    v_lshrrev_b32 v67, 5, v1
    v_mfma_f32_16x16x32_bf16 v[236:239], a[208:211], a[36:39], v[236:239]
    s_max_u32 s78, s78, s79
    ds_read_b64_tr_b16 a[204:205], v8 offset:28672
    v_mul_u32_u24 v67, 1024, v67
    v_mfma_f32_16x16x32_bf16 v[236:239], a[212:215], a[52:55], v[236:239]
    s_sub_u32 s79, s74, s77
    ds_read_b64_tr_b16 a[206:207], v8 offset:30720
    v_add_u32 v66, v66, v67
    v_mfma_f32_16x16x32_bf16 v[228:231], a[212:215], a[48:51], v[228:231]
    buffer_load_dwordx4 v3, s[8:11], s38 offen lds
    v_mfma_f32_16x16x32_bf16 v[228:231], a[208:211], a[32:35], v[228:231]
    s_max_u32 s78, s78, s79
    ds_read_b64_tr_b16 a[208:209], v9 offset:20480
    v_add_u32 v66, 114688, v66
    v_mfma_f32_16x16x32_bf16 v[96:99], a[184:187], a[64:67], v[96:99]
    s_waitcnt lgkmcnt(5)
    ds_read_b64_tr_b16 a[210:211], v9 offset:22528
    v_lshlrev_b32 v62, 2, v1
    v_mfma_f32_16x16x32_bf16 v[96:99], a[188:191], a[216:219], v[96:99]
    s_sub_u32 s79, s75, s77
    ds_read_b64_tr_b16 a[212:213], v9 offset:28672
    v_mov_b32 v67, 0x7ffffff0
    v_mfma_f32_16x16x32_bf16 v[104:107], a[188:191], a[220:223], v[104:107]
    s_max_u32 s78, s78, s79
    ds_read_b64_tr_b16 a[214:215], v9 offset:30720
    v_cndmask_b32 v62, v67, v62, vcc
    v_mfma_f32_16x16x32_bf16 v[104:107], a[184:187], a[68:71], v[104:107]
    s_cmp_gt_u32 s78, 2
    s_cbranch_scc1 spin_o3
spin_o3_ret:
    s_load_dwordx4 s[72:75], s[86:87], s5 glc
    v_mfma_f32_16x16x32_bf16 v[112:115], a[184:187], a[72:75], v[112:115]
    s_add_u32 s37, s59, 12288
    s_add_u32 s38, s47, 40960
    s_add_u32 m0, s63, 102400
    v_mfma_f32_16x16x32_bf16 v[112:115], a[188:191], a[224:227], v[112:115]
    buffer_load_dwordx4 a[32:35], v14, s[20:23], s37 offen offset:0 sc1
    v_mfma_f32_16x16x32_bf16 v[120:123], a[188:191], a[228:231], v[120:123]
    v_mfma_f32_16x16x32_bf16 v[120:123], a[184:187], a[76:79], v[120:123]
    ds_read_b64_tr_b16 a[184:185], v10 offset:20480
    v_mfma_f32_16x16x32_bf16 v[124:127], a[192:195], a[76:79], v[124:127]
    ds_read_b64_tr_b16 a[186:187], v10 offset:22528
    v_mfma_f32_16x16x32_bf16 v[124:127], a[196:199], a[228:231], v[124:127]
    ds_read_b64_tr_b16 a[188:189], v10 offset:28672
    v_mfma_f32_16x16x32_bf16 v[116:119], a[196:199], a[224:227], v[116:119]
    s_waitcnt lgkmcnt(5)
    ds_read_b64_tr_b16 a[190:191], v10 offset:30720
    v_mfma_f32_16x16x32_bf16 v[116:119], a[192:195], a[72:75], v[116:119]
    buffer_load_dwordx4 a[36:39], v14, s[20:23], s37 offen offset:1024 sc1
    v_mfma_f32_16x16x32_bf16 v[108:111], a[192:195], a[68:71], v[108:111]
    buffer_load_dwordx4 v2, s[8:11], s38 offen lds
    v_mfma_f32_16x16x32_bf16 v[108:111], a[196:199], a[220:223], v[108:111]
    v_mfma_f32_16x16x32_bf16 v[100:103], a[196:199], a[216:219], v[100:103]
    s_add_u32 s38, s47, 40960
    v_mfma_f32_16x16x32_bf16 v[100:103], a[192:195], a[64:67], v[100:103]
    ds_read_b64_tr_b16 a[192:193], v11 offset:20480
    v_mfma_f32_16x16x32_bf16 v[128:131], a[200:203], a[64:67], v[128:131]
    s_addk_i32 m0, 4096
    ds_read_b64_tr_b16 a[194:195], v11 offset:22528
    v_mfma_f32_16x16x32_bf16 v[128:131], a[204:207], a[216:219], v[128:131]
    ds_read_b64_tr_b16 a[196:197], v11 offset:28672
    v_mfma_f32_16x16x32_bf16 v[136:139], a[204:207], a[220:223], v[136:139]
    ds_read_b64_tr_b16 a[198:199], v11 offset:30720
    v_mfma_f32_16x16x32_bf16 v[136:139], a[200:203], a[68:71], v[136:139]
    v_mfma_f32_16x16x32_bf16 v[144:147], a[200:203], a[72:75], v[144:147]
    buffer_load_dwordx4 a[40:43], v14, s[20:23], s37 offen offset:2048 sc1
    v_mfma_f32_16x16x32_bf16 v[144:147], a[204:207], a[224:227], v[144:147]
    v_mfma_f32_16x16x32_bf16 v[152:155], a[204:207], a[228:231], v[152:155]
    buffer_load_dwordx4 v3, s[8:11], s38 offen lds
    v_mfma_f32_16x16x32_bf16 v[152:155], a[200:203], a[76:79], v[152:155]
    s_waitcnt lgkmcnt(4)
    ds_read_b64_tr_b16 a[200:201], v8 offset:24576
    v_mfma_f32_16x16x32_bf16 v[156:159], a[208:211], a[76:79], v[156:159]
    ds_read_b64_tr_b16 a[202:203], v8 offset:26624
    v_mfma_f32_16x16x32_bf16 v[156:159], a[212:215], a[228:231], v[156:159]
    ds_read_b64_tr_b16 a[204:205], v8 offset:32768
    v_mfma_f32_16x16x32_bf16 v[148:151], a[212:215], a[224:227], v[148:151]
    s_add_u32 s38, s45, 81920
    ds_read_b64_tr_b16 a[206:207], v8 offset:34816
    s_add_u32 s36, s46, 81920
    v_mfma_f32_16x16x32_bf16 v[148:151], a[208:211], a[72:75], v[148:151]
    s_cmp_lt_u32 s3, 2
    s_cselect_b32 s38, s38, s36
    v_mfma_f32_16x16x32_bf16 v[140:143], a[208:211], a[68:71], v[140:143]
    s_add_u32 m0, s63, 139264
    v_mfma_f32_16x16x32_bf16 v[140:143], a[212:215], a[220:223], v[140:143]
    v_mfma_f32_16x16x32_bf16 v[132:135], a[212:215], a[216:219], v[132:135]
    buffer_load_dwordx4 a[44:47], v14, s[20:23], s37 offen offset:3072 sc1
    v_mfma_f32_16x16x32_bf16 v[132:135], a[208:211], a[64:67], v[132:135]
    ds_read_b64_tr_b16 a[208:209], v9 offset:24576
    v_mfma_f32_16x16x32_bf16 v[160:163], a[184:187], a[64:67], v[160:163]
    ds_read_b64_tr_b16 a[210:211], v9 offset:26624
    v_mfma_f32_16x16x32_bf16 v[160:163], a[188:191], a[216:219], v[160:163]
    ds_read_b64_tr_b16 a[212:213], v9 offset:32768
    v_mfma_f32_16x16x32_bf16 v[168:171], a[188:191], a[220:223], v[168:171]
    s_waitcnt lgkmcnt(5)
    ds_read_b64_tr_b16 a[214:215], v9 offset:34816
    s_add_u32 s37, s60, 12288
    v_mfma_f32_16x16x32_bf16 v[168:171], a[184:187], a[68:71], v[168:171]
    buffer_load_dwordx4 v7, s[8:11], s38 offen lds
    v_mfma_f32_16x16x32_bf16 v[176:179], a[184:187], a[72:75], v[176:179]
    v_mfma_f32_16x16x32_bf16 v[176:179], a[188:191], a[224:227], v[176:179]
    v_mfma_f32_16x16x32_bf16 v[184:187], a[188:191], a[228:231], v[184:187]
    v_mfma_f32_16x16x32_bf16 v[184:187], a[184:187], a[76:79], v[184:187]
    ds_read_b64_tr_b16 a[184:185], v10 offset:24576
    v_mfma_f32_16x16x32_bf16 v[188:191], a[192:195], a[76:79], v[188:191]
    buffer_load_dwordx4 a[48:51], v14, s[20:23], s37 offen offset:0 sc1
    v_mfma_f32_16x16x32_bf16 v[188:191], a[196:199], a[228:231], v[188:191]
    s_mov_b32 s16, s84
    ds_read_b64_tr_b16 a[186:187], v10 offset:26624
    v_and_b32 v5, 15, v1
    v_mfma_f32_16x16x32_bf16 v[180:183], a[196:199], a[224:227], v[180:183]
    s_and_b32 s17, s85, 0xffff
    ds_read_b64_tr_b16 a[188:189], v10 offset:32768
    v_add_u32 v5, s6, v5
    v_mfma_f32_16x16x32_bf16 v[180:183], a[192:195], a[72:75], v[180:183]
    s_mov_b32 s18, 2621440
    ds_read_b64_tr_b16 a[190:191], v10 offset:34816
    v_bfe_u32 v50, v1, 4, 1
    v_mfma_f32_16x16x32_bf16 v[172:175], a[192:195], a[68:71], v[172:175]
    s_mov_b32 s19, 0x00020000
    v_bfe_u32 v51, v1, 5, 1
    v_lshl_add_u32 v50, v50, 1, v51
    v_mfma_f32_16x16x32_bf16 v[172:175], a[196:199], a[220:223], v[172:175]
    s_and_b32 s56, s53, 4
    v_mul_u32_u24 v4, 1280, v5
    v_lshl_add_u32 v4, v50, 4, v4
    v_mfma_f32_16x16x32_bf16 v[164:167], a[196:199], a[216:219], v[164:167]
    s_waitcnt lgkmcnt(5)
    v_xor_b32 v51, 16, v5
    v_mul_u32_u24 v35, 1280, v51
    v_mfma_f32_16x16x32_bf16 v[164:167], a[192:195], a[64:67], v[164:167]
    s_add_u32 s38, s47, 81920
    ds_read_b64_tr_b16 a[192:193], v11 offset:24576
    v_lshl_add_u32 v34, v50, 4, v35
    v_mfma_f32_16x16x32_bf16 v[192:195], a[200:203], a[64:67], v[192:195]
    s_add_u32 s36, s45, 122880
    ds_read_b64_tr_b16 a[194:195], v11 offset:26624
    v_and_b32 v51, 0xfffffff7, v51
    v_mfma_f32_16x16x32_bf16 v[192:195], a[204:207], a[216:219], v[192:195]
    s_cmp_lt_u32 s3, 2
    s_cselect_b32 s38, s38, s36
    v_lshrrev_b32 v50, 4, v1
    v_mfma_f32_16x16x32_bf16 v[200:203], a[204:207], a[220:223], v[200:203]
    s_addk_i32 m0, 4096
    ds_read_b64_tr_b16 a[196:197], v11 offset:32768
    s_lshl_b32 s56, s56, 1
    v_mfma_f32_16x16x32_bf16 v[200:203], a[200:203], a[68:71], v[200:203]
    ds_read_b64_tr_b16 a[198:199], v11 offset:34816
    v_or_b32 v37, s56, v51
    v_mfma_f32_16x16x32_bf16 v[208:211], a[200:203], a[72:75], v[208:211]
    buffer_load_dwordx4 a[52:55], v14, s[20:23], s37 offen offset:1024 sc1
    v_mfma_f32_16x16x32_bf16 v[208:211], a[204:207], a[224:227], v[208:211]
    s_xor_b32 s56, s56, 8
    v_mul_u32_u24 v35, 1280, v37
    v_lshl_add_u32 v35, v50, 3, v35
    v_mfma_f32_16x16x32_bf16 v[216:219], a[204:207], a[228:231], v[216:219]
    buffer_load_dwordx4 v7, s[8:11], s38 offen lds
    v_mfma_f32_16x16x32_bf16 v[216:219], a[200:203], a[76:79], v[216:219]
    s_waitcnt lgkmcnt(2)
    v_xor_b32 v50, s56, v1
    v_and_b32 v50, 8, v50
    v_mfma_f32_16x16x32_bf16 v[220:223], a[208:211], a[76:79], v[220:223]
    v_lshl_add_u32 v35, v50, 2, v35
    v_lshlrev_b32 v52, 3, v37
    v_mfma_f32_16x16x32_bf16 v[220:223], a[212:215], a[228:231], v[220:223]
    s_waitcnt vmcnt(27) lgkmcnt(0)
    v_add_u32 v52, 3211264, v52
    v_lshlrev_b32 v50, 3, v5
    v_mfma_f32_16x16x32_bf16 v[212:215], a[212:215], a[224:227], v[212:215]
    s_barrier
    v_mfma_f32_16x16x32_bf16 v[212:215], a[208:211], a[72:75], v[212:215]
    ds_read_b64_tr_b16 a[200:201], v12 offset:40960
    v_add_u32 v50, 3211264, v50
    v_mfma_f32_16x16x32_bf16 v[204:207], a[208:211], a[68:71], v[204:207]
    buffer_load_dwordx4 a[56:59], v14, s[20:23], s37 offen offset:2048 sc1
    v_mfma_f32_16x16x32_bf16 v[204:207], a[212:215], a[220:223], v[204:207]
    ds_read_b64_tr_b16 a[202:203], v12 offset:41984
    v_xor_b32 v51, 128, v50
    v_mfma_f32_16x16x32_bf16 v[196:199], a[212:215], a[216:219], v[196:199]
    ds_read_b64_tr_b16 a[204:205], v12 offset:43008
    v_mfma_f32_16x16x32_bf16 v[196:199], a[208:211], a[64:67], v[196:199]
    ds_read_b64_tr_b16 a[206:207], v12 offset:44032
    v_add_u32 v12, 73728, v12
    v_mfma_f32_16x16x32_bf16 v[224:227], a[184:187], a[64:67], v[224:227]
    ds_read_b64_tr_b16 a[208:209], v13 offset:40960
    v_mfma_f32_16x16x32_bf16 v[224:227], a[188:191], a[216:219], v[224:227]
    ds_read_b64_tr_b16 a[210:211], v13 offset:41984
    v_mfma_f32_16x16x32_bf16 v[232:235], a[188:191], a[220:223], v[232:235]
    s_add_u32 s38, s46, 122880
    ds_read_b64_tr_b16 a[212:213], v13 offset:43008
    s_add_u32 s36, s47, 122880
    v_mfma_f32_16x16x32_bf16 v[232:235], a[184:187], a[68:71], v[232:235]
    s_cmp_lt_u32 s3, 2
    s_cselect_b32 s38, s38, s36
    v_mfma_f32_16x16x32_bf16 v[240:243], a[184:187], a[72:75], v[240:243]
    s_addk_i32 m0, 4096
    ds_read_b64_tr_b16 a[214:215], v13 offset:44032
    v_add_u32 v13, 73728, v13
    v_mfma_f32_16x16x32_bf16 v[240:243], a[188:191], a[224:227], v[240:243]
    v_mfma_f32_16x16x32_bf16 v[248:251], a[188:191], a[228:231], v[248:251]
    buffer_load_dwordx4 a[60:63], v14, s[20:23], s37 offen offset:3072 sc1
    v_mfma_f32_16x16x32_bf16 v[248:251], a[184:187], a[76:79], v[248:251]
    ds_read_b64_tr_b16 a[184:185], v8 offset:40960
    v_mfma_f32_16x16x32_bf16 v[252:255], a[192:195], a[76:79], v[252:255]
    ds_read_b64_tr_b16 a[186:187], v8 offset:43008
    v_mfma_f32_16x16x32_bf16 v[252:255], a[196:199], a[228:231], v[252:255]
    ds_read_b64_tr_b16 a[188:189], v8 offset:49152
    v_mfma_f32_16x16x32_bf16 v[244:247], a[196:199], a[224:227], v[244:247]
    s_waitcnt lgkmcnt(4)
    ds_read_b64_tr_b16 a[190:191], v8 offset:51200
    s_add_u32 s37, s61, 12288
    v_mfma_f32_16x16x32_bf16 v[244:247], a[192:195], a[72:75], v[244:247]
    buffer_load_dwordx4 v7, s[8:11], s38 offen lds
    v_mfma_f32_16x16x32_bf16 v[236:239], a[192:195], a[68:71], v[236:239]
    v_mfma_f32_16x16x32_bf16 v[236:239], a[196:199], a[220:223], v[236:239]
    v_mfma_f32_16x16x32_bf16 v[228:231], a[196:199], a[216:219], v[228:231]
    v_mfma_f32_16x16x32_bf16 v[228:231], a[192:195], a[64:67], v[228:231]
    ds_read_b64_tr_b16 a[192:193], v9 offset:40960
    v_mfma_f32_16x16x32_bf16 v[96:99], a[200:203], a[232:235], v[96:99]
    buffer_load_dwordx4 a[64:67], v14, s[20:23], s37 offen offset:0 sc1
    v_mfma_f32_16x16x32_bf16 v[96:99], a[204:207], a[152:155], v[96:99]
    buffer_load_dwordx2 v[16:17], v50, s[24:27], 0 offen sc1
    v_mfma_f32_16x16x32_bf16 v[104:107], a[204:207], a[156:159], v[104:107]
    ds_read_b64_tr_b16 a[194:195], v9 offset:43008
    v_mfma_f32_16x16x32_bf16 v[104:107], a[200:203], a[236:239], v[104:107]
    ds_read_b64_tr_b16 a[196:197], v9 offset:49152
    v_mfma_f32_16x16x32_bf16 v[112:115], a[200:203], a[240:243], v[112:115]
    ds_read_b64_tr_b16 a[198:199], v9 offset:51200
    v_mfma_f32_16x16x32_bf16 v[112:115], a[204:207], a[160:163], v[112:115]
    ds_read_b64_tr_b16 v[76:77], v66 offset:0
    v_mfma_f32_16x16x32_bf16 v[120:123], a[204:207], a[164:167], v[120:123]
    s_waitcnt lgkmcnt(4)
    ds_read_b64_tr_b16 v[78:79], v66 offset:2048
    s_add_u32 s38, s45, 163840
    v_mfma_f32_16x16x32_bf16 v[120:123], a[200:203], a[244:247], v[120:123]
    s_add_u32 s36, s46, 163840
    ds_read_b64_tr_b16 v[80:81], v66 offset:4096
    v_mfma_f32_16x16x32_bf16 v[124:127], a[208:211], a[244:247], v[124:127]
    s_cmp_lt_u32 s3, 2
    s_cselect_b32 s38, s38, s36
    s_addk_i32 m0, 4096
    v_mfma_f32_16x16x32_bf16 v[124:127], a[212:215], a[164:167], v[124:127]
    ds_read_b64_tr_b16 v[82:83], v66 offset:6144
    v_mfma_f32_16x16x32_bf16 v[116:119], a[212:215], a[160:163], v[116:119]
    buffer_load_dwordx4 a[68:71], v14, s[20:23], s37 offen offset:1024 sc1
    v_mfma_f32_16x16x32_bf16 v[116:119], a[208:211], a[240:243], v[116:119]
    s_add_u32 s77, s7, 5
    ds_read_b64_tr_b16 a[200:201], v10 offset:40960
    v_mfma_f32_16x16x32_bf16 v[108:111], a[208:211], a[236:239], v[108:111]
    ds_read_b64_tr_b16 a[202:203], v10 offset:43008
    v_mfma_f32_16x16x32_bf16 v[108:111], a[212:215], a[156:159], v[108:111]
    ds_read_b64_tr_b16 a[204:205], v10 offset:49152
    v_mfma_f32_16x16x32_bf16 v[100:103], a[212:215], a[152:155], v[100:103]
    buffer_load_dwordx4 v7, s[8:11], s38 offen lds
    v_mfma_f32_16x16x32_bf16 v[100:103], a[208:211], a[232:235], v[100:103]
    buffer_load_dwordx2 v[18:19], v51, s[24:27], 0 offen sc1
    v_mfma_f32_16x16x32_bf16 v[128:131], a[184:187], a[232:235], v[128:131]
    ds_read_b64_tr_b16 a[206:207], v10 offset:51200
    v_mfma_f32_16x16x32_bf16 v[128:131], a[188:191], a[152:155], v[128:131]
    s_waitcnt lgkmcnt(4)
    ds_read_b64_tr_b16 a[208:209], v11 offset:40960
    v_mfma_f32_16x16x32_bf16 v[136:139], a[188:191], a[156:159], v[136:139]
    ds_read_b64_tr_b16 a[210:211], v11 offset:43008
    v_mfma_f32_16x16x32_bf16 v[136:139], a[184:187], a[236:239], v[136:139]
    ds_read_b64_tr_b16 a[212:213], v11 offset:49152
    v_mfma_f32_16x16x32_bf16 v[144:147], a[184:187], a[240:243], v[144:147]
    buffer_load_dwordx4 a[72:75], v14, s[20:23], s37 offen offset:2048 sc1
    v_mfma_f32_16x16x32_bf16 v[144:147], a[188:191], a[160:163], v[144:147]
    ds_read_b64_tr_b16 a[214:215], v11 offset:51200
    v_mfma_f32_16x16x32_bf16 v[152:155], a[188:191], a[164:167], v[152:155]
    v_mfma_f32_16x16x32_bf16 v[152:155], a[184:187], a[244:247], v[152:155]
    ds_read_b64_tr_b16 a[184:185], v8 offset:45056
    v_mfma_f32_16x16x32_bf16 v[156:159], a[192:195], a[244:247], v[156:159]
    ds_read_b64_tr_b16 a[186:187], v8 offset:47104
    v_mfma_f32_16x16x32_bf16 v[156:159], a[196:199], a[164:167], v[156:159]
    ds_read_b64_tr_b16 a[188:189], v8 offset:53248
    v_mfma_f32_16x16x32_bf16 v[148:151], a[196:199], a[160:163], v[148:151]
    s_waitcnt lgkmcnt(4)
    ds_read_b64_tr_b16 a[190:191], v8 offset:55296
    v_add_u32 v8, 73728, v8
    v_mfma_f32_16x16x32_bf16 v[148:151], a[192:195], a[240:243], v[148:151]
    s_add_u32 s38, s47, 163840
    s_add_u32 s36, s45, 204800
    v_mfma_f32_16x16x32_bf16 v[140:143], a[192:195], a[236:239], v[140:143]
    buffer_load_dwordx2 v[38:39], v52, s[24:27], 0 offen sc1
    v_mfma_f32_16x16x32_bf16 v[140:143], a[196:199], a[156:159], v[140:143]
    s_cmp_lt_u32 s3, 2
    s_cselect_b32 s38, s38, s36
    s_addk_i32 m0, 4096
    v_mfma_f32_16x16x32_bf16 v[132:135], a[196:199], a[152:155], v[132:135]
    buffer_load_dwordx4 a[76:79], v14, s[20:23], s37 offen offset:3072 sc1
    v_mfma_f32_16x16x32_bf16 v[132:135], a[192:195], a[232:235], v[132:135]
    s_sub_u32 s78, s72, s77
    ds_read_b64_tr_b16 a[192:193], v9 offset:45056
    s_sub_u32 s79, s73, s77
    v_mfma_f32_16x16x32_bf16 v[84:87], v[68:71], v[76:79], 0
    s_max_u32 s78, s78, s79
    ds_read_b64_tr_b16 a[194:195], v9 offset:47104
    s_sub_u32 s79, s74, s77
    v_mfma_f32_16x16x32_bf16 v[84:87], v[72:75], v[80:83], v[84:87]
    s_max_u32 s78, s78, s79
    ds_read_b64_tr_b16 a[196:197], v9 offset:53248
    s_sub_u32 s79, s75, s77
    v_mfma_f32_16x16x32_bf16 v[160:163], a[200:203], a[232:235], v[160:163]
    buffer_load_dwordx4 v7, s[8:11], s38 offen lds
    v_mfma_f32_16x16x32_bf16 v[160:163], a[204:207], a[152:155], v[160:163]
    s_max_u32 s78, s78, s79
    ds_read_b64_tr_b16 a[198:199], v9 offset:55296
    v_add_u32 v9, 73728, v9
    v_mfma_f32_16x16x32_bf16 v[168:171], a[204:207], a[156:159], v[168:171]
    buffer_store_dword v84, v62, s[24:27], s62 offen sc1
    v_mfma_f32_16x16x32_bf16 v[168:171], a[200:203], a[236:239], v[168:171]
    buffer_store_dword v85, v62, s[24:27], s62 offen offset:2560 sc1
    v_mfma_f32_16x16x32_bf16 v[176:179], a[200:203], a[240:243], v[176:179]
    s_cmp_gt_u32 s78, 1
    s_cbranch_scc1 spin_o4
spin_o4_ret:
    s_add_u32 s37, s59, 16384
    v_mfma_f32_16x16x32_bf16 v[176:179], a[204:207], a[160:163], v[176:179]
    v_mfma_f32_16x16x32_bf16 v[184:187], a[204:207], a[164:167], v[184:187]
    buffer_load_dwordx4 a[216:219], v14, s[20:23], s37 offen offset:0 sc1
    v_mfma_f32_16x16x32_bf16 v[184:187], a[200:203], a[244:247], v[184:187]
    s_waitcnt lgkmcnt(1)
    ds_read_b64_tr_b16 a[200:201], v10 offset:45056
    v_mfma_f32_16x16x32_bf16 v[188:191], a[208:211], a[244:247], v[188:191]
    buffer_load_dwordx2 v[32:33], v35, s[12:15], s68 offen
    v_mfma_f32_16x16x32_bf16 v[188:191], a[212:215], a[164:167], v[188:191]
    ds_read_b64_tr_b16 a[202:203], v10 offset:47104
    v_mfma_f32_16x16x32_bf16 v[180:183], a[212:215], a[160:163], v[180:183]
    ds_read_b64_tr_b16 a[204:205], v10 offset:53248
    v_mfma_f32_16x16x32_bf16 v[180:183], a[208:211], a[240:243], v[180:183]
    ds_read_b64_tr_b16 a[206:207], v10 offset:55296
    v_add_u32 v10, 73728, v10
    v_mfma_f32_16x16x32_bf16 v[172:175], a[208:211], a[236:239], v[172:175]
    s_add_u32 s38, s46, 204800
    s_add_u32 s36, s47, 204800
    v_mfma_f32_16x16x32_bf16 v[172:175], a[212:215], a[156:159], v[172:175]
    s_cmp_lt_u32 s3, 2
    s_cselect_b32 s38, s38, s36
    v_mfma_f32_16x16x32_bf16 v[164:167], a[212:215], a[152:155], v[164:167]
    s_addk_i32 m0, 4096
    v_mfma_f32_16x16x32_bf16 v[164:167], a[208:211], a[232:235], v[164:167]
    ds_read_b64_tr_b16 a[208:209], v11 offset:45056
    v_mfma_f32_16x16x32_bf16 v[192:195], a[184:187], a[232:235], v[192:195]
    buffer_load_dwordx4 a[220:223], v14, s[20:23], s37 offen offset:1024 sc1
    v_mfma_f32_16x16x32_bf16 v[192:195], a[188:191], a[152:155], v[192:195]
    ds_read_b64_tr_b16 a[210:211], v11 offset:47104
    v_mfma_f32_16x16x32_bf16 v[200:203], a[188:191], a[156:159], v[200:203]
    ds_read_b64_tr_b16 a[212:213], v11 offset:53248
    v_mfma_f32_16x16x32_bf16 v[200:203], a[184:187], a[236:239], v[200:203]
    ds_read_b64_tr_b16 a[214:215], v11 offset:55296
    v_add_u32 v11, 73728, v11
    v_mfma_f32_16x16x32_bf16 v[208:211], a[184:187], a[240:243], v[208:211]
    buffer_load_dwordx4 v7, s[8:11], s38 offen lds
    v_mfma_f32_16x16x32_bf16 v[208:211], a[188:191], a[160:163], v[208:211]
    v_mfma_f32_16x16x32_bf16 v[216:219], a[188:191], a[164:167], v[216:219]
    buffer_load_dwordx4 v[24:27], v4, s[12:15], s64 offen
    v_mfma_f32_16x16x32_bf16 v[216:219], a[184:187], a[244:247], v[216:219]
pg_13:
    s_cbranch_execz pg_back
    s_waitcnt lgkmcnt(3)
    v_mfma_f32_16x16x32_bf16 v[220:223], a[192:195], a[244:247], v[220:223]
    v_mfma_f32_16x16x32_bf16 v[220:223], a[196:199], a[164:167], v[220:223]
    s_waitcnt vmcnt(35) lgkmcnt(1)
    v_mfma_f32_16x16x32_bf16 v[212:215], a[196:199], a[160:163], v[212:215]
    s_barrier
    v_mfma_f32_16x16x32_bf16 v[212:215], a[192:195], a[240:243], v[212:215]
    buffer_load_dwordx4 a[224:227], v14, s[20:23], s37 offen offset:2048 sc1
    v_mfma_f32_16x16x32_bf16 v[204:207], a[192:195], a[236:239], v[204:207]
    ds_read_b64_tr_b16 a[184:185], v12 offset:0
    v_mfma_f32_16x16x32_bf16 v[204:207], a[196:199], a[156:159], v[204:207]
    ds_read_b64_tr_b16 a[186:187], v12 offset:1024
    v_mfma_f32_16x16x32_bf16 v[196:199], a[196:199], a[152:155], v[196:199]
    ds_read_b64_tr_b16 a[188:189], v12 offset:2048
    v_mfma_f32_16x16x32_bf16 v[196:199], a[192:195], a[232:235], v[196:199]
    ds_read_b64_tr_b16 a[190:191], v12 offset:3072
    v_mfma_f32_16x16x32_bf16 v[224:227], a[200:203], a[232:235], v[224:227]
    s_add_u32 s38, s45, 81920
    ds_read_b64_tr_b16 a[192:193], v13 offset:0
    v_mfma_f32_16x16x32_bf16 v[224:227], a[204:207], a[152:155], v[224:227]
    ds_read_b64_tr_b16 a[194:195], v13 offset:1024
    v_mfma_f32_16x16x32_bf16 v[232:235], a[204:207], a[156:159], v[232:235]
    s_add_u32 m0, s63, 0
    ds_read_b64_tr_b16 a[196:197], v13 offset:2048
    v_mfma_f32_16x16x32_bf16 v[232:235], a[200:203], a[236:239], v[232:235]
    ds_read_b64_tr_b16 a[198:199], v13 offset:3072
    v_mfma_f32_16x16x32_bf16 v[240:243], a[200:203], a[240:243], v[240:243]
    buffer_load_dwordx4 a[228:231], v14, s[20:23], s37 offen offset:3072 sc1
    v_mfma_f32_16x16x32_bf16 v[240:243], a[204:207], a[160:163], v[240:243]
    buffer_load_dwordx4 v[28:31], v34, s[12:15], s64 offen
    v_mfma_f32_16x16x32_bf16 v[248:251], a[204:207], a[164:167], v[248:251]
    s_waitcnt lgkmcnt(4)
    v_mfma_f32_16x16x32_bf16 v[248:251], a[200:203], a[244:247], v[248:251]
    ds_read_b64_tr_b16 a[200:201], v8 offset:0
    v_mfma_f32_16x16x32_bf16 v[252:255], a[208:211], a[244:247], v[252:255]
    buffer_load_dwordx4 v2, s[8:11], s38 offen lds
    v_mfma_f32_16x16x32_bf16 v[252:255], a[212:215], a[164:167], v[252:255]
    ds_read_b64_tr_b16 a[202:203], v8 offset:2048
    v_mfma_f32_16x16x32_bf16 v[244:247], a[212:215], a[160:163], v[244:247]
    s_add_u32 s37, s60, 16384
    ds_read_b64_tr_b16 a[204:205], v8 offset:8192
    v_mfma_f32_16x16x32_bf16 v[244:247], a[208:211], a[240:243], v[244:247]
    ds_read_b64_tr_b16 a[206:207], v8 offset:10240
    v_mfma_f32_16x16x32_bf16 v[236:239], a[208:211], a[236:239], v[236:239]
    v_mfma_f32_16x16x32_bf16 v[236:239], a[212:215], a[156:159], v[236:239]
    v_mfma_f32_16x16x32_bf16 v[228:231], a[212:215], a[152:155], v[228:231]
    s_add_u32 s38, s46, 81920
    v_mfma_f32_16x16x32_bf16 v[228:231], a[208:211], a[232:235], v[228:231]
    ds_read_b64_tr_b16 a[208:209], v9 offset:0
    v_mfma_f32_16x16x32_bf16 v[96:99], a[184:187], a[168:171], v[96:99]
    buffer_load_dwordx4 a[232:235], v14, s[20:23], s37 offen offset:0 sc1
    v_mfma_f32_16x16x32_bf16 v[96:99], a[188:191], a[80:83], v[96:99]
    s_addk_i32 m0, 4096
    ds_read_b64_tr_b16 a[210:211], v9 offset:2048
    v_mfma_f32_16x16x32_bf16 v[104:107], a[188:191], a[84:87], v[104:107]
    ds_read_b64_tr_b16 a[212:213], v9 offset:8192
    v_mfma_f32_16x16x32_bf16 v[104:107], a[184:187], a[172:175], v[104:107]
    s_waitcnt lgkmcnt(3)
    ds_read_b64_tr_b16 a[214:215], v9 offset:10240
    v_mfma_f32_16x16x32_bf16 v[112:115], a[184:187], a[176:179], v[112:115]
    v_mfma_f32_16x16x32_bf16 v[112:115], a[188:191], a[88:91], v[112:115]
    v_mfma_f32_16x16x32_bf16 v[120:123], a[188:191], a[92:95], v[120:123]
    buffer_load_dwordx4 v2, s[8:11], s38 offen lds
    v_mfma_f32_16x16x32_bf16 v[120:123], a[184:187], a[180:183], v[120:123]
    ds_read_b64_tr_b16 a[184:185], v10 offset:0
    v_mfma_f32_16x16x32_bf16 v[124:127], a[192:195], a[180:183], v[124:127]
    ds_read_b64_tr_b16 a[186:187], v10 offset:2048
    v_mfma_f32_16x16x32_bf16 v[124:127], a[196:199], a[92:95], v[124:127]
    ds_read_b64_tr_b16 a[188:189], v10 offset:8192
    v_mfma_f32_16x16x32_bf16 v[116:119], a[196:199], a[88:91], v[116:119]
    buffer_load_dwordx4 a[236:239], v14, s[20:23], s37 offen offset:1024 sc1
    v_mfma_f32_16x16x32_bf16 v[116:119], a[192:195], a[176:179], v[116:119]
    ds_read_b64_tr_b16 a[190:191], v10 offset:10240
    v_mfma_f32_16x16x32_bf16 v[108:111], a[192:195], a[172:175], v[108:111]
    s_add_u32 s38, s47, 81920
    v_mfma_f32_16x16x32_bf16 v[108:111], a[196:199], a[84:87], v[108:111]
    v_mfma_f32_16x16x32_bf16 v[100:103], a[196:199], a[80:83], v[100:103]
    s_addk_i32 m0, 4096
    v_mfma_f32_16x16x32_bf16 v[100:103], a[192:195], a[168:171], v[100:103]
    ds_read_b64_tr_b16 a[192:193], v11 offset:0
    v_mfma_f32_16x16x32_bf16 v[128:131], a[200:203], a[168:171], v[128:131]
    ds_read_b64_tr_b16 a[194:195], v11 offset:2048
    v_mfma_f32_16x16x32_bf16 v[128:131], a[204:207], a[80:83], v[128:131]
    ds_read_b64_tr_b16 a[196:197], v11 offset:8192
    v_mfma_f32_16x16x32_bf16 v[136:139], a[204:207], a[84:87], v[136:139]
    s_waitcnt lgkmcnt(3)
    ds_read_b64_tr_b16 a[198:199], v11 offset:10240
    v_lshrrev_b32 v65, 1, v1
    v_mfma_f32_16x16x32_bf16 v[136:139], a[200:203], a[172:175], v[136:139]
    s_and_b32 s39, s70, 0x7ff
    v_min_u32 v65, 23, v65
    v_mul_u32_u24 v65, 2560, v65
    v_mfma_f32_16x16x32_bf16 v[144:147], a[200:203], a[176:179], v[144:147]
    buffer_load_dwordx4 a[240:243], v14, s[20:23], s37 offen offset:2048 sc1
    v_mfma_f32_16x16x32_bf16 v[144:147], a[204:207], a[88:91], v[144:147]
    buffer_load_dwordx4 v2, s[8:11], s38 offen lds
    v_mfma_f32_16x16x32_bf16 v[152:155], a[204:207], a[92:95], v[152:155]
    s_sub_u32 s39, 2047, s39
    v_and_b32 v56, 1, v1
    v_lshl_add_u32 v65, v56, 2, v65
    v_mfma_f32_16x16x32_bf16 v[152:155], a[200:203], a[180:183], v[152:155]
    s_and_b32 s40, s71, 0x7ff
    ds_read_b64_tr_b16 a[200:201], v8 offset:4096
    v_cmp_lt_u32 vcc, 31, v1
    v_mfma_f32_16x16x32_bf16 v[156:159], a[208:211], a[180:183], v[156:159]
    s_load_dwordx4 s[72:75], s[86:87], s5 glc
    ds_read_b64_tr_b16 a[202:203], v8 offset:6144
    v_mov_b32 v54, s70
    v_mfma_f32_16x16x32_bf16 v[156:159], a[212:215], a[92:95], v[156:159]
    s_sub_u32 s40, 2047, s40
    ds_read_b64_tr_b16 a[204:205], v8 offset:12288
    v_mov_b32 v64, s71
    v_mfma_f32_16x16x32_bf16 v[148:151], a[212:215], a[88:91], v[148:151]
    s_add_u32 s38, s45, 122880
    ds_read_b64_tr_b16 a[206:207], v8 offset:14336
    v_cndmask_b32 v54, v54, v64, vcc
    v_mfma_f32_16x16x32_bf16 v[148:151], a[208:211], a[176:179], v[148:151]
    s_xor_b32 s56, s39, s6
    v_bfe_i32 v56, v1, 3, 1
    v_and_b32 v57, 7, v1
    v_mfma_f32_16x16x32_bf16 v[140:143], a[208:211], a[172:175], v[140:143]
    s_add_u32 m0, s63, 12288
    s_xor_b32 s57, s40, s6
    s_min_u32 s56, s56, s57
    v_mfma_f32_16x16x32_bf16 v[140:143], a[212:215], a[84:87], v[140:143]
    s_cmp_lt_u32 s56, 32
    s_cselect_b32 s43, 0, 0x70000000
    s_cselect_b32 s58, s7, 0
    v_mfma_f32_16x16x32_bf16 v[132:135], a[212:215], a[80:83], v[132:135]
    buffer_load_dwordx4 a[244:247], v14, s[20:23], s37 offen offset:3072 sc1
    v_mfma_f32_16x16x32_bf16 v[132:135], a[208:211], a[168:171], v[132:135]
    s_lshr_b32 s41, s64, 7
    ds_read_b64_tr_b16 a[208:209], v9 offset:4096
    v_or_b32 v65, s43, v65
    v_mfma_f32_16x16x32_bf16 v[160:163], a[184:187], a[168:171], v[160:163]
    s_lshl_b32 s41, s41, 8
    ds_read_b64_tr_b16 a[210:211], v9 offset:6144
    s_bfe_u32 s56, s64, 0x10006
    v_mfma_f32_16x16x32_bf16 v[160:163], a[188:191], a[80:83], v[160:163]
    s_lshl3_add_u32 s41, s56, s41
    ds_read_b64_tr_b16 a[212:213], v9 offset:12288
    s_add_u32 s41, s41, 3932320
    v_mfma_f32_16x16x32_bf16 v[168:171], a[188:191], a[84:87], v[168:171]
    s_waitcnt lgkmcnt(5)
    ds_read_b64_tr_b16 a[214:215], v9 offset:14336
    s_add_u32 s37, s61, 16384
    v_mfma_f32_16x16x32_bf16 v[168:171], a[184:187], a[172:175], v[168:171]
    buffer_load_dwordx4 v2, s[8:11], s38 offen lds
    v_mfma_f32_16x16x32_bf16 v[176:179], a[184:187], a[176:179], v[176:179]
    s_waitcnt vmcnt(16)
    s_lshr_b32 s42, s68, 7
    s_lshl_b32 s42, s42, 8
    v_mfma_f32_16x16x32_bf16 v[176:179], a[188:191], a[88:91], v[176:179]
    buffer_store_dword v6, v15, s[24:27], s4 offen offset:160 sc1
    v_mfma_f32_16x16x32_bf16 v[184:187], a[188:191], a[92:95], v[184:187]
    s_bfe_u32 s56, s68, 0x10006
    s_lshl3_add_u32 s42, s56, s42
    s_add_u32 s42, s42, 3932320
    v_mfma_f32_16x16x32_bf16 v[184:187], a[184:187], a[180:183], v[184:187]
    s_sub_u32 s56, s68, s64
    ds_read_b64_tr_b16 a[184:185], v10 offset:4096
    v_and_b32 v56, s56, v56
    v_mfma_f32_16x16x32_bf16 v[188:191], a[192:195], a[180:183], v[188:191]
    buffer_load_dwordx4 a[152:155], v14, s[20:23], s37 offen offset:0 sc1
    v_mfma_f32_16x16x32_bf16 v[188:191], a[196:199], a[92:95], v[188:191]
    s_add_u32 s38, s46, 122880
    ds_read_b64_tr_b16 a[186:187], v10 offset:6144
    v_lshl_add_u32 v64, v57, 3, v56
    v_mfma_f32_16x16x32_bf16 v[180:183], a[196:199], a[88:91], v[180:183]
    s_addk_i32 m0, 4096
    ds_read_b64_tr_b16 a[188:189], v10 offset:12288
    v_add_u32 v55, s64, v64
    v_mfma_f32_16x16x32_bf16 v[180:183], a[192:195], a[176:179], v[180:183]
    s_or_b32 s57, s64, s43
    ds_read_b64_tr_b16 a[190:191], v10 offset:14336
    v_add_u32 v64, s57, v64
    v_mfma_f32_16x16x32_bf16 v[172:175], a[192:195], a[172:175], v[172:175]
    s_add_u32 s55, s43, 3670016
    v_lshrrev_b32 v56, 5, v1
    v_bfe_u32 v57, v1, 4, 1
    v_mfma_f32_16x16x32_bf16 v[172:175], a[196:199], a[84:87], v[172:175]
    s_add_u32 s56, s43, 3211264
    v_lshl_add_u32 v56, v57, 1, v56
    v_mul_u32_u24 v56, 2560, v56
    v_mfma_f32_16x16x32_bf16 v[164:167], a[196:199], a[80:83], v[164:167]
    s_waitcnt lgkmcnt(5)
    v_lshl_add_u32 v55, v55, 1, v56
    v_and_b32 v56, 0x7ff, v54
    v_mfma_f32_16x16x32_bf16 v[164:167], a[192:195], a[168:171], v[164:167]
    ds_read_b64_tr_b16 a[192:193], v11 offset:4096
    v_sub_u32 v56, 2047, v56
    v_mfma_f32_16x16x32_bf16 v[192:195], a[200:203], a[168:171], v[192:195]
    buffer_load_dwordx4 v2, s[8:11], s38 offen lds
    v_mfma_f32_16x16x32_bf16 v[192:195], a[204:207], a[80:83], v[192:195]
    ds_read_b64_tr_b16 a[194:195], v11 offset:6144
    v_mul_u32_u24 v57, 1280, v56
    v_mfma_f32_16x16x32_bf16 v[200:203], a[204:207], a[84:87], v[200:203]
    buffer_load_dwordx4 a[156:159], v14, s[20:23], s37 offen offset:1024 sc1
    v_mfma_f32_16x16x32_bf16 v[200:203], a[200:203], a[172:175], v[200:203]
    s_add_u32 s77, s7, 6
    ds_read_b64_tr_b16 a[196:197], v11 offset:12288
    v_add_u32 v57, v57, v64
    v_mfma_f32_16x16x32_bf16 v[208:211], a[200:203], a[176:179], v[208:211]
    buffer_load_dwordx2 v[66:67], v57, s[12:15], 0 offen
    v_mfma_f32_16x16x32_bf16 v[208:211], a[204:207], a[88:91], v[208:211]
    ds_read_b64_tr_b16 a[198:199], v11 offset:14336
    v_lshlrev_b32 v56, 3, v56
    v_mfma_f32_16x16x32_bf16 v[216:219], a[204:207], a[92:95], v[216:219]
    buffer_load_dwordx2 v[68:69], v56, s[24:27], s56 offen sc1
    v_mfma_f32_16x16x32_bf16 v[216:219], a[200:203], a[180:183], v[216:219]
    s_waitcnt lgkmcnt(5)
    v_and_b32 v54, 0xffff0000, v54
    v_ashrrev_i32 v56, 31, v54
    v_mfma_f32_16x16x32_bf16 v[220:223], a[208:211], a[180:183], v[220:223]
    s_add_u32 s38, s47, 122880
    v_not_b32 v56, v56
    v_or_b32 v56, 0x80000000, v56
    v_mfma_f32_16x16x32_bf16 v[220:223], a[212:215], a[92:95], v[220:223]
    s_addk_i32 m0, 4096
    v_xor_b32 v54, v54, v56
    v_and_b32 v54, 0xffff0000, v54
    v_mfma_f32_16x16x32_bf16 v[212:215], a[212:215], a[88:91], v[212:215]
    s_barrier
    v_mfma_f32_16x16x32_bf16 v[212:215], a[208:211], a[176:179], v[212:215]
    ds_read_b64_tr_b16 a[200:201], v12 offset:20480
    v_mul_f32 v54, s92, v54
    v_mfma_f32_16x16x32_bf16 v[204:207], a[208:211], a[172:175], v[204:207]
    buffer_load_dwordx4 a[160:163], v14, s[20:23], s37 offen offset:2048 sc1
    v_mfma_f32_16x16x32_bf16 v[204:207], a[212:215], a[84:87], v[204:207]
    ds_read_b64_tr_b16 a[202:203], v12 offset:21504
    v_mfma_f32_16x16x32_bf16 v[196:199], a[212:215], a[80:83], v[196:199]
    buffer_load_dwordx4 v2, s[8:11], s38 offen lds
    v_mfma_f32_16x16x32_bf16 v[196:199], a[208:211], a[168:171], v[196:199]
    s_waitcnt lgkmcnt(4)
    ds_read_b64_tr_b16 a[204:205], v12 offset:22528
    v_mfma_f32_16x16x32_bf16 v[224:227], a[184:187], a[168:171], v[224:227]
    ds_read_b64_tr_b16 a[206:207], v12 offset:23552
    v_mfma_f32_16x16x32_bf16 v[224:227], a[188:191], a[80:83], v[224:227]
    ds_read_b64_tr_b16 a[208:209], v13 offset:20480
    v_mfma_f32_16x16x32_bf16 v[232:235], a[188:191], a[84:87], v[232:235]
    ds_read_b64_tr_b16 a[210:211], v13 offset:21504
    v_mfma_f32_16x16x32_bf16 v[232:235], a[184:187], a[172:175], v[232:235]
    ds_read_b64_tr_b16 a[212:213], v13 offset:22528
    v_mfma_f32_16x16x32_bf16 v[240:243], a[184:187], a[176:179], v[240:243]
    s_add_u32 s38, s45, 163840
    ds_read_b64_tr_b16 a[214:215], v13 offset:23552
    v_mfma_f32_16x16x32_bf16 v[240:243], a[188:191], a[88:91], v[240:243]
    v_exp_f32 v54, v54
    v_mfma_f32_16x16x32_bf16 v[248:251], a[188:191], a[92:95], v[248:251]
    buffer_load_dwordx4 a[164:167], v14, s[20:23], s37 offen offset:3072 sc1
    v_mfma_f32_16x16x32_bf16 v[248:251], a[184:187], a[180:183], v[248:251]
    s_waitcnt lgkmcnt(6)
    ds_read_b64_tr_b16 a[184:185], v8 offset:20480
    v_add_f32 v54, 1.0, v54
    v_mfma_f32_16x16x32_bf16 v[252:255], a[192:195], a[180:183], v[252:255]
    s_addk_i32 m0, 4096
    ds_read_b64_tr_b16 a[186:187], v8 offset:22528
    s_sub_u32 s78, s72, s77
    v_mfma_f32_16x16x32_bf16 v[252:255], a[196:199], a[92:95], v[252:255]
    s_sub_u32 s79, s73, s77
    ds_read_b64_tr_b16 a[188:189], v8 offset:28672
    s_max_u32 s78, s78, s79
    v_mfma_f32_16x16x32_bf16 v[244:247], a[196:199], a[88:91], v[244:247]
    s_sub_u32 s79, s74, s77
    ds_read_b64_tr_b16 a[190:191], v8 offset:30720
    s_max_u32 s78, s78, s79
    v_mfma_f32_16x16x32_bf16 v[244:247], a[192:195], a[176:179], v[244:247]
    s_sub_u32 s79, s75, s77
    v_rcp_f32 v54, v54
    v_mfma_f32_16x16x32_bf16 v[236:239], a[192:195], a[172:175], v[236:239]
    buffer_load_dwordx4 v2, s[8:11], s38 offen lds
    v_mfma_f32_16x16x32_bf16 v[236:239], a[196:199], a[84:87], v[236:239]
    s_max_u32 s78, s78, s79
    v_cvt_pk_bf16_f32 v54, 0, v54
    s_add_u32 s37, s59, 20480
    v_mfma_f32_16x16x32_bf16 v[228:231], a[196:199], a[80:83], v[228:231]
    s_waitcnt lgkmcnt(3)
    v_mfma_f32_16x16x32_bf16 v[228:231], a[192:195], a[168:171], v[228:231]
    s_waitcnt vmcnt(24)
    ds_read_b64_tr_b16 a[192:193], v9 offset:20480
    v_lshlrev_b32 v20, 16, v32
    v_mfma_f32_16x16x32_bf16 v[96:99], a[200:203], a[96:99], v[96:99]
    s_cmp_gt_u32 s78, 0
    s_cbranch_scc1 spin_o5
spin_o5_ret:
    v_and_b32 v21, 0xffff0000, v32
    v_mfma_f32_16x16x32_bf16 v[96:99], a[204:207], a[112:115], v[96:99]
    buffer_load_dwordx4 a[168:171], v14, s[20:23], s37 offen offset:0 sc1
    v_mfma_f32_16x16x32_bf16 v[104:107], a[204:207], a[116:119], v[104:107]
    s_xor_b32 s77, s50, 2
    ds_read_b64_tr_b16 a[194:195], v9 offset:22528
    v_sub_f32 v20, v20, v38
    v_mfma_f32_16x16x32_bf16 v[104:107], a[200:203], a[100:103], v[104:107]
    s_lshl_b32 s77, s77, 10
    ds_read_b64_tr_b16 a[196:197], v9 offset:28672
    v_sub_f32 v21, v21, v38
    v_mfma_f32_16x16x32_bf16 v[112:115], a[200:203], a[104:107], v[112:115]
    s_add_u32 s38, s46, 163840
    ds_read_b64_tr_b16 a[198:199], v9 offset:30720
    v_cvt_pk_bf16_f32 v20, 0, v20
    v_mfma_f32_16x16x32_bf16 v[112:115], a[204:207], a[120:123], v[112:115]
    s_addk_i32 m0, 4096
    v_cvt_pk_bf16_f32 v21, 0, v21
    v_mul_f32 v20, v20, v39
    v_mfma_f32_16x16x32_bf16 v[120:123], a[204:207], a[124:127], v[120:123]
    s_waitcnt vmcnt(22)
    v_permlane16_swap_b32 v24, v26
    v_mfma_f32_16x16x32_bf16 v[120:123], a[200:203], a[108:111], v[120:123]
    ds_read_b64_tr_b16 a[200:201], v10 offset:20480
    v_mul_f32 v21, v21, v39
    v_mfma_f32_16x16x32_bf16 v[124:127], a[208:211], a[108:111], v[124:127]
    ds_read_b64_tr_b16 a[202:203], v10 offset:22528
    v_cvt_pk_bf16_f32 v20, 0, v20
    v_mfma_f32_16x16x32_bf16 v[124:127], a[212:215], a[124:127], v[124:127]
    ds_read_b64_tr_b16 a[204:205], v10 offset:28672
    v_cvt_pk_bf16_f32 v21, 0, v21
    v_mfma_f32_16x16x32_bf16 v[116:119], a[212:215], a[120:123], v[116:119]
    buffer_load_dwordx4 a[172:175], v14, s[20:23], s37 offen offset:1024 sc1
    v_mfma_f32_16x16x32_bf16 v[116:119], a[208:211], a[104:107], v[116:119]
    buffer_load_dwordx4 v2, s[8:11], s38 offen lds
    v_mfma_f32_16x16x32_bf16 v[108:111], a[208:211], a[100:103], v[108:111]
    ds_read_b64_tr_b16 a[206:207], v10 offset:30720
    v_mul_f32 v23, s92, v20
    v_mfma_f32_16x16x32_bf16 v[108:111], a[212:215], a[116:119], v[108:111]
    s_waitcnt lgkmcnt(4)
    v_exp_f32 v23, v23
    v_mfma_f32_16x16x32_bf16 v[100:103], a[212:215], a[112:115], v[100:103]
    v_permlane16_swap_b32 v25, v27
    v_mfma_f32_16x16x32_bf16 v[100:103], a[208:211], a[96:99], v[100:103]
    ds_read_b64_tr_b16 a[208:209], v11 offset:20480
    v_mul_f32 v36, s92, v21
    v_mfma_f32_16x16x32_bf16 v[128:131], a[184:187], a[96:99], v[128:131]
    s_add_u32 s38, s47, 163840
    ds_read_b64_tr_b16 a[210:211], v11 offset:22528
    v_add_f32 v23, 1.0, v23
    v_mfma_f32_16x16x32_bf16 v[128:131], a[188:191], a[112:115], v[128:131]
    ds_read_b64_tr_b16 a[212:213], v11 offset:28672
    v_mfma_f32_16x16x32_bf16 v[136:139], a[188:191], a[116:119], v[136:139]
    s_addk_i32 m0, 4096
    ds_read_b64_tr_b16 a[214:215], v11 offset:30720
    v_mfma_f32_16x16x32_bf16 v[136:139], a[184:187], a[100:103], v[136:139]
    s_waitcnt vmcnt(21)
    v_exp_f32 v36, v36
    v_mfma_f32_16x16x32_bf16 v[144:147], a[184:187], a[104:107], v[144:147]
    buffer_load_dwordx4 a[176:179], v14, s[20:23], s37 offen offset:2048 sc1
    v_mfma_f32_16x16x32_bf16 v[144:147], a[188:191], a[120:123], v[144:147]
    v_rcp_f32 v23, v23
    v_mfma_f32_16x16x32_bf16 v[152:155], a[188:191], a[124:127], v[152:155]
    v_permlane16_swap_b32 v28, v30
    v_mfma_f32_16x16x32_bf16 v[152:155], a[184:187], a[108:111], v[152:155]
    ds_read_b64_tr_b16 a[184:185], v8 offset:24576
    v_add_f32 v36, 1.0, v36
    v_mfma_f32_16x16x32_bf16 v[156:159], a[192:195], a[108:111], v[156:159]
    buffer_load_dwordx4 v2, s[8:11], s38 offen lds
    v_mfma_f32_16x16x32_bf16 v[156:159], a[196:199], a[124:127], v[156:159]
    ds_read_b64_tr_b16 a[186:187], v8 offset:26624
    v_mul_f32 v20, v20, v23
    v_mfma_f32_16x16x32_bf16 v[148:151], a[196:199], a[120:123], v[148:151]
    ds_read_b64_tr_b16 a[188:189], v8 offset:32768
    v_mfma_f32_16x16x32_bf16 v[148:151], a[192:195], a[104:107], v[148:151]
    s_waitcnt lgkmcnt(3)
    ds_read_b64_tr_b16 a[190:191], v8 offset:34816
    v_subrev_u32 v8, 73728, v8
    v_mfma_f32_16x16x32_bf16 v[140:143], a[192:195], a[100:103], v[140:143]
    v_rcp_f32 v36, v36
    v_mfma_f32_16x16x32_bf16 v[140:143], a[196:199], a[116:119], v[140:143]
    v_permlane16_swap_b32 v29, v31
    v_mfma_f32_16x16x32_bf16 v[132:135], a[196:199], a[112:115], v[132:135]
    buffer_load_dwordx4 a[180:183], v14, s[20:23], s37 offen offset:3072 sc1
    v_mfma_f32_16x16x32_bf16 v[132:135], a[192:195], a[96:99], v[132:135]
    s_add_u32 s38, s45, 204800
    ds_read_b64_tr_b16 a[192:193], v9 offset:24576
    v_mul_f32 v21, v21, v36
    v_mfma_f32_16x16x32_bf16 v[160:163], a[200:203], a[96:99], v[160:163]
    s_addk_i32 m0, 4096
    ds_read_b64_tr_b16 a[194:195], v9 offset:26624
    v_cvt_pk_bf16_f32 v48, v20, v21
    v_mfma_f32_16x16x32_bf16 v[160:163], a[204:207], a[112:115], v[160:163]
    ds_read_b64_tr_b16 a[196:197], v9 offset:32768
    v_lshlrev_b32 v20, 16, v33
    v_mfma_f32_16x16x32_bf16 v[168:171], a[204:207], a[116:119], v[168:171]
    s_add_u32 s37, s60, 20480
    ds_read_b64_tr_b16 a[198:199], v9 offset:34816
    v_subrev_u32 v9, 73728, v9
    v_mfma_f32_16x16x32_bf16 v[168:171], a[200:203], a[100:103], v[168:171]
    v_and_b32 v21, 0xffff0000, v33
    v_sub_f32 v20, v20, v38
    v_mfma_f32_16x16x32_bf16 v[176:179], a[200:203], a[104:107], v[176:179]
    v_sub_f32 v21, v21, v38
    v_cvt_pk_bf16_f32 v20, 0, v20
    v_mfma_f32_16x16x32_bf16 v[176:179], a[204:207], a[120:123], v[176:179]
    v_cvt_pk_bf16_f32 v21, 0, v21
    v_mul_f32 v20, v20, v39
    v_mfma_f32_16x16x32_bf16 v[184:187], a[204:207], a[124:127], v[184:187]
    buffer_load_dwordx4 v2, s[8:11], s38 offen lds
    v_mfma_f32_16x16x32_bf16 v[184:187], a[200:203], a[108:111], v[184:187]
    ds_read_b64_tr_b16 a[200:201], v10 offset:24576
    v_mul_f32 v21, v21, v39
    v_mfma_f32_16x16x32_bf16 v[188:191], a[208:211], a[108:111], v[188:191]
    buffer_load_dwordx4 a[80:83], v14, s[20:23], s37 offen offset:0 sc1
    v_mfma_f32_16x16x32_bf16 v[188:191], a[212:215], a[124:127], v[188:191]
    ds_read_b64_tr_b16 a[202:203], v10 offset:26624
    v_cvt_pk_bf16_f32 v20, 0, v20
    v_mfma_f32_16x16x32_bf16 v[180:183], a[212:215], a[120:123], v[180:183]
    ds_read_b64_tr_b16 a[204:205], v10 offset:32768
    v_cvt_pk_bf16_f32 v21, 0, v21
    v_mfma_f32_16x16x32_bf16 v[180:183], a[208:211], a[104:107], v[180:183]
    s_waitcnt lgkmcnt(3)
    ds_read_b64_tr_b16 a[206:207], v10 offset:34816
    v_subrev_u32 v10, 73728, v10
    v_mfma_f32_16x16x32_bf16 v[172:175], a[208:211], a[100:103], v[172:175]
    s_add_u32 s38, s46, 204800
    v_mul_f32 v23, s92, v20
    v_mul_f32 v36, s92, v21
    v_mfma_f32_16x16x32_bf16 v[172:175], a[212:215], a[116:119], v[172:175]
    v_exp_f32 v23, v23
    v_mfma_f32_16x16x32_bf16 v[164:167], a[212:215], a[112:115], v[164:167]
    s_addk_i32 m0, 4096
    v_exp_f32 v36, v36
    v_mfma_f32_16x16x32_bf16 v[164:167], a[208:211], a[96:99], v[164:167]
    ds_read_b64_tr_b16 a[208:209], v11 offset:24576
    v_add_f32 v23, 1.0, v23
    v_mfma_f32_16x16x32_bf16 v[192:195], a[184:187], a[96:99], v[192:195]
    ds_read_b64_tr_b16 a[210:211], v11 offset:26624
    v_add_f32 v36, 1.0, v36
    v_mfma_f32_16x16x32_bf16 v[192:195], a[188:191], a[112:115], v[192:195]
    ds_read_b64_tr_b16 a[212:213], v11 offset:32768
    v_mfma_f32_16x16x32_bf16 v[200:203], a[188:191], a[116:119], v[200:203]
    buffer_load_dwordx4 a[84:87], v14, s[20:23], s37 offen offset:1024 sc1
    v_mfma_f32_16x16x32_bf16 v[200:203], a[184:187], a[100:103], v[200:203]
    ds_read_b64_tr_b16 a[214:215], v11 offset:34816
    v_subrev_u32 v11, 73728, v11
    v_mfma_f32_16x16x32_bf16 v[208:211], a[184:187], a[104:107], v[208:211]
    buffer_load_dwordx4 v2, s[8:11], s38 offen lds
    v_mfma_f32_16x16x32_bf16 v[208:211], a[188:191], a[120:123], v[208:211]
    v_rcp_f32 v23, v23
    v_mfma_f32_16x16x32_bf16 v[216:219], a[188:191], a[124:127], v[216:219]
    v_rcp_f32 v36, v36
    v_mfma_f32_16x16x32_bf16 v[216:219], a[184:187], a[108:111], v[216:219]
    v_mul_f32 v20, v20, v23
    v_mul_f32 v21, v21, v36
    v_mfma_f32_16x16x32_bf16 v[220:223], a[192:195], a[108:111], v[220:223]
    v_cvt_pk_bf16_f32 v49, v20, v21
    v_lshlrev_b32 v20, 16, v24
    v_mfma_f32_16x16x32_bf16 v[220:223], a[196:199], a[124:127], v[220:223]
    s_waitcnt lgkmcnt(0)
    v_and_b32 v21, 0xffff0000, v24
    v_sub_f32 v20, v20, v16
    v_mfma_f32_16x16x32_bf16 v[212:215], a[196:199], a[120:123], v[212:215]
    s_barrier
    v_mfma_f32_16x16x32_bf16 v[212:215], a[192:195], a[104:107], v[212:215]
    s_add_u32 s38, s47, 204800
    ds_read_b64_tr_b16 a[184:185], v12 offset:49152
    v_sub_f32 v21, v21, v16
    v_mfma_f32_16x16x32_bf16 v[204:207], a[192:195], a[100:103], v[204:207]
    buffer_load_dwordx4 a[88:91], v14, s[20:23], s37 offen offset:2048 sc1
    v_mfma_f32_16x16x32_bf16 v[204:207], a[196:199], a[116:119], v[204:207]
    s_addk_i32 m0, 4096
    ds_read_b64_tr_b16 a[186:187], v12 offset:50176
    v_cvt_pk_bf16_f32 v20, 0, v20
    v_mfma_f32_16x16x32_bf16 v[196:199], a[196:199], a[112:115], v[196:199]
    s_waitcnt vmcnt(16)
    ds_read_b64_tr_b16 a[188:189], v12 offset:51200
    v_cvt_pk_bf16_f32 v21, 0, v21
    v_mfma_f32_16x16x32_bf16 v[196:199], a[192:195], a[96:99], v[196:199]
    ds_read_b64_tr_b16 a[190:191], v12 offset:52224
    v_mul_f32 v20, v20, v17
    v_mfma_f32_16x16x32_bf16 v[224:227], a[200:203], a[96:99], v[224:227]
    ds_read_b64_tr_b16 a[192:193], v13 offset:49152
    v_mul_f32 v21, v21, v17
    v_mfma_f32_16x16x32_bf16 v[224:227], a[204:207], a[112:115], v[224:227]
    ds_read_b64_tr_b16 a[194:195], v13 offset:50176
    v_cvt_pk_bf16_f32 v20, 0, v20
    v_mfma_f32_16x16x32_bf16 v[232:235], a[204:207], a[116:119], v[232:235]
    buffer_load_dwordx4 v2, s[8:11], s38 offen lds
    v_mfma_f32_16x16x32_bf16 v[232:235], a[200:203], a[100:103], v[232:235]
    ds_read_b64_tr_b16 a[196:197], v13 offset:51200
    v_cvt_pk_bf16_f32 v21, 0, v21
    v_mfma_f32_16x16x32_bf16 v[240:243], a[200:203], a[104:107], v[240:243]
    ds_read_b64_tr_b16 a[198:199], v13 offset:52224
    v_mul_f32 v23, s92, v20
    v_mfma_f32_16x16x32_bf16 v[240:243], a[204:207], a[120:123], v[240:243]
    v_exp_f32 v23, v23
    v_mfma_f32_16x16x32_bf16 v[248:251], a[204:207], a[124:127], v[248:251]
    buffer_load_dwordx4 a[92:95], v14, s[20:23], s37 offen offset:3072 sc1
    v_mfma_f32_16x16x32_bf16 v[248:251], a[200:203], a[108:111], v[248:251]
    ds_read_b64_tr_b16 a[200:201], v12 offset:53248
    v_mul_f32 v36, s92, v21
    v_mfma_f32_16x16x32_bf16 v[252:255], a[208:211], a[108:111], v[252:255]
    ds_read_b64_tr_b16 a[202:203], v12 offset:54272
    v_lshlrev_b32 v50, 16, v66
    v_mfma_f32_16x16x32_bf16 v[252:255], a[212:215], a[124:127], v[252:255]
    s_waitcnt vmcnt(17)
    ds_read_b64_tr_b16 a[204:205], v12 offset:55296
    v_and_b32 v51, 0xffff0000, v66
    v_mfma_f32_16x16x32_bf16 v[244:247], a[212:215], a[120:123], v[244:247]
    s_waitcnt lgkmcnt(4)
    ds_read_b64_tr_b16 a[206:207], v12 offset:56320
    v_lshlrev_b32 v52, 16, v67
    v_mfma_f32_16x16x32_bf16 v[244:247], a[208:211], a[104:107], v[244:247]
    s_add_u32 s37, s61, 20480
    v_exp_f32 v36, v36
    v_mfma_f32_16x16x32_bf16 v[236:239], a[208:211], a[100:103], v[236:239]
    v_and_b32 v53, 0xffff0000, v67
    v_sub_f32 v50, v50, v68
    v_mfma_f32_16x16x32_bf16 v[236:239], a[212:215], a[116:119], v[236:239]
    v_sub_f32 v51, v51, v68
    v_sub_f32 v52, v52, v68
    v_mfma_f32_16x16x32_bf16 v[228:231], a[212:215], a[112:115], v[228:231]
    v_sub_f32 v53, v53, v68
    v_cvt_pk_bf16_f32 v50, 0, v50
    v_mfma_f32_16x16x32_bf16 v[228:231], a[208:211], a[96:99], v[228:231]
    ds_read_b64_tr_b16 a[208:209], v13 offset:53248
    v_cvt_pk_bf16_f32 v51, 0, v51
    v_mfma_f32_16x16x32_bf16 v[96:99], a[184:187], a[128:131], v[96:99]
    buffer_load_dwordx4 a[96:99], v14, s[20:23], s37 offen offset:0 sc1
    v_mfma_f32_16x16x32_bf16 v[96:99], a[188:191], a[0:3], v[96:99]
    ds_read_b64_tr_b16 a[210:211], v13 offset:54272
    v_cvt_pk_bf16_f32 v52, 0, v52
    v_mfma_f32_16x16x32_bf16 v[104:107], a[188:191], a[4:7], v[104:107]
    ds_read_b64_tr_b16 a[212:213], v13 offset:55296
    v_cvt_pk_bf16_f32 v53, 0, v53
    v_mfma_f32_16x16x32_bf16 v[104:107], a[184:187], a[132:135], v[104:107]
    ds_read_b64_tr_b16 a[214:215], v13 offset:56320
    v_mul_f32 v50, v50, v69
    v_mfma_f32_16x16x32_bf16 v[112:115], a[184:187], a[136:139], v[112:115]
    v_mul_f32 v51, v51, v69
    v_mul_f32 v52, v52, v69
    v_mfma_f32_16x16x32_bf16 v[112:115], a[188:191], a[8:11], v[112:115]
    v_mul_f32 v53, v53, v69
    v_cvt_pk_bf16_f32 v50, 0, v50
    v_mfma_f32_16x16x32_bf16 v[120:123], a[188:191], a[12:15], v[120:123]
    s_waitcnt lgkmcnt(3)
    v_cvt_pk_bf16_f32 v51, 0, v51
    v_cvt_pk_bf16_f32 v52, 0, v52
    v_mfma_f32_16x16x32_bf16 v[120:123], a[184:187], a[140:143], v[120:123]
    ds_read_b64_tr_b16 a[184:185], v12 offset:57344
    v_cvt_pk_bf16_f32 v53, 0, v53
    v_mfma_f32_16x16x32_bf16 v[124:127], a[192:195], a[140:143], v[124:127]
    ds_read_b64_tr_b16 a[186:187], v12 offset:58368
    v_add_f32 v23, 1.0, v23
    v_mfma_f32_16x16x32_bf16 v[124:127], a[196:199], a[12:15], v[124:127]
    ds_read_b64_tr_b16 a[188:189], v12 offset:59392
    v_add_f32 v36, 1.0, v36
    v_mfma_f32_16x16x32_bf16 v[116:119], a[196:199], a[8:11], v[116:119]
    buffer_load_dwordx4 a[100:103], v14, s[20:23], s37 offen offset:1024 sc1
    v_mfma_f32_16x16x32_bf16 v[116:119], a[192:195], a[136:139], v[116:119]
    s_lshl2_add_u32 s60, s54, s51
    ds_read_b64_tr_b16 a[190:191], v12 offset:60416
    v_lshrrev_b32 v70, 1, v1
    v_mfma_f32_16x16x32_bf16 v[108:111], a[192:195], a[132:135], v[108:111]
    s_mul_i32 s60, s60, 163840
    v_min_u32 v70, 1, v70
    v_and_b32 v39, 7, v1
    v_mfma_f32_16x16x32_bf16 v[108:111], a[196:199], a[4:7], v[108:111]
    s_add_u32 s60, s60, 50331648
    v_rcp_f32 v23, v23
    v_mfma_f32_16x16x32_bf16 v[100:103], a[196:199], a[0:3], v[100:103]
    s_mul_i32 s56, s53, 2560
    v_rcp_f32 v36, v36
    v_mfma_f32_16x16x32_bf16 v[100:103], a[192:195], a[128:131], v[100:103]
    s_add_u32 s59, s60, s56
    ds_read_b64_tr_b16 a[192:193], v13 offset:57344
    v_mul_f32 v20, v20, v23
    v_mfma_f32_16x16x32_bf16 v[96:99], a[200:203], a[16:19], v[96:99]
    s_mul_i32 s56, s53, 20480
    ds_read_b64_tr_b16 a[194:195], v13 offset:58368
    v_mul_f32 v21, v21, v36
    v_mfma_f32_16x16x32_bf16 v[96:99], a[204:207], a[32:35], v[96:99]
    s_add_u32 s60, s60, s56
    ds_read_b64_tr_b16 a[196:197], v13 offset:59392
    v_cvt_pk_bf16_f32 v40, v20, v21
    v_mfma_f32_16x16x32_bf16 v[104:107], a[204:207], a[36:39], v[104:107]
    s_andn2_b32 s61, s2, 7
    ds_read_b64_tr_b16 a[198:199], v13 offset:60416
    v_lshlrev_b32 v20, 16, v25
    v_mfma_f32_16x16x32_bf16 v[104:107], a[200:203], a[20:23], v[104:107]
    s_waitcnt lgkmcnt(4)
    v_and_b32 v21, 0xffff0000, v25
    v_sub_f32 v20, v20, v16
    v_mfma_f32_16x16x32_bf16 v[112:115], a[200:203], a[24:27], v[112:115]
    buffer_load_dwordx4 a[104:107], v14, s[20:23], s37 offen offset:2048 sc1
    v_mfma_f32_16x16x32_bf16 v[112:115], a[204:207], a[40:43], v[112:115]
    s_lshl_b32 s61, s61, 2
    v_sub_f32 v21, v21, v16
    v_cvt_pk_bf16_f32 v20, 0, v20
    v_mfma_f32_16x16x32_bf16 v[120:123], a[204:207], a[44:47], v[120:123]
    s_add_u32 s61, s61, s3
    v_cvt_pk_bf16_f32 v21, 0, v21
    v_mul_f32 v20, v20, v17
    v_mfma_f32_16x16x32_bf16 v[120:123], a[200:203], a[28:31], v[120:123]
pg_14:
    s_cbranch_execz pg_backL
    s_lshl_b32 s61, s61, 7
    ds_read_b64_tr_b16 a[200:201], v12 offset:61440
    v_mul_f32 v21, v21, v17
    v_mfma_f32_16x16x32_bf16 v[124:127], a[208:211], a[28:31], v[124:127]
    s_add_u32 s61, s61, 4194304
    ds_read_b64_tr_b16 a[202:203], v12 offset:62464
    v_cvt_pk_bf16_f32 v20, 0, v20
    v_mfma_f32_16x16x32_bf16 v[124:127], a[212:215], a[44:47], v[124:127]
    s_and_b32 s56, s53, 1
    ds_read_b64_tr_b16 a[204:205], v12 offset:63488
    v_xor_b32 v7, s56, v1
    v_mfma_f32_16x16x32_bf16 v[116:119], a[212:215], a[40:43], v[116:119]
    s_andn2_b32 s56, 4, s53
    ds_read_b64_tr_b16 a[206:207], v12 offset:64512
    v_add_u32 v12, 65536, v12
    v_mfma_f32_16x16x32_bf16 v[116:119], a[208:211], a[24:27], v[116:119]
    s_lshl_b32 s56, s56, 1
    v_add_u32 v2, 1, v7
    v_lshlrev_b32 v7, 2, v7
    v_mfma_f32_16x16x32_bf16 v[108:111], a[208:211], a[20:23], v[108:111]
    s_add_u32 s67, s61, s67
    v_lshl_add_u32 v7, v1, 9, v7
    v_lshl_or_b32 v7, v70, 30, v7
    v_mfma_f32_16x16x32_bf16 v[108:111], a[212:215], a[36:39], v[108:111]
    s_add_u32 s77, s61, s77
    v_lshrrev_b32 v70, 4, v1
    v_lshl_add_u32 v39, v70, 3, v39
    v_mfma_f32_16x16x32_bf16 v[100:103], a[212:215], a[32:35], v[100:103]
    buffer_load_dwordx4 a[108:111], v14, s[20:23], s37 offen offset:3072 sc1
    v_mfma_f32_16x16x32_bf16 v[100:103], a[208:211], a[16:19], v[100:103]
    s_add_u32 s38, s45, 81920
    ds_read_b64_tr_b16 a[208:209], v13 offset:61440
    v_lshlrev_b32 v39, 4, v39
    v_mfma_f32_16x16x32_bf16 v[96:99], a[184:187], a[48:51], v[96:99]
    s_add_u32 m0, s63, 135168
    ds_read_b64_tr_b16 a[210:211], v13 offset:62464
    v_and_b32 v70, 8, v1
    v_mfma_f32_16x16x32_bf16 v[96:99], a[188:191], a[64:67], v[96:99]
    buffer_load_dwordx4 v3, s[8:11], s38 offen lds
    v_mfma_f32_16x16x32_bf16 v[104:107], a[188:191], a[68:71], v[104:107]
    s_add_u32 s38, s46, 81920
    ds_read_b64_tr_b16 a[212:213], v13 offset:63488
    v_mul_u32_u24 v38, 1280, v70
    v_mfma_f32_16x16x32_bf16 v[104:107], a[184:187], a[52:55], v[104:107]
    s_waitcnt lgkmcnt(3)
    ds_read_b64_tr_b16 a[214:215], v13 offset:64512
    v_add_u32 v13, 65536, v13
    v_mfma_f32_16x16x32_bf16 v[112:115], a[184:187], a[56:59], v[112:115]
    s_addk_i32 m0, -4096
    v_add_u32 v38, v38, v39
    v_xor_b32 v70, s56, v70
    v_mfma_f32_16x16x32_bf16 v[112:115], a[188:191], a[72:75], v[112:115]
    buffer_load_dwordx4 v3, s[8:11], s38 offen lds
    v_mfma_f32_16x16x32_bf16 v[120:123], a[188:191], a[76:79], v[120:123]
    s_add_u32 s38, s47, 81920
    v_add_u32 v39, v39, v70
    v_cmp_ne_u32 s[74:75], 0, v70
    v_mfma_f32_16x16x32_bf16 v[120:123], a[184:187], a[60:63], v[120:123]
    s_add_u32 m0, s63, 126976
    ds_read_b64_tr_b16 a[184:185], v12 offset:0
    v_cvt_pk_bf16_f32 v21, 0, v21
    v_mfma_f32_16x16x32_bf16 v[124:127], a[192:195], a[60:63], v[124:127]
    ds_read_b64_tr_b16 a[186:187], v12 offset:1024
    v_mul_f32 v23, s92, v20
    v_mfma_f32_16x16x32_bf16 v[124:127], a[196:199], a[76:79], v[124:127]
    ds_read_b64_tr_b16 a[188:189], v12 offset:2048
    v_mul_f32 v36, s92, v21
    v_mfma_f32_16x16x32_bf16 v[116:119], a[196:199], a[72:75], v[116:119]
    buffer_load_dwordx4 v3, s[8:11], s38 offen lds
    v_mfma_f32_16x16x32_bf16 v[116:119], a[192:195], a[56:59], v[116:119]
    ds_read_b64_tr_b16 a[190:191], v12 offset:3072
    v_mfma_f32_16x16x32_bf16 v[108:111], a[192:195], a[52:55], v[108:111]
    v_exp_f32 v23, v23
    v_mfma_f32_16x16x32_bf16 v[108:111], a[196:199], a[68:71], v[108:111]
    v_exp_f32 v36, v36
    v_mfma_f32_16x16x32_bf16 v[100:103], a[196:199], a[64:67], v[100:103]
    s_add_u32 s38, s45, 122880
    v_add_f32 v23, 1.0, v23
    v_add_f32 v36, 1.0, v36
    v_mfma_f32_16x16x32_bf16 v[100:103], a[192:195], a[48:51], v[100:103]
    ds_read_b64_tr_b16 a[192:193], v13 offset:0
    v_mfma_f32_16x16x32_bf16 v[96:99], a[200:203], a[216:219], v[96:99]
    s_addk_i32 m0, -4096
    ds_read_b64_tr_b16 a[194:195], v13 offset:1024
    v_mfma_f32_16x16x32_bf16 v[96:99], a[204:207], a[232:235], v[96:99]
    ds_read_b64_tr_b16 a[196:197], v13 offset:2048
    v_mfma_f32_16x16x32_bf16 v[104:107], a[204:207], a[236:239], v[104:107]
    s_waitcnt lgkmcnt(3)
    ds_read_b64_tr_b16 a[198:199], v13 offset:3072
    v_mfma_f32_16x16x32_bf16 v[104:107], a[200:203], a[220:223], v[104:107]
    v_rcp_f32 v23, v23
    v_mfma_f32_16x16x32_bf16 v[112:115], a[200:203], a[224:227], v[112:115]
    v_rcp_f32 v36, v36
    v_mfma_f32_16x16x32_bf16 v[112:115], a[204:207], a[240:243], v[112:115]
    v_mul_f32 v20, v20, v23
    v_mul_f32 v21, v21, v36
    v_mfma_f32_16x16x32_bf16 v[120:123], a[204:207], a[244:247], v[120:123]
    buffer_load_dwordx4 v3, s[8:11], s38 offen lds
    v_mfma_f32_16x16x32_bf16 v[120:123], a[200:203], a[228:231], v[120:123]
    ds_read_b64_tr_b16 a[200:201], v12 offset:4096
    v_cvt_pk_bf16_f32 v41, v20, v21
    v_mfma_f32_16x16x32_bf16 v[124:127], a[208:211], a[228:231], v[124:127]
    ds_read_b64_tr_b16 a[202:203], v12 offset:5120
    v_lshlrev_b32 v20, 16, v26
    v_mfma_f32_16x16x32_bf16 v[124:127], a[212:215], a[244:247], v[124:127]
    ds_read_b64_tr_b16 a[204:205], v12 offset:6144
    v_and_b32 v21, 0xffff0000, v26
    v_mfma_f32_16x16x32_bf16 v[116:119], a[212:215], a[240:243], v[116:119]
    buffer_load_dword v58, v65, s[24:27], s41 offen sc1
    v_mfma_f32_16x16x32_bf16 v[116:119], a[208:211], a[224:227], v[116:119]
    buffer_load_dword v59, v65, s[24:27], s42 offen sc1
    v_mfma_f32_16x16x32_bf16 v[108:111], a[208:211], a[220:223], v[108:111]
    s_add_u32 s38, s46, 122880
    ds_read_b64_tr_b16 a[206:207], v12 offset:7168
    v_sub_f32 v20, v20, v16
    v_mfma_f32_16x16x32_bf16 v[108:111], a[212:215], a[236:239], v[108:111]
    s_addk_i32 m0, -4096
    v_sub_f32 v21, v21, v16
    v_cvt_pk_bf16_f32 v20, 0, v20
    v_mfma_f32_16x16x32_bf16 v[100:103], a[212:215], a[232:235], v[100:103]
    s_waitcnt vmcnt(22)
    v_cvt_pk_bf16_f32 v21, 0, v21
    v_mul_f32 v20, v20, v17
    v_mfma_f32_16x16x32_bf16 v[100:103], a[208:211], a[216:219], v[100:103]
    s_waitcnt vmcnt(21)
    ds_read_b64_tr_b16 a[208:209], v13 offset:4096
    v_mul_f32 v21, v21, v17
    v_mfma_f32_16x16x32_bf16 v[96:99], a[184:187], a[152:155], v[96:99]
    ds_read_b64_tr_b16 a[210:211], v13 offset:5120
    v_cvt_pk_bf16_f32 v20, 0, v20
    v_mfma_f32_16x16x32_bf16 v[96:99], a[188:191], a[168:171], v[96:99]
    ds_read_b64_tr_b16 a[212:213], v13 offset:6144
    v_cvt_pk_bf16_f32 v21, 0, v21
    v_mfma_f32_16x16x32_bf16 v[104:107], a[188:191], a[172:175], v[104:107]
    s_waitcnt vmcnt(19) lgkmcnt(4)
    ds_read_b64_tr_b16 a[214:215], v13 offset:7168
    v_mul_f32 v23, s92, v20
    v_mfma_f32_16x16x32_bf16 v[104:107], a[184:187], a[156:159], v[104:107]
    buffer_load_dwordx4 v3, s[8:11], s38 offen lds
    v_mfma_f32_16x16x32_bf16 v[112:115], a[184:187], a[160:163], v[112:115]
    s_waitcnt vmcnt(18)
    v_exp_f32 v23, v23
    v_mfma_f32_16x16x32_bf16 v[112:115], a[188:191], a[176:179], v[112:115]
    v_mul_f32 v36, s92, v21
    v_add_f32 v23, 1.0, v23
    v_mfma_f32_16x16x32_bf16 v[120:123], a[188:191], a[180:183], v[120:123]
    s_add_u32 s38, s47, 122880
    v_exp_f32 v36, v36
    v_mfma_f32_16x16x32_bf16 v[120:123], a[184:187], a[164:167], v[120:123]
    v_rcp_f32 v23, v23
    v_mfma_f32_16x16x32_bf16 v[124:127], a[192:195], a[164:167], v[124:127]
    s_addk_i32 m0, -4096
    v_add_f32 v36, 1.0, v36
    v_mul_f32 v20, v20, v23
    v_mfma_f32_16x16x32_bf16 v[124:127], a[196:199], a[180:183], v[124:127]
    v_rcp_f32 v36, v36
    v_mfma_f32_16x16x32_bf16 v[116:119], a[196:199], a[176:179], v[116:119]
    s_barrier
    v_mfma_f32_16x16x32_bf16 v[116:119], a[192:195], a[160:163], v[116:119]
    ds_read_b64_tr_b16 a[184:185], v8 offset:0
    v_mul_f32 v21, v21, v36
    v_mfma_f32_16x16x32_bf16 v[108:111], a[192:195], a[156:159], v[108:111]
    ds_read_b64_tr_b16 a[186:187], v8 offset:2048
    v_cvt_pk_bf16_f32 v42, v20, v21
    v_mfma_f32_16x16x32_bf16 v[108:111], a[196:199], a[172:175], v[108:111]
    s_waitcnt vmcnt(16)
    ds_read_b64_tr_b16 a[188:189], v8 offset:4096
    v_lshlrev_b32 v20, 16, v27
    v_mfma_f32_16x16x32_bf16 v[100:103], a[196:199], a[168:171], v[100:103]
    buffer_load_dwordx4 v3, s[8:11], s38 offen lds
    v_mfma_f32_16x16x32_bf16 v[100:103], a[192:195], a[152:155], v[100:103]
    s_waitcnt vmcnt(10) lgkmcnt(3)
    ds_read_b64_tr_b16 a[190:191], v8 offset:6144
    v_and_b32 v21, 0xffff0000, v27
    v_mfma_f32_16x16x32_bf16 v[96:99], a[200:203], a[80:83], v[96:99]
    ds_read_b64_tr_b16 a[192:193], v9 offset:0
    v_sub_f32 v20, v20, v16
    v_mfma_f32_16x16x32_bf16 v[96:99], a[204:207], a[96:99], v[96:99]
    ds_read_b64_tr_b16 a[194:195], v9 offset:2048
    v_sub_f32 v21, v21, v16
    v_mfma_f32_16x16x32_bf16 v[104:107], a[204:207], a[100:103], v[104:107]
    s_waitcnt vmcnt(9)
    ds_read_b64_tr_b16 a[196:197], v9 offset:4096
    v_lshlrev_b32 v16, 4, v2
    v_mfma_f32_16x16x32_bf16 v[104:107], a[200:203], a[84:87], v[104:107]
    s_waitcnt vmcnt(8)
    ds_read_b64_tr_b16 a[198:199], v9 offset:6144
    v_cvt_pk_bf16_f32 v96, v96, v97
    v_mfma_f32_16x16x32_bf16 v[112:115], a[200:203], a[88:91], v[112:115]
    s_add_u32 s38, s45, 163840
    v_cvt_pk_bf16_f32 v97, v98, v99
    v_cvt_pk_bf16_f32 v20, 0, v20
    v_mfma_f32_16x16x32_bf16 v[112:115], a[204:207], a[104:107], v[112:115]
    s_xor_b32 s78, s53, 3
    v_cvt_pk_bf16_f32 v104, v104, v105
    v_cvt_pk_bf16_f32 v105, v106, v107
    v_mfma_f32_16x16x32_bf16 v[120:123], a[204:207], a[108:111], v[120:123]
    s_and_b32 s78, s78, 3
    v_cvt_pk_bf16_f32 v21, 0, v21
    v_mul_f32 v20, v20, v17
    v_mfma_f32_16x16x32_bf16 v[120:123], a[200:203], a[92:95], v[120:123]
    s_mul_i32 s78, s78, 2560
    ds_read_b64_tr_b16 a[200:201], v8 offset:8192
    v_cvt_pk_bf16_f32 v112, v112, v113
    v_mfma_f32_16x16x32_bf16 v[124:127], a[208:211], a[92:95], v[124:127]
    s_add_u32 s78, s78, s60
    ds_read_b64_tr_b16 a[202:203], v8 offset:10240
    v_cvt_pk_bf16_f32 v113, v114, v115
    v_mfma_f32_16x16x32_bf16 v[124:127], a[212:215], a[108:111], v[124:127]
    s_xor_b32 s79, s53, 1
    ds_read_b64_tr_b16 a[204:205], v8 offset:12288
    v_mul_f32 v21, v21, v17
    v_mfma_f32_16x16x32_bf16 v[116:119], a[212:215], a[104:107], v[116:119]
    s_waitcnt lgkmcnt(3)
    ds_read_b64_tr_b16 a[206:207], v8 offset:14336
    v_lshlrev_b32 v17, 6, v2
    v_mfma_f32_16x16x32_bf16 v[116:119], a[208:211], a[88:91], v[116:119]
    s_and_b32 s79, s79, 3
    v_cvt_pk_bf16_f32 v20, 0, v20
    v_cvt_pk_bf16_f32 v21, 0, v21
    v_mfma_f32_16x16x32_bf16 v[108:111], a[208:211], a[84:87], v[108:111]
    s_mul_i32 s79, s79, 2560
    v_mul_f32 v23, s92, v20
    v_mul_f32 v36, s92, v21
    v_mfma_f32_16x16x32_bf16 v[108:111], a[212:215], a[100:103], v[108:111]
    s_add_u32 s79, s79, s60
    v_cvt_pk_bf16_f32 v114, v116, v117
    v_cvt_pk_bf16_f32 v115, v118, v119
    v_mfma_f32_16x16x32_bf16 v[100:103], a[212:215], a[96:99], v[100:103]
    s_addk_i32 m0, -4096
    v_mov_b32_dpp v116, v120 row_ror:8 row_mask:0xf bank_mask:0xf
    v_mov_b32_dpp v117, v121 row_ror:8 row_mask:0xf bank_mask:0xf
    v_mfma_f32_16x16x32_bf16 v[100:103], a[208:211], a[80:83], v[100:103]
    buffer_load_dwordx4 v3, s[8:11], s38 offen lds
    v_mfma_f32_16x16x32_bf16 v[128:131], a[184:187], a[128:131], v[128:131]
    s_add_u32 s38, s46, 163840
    ds_read_b64_tr_b16 a[208:209], v9 offset:8192
    v_cvt_pk_bf16_f32 v106, v108, v109
    v_mfma_f32_16x16x32_bf16 v[128:131], a[188:191], a[0:3], v[128:131]
    s_addk_i32 m0, -4096
    ds_read_b64_tr_b16 a[210:211], v9 offset:10240
    v_cvt_pk_bf16_f32 v98, v100, v101
    v_mfma_f32_16x16x32_bf16 v[136:139], a[188:191], a[4:7], v[136:139]
    ds_read_b64_tr_b16 a[212:213], v9 offset:12288
    v_cvt_pk_bf16_f32 v99, v102, v103
    v_mfma_f32_16x16x32_bf16 v[136:139], a[184:187], a[132:135], v[136:139]
    buffer_store_dwordx4 v[96:99], v38, s[24:27], s78 offen offset:2048 sc1
    v_cvt_pk_bf16_f32 v107, v110, v111
    v_mfma_f32_16x16x32_bf16 v[144:147], a[184:187], a[136:139], v[144:147]
    s_xor_b32 s78, s53, 2
    ds_read_b64_tr_b16 a[214:215], v9 offset:14336
    v_mov_b32_dpp v118, v122 row_ror:8 row_mask:0xf bank_mask:0xf
    v_mfma_f32_16x16x32_bf16 v[144:147], a[188:191], a[8:11], v[144:147]
    buffer_store_dwordx4 v[104:107], v38, s[24:27], s79 offen offset:2048 sc1
    v_mov_b32_dpp v119, v123 row_ror:8 row_mask:0xf bank_mask:0xf
    v_mfma_f32_16x16x32_bf16 v[152:155], a[188:191], a[12:15], v[152:155]
    buffer_load_dwordx4 v3, s[8:11], s38 offen lds
    v_mfma_f32_16x16x32_bf16 v[152:155], a[184:187], a[140:143], v[152:155]
    s_and_b32 s78, s78, 3
    ds_read_b64_tr_b16 a[184:185], v8 offset:16384
    v_cvt_pk_bf16_f32 v120, v120, v121
    v_mfma_f32_16x16x32_bf16 v[156:159], a[192:195], a[140:143], v[156:159]
    s_mul_i32 s78, s78, 2560
    ds_read_b64_tr_b16 a[186:187], v8 offset:18432
    v_cvt_pk_bf16_f32 v121, v122, v123
    v_mfma_f32_16x16x32_bf16 v[156:159], a[196:199], a[12:15], v[156:159]
    s_add_u32 s78, s78, s60
    ds_read_b64_tr_b16 a[188:189], v8 offset:20480
    v_cvt_pk_bf16_f32 v122, v124, v125
    v_mfma_f32_16x16x32_bf16 v[148:151], a[196:199], a[8:11], v[148:151]
    s_waitcnt lgkmcnt(4)
    ds_read_b64_tr_b16 a[190:191], v8 offset:22528
    v_cvt_pk_bf16_f32 v123, v126, v127
    v_mfma_f32_16x16x32_bf16 v[148:151], a[192:195], a[136:139], v[148:151]
    buffer_store_dwordx4 v[112:115], v38, s[24:27], s78 offen offset:2048 sc1
    v_cndmask_b32 v124, v116, v124, s[74:75]
    v_mfma_f32_16x16x32_bf16 v[140:143], a[192:195], a[132:135], v[140:143]
    s_xor_b32 s79, s53, 0
    v_exp_f32 v23, v23
    v_mfma_f32_16x16x32_bf16 v[140:143], a[196:199], a[4:7], v[140:143]
    s_and_b32 s79, s79, 3
    v_exp_f32 v36, v36
    v_mfma_f32_16x16x32_bf16 v[132:135], a[196:199], a[0:3], v[132:135]
    s_mul_i32 s79, s79, 2560
    v_add_f32 v23, 1.0, v23
    v_add_f32 v36, 1.0, v36
    v_mfma_f32_16x16x32_bf16 v[132:135], a[192:195], a[128:131], v[132:135]
    s_add_u32 s79, s79, s60
    ds_read_b64_tr_b16 a[192:193], v9 offset:16384
    v_cndmask_b32 v125, v117, v125, s[74:75]
    v_mfma_f32_16x16x32_bf16 v[128:131], a[200:203], a[16:19], v[128:131]
    s_add_u32 s38, s47, 163840
    ds_read_b64_tr_b16 a[194:195], v9 offset:18432
    v_cndmask_b32 v126, v118, v126, s[74:75]
    v_mfma_f32_16x16x32_bf16 v[128:131], a[204:207], a[32:35], v[128:131]
    buffer_store_dwordx4 v[120:123], v38, s[24:27], s79 offen offset:2048 sc1
    v_cndmask_b32 v127, v119, v127, s[74:75]
    v_mfma_f32_16x16x32_bf16 v[136:139], a[204:207], a[36:39], v[136:139]
    s_addk_i32 m0, -4096
    ds_read_b64_tr_b16 a[196:197], v9 offset:20480
    v_mfma_f32_16x16x32_bf16 v[136:139], a[200:203], a[20:23], v[136:139]
    buffer_load_dwordx4 v3, s[8:11], s38 offen lds
    v_mfma_f32_16x16x32_bf16 v[144:147], a[200:203], a[24:27], v[144:147]
    ds_read_b64_tr_b16 a[198:199], v9 offset:22528
    v_mfma_f32_16x16x32_bf16 v[144:147], a[204:207], a[40:43], v[144:147]
    v_rcp_f32 v23, v23
    v_mfma_f32_16x16x32_bf16 v[152:155], a[204:207], a[44:47], v[152:155]
    s_waitcnt lgkmcnt(3)
    v_rcp_f32 v36, v36
    v_mfma_f32_16x16x32_bf16 v[152:155], a[200:203], a[28:31], v[152:155]
    s_add_u32 s38, s45, 204800
    v_mul_f32 v20, v20, v23
    v_mul_f32 v21, v21, v36
    v_mfma_f32_16x16x32_bf16 v[156:159], a[208:211], a[28:31], v[156:159]
    s_addk_i32 m0, -4096
    v_cvt_pk_bf16_f32 v43, v20, v21
    v_lshlrev_b32 v20, 16, v28
    v_mfma_f32_16x16x32_bf16 v[156:159], a[212:215], a[44:47], v[156:159]
    v_and_b32 v21, 0xffff0000, v28
    v_sub_f32 v20, v20, v18
    v_mfma_f32_16x16x32_bf16 v[148:151], a[212:215], a[40:43], v[148:151]
    s_barrier
    v_mfma_f32_16x16x32_bf16 v[148:151], a[208:211], a[24:27], v[148:151]
    s_waitcnt vmcnt(10)
    ds_read_b64_tr_b16 a[200:201], v8 offset:24576
    v_xor_b32 v58, s58, v58
    v_mfma_f32_16x16x32_bf16 v[140:143], a[208:211], a[20:23], v[140:143]
    s_waitcnt vmcnt(9)
    ds_read_b64_tr_b16 a[202:203], v8 offset:26624
    v_xor_b32 v59, s58, v59
    v_mfma_f32_16x16x32_bf16 v[140:143], a[212:215], a[36:39], v[140:143]
    ds_read_b64_tr_b16 a[204:205], v8 offset:28672
    v_or_b32 v58, v58, v59
    v_mfma_f32_16x16x32_bf16 v[132:135], a[212:215], a[32:35], v[132:135]
    buffer_load_dwordx4 v3, s[8:11], s38 offen lds
    v_mfma_f32_16x16x32_bf16 v[132:135], a[208:211], a[16:19], v[132:135]
    ds_read_b64_tr_b16 a[206:207], v8 offset:30720
    v_cmp_ne_u32 vcc, 0, v58
    v_mfma_f32_16x16x32_bf16 v[128:131], a[184:187], a[48:51], v[128:131]
    s_cbranch_vccnz spin_y
spin_y_ret:
    v_sub_f32 v21, v21, v18
    v_mfma_f32_16x16x32_bf16 v[128:131], a[188:191], a[64:67], v[128:131]
    buffer_load_dwordx4 v[116:119], v55, s[24:27], s55 offen sc1
    v_mfma_f32_16x16x32_bf16 v[136:139], a[188:191], a[68:71], v[136:139]
    s_add_u32 s55, s55, 10240
    ds_read_b64_tr_b16 a[208:209], v9 offset:24576
    v_cvt_pk_bf16_f32 v20, 0, v20
    v_mfma_f32_16x16x32_bf16 v[136:139], a[184:187], a[52:55], v[136:139]
    s_add_u32 s38, s46, 204800
    ds_read_b64_tr_b16 a[210:211], v9 offset:26624
    v_cvt_pk_bf16_f32 v21, 0, v21
    v_mfma_f32_16x16x32_bf16 v[144:147], a[184:187], a[56:59], v[144:147]
    buffer_load_dwordx4 v[120:123], v55, s[24:27], s55 offen sc1
    v_mfma_f32_16x16x32_bf16 v[144:147], a[188:191], a[72:75], v[144:147]
    s_waitcnt lgkmcnt(3)
    ds_read_b64_tr_b16 a[212:213], v9 offset:28672
    v_mul_f32 v20, v20, v19
    v_mfma_f32_16x16x32_bf16 v[152:155], a[188:191], a[76:79], v[152:155]
    s_add_u32 s55, s55, 10240
    ds_read_b64_tr_b16 a[214:215], v9 offset:30720
    v_mul_f32 v21, v21, v19
    v_mfma_f32_16x16x32_bf16 v[152:155], a[184:187], a[60:63], v[152:155]
    s_addk_i32 m0, -4096
    ds_read_b64_tr_b16 a[184:185], v8 offset:32768
    v_cvt_pk_bf16_f32 v20, 0, v20
    v_mfma_f32_16x16x32_bf16 v[156:159], a[192:195], a[60:63], v[156:159]
    buffer_load_dwordx4 v[56:59], v55, s[24:27], s55 offen sc1
    v_mfma_f32_16x16x32_bf16 v[156:159], a[196:199], a[76:79], v[156:159]
    s_add_u32 s55, s55, 10240
    ds_read_b64_tr_b16 a[186:187], v8 offset:34816
    v_cvt_pk_bf16_f32 v21, 0, v21
    v_mfma_f32_16x16x32_bf16 v[148:151], a[196:199], a[72:75], v[148:151]
    buffer_load_dwordx4 v3, s[8:11], s38 offen lds
    v_mfma_f32_16x16x32_bf16 v[148:151], a[192:195], a[56:59], v[148:151]
    ds_read_b64_tr_b16 a[188:189], v8 offset:36864
    v_mul_f32 v23, s92, v20
    v_mfma_f32_16x16x32_bf16 v[140:143], a[192:195], a[52:55], v[140:143]
    buffer_load_dwordx4 v[60:63], v55, s[24:27], s55 offen sc1
    v_mfma_f32_16x16x32_bf16 v[140:143], a[196:199], a[68:71], v[140:143]
    s_add_u32 s55, s55, 10240
    ds_read_b64_tr_b16 a[190:191], v8 offset:38912
    v_mul_f32 v36, s92, v21
    v_mfma_f32_16x16x32_bf16 v[132:135], a[196:199], a[64:67], v[132:135]
    s_waitcnt lgkmcnt(3)
    v_exp_f32 v23, v23
    v_mfma_f32_16x16x32_bf16 v[132:135], a[192:195], a[48:51], v[132:135]
    s_add_u32 s38, s47, 204800
    ds_read_b64_tr_b16 a[192:193], v9 offset:32768
    v_add_f32 v23, 1.0, v23
    v_mfma_f32_16x16x32_bf16 v[128:131], a[200:203], a[216:219], v[128:131]
    buffer_load_dwordx4 v[64:67], v55, s[24:27], s55 offen sc1
    v_mfma_f32_16x16x32_bf16 v[128:131], a[204:207], a[232:235], v[128:131]
    s_add_u32 s55, s55, 10240
    ds_read_b64_tr_b16 a[194:195], v9 offset:34816
    s_addk_i32 m0, -4096
    v_mfma_f32_16x16x32_bf16 v[136:139], a[204:207], a[236:239], v[136:139]
    ds_read_b64_tr_b16 a[196:197], v9 offset:36864
    v_mfma_f32_16x16x32_bf16 v[136:139], a[200:203], a[220:223], v[136:139]
    ds_read_b64_tr_b16 a[198:199], v9 offset:38912
    v_mfma_f32_16x16x32_bf16 v[144:147], a[200:203], a[224:227], v[144:147]
    buffer_load_dwordx4 v[68:71], v55, s[24:27], s55 offen sc1
    v_mfma_f32_16x16x32_bf16 v[144:147], a[204:207], a[240:243], v[144:147]
    s_add_u32 s55, s55, 10240
    v_exp_f32 v36, v36
    v_mfma_f32_16x16x32_bf16 v[152:155], a[204:207], a[244:247], v[152:155]
    buffer_load_dwordx4 v3, s[8:11], s38 offen lds
    v_mfma_f32_16x16x32_bf16 v[152:155], a[200:203], a[228:231], v[152:155]
    ds_read_b64_tr_b16 a[200:201], v8 offset:40960
    v_add_f32 v36, 1.0, v36
    v_mfma_f32_16x16x32_bf16 v[156:159], a[208:211], a[228:231], v[156:159]
    buffer_load_dwordx4 v[72:75], v55, s[24:27], s55 offen sc1
    v_mfma_f32_16x16x32_bf16 v[156:159], a[212:215], a[244:247], v[156:159]
    s_add_u32 s55, s55, 10240
    ds_read_b64_tr_b16 a[202:203], v8 offset:43008
    v_mfma_f32_16x16x32_bf16 v[148:151], a[212:215], a[240:243], v[148:151]
    ds_read_b64_tr_b16 a[204:205], v8 offset:45056
    v_mfma_f32_16x16x32_bf16 v[148:151], a[208:211], a[224:227], v[148:151]
    ds_read_b64_tr_b16 a[206:207], v8 offset:47104
    v_add_u32 v8, 90112, v8
    v_mfma_f32_16x16x32_bf16 v[140:143], a[208:211], a[220:223], v[140:143]
    s_waitcnt lgkmcnt(4)
    v_rcp_f32 v23, v23
    v_mfma_f32_16x16x32_bf16 v[140:143], a[212:215], a[236:239], v[140:143]
    buffer_load_dwordx4 v[76:79], v55, s[24:27], s55 offen sc1
    v_mfma_f32_16x16x32_bf16 v[132:135], a[212:215], a[232:235], v[132:135]
    s_add_u32 s55, s55, 10240
    v_rcp_f32 v36, v36
    v_mfma_f32_16x16x32_bf16 v[132:135], a[208:211], a[216:219], v[132:135]
    ds_read_b64_tr_b16 a[208:209], v9 offset:40960
    v_mul_f32 v20, v20, v23
    v_mfma_f32_16x16x32_bf16 v[128:131], a[184:187], a[152:155], v[128:131]
    buffer_load_dwordx4 v[80:83], v55, s[24:27], s55 offen sc1
    v_mfma_f32_16x16x32_bf16 v[128:131], a[188:191], a[168:171], v[128:131]
    s_add_u32 s55, s55, 10240
    ds_read_b64_tr_b16 a[210:211], v9 offset:43008
    v_mul_f32 v21, v21, v36
    v_mfma_f32_16x16x32_bf16 v[136:139], a[188:191], a[172:175], v[136:139]
    ds_read_b64_tr_b16 a[212:213], v9 offset:45056
    v_cvt_pk_bf16_f32 v44, v20, v21
    v_mfma_f32_16x16x32_bf16 v[136:139], a[184:187], a[156:159], v[136:139]
    ds_read_b64_tr_b16 a[214:215], v9 offset:47104
    v_add_u32 v9, 90112, v9
    v_mfma_f32_16x16x32_bf16 v[144:147], a[184:187], a[160:163], v[144:147]
    buffer_load_dwordx4 v[84:87], v55, s[24:27], s55 offen sc1
    v_mfma_f32_16x16x32_bf16 v[144:147], a[188:191], a[176:179], v[144:147]
    s_add_u32 s55, s55, 10240
    v_lshlrev_b32 v20, 16, v29
    v_and_b32 v21, 0xffff0000, v29
    v_mfma_f32_16x16x32_bf16 v[152:155], a[188:191], a[180:183], v[152:155]
    v_sub_f32 v20, v20, v18
    v_sub_f32 v21, v21, v18
    v_mfma_f32_16x16x32_bf16 v[152:155], a[184:187], a[164:167], v[152:155]
    ds_read_b64_tr_b16 a[184:185], v10 offset:0
    v_cvt_pk_bf16_f32 v20, 0, v20
    v_mfma_f32_16x16x32_bf16 v[156:159], a[192:195], a[164:167], v[156:159]
    buffer_load_dwordx4 v[88:91], v55, s[24:27], s55 offen sc1
    v_mfma_f32_16x16x32_bf16 v[156:159], a[196:199], a[180:183], v[156:159]
    s_add_u32 s55, s55, 10240
    ds_read_b64_tr_b16 a[186:187], v10 offset:2048
    v_cvt_pk_bf16_f32 v21, 0, v21
    v_mfma_f32_16x16x32_bf16 v[148:151], a[196:199], a[176:179], v[148:151]
    ds_read_b64_tr_b16 a[188:189], v10 offset:4096
    v_mul_f32 v20, v20, v19
    v_mfma_f32_16x16x32_bf16 v[148:151], a[192:195], a[160:163], v[148:151]
    s_waitcnt lgkmcnt(3)
    ds_read_b64_tr_b16 a[190:191], v10 offset:6144
    v_mul_f32 v21, v21, v19
    v_mfma_f32_16x16x32_bf16 v[140:143], a[192:195], a[156:159], v[140:143]
    buffer_load_dwordx4 v[92:95], v55, s[24:27], s55 offen sc1
    v_mfma_f32_16x16x32_bf16 v[140:143], a[196:199], a[172:175], v[140:143]
    v_cvt_pk_bf16_f32 v20, 0, v20
    v_cvt_pk_bf16_f32 v21, 0, v21
    v_mfma_f32_16x16x32_bf16 v[132:135], a[196:199], a[168:171], v[132:135]
    v_mul_f32 v23, s92, v20
    v_mul_f32 v36, s92, v21
    v_mfma_f32_16x16x32_bf16 v[132:135], a[192:195], a[152:155], v[132:135]
    ds_read_b64_tr_b16 a[192:193], v11 offset:0
    v_mfma_f32_16x16x32_bf16 v[128:131], a[200:203], a[80:83], v[128:131]
    ds_read_b64_tr_b16 a[194:195], v11 offset:2048
    v_mfma_f32_16x16x32_bf16 v[128:131], a[204:207], a[96:99], v[128:131]
    ds_read_b64_tr_b16 a[196:197], v11 offset:4096
    v_mfma_f32_16x16x32_bf16 v[136:139], a[204:207], a[100:103], v[136:139]
    s_load_dwordx8 s[28:35], s[86:87], s93 glc
    ds_read_b64_tr_b16 a[198:199], v11 offset:6144
    v_mfma_f32_16x16x32_bf16 v[136:139], a[200:203], a[84:87], v[136:139]
    v_exp_f32 v23, v23
    v_mfma_f32_16x16x32_bf16 v[144:147], a[200:203], a[88:91], v[144:147]
    v_exp_f32 v36, v36
    v_mfma_f32_16x16x32_bf16 v[144:147], a[204:207], a[104:107], v[144:147]
    s_xor_b32 s78, s53, 7
    v_cvt_pk_bf16_f32 v128, v128, v129
    v_cvt_pk_bf16_f32 v129, v130, v131
    v_mfma_f32_16x16x32_bf16 v[152:155], a[204:207], a[108:111], v[152:155]
    s_mul_i32 s78, s78, 2560
    v_cvt_pk_bf16_f32 v136, v136, v137
    v_cvt_pk_bf16_f32 v137, v138, v139
    v_mfma_f32_16x16x32_bf16 v[152:155], a[200:203], a[92:95], v[152:155]
    s_add_u32 s78, s78, s60
    ds_read_b64_tr_b16 a[200:201], v10 offset:8192
    v_cvt_pk_bf16_f32 v144, v144, v145
    v_mfma_f32_16x16x32_bf16 v[156:159], a[208:211], a[92:95], v[156:159]
    s_xor_b32 s79, s53, 6
    ds_read_b64_tr_b16 a[202:203], v10 offset:10240
    v_cvt_pk_bf16_f32 v145, v146, v147
    v_mfma_f32_16x16x32_bf16 v[156:159], a[212:215], a[108:111], v[156:159]
    s_mul_i32 s79, s79, 2560
    ds_read_b64_tr_b16 a[204:205], v10 offset:12288
    v_cvt_pk_bf16_f32 v152, v152, v153
    v_mfma_f32_16x16x32_bf16 v[148:151], a[212:215], a[104:107], v[148:151]
    s_waitcnt lgkmcnt(5)
    ds_read_b64_tr_b16 a[206:207], v10 offset:14336
    v_cvt_pk_bf16_f32 v153, v154, v155
    v_mfma_f32_16x16x32_bf16 v[148:151], a[208:211], a[88:91], v[148:151]
    s_add_u32 s79, s79, s60
    v_cvt_pk_bf16_f32 v154, v156, v157
    v_cvt_pk_bf16_f32 v155, v158, v159
    v_mfma_f32_16x16x32_bf16 v[140:143], a[208:211], a[84:87], v[140:143]
    s_lshl_b32 s56, s3, 9
    v_add_f32 v23, 1.0, v23
    v_add_f32 v36, 1.0, v36
    v_mfma_f32_16x16x32_bf16 v[140:143], a[212:215], a[100:103], v[140:143]
    s_add_u32 s56, s56, 61440
    v_cvt_pk_bf16_f32 v146, v148, v149
    v_cvt_pk_bf16_f32 v147, v150, v151
    v_mfma_f32_16x16x32_bf16 v[132:135], a[212:215], a[96:99], v[132:135]
    v_rcp_f32 v23, v23
    v_mfma_f32_16x16x32_bf16 v[132:135], a[208:211], a[80:83], v[132:135]
    ds_read_b64_tr_b16 a[208:209], v11 offset:8192
    v_mul_f32 v20, v20, v23
    v_mfma_f32_16x16x32_bf16 v[160:163], a[184:187], a[128:131], v[160:163]
    ds_read_b64_tr_b16 a[210:211], v11 offset:10240
    v_cvt_pk_bf16_f32 v138, v140, v141
    v_mfma_f32_16x16x32_bf16 v[160:163], a[188:191], a[0:3], v[160:163]
    ds_read_b64_tr_b16 a[212:213], v11 offset:12288
    v_cvt_pk_bf16_f32 v139, v142, v143
    v_mfma_f32_16x16x32_bf16 v[168:171], a[188:191], a[4:7], v[168:171]
    ds_read_b64_tr_b16 a[214:215], v11 offset:14336
    v_cvt_pk_bf16_f32 v130, v132, v133
    v_mfma_f32_16x16x32_bf16 v[168:171], a[184:187], a[132:135], v[168:171]
    v_cvt_pk_bf16_f32 v131, v134, v135
    v_cmp_eq_u32 s[8:9], s39, v5
    v_mfma_f32_16x16x32_bf16 v[176:179], a[184:187], a[136:139], v[176:179]
    buffer_store_dwordx4 v[128:131], v14, s[24:27], s78 offen offset:1024 sc1
    v_cmp_eq_u32 s[20:21], s40, v5
    v_mfma_f32_16x16x32_bf16 v[176:179], a[188:191], a[8:11], v[176:179]
    buffer_store_dwordx4 v[136:139], v14, s[24:27], s78 offen offset:0 sc1
    v_lshl_add_u32 v12, v1, 3, s56
    v_mfma_f32_16x16x32_bf16 v[184:187], a[188:191], a[12:15], v[184:187]
    s_waitcnt lgkmcnt(5)
    v_rcp_f32 v36, v36
    v_mfma_f32_16x16x32_bf16 v[184:187], a[184:187], a[140:143], v[184:187]
    s_or_b64 s[8:9], s[8:9], s[20:21]
    ds_read_b64_tr_b16 a[184:185], v10 offset:16384
    v_mul_f32 v21, v21, v36
    v_mfma_f32_16x16x32_bf16 v[188:191], a[192:195], a[140:143], v[188:191]
    ds_read_b64_tr_b16 a[186:187], v10 offset:18432
    v_cvt_pk_bf16_f32 v45, v20, v21
    v_mfma_f32_16x16x32_bf16 v[188:191], a[196:199], a[12:15], v[188:191]
    ds_read_b64_tr_b16 a[188:189], v10 offset:20480
    v_lshlrev_b32 v20, 16, v30
    v_mfma_f32_16x16x32_bf16 v[180:183], a[196:199], a[8:11], v[180:183]
    s_waitcnt vmcnt(14)
    ds_read_b64_tr_b16 a[190:191], v10 offset:22528
    v_and_b32 v21, 0xffff0000, v30
    v_mfma_f32_16x16x32_bf16 v[180:183], a[192:195], a[136:139], v[180:183]
    buffer_store_dwordx4 v[144:147], v14, s[24:27], s79 offen offset:1024 sc1
    v_sub_f32 v20, v20, v18
    v_mfma_f32_16x16x32_bf16 v[172:175], a[192:195], a[132:135], v[172:175]
    v_sub_f32 v21, v21, v18
    v_cvt_pk_bf16_f32 v20, 0, v20
    v_mfma_f32_16x16x32_bf16 v[172:175], a[196:199], a[4:7], v[172:175]
    s_or_b64 s[88:89], s[28:29], s[30:31]
    v_cvt_pk_bf16_f32 v21, 0, v21
    v_mul_f32 v20, v20, v19
    v_mfma_f32_16x16x32_bf16 v[164:167], a[196:199], a[0:3], v[164:167]
    s_waitcnt lgkmcnt(5)
    v_mul_f32 v21, v21, v19
    v_cvt_pk_bf16_f32 v20, 0, v20
    v_mfma_f32_16x16x32_bf16 v[164:167], a[192:195], a[128:131], v[164:167]
    s_or_b64 s[88:89], s[88:89], s[32:33]
    ds_read_b64_tr_b16 a[192:193], v11 offset:16384
    v_cvt_pk_bf16_f32 v21, 0, v21
    v_mfma_f32_16x16x32_bf16 v[160:163], a[200:203], a[16:19], v[160:163]
    s_load_dwordx8 s[28:35], s[86:87], s93 glc
    ds_read_b64_tr_b16 a[194:195], v11 offset:18432
    v_mul_f32 v23, s92, v20
    v_mfma_f32_16x16x32_bf16 v[160:163], a[204:207], a[32:35], v[160:163]
pg_15:
    s_cbranch_execz pg_backL
    buffer_store_dwordx4 v[152:155], v14, s[24:27], s79 offen offset:0 sc1
    v_mul_f32 v36, s92, v21
    v_mfma_f32_16x16x32_bf16 v[168:171], a[204:207], a[36:39], v[168:171]
    s_or_b64 s[88:89], s[88:89], s[34:35]
    ds_read_b64_tr_b16 a[196:197], v11 offset:20480
    v_add_f32 v116, v116, v120
    v_mfma_f32_16x16x32_bf16 v[168:171], a[200:203], a[20:23], v[168:171]
    s_or_b32 s66, s88, s89
    ds_read_b64_tr_b16 a[198:199], v11 offset:22528
    v_add_f32 v117, v117, v121
    v_mfma_f32_16x16x32_bf16 v[176:179], a[200:203], a[24:27], v[176:179]
    s_andn2_b32 s69, s66, s80
    s_cselect_b32 s65, s59, 0x70000000
    v_add_f32 v118, v118, v122
    v_mfma_f32_16x16x32_bf16 v[176:179], a[204:207], a[40:43], v[176:179]
    s_ff1_i32_b32 s69, s69
    v_exp_f32 v23, v23
    v_mfma_f32_16x16x32_bf16 v[184:187], a[204:207], a[44:47], v[184:187]
    s_waitcnt lgkmcnt(7)
    v_exp_f32 v36, v36
    v_mfma_f32_16x16x32_bf16 v[184:187], a[200:203], a[28:31], v[184:187]
    s_xor_b32 s81, s53, s69
    ds_read_b64_tr_b16 a[200:201], v10 offset:24576
    v_add_f32 v23, 1.0, v23
    v_mfma_f32_16x16x32_bf16 v[188:191], a[208:211], a[28:31], v[188:191]
    s_mul_i32 s81, s81, 20480
    ds_read_b64_tr_b16 a[202:203], v10 offset:26624
    v_add_f32 v36, 1.0, v36
    v_mfma_f32_16x16x32_bf16 v[188:191], a[212:215], a[44:47], v[188:191]
    s_add_u32 s81, s81, s65
    ds_read_b64_tr_b16 a[204:205], v10 offset:28672
    v_add_f32 v119, v119, v123
    v_mfma_f32_16x16x32_bf16 v[180:183], a[212:215], a[40:43], v[180:183]
    s_bitset1_b32 s80, s69
    ds_read_b64_tr_b16 a[206:207], v10 offset:30720
    v_mfma_f32_16x16x32_bf16 v[180:183], a[208:211], a[24:27], v[180:183]
    s_waitcnt lgkmcnt(8)
    v_rcp_f32 v23, v23
    v_mfma_f32_16x16x32_bf16 v[172:175], a[208:211], a[20:23], v[172:175]
    s_waitcnt vmcnt(15)
    v_rcp_f32 v36, v36
    v_mfma_f32_16x16x32_bf16 v[172:175], a[212:215], a[36:39], v[172:175]
    v_mul_f32 v20, v20, v23
    v_mul_f32 v21, v21, v36
    v_mfma_f32_16x16x32_bf16 v[164:167], a[212:215], a[32:35], v[164:167]
    v_cvt_pk_bf16_f32 v46, v20, v21
    v_lshlrev_b32 v20, 16, v31
    v_mfma_f32_16x16x32_bf16 v[164:167], a[208:211], a[16:19], v[164:167]
    buffer_load_dwordx4 v[98:101], v14, s[24:27], s81 offen sc1
    v_mfma_f32_16x16x32_bf16 v[160:163], a[184:187], a[48:51], v[160:163]
    ds_read_b64_tr_b16 a[208:209], v11 offset:24576
    v_and_b32 v21, 0xffff0000, v31
    v_mfma_f32_16x16x32_bf16 v[160:163], a[188:191], a[64:67], v[160:163]
    ds_read_b64_tr_b16 a[210:211], v11 offset:26624
    v_sub_f32 v20, v20, v18
    v_mfma_f32_16x16x32_bf16 v[168:171], a[188:191], a[68:71], v[168:171]
    buffer_load_dwordx4 v[102:105], v14, s[24:27], s81 offen offset:1024 sc1
    v_mfma_f32_16x16x32_bf16 v[168:171], a[184:187], a[52:55], v[168:171]
    ds_read_b64_tr_b16 a[212:213], v11 offset:28672
    v_sub_f32 v21, v21, v18
    v_mfma_f32_16x16x32_bf16 v[176:179], a[184:187], a[56:59], v[176:179]
    s_waitcnt lgkmcnt(7)
    ds_read_b64_tr_b16 a[214:215], v11 offset:30720
    v_cvt_pk_bf16_f32 v20, 0, v20
    v_mfma_f32_16x16x32_bf16 v[176:179], a[188:191], a[72:75], v[176:179]
    buffer_load_dwordx2 v[96:97], v39, s[24:27], s81 offen offset:2048 sc1
    v_mfma_f32_16x16x32_bf16 v[184:187], a[188:191], a[76:79], v[184:187]
    v_cvt_pk_bf16_f32 v21, 0, v21
    v_mul_f32 v20, v20, v19
    v_mfma_f32_16x16x32_bf16 v[184:187], a[184:187], a[60:63], v[184:187]
    ds_read_b64_tr_b16 a[184:185], v10 offset:32768
    v_mul_f32 v21, v21, v19
    v_mfma_f32_16x16x32_bf16 v[188:191], a[192:195], a[60:63], v[188:191]
    ds_read_b64_tr_b16 a[186:187], v10 offset:34816
    v_cvt_pk_bf16_f32 v20, 0, v20
    v_mfma_f32_16x16x32_bf16 v[188:191], a[196:199], a[76:79], v[188:191]
    ds_read_b64_tr_b16 a[188:189], v10 offset:36864
    v_cvt_pk_bf16_f32 v21, 0, v21
    v_mfma_f32_16x16x32_bf16 v[180:183], a[196:199], a[72:75], v[180:183]
    s_waitcnt lgkmcnt(6)
    ds_read_b64_tr_b16 a[190:191], v10 offset:38912
    v_mul_f32 v23, s92, v20
    v_mfma_f32_16x16x32_bf16 v[180:183], a[192:195], a[56:59], v[180:183]
    v_exp_f32 v23, v23
    v_mfma_f32_16x16x32_bf16 v[172:175], a[192:195], a[52:55], v[172:175]
    v_mul_f32 v36, s92, v21
    v_add_f32 v23, 1.0, v23
    v_mfma_f32_16x16x32_bf16 v[172:175], a[196:199], a[68:71], v[172:175]
    v_exp_f32 v36, v36
    v_mfma_f32_16x16x32_bf16 v[164:167], a[196:199], a[64:67], v[164:167]
    v_rcp_f32 v23, v23
    v_mfma_f32_16x16x32_bf16 v[164:167], a[192:195], a[48:51], v[164:167]
    ds_read_b64_tr_b16 a[192:193], v11 offset:32768
    v_add_f32 v36, 1.0, v36
    v_mfma_f32_16x16x32_bf16 v[160:163], a[200:203], a[216:219], v[160:163]
    s_or_b64 s[88:89], s[28:29], s[30:31]
    ds_read_b64_tr_b16 a[194:195], v11 offset:34816
    v_mul_f32 v20, v20, v23
    v_mfma_f32_16x16x32_bf16 v[160:163], a[204:207], a[232:235], v[160:163]
    s_or_b64 s[88:89], s[88:89], s[32:33]
    ds_read_b64_tr_b16 a[196:197], v11 offset:36864
    v_add_f32 v116, v116, v56
    v_mfma_f32_16x16x32_bf16 v[168:171], a[204:207], a[236:239], v[168:171]
    s_or_b64 s[88:89], s[88:89], s[34:35]
    ds_read_b64_tr_b16 a[198:199], v11 offset:38912
    v_add_f32 v117, v117, v57
    v_mfma_f32_16x16x32_bf16 v[168:171], a[200:203], a[220:223], v[168:171]
    s_waitcnt lgkmcnt(6)
    v_rcp_f32 v36, v36
    v_mfma_f32_16x16x32_bf16 v[176:179], a[200:203], a[224:227], v[176:179]
    s_or_b32 s66, s88, s89
    v_mul_f32 v21, v21, v36
    v_cvt_pk_bf16_f32 v47, v20, v21
    v_mfma_f32_16x16x32_bf16 v[176:179], a[204:207], a[240:243], v[176:179]
    s_waitcnt vmcnt(16)
    v_add_f32 v118, v118, v58
    v_add_f32 v119, v119, v59
    v_mfma_f32_16x16x32_bf16 v[184:187], a[204:207], a[244:247], v[184:187]
    s_andn2_b32 s69, s66, s80
    s_cselect_b32 s65, s59, 0x70000000
    v_add_f32 v116, v116, v60
    v_mfma_f32_16x16x32_bf16 v[184:187], a[200:203], a[228:231], v[184:187]
    s_ff1_i32_b32 s69, s69
    ds_read_b64_tr_b16 a[200:201], v10 offset:40960
    v_add_f32 v117, v117, v61
    v_mfma_f32_16x16x32_bf16 v[188:191], a[208:211], a[228:231], v[188:191]
    s_xor_b32 s72, s53, s69
    ds_read_b64_tr_b16 a[202:203], v10 offset:43008
    v_add_f32 v118, v118, v62
    v_mfma_f32_16x16x32_bf16 v[188:191], a[212:215], a[244:247], v[188:191]
    s_mul_i32 s72, s72, 20480
    ds_read_b64_tr_b16 a[204:205], v10 offset:45056
    v_add_f32 v119, v119, v63
    v_mfma_f32_16x16x32_bf16 v[180:183], a[212:215], a[240:243], v[180:183]
    s_add_u32 s72, s72, s65
    ds_read_b64_tr_b16 a[206:207], v10 offset:47104
    v_add_u32 v10, 90112, v10
    v_mfma_f32_16x16x32_bf16 v[180:183], a[208:211], a[224:227], v[180:183]
    s_bitset1_b32 s80, s69
    v_xor_b32 v20, 16, v5
    v_cmp_eq_u32 s[10:11], s39, v20
    v_mfma_f32_16x16x32_bf16 v[172:175], a[208:211], a[220:223], v[172:175]
    s_waitcnt vmcnt(15)
    v_add_f32 v116, v116, v64
    v_add_f32 v117, v117, v65
    v_mfma_f32_16x16x32_bf16 v[172:175], a[212:215], a[236:239], v[172:175]
    s_waitcnt vmcnt(14)
    v_add_f32 v118, v118, v66
    v_add_f32 v119, v119, v67
    v_mfma_f32_16x16x32_bf16 v[164:167], a[212:215], a[232:235], v[164:167]
    s_waitcnt lgkmcnt(5)
    v_add_f32 v116, v116, v68
    v_add_f32 v117, v117, v69
    v_mfma_f32_16x16x32_bf16 v[164:167], a[208:211], a[216:219], v[164:167]
    s_waitcnt vmcnt(12)
    ds_read_b64_tr_b16 a[208:209], v11 offset:40960
    v_add_f32 v118, v118, v70
    v_mfma_f32_16x16x32_bf16 v[160:163], a[184:187], a[152:155], v[160:163]
    ds_read_b64_tr_b16 a[210:211], v11 offset:43008
    v_add_f32 v119, v119, v71
    v_mfma_f32_16x16x32_bf16 v[160:163], a[188:191], a[168:171], v[160:163]
    ds_read_b64_tr_b16 a[212:213], v11 offset:45056
    v_add_f32 v116, v116, v72
    v_mfma_f32_16x16x32_bf16 v[168:171], a[188:191], a[172:175], v[168:171]
    buffer_load_dwordx4 v[108:111], v14, s[24:27], s72 offen sc1
    v_mfma_f32_16x16x32_bf16 v[168:171], a[184:187], a[156:159], v[168:171]
    s_waitcnt vmcnt(4)
    ds_read_b64_tr_b16 a[214:215], v11 offset:47104
    v_add_u32 v11, 90112, v11
    v_mfma_f32_16x16x32_bf16 v[176:179], a[184:187], a[160:163], v[176:179]
    buffer_store_dword v17, v7, s[24:27], s67 offen offset:24 sc1
    v_mfma_f32_16x16x32_bf16 v[176:179], a[188:191], a[176:179], v[176:179]
    buffer_load_dwordx4 v[112:115], v14, s[24:27], s72 offen offset:1024 sc1
    v_mfma_f32_16x16x32_bf16 v[184:187], a[188:191], a[180:183], v[184:187]
    s_waitcnt lgkmcnt(3)
    v_lshlrev_b32 v17, 2, v2
    v_add_f32 v117, v117, v73
    v_mfma_f32_16x16x32_bf16 v[184:187], a[184:187], a[164:167], v[184:187]
    s_xor_b32 s67, s50, 1
    v_add_f32 v118, v118, v74
    v_add_f32 v119, v119, v75
    v_mfma_f32_16x16x32_bf16 v[188:191], a[192:195], a[164:167], v[188:191]
    buffer_load_dwordx2 v[106:107], v39, s[24:27], s72 offen offset:2048 sc1
    v_mfma_f32_16x16x32_bf16 v[188:191], a[196:199], a[180:183], v[188:191]
    s_lshl_b32 s67, s67, 10
    v_add_f32 v116, v116, v76
    v_add_f32 v117, v117, v77
    v_mfma_f32_16x16x32_bf16 v[180:183], a[196:199], a[176:179], v[180:183]
    s_barrier
    v_mfma_f32_16x16x32_bf16 v[180:183], a[192:195], a[160:163], v[180:183]
    s_add_u32 s67, s61, s67
    ds_read_b64_tr_b16 a[184:185], v8 offset:45056
    v_add_f32 v118, v118, v78
    v_mfma_f32_16x16x32_bf16 v[172:175], a[192:195], a[156:159], v[172:175]
    ds_read_b64_tr_b16 a[186:187], v8 offset:47104
    v_add_f32 v119, v119, v79
    v_mfma_f32_16x16x32_bf16 v[172:175], a[196:199], a[172:175], v[172:175]
    ds_read_b64_tr_b16 a[188:189], v8 offset:40960
    v_add_f32 v116, v116, v80
    v_mfma_f32_16x16x32_bf16 v[164:167], a[196:199], a[168:171], v[164:167]
    ds_read_b64_tr_b16 a[190:191], v8 offset:43008
    v_add_f32 v117, v117, v81
    v_mfma_f32_16x16x32_bf16 v[164:167], a[192:195], a[152:155], v[164:167]
    ds_read_b64_tr_b16 a[192:193], v9 offset:45056
    v_add_f32 v118, v118, v82
    v_mfma_f32_16x16x32_bf16 v[160:163], a[200:203], a[80:83], v[160:163]
    s_load_dwordx8 s[28:35], s[86:87], s93 glc
    ds_read_b64_tr_b16 a[194:195], v9 offset:47104
    v_add_f32 v119, v119, v83
    v_mfma_f32_16x16x32_bf16 v[160:163], a[204:207], a[96:99], v[160:163]
    ds_read_b64_tr_b16 a[196:197], v9 offset:40960
    v_add_f32 v116, v116, v84
    v_mfma_f32_16x16x32_bf16 v[168:171], a[204:207], a[100:103], v[168:171]
    ds_read_b64_tr_b16 a[198:199], v9 offset:43008
    v_add_f32 v117, v117, v85
    v_mfma_f32_16x16x32_bf16 v[168:171], a[200:203], a[84:87], v[168:171]
    s_waitcnt lgkmcnt(8)
    v_add_f32 v118, v118, v86
    v_cvt_pk_bf16_f32 v160, v160, v161
    v_mfma_f32_16x16x32_bf16 v[176:179], a[200:203], a[88:91], v[176:179]
    v_cvt_pk_bf16_f32 v161, v162, v163
    v_add_f32 v119, v119, v87
    v_mfma_f32_16x16x32_bf16 v[176:179], a[204:207], a[104:107], v[176:179]
    s_xor_b32 s78, s53, 5
    v_cvt_pk_bf16_f32 v168, v168, v169
    v_cvt_pk_bf16_f32 v169, v170, v171
    v_mfma_f32_16x16x32_bf16 v[184:187], a[204:207], a[108:111], v[184:187]
    s_mul_i32 s78, s78, 2560
    v_add_f32 v116, v116, v88
    v_add_f32 v117, v117, v89
    v_mfma_f32_16x16x32_bf16 v[184:187], a[200:203], a[92:95], v[184:187]
    s_add_u32 s78, s78, s60
    ds_read_b64_tr_b16 a[200:201], v8 offset:36864
    v_cvt_pk_bf16_f32 v176, v176, v177
    v_mfma_f32_16x16x32_bf16 v[188:191], a[208:211], a[92:95], v[188:191]
    s_xor_b32 s79, s53, 4
    ds_read_b64_tr_b16 a[202:203], v8 offset:38912
    v_cvt_pk_bf16_f32 v177, v178, v179
    v_mfma_f32_16x16x32_bf16 v[188:191], a[212:215], a[108:111], v[188:191]
    s_mul_i32 s79, s79, 2560
    ds_read_b64_tr_b16 a[204:205], v8 offset:32768
    v_cvt_pk_bf16_f32 v184, v184, v185
    v_mfma_f32_16x16x32_bf16 v[180:183], a[212:215], a[104:107], v[180:183]
    s_waitcnt lgkmcnt(5)
    ds_read_b64_tr_b16 a[206:207], v8 offset:34816
    v_cvt_pk_bf16_f32 v185, v186, v187
    v_mfma_f32_16x16x32_bf16 v[180:183], a[208:211], a[88:91], v[180:183]
    s_add_u32 s79, s79, s60
    v_cvt_pk_bf16_f32 v186, v188, v189
    v_cvt_pk_bf16_f32 v187, v190, v191
    v_mfma_f32_16x16x32_bf16 v[172:175], a[208:211], a[84:87], v[172:175]
    v_add_f32 v118, v118, v90
    v_add_f32 v119, v119, v91
    v_mfma_f32_16x16x32_bf16 v[172:175], a[212:215], a[100:103], v[172:175]
    v_add_f32 v116, v116, v92
    v_cvt_pk_bf16_f32 v178, v180, v181
    v_mfma_f32_16x16x32_bf16 v[164:167], a[212:215], a[96:99], v[164:167]
    v_cvt_pk_bf16_f32 v179, v182, v183
    v_add_f32 v117, v117, v93
    v_mfma_f32_16x16x32_bf16 v[164:167], a[208:211], a[80:83], v[164:167]
    ds_read_b64_tr_b16 a[208:209], v9 offset:36864
    v_add_f32 v118, v118, v94
    v_mfma_f32_16x16x32_bf16 v[192:195], a[184:187], a[128:131], v[192:195]
    ds_read_b64_tr_b16 a[210:211], v9 offset:38912
    v_cvt_pk_bf16_f32 v170, v172, v173
    v_mfma_f32_16x16x32_bf16 v[192:195], a[188:191], a[0:3], v[192:195]
    ds_read_b64_tr_b16 a[212:213], v9 offset:32768
    v_cvt_pk_bf16_f32 v171, v174, v175
    v_mfma_f32_16x16x32_bf16 v[200:203], a[188:191], a[4:7], v[200:203]
    ds_read_b64_tr_b16 a[214:215], v9 offset:34816
    v_cvt_pk_bf16_f32 v162, v164, v165
    v_mfma_f32_16x16x32_bf16 v[200:203], a[184:187], a[132:135], v[200:203]
    v_cvt_pk_bf16_f32 v163, v166, v167
    v_add_f32 v119, v119, v95
    v_mfma_f32_16x16x32_bf16 v[208:211], a[184:187], a[136:139], v[208:211]
    buffer_store_dwordx4 v[160:163], v14, s[24:27], s78 offen offset:0 sc1
    v_mov_b32 v120, v116
    v_mfma_f32_16x16x32_bf16 v[208:211], a[188:191], a[8:11], v[208:211]
    buffer_store_dwordx4 v[168:171], v14, s[24:27], s78 offen offset:1024 sc1
    v_mov_b32 v121, v117
    v_mfma_f32_16x16x32_bf16 v[216:219], a[188:191], a[12:15], v[216:219]
    s_waitcnt lgkmcnt(5)
    v_permlane16_swap_b32 v116, v120
    v_mfma_f32_16x16x32_bf16 v[216:219], a[184:187], a[140:143], v[216:219]
    ds_read_b64_tr_b16 a[184:185], v8 offset:28672
    v_mov_b32 v122, v118
    v_mfma_f32_16x16x32_bf16 v[220:223], a[192:195], a[140:143], v[220:223]
    ds_read_b64_tr_b16 a[186:187], v8 offset:30720
    v_mov_b32 v123, v119
    v_mfma_f32_16x16x32_bf16 v[220:223], a[196:199], a[12:15], v[220:223]
    ds_read_b64_tr_b16 a[188:189], v8 offset:24576
    v_add_f32 v116, v116, v120
    v_mfma_f32_16x16x32_bf16 v[212:215], a[196:199], a[8:11], v[212:215]
    ds_read_b64_tr_b16 a[190:191], v8 offset:26624
    v_cvt_pk_bf16_f32 v116, 0, v116
    v_mfma_f32_16x16x32_bf16 v[212:215], a[192:195], a[136:139], v[212:215]
    buffer_store_dwordx4 v[176:179], v14, s[24:27], s79 offen offset:0 sc1
    v_mul_f32 v116, v116, v54
    v_mfma_f32_16x16x32_bf16 v[204:207], a[192:195], a[132:135], v[204:207]
    s_or_b64 s[88:89], s[28:29], s[30:31]
    v_permlane16_swap_b32 v117, v121
    v_mfma_f32_16x16x32_bf16 v[204:207], a[196:199], a[4:7], v[204:207]
    s_or_b64 s[88:89], s[88:89], s[32:33]
    v_permlane16_swap_b32 v118, v122
    v_mfma_f32_16x16x32_bf16 v[196:199], a[196:199], a[0:3], v[196:199]
    s_waitcnt lgkmcnt(5)
    v_permlane16_swap_b32 v119, v123
    v_mfma_f32_16x16x32_bf16 v[196:199], a[192:195], a[128:131], v[196:199]
    s_load_dwordx8 s[28:35], s[86:87], s93 glc
    ds_read_b64_tr_b16 a[192:193], v9 offset:28672
    v_add_f32 v117, v117, v121
    v_mfma_f32_16x16x32_bf16 v[192:195], a[200:203], a[16:19], v[192:195]
    s_or_b64 s[88:89], s[88:89], s[34:35]
    ds_read_b64_tr_b16 a[194:195], v9 offset:30720
    v_add_f32 v118, v118, v122
    v_mfma_f32_16x16x32_bf16 v[192:195], a[204:207], a[32:35], v[192:195]
    buffer_store_dwordx4 v[184:187], v14, s[24:27], s79 offen offset:1024 sc1
    v_add_f32 v119, v119, v123
    v_mfma_f32_16x16x32_bf16 v[200:203], a[204:207], a[36:39], v[200:203]
    s_or_b32 s66, s88, s89
    ds_read_b64_tr_b16 a[196:197], v9 offset:24576
    v_cvt_pk_bf16_f32 v117, 0, v117
    v_mfma_f32_16x16x32_bf16 v[200:203], a[200:203], a[20:23], v[200:203]
    s_andn2_b32 s69, s66, s80
    s_cselect_b32 s65, s59, 0x70000000
    v_cvt_pk_bf16_f32 v118, 0, v118
    v_mfma_f32_16x16x32_bf16 v[208:211], a[200:203], a[24:27], v[208:211]
    s_ff1_i32_b32 s69, s69
    ds_read_b64_tr_b16 a[198:199], v9 offset:26624
    v_cvt_pk_bf16_f32 v119, 0, v119
    v_mfma_f32_16x16x32_bf16 v[208:211], a[204:207], a[40:43], v[208:211]
    s_xor_b32 s73, s53, s69
    v_mul_f32 v117, v117, v54
    v_mul_f32 v118, v118, v54
    v_mfma_f32_16x16x32_bf16 v[216:219], a[204:207], a[44:47], v[216:219]
    s_waitcnt lgkmcnt(7)
    v_mul_f32 v119, v119, v54
    v_cvt_pk_bf16_f32 v116, 0, v116
    v_mfma_f32_16x16x32_bf16 v[216:219], a[200:203], a[28:31], v[216:219]
    s_mul_i32 s73, s73, 20480
    v_cvt_pk_bf16_f32 v117, 0, v117
    v_cvt_pk_bf16_f32 v118, 0, v118
    v_mfma_f32_16x16x32_bf16 v[220:223], a[208:211], a[28:31], v[220:223]
    s_add_u32 s73, s73, s65
    v_cvt_pk_bf16_f32 v119, 0, v119
    v_add_f32 v116, v116, v50
    v_mfma_f32_16x16x32_bf16 v[220:223], a[212:215], a[44:47], v[220:223]
    s_bitset1_b32 s80, s69
    v_add_f32 v117, v117, v51
    v_add_f32 v118, v118, v52
    v_mfma_f32_16x16x32_bf16 v[212:215], a[212:215], a[40:43], v[212:215]
    s_barrier
    v_mfma_f32_16x16x32_bf16 v[212:215], a[208:211], a[24:27], v[212:215]
    ds_read_b64_tr_b16 a[200:201], v8 offset:20480
    v_add_f32 v119, v119, v53
    v_mfma_f32_16x16x32_bf16 v[204:207], a[208:211], a[20:23], v[204:207]
    ds_read_b64_tr_b16 a[202:203], v8 offset:22528
    v_cvt_pk_bf16_f32 v116, 0, v116
    v_mfma_f32_16x16x32_bf16 v[204:207], a[212:215], a[36:39], v[204:207]
    s_waitcnt lgkmcnt(6)
    ds_read_b64_tr_b16 a[204:205], v8 offset:16384
    v_cvt_pk_bf16_f32 v117, 0, v117
    v_mfma_f32_16x16x32_bf16 v[196:199], a[212:215], a[32:35], v[196:199]
    buffer_load_dwordx4 v[130:133], v14, s[24:27], s73 offen sc1
    v_mfma_f32_16x16x32_bf16 v[196:199], a[208:211], a[16:19], v[196:199]
    ds_read_b64_tr_b16 a[206:207], v8 offset:18432
    v_cvt_pk_bf16_f32 v118, 0, v118
    v_mfma_f32_16x16x32_bf16 v[192:195], a[184:187], a[48:51], v[192:195]
    ds_read_b64_tr_b16 a[208:209], v9 offset:20480
    v_cvt_pk_bf16_f32 v119, 0, v119
    v_mfma_f32_16x16x32_bf16 v[192:195], a[188:191], a[64:67], v[192:195]
    buffer_load_dwordx4 v[134:137], v14, s[24:27], s73 offen offset:1024 sc1
    v_mfma_f32_16x16x32_bf16 v[200:203], a[188:191], a[68:71], v[200:203]
    ds_read_b64_tr_b16 a[210:211], v9 offset:22528
    v_mul_f32 v120, s92, v116
    v_mfma_f32_16x16x32_bf16 v[200:203], a[184:187], a[52:55], v[200:203]
    ds_read_b64_tr_b16 a[212:213], v9 offset:16384
    v_mul_f32 v121, s92, v117
    v_mfma_f32_16x16x32_bf16 v[208:211], a[184:187], a[56:59], v[208:211]
    s_waitcnt lgkmcnt(6)
    ds_read_b64_tr_b16 a[214:215], v9 offset:18432
    v_mul_f32 v122, s92, v118
    v_mfma_f32_16x16x32_bf16 v[208:211], a[188:191], a[72:75], v[208:211]
    buffer_load_dwordx2 v[128:129], v39, s[24:27], s73 offen offset:2048 sc1
    v_mfma_f32_16x16x32_bf16 v[216:219], a[188:191], a[76:79], v[216:219]
    v_exp_f32 v120, v120
    v_mfma_f32_16x16x32_bf16 v[216:219], a[184:187], a[60:63], v[216:219]
    ds_read_b64_tr_b16 a[184:185], v8 offset:12288
    v_mul_f32 v123, s92, v119
    v_mfma_f32_16x16x32_bf16 v[220:223], a[192:195], a[60:63], v[220:223]
    ds_read_b64_tr_b16 a[186:187], v8 offset:14336
    v_add_f32 v120, 1.0, v120
    v_mfma_f32_16x16x32_bf16 v[220:223], a[196:199], a[76:79], v[220:223]
    ds_read_b64_tr_b16 a[188:189], v8 offset:8192
    v_cmp_eq_u32 s[22:23], s40, v20
    v_mfma_f32_16x16x32_bf16 v[212:215], a[196:199], a[72:75], v[212:215]
    s_or_b64 s[10:11], s[10:11], s[22:23]
    ds_read_b64_tr_b16 a[190:191], v8 offset:10240
    v_lshrrev_b32 v21, 4, v1
    v_mfma_f32_16x16x32_bf16 v[212:215], a[192:195], a[56:59], v[212:215]
    s_waitcnt lgkmcnt(6)
    v_exp_f32 v121, v121
    v_mfma_f32_16x16x32_bf16 v[204:207], a[192:195], a[52:55], v[204:207]
    v_exp_f32 v122, v122
    v_mfma_f32_16x16x32_bf16 v[204:207], a[196:199], a[68:71], v[204:207]
    v_exp_f32 v123, v123
    v_mfma_f32_16x16x32_bf16 v[196:199], a[196:199], a[64:67], v[196:199]
    v_rcp_f32 v120, v120
    v_mfma_f32_16x16x32_bf16 v[196:199], a[192:195], a[48:51], v[196:199]
    s_or_b64 s[88:89], s[28:29], s[30:31]
    ds_read_b64_tr_b16 a[192:193], v9 offset:12288
    v_add_f32 v121, 1.0, v121
    v_mfma_f32_16x16x32_bf16 v[192:195], a[200:203], a[216:219], v[192:195]
    s_or_b64 s[88:89], s[88:89], s[32:33]
    ds_read_b64_tr_b16 a[194:195], v9 offset:14336
    v_add_f32 v122, 1.0, v122
    v_mfma_f32_16x16x32_bf16 v[192:195], a[204:207], a[232:235], v[192:195]
    s_or_b64 s[88:89], s[88:89], s[34:35]
    ds_read_b64_tr_b16 a[196:197], v9 offset:8192
    v_add_f32 v123, 1.0, v123
    v_mfma_f32_16x16x32_bf16 v[200:203], a[204:207], a[236:239], v[200:203]
    s_or_b32 s66, s88, s89
    ds_read_b64_tr_b16 a[198:199], v9 offset:10240
    v_mul_f32 v116, v116, v120
    v_mfma_f32_16x16x32_bf16 v[200:203], a[200:203], a[220:223], v[200:203]
    v_rcp_f32 v121, v121
    v_mfma_f32_16x16x32_bf16 v[208:211], a[200:203], a[224:227], v[208:211]
    v_rcp_f32 v122, v122
    v_mfma_f32_16x16x32_bf16 v[208:211], a[204:207], a[240:243], v[208:211]
    s_andn2_b32 s69, s66, s80
    s_cselect_b32 s65, s59, 0x70000000
    v_mul_f32 v117, v117, v121
    v_mfma_f32_16x16x32_bf16 v[216:219], a[204:207], a[244:247], v[216:219]
    s_waitcnt lgkmcnt(5)
    v_rcp_f32 v123, v123
    v_mfma_f32_16x16x32_bf16 v[216:219], a[200:203], a[228:231], v[216:219]
    s_ff1_i32_b32 s69, s69
    ds_read_b64_tr_b16 a[200:201], v8 offset:4096
    v_mul_f32 v118, v118, v122
    v_mfma_f32_16x16x32_bf16 v[220:223], a[208:211], a[228:231], v[220:223]
    s_xor_b32 s81, s53, s69
    ds_read_b64_tr_b16 a[202:203], v8 offset:6144
    v_mul_f32 v119, v119, v123
    v_mfma_f32_16x16x32_bf16 v[220:223], a[212:215], a[244:247], v[220:223]
    s_mul_i32 s81, s81, 20480
    ds_read_b64_tr_b16 a[204:205], v8 offset:0
    v_cvt_pk_bf16_f32 v116, v116, v117
    v_mfma_f32_16x16x32_bf16 v[212:215], a[212:215], a[240:243], v[212:215]
    s_add_u32 s81, s81, s65
    ds_read_b64_tr_b16 a[206:207], v8 offset:2048
    v_cvt_pk_bf16_f32 v117, v118, v119
    v_mfma_f32_16x16x32_bf16 v[212:215], a[208:211], a[224:227], v[212:215]
    ds_write_b64 v12, v[116:117]
    v_mfma_f32_16x16x32_bf16 v[204:207], a[208:211], a[220:223], v[204:207]
    s_bitset1_b32 s80, s69
    v_lshl_add_u32 v21, v21, 3, s56
    v_add_u32 v20, 256, v21
    v_mfma_f32_16x16x32_bf16 v[204:207], a[212:215], a[236:239], v[204:207]
    v_cndmask_b32 v22, v21, v20, s[20:21]
    v_cndmask_b32 v23, v21, v20, s[22:23]
    v_mfma_f32_16x16x32_bf16 v[196:199], a[212:215], a[232:235], v[196:199]
    s_mov_b64 exec, s[8:9]
    ds_read2_b64 v[40:43], v22 offset0:0 offset1:4
    s_mov_b64 exec, -1
    v_mfma_f32_16x16x32_bf16 v[196:199], a[208:211], a[216:219], v[196:199]
    s_mov_b64 exec, s[10:11]
    ds_read2_b64 v[44:47], v23 offset0:0 offset1:4
    s_mov_b64 exec, -1
    v_mfma_f32_16x16x32_bf16 v[192:195], a[184:187], a[152:155], v[192:195]
    s_waitcnt lgkmcnt(6)
    ds_read_b64_tr_b16 a[208:209], v9 offset:4096
    v_cmp_eq_u32 s[20:21], s39, v37
    v_mfma_f32_16x16x32_bf16 v[192:195], a[188:191], a[168:171], v[192:195]
    buffer_load_dwordx4 v[140:143], v14, s[24:27], s81 offen sc1
    v_mfma_f32_16x16x32_bf16 v[200:203], a[188:191], a[172:175], v[200:203]
    ds_read_b64_tr_b16 a[210:211], v9 offset:6144
    v_cmp_eq_u32 s[22:23], s40, v37
    v_mfma_f32_16x16x32_bf16 v[200:203], a[184:187], a[156:159], v[200:203]
    s_waitcnt vmcnt(4)
    ds_read_b64_tr_b16 a[212:213], v9 offset:0
    v_cndmask_b32 v13, v21, v20, s[22:23]
    v_mfma_f32_16x16x32_bf16 v[208:211], a[184:187], a[160:163], v[208:211]
    buffer_store_dword v16, v7, s[24:27], s77 offen offset:16 sc1
    v_mfma_f32_16x16x32_bf16 v[208:211], a[188:191], a[176:179], v[208:211]
    buffer_load_dwordx4 v[144:147], v14, s[24:27], s81 offen offset:1024 sc1
    v_mfma_f32_16x16x32_bf16 v[216:219], a[188:191], a[180:183], v[216:219]
    s_xor_b32 s77, s50, 0
    ds_read_b64_tr_b16 a[214:215], v9 offset:2048
    v_lshlrev_b32 v16, 0, v2
    v_mfma_f32_16x16x32_bf16 v[216:219], a[184:187], a[164:167], v[216:219]
    buffer_load_dwordx2 v[138:139], v39, s[24:27], s81 offen offset:2048 sc1
    v_mfma_f32_16x16x32_bf16 v[220:223], a[192:195], a[164:167], v[220:223]
    s_lshl_b32 s77, s77, 10
    ds_read_b64_tr_b16 a[184:185], v10 offset:45056
    v_and_b32 v20, 8, v39
    v_mfma_f32_16x16x32_bf16 v[220:223], a[196:199], a[180:183], v[220:223]
    s_waitcnt lgkmcnt(3)
    ds_read_b64_tr_b16 a[186:187], v10 offset:47104
    v_lshl_add_u32 v13, v20, 2, v13
    v_mfma_f32_16x16x32_bf16 v[212:215], a[196:199], a[176:179], v[212:215]
    s_add_u32 s77, s61, s77
    ds_read_b64_tr_b16 a[188:189], v10 offset:40960
    v_bfe_u32 v20, v1, 2, 2
    v_mfma_f32_16x16x32_bf16 v[212:215], a[192:195], a[160:163], v[212:215]
    s_or_b64 s[20:21], s[20:21], s[22:23]
    ds_read_b64_tr_b16 a[190:191], v10 offset:43008
    v_lshrrev_b32 v21, 4, v1
    v_mfma_f32_16x16x32_bf16 v[204:207], a[192:195], a[156:159], v[204:207]
    s_mov_b64 exec, s[20:21]
    ds_read_b64 v[48:49], v13 offset:64
    s_mov_b64 exec, -1
    v_mfma_f32_16x16x32_bf16 v[204:207], a[196:199], a[172:175], v[204:207]
    v_cmp_eq_u32 vcc, v20, v21
    v_and_b32 v20, 1, v1
    v_mfma_f32_16x16x32_bf16 v[196:199], a[196:199], a[168:171], v[196:199]
    v_lshlrev_b32 v20, 4, v20
    v_mov_b32 v21, 0x3f80
    v_mfma_f32_16x16x32_bf16 v[196:199], a[192:195], a[152:155], v[196:199]
    ds_read_b64_tr_b16 a[192:193], v11 offset:45056
    v_lshlrev_b32 v20, v20, v21
    v_mfma_f32_16x16x32_bf16 v[192:195], a[200:203], a[80:83], v[192:195]
    ds_read_b64_tr_b16 a[194:195], v11 offset:47104
    v_cndmask_b32 v20, 0, v20, vcc
    v_mfma_f32_16x16x32_bf16 v[192:195], a[204:207], a[96:99], v[192:195]
    ds_read_b64_tr_b16 a[196:197], v11 offset:40960
    v_and_b32 v21, 2, v1
    v_mfma_f32_16x16x32_bf16 v[200:203], a[204:207], a[100:103], v[200:203]
    ds_read_b64_tr_b16 a[198:199], v11 offset:43008
    v_cmp_eq_u32 vcc, 0, v21
    v_mfma_f32_16x16x32_bf16 v[200:203], a[200:203], a[84:87], v[200:203]
    s_waitcnt lgkmcnt(4)
    v_cndmask_b32 v184, 0, v20, vcc
    v_cvt_pk_bf16_f32 v192, v192, v193
    v_mfma_f32_16x16x32_bf16 v[208:211], a[200:203], a[88:91], v[208:211]
    v_cvt_pk_bf16_f32 v193, v194, v195
    v_sub_u32 v185, v20, v184
    v_mfma_f32_16x16x32_bf16 v[208:211], a[204:207], a[104:107], v[208:211]
    s_xor_b32 s78, s53, 3
    v_cvt_pk_bf16_f32 v200, v200, v201
    v_cvt_pk_bf16_f32 v201, v202, v203
    v_mfma_f32_16x16x32_bf16 v[216:219], a[204:207], a[108:111], v[216:219]
    s_mul_i32 s78, s78, 2560
    v_mov_b32 v186, v184
    v_mov_b32 v187, v185
    v_mfma_f32_16x16x32_bf16 v[216:219], a[200:203], a[92:95], v[216:219]
    s_add_u32 s78, s78, s60
    ds_read_b64_tr_b16 a[200:201], v10 offset:36864
    v_cvt_pk_bf16_f32 v208, v208, v209
    v_mfma_f32_16x16x32_bf16 v[220:223], a[208:211], a[92:95], v[220:223]
    s_xor_b32 s79, s53, 2
    ds_read_b64_tr_b16 a[202:203], v10 offset:38912
    v_cvt_pk_bf16_f32 v209, v210, v211
    v_mfma_f32_16x16x32_bf16 v[220:223], a[212:215], a[108:111], v[220:223]
    s_mul_i32 s79, s79, 2560
    ds_read_b64_tr_b16 a[204:205], v10 offset:32768
    v_cvt_pk_bf16_f32 v216, v216, v217
    v_mfma_f32_16x16x32_bf16 v[212:215], a[212:215], a[104:107], v[212:215]
    s_add_u32 s79, s79, s60
    ds_read_b64_tr_b16 a[206:207], v10 offset:34816
    v_cvt_pk_bf16_f32 v217, v218, v219
    v_mfma_f32_16x16x32_bf16 v[212:215], a[208:211], a[88:91], v[212:215]
    v_cvt_pk_bf16_f32 v218, v220, v221
    v_cvt_pk_bf16_f32 v219, v222, v223
    v_mfma_f32_16x16x32_bf16 v[204:207], a[208:211], a[84:87], v[204:207]
    v_mov_b32 v188, 0
    v_mov_b32 v189, 0
    v_mfma_f32_16x16x32_bf16 v[204:207], a[212:215], a[100:103], v[204:207]
    v_mov_b32 v190, v184
    v_mov_b32 v191, v185
    v_mfma_f32_16x16x32_bf16 v[196:199], a[212:215], a[96:99], v[196:199]
    v_cvt_pk_bf16_f32 v210, v212, v213
    v_cvt_pk_bf16_f32 v211, v214, v215
    v_mfma_f32_16x16x32_bf16 v[196:199], a[208:211], a[80:83], v[196:199]
    s_load_dwordx8 s[28:35], s[86:87], s93 glc
    ds_read_b64_tr_b16 a[208:209], v11 offset:36864
    v_cvt_pk_bf16_f32 v202, v204, v205
    v_mfma_f32_16x16x32_bf16 v[224:227], a[184:187], a[128:131], v[224:227]
    ds_read_b64_tr_b16 a[210:211], v11 offset:38912
    v_cvt_pk_bf16_f32 v203, v206, v207
    v_mfma_f32_16x16x32_bf16 v[224:227], a[188:191], a[0:3], v[224:227]
    s_waitcnt lgkmcnt(4)
    ds_read_b64_tr_b16 a[212:213], v11 offset:32768
    v_cvt_pk_bf16_f32 v194, v196, v197
    v_mfma_f32_16x16x32_bf16 v[232:235], a[188:191], a[4:7], v[232:235]
    ds_read_b64_tr_b16 a[214:215], v11 offset:34816
    v_cvt_pk_bf16_f32 v195, v198, v199
    v_mfma_f32_16x16x32_bf16 v[232:235], a[184:187], a[132:135], v[232:235]
    buffer_store_dwordx4 v[192:195], v14, s[24:27], s78 offen offset:1024 sc1
    v_lshlrev_b32 v196, 16, v26
    v_mfma_f32_16x16x32_bf16 v[236:239], a[192:195], a[132:135], v[236:239]
    ds_read_b64_tr_b16 a[184:185], v10 offset:28672
    v_lshlrev_b32 v192, 16, v24
    v_mfma_f32_16x16x32_bf16 v[236:239], a[196:199], a[4:7], v[236:239]
    ds_read_b64_tr_b16 a[186:187], v10 offset:30720
    v_and_b32 v193, 0xffff0000, v24
    v_mfma_f32_16x16x32_bf16 v[228:231], a[196:199], a[0:3], v[228:231]
    s_waitcnt lgkmcnt(6)
    ds_read_b64_tr_b16 a[188:189], v10 offset:24576
    v_lshlrev_b32 v194, 16, v25
    v_mfma_f32_16x16x32_bf16 v[228:231], a[192:195], a[128:131], v[228:231]
    buffer_store_dwordx4 v[200:203], v14, s[24:27], s78 offen offset:0 sc1
    v_and_b32 v195, 0xffff0000, v25
    v_mfma_f32_16x16x32_bf16 v[224:227], a[200:203], a[16:19], v[224:227]
    ds_read_b64_tr_b16 a[190:191], v10 offset:26624
    v_and_b32 v197, 0xffff0000, v26
    v_mfma_f32_16x16x32_bf16 v[224:227], a[204:207], a[32:35], v[224:227]
    s_waitcnt lgkmcnt(6)
    ds_read_b64_tr_b16 a[192:193], v11 offset:28672
    v_lshlrev_b32 v212, 16, v42
    v_mfma_f32_16x16x32_bf16 v[232:235], a[204:207], a[36:39], v[232:235]
    s_waitcnt lgkmcnt(5)
    ds_read_b64_tr_b16 a[194:195], v11 offset:30720
    v_and_b32 v213, 0xffff0000, v42
    v_mfma_f32_16x16x32_bf16 v[232:235], a[200:203], a[20:23], v[232:235]
    ds_read_b64_tr_b16 a[196:197], v11 offset:24576
    v_lshlrev_b32 v198, 16, v27
    v_mfma_f32_16x16x32_bf16 v[236:239], a[208:211], a[20:23], v[236:239]
    ds_read_b64_tr_b16 a[198:199], v11 offset:26624
    v_and_b32 v199, 0xffff0000, v27
    v_mfma_f32_16x16x32_bf16 v[236:239], a[212:215], a[36:39], v[236:239]
    s_waitcnt lgkmcnt(6)
    ds_read_b64_tr_b16 a[200:201], v10 offset:20480
    v_lshlrev_b32 v214, 16, v43
    v_mfma_f32_16x16x32_bf16 v[228:231], a[212:215], a[32:35], v[228:231]
pg_last:
    s_cbranch_execz pg_back2
    ds_read_b64_tr_b16 a[202:203], v10 offset:22528
    v_and_b32 v215, 0xffff0000, v43
    v_mfma_f32_16x16x32_bf16 v[228:231], a[208:211], a[16:19], v[228:231]
    buffer_store_dwordx4 v[208:211], v14, s[24:27], s79 offen offset:1024 sc1
    v_lshlrev_b32 v200, 16, v28
    v_mfma_f32_16x16x32_bf16 v[224:227], a[184:187], a[48:51], v[224:227]
    s_waitcnt lgkmcnt(6)
    ds_read_b64_tr_b16 a[204:205], v10 offset:16384
    v_lshlrev_b32 v208, 16, v40
    v_mfma_f32_16x16x32_bf16 v[224:227], a[188:191], a[64:67], v[224:227]
    s_waitcnt lgkmcnt(5)
    ds_read_b64_tr_b16 a[206:207], v10 offset:18432
    v_and_b32 v209, 0xffff0000, v40
    v_mfma_f32_16x16x32_bf16 v[232:235], a[188:191], a[68:71], v[232:235]
    ds_read_b64_tr_b16 a[208:209], v11 offset:20480
    v_lshlrev_b32 v210, 16, v41
    v_mfma_f32_16x16x32_bf16 v[232:235], a[184:187], a[52:55], v[232:235]
    s_waitcnt lgkmcnt(5)
    ds_read_b64_tr_b16 a[210:211], v11 offset:22528
    v_and_b32 v211, 0xffff0000, v41
    v_mfma_f32_16x16x32_bf16 v[236:239], a[192:195], a[52:55], v[236:239]
    ds_read_b64_tr_b16 a[212:213], v11 offset:16384
    v_and_b32 v201, 0xffff0000, v28
    v_mfma_f32_16x16x32_bf16 v[236:239], a[196:199], a[68:71], v[236:239]
    s_waitcnt lgkmcnt(5)
    ds_read_b64_tr_b16 a[214:215], v11 offset:18432
    v_lshlrev_b32 v202, 16, v29
    v_mfma_f32_16x16x32_bf16 v[228:231], a[196:199], a[64:67], v[228:231]
    ds_read_b64_tr_b16 a[184:185], v10 offset:12288
    v_and_b32 v203, 0xffff0000, v29
    v_mfma_f32_16x16x32_bf16 v[228:231], a[192:195], a[48:51], v[228:231]
    buffer_store_dwordx4 v[216:219], v14, s[24:27], s79 offen offset:0 sc1
    v_lshlrev_b32 v204, 16, v30
    v_mfma_f32_16x16x32_bf16 v[224:227], a[200:203], a[216:219], v[224:227]
    s_waitcnt lgkmcnt(5)
    ds_read_b64_tr_b16 a[186:187], v10 offset:14336
    v_lshlrev_b32 v216, 16, v44
    v_mfma_f32_16x16x32_bf16 v[224:227], a[204:207], a[232:235], v[224:227]
    ds_read_b64_tr_b16 a[188:189], v10 offset:8192
    v_and_b32 v217, 0xffff0000, v44
    v_mfma_f32_16x16x32_bf16 v[232:235], a[204:207], a[236:239], v[232:235]
    s_waitcnt lgkmcnt(5)
    ds_read_b64_tr_b16 a[190:191], v10 offset:10240
    v_lshlrev_b32 v218, 16, v45
    v_mfma_f32_16x16x32_bf16 v[232:235], a[200:203], a[220:223], v[232:235]
    ds_read_b64_tr_b16 a[192:193], v11 offset:12288
    v_and_b32 v219, 0xffff0000, v45
    v_mfma_f32_16x16x32_bf16 v[236:239], a[208:211], a[220:223], v[236:239]
    s_waitcnt lgkmcnt(5)
    ds_read_b64_tr_b16 a[194:195], v11 offset:14336
    v_and_b32 v205, 0xffff0000, v30
    v_mfma_f32_16x16x32_bf16 v[236:239], a[212:215], a[236:239], v[236:239]
    ds_read_b64_tr_b16 a[196:197], v11 offset:8192
    v_lshlrev_b32 v220, 16, v46
    v_mfma_f32_16x16x32_bf16 v[228:231], a[212:215], a[232:235], v[228:231]
    ds_read_b64_tr_b16 a[198:199], v11 offset:10240
    v_and_b32 v221, 0xffff0000, v46
    v_mfma_f32_16x16x32_bf16 v[228:231], a[208:211], a[216:219], v[228:231]
    s_waitcnt lgkmcnt(6)
    ds_read_b64_tr_b16 a[200:201], v10 offset:4096
    v_lshlrev_b32 v206, 16, v31
    v_mfma_f32_16x16x32_bf16 v[224:227], a[184:187], a[152:155], v[224:227]
    s_waitcnt lgkmcnt(5)
    ds_read_b64_tr_b16 a[202:203], v10 offset:6144
    v_and_b32 v207, 0xffff0000, v31
    v_mfma_f32_16x16x32_bf16 v[224:227], a[188:191], a[168:171], v[224:227]
    ds_read_b64_tr_b16 a[204:205], v10 offset:0
    v_lshlrev_b32 v222, 16, v47
    v_mfma_f32_16x16x32_bf16 v[232:235], a[188:191], a[172:175], v[232:235]
    ds_read_b64_tr_b16 a[206:207], v10 offset:2048
    v_and_b32 v223, 0xffff0000, v47
    v_mfma_f32_16x16x32_bf16 v[232:235], a[184:187], a[156:159], v[232:235]
    s_waitcnt lgkmcnt(6)
    ds_read_b64_tr_b16 a[208:209], v11 offset:4096
    v_lshlrev_b32 v50, 16, v32
    v_mfma_f32_16x16x32_bf16 v[236:239], a[192:195], a[156:159], v[236:239]
    s_waitcnt lgkmcnt(5)
    ds_read_b64_tr_b16 a[210:211], v11 offset:6144
    v_and_b32 v51, 0xffff0000, v32
    v_mfma_f32_16x16x32_bf16 v[236:239], a[196:199], a[172:175], v[236:239]
    s_xor_b32 s78, s53, 1
    ds_read_b64_tr_b16 a[212:213], v11 offset:0
    v_lshlrev_b32 v116, 16, v48
    v_mfma_f32_16x16x32_bf16 v[228:231], a[196:199], a[168:171], v[228:231]
    s_mul_i32 s78, s78, 2560
    ds_read_b64_tr_b16 a[214:215], v11 offset:2048
    v_and_b32 v117, 0xffff0000, v48
    v_mfma_f32_16x16x32_bf16 v[228:231], a[192:195], a[152:155], v[228:231]
    s_waitcnt lgkmcnt(6)
    ds_read_b64_tr_b16 a[184:185], v10 offset:45056
    v_lshlrev_b32 v52, 16, v33
    v_mfma_f32_16x16x32_bf16 v[224:227], a[200:203], a[80:83], v[224:227]
    s_waitcnt lgkmcnt(5)
    ds_read_b64_tr_b16 a[186:187], v10 offset:47104
    v_and_b32 v53, 0xffff0000, v33
    v_mfma_f32_16x16x32_bf16 v[224:227], a[204:207], a[96:99], v[224:227]
    s_add_u32 s78, s78, s60
    ds_read_b64_tr_b16 a[188:189], v10 offset:40960
    v_lshlrev_b32 v118, 16, v49
    v_mfma_f32_16x16x32_bf16 v[232:235], a[204:207], a[100:103], v[232:235]
    s_or_b64 s[88:89], s[28:29], s[30:31]
    ds_read_b64_tr_b16 a[190:191], v10 offset:43008
    v_and_b32 v119, 0xffff0000, v49
    v_mfma_f32_16x16x32_bf16 v[232:235], a[200:203], a[84:87], v[232:235]
    s_waitcnt lgkmcnt(6)
    ds_read_b64_tr_b16 a[192:193], v11 offset:45056
    v_cvt_pk_bf16_f32 v224, v224, v225
    v_mfma_f32_16x16x32_bf16 v[236:239], a[208:211], a[84:87], v[236:239]
    s_waitcnt lgkmcnt(5)
    ds_read_b64_tr_b16 a[194:195], v11 offset:47104
    v_cvt_pk_bf16_f32 v225, v226, v227
    v_mfma_f32_16x16x32_bf16 v[236:239], a[212:215], a[100:103], v[236:239]
    s_or_b64 s[88:89], s[88:89], s[32:33]
    ds_read_b64_tr_b16 a[196:197], v11 offset:40960
    v_cvt_pk_bf16_f32 v232, v232, v233
    v_mfma_f32_16x16x32_bf16 v[228:231], a[212:215], a[96:99], v[228:231]
    s_or_b64 s[88:89], s[88:89], s[34:35]
    ds_read_b64_tr_b16 a[198:199], v11 offset:43008
    v_cvt_pk_bf16_f32 v233, v234, v235
    v_mfma_f32_16x16x32_bf16 v[228:231], a[208:211], a[80:83], v[228:231]
    s_waitcnt lgkmcnt(6)
    ds_read_b64_tr_b16 a[200:201], v10 offset:36864
    v_cvt_pk_bf16_f32 v234, v236, v237
    v_mfma_f32_16x16x32_bf16 v[240:243], a[184:187], a[136:139], v[240:243]
    s_waitcnt lgkmcnt(5)
    ds_read_b64_tr_b16 a[202:203], v10 offset:38912
    v_cvt_pk_bf16_f32 v235, v238, v239
    v_mfma_f32_16x16x32_bf16 v[240:243], a[188:191], a[8:11], v[240:243]
    s_or_b32 s66, s88, s89
    ds_read_b64_tr_b16 a[204:205], v10 offset:32768
    v_cvt_pk_bf16_f32 v226, v228, v229
    v_mfma_f32_16x16x32_bf16 v[248:251], a[188:191], a[12:15], v[248:251]
    s_andn2_b32 s69, s66, s80
    s_cselect_b32 s65, s59, 0x70000000
    v_cvt_pk_bf16_f32 v227, v230, v231
    ds_read_b64_tr_b16 a[206:207], v10 offset:34816
    v_mfma_f32_16x16x32_bf16 v[248:251], a[184:187], a[140:143], v[248:251]
    s_waitcnt lgkmcnt(6)
    buffer_store_dwordx4 v[224:227], v14, s[24:27], s78 offen offset:0 sc1
    v_mfma_f32_16x16x32_bf16 v[252:255], a[192:195], a[140:143], v[252:255]
    s_waitcnt lgkmcnt(4)
    buffer_store_dwordx4 v[232:235], v14, s[24:27], s78 offen offset:1024 sc1
    v_mfma_f32_16x16x32_bf16 v[252:255], a[196:199], a[12:15], v[252:255]
    s_ff1_i32_b32 s69, s69
    ds_read_b64_tr_b16 a[208:209], v11 offset:36864
    s_xor_b32 s72, s53, s69
    ds_read_b64_tr_b16 a[210:211], v11 offset:38912
    v_mfma_f32_16x16x32_bf16 v[244:247], a[196:199], a[8:11], v[244:247]
    s_mul_i32 s72, s72, 20480
    ds_read_b64_tr_b16 a[212:213], v11 offset:32768
    s_add_u32 s72, s72, s65
    ds_read_b64_tr_b16 a[214:215], v11 offset:34816
    v_mfma_f32_16x16x32_bf16 v[244:247], a[192:195], a[136:139], v[244:247]
    s_waitcnt lgkmcnt(6)
    ds_read_b64_tr_b16 a[184:185], v10 offset:28672
    s_bitset1_b32 s80, s69
    v_mfma_f32_16x16x32_bf16 v[240:243], a[200:203], a[24:27], v[240:243]
    s_waitcnt lgkmcnt(5)
    ds_read_b64_tr_b16 a[186:187], v10 offset:30720
    v_mfma_f32_16x16x32_bf16 v[240:243], a[204:207], a[40:43], v[240:243]
    s_andn2_b32 s69, s66, s80
    s_cselect_b32 s65, s59, 0x70000000
    s_ff1_i32_b32 s69, s69
    ds_read_b64_tr_b16 a[188:189], v10 offset:24576
    v_mfma_f32_16x16x32_bf16 v[248:251], a[204:207], a[44:47], v[248:251]
    s_xor_b32 s73, s53, s69
    ds_read_b64_tr_b16 a[190:191], v10 offset:26624
    s_mul_i32 s73, s73, 20480
    v_mfma_f32_16x16x32_bf16 v[248:251], a[200:203], a[28:31], v[248:251]
    s_waitcnt lgkmcnt(6)
    ds_read_b64_tr_b16 a[192:193], v11 offset:28672
    s_add_u32 s73, s73, s65
    v_mfma_f32_16x16x32_bf16 v[252:255], a[208:211], a[28:31], v[252:255]
    s_waitcnt lgkmcnt(5)
    ds_read_b64_tr_b16 a[194:195], v11 offset:30720
    s_bitset1_b32 s80, s69
    v_mfma_f32_16x16x32_bf16 v[252:255], a[212:215], a[44:47], v[252:255]
    ds_read_b64_tr_b16 a[196:197], v11 offset:24576
    v_mfma_f32_16x16x32_bf16 v[244:247], a[212:215], a[40:43], v[244:247]
    ds_read_b64_tr_b16 a[198:199], v11 offset:26624
    v_mfma_f32_16x16x32_bf16 v[244:247], a[208:211], a[24:27], v[244:247]
    s_waitcnt lgkmcnt(6)
    ds_read_b64_tr_b16 a[200:201], v10 offset:20480
    v_mfma_f32_16x16x32_bf16 v[240:243], a[184:187], a[56:59], v[240:243]
    s_waitcnt lgkmcnt(5)
    ds_read_b64_tr_b16 a[202:203], v10 offset:22528
    v_mfma_f32_16x16x32_bf16 v[240:243], a[188:191], a[72:75], v[240:243]
    buffer_load_dwordx4 v[58:61], v14, s[24:27], s72 offen sc1
    ds_read_b64_tr_b16 a[204:205], v10 offset:16384
    v_mfma_f32_16x16x32_bf16 v[248:251], a[188:191], a[76:79], v[248:251]
    ds_read_b64_tr_b16 a[206:207], v10 offset:18432
    v_mfma_f32_16x16x32_bf16 v[248:251], a[184:187], a[60:63], v[248:251]
    s_waitcnt lgkmcnt(6)
    ds_read_b64_tr_b16 a[208:209], v11 offset:20480
    v_mfma_f32_16x16x32_bf16 v[252:255], a[192:195], a[60:63], v[252:255]
    s_waitcnt lgkmcnt(5)
    buffer_load_dwordx4 v[62:65], v14, s[24:27], s72 offen offset:1024 sc1
    v_mfma_f32_16x16x32_bf16 v[252:255], a[196:199], a[76:79], v[252:255]
    ds_read_b64_tr_b16 a[210:211], v11 offset:22528
    ds_read_b64_tr_b16 a[212:213], v11 offset:16384
    v_mfma_f32_16x16x32_bf16 v[244:247], a[196:199], a[72:75], v[244:247]
    ds_read_b64_tr_b16 a[214:215], v11 offset:18432
    v_mfma_f32_16x16x32_bf16 v[244:247], a[192:195], a[56:59], v[244:247]
    s_waitcnt lgkmcnt(6)
    buffer_load_dwordx2 v[56:57], v39, s[24:27], s72 offen offset:2048 sc1
    v_mfma_f32_16x16x32_bf16 v[240:243], a[200:203], a[224:227], v[240:243]
    s_waitcnt lgkmcnt(4)
    ds_read_b64_tr_b16 a[184:185], v10 offset:12288
    v_mfma_f32_16x16x32_bf16 v[240:243], a[204:207], a[240:243], v[240:243]
    s_waitcnt vmcnt(5)
    ds_read_b64_tr_b16 a[186:187], v10 offset:14336
    ds_read_b64_tr_b16 a[188:189], v10 offset:8192
    v_mfma_f32_16x16x32_bf16 v[248:251], a[204:207], a[244:247], v[248:251]
    buffer_store_dword v17, v7, s[24:27], s67 offen offset:8 sc1
    ds_read_b64_tr_b16 a[190:191], v10 offset:10240
    v_mfma_f32_16x16x32_bf16 v[248:251], a[200:203], a[228:231], v[248:251]
    s_waitcnt lgkmcnt(6)
    ds_read_b64_tr_b16 a[192:193], v11 offset:12288
    v_mfma_f32_16x16x32_bf16 v[252:255], a[208:211], a[228:231], v[252:255]
    s_waitcnt lgkmcnt(5)
    ds_read_b64_tr_b16 a[194:195], v11 offset:14336
    v_mfma_f32_16x16x32_bf16 v[252:255], a[212:215], a[244:247], v[252:255]
    ds_read_b64_tr_b16 a[196:197], v11 offset:8192
    v_mfma_f32_16x16x32_bf16 v[244:247], a[212:215], a[240:243], v[244:247]
    ds_read_b64_tr_b16 a[198:199], v11 offset:10240
    v_mfma_f32_16x16x32_bf16 v[244:247], a[208:211], a[224:227], v[244:247]
    s_waitcnt lgkmcnt(6)
    ds_read_b64_tr_b16 a[200:201], v10 offset:4096
    v_mfma_f32_16x16x32_bf16 v[240:243], a[184:187], a[160:163], v[240:243]
    s_waitcnt lgkmcnt(5)
    ds_read_b64_tr_b16 a[202:203], v10 offset:6144
    v_mfma_f32_16x16x32_bf16 v[240:243], a[188:191], a[176:179], v[240:243]
    ds_read_b64_tr_b16 a[204:205], v10 offset:0
    v_mfma_f32_16x16x32_bf16 v[248:251], a[188:191], a[180:183], v[248:251]
    ds_read_b64_tr_b16 a[206:207], v10 offset:2048
    v_mfma_f32_16x16x32_bf16 v[248:251], a[184:187], a[164:167], v[248:251]
    s_waitcnt lgkmcnt(6)
    ds_read_b64_tr_b16 a[208:209], v11 offset:4096
    v_mfma_f32_16x16x32_bf16 v[252:255], a[192:195], a[164:167], v[252:255]
    s_waitcnt lgkmcnt(5)
    ds_read_b64_tr_b16 a[210:211], v11 offset:6144
    v_mfma_f32_16x16x32_bf16 v[252:255], a[196:199], a[180:183], v[252:255]
    buffer_load_dwordx4 v[68:71], v14, s[24:27], s73 offen sc1
    ds_read_b64_tr_b16 a[212:213], v11 offset:0
    v_mfma_f32_16x16x32_bf16 v[244:247], a[196:199], a[176:179], v[244:247]
    ds_read_b64_tr_b16 a[214:215], v11 offset:2048
    v_mfma_f32_16x16x32_bf16 v[244:247], a[192:195], a[160:163], v[244:247]
    s_waitcnt lgkmcnt(6)
    v_mfma_f32_16x16x32_bf16 v[240:243], a[200:203], a[88:91], v[240:243]
    s_waitcnt lgkmcnt(4)
    buffer_load_dwordx4 v[72:75], v14, s[24:27], s73 offen offset:1024 sc1
    v_mfma_f32_16x16x32_bf16 v[240:243], a[204:207], a[104:107], v[240:243]
    buffer_load_dwordx2 v[66:67], v39, s[24:27], s73 offen offset:2048 sc1
    v_mfma_f32_16x16x32_bf16 v[248:251], a[204:207], a[108:111], v[248:251]
    v_mfma_f32_16x16x32_bf16 v[248:251], a[200:203], a[92:95], v[248:251]
    s_waitcnt lgkmcnt(2)
    v_mfma_f32_16x16x32_bf16 v[252:255], a[208:211], a[92:95], v[252:255]
    s_waitcnt lgkmcnt(0)
    v_mfma_f32_16x16x32_bf16 v[252:255], a[212:215], a[108:111], v[252:255]
    s_waitcnt vmcnt(7)
    s_load_dwordx8 s[28:35], s[86:87], s93 glc
    v_mfma_f32_16x16x32_bf16 v[244:247], a[212:215], a[104:107], v[244:247]
    buffer_store_dword v16, v7, s[24:27], s77 offen offset:0 sc1
    v_mfma_f32_16x16x32_bf16 v[244:247], a[208:211], a[88:91], v[244:247]
    v_mfma_f32_16x16x32_bf16 v[124:127], v[186:189], v[96:99], v[124:127]
    v_mfma_f32_16x16x32_bf16 v[240:243], v[186:189], v[98:101], v[240:243]
    v_mfma_f32_16x16x32_bf16 v[244:247], v[188:191], v[98:101], v[244:247]
    v_mfma_f32_16x16x32_bf16 v[252:255], v[188:191], v[102:105], v[252:255]
    v_mfma_f32_16x16x32_bf16 v[248:251], v[186:189], v[102:105], v[248:251]
    v_mfma_f32_16x16x32_bf16 v[124:127], v[186:189], v[106:109], v[124:127]
    v_mfma_f32_16x16x32_bf16 v[240:243], v[186:189], v[108:111], v[240:243]
    v_mfma_f32_16x16x32_bf16 v[244:247], v[188:191], v[108:111], v[244:247]
    v_mfma_f32_16x16x32_bf16 v[252:255], v[188:191], v[112:115], v[252:255]
    v_mfma_f32_16x16x32_bf16 v[248:251], v[186:189], v[112:115], v[248:251]
    v_mfma_f32_16x16x32_bf16 v[124:127], v[186:189], v[128:131], v[124:127]
    v_mfma_f32_16x16x32_bf16 v[240:243], v[186:189], v[130:133], v[240:243]
    v_mfma_f32_16x16x32_bf16 v[244:247], v[188:191], v[130:133], v[244:247]
    v_mfma_f32_16x16x32_bf16 v[252:255], v[188:191], v[134:137], v[252:255]
    v_mfma_f32_16x16x32_bf16 v[248:251], v[186:189], v[134:137], v[248:251]
    v_mfma_f32_16x16x32_bf16 v[124:127], v[186:189], v[138:141], v[124:127]
    v_mfma_f32_16x16x32_bf16 v[240:243], v[186:189], v[140:143], v[240:243]
    v_mfma_f32_16x16x32_bf16 v[244:247], v[188:191], v[140:143], v[244:247]
    v_mfma_f32_16x16x32_bf16 v[252:255], v[188:191], v[144:147], v[252:255]
    v_mfma_f32_16x16x32_bf16 v[248:251], v[186:189], v[144:147], v[248:251]
post_code:
    s_cmp_eq_u32 s80, -1
    s_cbranch_scc1 ev_st
    s_or_b64 s[88:89], s[28:29], s[30:31]
    s_or_b64 s[88:89], s[88:89], s[32:33]
    s_or_b64 s[88:89], s[88:89], s[34:35]
    s_or_b32 s66, s88, s89
    s_andn2_b32 s69, s66, s80
    s_cbranch_scc1 ev_i2
    s_branch ev_w2
ev_st:
    s_waitcnt vmcnt(1)
    v_mfma_f32_16x16x32_bf16 v[124:127], v[186:189], v[56:59], v[124:127]
    v_mfma_f32_16x16x32_bf16 v[240:243], v[186:189], v[58:61], v[240:243]
    v_mfma_f32_16x16x32_bf16 v[244:247], v[188:191], v[58:61], v[244:247]
    v_mfma_f32_16x16x32_bf16 v[252:255], v[188:191], v[62:65], v[252:255]
    v_mfma_f32_16x16x32_bf16 v[248:251], v[186:189], v[62:65], v[248:251]
    v_mfma_f32_16x16x32_bf16 v[124:127], v[186:189], v[66:69], v[124:127]
    v_mfma_f32_16x16x32_bf16 v[240:243], v[186:189], v[68:71], v[240:243]
    v_mfma_f32_16x16x32_bf16 v[244:247], v[188:191], v[68:71], v[244:247]
    v_mfma_f32_16x16x32_bf16 v[252:255], v[188:191], v[72:75], v[252:255]
    v_mfma_f32_16x16x32_bf16 v[248:251], v[186:189], v[72:75], v[248:251]
    s_branch ev_sum
ev_w0:
    s_waitcnt lgkmcnt(0)
    s_load_dwordx8 s[28:35], s[86:87], s93 glc
    s_add_u32 s101, s101, 1
    s_cmp_gt_u32 s101, 0x2000000
    s_cbranch_scc1 ev_done
    s_or_b64 s[88:89], s[28:29], s[30:31]
    s_or_b64 s[88:89], s[88:89], s[32:33]
    s_or_b64 s[88:89], s[88:89], s[34:35]
    s_or_b32 s66, s88, s89
    s_andn2_b32 s69, s66, s80
    s_cbranch_scc0 ev_w0
ev_i0:
    s_ff1_i32_b32 s69, s69
    s_xor_b32 s81, s53, s69
    s_mul_i32 s81, s81, 20480
    s_add_u32 s81, s81, s59
    s_bitset1_b32 s80, s69
    s_cmp_eq_u32 s80, -1
    s_cbranch_scc0 ev_n0
    buffer_load_dwordx4 a[122:125], v14, s[24:27], s81 offen sc1
    buffer_load_dwordx4 a[126:129], v14, s[24:27], s81 offen offset:1024 sc1
    buffer_load_dwordx2 a[120:121], v39, s[24:27], s81 offen offset:2048 sc1
    s_branch ev_z
ev_n0:
    buffer_load_dwordx4 v[58:61], v14, s[24:27], s81 offen sc1
    buffer_load_dwordx4 v[62:65], v14, s[24:27], s81 offen offset:1024 sc1
    buffer_load_dwordx2 v[56:57], v39, s[24:27], s81 offen offset:2048 sc1
    s_andn2_b32 s69, s66, s80
    s_cbranch_scc0 ev_w1
ev_i1:
    s_ff1_i32_b32 s69, s69
    s_xor_b32 s81, s53, s69
    s_mul_i32 s81, s81, 20480
    s_add_u32 s81, s81, s59
    s_bitset1_b32 s80, s69
    s_cmp_eq_u32 s80, -1
    s_cbranch_scc1 ev_l1
    buffer_load_dwordx4 v[68:71], v14, s[24:27], s81 offen sc1
    buffer_load_dwordx4 v[72:75], v14, s[24:27], s81 offen offset:1024 sc1
    buffer_load_dwordx2 v[66:67], v39, s[24:27], s81 offen offset:2048 sc1
    s_andn2_b32 s69, s66, s80
    s_cbranch_scc0 ev_w2
ev_i2:
    s_ff1_i32_b32 s69, s69
    s_xor_b32 s81, s53, s69
    s_mul_i32 s81, s81, 20480
    s_add_u32 s81, s81, s59
    s_bitset1_b32 s80, s69
    s_cmp_eq_u32 s80, -1
    s_cbranch_scc1 ev_l2
    buffer_load_dwordx4 a[2:5], v14, s[24:27], s81 offen sc1
    buffer_load_dwordx4 a[6:9], v14, s[24:27], s81 offen offset:1024 sc1
    buffer_load_dwordx2 a[0:1], v39, s[24:27], s81 offen offset:2048 sc1
    s_andn2_b32 s69, s66, s80
    s_cbranch_scc0 ev_w3
ev_i3:
    s_ff1_i32_b32 s69, s69
    s_xor_b32 s81, s53, s69
    s_mul_i32 s81, s81, 20480
    s_add_u32 s81, s81, s59
    s_bitset1_b32 s80, s69
    s_cmp_eq_u32 s80, -1
    s_cbranch_scc1 ev_l3
    buffer_load_dwordx4 a[12:15], v14, s[24:27], s81 offen sc1
    buffer_load_dwordx4 a[16:19], v14, s[24:27], s81 offen offset:1024 sc1
    buffer_load_dwordx2 a[10:11], v39, s[24:27], s81 offen offset:2048 sc1
    s_andn2_b32 s69, s66, s80
    s_cbranch_scc0 ev_w4
ev_i4:
    s_ff1_i32_b32 s69, s69
    s_xor_b32 s81, s53, s69
    s_mul_i32 s81, s81, 20480
    s_add_u32 s81, s81, s59
    s_bitset1_b32 s80, s69
    s_cmp_eq_u32 s80, -1
    s_cbranch_scc1 ev_l4
    buffer_load_dwordx4 a[22:25], v14, s[24:27], s81 offen sc1
    buffer_load_dwordx4 a[26:29], v14, s[24:27], s81 offen offset:1024 sc1
    buffer_load_dwordx2 a[20:21], v39, s[24:27], s81 offen offset:2048 sc1
    s_andn2_b32 s69, s66, s80
    s_cbranch_scc0 ev_w5
ev_i5:
    s_ff1_i32_b32 s69, s69
    s_xor_b32 s81, s53, s69
    s_mul_i32 s81, s81, 20480
    s_add_u32 s81, s81, s59
    s_bitset1_b32 s80, s69
    s_cmp_eq_u32 s80, -1
    s_cbranch_scc1 ev_l5
    buffer_load_dwordx4 a[32:35], v14, s[24:27], s81 offen sc1
    buffer_load_dwordx4 a[36:39], v14, s[24:27], s81 offen offset:1024 sc1
    buffer_load_dwordx2 a[30:31], v39, s[24:27], s81 offen offset:2048 sc1
    s_waitcnt vmcnt(0)
ev_c6:
    v_mfma_f32_16x16x32_bf16 v[124:127], v[186:189], a[30:33], v[124:127]
    v_mfma_f32_16x16x32_bf16 v[240:243], v[186:189], a[32:35], v[240:243]
    v_mfma_f32_16x16x32_bf16 v[244:247], v[188:191], a[32:35], v[244:247]
    v_mfma_f32_16x16x32_bf16 v[252:255], v[188:191], a[36:39], v[252:255]
    v_mfma_f32_16x16x32_bf16 v[248:251], v[186:189], a[36:39], v[248:251]
ev_c5:
    v_mfma_f32_16x16x32_bf16 v[124:127], v[186:189], a[20:23], v[124:127]
    v_mfma_f32_16x16x32_bf16 v[240:243], v[186:189], a[22:25], v[240:243]
    v_mfma_f32_16x16x32_bf16 v[244:247], v[188:191], a[22:25], v[244:247]
    v_mfma_f32_16x16x32_bf16 v[252:255], v[188:191], a[26:29], v[252:255]
    v_mfma_f32_16x16x32_bf16 v[248:251], v[186:189], a[26:29], v[248:251]
ev_c4:
    v_mfma_f32_16x16x32_bf16 v[124:127], v[186:189], a[10:13], v[124:127]
    v_mfma_f32_16x16x32_bf16 v[240:243], v[186:189], a[12:15], v[240:243]
    v_mfma_f32_16x16x32_bf16 v[244:247], v[188:191], a[12:15], v[244:247]
    v_mfma_f32_16x16x32_bf16 v[252:255], v[188:191], a[16:19], v[252:255]
    v_mfma_f32_16x16x32_bf16 v[248:251], v[186:189], a[16:19], v[248:251]
ev_c3:
    v_mfma_f32_16x16x32_bf16 v[124:127], v[186:189], a[0:3], v[124:127]
    v_mfma_f32_16x16x32_bf16 v[240:243], v[186:189], a[2:5], v[240:243]
    v_mfma_f32_16x16x32_bf16 v[244:247], v[188:191], a[2:5], v[244:247]
    v_mfma_f32_16x16x32_bf16 v[252:255], v[188:191], a[6:9], v[252:255]
    v_mfma_f32_16x16x32_bf16 v[248:251], v[186:189], a[6:9], v[248:251]
ev_c2:
    v_mfma_f32_16x16x32_bf16 v[124:127], v[186:189], v[66:69], v[124:127]
    v_mfma_f32_16x16x32_bf16 v[240:243], v[186:189], v[68:71], v[240:243]
    v_mfma_f32_16x16x32_bf16 v[244:247], v[188:191], v[68:71], v[244:247]
    v_mfma_f32_16x16x32_bf16 v[252:255], v[188:191], v[72:75], v[252:255]
    v_mfma_f32_16x16x32_bf16 v[248:251], v[186:189], v[72:75], v[248:251]
ev_c1:
    v_mfma_f32_16x16x32_bf16 v[124:127], v[186:189], v[56:59], v[124:127]
    v_mfma_f32_16x16x32_bf16 v[240:243], v[186:189], v[58:61], v[240:243]
    v_mfma_f32_16x16x32_bf16 v[244:247], v[188:191], v[58:61], v[244:247]
    v_mfma_f32_16x16x32_bf16 v[252:255], v[188:191], v[62:65], v[252:255]
    v_mfma_f32_16x16x32_bf16 v[248:251], v[186:189], v[62:65], v[248:251]
    s_cmp_lg_u32 s80, -1
    s_cbranch_scc1 ev_w0
ev_z:
    s_waitcnt vmcnt(0)
    v_mfma_f32_16x16x32_bf16 v[124:127], v[186:189], a[120:123], v[124:127]
    v_mfma_f32_16x16x32_bf16 v[240:243], v[186:189], a[122:125], v[240:243]
    v_mfma_f32_16x16x32_bf16 v[244:247], v[188:191], a[122:125], v[244:247]
    v_mfma_f32_16x16x32_bf16 v[252:255], v[188:191], a[126:129], v[252:255]
    v_mfma_f32_16x16x32_bf16 v[248:251], v[186:189], a[126:129], v[248:251]
ev_sum:
    s_nop 4
    v_pk_fma_f32 v[124:125], v[124:125], v[116:117], v[50:51]
    v_pk_fma_f32 v[126:127], v[126:127], v[118:119], v[52:53]
    v_cvt_pk_bf16_f32 v124, v124, v125
    v_cvt_pk_bf16_f32 v125, v126, v127
    buffer_store_dwordx2 v[124:125], v35, s[16:19], s68 offen sc1
    v_pk_fma_f32 v[240:241], v[240:241], v[208:209], v[192:193]
    v_pk_fma_f32 v[242:243], v[242:243], v[210:211], v[194:195]
    v_pk_fma_f32 v[244:245], v[244:245], v[212:213], v[196:197]
    v_pk_fma_f32 v[246:247], v[246:247], v[214:215], v[198:199]
    v_cvt_pk_bf16_f32 v240, v240, v241
    v_cvt_pk_bf16_f32 v241, v242, v243
    v_cvt_pk_bf16_f32 v242, v244, v245
    v_cvt_pk_bf16_f32 v243, v246, v247
    s_nop 1
    v_permlane16_swap_b32 v240, v242
    v_permlane16_swap_b32 v241, v243
    buffer_store_dwordx4 v[240:243], v4, s[16:19], s64 offen sc1
    v_pk_fma_f32 v[248:249], v[248:249], v[216:217], v[200:201]
    v_pk_fma_f32 v[250:251], v[250:251], v[218:219], v[202:203]
    v_pk_fma_f32 v[252:253], v[252:253], v[220:221], v[204:205]
    v_pk_fma_f32 v[254:255], v[254:255], v[222:223], v[206:207]
    v_cvt_pk_bf16_f32 v248, v248, v249
    v_cvt_pk_bf16_f32 v249, v250, v251
    v_cvt_pk_bf16_f32 v250, v252, v253
    v_cvt_pk_bf16_f32 v251, v254, v255
    s_nop 1
    v_permlane16_swap_b32 v248, v250
    v_permlane16_swap_b32 v249, v251
    buffer_store_dwordx4 v[248:251], v34, s[16:19], s64 offen sc1
ev_done:
    s_or_b32 s56, s2, s3
    s_cmp_eq_u32 s56, 0
    s_cselect_b32 s56, 0, 0x7ffffff0
    s_add_u32 s56, s56, 3203072
    buffer_store_dword v6, v15, s[24:27], s56 offen
main_fin:
main_end:
    s_endpgm
ev_w1:
    s_getreg_b32 s56, hwreg(HW_REG_IB_STS, 0, 4)
    s_cmp_eq_u32 s56, 0
    s_cbranch_scc1 ev_d1
    s_waitcnt lgkmcnt(0)
    s_load_dwordx8 s[28:35], s[86:87], s93 glc
    s_add_u32 s101, s101, 1
    s_cmp_gt_u32 s101, 0x2000000
    s_cbranch_scc1 ev_done
    s_or_b64 s[88:89], s[28:29], s[30:31]
    s_or_b64 s[88:89], s[88:89], s[32:33]
    s_or_b64 s[88:89], s[88:89], s[34:35]
    s_or_b32 s66, s88, s89
    s_andn2_b32 s69, s66, s80
    s_cbranch_scc0 ev_w1
    s_branch ev_i1
ev_d1:
    s_waitcnt vmcnt(0)
    s_branch ev_c1
ev_l1:
    buffer_load_dwordx4 a[122:125], v14, s[24:27], s81 offen sc1
    buffer_load_dwordx4 a[126:129], v14, s[24:27], s81 offen offset:1024 sc1
    buffer_load_dwordx2 a[120:121], v39, s[24:27], s81 offen offset:2048 sc1
    s_waitcnt vmcnt(3)
    s_branch ev_c1
ev_w2:
    s_getreg_b32 s56, hwreg(HW_REG_IB_STS, 0, 4)
    s_cmp_eq_u32 s56, 0
    s_cbranch_scc1 ev_d2
    s_waitcnt lgkmcnt(0)
    s_load_dwordx8 s[28:35], s[86:87], s93 glc
    s_add_u32 s101, s101, 1
    s_cmp_gt_u32 s101, 0x2000000
    s_cbranch_scc1 ev_done
    s_or_b64 s[88:89], s[28:29], s[30:31]
    s_or_b64 s[88:89], s[88:89], s[32:33]
    s_or_b64 s[88:89], s[88:89], s[34:35]
    s_or_b32 s66, s88, s89
    s_andn2_b32 s69, s66, s80
    s_cbranch_scc0 ev_w2
    s_branch ev_i2
ev_d2:
    s_waitcnt vmcnt(0)
    s_branch ev_c2
ev_l2:
    buffer_load_dwordx4 a[122:125], v14, s[24:27], s81 offen sc1
    buffer_load_dwordx4 a[126:129], v14, s[24:27], s81 offen offset:1024 sc1
    buffer_load_dwordx2 a[120:121], v39, s[24:27], s81 offen offset:2048 sc1
    s_waitcnt vmcnt(3)
    s_branch ev_c2
ev_w3:
    s_getreg_b32 s56, hwreg(HW_REG_IB_STS, 0, 4)
    s_cmp_eq_u32 s56, 0
    s_cbranch_scc1 ev_d3
    s_waitcnt lgkmcnt(0)
    s_load_dwordx8 s[28:35], s[86:87], s93 glc
    s_add_u32 s101, s101, 1
    s_cmp_gt_u32 s101, 0x2000000
    s_cbranch_scc1 ev_done
    s_or_b64 s[88:89], s[28:29], s[30:31]
    s_or_b64 s[88:89], s[88:89], s[32:33]
    s_or_b64 s[88:89], s[88:89], s[34:35]
    s_or_b32 s66, s88, s89
    s_andn2_b32 s69, s66, s80
    s_cbranch_scc0 ev_w3
    s_branch ev_i3
ev_d3:
    s_waitcnt vmcnt(0)
    s_branch ev_c3
ev_l3:
    buffer_load_dwordx4 a[122:125], v14, s[24:27], s81 offen sc1
    buffer_load_dwordx4 a[126:129], v14, s[24:27], s81 offen offset:1024 sc1
    buffer_load_dwordx2 a[120:121], v39, s[24:27], s81 offen offset:2048 sc1
    s_waitcnt vmcnt(3)
    s_branch ev_c3
ev_w4:
    s_getreg_b32 s56, hwreg(HW_REG_IB_STS, 0, 4)
    s_cmp_eq_u32 s56, 0
    s_cbranch_scc1 ev_d4
    s_waitcnt lgkmcnt(0)
    s_load_dwordx8 s[28:35], s[86:87], s93 glc
    s_add_u32 s101, s101, 1
    s_cmp_gt_u32 s101, 0x2000000
    s_cbranch_scc1 ev_done
    s_or_b64 s[88:89], s[28:29], s[30:31]
    s_or_b64 s[88:89], s[88:89], s[32:33]
    s_or_b64 s[88:89], s[88:89], s[34:35]
    s_or_b32 s66, s88, s89
    s_andn2_b32 s69, s66, s80
    s_cbranch_scc0 ev_w4
    s_branch ev_i4
ev_d4:
    s_waitcnt vmcnt(0)
    s_branch ev_c4
ev_l4:
    buffer_load_dwordx4 a[122:125], v14, s[24:27], s81 offen sc1
    buffer_load_dwordx4 a[126:129], v14, s[24:27], s81 offen offset:1024 sc1
    buffer_load_dwordx2 a[120:121], v39, s[24:27], s81 offen offset:2048 sc1
    s_waitcnt vmcnt(3)
    s_branch ev_c4
ev_w5:
    s_getreg_b32 s56, hwreg(HW_REG_IB_STS, 0, 4)
    s_cmp_eq_u32 s56, 0
    s_cbranch_scc1 ev_d5
    s_waitcnt lgkmcnt(0)
    s_load_dwordx8 s[28:35], s[86:87], s93 glc
    s_add_u32 s101, s101, 1
    s_cmp_gt_u32 s101, 0x2000000
    s_cbranch_scc1 ev_done
    s_or_b64 s[88:89], s[28:29], s[30:31]
    s_or_b64 s[88:89], s[88:89], s[32:33]
    s_or_b64 s[88:89], s[88:89], s[34:35]
    s_or_b32 s66, s88, s89
    s_andn2_b32 s69, s66, s80
    s_cbranch_scc0 ev_w5
    s_branch ev_i5
ev_d5:
    s_waitcnt vmcnt(0)
    s_branch ev_c5
ev_l5:
    buffer_load_dwordx4 a[122:125], v14, s[24:27], s81 offen sc1
    buffer_load_dwordx4 a[126:129], v14, s[24:27], s81 offen offset:1024 sc1
    buffer_load_dwordx2 a[120:121], v39, s[24:27], s81 offen offset:2048 sc1
    s_waitcnt vmcnt(3)
    s_branch ev_c5
spin_o0:
    s_load_dwordx4 s[72:75], s[86:87], s5 glc
    s_add_u32 s101, s101, 1
    s_cmp_gt_u32 s101, 0x2000000
    s_waitcnt lgkmcnt(0)
    s_cbranch_scc1 spin_o0_ret
    s_sub_u32 s78, s72, s77
    s_sub_u32 s79, s73, s77
    s_max_u32 s78, s78, s79
    s_sub_u32 s79, s74, s77
    s_max_u32 s78, s78, s79
    s_sub_u32 s79, s75, s77
    s_max_u32 s78, s78, s79
    s_cmp_gt_u32 s78, 5
    s_cbranch_scc1 spin_o0
    s_branch spin_o0_ret
spin_o1:
    s_load_dwordx4 s[72:75], s[86:87], s5 glc
    s_add_u32 s101, s101, 1
    s_cmp_gt_u32 s101, 0x2000000
    s_waitcnt lgkmcnt(0)
    s_cbranch_scc1 spin_o1_ret
    s_sub_u32 s78, s72, s77
    s_sub_u32 s79, s73, s77
    s_max_u32 s78, s78, s79
    s_sub_u32 s79, s74, s77
    s_max_u32 s78, s78, s79
    s_sub_u32 s79, s75, s77
    s_max_u32 s78, s78, s79
    s_cmp_gt_u32 s78, 4
    s_cbranch_scc1 spin_o1
    s_branch spin_o1_ret
spin_o2:
    s_load_dwordx4 s[72:75], s[86:87], s5 glc
    s_add_u32 s101, s101, 1
    s_cmp_gt_u32 s101, 0x2000000
    s_waitcnt lgkmcnt(0)
    s_cbranch_scc1 spin_o2_ret
    s_sub_u32 s78, s72, s77
    s_sub_u32 s79, s73, s77
    s_max_u32 s78, s78, s79
    s_sub_u32 s79, s74, s77
    s_max_u32 s78, s78, s79
    s_sub_u32 s79, s75, s77
    s_max_u32 s78, s78, s79
    s_cmp_gt_u32 s78, 3
    s_cbranch_scc1 spin_o2
    s_branch spin_o2_ret
spin_o3:
    s_load_dwordx4 s[72:75], s[86:87], s5 glc
    s_add_u32 s101, s101, 1
    s_cmp_gt_u32 s101, 0x2000000
    s_waitcnt lgkmcnt(0)
    s_cbranch_scc1 spin_o3_ret
    s_sub_u32 s78, s72, s77
    s_sub_u32 s79, s73, s77
    s_max_u32 s78, s78, s79
    s_sub_u32 s79, s74, s77
    s_max_u32 s78, s78, s79
    s_sub_u32 s79, s75, s77
    s_max_u32 s78, s78, s79
    s_cmp_gt_u32 s78, 2
    s_cbranch_scc1 spin_o3
    s_branch spin_o3_ret
spin_o4:
    s_load_dwordx4 s[72:75], s[86:87], s5 glc
    s_add_u32 s101, s101, 1
    s_cmp_gt_u32 s101, 0x2000000
    s_waitcnt lgkmcnt(0)
    s_cbranch_scc1 spin_o4_ret
    s_sub_u32 s78, s72, s77
    s_sub_u32 s79, s73, s77
    s_max_u32 s78, s78, s79
    s_sub_u32 s79, s74, s77
    s_max_u32 s78, s78, s79
    s_sub_u32 s79, s75, s77
    s_max_u32 s78, s78, s79
    s_cmp_gt_u32 s78, 1
    s_cbranch_scc1 spin_o4
    s_branch spin_o4_ret
spin_o5:
    s_load_dwordx4 s[72:75], s[86:87], s5 glc
    s_add_u32 s101, s101, 1
    s_cmp_gt_u32 s101, 0x2000000
    s_waitcnt lgkmcnt(0)
    s_cbranch_scc1 spin_o5_ret
    s_sub_u32 s78, s72, s77
    s_sub_u32 s79, s73, s77
    s_max_u32 s78, s78, s79
    s_sub_u32 s79, s74, s77
    s_max_u32 s78, s78, s79
    s_sub_u32 s79, s75, s77
    s_max_u32 s78, s78, s79
    s_cmp_gt_u32 s78, 0
    s_cbranch_scc1 spin_o5
    s_branch spin_o5_ret
ln_exact:
    v_mov_b32 v146, 0
    v_lshlrev_b32 v156, 16, v64
    v_and_b32 v157, s42, v64
    v_sub_f32 v156, v156, v150
    v_sub_f32 v157, v157, v150
    v_fmac_f32 v146, v156, v156
    v_fmac_f32 v146, v157, v157
    v_lshlrev_b32 v156, 16, v65
    v_and_b32 v157, s42, v65
    v_sub_f32 v156, v156, v150
    v_sub_f32 v157, v157, v150
    v_fmac_f32 v146, v156, v156
    v_fmac_f32 v146, v157, v157
    v_lshlrev_b32 v156, 16, v66
    v_and_b32 v157, s42, v66
    v_sub_f32 v156, v156, v150
    v_sub_f32 v157, v157, v150
    v_fmac_f32 v146, v156, v156
    v_fmac_f32 v146, v157, v157
    v_lshlrev_b32 v156, 16, v67
    v_and_b32 v157, s42, v67
    v_sub_f32 v156, v156, v150
    v_sub_f32 v157, v157, v150
    v_fmac_f32 v146, v156, v156
    v_fmac_f32 v146, v157, v157
    v_lshlrev_b32 v156, 16, v68
    v_and_b32 v157, s42, v68
    v_sub_f32 v156, v156, v150
    v_sub_f32 v157, v157, v150
    v_fmac_f32 v146, v156, v156
    v_fmac_f32 v146, v157, v157
    v_lshlrev_b32 v156, 16, v69
    v_and_b32 v157, s42, v69
    v_sub_f32 v156, v156, v150
    v_sub_f32 v157, v157, v150
    v_fmac_f32 v146, v156, v156
    v_fmac_f32 v146, v157, v157
    v_lshlrev_b32 v156, 16, v70
    v_and_b32 v157, s42, v70
    v_sub_f32 v156, v156, v150
    v_sub_f32 v157, v157, v150
    v_fmac_f32 v146, v156, v156
    v_fmac_f32 v146, v157, v157
    v_lshlrev_b32 v156, 16, v71
    v_and_b32 v157, s42, v71
    v_sub_f32 v156, v156, v150
    v_sub_f32 v157, v157, v150
    v_fmac_f32 v146, v156, v156
    v_fmac_f32 v146, v157, v157
    v_lshlrev_b32 v156, 16, v72
    v_and_b32 v157, s42, v72
    v_sub_f32 v156, v156, v150
    v_sub_f32 v157, v157, v150
    v_fmac_f32 v146, v156, v156
    v_fmac_f32 v146, v157, v157
    v_lshlrev_b32 v156, 16, v73
    v_and_b32 v157, s42, v73
    v_sub_f32 v156, v156, v150
    v_sub_f32 v157, v157, v150
    v_fmac_f32 v146, v156, v156
    v_fmac_f32 v146, v157, v157
    v_lshlrev_b32 v156, 16, v74
    v_and_b32 v157, s42, v74
    v_sub_f32 v156, v156, v150
    v_sub_f32 v157, v157, v150
    v_fmac_f32 v146, v156, v156
    v_fmac_f32 v146, v157, v157
    v_lshlrev_b32 v156, 16, v75
    v_and_b32 v157, s42, v75
    v_sub_f32 v156, v156, v150
    v_sub_f32 v157, v157, v150
    v_fmac_f32 v146, v156, v156
    v_fmac_f32 v146, v157, v157
    v_lshlrev_b32 v156, 16, v76
    v_and_b32 v157, s42, v76
    v_sub_f32 v156, v156, v150
    v_sub_f32 v157, v157, v150
    v_fmac_f32 v146, v156, v156
    v_fmac_f32 v146, v157, v157
    v_lshlrev_b32 v156, 16, v77
    v_and_b32 v157, s42, v77
    v_sub_f32 v156, v156, v150
    v_sub_f32 v157, v157, v150
    v_fmac_f32 v146, v156, v156
    v_fmac_f32 v146, v157, v157
    v_lshlrev_b32 v156, 16, v78
    v_and_b32 v157, s42, v78
    v_sub_f32 v156, v156, v150
    v_sub_f32 v157, v157, v150
    v_fmac_f32 v146, v156, v156
    v_fmac_f32 v146, v157, v157
    v_lshlrev_b32 v156, 16, v79
    v_and_b32 v157, s42, v79
    v_sub_f32 v156, v156, v150
    v_sub_f32 v157, v157, v150
    v_fmac_f32 v146, v156, v156
    v_fmac_f32 v146, v157, v157
    v_lshlrev_b32 v156, 16, v80
    v_and_b32 v157, s42, v80
    v_sub_f32 v156, v156, v150
    v_sub_f32 v157, v157, v150
    v_fmac_f32 v146, v156, v156
    v_fmac_f32 v146, v157, v157
    v_lshlrev_b32 v156, 16, v81
    v_and_b32 v157, s42, v81
    v_sub_f32 v156, v156, v150
    v_sub_f32 v157, v157, v150
    v_fmac_f32 v146, v156, v156
    v_fmac_f32 v146, v157, v157
    v_lshlrev_b32 v156, 16, v82
    v_and_b32 v157, s42, v82
    v_sub_f32 v156, v156, v150
    v_sub_f32 v157, v157, v150
    v_fmac_f32 v146, v156, v156
    v_fmac_f32 v146, v157, v157
    v_lshlrev_b32 v156, 16, v83
    v_and_b32 v157, s42, v83
    v_sub_f32 v156, v156, v150
    v_sub_f32 v157, v157, v150
    v_fmac_f32 v146, v156, v156
    v_fmac_f32 v146, v157, v157
    s_nop 0
    s_nop 0
    v_add_f32_dpp v146, v146, v146 quad_perm:[1,0,3,2] row_mask:0xf bank_mask:0xf
    s_nop 0
    s_nop 0
    v_add_f32_dpp v146, v146, v146 row_ror:8 row_mask:0xf bank_mask:0xf
    v_mov_b32 v148, v146
    s_nop 0
    s_nop 0
    v_permlane16_swap_b32 v146, v148
    s_nop 0
    s_nop 0
    v_add_f32 v146, v146, v148
    v_mov_b32 v148, v146
    s_nop 0
    s_nop 0
    v_permlane32_swap_b32 v146, v148
    s_nop 0
    s_nop 0
    v_add_f32 v146, v146, v148
    v_mul_f32 v154, s38, v146
    s_branch ln_back
spin_y:
    s_add_u32 s101, s101, 1
    s_cmp_gt_u32 s101, 0x2000000
    s_cbranch_scc1 spin_y_x
    buffer_load_dword v58, v65, s[24:27], s41 offen sc1
    buffer_load_dword v59, v65, s[24:27], s42 offen sc1
    s_waitcnt vmcnt(0)
    v_xor_b32 v58, s58, v58
    v_xor_b32 v59, s58, v59
    v_or_b32 v58, v58, v59
    v_cmp_ne_u32 vcc, 0, v58
    s_cbranch_vccnz spin_y
spin_y_x:
    s_branch spin_y_ret
spin_rec:
    s_add_u32 s101, s101, 1
    s_cmp_gt_u32 s101, 0x2000000
    s_cbranch_scc1 spin_rec_x
    buffer_load_dwordx4 v[32:35], v17, s[24:27], s47 offen offset:0 sc1
    buffer_load_dwordx4 v[36:39], v17, s[24:27], s47 offen offset:1024 sc1
    buffer_load_dwordx4 v[40:43], v17, s[24:27], s47 offen offset:2048 sc1
    buffer_load_dwordx4 v[44:47], v17, s[24:27], s47 offen offset:3072 sc1
    s_waitcnt vmcnt(0)
    v_xor_b32 v34, s7, v34
    v_xor_b32 v38, s7, v38
    v_xor_b32 v42, s7, v42
    v_xor_b32 v46, s7, v46
    v_or3_b32 v34, v34, v38, v42
    v_or_b32 v34, v34, v46
    v_cmp_ne_u32 vcc, 0, v34
    s_cbranch_vccnz spin_rec
spin_rec_x:
    s_branch spin_rec_ret
spin_gu:
    s_add_u32 s101, s101, 1
    s_cmp_gt_u32 s101, 0x2000000
    s_cbranch_scc1 spin_gu_x
    buffer_load_dword v23, v22, s[24:27], s42 offen sc1
    s_waitcnt vmcnt(0)
    v_cmp_ne_u32 vcc, s7, v23
    s_cbranch_vccnz spin_gu
spin_gu_x:
    s_branch spin_gu_ret
rare:
    s_nop 7
    s_nop 7
    v_and_b32 v21, 15, v1
    v_mul_u32_u24 v21, 384, v21
    v_bfe_u32 v22, v1, 4, 1
    v_bfe_u32 v23, v1, 5, 1
    v_lshl_add_u32 v22, v22, 1, v23
    v_lshl_add_u32 v21, v22, 4, v21
    v_mov_b32 v24, 0
    v_mov_b32 v25, 0
    v_mov_b32 v26, 0
    v_mov_b32 v27, 0
    v_mov_b32 v28, 0
    v_mov_b32 v29, 0
    v_mov_b32 v30, 0
    v_mov_b32 v31, 0
    v_mov_b32 v32, 0
    v_mov_b32 v33, 0
    v_mov_b32 v34, 0
    v_mov_b32 v35, 0
    v_mov_b32 v36, 0
    v_mov_b32 v37, 0
    v_mov_b32 v38, 0
    v_mov_b32 v39, 0
    v_mov_b32 v16, 0xff800000
    v_mov_b32 v17, 0xff800000
    v_mov_b32 v18, 0xff800000
    v_mov_b32 v19, 0xff800000
    s_mov_b32 s78, 0
rare_pass:
    s_mov_b32 s77, 0
rare_loop:
    buffer_load_dwordx4 a[216:219], v21, s[12:15], s77 offen offset:0
    buffer_load_dwordx4 a[220:223], v21, s[12:15], s77 offen offset:64
    buffer_load_dwordx4 a[224:227], v21, s[12:15], s77 offen offset:128
    buffer_load_dwordx4 a[228:231], v21, s[12:15], s77 offen offset:192
    buffer_load_dwordx4 a[232:235], v21, s[12:15], s77 offen offset:256
    buffer_load_dwordx4 a[236:239], v21, s[12:15], s77 offen offset:320
    s_waitcnt vmcnt(0)
    v_mfma_f32_16x16x32_bf16 v[40:43], a[216:219], a[0:3], v[24:27]
    v_mfma_f32_16x16x32_bf16 v[44:47], a[216:219], a[4:7], v[28:31]
    v_mfma_f32_16x16x32_bf16 v[48:51], a[216:219], a[8:11], v[32:35]
    v_mfma_f32_16x16x32_bf16 v[52:55], a[216:219], a[12:15], v[36:39]
    v_mfma_f32_16x16x32_bf16 v[40:43], a[220:223], a[16:19], v[40:43]
    v_mfma_f32_16x16x32_bf16 v[44:47], a[220:223], a[20:23], v[44:47]
    v_mfma_f32_16x16x32_bf16 v[48:51], a[220:223], a[24:27], v[48:51]
    v_mfma_f32_16x16x32_bf16 v[52:55], a[220:223], a[28:31], v[52:55]
    v_mfma_f32_16x16x32_bf16 v[40:43], a[224:227], a[32:35], v[40:43]
    v_mfma_f32_16x16x32_bf16 v[44:47], a[224:227], a[36:39], v[44:47]
    v_mfma_f32_16x16x32_bf16 v[48:51], a[224:227], a[40:43], v[48:51]
    v_mfma_f32_16x16x32_bf16 v[52:55], a[224:227], a[44:47], v[52:55]
    v_mfma_f32_16x16x32_bf16 v[40:43], a[228:231], a[48:51], v[40:43]
    v_mfma_f32_16x16x32_bf16 v[44:47], a[228:231], a[52:55], v[44:47]
    v_mfma_f32_16x16x32_bf16 v[48:51], a[228:231], a[56:59], v[48:51]
    v_mfma_f32_16x16x32_bf16 v[52:55], a[228:231], a[60:63], v[52:55]
    v_mfma_f32_16x16x32_bf16 v[40:43], a[232:235], a[64:67], v[40:43]
    v_mfma_f32_16x16x32_bf16 v[44:47], a[232:235], a[68:71], v[44:47]
    v_mfma_f32_16x16x32_bf16 v[48:51], a[232:235], a[72:75], v[48:51]
    v_mfma_f32_16x16x32_bf16 v[52:55], a[232:235], a[76:79], v[52:55]
    v_mfma_f32_16x16x32_bf16 v[40:43], a[236:239], a[80:83], v[40:43]
    v_mfma_f32_16x16x32_bf16 v[44:47], a[236:239], a[84:87], v[44:47]
    v_mfma_f32_16x16x32_bf16 v[48:51], a[236:239], a[88:91], v[48:51]
    v_mfma_f32_16x16x32_bf16 v[52:55], a[236:239], a[92:95], v[52:55]
    s_nop 7
    s_cmp_eq_u32 s78, 0
    s_cbranch_scc0 rare_p2
    v_max3_f32 v16, v16, v40, v41
    v_max3_f32 v16, v16, v42, v43
    v_max3_f32 v17, v17, v44, v45
    v_max3_f32 v17, v17, v46, v47
    v_max3_f32 v18, v18, v48, v49
    v_max3_f32 v18, v18, v50, v51
    v_max3_f32 v19, v19, v52, v53
    v_max3_f32 v19, v19, v54, v55
    s_add_u32 s77, s77, 6144
    s_cmp_lt_u32 s77, 196608
    s_cbranch_scc1 rare_loop
    v_mov_b32 v22, v16
    s_nop 1
    v_permlane16_swap_b32 v16, v22
    s_nop 1
    v_max_f32 v16, v16, v22
    v_mov_b32 v22, v16
    s_nop 1
    v_permlane32_swap_b32 v16, v22
    s_nop 1
    v_max_f32 v16, v16, v22
    v_sub_f32 v24, 0, v16
    v_sub_f32 v25, 0, v16
    v_sub_f32 v26, 0, v16
    v_sub_f32 v27, 0, v16
    v_mov_b32 v22, v17
    s_nop 1
    v_permlane16_swap_b32 v17, v22
    s_nop 1
    v_max_f32 v17, v17, v22
    v_mov_b32 v22, v17
    s_nop 1
    v_permlane32_swap_b32 v17, v22
    s_nop 1
    v_max_f32 v17, v17, v22
    v_sub_f32 v28, 0, v17
    v_sub_f32 v29, 0, v17
    v_sub_f32 v30, 0, v17
    v_sub_f32 v31, 0, v17
    v_mov_b32 v22, v18
    s_nop 1
    v_permlane16_swap_b32 v18, v22
    s_nop 1
    v_max_f32 v18, v18, v22
    v_mov_b32 v22, v18
    s_nop 1
    v_permlane32_swap_b32 v18, v22
    s_nop 1
    v_max_f32 v18, v18, v22
    v_sub_f32 v32, 0, v18
    v_sub_f32 v33, 0, v18
    v_sub_f32 v34, 0, v18
    v_sub_f32 v35, 0, v18
    v_mov_b32 v22, v19
    s_nop 1
    v_permlane16_swap_b32 v19, v22
    s_nop 1
    v_max_f32 v19, v19, v22
    v_mov_b32 v22, v19
    s_nop 1
    v_permlane32_swap_b32 v19, v22
    s_nop 1
    v_max_f32 v19, v19, v22
    v_sub_f32 v36, 0, v19
    v_sub_f32 v37, 0, v19
    v_sub_f32 v38, 0, v19
    v_sub_f32 v39, 0, v19
    s_mov_b32 s78, 1
    s_branch rare_pass
rare_p2:
    v_exp_f32 v40, v40
    v_exp_f32 v41, v41
    v_exp_f32 v42, v42
    v_exp_f32 v43, v43
    v_exp_f32 v44, v44
    v_exp_f32 v45, v45
    v_exp_f32 v46, v46
    v_exp_f32 v47, v47
    v_exp_f32 v48, v48
    v_exp_f32 v49, v49
    v_exp_f32 v50, v50
    v_exp_f32 v51, v51
    v_exp_f32 v52, v52
    v_exp_f32 v53, v53
    v_exp_f32 v54, v54
    v_exp_f32 v55, v55
    s_cmp_eq_u32 s77, 0
    s_cbranch_scc0 rare_d0
    v_cvt_pk_bf16_f32 v22, v40, v41
    v_cvt_pk_bf16_f32 v23, v42, v43
    v_accvgpr_write_b32 a96, v22
    v_accvgpr_write_b32 a97, v23
    v_cvt_pk_bf16_f32 v22, v44, v45
    v_cvt_pk_bf16_f32 v23, v46, v47
    v_accvgpr_write_b32 a104, v22
    v_accvgpr_write_b32 a105, v23
    v_cvt_pk_bf16_f32 v22, v48, v49
    v_cvt_pk_bf16_f32 v23, v50, v51
    v_accvgpr_write_b32 a112, v22
    v_accvgpr_write_b32 a113, v23
    v_cvt_pk_bf16_f32 v22, v52, v53
    v_cvt_pk_bf16_f32 v23, v54, v55
    v_accvgpr_write_b32 a120, v22
    v_accvgpr_write_b32 a121, v23
rare_d0:
    s_cmp_eq_u32 s77, 6144
    s_cbranch_scc0 rare_d1
    v_cvt_pk_bf16_f32 v22, v40, v41
    v_cvt_pk_bf16_f32 v23, v42, v43
    v_accvgpr_write_b32 a98, v22
    v_accvgpr_write_b32 a99, v23
    v_cvt_pk_bf16_f32 v22, v44, v45
    v_cvt_pk_bf16_f32 v23, v46, v47
    v_accvgpr_write_b32 a106, v22
    v_accvgpr_write_b32 a107, v23
    v_cvt_pk_bf16_f32 v22, v48, v49
    v_cvt_pk_bf16_f32 v23, v50, v51
    v_accvgpr_write_b32 a114, v22
    v_accvgpr_write_b32 a115, v23
    v_cvt_pk_bf16_f32 v22, v52, v53
    v_cvt_pk_bf16_f32 v23, v54, v55
    v_accvgpr_write_b32 a122, v22
    v_accvgpr_write_b32 a123, v23
rare_d1:
    s_cmp_eq_u32 s77, 12288
    s_cbranch_scc0 rare_d2
    v_cvt_pk_bf16_f32 v22, v40, v41
    v_cvt_pk_bf16_f32 v23, v42, v43
    v_accvgpr_write_b32 a100, v22
    v_accvgpr_write_b32 a101, v23
    v_cvt_pk_bf16_f32 v22, v44, v45
    v_cvt_pk_bf16_f32 v23, v46, v47
    v_accvgpr_write_b32 a108, v22
    v_accvgpr_write_b32 a109, v23
    v_cvt_pk_bf16_f32 v22, v48, v49
    v_cvt_pk_bf16_f32 v23, v50, v51
    v_accvgpr_write_b32 a116, v22
    v_accvgpr_write_b32 a117, v23
    v_cvt_pk_bf16_f32 v22, v52, v53
    v_cvt_pk_bf16_f32 v23, v54, v55
    v_accvgpr_write_b32 a124, v22
    v_accvgpr_write_b32 a125, v23
rare_d2:
    s_cmp_eq_u32 s77, 18432
    s_cbranch_scc0 rare_d3
    v_cvt_pk_bf16_f32 v22, v40, v41
    v_cvt_pk_bf16_f32 v23, v42, v43
    v_accvgpr_write_b32 a102, v22
    v_accvgpr_write_b32 a103, v23
    v_cvt_pk_bf16_f32 v22, v44, v45
    v_cvt_pk_bf16_f32 v23, v46, v47
    v_accvgpr_write_b32 a110, v22
    v_accvgpr_write_b32 a111, v23
    v_cvt_pk_bf16_f32 v22, v48, v49
    v_cvt_pk_bf16_f32 v23, v50, v51
    v_accvgpr_write_b32 a118, v22
    v_accvgpr_write_b32 a119, v23
    v_cvt_pk_bf16_f32 v22, v52, v53
    v_cvt_pk_bf16_f32 v23, v54, v55
    v_accvgpr_write_b32 a126, v22
    v_accvgpr_write_b32 a127, v23
rare_d3:
    s_cmp_eq_u32 s77, 24576
    s_cbranch_scc0 rare_d4
    v_cvt_pk_bf16_f32 v22, v40, v41
    v_cvt_pk_bf16_f32 v23, v42, v43
    v_accvgpr_write_b32 a128, v22
    v_accvgpr_write_b32 a129, v23
    v_cvt_pk_bf16_f32 v22, v44, v45
    v_cvt_pk_bf16_f32 v23, v46, v47
    v_accvgpr_write_b32 a136, v22
    v_accvgpr_write_b32 a137, v23
    v_cvt_pk_bf16_f32 v22, v48, v49
    v_cvt_pk_bf16_f32 v23, v50, v51
    v_accvgpr_write_b32 a144, v22
    v_accvgpr_write_b32 a145, v23
    v_cvt_pk_bf16_f32 v120, v52, v53
    v_cvt_pk_bf16_f32 v121, v54, v55
rare_d4:
    s_cmp_eq_u32 s77, 30720
    s_cbranch_scc0 rare_d5
    v_cvt_pk_bf16_f32 v22, v40, v41
    v_cvt_pk_bf16_f32 v23, v42, v43
    v_accvgpr_write_b32 a130, v22
    v_accvgpr_write_b32 a131, v23
    v_cvt_pk_bf16_f32 v22, v44, v45
    v_cvt_pk_bf16_f32 v23, v46, v47
    v_accvgpr_write_b32 a138, v22
    v_accvgpr_write_b32 a139, v23
    v_cvt_pk_bf16_f32 v22, v48, v49
    v_cvt_pk_bf16_f32 v23, v50, v51
    v_accvgpr_write_b32 a146, v22
    v_accvgpr_write_b32 a147, v23
    v_cvt_pk_bf16_f32 v122, v52, v53
    v_cvt_pk_bf16_f32 v123, v54, v55
rare_d5:
    s_cmp_eq_u32 s77, 36864
    s_cbranch_scc0 rare_d6
    v_cvt_pk_bf16_f32 v22, v40, v41
    v_cvt_pk_bf16_f32 v23, v42, v43
    v_accvgpr_write_b32 a132, v22
    v_accvgpr_write_b32 a133, v23
    v_cvt_pk_bf16_f32 v22, v44, v45
    v_cvt_pk_bf16_f32 v23, v46, v47
    v_accvgpr_write_b32 a140, v22
    v_accvgpr_write_b32 a141, v23
    v_cvt_pk_bf16_f32 v22, v48, v49
    v_cvt_pk_bf16_f32 v23, v50, v51
    v_accvgpr_write_b32 a148, v22
    v_accvgpr_write_b32 a149, v23
    v_cvt_pk_bf16_f32 v124, v52, v53
    v_cvt_pk_bf16_f32 v125, v54, v55
rare_d6:
    s_cmp_eq_u32 s77, 43008
    s_cbranch_scc0 rare_d7
    v_cvt_pk_bf16_f32 v22, v40, v41
    v_cvt_pk_bf16_f32 v23, v42, v43
    v_accvgpr_write_b32 a134, v22
    v_accvgpr_write_b32 a135, v23
    v_cvt_pk_bf16_f32 v22, v44, v45
    v_cvt_pk_bf16_f32 v23, v46, v47
    v_accvgpr_write_b32 a142, v22
    v_accvgpr_write_b32 a143, v23
    v_cvt_pk_bf16_f32 v22, v48, v49
    v_cvt_pk_bf16_f32 v23, v50, v51
    v_accvgpr_write_b32 a150, v22
    v_accvgpr_write_b32 a151, v23
    v_cvt_pk_bf16_f32 v126, v52, v53
    v_cvt_pk_bf16_f32 v127, v54, v55
rare_d7:
    s_cmp_eq_u32 s77, 49152
    s_cbranch_scc0 rare_d8
    v_cvt_pk_bf16_f32 v128, v40, v41
    v_cvt_pk_bf16_f32 v129, v42, v43
    v_cvt_pk_bf16_f32 v136, v44, v45
    v_cvt_pk_bf16_f32 v137, v46, v47
    v_cvt_pk_bf16_f32 v144, v48, v49
    v_cvt_pk_bf16_f32 v145, v50, v51
    v_cvt_pk_bf16_f32 v152, v52, v53
    v_cvt_pk_bf16_f32 v153, v54, v55
rare_d8:
    s_cmp_eq_u32 s77, 55296
    s_cbranch_scc0 rare_d9
    v_cvt_pk_bf16_f32 v130, v40, v41
    v_cvt_pk_bf16_f32 v131, v42, v43
    v_cvt_pk_bf16_f32 v138, v44, v45
    v_cvt_pk_bf16_f32 v139, v46, v47
    v_cvt_pk_bf16_f32 v146, v48, v49
    v_cvt_pk_bf16_f32 v147, v50, v51
    v_cvt_pk_bf16_f32 v154, v52, v53
    v_cvt_pk_bf16_f32 v155, v54, v55
rare_d9:
    s_cmp_eq_u32 s77, 61440
    s_cbranch_scc0 rare_d10
    v_cvt_pk_bf16_f32 v132, v40, v41
    v_cvt_pk_bf16_f32 v133, v42, v43
    v_cvt_pk_bf16_f32 v140, v44, v45
    v_cvt_pk_bf16_f32 v141, v46, v47
    v_cvt_pk_bf16_f32 v148, v48, v49
    v_cvt_pk_bf16_f32 v149, v50, v51
    v_cvt_pk_bf16_f32 v156, v52, v53
    v_cvt_pk_bf16_f32 v157, v54, v55
rare_d10:
    s_cmp_eq_u32 s77, 67584
    s_cbranch_scc0 rare_d11
    v_cvt_pk_bf16_f32 v134, v40, v41
    v_cvt_pk_bf16_f32 v135, v42, v43
    v_cvt_pk_bf16_f32 v142, v44, v45
    v_cvt_pk_bf16_f32 v143, v46, v47
    v_cvt_pk_bf16_f32 v150, v48, v49
    v_cvt_pk_bf16_f32 v151, v50, v51
    v_cvt_pk_bf16_f32 v158, v52, v53
    v_cvt_pk_bf16_f32 v159, v54, v55
rare_d11:
    s_cmp_eq_u32 s77, 73728
    s_cbranch_scc0 rare_d12
    v_cvt_pk_bf16_f32 v160, v40, v41
    v_cvt_pk_bf16_f32 v161, v42, v43
    v_cvt_pk_bf16_f32 v168, v44, v45
    v_cvt_pk_bf16_f32 v169, v46, v47
    v_cvt_pk_bf16_f32 v176, v48, v49
    v_cvt_pk_bf16_f32 v177, v50, v51
    v_cvt_pk_bf16_f32 v184, v52, v53
    v_cvt_pk_bf16_f32 v185, v54, v55
rare_d12:
    s_cmp_eq_u32 s77, 79872
    s_cbranch_scc0 rare_d13
    v_cvt_pk_bf16_f32 v162, v40, v41
    v_cvt_pk_bf16_f32 v163, v42, v43
    v_cvt_pk_bf16_f32 v170, v44, v45
    v_cvt_pk_bf16_f32 v171, v46, v47
    v_cvt_pk_bf16_f32 v178, v48, v49
    v_cvt_pk_bf16_f32 v179, v50, v51
    v_cvt_pk_bf16_f32 v186, v52, v53
    v_cvt_pk_bf16_f32 v187, v54, v55
rare_d13:
    s_cmp_eq_u32 s77, 86016
    s_cbranch_scc0 rare_d14
    v_cvt_pk_bf16_f32 v164, v40, v41
    v_cvt_pk_bf16_f32 v165, v42, v43
    v_cvt_pk_bf16_f32 v172, v44, v45
    v_cvt_pk_bf16_f32 v173, v46, v47
    v_cvt_pk_bf16_f32 v180, v48, v49
    v_cvt_pk_bf16_f32 v181, v50, v51
    v_cvt_pk_bf16_f32 v188, v52, v53
    v_cvt_pk_bf16_f32 v189, v54, v55
rare_d14:
    s_cmp_eq_u32 s77, 92160
    s_cbranch_scc0 rare_d15
    v_cvt_pk_bf16_f32 v166, v40, v41
    v_cvt_pk_bf16_f32 v167, v42, v43
    v_cvt_pk_bf16_f32 v174, v44, v45
    v_cvt_pk_bf16_f32 v175, v46, v47
    v_cvt_pk_bf16_f32 v182, v48, v49
    v_cvt_pk_bf16_f32 v183, v50, v51
    v_cvt_pk_bf16_f32 v190, v52, v53
    v_cvt_pk_bf16_f32 v191, v54, v55
rare_d15:
    s_cmp_eq_u32 s77, 98304
    s_cbranch_scc0 rare_d16
    v_cvt_pk_bf16_f32 v192, v40, v41
    v_cvt_pk_bf16_f32 v193, v42, v43
    v_cvt_pk_bf16_f32 v200, v44, v45
    v_cvt_pk_bf16_f32 v201, v46, v47
    v_cvt_pk_bf16_f32 v208, v48, v49
    v_cvt_pk_bf16_f32 v209, v50, v51
    v_cvt_pk_bf16_f32 v216, v52, v53
    v_cvt_pk_bf16_f32 v217, v54, v55
rare_d16:
    s_cmp_eq_u32 s77, 104448
    s_cbranch_scc0 rare_d17
    v_cvt_pk_bf16_f32 v194, v40, v41
    v_cvt_pk_bf16_f32 v195, v42, v43
    v_cvt_pk_bf16_f32 v202, v44, v45
    v_cvt_pk_bf16_f32 v203, v46, v47
    v_cvt_pk_bf16_f32 v210, v48, v49
    v_cvt_pk_bf16_f32 v211, v50, v51
    v_cvt_pk_bf16_f32 v218, v52, v53
    v_cvt_pk_bf16_f32 v219, v54, v55
rare_d17:
    s_cmp_eq_u32 s77, 110592
    s_cbranch_scc0 rare_d18
    v_cvt_pk_bf16_f32 v196, v40, v41
    v_cvt_pk_bf16_f32 v197, v42, v43
    v_cvt_pk_bf16_f32 v204, v44, v45
    v_cvt_pk_bf16_f32 v205, v46, v47
    v_cvt_pk_bf16_f32 v212, v48, v49
    v_cvt_pk_bf16_f32 v213, v50, v51
    v_cvt_pk_bf16_f32 v220, v52, v53
    v_cvt_pk_bf16_f32 v221, v54, v55
rare_d18:
    s_cmp_eq_u32 s77, 116736
    s_cbranch_scc0 rare_d19
    v_cvt_pk_bf16_f32 v198, v40, v41
    v_cvt_pk_bf16_f32 v199, v42, v43
    v_cvt_pk_bf16_f32 v206, v44, v45
    v_cvt_pk_bf16_f32 v207, v46, v47
    v_cvt_pk_bf16_f32 v214, v48, v49
    v_cvt_pk_bf16_f32 v215, v50, v51
    v_cvt_pk_bf16_f32 v222, v52, v53
    v_cvt_pk_bf16_f32 v223, v54, v55
rare_d19:
    s_cmp_eq_u32 s77, 122880
    s_cbranch_scc0 rare_d20
    v_cvt_pk_bf16_f32 v224, v40, v41
    v_cvt_pk_bf16_f32 v225, v42, v43
    v_cvt_pk_bf16_f32 v232, v44, v45
    v_cvt_pk_bf16_f32 v233, v46, v47
    v_cvt_pk_bf16_f32 v240, v48, v49
    v_cvt_pk_bf16_f32 v241, v50, v51
    v_cvt_pk_bf16_f32 v248, v52, v53
    v_cvt_pk_bf16_f32 v249, v54, v55
rare_d20:
    s_cmp_eq_u32 s77, 129024
    s_cbranch_scc0 rare_d21
    v_cvt_pk_bf16_f32 v226, v40, v41
    v_cvt_pk_bf16_f32 v227, v42, v43
    v_cvt_pk_bf16_f32 v234, v44, v45
    v_cvt_pk_bf16_f32 v235, v46, v47
    v_cvt_pk_bf16_f32 v242, v48, v49
    v_cvt_pk_bf16_f32 v243, v50, v51
    v_cvt_pk_bf16_f32 v250, v52, v53
    v_cvt_pk_bf16_f32 v251, v54, v55
rare_d21:
    s_cmp_eq_u32 s77, 135168
    s_cbranch_scc0 rare_d22
    v_cvt_pk_bf16_f32 v228, v40, v41
    v_cvt_pk_bf16_f32 v229, v42, v43
    v_cvt_pk_bf16_f32 v236, v44, v45
    v_cvt_pk_bf16_f32 v237, v46, v47
    v_cvt_pk_bf16_f32 v244, v48, v49
    v_cvt_pk_bf16_f32 v245, v50, v51
    v_cvt_pk_bf16_f32 v252, v52, v53
    v_cvt_pk_bf16_f32 v253, v54, v55
rare_d22:
    s_cmp_eq_u32 s77, 141312
    s_cbranch_scc0 rare_d23
    v_cvt_pk_bf16_f32 v230, v40, v41
    v_cvt_pk_bf16_f32 v231, v42, v43
    v_cvt_pk_bf16_f32 v238, v44, v45
    v_cvt_pk_bf16_f32 v239, v46, v47
    v_cvt_pk_bf16_f32 v246, v48, v49
    v_cvt_pk_bf16_f32 v247, v50, v51
    v_cvt_pk_bf16_f32 v254, v52, v53
    v_cvt_pk_bf16_f32 v255, v54, v55
rare_d23:
    s_cmp_eq_u32 s77, 147456
    s_cbranch_scc0 rare_d24
    v_cvt_pk_bf16_f32 v56, v40, v41
    v_cvt_pk_bf16_f32 v57, v42, v43
    v_cvt_pk_bf16_f32 v64, v44, v45
    v_cvt_pk_bf16_f32 v65, v46, v47
    v_cvt_pk_bf16_f32 v72, v48, v49
    v_cvt_pk_bf16_f32 v73, v50, v51
    v_cvt_pk_bf16_f32 v80, v52, v53
    v_cvt_pk_bf16_f32 v81, v54, v55
rare_d24:
    s_cmp_eq_u32 s77, 153600
    s_cbranch_scc0 rare_d25
    v_cvt_pk_bf16_f32 v58, v40, v41
    v_cvt_pk_bf16_f32 v59, v42, v43
    v_cvt_pk_bf16_f32 v66, v44, v45
    v_cvt_pk_bf16_f32 v67, v46, v47
    v_cvt_pk_bf16_f32 v74, v48, v49
    v_cvt_pk_bf16_f32 v75, v50, v51
    v_cvt_pk_bf16_f32 v82, v52, v53
    v_cvt_pk_bf16_f32 v83, v54, v55
rare_d25:
    s_cmp_eq_u32 s77, 159744
    s_cbranch_scc0 rare_d26
    v_cvt_pk_bf16_f32 v60, v40, v41
    v_cvt_pk_bf16_f32 v61, v42, v43
    v_cvt_pk_bf16_f32 v68, v44, v45
    v_cvt_pk_bf16_f32 v69, v46, v47
    v_cvt_pk_bf16_f32 v76, v48, v49
    v_cvt_pk_bf16_f32 v77, v50, v51
    v_cvt_pk_bf16_f32 v84, v52, v53
    v_cvt_pk_bf16_f32 v85, v54, v55
rare_d26:
    s_cmp_eq_u32 s77, 165888
    s_cbranch_scc0 rare_d27
    v_cvt_pk_bf16_f32 v62, v40, v41
    v_cvt_pk_bf16_f32 v63, v42, v43
    v_cvt_pk_bf16_f32 v70, v44, v45
    v_cvt_pk_bf16_f32 v71, v46, v47
    v_cvt_pk_bf16_f32 v78, v48, v49
    v_cvt_pk_bf16_f32 v79, v50, v51
    v_cvt_pk_bf16_f32 v86, v52, v53
    v_cvt_pk_bf16_f32 v87, v54, v55
rare_d27:
    s_cmp_eq_u32 s77, 172032
    s_cbranch_scc0 rare_d28
    v_cvt_pk_bf16_f32 v88, v40, v41
    v_cvt_pk_bf16_f32 v89, v42, v43
    v_cvt_pk_bf16_f32 v96, v44, v45
    v_cvt_pk_bf16_f32 v97, v46, v47
    v_cvt_pk_bf16_f32 v104, v48, v49
    v_cvt_pk_bf16_f32 v105, v50, v51
    v_cvt_pk_bf16_f32 v112, v52, v53
    v_cvt_pk_bf16_f32 v113, v54, v55
rare_d28:
    s_cmp_eq_u32 s77, 178176
    s_cbranch_scc0 rare_d29
    v_cvt_pk_bf16_f32 v90, v40, v41
    v_cvt_pk_bf16_f32 v91, v42, v43
    v_cvt_pk_bf16_f32 v98, v44, v45
    v_cvt_pk_bf16_f32 v99, v46, v47
    v_cvt_pk_bf16_f32 v106, v48, v49
    v_cvt_pk_bf16_f32 v107, v50, v51
    v_cvt_pk_bf16_f32 v114, v52, v53
    v_cvt_pk_bf16_f32 v115, v54, v55
rare_d29:
    s_cmp_eq_u32 s77, 184320
    s_cbranch_scc0 rare_d30
    v_cvt_pk_bf16_f32 v92, v40, v41
    v_cvt_pk_bf16_f32 v93, v42, v43
    v_cvt_pk_bf16_f32 v100, v44, v45
    v_cvt_pk_bf16_f32 v101, v46, v47
    v_cvt_pk_bf16_f32 v108, v48, v49
    v_cvt_pk_bf16_f32 v109, v50, v51
    v_cvt_pk_bf16_f32 v116, v52, v53
    v_cvt_pk_bf16_f32 v117, v54, v55
rare_d30:
    s_cmp_eq_u32 s77, 190464
    s_cbranch_scc0 rare_d31
    v_cvt_pk_bf16_f32 v94, v40, v41
    v_cvt_pk_bf16_f32 v95, v42, v43
    v_cvt_pk_bf16_f32 v102, v44, v45
    v_cvt_pk_bf16_f32 v103, v46, v47
    v_cvt_pk_bf16_f32 v110, v48, v49
    v_cvt_pk_bf16_f32 v111, v50, v51
    v_cvt_pk_bf16_f32 v118, v52, v53
    v_cvt_pk_bf16_f32 v119, v54, v55
rare_d31:
    s_add_u32 s77, s77, 6144
    s_cmp_lt_u32 s77, 196608
    s_cbranch_scc1 rare_loop
    ds_read_b64_tr_b16 a[216:217], v8 offset:0
    ds_read_b64_tr_b16 a[218:219], v8 offset:2048
    ds_read_b64_tr_b16 a[220:221], v9 offset:0
    ds_read_b64_tr_b16 a[222:223], v9 offset:2048
    s_waitcnt lgkmcnt(0)
    v_mfma_f32_16x16x32_bf16 a[152:155], a[216:219], a[96:99], 0
    v_mfma_f32_16x16x32_bf16 a[156:159], a[216:219], a[104:107], 0
    v_mfma_f32_16x16x32_bf16 a[160:163], a[216:219], a[112:115], 0
    v_mfma_f32_16x16x32_bf16 a[164:167], a[216:219], a[120:123], 0
    v_mfma_f32_16x16x32_bf16 a[168:171], a[220:223], a[96:99], 0
    v_mfma_f32_16x16x32_bf16 a[172:175], a[220:223], a[104:107], 0
    v_mfma_f32_16x16x32_bf16 a[176:179], a[220:223], a[112:115], 0
    v_mfma_f32_16x16x32_bf16 a[180:183], a[220:223], a[120:123], 0
    ds_read_b64_tr_b16 a[216:217], v8 offset:4096
    ds_read_b64_tr_b16 a[218:219], v8 offset:6144
    ds_read_b64_tr_b16 a[220:221], v9 offset:4096
    ds_read_b64_tr_b16 a[222:223], v9 offset:6144
    s_waitcnt lgkmcnt(0)
    v_mfma_f32_16x16x32_bf16 a[152:155], a[216:219], a[100:103], a[152:155]
    v_mfma_f32_16x16x32_bf16 a[156:159], a[216:219], a[108:111], a[156:159]
    v_mfma_f32_16x16x32_bf16 a[160:163], a[216:219], a[116:119], a[160:163]
    v_mfma_f32_16x16x32_bf16 a[164:167], a[216:219], a[124:127], a[164:167]
    v_mfma_f32_16x16x32_bf16 a[168:171], a[220:223], a[100:103], a[168:171]
    v_mfma_f32_16x16x32_bf16 a[172:175], a[220:223], a[108:111], a[172:175]
    v_mfma_f32_16x16x32_bf16 a[176:179], a[220:223], a[116:119], a[176:179]
    v_mfma_f32_16x16x32_bf16 a[180:183], a[220:223], a[124:127], a[180:183]
    ds_read_b64_tr_b16 a[216:217], v8 offset:8192
    ds_read_b64_tr_b16 a[218:219], v8 offset:10240
    ds_read_b64_tr_b16 a[220:221], v9 offset:8192
    ds_read_b64_tr_b16 a[222:223], v9 offset:10240
    s_waitcnt lgkmcnt(0)
    v_mfma_f32_16x16x32_bf16 a[152:155], a[216:219], a[128:131], a[152:155]
    v_mfma_f32_16x16x32_bf16 a[156:159], a[216:219], a[136:139], a[156:159]
    v_mfma_f32_16x16x32_bf16 a[160:163], a[216:219], a[144:147], a[160:163]
    v_mfma_f32_16x16x32_bf16 a[164:167], a[216:219], v[120:123], a[164:167]
    v_mfma_f32_16x16x32_bf16 a[168:171], a[220:223], a[128:131], a[168:171]
    v_mfma_f32_16x16x32_bf16 a[172:175], a[220:223], a[136:139], a[172:175]
    v_mfma_f32_16x16x32_bf16 a[176:179], a[220:223], a[144:147], a[176:179]
    v_mfma_f32_16x16x32_bf16 a[180:183], a[220:223], v[120:123], a[180:183]
    ds_read_b64_tr_b16 a[216:217], v8 offset:12288
    ds_read_b64_tr_b16 a[218:219], v8 offset:14336
    ds_read_b64_tr_b16 a[220:221], v9 offset:12288
    ds_read_b64_tr_b16 a[222:223], v9 offset:14336
    s_waitcnt lgkmcnt(0)
    v_mfma_f32_16x16x32_bf16 a[152:155], a[216:219], a[132:135], a[152:155]
    v_mfma_f32_16x16x32_bf16 a[156:159], a[216:219], a[140:143], a[156:159]
    v_mfma_f32_16x16x32_bf16 a[160:163], a[216:219], a[148:151], a[160:163]
    v_mfma_f32_16x16x32_bf16 a[164:167], a[216:219], v[124:127], a[164:167]
    v_mfma_f32_16x16x32_bf16 a[168:171], a[220:223], a[132:135], a[168:171]
    v_mfma_f32_16x16x32_bf16 a[172:175], a[220:223], a[140:143], a[172:175]
    v_mfma_f32_16x16x32_bf16 a[176:179], a[220:223], a[148:151], a[176:179]
    v_mfma_f32_16x16x32_bf16 a[180:183], a[220:223], v[124:127], a[180:183]
    ds_read_b64_tr_b16 a[216:217], v8 offset:16384
    ds_read_b64_tr_b16 a[218:219], v8 offset:18432
    ds_read_b64_tr_b16 a[220:221], v9 offset:16384
    ds_read_b64_tr_b16 a[222:223], v9 offset:18432
    s_waitcnt lgkmcnt(0)
    v_mfma_f32_16x16x32_bf16 a[152:155], a[216:219], v[128:131], a[152:155]
    v_mfma_f32_16x16x32_bf16 a[156:159], a[216:219], v[136:139], a[156:159]
    v_mfma_f32_16x16x32_bf16 a[160:163], a[216:219], v[144:147], a[160:163]
    v_mfma_f32_16x16x32_bf16 a[164:167], a[216:219], v[152:155], a[164:167]
    v_mfma_f32_16x16x32_bf16 a[168:171], a[220:223], v[128:131], a[168:171]
    v_mfma_f32_16x16x32_bf16 a[172:175], a[220:223], v[136:139], a[172:175]
    v_mfma_f32_16x16x32_bf16 a[176:179], a[220:223], v[144:147], a[176:179]
    v_mfma_f32_16x16x32_bf16 a[180:183], a[220:223], v[152:155], a[180:183]
    ds_read_b64_tr_b16 a[216:217], v8 offset:20480
    ds_read_b64_tr_b16 a[218:219], v8 offset:22528
    ds_read_b64_tr_b16 a[220:221], v9 offset:20480
    ds_read_b64_tr_b16 a[222:223], v9 offset:22528
    s_waitcnt lgkmcnt(0)
    v_mfma_f32_16x16x32_bf16 a[152:155], a[216:219], v[132:135], a[152:155]
    v_mfma_f32_16x16x32_bf16 a[156:159], a[216:219], v[140:143], a[156:159]
    v_mfma_f32_16x16x32_bf16 a[160:163], a[216:219], v[148:151], a[160:163]
    v_mfma_f32_16x16x32_bf16 a[164:167], a[216:219], v[156:159], a[164:167]
    v_mfma_f32_16x16x32_bf16 a[168:171], a[220:223], v[132:135], a[168:171]
    v_mfma_f32_16x16x32_bf16 a[172:175], a[220:223], v[140:143], a[172:175]
    v_mfma_f32_16x16x32_bf16 a[176:179], a[220:223], v[148:151], a[176:179]
    v_mfma_f32_16x16x32_bf16 a[180:183], a[220:223], v[156:159], a[180:183]
    ds_read_b64_tr_b16 a[216:217], v8 offset:24576
    ds_read_b64_tr_b16 a[218:219], v8 offset:26624
    ds_read_b64_tr_b16 a[220:221], v9 offset:24576
    ds_read_b64_tr_b16 a[222:223], v9 offset:26624
    s_waitcnt lgkmcnt(0)
    v_mfma_f32_16x16x32_bf16 a[152:155], a[216:219], v[160:163], a[152:155]
    v_mfma_f32_16x16x32_bf16 a[156:159], a[216:219], v[168:171], a[156:159]
    v_mfma_f32_16x16x32_bf16 a[160:163], a[216:219], v[176:179], a[160:163]
    v_mfma_f32_16x16x32_bf16 a[164:167], a[216:219], v[184:187], a[164:167]
    v_mfma_f32_16x16x32_bf16 a[168:171], a[220:223], v[160:163], a[168:171]
    v_mfma_f32_16x16x32_bf16 a[172:175], a[220:223], v[168:171], a[172:175]
    v_mfma_f32_16x16x32_bf16 a[176:179], a[220:223], v[176:179], a[176:179]
    v_mfma_f32_16x16x32_bf16 a[180:183], a[220:223], v[184:187], a[180:183]
    ds_read_b64_tr_b16 a[216:217], v8 offset:28672
    ds_read_b64_tr_b16 a[218:219], v8 offset:30720
    ds_read_b64_tr_b16 a[220:221], v9 offset:28672
    ds_read_b64_tr_b16 a[222:223], v9 offset:30720
    s_waitcnt lgkmcnt(0)
    v_mfma_f32_16x16x32_bf16 a[152:155], a[216:219], v[164:167], a[152:155]
    v_mfma_f32_16x16x32_bf16 a[156:159], a[216:219], v[172:175], a[156:159]
    v_mfma_f32_16x16x32_bf16 a[160:163], a[216:219], v[180:183], a[160:163]
    v_mfma_f32_16x16x32_bf16 a[164:167], a[216:219], v[188:191], a[164:167]
    v_mfma_f32_16x16x32_bf16 a[168:171], a[220:223], v[164:167], a[168:171]
    v_mfma_f32_16x16x32_bf16 a[172:175], a[220:223], v[172:175], a[172:175]
    v_mfma_f32_16x16x32_bf16 a[176:179], a[220:223], v[180:183], a[176:179]
    v_mfma_f32_16x16x32_bf16 a[180:183], a[220:223], v[188:191], a[180:183]
    ds_read_b64_tr_b16 a[216:217], v8 offset:32768
    ds_read_b64_tr_b16 a[218:219], v8 offset:34816
    ds_read_b64_tr_b16 a[220:221], v9 offset:32768
    ds_read_b64_tr_b16 a[222:223], v9 offset:34816
    s_waitcnt lgkmcnt(0)
    v_mfma_f32_16x16x32_bf16 a[152:155], a[216:219], v[192:195], a[152:155]
    v_mfma_f32_16x16x32_bf16 a[156:159], a[216:219], v[200:203], a[156:159]
    v_mfma_f32_16x16x32_bf16 a[160:163], a[216:219], v[208:211], a[160:163]
    v_mfma_f32_16x16x32_bf16 a[164:167], a[216:219], v[216:219], a[164:167]
    v_mfma_f32_16x16x32_bf16 a[168:171], a[220:223], v[192:195], a[168:171]
    v_mfma_f32_16x16x32_bf16 a[172:175], a[220:223], v[200:203], a[172:175]
    v_mfma_f32_16x16x32_bf16 a[176:179], a[220:223], v[208:211], a[176:179]
    v_mfma_f32_16x16x32_bf16 a[180:183], a[220:223], v[216:219], a[180:183]
    ds_read_b64_tr_b16 a[216:217], v8 offset:36864
    ds_read_b64_tr_b16 a[218:219], v8 offset:38912
    ds_read_b64_tr_b16 a[220:221], v9 offset:36864
    ds_read_b64_tr_b16 a[222:223], v9 offset:38912
    s_waitcnt lgkmcnt(0)
    v_mfma_f32_16x16x32_bf16 a[152:155], a[216:219], v[196:199], a[152:155]
    v_mfma_f32_16x16x32_bf16 a[156:159], a[216:219], v[204:207], a[156:159]
    v_mfma_f32_16x16x32_bf16 a[160:163], a[216:219], v[212:215], a[160:163]
    v_mfma_f32_16x16x32_bf16 a[164:167], a[216:219], v[220:223], a[164:167]
    v_mfma_f32_16x16x32_bf16 a[168:171], a[220:223], v[196:199], a[168:171]
    v_mfma_f32_16x16x32_bf16 a[172:175], a[220:223], v[204:207], a[172:175]
    v_mfma_f32_16x16x32_bf16 a[176:179], a[220:223], v[212:215], a[176:179]
    v_mfma_f32_16x16x32_bf16 a[180:183], a[220:223], v[220:223], a[180:183]
    ds_read_b64_tr_b16 a[216:217], v8 offset:40960
    ds_read_b64_tr_b16 a[218:219], v8 offset:43008
    ds_read_b64_tr_b16 a[220:221], v9 offset:40960
    ds_read_b64_tr_b16 a[222:223], v9 offset:43008
    s_waitcnt lgkmcnt(0)
    v_mfma_f32_16x16x32_bf16 a[152:155], a[216:219], v[224:227], a[152:155]
    v_mfma_f32_16x16x32_bf16 a[156:159], a[216:219], v[232:235], a[156:159]
    v_mfma_f32_16x16x32_bf16 a[160:163], a[216:219], v[240:243], a[160:163]
    v_mfma_f32_16x16x32_bf16 a[164:167], a[216:219], v[248:251], a[164:167]
    v_mfma_f32_16x16x32_bf16 a[168:171], a[220:223], v[224:227], a[168:171]
    v_mfma_f32_16x16x32_bf16 a[172:175], a[220:223], v[232:235], a[172:175]
    v_mfma_f32_16x16x32_bf16 a[176:179], a[220:223], v[240:243], a[176:179]
    v_mfma_f32_16x16x32_bf16 a[180:183], a[220:223], v[248:251], a[180:183]
    ds_read_b64_tr_b16 a[216:217], v8 offset:45056
    ds_read_b64_tr_b16 a[218:219], v8 offset:47104
    ds_read_b64_tr_b16 a[220:221], v9 offset:45056
    ds_read_b64_tr_b16 a[222:223], v9 offset:47104
    s_waitcnt lgkmcnt(0)
    v_mfma_f32_16x16x32_bf16 a[152:155], a[216:219], v[228:231], a[152:155]
    v_mfma_f32_16x16x32_bf16 a[156:159], a[216:219], v[236:239], a[156:159]
    v_mfma_f32_16x16x32_bf16 a[160:163], a[216:219], v[244:247], a[160:163]
    v_mfma_f32_16x16x32_bf16 a[164:167], a[216:219], v[252:255], a[164:167]
    v_mfma_f32_16x16x32_bf16 a[168:171], a[220:223], v[228:231], a[168:171]
    v_mfma_f32_16x16x32_bf16 a[172:175], a[220:223], v[236:239], a[172:175]
    v_mfma_f32_16x16x32_bf16 a[176:179], a[220:223], v[244:247], a[176:179]
    v_mfma_f32_16x16x32_bf16 a[180:183], a[220:223], v[252:255], a[180:183]
    ds_read_b64_tr_b16 a[216:217], v8 offset:49152
    ds_read_b64_tr_b16 a[218:219], v8 offset:51200
    ds_read_b64_tr_b16 a[220:221], v9 offset:49152
    ds_read_b64_tr_b16 a[222:223], v9 offset:51200
    s_waitcnt lgkmcnt(0)
    v_mfma_f32_16x16x32_bf16 a[152:155], a[216:219], v[56:59], a[152:155]
    v_mfma_f32_16x16x32_bf16 a[156:159], a[216:219], v[64:67], a[156:159]
    v_mfma_f32_16x16x32_bf16 a[160:163], a[216:219], v[72:75], a[160:163]
    v_mfma_f32_16x16x32_bf16 a[164:167], a[216:219], v[80:83], a[164:167]
    v_mfma_f32_16x16x32_bf16 a[168:171], a[220:223], v[56:59], a[168:171]
    v_mfma_f32_16x16x32_bf16 a[172:175], a[220:223], v[64:67], a[172:175]
    v_mfma_f32_16x16x32_bf16 a[176:179], a[220:223], v[72:75], a[176:179]
    v_mfma_f32_16x16x32_bf16 a[180:183], a[220:223], v[80:83], a[180:183]
    ds_read_b64_tr_b16 a[216:217], v8 offset:53248
    ds_read_b64_tr_b16 a[218:219], v8 offset:55296
    ds_read_b64_tr_b16 a[220:221], v9 offset:53248
    ds_read_b64_tr_b16 a[222:223], v9 offset:55296
    s_waitcnt lgkmcnt(0)
    v_mfma_f32_16x16x32_bf16 a[152:155], a[216:219], v[60:63], a[152:155]
    v_mfma_f32_16x16x32_bf16 a[156:159], a[216:219], v[68:71], a[156:159]
    v_mfma_f32_16x16x32_bf16 a[160:163], a[216:219], v[76:79], a[160:163]
    v_mfma_f32_16x16x32_bf16 a[164:167], a[216:219], v[84:87], a[164:167]
    v_mfma_f32_16x16x32_bf16 a[168:171], a[220:223], v[60:63], a[168:171]
    v_mfma_f32_16x16x32_bf16 a[172:175], a[220:223], v[68:71], a[172:175]
    v_mfma_f32_16x16x32_bf16 a[176:179], a[220:223], v[76:79], a[176:179]
    v_mfma_f32_16x16x32_bf16 a[180:183], a[220:223], v[84:87], a[180:183]
    ds_read_b64_tr_b16 a[216:217], v8 offset:57344
    ds_read_b64_tr_b16 a[218:219], v8 offset:59392
    ds_read_b64_tr_b16 a[220:221], v9 offset:57344
    ds_read_b64_tr_b16 a[222:223], v9 offset:59392
    s_waitcnt lgkmcnt(0)
    v_mfma_f32_16x16x32_bf16 a[152:155], a[216:219], v[88:91], a[152:155]
    v_mfma_f32_16x16x32_bf16 a[156:159], a[216:219], v[96:99], a[156:159]
    v_mfma_f32_16x16x32_bf16 a[160:163], a[216:219], v[104:107], a[160:163]
    v_mfma_f32_16x16x32_bf16 a[164:167], a[216:219], v[112:115], a[164:167]
    v_mfma_f32_16x16x32_bf16 a[168:171], a[220:223], v[88:91], a[168:171]
    v_mfma_f32_16x16x32_bf16 a[172:175], a[220:223], v[96:99], a[172:175]
    v_mfma_f32_16x16x32_bf16 a[176:179], a[220:223], v[104:107], a[176:179]
    v_mfma_f32_16x16x32_bf16 a[180:183], a[220:223], v[112:115], a[180:183]
    ds_read_b64_tr_b16 a[216:217], v8 offset:61440
    ds_read_b64_tr_b16 a[218:219], v8 offset:63488
    ds_read_b64_tr_b16 a[220:221], v9 offset:61440
    ds_read_b64_tr_b16 a[222:223], v9 offset:63488
    s_waitcnt lgkmcnt(0)
    v_mfma_f32_16x16x32_bf16 a[152:155], a[216:219], v[92:95], a[152:155]
    v_mfma_f32_16x16x32_bf16 a[156:159], a[216:219], v[100:103], a[156:159]
    v_mfma_f32_16x16x32_bf16 a[160:163], a[216:219], v[108:111], a[160:163]
    v_mfma_f32_16x16x32_bf16 a[164:167], a[216:219], v[116:119], a[164:167]
    v_mfma_f32_16x16x32_bf16 a[168:171], a[220:223], v[92:95], a[168:171]
    v_mfma_f32_16x16x32_bf16 a[172:175], a[220:223], v[100:103], a[172:175]
    v_mfma_f32_16x16x32_bf16 a[176:179], a[220:223], v[108:111], a[176:179]
    v_mfma_f32_16x16x32_bf16 a[180:183], a[220:223], v[116:119], a[180:183]
    v_mov_b32 v24, 0
    v_mov_b32 v25, 0
    v_mov_b32 v26, 0
    v_mov_b32 v27, 0
    v_mov_b32 v28, 0
    v_mov_b32 v29, 0
    v_mov_b32 v30, 0
    v_mov_b32 v31, 0
    v_mov_b32 v32, 0
    v_mov_b32 v33, 0
    v_mov_b32 v34, 0
    v_mov_b32 v35, 0
    v_mov_b32 v36, 0
    v_mov_b32 v37, 0
    v_mov_b32 v38, 0
    v_mov_b32 v39, 0
    s_nop 1
    v_smfmac_f32_16x16x64_bf16 v[24:27], a[248:251], a[96:103], v20
    v_smfmac_f32_16x16x64_bf16 v[28:31], a[248:251], a[104:111], v20
    v_smfmac_f32_16x16x64_bf16 v[32:35], a[248:251], a[112:119], v20
    v_smfmac_f32_16x16x64_bf16 v[36:39], a[248:251], a[120:127], v20
    v_smfmac_f32_16x16x64_bf16 v[24:27], a[248:251], a[128:135], v20
    v_smfmac_f32_16x16x64_bf16 v[28:31], a[248:251], a[136:143], v20
    v_smfmac_f32_16x16x64_bf16 v[32:35], a[248:251], a[144:151], v20
    v_smfmac_f32_16x16x64_bf16 v[36:39], a[248:251], v[120:127], v20
    v_smfmac_f32_16x16x64_bf16 v[24:27], a[248:251], v[128:135], v20
    v_smfmac_f32_16x16x64_bf16 v[28:31], a[248:251], v[136:143], v20
    v_smfmac_f32_16x16x64_bf16 v[32:35], a[248:251], v[144:151], v20
    v_smfmac_f32_16x16x64_bf16 v[36:39], a[248:251], v[152:159], v20
    v_smfmac_f32_16x16x64_bf16 v[24:27], a[248:251], v[160:167], v20
    v_smfmac_f32_16x16x64_bf16 v[28:31], a[248:251], v[168:175], v20
    v_smfmac_f32_16x16x64_bf16 v[32:35], a[248:251], v[176:183], v20
    v_smfmac_f32_16x16x64_bf16 v[36:39], a[248:251], v[184:191], v20
    v_smfmac_f32_16x16x64_bf16 v[24:27], a[248:251], v[192:199], v20
    v_smfmac_f32_16x16x64_bf16 v[28:31], a[248:251], v[200:207], v20
    v_smfmac_f32_16x16x64_bf16 v[32:35], a[248:251], v[208:215], v20
    v_smfmac_f32_16x16x64_bf16 v[36:39], a[248:251], v[216:223], v20
    v_smfmac_f32_16x16x64_bf16 v[24:27], a[248:251], v[224:231], v20
    v_smfmac_f32_16x16x64_bf16 v[28:31], a[248:251], v[232:239], v20
    v_smfmac_f32_16x16x64_bf16 v[32:35], a[248:251], v[240:247], v20
    v_smfmac_f32_16x16x64_bf16 v[36:39], a[248:251], v[248:255], v20
    v_smfmac_f32_16x16x64_bf16 v[24:27], a[248:251], v[56:63], v20
    v_smfmac_f32_16x16x64_bf16 v[28:31], a[248:251], v[64:71], v20
    v_smfmac_f32_16x16x64_bf16 v[32:35], a[248:251], v[72:79], v20
    v_smfmac_f32_16x16x64_bf16 v[36:39], a[248:251], v[80:87], v20
    v_smfmac_f32_16x16x64_bf16 v[24:27], a[248:251], v[88:95], v20
    v_smfmac_f32_16x16x64_bf16 v[28:31], a[248:251], v[96:103], v20
    v_smfmac_f32_16x16x64_bf16 v[32:35], a[248:251], v[104:111], v20
    v_smfmac_f32_16x16x64_bf16 v[36:39], a[248:251], v[112:119], v20
    s_nop 15
    v_add_f32 v24, v24, v25
    v_add_f32 v28, v28, v29
    v_add_f32 v32, v32, v33
    v_add_f32 v36, v36, v37
    v_rcp_f32 v16, v24
    v_rcp_f32 v17, v28
    v_rcp_f32 v18, v32
    v_rcp_f32 v19, v36
    s_nop 1
    s_branch rare_ret
code_end:
    s_endpgm
.section .rodata,"a"
.p2align 6
.amdhsa_kernel recurrent_scan__sliding_block_cached__moe_arch_mod__prompt_kernel
  .amdhsa_next_free_vgpr 512
  .amdhsa_next_free_sgpr 102
  .amdhsa_accum_offset 256
  .amdhsa_group_segment_fixed_size 0
  .amdhsa_kernarg_size 104
  .amdhsa_user_sgpr_count 2
  .amdhsa_user_sgpr_kernarg_segment_ptr 1
  .amdhsa_system_sgpr_workgroup_id_x 1
  .amdhsa_float_denorm_mode_32 3
.end_amdhsa_kernel
```

```asm
; @launch grid=(256,1,1) block=(256,1,1) lds=163840
.amdgcn_target "amdgcn-amd-amdhsa--gfx950"
.text
.globl recurrent_scan__sliding_block_cached__moe_arch_mod__prompt_kernel
.p2align 12
.p2align 8
.type recurrent_scan__sliding_block_cached__moe_arch_mod__prompt_kernel,@function
recurrent_scan__sliding_block_cached__moe_arch_mod__prompt_kernel:
    s_cmp_ge_u32 s2, 256
    s_cbranch_scc1 main_end
    s_load_dwordx16 s[64:79], s[0:1], 0
    s_load_dwordx4 s[80:83], s[0:1], 64
    s_load_dwordx2 s[84:85], s[0:1], 80
    s_load_dwordx2 s[86:87], s[0:1], 96
    s_lshr_b32 s56, s2, 3
    s_lshl_b32 s56, s56, 10
    v_lshrrev_b32 v18, 5, v0
    v_lshlrev_b32 v18, 7, v18
    v_add_u32 v18, s56, v18
    s_getpc_b64 s[88:89]
code0:
    v_and_b32 v19, 3, v0
    v_lshl_add_u32 v19, v19, 15, v18
    v_min_u32 v19, code_end-code0-4, v19
    global_load_dword a252, v19, s[88:89]
    v_lshrrev_b32 v17, 6, v0
    v_lshlrev_b32 v17, 12, v17
    v_and_b32 v1, 63, v0
    v_lshl_add_u32 v17, v1, 4, v17
    v_lshrrev_b32 v29, 6, v0
    v_mov_b32 v16, v0
    v_readfirstlane_b32 s3, v29
    s_and_b32 s53, s2, 7
    s_lshr_b32 s52, s2, 5
    s_bfe_u32 s51, s2, 0x20003
    s_lshl_b32 s50, s53, 2
    s_add_u32 s50, s50, s51
    s_lshl_b32 s60, s2, 3
    s_lshl2_add_u32 s60, s3, s60
    v_bfe_u32 v240, v1, 1, 2
    v_add_u32 v240, s60, v240
    v_lshrrev_b32 v241, 3, v1
    v_lshlrev_b32 v241, 5, v241
    v_and_b32 v29, 1, v1
    v_lshl_add_u32 v241, v29, 4, v241
    v_mul_u32_u24 v242, 1280, v240
    v_add_u32 v242, v242, v241
    s_cmp_lt_u32 s3, 2
    s_cselect_b32 s44, 0, 0x70000000
    v_lshrrev_b32 v29, 4, v1
    v_lshlrev_b32 v29, 1, v29
    v_and_b32 v7, 7, v1
    v_xor_b32 v7, v7, v29
    v_lshlrev_b32 v7, 4, v7
    v_lshrrev_b32 v29, 5, v1
    v_lshlrev_b32 v29, 3, v29
    v_bfe_u32 v5, v1, 3, 2
    v_add_u32 v5, v5, v29
    v_mul_u32_u24 v2, 12288, v5
    v_add_u32 v2, v2, v7
    v_add_u32 v3, 196608, v2
    s_lshl_b32 s54, s52, 2
    s_add_u32 s54, s54, s3
    s_mul_i32 s49, s3, 6144
    s_lshr_b32 s59, s3, 1
    s_lshl_b32 s59, s59, 5
    s_and_b32 s56, s3, 1
    s_lshl_b32 s56, s56, 2
    s_add_u32 s59, s59, s56
    s_mul_i32 s36, s59, 12288
    s_mov_b32 s37, 786432
    s_add_u32 s45, s51, s52
    s_and_b32 s45, s45, 3
    s_lshl_b32 s45, s45, 2
    s_lshr_b32 s45, 0x5050, s45
    s_and_b32 s45, s45, 15
    s_mul_i32 s56, s45, 786432
    s_add_u32 s36, s36, s56
    s_lshl_b32 s45, s45, 13
    s_andn2_b32 s56, 2, s2
    s_lshl_b32 s56, s56, 9
    s_add_u32 s45, s45, s56
    s_mul_i32 s56, s50, 384
    s_sub_u32 s57, 7864320, s56
    s_waitcnt lgkmcnt(0)
    s_mov_b32 s12, s64
    s_and_b32 s13, s65, 0xffff
    s_mov_b32 s14, 2621440
    s_mov_b32 s15, 0x00020000
    s_mov_b32 s16, s76
    s_and_b32 s17, s77, 0xffff
    s_mov_b32 s18, 1280
    s_mov_b32 s19, 0x00020000
    s_cmp_lt_u32 s3, 2
    s_cbranch_scc0 no_lx
    buffer_load_dwordx4 v[64:67], v242, s[12:15], 0 offen offset:0
    buffer_load_dwordx4 v[68:71], v242, s[12:15], 0 offen offset:256
    buffer_load_dwordx4 v[72:75], v242, s[12:15], 0 offen offset:512
    buffer_load_dwordx4 v[76:79], v242, s[12:15], 0 offen offset:768
    buffer_load_dwordx4 v[80:83], v242, s[12:15], 0 offen offset:1024
no_lx:
    v_mov_b32 v25, 3203072
    global_load_dword v26, v25, s[86:87] sc1
    s_lshr_b32 s47, s2, 3
    s_lshl_b32 s47, s47, 7
    s_add_u32 s47, s47, 4128768
    s_load_dword s93, s[86:87], s47 glc
    s_add_u32 s8, s70, s56
    s_addc_u32 s9, s71, 0
    s_and_b32 s9, s9, 0xffff
    s_mov_b32 s10, s57
    s_mov_b32 s11, 0x00020000
    s_cmp_lt_u32 s3, 2
    s_cbranch_scc1 no_w0
    s_sub_u32 s47, s36, 393216
    s_add_u32 m0, s49, 36864
    s_nop 0
    buffer_load_dwordx4 v2, s[8:11], s47 offen offset:0 lds
    s_add_u32 m0, s49, 37760
    s_nop 0
    buffer_load_dwordx4 v2, s[8:11], s47 offen offset:128 lds
    s_add_u32 m0, s49, 38656
    s_nop 0
    buffer_load_dwordx4 v2, s[8:11], s47 offen offset:256 lds
    s_add_u32 m0, s49, 39936
    s_nop 0
    buffer_load_dwordx4 v3, s[8:11], s47 offen offset:0 lds
    s_add_u32 m0, s49, 40832
    s_nop 0
    buffer_load_dwordx4 v3, s[8:11], s47 offen offset:128 lds
    s_add_u32 m0, s49, 41728
    s_nop 0
    buffer_load_dwordx4 v3, s[8:11], s47 offen offset:256 lds
    s_add_u32 m0, s49, 49152
    s_nop 0
    buffer_load_dwordx4 v2, s[8:11], s36 offen offset:0 lds
    s_add_u32 m0, s49, 50048
    s_nop 0
    buffer_load_dwordx4 v2, s[8:11], s36 offen offset:128 lds
    s_add_u32 m0, s49, 50944
    s_nop 0
    buffer_load_dwordx4 v2, s[8:11], s36 offen offset:256 lds
    s_add_u32 m0, s49, 52224
    s_nop 0
    buffer_load_dwordx4 v3, s[8:11], s36 offen offset:0 lds
    s_add_u32 m0, s49, 53120
    s_nop 0
    buffer_load_dwordx4 v3, s[8:11], s36 offen offset:128 lds
    s_add_u32 m0, s49, 54016
    s_nop 0
    buffer_load_dwordx4 v3, s[8:11], s36 offen offset:256 lds
    s_add_u32 s36, s36, s37
    s_sub_u32 s55, s36, 7864320
    s_min_u32 s36, s36, s55
no_w0:
    s_mov_b32 s24, s86
    s_and_b32 s25, s87, 0xffff
    s_mov_b32 s26, 268435456
    s_mov_b32 s27, 0x00020000
    s_lshr_b32 s56, s60, 6
    s_mul_i32 s41, s56, 81920
    s_and_b32 s56, s60, 63
    s_lshl_b32 s56, s56, 6
    s_add_u32 s41, s41, s56
    v_lshrrev_b32 v29, 4, v1
    v_and_b32 v243, 15, v1
    v_lshlrev_b32 v243, 4, v243
    v_lshl_add_u32 v243, v29, 12, v243
    s_mov_b32 s38, 0x3acccccd
    s_mov_b32 s42, 0xffff0000
    s_mov_b32 s43, 0x3f803f80
    v_bfe_u32 v29, v1, 2, 3
    v_lshlrev_b32 v8, 7, v29
    v_lshrrev_b32 v29, 1, v29
    v_xor_b32 v29, 0, v29
    v_lshl_add_u32 v8, v29, 5, v8
    v_and_b32 v29, 3, v1
    v_lshl_add_u32 v8, v29, 3, v8
    v_lshrrev_b32 v29, 5, v1
    v_mul_u32_u24 v29, 3072, v29
    v_add_u32 v8, v8, v29
    v_add_u32 v8, 49152, v8
    v_xor_b32 v9, 32, v8
    v_xor_b32 v10, 64, v8
    v_xor_b32 v11, 96, v8
    v_and_b32 v15, 12, v1
    v_lshlrev_b32 v15, 6, v15
    v_and_b32 v29, 3, v1
    v_lshl_add_u32 v15, v29, 5, v15
    v_and_b32 v29, 16, v1
    v_add_u32 v15, v15, v29
    v_and_b32 v29, 32, v1
    v_lshl_add_u32 v15, v29, 2, v15
    s_and_b32 s56, s2, 1
    s_lshl_b32 s56, s56, 11
    v_add_u32 v15, s56, v15
    v_xor_b32 v14, 2048, v15
    s_mul_i32 s56, s54, 81920
    s_add_u32 s56, s56, 0
    s_add_u32 s20, s86, s56
    s_addc_u32 s21, s87, 0
    s_and_b32 s21, s21, 0xffff
    s_mov_b32 s22, 81920
    s_mov_b32 s23, 0x00020000
    s_lshl_b32 s46, s54, 7
    s_add_u32 s46, s46, 4128768
    s_mov_b32 s101, 0
    s_lshl_b32 s56, s53, 12
    s_add_u32 s46, s46, s56
    s_load_dword s92, s[86:87], s46 glc
    s_lshr_b32 s6, s2, 3
    s_lshl_b32 s6, s6, 7
    s_lshl_b32 s56, s53, 2
    s_add_u32 s6, s6, s56
    s_add_u32 s6, s6, 4128768
    v_lshlrev_b32 v20, 12, v1
    s_cmp_eq_u32 s3, 0
    s_cselect_b32 s6, s6, 0x70000000
    v_mov_b32 v144, 0
    v_mov_b32 v145, 0
    v_mov_b32 v146, 0
    v_mov_b32 v147, 0
    s_cmp_lt_u32 s3, 2
    s_cbranch_scc1 ln_go
no_ln:
    s_mov_b64 exec, 0
    s_cmp_eq_u32 s3, 2
    s_cbranch_scc1 pg_0
    s_branch pg_1
pg_back:
    s_mov_b64 exec, -1
    s_barrier
    s_sub_u32 s47, s36, 393216
    s_add_u32 m0, s49, 61440
    s_nop 0
    buffer_load_dwordx4 v2, s[8:11], s47 offen offset:0 lds
    s_add_u32 m0, s49, 62336
    s_nop 0
    buffer_load_dwordx4 v2, s[8:11], s47 offen offset:128 lds
    s_add_u32 m0, s49, 63232
    s_nop 0
    buffer_load_dwordx4 v2, s[8:11], s47 offen offset:256 lds
    s_add_u32 m0, s49, 64512
    s_nop 0
    buffer_load_dwordx4 v3, s[8:11], s47 offen offset:0 lds
    s_add_u32 m0, s49, 65408
    s_nop 0
    buffer_load_dwordx4 v3, s[8:11], s47 offen offset:128 lds
    s_add_u32 m0, s49, 66304
    s_nop 0
    buffer_load_dwordx4 v3, s[8:11], s47 offen offset:256 lds
    s_add_u32 m0, s49, 73728
    s_nop 0
    buffer_load_dwordx4 v2, s[8:11], s36 offen offset:0 lds
    s_add_u32 m0, s49, 74624
    s_nop 0
    buffer_load_dwordx4 v2, s[8:11], s36 offen offset:128 lds
    s_add_u32 m0, s49, 75520
    s_nop 0
    buffer_load_dwordx4 v2, s[8:11], s36 offen offset:256 lds
    s_add_u32 m0, s49, 76800
    s_nop 0
    buffer_load_dwordx4 v3, s[8:11], s36 offen offset:0 lds
    s_add_u32 m0, s49, 77696
    s_nop 0
    buffer_load_dwordx4 v3, s[8:11], s36 offen offset:128 lds
    s_add_u32 m0, s49, 78592
    s_nop 0
    buffer_load_dwordx4 v3, s[8:11], s36 offen offset:256 lds
    s_add_u32 s36, s36, s37
    s_sub_u32 s55, s36, 7864320
    s_min_u32 s36, s36, s55
    s_waitcnt vmcnt(24)
    v_readfirstlane_b32 s7, v26
    s_lshr_b32 s7, s7, 4
    s_mul_i32 s7, s7, 0x2c9277b5
    s_add_u32 s7, s7, 0x6c564b05
    s_lshl_b32 s7, s7, 4
    s_branch ln_join
ln_go:
    s_waitcnt vmcnt(5)
    v_dot2c_f32_bf16 v144, s43, v64
    v_dot2c_f32_bf16 v146, v64, v64
    v_dot2c_f32_bf16 v145, s43, v65
    v_dot2c_f32_bf16 v147, v65, v65
    v_dot2c_f32_bf16 v144, s43, v66
    v_dot2c_f32_bf16 v146, v66, v66
    v_dot2c_f32_bf16 v145, s43, v67
    v_dot2c_f32_bf16 v147, v67, v67
    v_lshlrev_b32 v104, 16, v64
    v_and_b32 v105, s42, v64
    v_lshlrev_b32 v106, 16, v65
    v_and_b32 v107, s42, v65
    v_lshlrev_b32 v108, 16, v66
    v_and_b32 v109, s42, v66
    v_lshlrev_b32 v110, 16, v67
    s_waitcnt vmcnt(4)
    v_dot2c_f32_bf16 v144, s43, v68
    v_dot2c_f32_bf16 v146, v68, v68
    v_dot2c_f32_bf16 v145, s43, v69
    v_dot2c_f32_bf16 v147, v69, v69
    v_dot2c_f32_bf16 v144, s43, v70
    v_dot2c_f32_bf16 v146, v70, v70
    v_dot2c_f32_bf16 v145, s43, v71
    v_dot2c_f32_bf16 v147, v71, v71
    v_and_b32 v111, s42, v67
    v_lshlrev_b32 v112, 16, v68
    v_and_b32 v113, s42, v68
    v_lshlrev_b32 v114, 16, v69
    v_and_b32 v115, s42, v69
    v_lshlrev_b32 v116, 16, v70
    v_and_b32 v117, s42, v70
    s_waitcnt vmcnt(3)
    v_dot2c_f32_bf16 v144, s43, v72
    v_dot2c_f32_bf16 v146, v72, v72
    v_dot2c_f32_bf16 v145, s43, v73
    v_dot2c_f32_bf16 v147, v73, v73
    v_dot2c_f32_bf16 v144, s43, v74
    v_dot2c_f32_bf16 v146, v74, v74
    v_dot2c_f32_bf16 v145, s43, v75
    v_dot2c_f32_bf16 v147, v75, v75
    v_lshlrev_b32 v118, 16, v71
    v_and_b32 v119, s42, v71
    v_lshlrev_b32 v120, 16, v72
    v_and_b32 v121, s42, v72
    v_lshlrev_b32 v122, 16, v73
    v_and_b32 v123, s42, v73
    v_lshlrev_b32 v124, 16, v74
    s_waitcnt vmcnt(2)
    v_dot2c_f32_bf16 v144, s43, v76
    v_dot2c_f32_bf16 v146, v76, v76
    v_dot2c_f32_bf16 v145, s43, v77
    v_dot2c_f32_bf16 v147, v77, v77
    v_dot2c_f32_bf16 v144, s43, v78
    v_dot2c_f32_bf16 v146, v78, v78
    v_dot2c_f32_bf16 v145, s43, v79
    v_dot2c_f32_bf16 v147, v79, v79
    v_and_b32 v125, s42, v74
    v_lshlrev_b32 v126, 16, v75
    v_and_b32 v127, s42, v75
    v_lshlrev_b32 v128, 16, v76
    v_and_b32 v129, s42, v76
    v_lshlrev_b32 v130, 16, v77
    v_and_b32 v131, s42, v77
    s_waitcnt vmcnt(1)
    v_dot2c_f32_bf16 v144, s43, v80
    v_dot2c_f32_bf16 v146, v80, v80
    v_dot2c_f32_bf16 v145, s43, v81
    v_dot2c_f32_bf16 v147, v81, v81
    v_dot2c_f32_bf16 v144, s43, v82
    v_dot2c_f32_bf16 v146, v82, v82
    v_dot2c_f32_bf16 v145, s43, v83
    v_dot2c_f32_bf16 v147, v83, v83
    v_lshlrev_b32 v132, 16, v78
    v_and_b32 v133, s42, v78
    v_lshlrev_b32 v134, 16, v79
    v_add_f32 v144, v144, v145
    v_add_f32 v146, v146, v147
    v_and_b32 v135, s42, v79
    v_add_f32_dpp v144, v144, v144 quad_perm:[1,0,3,2] row_mask:0xf bank_mask:0xf
    v_add_f32_dpp v146, v146, v146 quad_perm:[1,0,3,2] row_mask:0xf bank_mask:0xf
    v_lshlrev_b32 v136, 16, v80
    v_add_f32_dpp v144, v144, v144 row_ror:8 row_mask:0xf bank_mask:0xf
    v_add_f32_dpp v146, v146, v146 row_ror:8 row_mask:0xf bank_mask:0xf
    v_mov_b32 v148, v144
    v_mov_b32 v149, v146
    v_and_b32 v137, s42, v80
    v_permlane16_swap_b32 v144, v148
    v_permlane16_swap_b32 v146, v149
    v_lshlrev_b32 v138, 16, v81
    v_add_f32 v144, v144, v148
    v_add_f32 v146, v146, v149
    v_mov_b32 v148, v144
    v_mov_b32 v149, v146
    v_and_b32 v139, s42, v81
    v_permlane32_swap_b32 v144, v148
    v_permlane32_swap_b32 v146, v149
    v_lshlrev_b32 v140, 16, v82
    v_add_f32 v144, v144, v148
    v_add_f32 v146, v146, v149
    v_mul_f32 v150, s38, v144
    v_mul_f32 v146, s38, v146
    v_fma_f32 v154, -v150, v150, v146
    v_mul_f32 v146, 0x3d800000, v146
    v_cmp_nge_f32 vcc, v154, v146
    s_cbranch_vccnz ln_exact
ln_back:
    v_cvt_pk_bf16_f32 v154, 0, v154
    v_cvt_pk_bf16_f32 v150, 0, v150
    v_add_f32 v154, 0x3727c5ac, v154
    v_cvt_pk_bf16_f32 v154, 0, v154
    v_sqrt_f32 v154, v154
    v_and_b32 v141, s42, v82
    v_cvt_pk_bf16_f32 v154, 0, v154
    v_rcp_f32 v151, v154
    v_lshlrev_b32 v142, 16, v83
    v_mul_f32 v144, 0x3dd53b95, v151
    v_mul_f32 v146, -v150, v144
    v_pk_fma_f32 v[156:157], v[104:105], v[144:145], v[146:147] op_sel_hi:[1,0,0]
    v_cvt_pk_bf16_f32 v160, v156, v157
    v_pk_fma_f32 v[158:159], v[106:107], v[144:145], v[146:147] op_sel_hi:[1,0,0]
    v_cvt_pk_bf16_f32 v161, v158, v159
    v_pk_fma_f32 v[156:157], v[108:109], v[144:145], v[146:147] op_sel_hi:[1,0,0]
    v_cvt_pk_bf16_f32 v162, v156, v157
    v_pk_fma_f32 v[158:159], v[110:111], v[144:145], v[146:147] op_sel_hi:[1,0,0]
    v_cvt_pk_bf16_f32 v163, v158, v159
    buffer_store_dwordx4 v[160:163], v243, s[24:27], s41 offen sc1
    s_addk_i32 s41, 16384
    v_pk_fma_f32 v[156:157], v[112:113], v[144:145], v[146:147] op_sel_hi:[1,0,0]
    v_cvt_pk_bf16_f32 v164, v156, v157
    v_pk_fma_f32 v[158:159], v[114:115], v[144:145], v[146:147] op_sel_hi:[1,0,0]
    v_cvt_pk_bf16_f32 v165, v158, v159
    v_pk_fma_f32 v[156:157], v[116:117], v[144:145], v[146:147] op_sel_hi:[1,0,0]
    v_cvt_pk_bf16_f32 v166, v156, v157
    v_pk_fma_f32 v[158:159], v[118:119], v[144:145], v[146:147] op_sel_hi:[1,0,0]
    v_cvt_pk_bf16_f32 v167, v158, v159
    buffer_store_dwordx4 v[164:167], v243, s[24:27], s41 offen sc1
    s_addk_i32 s41, 16384
    v_pk_fma_f32 v[156:157], v[120:121], v[144:145], v[146:147] op_sel_hi:[1,0,0]
    v_cvt_pk_bf16_f32 v168, v156, v157
    v_pk_fma_f32 v[158:159], v[122:123], v[144:145], v[146:147] op_sel_hi:[1,0,0]
    v_cvt_pk_bf16_f32 v169, v158, v159
    v_pk_fma_f32 v[156:157], v[124:125], v[144:145], v[146:147] op_sel_hi:[1,0,0]
    v_cvt_pk_bf16_f32 v170, v156, v157
    v_pk_fma_f32 v[158:159], v[126:127], v[144:145], v[146:147] op_sel_hi:[1,0,0]
    v_cvt_pk_bf16_f32 v171, v158, v159
    buffer_store_dwordx4 v[168:171], v243, s[24:27], s41 offen sc1
    s_addk_i32 s41, 16384
    v_pk_fma_f32 v[156:157], v[128:129], v[144:145], v[146:147] op_sel_hi:[1,0,0]
    v_cvt_pk_bf16_f32 v172, v156, v157
    v_pk_fma_f32 v[158:159], v[130:131], v[144:145], v[146:147] op_sel_hi:[1,0,0]
    v_cvt_pk_bf16_f32 v173, v158, v159
    v_pk_fma_f32 v[156:157], v[132:133], v[144:145], v[146:147] op_sel_hi:[1,0,0]
    v_cvt_pk_bf16_f32 v174, v156, v157
    v_pk_fma_f32 v[158:159], v[134:135], v[144:145], v[146:147] op_sel_hi:[1,0,0]
    v_cvt_pk_bf16_f32 v175, v158, v159
    buffer_store_dwordx4 v[172:175], v243, s[24:27], s41 offen sc1
    s_addk_i32 s41, 16384
    v_pk_fma_f32 v[156:157], v[136:137], v[144:145], v[146:147] op_sel_hi:[1,0,0]
    v_cvt_pk_bf16_f32 v176, v156, v157
    v_pk_fma_f32 v[158:159], v[138:139], v[144:145], v[146:147] op_sel_hi:[1,0,0]
    v_cvt_pk_bf16_f32 v177, v158, v159
    v_pk_fma_f32 v[156:157], v[140:141], v[144:145], v[146:147] op_sel_hi:[1,0,0]
    v_cvt_pk_bf16_f32 v178, v156, v157
    v_and_b32 v143, s42, v83
    v_pk_fma_f32 v[158:159], v[142:143], v[144:145], v[146:147] op_sel_hi:[1,0,0]
    v_cvt_pk_bf16_f32 v179, v158, v159
    buffer_store_dwordx4 v[176:179], v243, s[24:27], s41 offen sc1
    s_barrier
    buffer_load_dwordx4 v[84:87], v241, s[16:19], 0 offen offset:0
    buffer_load_dwordx4 v[88:91], v241, s[16:19], 0 offen offset:256
    buffer_load_dwordx4 v[92:95], v241, s[16:19], 0 offen offset:512
    buffer_load_dwordx4 v[96:99], v241, s[16:19], 0 offen offset:768
    buffer_load_dwordx4 v[100:103], v241, s[16:19], 0 offen offset:1024
    s_waitcnt vmcnt(10)
    v_readfirstlane_b32 s7, v26
    s_lshr_b32 s7, s7, 4
    s_mul_i32 s7, s7, 0x2c9277b5
    s_add_u32 s7, s7, 0x6c564b05
    s_lshl_b32 s7, s7, 4
    s_add_u32 s36, s36, s37
    s_sub_u32 s55, s36, 7864320
    s_min_u32 s36, s36, s55
    s_add_u32 s36, s36, s37
    s_sub_u32 s55, s36, 7864320
    s_min_u32 s36, s36, s55
    s_mov_b64 exec, 0
    s_cmp_eq_u32 s3, 0
    s_cbranch_scc1 pg_2
    s_branch pg_3
pg_backL:
    s_mov_b64 exec, -1
    s_waitcnt vmcnt(5)
ln_join:
    s_waitcnt lgkmcnt(0)
    s_barrier
    v_mov_b32 v21, s7
    s_mov_b64 exec, 0xff
    buffer_store_dword v21, v20, s[24:27], s6 offen sc1
    s_mov_b64 exec, 0x55
    v_lshlrev_b32 v29, 3, v240
    s_add_u32 s56, s44, 3211264
    buffer_store_dwordx2 v[150:151], v29, s[24:27], s56 offen sc1
    s_mov_b64 exec, -1
    s_add_u32 m0, s49, 98304
    s_nop 0
    buffer_load_dwordx4 v2, s[8:11], s36 offen offset:0 lds
    s_add_u32 m0, s49, 99200
    s_nop 0
    buffer_load_dwordx4 v2, s[8:11], s36 offen offset:128 lds
    s_add_u32 m0, s49, 100096
    s_nop 0
    buffer_load_dwordx4 v2, s[8:11], s36 offen offset:256 lds
    s_add_u32 m0, s49, 101376
    s_nop 0
    buffer_load_dwordx4 v3, s[8:11], s36 offen offset:0 lds
    s_add_u32 m0, s49, 102272
    s_nop 0
    buffer_load_dwordx4 v3, s[8:11], s36 offen offset:128 lds
    s_add_u32 m0, s49, 103168
    s_nop 0
    buffer_load_dwordx4 v3, s[8:11], s36 offen offset:256 lds
    s_add_u32 s36, s36, s37
    s_sub_u32 s55, s36, 7864320
    s_min_u32 s36, s36, s55
    v_mov_b32 v144, 0
    v_mov_b32 v145, 0
    s_waitcnt vmcnt(8)
    v_pk_add_f32 v[104:105], v[104:105], v[150:151] op_sel_hi:[1,0] neg_lo:[0,1] neg_hi:[0,1]
    v_cvt_pk_bf16_f32 v104, 0, v104
    v_cvt_pk_bf16_f32 v105, 0, v105
    v_pk_mul_f32 v[104:105], v[104:105], v[150:151] op_sel:[0,1]
    v_cvt_pk_bf16_f32 v104, v104, v105
    v_dot2c_f32_bf16 v144, v104, v84
    v_pk_add_f32 v[106:107], v[106:107], v[150:151] op_sel_hi:[1,0] neg_lo:[0,1] neg_hi:[0,1]
    v_cvt_pk_bf16_f32 v106, 0, v106
    v_cvt_pk_bf16_f32 v107, 0, v107
    v_pk_mul_f32 v[106:107], v[106:107], v[150:151] op_sel:[0,1]
    v_cvt_pk_bf16_f32 v106, v106, v107
    v_dot2c_f32_bf16 v145, v106, v85
    v_pk_add_f32 v[108:109], v[108:109], v[150:151] op_sel_hi:[1,0] neg_lo:[0,1] neg_hi:[0,1]
    v_cvt_pk_bf16_f32 v108, 0, v108
    v_cvt_pk_bf16_f32 v109, 0, v109
    v_pk_mul_f32 v[108:109], v[108:109], v[150:151] op_sel:[0,1]
    v_cvt_pk_bf16_f32 v108, v108, v109
    v_dot2c_f32_bf16 v144, v108, v86
    v_pk_add_f32 v[110:111], v[110:111], v[150:151] op_sel_hi:[1,0] neg_lo:[0,1] neg_hi:[0,1]
    v_cvt_pk_bf16_f32 v110, 0, v110
    v_cvt_pk_bf16_f32 v111, 0, v111
    v_pk_mul_f32 v[110:111], v[110:111], v[150:151] op_sel:[0,1]
    v_cvt_pk_bf16_f32 v110, v110, v111
    v_dot2c_f32_bf16 v145, v110, v87
    v_pk_add_f32 v[112:113], v[112:113], v[150:151] op_sel_hi:[1,0] neg_lo:[0,1] neg_hi:[0,1]
    v_cvt_pk_bf16_f32 v112, 0, v112
    v_cvt_pk_bf16_f32 v113, 0, v113
    v_pk_mul_f32 v[112:113], v[112:113], v[150:151] op_sel:[0,1]
    v_cvt_pk_bf16_f32 v112, v112, v113
    v_dot2c_f32_bf16 v144, v112, v88
    v_pk_add_f32 v[114:115], v[114:115], v[150:151] op_sel_hi:[1,0] neg_lo:[0,1] neg_hi:[0,1]
    v_cvt_pk_bf16_f32 v114, 0, v114
    v_cvt_pk_bf16_f32 v115, 0, v115
    v_pk_mul_f32 v[114:115], v[114:115], v[150:151] op_sel:[0,1]
    v_cvt_pk_bf16_f32 v114, v114, v115
    v_dot2c_f32_bf16 v145, v114, v89
    v_pk_add_f32 v[116:117], v[116:117], v[150:151] op_sel_hi:[1,0] neg_lo:[0,1] neg_hi:[0,1]
    v_cvt_pk_bf16_f32 v116, 0, v116
    v_cvt_pk_bf16_f32 v117, 0, v117
    v_pk_mul_f32 v[116:117], v[116:117], v[150:151] op_sel:[0,1]
    v_cvt_pk_bf16_f32 v116, v116, v117
    v_dot2c_f32_bf16 v144, v116, v90
    v_pk_add_f32 v[118:119], v[118:119], v[150:151] op_sel_hi:[1,0] neg_lo:[0,1] neg_hi:[0,1]
    v_cvt_pk_bf16_f32 v118, 0, v118
    v_cvt_pk_bf16_f32 v119, 0, v119
    v_pk_mul_f32 v[118:119], v[118:119], v[150:151] op_sel:[0,1]
    v_cvt_pk_bf16_f32 v118, v118, v119
    v_dot2c_f32_bf16 v145, v118, v91
    v_pk_add_f32 v[120:121], v[120:121], v[150:151] op_sel_hi:[1,0] neg_lo:[0,1] neg_hi:[0,1]
    v_cvt_pk_bf16_f32 v120, 0, v120
    v_cvt_pk_bf16_f32 v121, 0, v121
    v_pk_mul_f32 v[120:121], v[120:121], v[150:151] op_sel:[0,1]
    v_cvt_pk_bf16_f32 v120, v120, v121
    v_dot2c_f32_bf16 v144, v120, v92
    v_pk_add_f32 v[122:123], v[122:123], v[150:151] op_sel_hi:[1,0] neg_lo:[0,1] neg_hi:[0,1]
    v_cvt_pk_bf16_f32 v122, 0, v122
    v_cvt_pk_bf16_f32 v123, 0, v123
    v_pk_mul_f32 v[122:123], v[122:123], v[150:151] op_sel:[0,1]
    v_cvt_pk_bf16_f32 v122, v122, v123
    v_dot2c_f32_bf16 v145, v122, v93
    v_pk_add_f32 v[124:125], v[124:125], v[150:151] op_sel_hi:[1,0] neg_lo:[0,1] neg_hi:[0,1]
    v_cvt_pk_bf16_f32 v124, 0, v124
    v_cvt_pk_bf16_f32 v125, 0, v125
    v_pk_mul_f32 v[124:125], v[124:125], v[150:151] op_sel:[0,1]
    v_cvt_pk_bf16_f32 v124, v124, v125
    v_dot2c_f32_bf16 v144, v124, v94
    v_pk_add_f32 v[126:127], v[126:127], v[150:151] op_sel_hi:[1,0] neg_lo:[0,1] neg_hi:[0,1]
    v_cvt_pk_bf16_f32 v126, 0, v126
    v_cvt_pk_bf16_f32 v127, 0, v127
    v_pk_mul_f32 v[126:127], v[126:127], v[150:151] op_sel:[0,1]
    v_cvt_pk_bf16_f32 v126, v126, v127
    v_dot2c_f32_bf16 v145, v126, v95
    s_branch page0
    .p2align 12
    .fill 32, 4, 0xbf810000
page0:
pg_0:
    s_cbranch_execz pg_4
    v_pk_add_f32 v[128:129], v[128:129], v[150:151] op_sel_hi:[1,0] neg_lo:[0,1] neg_hi:[0,1]
    v_cvt_pk_bf16_f32 v128, 0, v128
    v_cvt_pk_bf16_f32 v129, 0, v129
    v_pk_mul_f32 v[128:129], v[128:129], v[150:151] op_sel:[0,1]
    v_cvt_pk_bf16_f32 v128, v128, v129
    v_dot2c_f32_bf16 v144, v128, v96
    v_pk_add_f32 v[130:131], v[130:131], v[150:151] op_sel_hi:[1,0] neg_lo:[0,1] neg_hi:[0,1]
    v_cvt_pk_bf16_f32 v130, 0, v130
    v_cvt_pk_bf16_f32 v131, 0, v131
    v_pk_mul_f32 v[130:131], v[130:131], v[150:151] op_sel:[0,1]
    v_cvt_pk_bf16_f32 v130, v130, v131
    v_dot2c_f32_bf16 v145, v130, v97
    v_pk_add_f32 v[132:133], v[132:133], v[150:151] op_sel_hi:[1,0] neg_lo:[0,1] neg_hi:[0,1]
    v_cvt_pk_bf16_f32 v132, 0, v132
    v_cvt_pk_bf16_f32 v133, 0, v133
    v_pk_mul_f32 v[132:133], v[132:133], v[150:151] op_sel:[0,1]
    v_cvt_pk_bf16_f32 v132, v132, v133
    v_dot2c_f32_bf16 v144, v132, v98
    v_pk_add_f32 v[134:135], v[134:135], v[150:151] op_sel_hi:[1,0] neg_lo:[0,1] neg_hi:[0,1]
    v_cvt_pk_bf16_f32 v134, 0, v134
    v_cvt_pk_bf16_f32 v135, 0, v135
    v_pk_mul_f32 v[134:135], v[134:135], v[150:151] op_sel:[0,1]
    v_cvt_pk_bf16_f32 v134, v134, v135
    v_dot2c_f32_bf16 v145, v134, v99
    s_mov_b32 s4, s7
    s_mov_b32 s5, s7
    s_add_u32 s47, s46, 32
spin_ln:
    s_load_dwordx8 s[28:35], s[86:87], s46 glc
    s_add_u32 s101, s101, 1
    s_cmp_gt_u32 s101, 0x2000000
    s_cselect_b32 s57, 0, -1
    s_waitcnt lgkmcnt(0)
    s_xor_b64 s[28:29], s[28:29], s[4:5]
    s_xor_b64 s[30:31], s[30:31], s[4:5]
    s_xor_b64 s[32:33], s[32:33], s[4:5]
    s_xor_b64 s[34:35], s[34:35], s[4:5]
    s_or_b64 s[28:29], s[28:29], s[30:31]
    s_or_b64 s[28:29], s[28:29], s[32:33]
    s_or_b64 s[28:29], s[28:29], s[34:35]
    s_or_b32 s56, s28, s29
    s_and_b32 s56, s56, s57
    s_cbranch_scc1 spin_ln
    s_add_u32 s46, s45, 0
    s_sub_u32 s77, s46, 81920
    s_min_u32 s46, s46, s77
    s_xor_b32 s77, s46, 1024
    buffer_load_dwordx4 a[160:163], v14, s[20:23], s46 offen sc1
    buffer_load_dwordx4 a[164:167], v14, s[20:23], s77 offen sc1
    buffer_load_dwordx4 a[168:171], v15, s[20:23], s46 offen sc1
    buffer_load_dwordx4 a[172:175], v15, s[20:23], s77 offen sc1
    s_add_u32 s46, s45, 4096
    s_sub_u32 s77, s46, 81920
    s_min_u32 s46, s46, s77
    s_xor_b32 s77, s46, 1024
    buffer_load_dwordx4 a[176:179], v14, s[20:23], s46 offen sc1
    buffer_load_dwordx4 a[180:183], v14, s[20:23], s77 offen sc1
    buffer_load_dwordx4 a[184:187], v15, s[20:23], s46 offen sc1
    buffer_load_dwordx4 a[188:191], v15, s[20:23], s77 offen sc1
    v_pk_add_f32 v[136:137], v[136:137], v[150:151] op_sel_hi:[1,0] neg_lo:[0,1] neg_hi:[0,1]
    v_cvt_pk_bf16_f32 v136, 0, v136
    v_cvt_pk_bf16_f32 v137, 0, v137
    v_pk_mul_f32 v[136:137], v[136:137], v[150:151] op_sel:[0,1]
    v_cvt_pk_bf16_f32 v136, v136, v137
    v_dot2c_f32_bf16 v144, v136, v100
    v_pk_add_f32 v[138:139], v[138:139], v[150:151] op_sel_hi:[1,0] neg_lo:[0,1] neg_hi:[0,1]
    v_cvt_pk_bf16_f32 v138, 0, v138
    v_cvt_pk_bf16_f32 v139, 0, v139
    v_pk_mul_f32 v[138:139], v[138:139], v[150:151] op_sel:[0,1]
    v_cvt_pk_bf16_f32 v138, v138, v139
    v_dot2c_f32_bf16 v145, v138, v101
    v_pk_add_f32 v[140:141], v[140:141], v[150:151] op_sel_hi:[1,0] neg_lo:[0,1] neg_hi:[0,1]
    v_cvt_pk_bf16_f32 v140, 0, v140
    v_cvt_pk_bf16_f32 v141, 0, v141
    v_pk_mul_f32 v[140:141], v[140:141], v[150:151] op_sel:[0,1]
    v_cvt_pk_bf16_f32 v140, v140, v141
    v_dot2c_f32_bf16 v144, v140, v102
    v_pk_add_f32 v[142:143], v[142:143], v[150:151] op_sel_hi:[1,0] neg_lo:[0,1] neg_hi:[0,1]
    v_cvt_pk_bf16_f32 v142, 0, v142
    v_cvt_pk_bf16_f32 v143, 0, v143
    v_pk_mul_f32 v[142:143], v[142:143], v[150:151] op_sel:[0,1]
    v_cvt_pk_bf16_f32 v142, v142, v143
    v_dot2c_f32_bf16 v145, v142, v103
    s_nop 2
    v_add_f32 v144, v144, v145
    s_nop 0
    s_nop 0
    v_add_f32_dpp v144, v144, v144 quad_perm:[1,0,3,2] row_mask:0xf bank_mask:0xf
    s_nop 0
    s_nop 0
    v_add_f32_dpp v144, v144, v144 row_ror:8 row_mask:0xf bank_mask:0xf
    v_mov_b32 v148, v144
    s_nop 0
    s_nop 0
    v_permlane16_swap_b32 v144, v148
    s_nop 0
    s_nop 0
    v_add_f32 v144, v144, v148
    v_mov_b32 v148, v144
    s_nop 0
    s_nop 0
    v_permlane32_swap_b32 v144, v148
    s_nop 0
    s_nop 0
    v_add_f32 v144, v144, v148
    v_cvt_pk_bf16_f32 v144, 0, v144
    v_ashrrev_i32 v146, 31, v144
    v_or_b32 v146, 0x80000000, v146
    v_xor_b32 v144, v144, v146
    v_and_b32 v144, s42, v144
    v_sub_u32 v146, 2047, v240
    v_or_b32 v144, v144, v146
    s_cmp_lt_u32 s3, 2
    s_cselect_b32 s56, -1, 0
    v_and_b32 v144, s56, v144
    v_mov_b32 v34, s7
    v_mov_b32 v35, s7
    v_max_u32_dpp v32, v144, v144 quad_perm:[2,3,0,1] row_mask:0xf bank_mask:0xf
    v_min_u32_dpp v33, v144, v144 quad_perm:[2,3,0,1] row_mask:0xf bank_mask:0xf
    s_nop 0
    v_min_u32_dpp v146, v32, v32 row_ror:4 row_mask:0xf bank_mask:0xf
    v_max_u32_dpp v33, v33, v33 row_ror:4 row_mask:0xf bank_mask:0xf
    v_max_u32_dpp v32, v32, v32 row_ror:4 row_mask:0xf bank_mask:0xf
    v_max_u32 v33, v33, v146
    s_waitcnt vmcnt(8)
head_code:
    s_waitcnt vmcnt(26)
    s_barrier
    ds_read_b64_tr_b16 a[224:225], v8 offset:0
    ds_read_b64_tr_b16 a[226:227], v8 offset:6144
    ds_read_b64_tr_b16 a[228:229], v8 offset:12288
    ds_read_b64_tr_b16 a[230:231], v8 offset:18432
    ds_read_b64_tr_b16 a[232:233], v9 offset:0
    ds_read_b64_tr_b16 a[234:235], v9 offset:6144
    ds_read_b64_tr_b16 a[236:237], v9 offset:12288
    ds_read_b64_tr_b16 a[238:239], v9 offset:18432
    ds_read_b64_tr_b16 a[240:241], v10 offset:0
    ds_read_b64_tr_b16 a[242:243], v10 offset:6144
    ds_read_b64_tr_b16 a[244:245], v10 offset:12288
    ds_read_b64_tr_b16 a[246:247], v10 offset:18432
    s_waitcnt vmcnt(7) lgkmcnt(10)
    v_mfma_f32_16x16x32_bf16 v[64:67], a[224:227], a[160:163], 0
    s_waitcnt vmcnt(2) lgkmcnt(8)
    v_min_u32 v36, 1, v1
    v_lshlrev_b32 v36, 30, v36
    v_mfma_f32_16x16x32_bf16 v[64:67], a[228:231], a[176:179], v[64:67]
    s_add_u32 s46, s45, 8192
    v_and_b32 v37, 31, v1
    v_lshlrev_b32 v37, 2, v37
    v_mfma_f32_16x16x32_bf16 v[72:75], a[228:231], a[180:183], 0
    s_waitcnt vmcnt(1)
    v_mov_b32 v38, 0
    s_sub_u32 s77, s46, 81920
    v_mfma_f32_16x16x32_bf16 v[72:75], a[224:227], a[164:167], v[72:75]
    s_waitcnt vmcnt(0)
    s_min_u32 s46, s46, s77
    s_xor_b32 s77, s46, 1024
    v_mfma_f32_16x16x32_bf16 v[80:83], a[224:227], a[168:171], 0
    buffer_load_dwordx4 a[96:99], v14, s[20:23], s46 offen sc1
    v_mfma_f32_16x16x32_bf16 v[80:83], a[228:231], a[184:187], v[80:83]
    s_lshl2_add_u32 s6, s2, s3
    s_lshl_b32 s6, s6, 4
    s_add_u32 s6, s6, 3162112
    v_mfma_f32_16x16x32_bf16 v[88:91], a[228:231], a[188:191], 0
    s_waitcnt lgkmcnt(0)
    s_lshl2_add_u32 s93, s2, s3
    s_lshl_b32 s93, s93, 7
    v_mfma_f32_16x16x32_bf16 v[88:91], a[224:227], a[172:175], v[88:91]
    s_add_u32 s93, s93, 4194304
    ds_read_b64_tr_b16 a[224:225], v11 offset:0
    v_mfma_f32_16x16x32_bf16 v[92:95], a[232:235], a[172:175], 0
    buffer_store_dword v38, v37, s[24:27], s93 offen sc1
    v_mfma_f32_16x16x32_bf16 v[92:95], a[236:239], a[188:191], v[92:95]
    buffer_load_dwordx4 a[100:103], v14, s[20:23], s77 offen sc1
    v_mfma_f32_16x16x32_bf16 v[84:87], a[236:239], a[184:187], 0
    s_mul_i32 s56, s50, 786432
    ds_read_b64_tr_b16 a[226:227], v11 offset:6144
    v_mul_u32_u24 v56, 3072, v5
    v_mfma_f32_16x16x32_bf16 v[84:87], a[232:235], a[168:171], v[84:87]
    s_add_u32 s56, s56, 589824
    ds_read_b64_tr_b16 a[228:229], v11 offset:12288
    v_add_u32 v56, v56, v7
    v_mfma_f32_16x16x32_bf16 v[76:79], a[232:235], a[164:167], 0
    s_add_u32 s12, s66, s56
    s_addc_u32 s13, s67, 0
    v_add_u32 v57, 49152, v56
    v_mfma_f32_16x16x32_bf16 v[76:79], a[236:239], a[180:183], v[76:79]
    s_and_b32 s13, s13, 0xffff
    ds_read_b64_tr_b16 a[230:231], v11 offset:18432
    v_lshrrev_b32 v29, 3, v1
    v_mfma_f32_16x16x32_bf16 v[68:71], a[236:239], a[176:179], 0
    buffer_load_dwordx4 a[104:107], v15, s[20:23], s46 offen sc1
    v_mfma_f32_16x16x32_bf16 v[68:71], a[232:235], a[160:163], v[68:71]
    s_mov_b32 s14, 196608
    ds_read_b64_tr_b16 a[232:233], v8 offset:1024
    v_mul_u32_u24 v31, 384, v29
    v_mfma_f32_16x16x32_bf16 v[96:99], a[240:243], a[160:163], 0
    s_mov_b32 s15, 0x00020000
    ds_read_b64_tr_b16 a[234:235], v8 offset:7168
    v_add_u32 v6, v31, v7
    v_mfma_f32_16x16x32_bf16 v[96:99], a[244:247], a[176:179], v[96:99]
    s_add_u32 s16, s68, s56
    s_addc_u32 s17, s69, 0
    v_bfe_u32 v29, v1, 4, 1
    v_mfma_f32_16x16x32_bf16 v[104:107], a[244:247], a[180:183], 0
    s_and_b32 s17, s17, 0xffff
    ds_read_b64_tr_b16 a[236:237], v8 offset:13312
    v_bfe_u32 v30, v1, 5, 1
    v_mfma_f32_16x16x32_bf16 v[104:107], a[240:243], a[164:167], v[104:107]
    s_mov_b32 s18, 196608
    ds_read_b64_tr_b16 a[238:239], v8 offset:19456
    v_lshl_add_u32 v29, v29, 1, v30
    v_mfma_f32_16x16x32_bf16 v[112:115], a[240:243], a[168:171], 0
    buffer_load_dwordx4 a[108:111], v15, s[20:23], s77 offen sc1
    v_mfma_f32_16x16x32_bf16 v[112:115], a[244:247], a[184:187], v[112:115]
    s_waitcnt lgkmcnt(4)
    v_and_b32 v30, 7, v1
    v_xor_b32 v30, v30, v29
    v_mfma_f32_16x16x32_bf16 v[120:123], a[244:247], a[188:191], 0
    s_add_u32 s46, s45, 12288
    v_lshl_add_u32 v4, v30, 4, v31
    v_xor_b32 v30, 4, v30
    v_mfma_f32_16x16x32_bf16 v[120:123], a[240:243], a[172:175], v[120:123]
    s_sub_u32 s77, s46, 81920
    ds_read_b64_tr_b16 a[240:241], v9 offset:1024
    v_lshl_add_u32 v5, v30, 4, v31
    v_mfma_f32_16x16x32_bf16 v[124:127], a[224:227], a[172:175], 0
    s_min_u32 s46, s46, s77
    ds_read_b64_tr_b16 a[242:243], v9 offset:7168
    v_add_u32 v5, 3072, v5
    v_mfma_f32_16x16x32_bf16 v[124:127], a[228:231], a[188:191], v[124:127]
    s_xor_b32 s77, s46, 1024
    ds_read_b64_tr_b16 a[244:245], v9 offset:13312
    v_bfe_u32 v30, v1, 1, 1
    v_mfma_f32_16x16x32_bf16 v[116:119], a[228:231], a[184:187], 0
    buffer_load_dwordx4 a[112:115], v14, s[20:23], s46 offen sc1
    v_mfma_f32_16x16x32_bf16 v[116:119], a[224:227], a[168:171], v[116:119]
    s_mov_b32 s19, 0x00020000
    ds_read_b64_tr_b16 a[246:247], v9 offset:19456
    v_bfe_u32 v31, v1, 2, 1
    v_mfma_f32_16x16x32_bf16 v[108:111], a[224:227], a[164:167], 0
    s_mov_b32 s28, s78
    v_lshl_add_u32 v30, v30, 1, v31
    v_bfe_u32 v31, v1, 3, 1
    v_mfma_f32_16x16x32_bf16 v[108:111], a[228:231], a[180:183], v[108:111]
    s_waitcnt lgkmcnt(4)
    v_lshl_add_u32 v30, v31, 2, v30
    v_xor_b32 v30, v30, v29
    v_mfma_f32_16x16x32_bf16 v[100:103], a[228:231], a[176:179], 0
    s_and_b32 s29, s79, 0xffff
    v_lshlrev_b32 v30, 4, v30
    v_mul_u32_u24 v31, 3072, v31
    v_mfma_f32_16x16x32_bf16 v[100:103], a[224:227], a[160:163], v[100:103]
    s_mov_b32 s30, 1966080
    ds_read_b64_tr_b16 a[224:225], v10 offset:1024
    v_and_b32 v29, 7, v1
    v_mfma_f32_16x16x32_bf16 v[128:131], a[232:235], a[160:163], 0
    buffer_load_dwordx4 a[116:119], v14, s[20:23], s77 offen sc1
    v_mfma_f32_16x16x32_bf16 v[128:131], a[236:239], a[176:179], v[128:131]
    s_mov_b32 s31, 0x00020000
    ds_read_b64_tr_b16 a[226:227], v10 offset:7168
    v_lshl_add_u32 v31, v29, 7, v31
    v_mfma_f32_16x16x32_bf16 v[136:139], a[236:239], a[180:183], 0
    s_mov_b32 s32, s80
    ds_read_b64_tr_b16 a[228:229], v10 offset:13312
    v_add_u32 v12, v31, v30
    v_mfma_f32_16x16x32_bf16 v[136:139], a[232:235], a[164:167], v[136:139]
    s_and_b32 s33, s81, 0xffff
    ds_read_b64_tr_b16 a[230:231], v10 offset:19456
    v_xor_b32 v30, 64, v30
    v_mfma_f32_16x16x32_bf16 v[144:147], a[232:235], a[168:171], 0
    s_mov_b32 s34, 1966080
    v_add_u32 v13, v31, v30
    v_lshrrev_b32 v19, 5, v1
    v_mfma_f32_16x16x32_bf16 v[144:147], a[236:239], a[184:187], v[144:147]
    s_waitcnt lgkmcnt(4)
    v_lshlrev_b32 v19, 11, v19
    v_sub_u32 v19, 0xffffa000, v19
    v_mfma_f32_16x16x32_bf16 v[152:155], a[236:239], a[188:191], 0
    buffer_load_dwordx4 a[120:123], v15, s[20:23], s46 offen sc1
    v_mfma_f32_16x16x32_bf16 v[152:155], a[232:235], a[172:175], v[152:155]
    s_mov_b32 s35, 0x00020000
    ds_read_b64_tr_b16 a[232:233], v11 offset:1024
    s_min_u32 s58, s2, 239
    v_mfma_f32_16x16x32_bf16 v[156:159], a[240:243], a[172:175], 0
    s_mul_hi_u32 s56, s58, 178956971
    ds_read_b64_tr_b16 a[234:235], v11 offset:7168
    s_mul_i32 s57, s56, 24
    v_mfma_f32_16x16x32_bf16 v[156:159], a[244:247], a[188:191], v[156:159]
    s_sub_u32 s57, s58, s57
    ds_read_b64_tr_b16 a[236:237], v11 offset:13312
    s_lshl_b32 s60, s56, 6
    v_mfma_f32_16x16x32_bf16 v[148:151], a[244:247], a[184:187], 0
    s_add_u32 s60, s60, s59
    ds_read_b64_tr_b16 a[238:239], v11 offset:19456
    s_mul_i32 s60, s60, 3072
    v_mfma_f32_16x16x32_bf16 v[148:151], a[240:243], a[168:171], v[148:151]
    s_lshl_b32 s44, s57, 7
    s_add_u32 s60, s60, s44
    s_lshl_b32 s61, s56, 7
    v_mfma_f32_16x16x32_bf16 v[140:143], a[240:243], a[164:167], 0
    buffer_load_dwordx4 a[124:127], v15, s[20:23], s77 offen sc1
    v_mfma_f32_16x16x32_bf16 v[140:143], a[244:247], a[180:183], v[140:143]
    s_waitcnt lgkmcnt(4)
    s_add_u32 m0, s49, 122880
    s_mul_i32 s62, s56, 1536
    v_mfma_f32_16x16x32_bf16 v[132:135], a[244:247], a[176:179], 0
    s_lshl_b32 s44, s57, 6
    s_add_u32 s62, s62, s44
    s_lshl_b32 s44, s3, 4
    v_mfma_f32_16x16x32_bf16 v[132:135], a[240:243], a[160:163], v[132:135]
    s_add_u32 s62, s62, s44
    ds_read_b64_tr_b16 a[240:241], v8 offset:2048
    s_lshl_b32 s62, s62, 4
    v_mfma_f32_16x16x32_bf16 v[160:163], a[224:227], a[160:163], 0
    s_add_u32 s62, s62, 3276800
    ds_read_b64_tr_b16 a[242:243], v8 offset:8192
    s_lshl_b32 s4, s2, 8
    v_mfma_f32_16x16x32_bf16 v[160:163], a[228:231], a[176:179], v[160:163]
    s_lshl_b32 s44, s3, 2
    ds_read_b64_tr_b16 a[244:245], v8 offset:14336
    s_add_u32 s4, s4, s44
    v_mfma_f32_16x16x32_bf16 v[168:171], a[228:231], a[180:183], 0
    buffer_load_dwordx4 v2, s[8:11], s36 offen offset:0 lds
    v_mfma_f32_16x16x32_bf16 v[168:171], a[224:227], a[164:167], v[168:171]
    s_addk_i32 m0, 896
    ds_read_b64_tr_b16 a[246:247], v8 offset:20480
    s_add_u32 s4, s4, 3932160
    v_mfma_f32_16x16x32_bf16 v[176:179], a[224:227], a[168:171], 0
    s_lshl_b32 s5, s52, 3
    s_add_u32 s5, s5, s53
    s_lshl_b32 s5, s5, 2
    v_mfma_f32_16x16x32_bf16 v[176:179], a[228:231], a[184:187], v[176:179]
    s_waitcnt lgkmcnt(4)
    s_add_u32 s5, s5, s3
    s_lshl_b32 s5, s5, 7
    v_mfma_f32_16x16x32_bf16 v[184:187], a[228:231], a[188:191], 0
    s_add_u32 s5, s5, 4096000
    s_lshl_b32 s76, s51, 2
    s_add_u32 s76, s76, s5
    v_mfma_f32_16x16x32_bf16 v[184:187], a[224:227], a[172:175], v[184:187]
    s_mov_b32 s92, 0xbfb8aa3b
    ds_read_b64_tr_b16 a[224:225], v9 offset:2048
    s_lshl_b32 s44, s3, 12
    v_mfma_f32_16x16x32_bf16 v[188:191], a[232:235], a[172:175], 0
    buffer_load_dwordx4 v2, s[8:11], s36 offen offset:128 lds
    v_mfma_f32_16x16x32_bf16 v[188:191], a[236:239], a[188:191], v[188:191]
    s_addk_i32 m0, 896
    ds_read_b64_tr_b16 a[226:227], v9 offset:8192
    s_mov_b32 s38, s49
    v_mfma_f32_16x16x32_bf16 v[180:183], a[236:239], a[184:187], 0
    s_mul_i32 s40, s3, 3072
    ds_read_b64_tr_b16 a[228:229], v9 offset:14336
    s_mov_b32 s47, 3162112
    v_mfma_f32_16x16x32_bf16 v[180:183], a[232:235], a[168:171], v[180:183]
    s_lshl_b32 s63, s3, 10
    ds_read_b64_tr_b16 a[230:231], v9 offset:20480
    v_mfma_f32_16x16x32_bf16 v[172:175], a[232:235], a[164:167], 0
    s_mov_b32 s80, 0xffffff01
    v_mfma_f32_16x16x32_bf16 v[172:175], a[236:239], a[180:183], v[172:175]
    s_waitcnt lgkmcnt(4)
    v_mfma_f32_16x16x32_bf16 v[164:167], a[236:239], a[176:179], 0
    buffer_load_dwordx4 v2, s[8:11], s36 offen offset:256 lds
    v_mfma_f32_16x16x32_bf16 v[164:167], a[232:235], a[160:163], v[164:167]
    s_addk_i32 m0, 1280
    ds_read_b64_tr_b16 a[232:233], v10 offset:2048
    v_mfma_f32_16x16x32_bf16 v[192:195], a[240:243], a[160:163], 0
    ds_read_b64_tr_b16 a[234:235], v10 offset:8192
    v_mfma_f32_16x16x32_bf16 v[192:195], a[244:247], a[176:179], v[192:195]
    ds_read_b64_tr_b16 a[236:237], v10 offset:14336
    v_mfma_f32_16x16x32_bf16 v[200:203], a[244:247], a[180:183], 0
    ds_read_b64_tr_b16 a[238:239], v10 offset:20480
    v_mfma_f32_16x16x32_bf16 v[200:203], a[240:243], a[164:167], v[200:203]
    v_mfma_f32_16x16x32_bf16 v[208:211], a[240:243], a[168:171], 0
    buffer_load_dwordx4 v3, s[8:11], s36 offen offset:0 lds
    v_mfma_f32_16x16x32_bf16 v[208:211], a[244:247], a[184:187], v[208:211]
    s_waitcnt lgkmcnt(4)
    s_addk_i32 m0, 896
    v_mfma_f32_16x16x32_bf16 v[216:219], a[244:247], a[188:191], 0
    v_mfma_f32_16x16x32_bf16 v[216:219], a[240:243], a[172:175], v[216:219]
    ds_read_b64_tr_b16 a[240:241], v11 offset:2048
    ds_read_b64_tr_b16 a[242:243], v11 offset:8192
    ds_read_b64_tr_b16 a[244:245], v11 offset:14336
    v_mfma_f32_16x16x32_bf16 v[220:223], a[224:227], a[172:175], 0
    ds_read_b64_tr_b16 a[246:247], v11 offset:20480
    v_mfma_f32_16x16x32_bf16 v[220:223], a[228:231], a[188:191], v[220:223]
    v_mfma_f32_16x16x32_bf16 v[212:215], a[228:231], a[184:187], 0
    buffer_load_dwordx4 v3, s[8:11], s36 offen offset:128 lds
    s_cmp_lg_u32 s3, 0
    s_cselect_b64 exec, -1, 0
    s_cbranch_execz pg_last
pg_back2:
    s_mov_b64 exec, -1
    v_mfma_f32_16x16x32_bf16 v[212:215], a[224:227], a[168:171], v[212:215]
    s_addk_i32 m0, 896
    v_mfma_f32_16x16x32_bf16 v[204:207], a[224:227], a[164:167], 0
    v_mfma_f32_16x16x32_bf16 v[204:207], a[228:231], a[180:183], v[204:207]
    s_waitcnt lgkmcnt(4)
    v_mfma_f32_16x16x32_bf16 v[196:199], a[228:231], a[176:179], 0
    s_waitcnt lgkmcnt(0)
    s_barrier
    v_mfma_f32_16x16x32_bf16 v[196:199], a[224:227], a[160:163], v[196:199]
    s_waitcnt vmcnt(12)
    ds_read_b64_tr_b16 a[224:225], v8 offset:24576
    v_mfma_f32_16x16x32_bf16 v[224:227], a[232:235], a[160:163], 0
    buffer_store_dwordx4 v[32:35], v36, s[24:27], s6 offen sc1
    v_mfma_f32_16x16x32_bf16 v[224:227], a[236:239], a[176:179], v[224:227]
    buffer_load_dwordx4 v3, s[8:11], s36 offen offset:256 lds
    v_mfma_f32_16x16x32_bf16 v[232:235], a[236:239], a[180:183], 0
    s_add_u32 s36, s36, s37
    ds_read_b64_tr_b16 a[226:227], v8 offset:30720
    s_sub_u32 s55, s36, 7864320
    v_mfma_f32_16x16x32_bf16 v[232:235], a[232:235], a[164:167], v[232:235]
    s_min_u32 s36, s36, s55
    ds_read_b64_tr_b16 a[228:229], v8 offset:36864
    s_add_u32 m0, s49, 0
    v_mfma_f32_16x16x32_bf16 v[240:243], a[232:235], a[168:171], 0
    ds_read_b64_tr_b16 a[230:231], v8 offset:43008
    v_mfma_f32_16x16x32_bf16 v[240:243], a[236:239], a[184:187], v[240:243]
    v_mfma_f32_16x16x32_bf16 v[248:251], a[236:239], a[188:191], 0
    buffer_load_dwordx4 v2, s[8:11], s36 offen offset:0 lds
    v_mfma_f32_16x16x32_bf16 v[248:251], a[232:235], a[172:175], v[248:251]
    s_addk_i32 m0, 896
    ds_read_b64_tr_b16 a[232:233], v9 offset:24576
    v_mfma_f32_16x16x32_bf16 v[252:255], a[240:243], a[172:175], 0
    ds_read_b64_tr_b16 a[234:235], v9 offset:30720
    v_mfma_f32_16x16x32_bf16 v[252:255], a[244:247], a[188:191], v[252:255]
    ds_read_b64_tr_b16 a[236:237], v9 offset:36864
    v_mfma_f32_16x16x32_bf16 v[244:247], a[244:247], a[184:187], 0
    ds_read_b64_tr_b16 a[238:239], v9 offset:43008
    v_mfma_f32_16x16x32_bf16 v[244:247], a[240:243], a[168:171], v[244:247]
    v_mfma_f32_16x16x32_bf16 v[236:239], a[240:243], a[164:167], 0
    buffer_load_dwordx4 v2, s[8:11], s36 offen offset:128 lds
    v_mfma_f32_16x16x32_bf16 v[236:239], a[244:247], a[180:183], v[236:239]
    s_waitcnt lgkmcnt(4)
    s_addk_i32 m0, 896
    v_mfma_f32_16x16x32_bf16 v[228:231], a[244:247], a[176:179], 0
    s_waitcnt vmcnt(12)
    v_mfma_f32_16x16x32_bf16 v[228:231], a[240:243], a[160:163], v[228:231]
    s_waitcnt vmcnt(11)
    ds_read_b64_tr_b16 a[240:241], v10 offset:24576
    v_mfma_f32_16x16x32_bf16 v[64:67], a[224:227], a[96:99], v[64:67]
    ds_read_b64_tr_b16 a[242:243], v10 offset:30720
    v_mfma_f32_16x16x32_bf16 v[64:67], a[228:231], a[112:115], v[64:67]
    ds_read_b64_tr_b16 a[244:245], v10 offset:36864
    v_mfma_f32_16x16x32_bf16 v[72:75], a[228:231], a[116:119], v[72:75]
    buffer_load_dwordx4 v2, s[8:11], s36 offen offset:256 lds
    v_mfma_f32_16x16x32_bf16 v[72:75], a[224:227], a[100:103], v[72:75]
    s_waitcnt vmcnt(10)
    ds_read_b64_tr_b16 a[246:247], v10 offset:43008
    s_addk_i32 m0, 1280
    v_mfma_f32_16x16x32_bf16 v[80:83], a[224:227], a[104:107], v[80:83]
    v_mfma_f32_16x16x32_bf16 v[80:83], a[228:231], a[120:123], v[80:83]
    s_waitcnt lgkmcnt(4)
    v_mfma_f32_16x16x32_bf16 v[88:91], a[228:231], a[124:127], v[88:91]
    v_mfma_f32_16x16x32_bf16 v[88:91], a[224:227], a[108:111], v[88:91]
    ds_read_b64_tr_b16 a[224:225], v11 offset:24576
    v_mfma_f32_16x16x32_bf16 v[92:95], a[232:235], a[108:111], v[92:95]
    buffer_load_dwordx4 v3, s[8:11], s36 offen offset:0 lds
    v_mfma_f32_16x16x32_bf16 v[92:95], a[236:239], a[124:127], v[92:95]
    s_addk_i32 m0, 896
    ds_read_b64_tr_b16 a[226:227], v11 offset:30720
    v_mfma_f32_16x16x32_bf16 v[84:87], a[236:239], a[120:123], v[84:87]
    ds_read_b64_tr_b16 a[228:229], v11 offset:36864
    v_mfma_f32_16x16x32_bf16 v[84:87], a[232:235], a[104:107], v[84:87]
    ds_read_b64_tr_b16 a[230:231], v11 offset:43008
    v_mfma_f32_16x16x32_bf16 v[76:79], a[232:235], a[100:103], v[76:79]
    v_mfma_f32_16x16x32_bf16 v[76:79], a[236:239], a[116:119], v[76:79]
    s_waitcnt lgkmcnt(4)
    v_mfma_f32_16x16x32_bf16 v[68:71], a[236:239], a[112:115], v[68:71]
    buffer_load_dwordx4 v3, s[8:11], s36 offen offset:128 lds
    v_mfma_f32_16x16x32_bf16 v[68:71], a[232:235], a[96:99], v[68:71]
    s_addk_i32 m0, 896
    ds_read_b64_tr_b16 a[232:233], v8 offset:25600
    v_mfma_f32_16x16x32_bf16 v[96:99], a[240:243], a[96:99], v[96:99]
    ds_read_b64_tr_b16 a[234:235], v8 offset:31744
    v_mfma_f32_16x16x32_bf16 v[96:99], a[244:247], a[112:115], v[96:99]
    ds_read_b64_tr_b16 a[236:237], v8 offset:37888
    v_mfma_f32_16x16x32_bf16 v[104:107], a[244:247], a[116:119], v[104:107]
    ds_read_b64_tr_b16 a[238:239], v8 offset:44032
    v_mfma_f32_16x16x32_bf16 v[104:107], a[240:243], a[100:103], v[104:107]
    v_mfma_f32_16x16x32_bf16 v[112:115], a[240:243], a[104:107], v[112:115]
    buffer_load_dwordx4 v3, s[8:11], s36 offen offset:256 lds
    v_mfma_f32_16x16x32_bf16 v[112:115], a[244:247], a[120:123], v[112:115]
    s_waitcnt lgkmcnt(4)
    s_add_u32 s36, s36, s37
    s_sub_u32 s55, s36, 7864320
    v_mfma_f32_16x16x32_bf16 v[120:123], a[244:247], a[124:127], v[120:123]
    s_min_u32 s36, s36, s55
    s_add_u32 s46, s45, 16384
    s_sub_u32 s77, s46, 81920
    v_mfma_f32_16x16x32_bf16 v[120:123], a[240:243], a[108:111], v[120:123]
    s_min_u32 s46, s46, s77
    ds_read_b64_tr_b16 a[240:241], v9 offset:25600
    s_xor_b32 s77, s46, 1024
    v_mfma_f32_16x16x32_bf16 v[124:127], a[224:227], a[108:111], v[124:127]
    ds_read_b64_tr_b16 a[242:243], v9 offset:31744
    v_mfma_f32_16x16x32_bf16 v[124:127], a[228:231], a[124:127], v[124:127]
    ds_read_b64_tr_b16 a[244:245], v9 offset:37888
    v_mfma_f32_16x16x32_bf16 v[116:119], a[228:231], a[120:123], v[116:119]
    buffer_load_dwordx4 a[128:131], v14, s[20:23], s46 offen sc1
    v_mfma_f32_16x16x32_bf16 v[116:119], a[224:227], a[104:107], v[116:119]
    ds_read_b64_tr_b16 a[246:247], v9 offset:44032
    v_mfma_f32_16x16x32_bf16 v[108:111], a[224:227], a[100:103], v[108:111]
    v_mfma_f32_16x16x32_bf16 v[108:111], a[228:231], a[116:119], v[108:111]
    s_waitcnt lgkmcnt(4)
    v_mfma_f32_16x16x32_bf16 v[100:103], a[228:231], a[112:115], v[100:103]
    v_mfma_f32_16x16x32_bf16 v[100:103], a[224:227], a[96:99], v[100:103]
    ds_read_b64_tr_b16 a[224:225], v10 offset:25600
    v_mfma_f32_16x16x32_bf16 v[128:131], a[232:235], a[96:99], v[128:131]
    buffer_load_dwordx4 a[132:135], v14, s[20:23], s77 offen sc1
    v_mfma_f32_16x16x32_bf16 v[128:131], a[236:239], a[112:115], v[128:131]
    ds_read_b64_tr_b16 a[226:227], v10 offset:31744
    v_mfma_f32_16x16x32_bf16 v[136:139], a[236:239], a[116:119], v[136:139]
    ds_read_b64_tr_b16 a[228:229], v10 offset:37888
    v_mfma_f32_16x16x32_bf16 v[136:139], a[232:235], a[100:103], v[136:139]
    ds_read_b64_tr_b16 a[230:231], v10 offset:44032
    v_mfma_f32_16x16x32_bf16 v[144:147], a[232:235], a[104:107], v[144:147]
    v_mfma_f32_16x16x32_bf16 v[144:147], a[236:239], a[120:123], v[144:147]
    s_waitcnt lgkmcnt(4)
    v_mfma_f32_16x16x32_bf16 v[152:155], a[236:239], a[124:127], v[152:155]
    buffer_load_dwordx4 a[136:139], v15, s[20:23], s46 offen sc1
    v_mfma_f32_16x16x32_bf16 v[152:155], a[232:235], a[108:111], v[152:155]
    ds_read_b64_tr_b16 a[232:233], v11 offset:25600
    v_mfma_f32_16x16x32_bf16 v[156:159], a[240:243], a[108:111], v[156:159]
    ds_read_b64_tr_b16 a[234:235], v11 offset:31744
    v_mfma_f32_16x16x32_bf16 v[156:159], a[244:247], a[124:127], v[156:159]
    ds_read_b64_tr_b16 a[236:237], v11 offset:37888
    v_mfma_f32_16x16x32_bf16 v[148:151], a[244:247], a[120:123], v[148:151]
    ds_read_b64_tr_b16 a[238:239], v11 offset:44032
    v_mfma_f32_16x16x32_bf16 v[148:151], a[240:243], a[104:107], v[148:151]
    v_mfma_f32_16x16x32_bf16 v[140:143], a[240:243], a[100:103], v[140:143]
    buffer_load_dwordx4 a[140:143], v15, s[20:23], s77 offen sc1
    v_mfma_f32_16x16x32_bf16 v[140:143], a[244:247], a[116:119], v[140:143]
    s_waitcnt lgkmcnt(4)
    s_add_u32 s46, s45, 20480
    s_sub_u32 s77, s46, 81920
    v_mfma_f32_16x16x32_bf16 v[132:135], a[244:247], a[112:115], v[132:135]
    s_min_u32 s46, s46, s77
    s_xor_b32 s77, s46, 1024
    v_mfma_f32_16x16x32_bf16 v[132:135], a[240:243], a[96:99], v[132:135]
    ds_read_b64_tr_b16 a[240:241], v8 offset:26624
    v_mfma_f32_16x16x32_bf16 v[160:163], a[224:227], a[96:99], v[160:163]
    ds_read_b64_tr_b16 a[242:243], v8 offset:32768
    v_mfma_f32_16x16x32_bf16 v[160:163], a[228:231], a[112:115], v[160:163]
    ds_read_b64_tr_b16 a[244:245], v8 offset:38912
    v_mfma_f32_16x16x32_bf16 v[168:171], a[228:231], a[116:119], v[168:171]
    buffer_load_dwordx4 a[144:147], v14, s[20:23], s46 offen sc1
    v_mfma_f32_16x16x32_bf16 v[168:171], a[224:227], a[100:103], v[168:171]
    ds_read_b64_tr_b16 a[246:247], v8 offset:45056
    v_mfma_f32_16x16x32_bf16 v[176:179], a[224:227], a[104:107], v[176:179]
    v_add_u32 v8, 49152, v8
    v_mfma_f32_16x16x32_bf16 v[176:179], a[228:231], a[120:123], v[176:179]
    s_waitcnt lgkmcnt(4)
    v_mfma_f32_16x16x32_bf16 v[184:187], a[228:231], a[124:127], v[184:187]
    v_mfma_f32_16x16x32_bf16 v[184:187], a[224:227], a[108:111], v[184:187]
    ds_read_b64_tr_b16 a[224:225], v9 offset:26624
    v_mfma_f32_16x16x32_bf16 v[188:191], a[232:235], a[108:111], v[188:191]
    buffer_load_dwordx4 a[148:151], v14, s[20:23], s77 offen sc1
    v_mfma_f32_16x16x32_bf16 v[188:191], a[236:239], a[124:127], v[188:191]
    ds_read_b64_tr_b16 a[226:227], v9 offset:32768
    v_mfma_f32_16x16x32_bf16 v[180:183], a[236:239], a[120:123], v[180:183]
    ds_read_b64_tr_b16 a[228:229], v9 offset:38912
    v_mfma_f32_16x16x32_bf16 v[180:183], a[232:235], a[104:107], v[180:183]
    ds_read_b64_tr_b16 a[230:231], v9 offset:45056
    v_mfma_f32_16x16x32_bf16 v[172:175], a[232:235], a[100:103], v[172:175]
    v_add_u32 v9, 49152, v9
    v_mfma_f32_16x16x32_bf16 v[172:175], a[236:239], a[116:119], v[172:175]
    s_waitcnt lgkmcnt(4)
    v_mfma_f32_16x16x32_bf16 v[164:167], a[236:239], a[112:115], v[164:167]
    buffer_load_dwordx4 a[152:155], v15, s[20:23], s46 offen sc1
    v_mfma_f32_16x16x32_bf16 v[164:167], a[232:235], a[96:99], v[164:167]
    ds_read_b64_tr_b16 a[232:233], v10 offset:26624
    v_mfma_f32_16x16x32_bf16 v[192:195], a[240:243], a[96:99], v[192:195]
    ds_read_b64_tr_b16 a[234:235], v10 offset:32768
    v_mfma_f32_16x16x32_bf16 v[192:195], a[244:247], a[112:115], v[192:195]
    ds_read_b64_tr_b16 a[236:237], v10 offset:38912
    v_mfma_f32_16x16x32_bf16 v[200:203], a[244:247], a[116:119], v[200:203]
    ds_read_b64_tr_b16 a[238:239], v10 offset:45056
    v_mfma_f32_16x16x32_bf16 v[200:203], a[240:243], a[100:103], v[200:203]
    v_add_u32 v10, 49152, v10
    v_mfma_f32_16x16x32_bf16 v[208:211], a[240:243], a[104:107], v[208:211]
pg_1:
    s_cbranch_execz pg_5
    buffer_load_dwordx4 a[156:159], v15, s[20:23], s77 offen sc1
    v_mfma_f32_16x16x32_bf16 v[208:211], a[244:247], a[120:123], v[208:211]
    s_waitcnt lgkmcnt(4)
    s_addk_i32 m0, 19712
    v_mfma_f32_16x16x32_bf16 v[216:219], a[244:247], a[124:127], v[216:219]
    v_mfma_f32_16x16x32_bf16 v[216:219], a[240:243], a[108:111], v[216:219]
    ds_read_b64_tr_b16 a[240:241], v11 offset:26624
    ds_read_b64_tr_b16 a[242:243], v11 offset:32768
    ds_read_b64_tr_b16 a[244:245], v11 offset:38912
    v_mfma_f32_16x16x32_bf16 v[220:223], a[224:227], a[108:111], v[220:223]
    ds_read_b64_tr_b16 a[246:247], v11 offset:45056
    v_mfma_f32_16x16x32_bf16 v[220:223], a[228:231], a[124:127], v[220:223]
    v_add_u32 v11, 49152, v11
    v_mfma_f32_16x16x32_bf16 v[212:215], a[228:231], a[120:123], v[212:215]
    buffer_load_dwordx4 v2, s[8:11], s36 offen offset:0 lds
    v_mfma_f32_16x16x32_bf16 v[212:215], a[224:227], a[104:107], v[212:215]
    s_addk_i32 m0, 896
    v_mfma_f32_16x16x32_bf16 v[204:207], a[224:227], a[100:103], v[204:207]
    v_mfma_f32_16x16x32_bf16 v[204:207], a[228:231], a[116:119], v[204:207]
    s_waitcnt lgkmcnt(4)
    v_mfma_f32_16x16x32_bf16 v[196:199], a[228:231], a[112:115], v[196:199]
    s_waitcnt lgkmcnt(0)
    s_barrier
    v_mfma_f32_16x16x32_bf16 v[196:199], a[224:227], a[96:99], v[196:199]
    ds_read_b64_tr_b16 a[224:225], v8 offset:0
    v_mfma_f32_16x16x32_bf16 v[224:227], a[232:235], a[96:99], v[224:227]
    buffer_load_dwordx4 v2, s[8:11], s36 offen offset:128 lds
    v_mfma_f32_16x16x32_bf16 v[224:227], a[236:239], a[112:115], v[224:227]
    s_addk_i32 m0, 896
    ds_read_b64_tr_b16 a[226:227], v8 offset:6144
    v_mfma_f32_16x16x32_bf16 v[232:235], a[236:239], a[116:119], v[232:235]
    ds_read_b64_tr_b16 a[228:229], v8 offset:12288
    v_mfma_f32_16x16x32_bf16 v[232:235], a[232:235], a[100:103], v[232:235]
    ds_read_b64_tr_b16 a[230:231], v8 offset:18432
    v_mfma_f32_16x16x32_bf16 v[240:243], a[232:235], a[104:107], v[240:243]
    v_mfma_f32_16x16x32_bf16 v[240:243], a[236:239], a[120:123], v[240:243]
    v_mfma_f32_16x16x32_bf16 v[248:251], a[236:239], a[124:127], v[248:251]
    buffer_load_dwordx4 v2, s[8:11], s36 offen offset:256 lds
    v_mfma_f32_16x16x32_bf16 v[248:251], a[232:235], a[108:111], v[248:251]
    s_addk_i32 m0, 1280
    ds_read_b64_tr_b16 a[232:233], v9 offset:0
    v_mfma_f32_16x16x32_bf16 v[252:255], a[240:243], a[108:111], v[252:255]
    ds_read_b64_tr_b16 a[234:235], v9 offset:6144
    v_mfma_f32_16x16x32_bf16 v[252:255], a[244:247], a[124:127], v[252:255]
    ds_read_b64_tr_b16 a[236:237], v9 offset:12288
    v_mfma_f32_16x16x32_bf16 v[244:247], a[244:247], a[120:123], v[244:247]
    ds_read_b64_tr_b16 a[238:239], v9 offset:18432
    v_mfma_f32_16x16x32_bf16 v[244:247], a[240:243], a[104:107], v[244:247]
    v_mfma_f32_16x16x32_bf16 v[236:239], a[240:243], a[100:103], v[236:239]
    buffer_load_dwordx4 v3, s[8:11], s36 offen offset:0 lds
    v_mfma_f32_16x16x32_bf16 v[236:239], a[244:247], a[116:119], v[236:239]
    s_waitcnt vmcnt(11) lgkmcnt(4)
    s_addk_i32 m0, 896
    v_mfma_f32_16x16x32_bf16 v[228:231], a[244:247], a[112:115], v[228:231]
    s_waitcnt vmcnt(7)
    v_and_b32 v22, 1, v1
    v_mfma_f32_16x16x32_bf16 v[228:231], a[240:243], a[96:99], v[228:231]
    s_waitcnt vmcnt(6)
    ds_read_b64_tr_b16 a[240:241], v10 offset:0
    s_sub_u32 s56, s5, s4
    v_mfma_f32_16x16x32_bf16 v[64:67], a[224:227], a[128:131], v[64:67]
    s_sub_u32 s56, s56, 128
    ds_read_b64_tr_b16 a[242:243], v10 offset:6144
    v_mul_lo_u32 v22, v22, s56
    v_mfma_f32_16x16x32_bf16 v[64:67], a[228:231], a[144:147], v[64:67]
    buffer_load_dword a252, v22, s[24:27], s4 offen offset:128 sc1
    v_mfma_f32_16x16x32_bf16 v[72:75], a[228:231], a[148:151], v[72:75]
    buffer_load_dwordx4 v3, s[8:11], s36 offen offset:128 lds
    v_mfma_f32_16x16x32_bf16 v[72:75], a[224:227], a[132:135], v[72:75]
    s_waitcnt vmcnt(6)
    ds_read_b64_tr_b16 a[244:245], v10 offset:12288
    s_addk_i32 m0, 896
    v_mfma_f32_16x16x32_bf16 v[80:83], a[224:227], a[136:139], v[80:83]
    ds_read_b64_tr_b16 a[246:247], v10 offset:18432
    v_mfma_f32_16x16x32_bf16 v[80:83], a[228:231], a[152:155], v[80:83]
    s_waitcnt lgkmcnt(4)
    v_mfma_f32_16x16x32_bf16 v[88:91], a[228:231], a[156:159], v[88:91]
    v_mfma_f32_16x16x32_bf16 v[88:91], a[224:227], a[140:143], v[88:91]
    ds_read_b64_tr_b16 a[224:225], v11 offset:0
    v_mfma_f32_16x16x32_bf16 v[92:95], a[232:235], a[140:143], v[92:95]
    buffer_load_dwordx4 v3, s[8:11], s36 offen offset:256 lds
    v_mfma_f32_16x16x32_bf16 v[92:95], a[236:239], a[156:159], v[92:95]
    s_add_u32 s36, s36, s37
    ds_read_b64_tr_b16 a[226:227], v11 offset:6144
    s_sub_u32 s55, s36, 7864320
    v_mfma_f32_16x16x32_bf16 v[84:87], a[236:239], a[152:155], v[84:87]
    s_min_u32 s36, s36, s55
    ds_read_b64_tr_b16 a[228:229], v11 offset:12288
    s_add_u32 s46, s45, 24576
    v_mfma_f32_16x16x32_bf16 v[84:87], a[232:235], a[136:139], v[84:87]
    s_sub_u32 s77, s46, 81920
    ds_read_b64_tr_b16 a[230:231], v11 offset:18432
    s_min_u32 s46, s46, s77
    v_mfma_f32_16x16x32_bf16 v[76:79], a[232:235], a[132:135], v[76:79]
    s_xor_b32 s77, s46, 1024
    v_mfma_f32_16x16x32_bf16 v[76:79], a[236:239], a[148:151], v[76:79]
    s_waitcnt lgkmcnt(4)
    v_mfma_f32_16x16x32_bf16 v[68:71], a[236:239], a[144:147], v[68:71]
    buffer_load_dwordx4 a[192:195], v14, s[20:23], s46 offen sc1
    v_mfma_f32_16x16x32_bf16 v[68:71], a[232:235], a[128:131], v[68:71]
    ds_read_b64_tr_b16 a[232:233], v8 offset:1024
    v_mfma_f32_16x16x32_bf16 v[96:99], a[240:243], a[128:131], v[96:99]
    ds_read_b64_tr_b16 a[234:235], v8 offset:7168
    v_mfma_f32_16x16x32_bf16 v[96:99], a[244:247], a[144:147], v[96:99]
    ds_read_b64_tr_b16 a[236:237], v8 offset:13312
    v_mfma_f32_16x16x32_bf16 v[104:107], a[244:247], a[148:151], v[104:107]
    ds_read_b64_tr_b16 a[238:239], v8 offset:19456
    v_mfma_f32_16x16x32_bf16 v[104:107], a[240:243], a[132:135], v[104:107]
    v_mfma_f32_16x16x32_bf16 v[112:115], a[240:243], a[136:139], v[112:115]
    buffer_load_dwordx4 a[196:199], v14, s[20:23], s77 offen sc1
    v_mfma_f32_16x16x32_bf16 v[112:115], a[244:247], a[152:155], v[112:115]
    s_waitcnt lgkmcnt(4)
    v_mfma_f32_16x16x32_bf16 v[120:123], a[244:247], a[156:159], v[120:123]
    v_mfma_f32_16x16x32_bf16 v[120:123], a[240:243], a[140:143], v[120:123]
    ds_read_b64_tr_b16 a[240:241], v9 offset:1024
    v_mfma_f32_16x16x32_bf16 v[124:127], a[224:227], a[140:143], v[124:127]
    ds_read_b64_tr_b16 a[242:243], v9 offset:7168
    v_mfma_f32_16x16x32_bf16 v[124:127], a[228:231], a[156:159], v[124:127]
    ds_read_b64_tr_b16 a[244:245], v9 offset:13312
    v_mfma_f32_16x16x32_bf16 v[116:119], a[228:231], a[152:155], v[116:119]
    buffer_load_dwordx4 a[200:203], v15, s[20:23], s46 offen sc1
    v_mfma_f32_16x16x32_bf16 v[116:119], a[224:227], a[136:139], v[116:119]
    ds_read_b64_tr_b16 a[246:247], v9 offset:19456
    v_mfma_f32_16x16x32_bf16 v[108:111], a[224:227], a[132:135], v[108:111]
    v_mfma_f32_16x16x32_bf16 v[108:111], a[228:231], a[148:151], v[108:111]
    s_waitcnt lgkmcnt(4)
    v_mfma_f32_16x16x32_bf16 v[100:103], a[228:231], a[144:147], v[100:103]
    v_mfma_f32_16x16x32_bf16 v[100:103], a[224:227], a[128:131], v[100:103]
    ds_read_b64_tr_b16 a[224:225], v10 offset:1024
    v_mfma_f32_16x16x32_bf16 v[128:131], a[232:235], a[128:131], v[128:131]
    buffer_load_dwordx4 a[204:207], v15, s[20:23], s77 offen sc1
    v_mfma_f32_16x16x32_bf16 v[128:131], a[236:239], a[144:147], v[128:131]
    s_add_u32 s46, s45, 28672
    ds_read_b64_tr_b16 a[226:227], v10 offset:7168
    s_sub_u32 s77, s46, 81920
    v_mfma_f32_16x16x32_bf16 v[136:139], a[236:239], a[148:151], v[136:139]
    s_min_u32 s46, s46, s77
    ds_read_b64_tr_b16 a[228:229], v10 offset:13312
    s_xor_b32 s77, s46, 1024
    v_mfma_f32_16x16x32_bf16 v[136:139], a[232:235], a[132:135], v[136:139]
    ds_read_b64_tr_b16 a[230:231], v10 offset:19456
    v_mfma_f32_16x16x32_bf16 v[144:147], a[232:235], a[136:139], v[144:147]
    v_mfma_f32_16x16x32_bf16 v[144:147], a[236:239], a[152:155], v[144:147]
    s_waitcnt lgkmcnt(4)
    v_mfma_f32_16x16x32_bf16 v[152:155], a[236:239], a[156:159], v[152:155]
    buffer_load_dwordx4 v[32:35], v17, s[24:27], s47 offen offset:0 sc1
    v_mfma_f32_16x16x32_bf16 v[152:155], a[232:235], a[140:143], v[152:155]
    buffer_load_dwordx4 a[208:211], v14, s[20:23], s46 offen sc1
    v_mfma_f32_16x16x32_bf16 v[156:159], a[240:243], a[140:143], v[156:159]
    ds_read_b64_tr_b16 a[232:233], v11 offset:1024
    v_mfma_f32_16x16x32_bf16 v[156:159], a[244:247], a[156:159], v[156:159]
    ds_read_b64_tr_b16 a[234:235], v11 offset:7168
    v_mfma_f32_16x16x32_bf16 v[148:151], a[244:247], a[152:155], v[148:151]
    ds_read_b64_tr_b16 a[236:237], v11 offset:13312
    v_mfma_f32_16x16x32_bf16 v[148:151], a[240:243], a[136:139], v[148:151]
    ds_read_b64_tr_b16 a[238:239], v11 offset:19456
    v_mfma_f32_16x16x32_bf16 v[140:143], a[240:243], a[132:135], v[140:143]
    buffer_load_dwordx4 a[212:215], v14, s[20:23], s77 offen sc1
    v_mfma_f32_16x16x32_bf16 v[140:143], a[244:247], a[148:151], v[140:143]
    s_waitcnt lgkmcnt(4)
    v_mfma_f32_16x16x32_bf16 v[132:135], a[244:247], a[144:147], v[132:135]
    v_mfma_f32_16x16x32_bf16 v[132:135], a[240:243], a[128:131], v[132:135]
    ds_read_b64_tr_b16 a[240:241], v8 offset:2048
    v_mfma_f32_16x16x32_bf16 v[160:163], a[224:227], a[128:131], v[160:163]
    ds_read_b64_tr_b16 a[242:243], v8 offset:8192
    v_mfma_f32_16x16x32_bf16 v[160:163], a[228:231], a[144:147], v[160:163]
    ds_read_b64_tr_b16 a[244:245], v8 offset:14336
    v_mfma_f32_16x16x32_bf16 v[168:171], a[228:231], a[148:151], v[168:171]
    buffer_load_dwordx4 a[216:219], v15, s[20:23], s46 offen sc1
    v_mfma_f32_16x16x32_bf16 v[168:171], a[224:227], a[132:135], v[168:171]
    ds_read_b64_tr_b16 a[246:247], v8 offset:20480
    v_mfma_f32_16x16x32_bf16 v[176:179], a[224:227], a[136:139], v[176:179]
    buffer_load_dwordx4 v[36:39], v17, s[24:27], s47 offen offset:1024 sc1
    v_mfma_f32_16x16x32_bf16 v[176:179], a[228:231], a[152:155], v[176:179]
    s_waitcnt lgkmcnt(4)
    v_mfma_f32_16x16x32_bf16 v[184:187], a[228:231], a[156:159], v[184:187]
    v_mfma_f32_16x16x32_bf16 v[184:187], a[224:227], a[140:143], v[184:187]
    ds_read_b64_tr_b16 a[224:225], v9 offset:2048
    v_mfma_f32_16x16x32_bf16 v[188:191], a[232:235], a[140:143], v[188:191]
    buffer_load_dwordx4 a[220:223], v15, s[20:23], s77 offen sc1
    v_mfma_f32_16x16x32_bf16 v[188:191], a[236:239], a[156:159], v[188:191]
    s_addk_i32 m0, 19712
    ds_read_b64_tr_b16 a[226:227], v9 offset:8192
    v_mfma_f32_16x16x32_bf16 v[180:183], a[236:239], a[152:155], v[180:183]
    ds_read_b64_tr_b16 a[228:229], v9 offset:14336
    v_mfma_f32_16x16x32_bf16 v[180:183], a[232:235], a[136:139], v[180:183]
    ds_read_b64_tr_b16 a[230:231], v9 offset:20480
    v_mfma_f32_16x16x32_bf16 v[172:175], a[232:235], a[132:135], v[172:175]
    v_mfma_f32_16x16x32_bf16 v[172:175], a[236:239], a[148:151], v[172:175]
    s_waitcnt lgkmcnt(4)
    v_mfma_f32_16x16x32_bf16 v[164:167], a[236:239], a[144:147], v[164:167]
    buffer_load_dwordx4 v2, s[8:11], s36 offen offset:0 lds
    v_mfma_f32_16x16x32_bf16 v[164:167], a[232:235], a[128:131], v[164:167]
    s_addk_i32 m0, 896
    ds_read_b64_tr_b16 a[232:233], v10 offset:2048
    v_mfma_f32_16x16x32_bf16 v[192:195], a[240:243], a[128:131], v[192:195]
    ds_read_b64_tr_b16 a[234:235], v10 offset:8192
    v_mfma_f32_16x16x32_bf16 v[192:195], a[244:247], a[144:147], v[192:195]
    ds_read_b64_tr_b16 a[236:237], v10 offset:14336
    v_mfma_f32_16x16x32_bf16 v[200:203], a[244:247], a[148:151], v[200:203]
    buffer_load_dwordx4 v[40:43], v17, s[24:27], s47 offen offset:2048 sc1
    v_mfma_f32_16x16x32_bf16 v[200:203], a[240:243], a[132:135], v[200:203]
    ds_read_b64_tr_b16 a[238:239], v10 offset:20480
    v_mfma_f32_16x16x32_bf16 v[208:211], a[240:243], a[136:139], v[208:211]
    buffer_load_dwordx4 v2, s[8:11], s36 offen offset:128 lds
    v_mfma_f32_16x16x32_bf16 v[208:211], a[244:247], a[152:155], v[208:211]
    s_waitcnt lgkmcnt(4)
    s_addk_i32 m0, 896
    v_mfma_f32_16x16x32_bf16 v[216:219], a[244:247], a[156:159], v[216:219]
    v_mfma_f32_16x16x32_bf16 v[216:219], a[240:243], a[140:143], v[216:219]
    ds_read_b64_tr_b16 a[240:241], v11 offset:2048
    ds_read_b64_tr_b16 a[242:243], v11 offset:8192
    ds_read_b64_tr_b16 a[244:245], v11 offset:14336
    v_mfma_f32_16x16x32_bf16 v[220:223], a[224:227], a[140:143], v[220:223]
    ds_read_b64_tr_b16 a[246:247], v11 offset:20480
    v_mfma_f32_16x16x32_bf16 v[220:223], a[228:231], a[156:159], v[220:223]
    v_mfma_f32_16x16x32_bf16 v[212:215], a[228:231], a[152:155], v[212:215]
    buffer_load_dwordx4 v2, s[8:11], s36 offen offset:256 lds
    v_mfma_f32_16x16x32_bf16 v[212:215], a[224:227], a[136:139], v[212:215]
    s_addk_i32 m0, 1280
    v_mfma_f32_16x16x32_bf16 v[204:207], a[224:227], a[132:135], v[204:207]
    v_mfma_f32_16x16x32_bf16 v[204:207], a[228:231], a[148:151], v[204:207]
    s_waitcnt lgkmcnt(4)
    v_mfma_f32_16x16x32_bf16 v[196:199], a[228:231], a[144:147], v[196:199]
    s_waitcnt lgkmcnt(0)
    s_barrier
    v_mfma_f32_16x16x32_bf16 v[196:199], a[224:227], a[128:131], v[196:199]
    ds_read_b64_tr_b16 a[224:225], v8 offset:24576
    v_mfma_f32_16x16x32_bf16 v[224:227], a[232:235], a[128:131], v[224:227]
    buffer_load_dwordx4 v[44:47], v17, s[24:27], s47 offen offset:3072 sc1
    v_mfma_f32_16x16x32_bf16 v[224:227], a[236:239], a[144:147], v[224:227]
    buffer_load_dwordx4 v3, s[8:11], s36 offen offset:0 lds
    v_mfma_f32_16x16x32_bf16 v[232:235], a[236:239], a[148:151], v[232:235]
    s_addk_i32 m0, 896
    ds_read_b64_tr_b16 a[226:227], v8 offset:30720
    v_mfma_f32_16x16x32_bf16 v[232:235], a[232:235], a[132:135], v[232:235]
    ds_read_b64_tr_b16 a[228:229], v8 offset:36864
    v_mfma_f32_16x16x32_bf16 v[240:243], a[232:235], a[136:139], v[240:243]
    ds_read_b64_tr_b16 a[230:231], v8 offset:43008
    v_mfma_f32_16x16x32_bf16 v[240:243], a[236:239], a[152:155], v[240:243]
    v_mfma_f32_16x16x32_bf16 v[248:251], a[236:239], a[156:159], v[248:251]
    buffer_load_dwordx4 v3, s[8:11], s36 offen offset:128 lds
    v_mfma_f32_16x16x32_bf16 v[248:251], a[232:235], a[140:143], v[248:251]
    s_addk_i32 m0, 896
    ds_read_b64_tr_b16 a[232:233], v9 offset:24576
    v_mfma_f32_16x16x32_bf16 v[252:255], a[240:243], a[140:143], v[252:255]
    ds_read_b64_tr_b16 a[234:235], v9 offset:30720
    v_mfma_f32_16x16x32_bf16 v[252:255], a[244:247], a[156:159], v[252:255]
    ds_read_b64_tr_b16 a[236:237], v9 offset:36864
    v_mfma_f32_16x16x32_bf16 v[244:247], a[244:247], a[152:155], v[244:247]
    ds_read_b64_tr_b16 a[238:239], v9 offset:43008
    v_mfma_f32_16x16x32_bf16 v[244:247], a[240:243], a[136:139], v[244:247]
    v_mfma_f32_16x16x32_bf16 v[236:239], a[240:243], a[132:135], v[236:239]
    buffer_load_dwordx4 v3, s[8:11], s36 offen offset:256 lds
    v_mfma_f32_16x16x32_bf16 v[236:239], a[244:247], a[148:151], v[236:239]
    s_waitcnt vmcnt(17) lgkmcnt(4)
    s_add_u32 s36, s36, s37
    s_sub_u32 s55, s36, 7864320
    v_mfma_f32_16x16x32_bf16 v[228:231], a[244:247], a[144:147], v[228:231]
    s_waitcnt vmcnt(12)
    s_min_u32 s36, s36, s55
    s_add_u32 s46, s45, 32768
    v_mfma_f32_16x16x32_bf16 v[228:231], a[240:243], a[128:131], v[228:231]
    s_waitcnt vmcnt(11)
    ds_read_b64_tr_b16 a[240:241], v10 offset:24576
    s_sub_u32 s77, s46, 81920
    v_mfma_f32_16x16x32_bf16 v[64:67], a[224:227], a[192:195], v[64:67]
    s_min_u32 s46, s46, s77
    ds_read_b64_tr_b16 a[242:243], v10 offset:30720
    s_xor_b32 s77, s46, 1024
    v_mfma_f32_16x16x32_bf16 v[64:67], a[228:231], a[208:211], v[64:67]
    ds_read_b64_tr_b16 a[244:245], v10 offset:36864
    v_mfma_f32_16x16x32_bf16 v[72:75], a[228:231], a[212:215], v[72:75]
    buffer_load_dwordx4 a[0:3], v14, s[20:23], s46 offen sc1
    v_mfma_f32_16x16x32_bf16 v[72:75], a[224:227], a[196:199], v[72:75]
    s_waitcnt vmcnt(9)
    ds_read_b64_tr_b16 a[246:247], v10 offset:43008
    v_mfma_f32_16x16x32_bf16 v[80:83], a[224:227], a[200:203], v[80:83]
    v_mfma_f32_16x16x32_bf16 v[80:83], a[228:231], a[216:219], v[80:83]
    s_waitcnt lgkmcnt(4)
    v_mfma_f32_16x16x32_bf16 v[88:91], a[228:231], a[220:223], v[88:91]
    v_mfma_f32_16x16x32_bf16 v[88:91], a[224:227], a[204:207], v[88:91]
    ds_read_b64_tr_b16 a[224:225], v11 offset:24576
    v_mfma_f32_16x16x32_bf16 v[92:95], a[232:235], a[204:207], v[92:95]
    buffer_load_dwordx4 a[4:7], v14, s[20:23], s77 offen sc1
    v_mfma_f32_16x16x32_bf16 v[92:95], a[236:239], a[220:223], v[92:95]
    ds_read_b64_tr_b16 a[226:227], v11 offset:30720
    v_mfma_f32_16x16x32_bf16 v[84:87], a[236:239], a[216:219], v[84:87]
    ds_read_b64_tr_b16 a[228:229], v11 offset:36864
    v_mfma_f32_16x16x32_bf16 v[84:87], a[232:235], a[200:203], v[84:87]
    ds_read_b64_tr_b16 a[230:231], v11 offset:43008
    v_mfma_f32_16x16x32_bf16 v[76:79], a[232:235], a[196:199], v[76:79]
    v_mfma_f32_16x16x32_bf16 v[76:79], a[236:239], a[212:215], v[76:79]
    s_waitcnt lgkmcnt(4)
    v_mfma_f32_16x16x32_bf16 v[68:71], a[236:239], a[208:211], v[68:71]
    buffer_load_dwordx4 a[8:11], v15, s[20:23], s46 offen sc1
    v_mfma_f32_16x16x32_bf16 v[68:71], a[232:235], a[192:195], v[68:71]
    ds_read_b64_tr_b16 a[232:233], v8 offset:25600
    v_mfma_f32_16x16x32_bf16 v[96:99], a[240:243], a[192:195], v[96:99]
    ds_read_b64_tr_b16 a[234:235], v8 offset:31744
    v_mfma_f32_16x16x32_bf16 v[96:99], a[244:247], a[208:211], v[96:99]
    ds_read_b64_tr_b16 a[236:237], v8 offset:37888
    v_mfma_f32_16x16x32_bf16 v[104:107], a[244:247], a[212:215], v[104:107]
    ds_read_b64_tr_b16 a[238:239], v8 offset:44032
    v_mfma_f32_16x16x32_bf16 v[104:107], a[240:243], a[196:199], v[104:107]
    v_mfma_f32_16x16x32_bf16 v[112:115], a[240:243], a[200:203], v[112:115]
    buffer_load_dwordx4 a[12:15], v15, s[20:23], s77 offen sc1
    v_mfma_f32_16x16x32_bf16 v[112:115], a[244:247], a[216:219], v[112:115]
    s_waitcnt lgkmcnt(4)
    s_add_u32 s46, s45, 36864
    s_sub_u32 s77, s46, 81920
    v_mfma_f32_16x16x32_bf16 v[120:123], a[244:247], a[220:223], v[120:123]
    s_min_u32 s46, s46, s77
    s_xor_b32 s77, s46, 1024
    v_mfma_f32_16x16x32_bf16 v[120:123], a[240:243], a[204:207], v[120:123]
    ds_read_b64_tr_b16 a[240:241], v9 offset:25600
    v_mfma_f32_16x16x32_bf16 v[124:127], a[224:227], a[204:207], v[124:127]
    ds_read_b64_tr_b16 a[242:243], v9 offset:31744
    v_mfma_f32_16x16x32_bf16 v[124:127], a[228:231], a[220:223], v[124:127]
    ds_read_b64_tr_b16 a[244:245], v9 offset:37888
    v_mfma_f32_16x16x32_bf16 v[116:119], a[228:231], a[216:219], v[116:119]
    buffer_load_dwordx4 a[16:19], v14, s[20:23], s46 offen sc1
    v_mfma_f32_16x16x32_bf16 v[116:119], a[224:227], a[200:203], v[116:119]
    ds_read_b64_tr_b16 a[246:247], v9 offset:44032
    v_mfma_f32_16x16x32_bf16 v[108:111], a[224:227], a[196:199], v[108:111]
    v_mfma_f32_16x16x32_bf16 v[108:111], a[228:231], a[212:215], v[108:111]
    s_waitcnt lgkmcnt(4)
    v_mfma_f32_16x16x32_bf16 v[100:103], a[228:231], a[208:211], v[100:103]
    v_mfma_f32_16x16x32_bf16 v[100:103], a[224:227], a[192:195], v[100:103]
    ds_read_b64_tr_b16 a[224:225], v10 offset:25600
    v_mfma_f32_16x16x32_bf16 v[128:131], a[232:235], a[192:195], v[128:131]
    buffer_load_dwordx4 a[20:23], v14, s[20:23], s77 offen sc1
    v_mfma_f32_16x16x32_bf16 v[128:131], a[236:239], a[208:211], v[128:131]
    ds_read_b64_tr_b16 a[226:227], v10 offset:31744
    v_mfma_f32_16x16x32_bf16 v[136:139], a[236:239], a[212:215], v[136:139]
    ds_read_b64_tr_b16 a[228:229], v10 offset:37888
    v_mfma_f32_16x16x32_bf16 v[136:139], a[232:235], a[196:199], v[136:139]
    ds_read_b64_tr_b16 a[230:231], v10 offset:44032
    v_mfma_f32_16x16x32_bf16 v[144:147], a[232:235], a[200:203], v[144:147]
    v_mfma_f32_16x16x32_bf16 v[144:147], a[236:239], a[216:219], v[144:147]
    s_waitcnt lgkmcnt(4)
    v_mfma_f32_16x16x32_bf16 v[152:155], a[236:239], a[220:223], v[152:155]
    buffer_load_dwordx4 a[24:27], v15, s[20:23], s46 offen sc1
    v_mfma_f32_16x16x32_bf16 v[152:155], a[232:235], a[204:207], v[152:155]
    ds_read_b64_tr_b16 a[232:233], v11 offset:25600
    v_mfma_f32_16x16x32_bf16 v[156:159], a[240:243], a[204:207], v[156:159]
    ds_read_b64_tr_b16 a[234:235], v11 offset:31744
    v_mfma_f32_16x16x32_bf16 v[156:159], a[244:247], a[220:223], v[156:159]
    ds_read_b64_tr_b16 a[236:237], v11 offset:37888
    v_mfma_f32_16x16x32_bf16 v[148:151], a[244:247], a[216:219], v[148:151]
    ds_read_b64_tr_b16 a[238:239], v11 offset:44032
    v_mfma_f32_16x16x32_bf16 v[148:151], a[240:243], a[200:203], v[148:151]
    v_mfma_f32_16x16x32_bf16 v[140:143], a[240:243], a[196:199], v[140:143]
    buffer_load_dwordx4 a[28:31], v15, s[20:23], s77 offen sc1
    v_mfma_f32_16x16x32_bf16 v[140:143], a[244:247], a[212:215], v[140:143]
    s_waitcnt lgkmcnt(4)
    s_addk_i32 m0, 19712
    v_mfma_f32_16x16x32_bf16 v[132:135], a[244:247], a[208:211], v[132:135]
    v_mfma_f32_16x16x32_bf16 v[132:135], a[240:243], a[192:195], v[132:135]
    ds_read_b64_tr_b16 a[240:241], v8 offset:26624
    v_mfma_f32_16x16x32_bf16 v[160:163], a[224:227], a[192:195], v[160:163]
    ds_read_b64_tr_b16 a[242:243], v8 offset:32768
    v_mfma_f32_16x16x32_bf16 v[160:163], a[228:231], a[208:211], v[160:163]
    ds_read_b64_tr_b16 a[244:245], v8 offset:38912
    v_mfma_f32_16x16x32_bf16 v[168:171], a[228:231], a[212:215], v[168:171]
    buffer_load_dwordx4 v2, s[8:11], s36 offen offset:0 lds
    v_mfma_f32_16x16x32_bf16 v[168:171], a[224:227], a[196:199], v[168:171]
    s_addk_i32 m0, 896
    ds_read_b64_tr_b16 a[246:247], v8 offset:45056
    v_mfma_f32_16x16x32_bf16 v[176:179], a[224:227], a[200:203], v[176:179]
    v_subrev_u32 v8, 98304, v8
    v_mfma_f32_16x16x32_bf16 v[176:179], a[228:231], a[216:219], v[176:179]
    s_waitcnt lgkmcnt(4)
    v_mfma_f32_16x16x32_bf16 v[184:187], a[228:231], a[220:223], v[184:187]
    v_mfma_f32_16x16x32_bf16 v[184:187], a[224:227], a[204:207], v[184:187]
    ds_read_b64_tr_b16 a[224:225], v9 offset:26624
    v_mfma_f32_16x16x32_bf16 v[188:191], a[232:235], a[204:207], v[188:191]
    buffer_load_dwordx4 v2, s[8:11], s36 offen offset:128 lds
    v_mfma_f32_16x16x32_bf16 v[188:191], a[236:239], a[220:223], v[188:191]
    s_addk_i32 m0, 896
    ds_read_b64_tr_b16 a[226:227], v9 offset:32768
    v_mfma_f32_16x16x32_bf16 v[180:183], a[236:239], a[216:219], v[180:183]
    ds_read_b64_tr_b16 a[228:229], v9 offset:38912
    v_mfma_f32_16x16x32_bf16 v[180:183], a[232:235], a[200:203], v[180:183]
    ds_read_b64_tr_b16 a[230:231], v9 offset:45056
    v_mfma_f32_16x16x32_bf16 v[172:175], a[232:235], a[196:199], v[172:175]
    v_subrev_u32 v9, 98304, v9
    v_mfma_f32_16x16x32_bf16 v[172:175], a[236:239], a[212:215], v[172:175]
    s_waitcnt lgkmcnt(4)
    v_mfma_f32_16x16x32_bf16 v[164:167], a[236:239], a[208:211], v[164:167]
    buffer_load_dwordx4 v2, s[8:11], s36 offen offset:256 lds
    v_mfma_f32_16x16x32_bf16 v[164:167], a[232:235], a[192:195], v[164:167]
    s_addk_i32 m0, 1280
    ds_read_b64_tr_b16 a[232:233], v10 offset:26624
    v_xor_b32 v34, s7, v34
    v_mfma_f32_16x16x32_bf16 v[192:195], a[240:243], a[192:195], v[192:195]
    s_waitcnt vmcnt(17)
    ds_read_b64_tr_b16 a[234:235], v10 offset:32768
    v_xor_b32 v38, s7, v38
    v_mfma_f32_16x16x32_bf16 v[192:195], a[244:247], a[208:211], v[192:195]
    s_waitcnt vmcnt(14)
    ds_read_b64_tr_b16 a[236:237], v10 offset:38912
    v_xor_b32 v42, s7, v42
    v_mfma_f32_16x16x32_bf16 v[200:203], a[244:247], a[212:215], v[200:203]
    s_lshl_b32 s56, s3, 3
    ds_read_b64_tr_b16 a[238:239], v10 offset:45056
    v_xor_b32 v46, s7, v46
    v_mfma_f32_16x16x32_bf16 v[200:203], a[240:243], a[196:199], v[200:203]
    s_add_u32 s56, s56, 147456
    v_or3_b32 v34, v34, v38, v42
    v_or_b32 v34, v34, v46
    v_mfma_f32_16x16x32_bf16 v[208:211], a[240:243], a[200:203], v[208:211]
    buffer_load_dwordx4 v3, s[8:11], s36 offen offset:0 lds
    v_mfma_f32_16x16x32_bf16 v[208:211], a[244:247], a[216:219], v[208:211]
    s_waitcnt lgkmcnt(4)
    v_cmp_ne_u32 vcc, 0, v34
    s_addk_i32 m0, 896
    v_mfma_f32_16x16x32_bf16 v[216:219], a[244:247], a[220:223], v[216:219]
    s_cbranch_vccnz spin_rec
spin_rec_ret:
    v_max_u32 v20, v32, v33
    v_mfma_f32_16x16x32_bf16 v[216:219], a[240:243], a[204:207], v[216:219]
    ds_read_b64_tr_b16 a[240:241], v11 offset:26624
    v_min_u32 v21, v32, v33
    ds_read_b64_tr_b16 a[242:243], v11 offset:32768
    v_mfma_f32_16x16x32_bf16 v[220:223], a[224:227], a[204:207], v[220:223]
    ds_read_b64_tr_b16 a[244:245], v11 offset:38912
    v_med3_u32 v21, v20, v21, v36
    ds_read_b64_tr_b16 a[246:247], v11 offset:45056
    v_mfma_f32_16x16x32_bf16 v[220:223], a[228:231], a[220:223], v[220:223]
    v_max_u32 v20, v20, v36
    v_med3_u32 v21, v20, v21, v37
    v_mfma_f32_16x16x32_bf16 v[212:215], a[228:231], a[216:219], v[212:215]
    buffer_load_dwordx4 v3, s[8:11], s36 offen offset:128 lds
    v_mfma_f32_16x16x32_bf16 v[212:215], a[224:227], a[200:203], v[212:215]
    s_addk_i32 m0, 896
    v_max_u32 v20, v20, v37
    v_med3_u32 v21, v20, v21, v40
    v_mfma_f32_16x16x32_bf16 v[204:207], a[224:227], a[196:199], v[204:207]
    v_max_u32 v20, v20, v40
    v_med3_u32 v21, v20, v21, v41
    v_mfma_f32_16x16x32_bf16 v[204:207], a[228:231], a[212:215], v[204:207]
    s_waitcnt lgkmcnt(4)
    v_max_u32 v20, v20, v41
    v_med3_u32 v21, v20, v21, v44
    v_mfma_f32_16x16x32_bf16 v[196:199], a[228:231], a[208:211], v[196:199]
    s_waitcnt lgkmcnt(0)
    s_barrier
    v_mfma_f32_16x16x32_bf16 v[196:199], a[224:227], a[192:195], v[196:199]
    ds_read_b64_tr_b16 a[224:225], v8 offset:0
    v_max_u32 v20, v20, v44
    v_mfma_f32_16x16x32_bf16 v[224:227], a[232:235], a[192:195], v[224:227]
    buffer_load_dwordx4 v3, s[8:11], s36 offen offset:256 lds
    v_mfma_f32_16x16x32_bf16 v[224:227], a[236:239], a[208:211], v[224:227]
    s_add_u32 s36, s36, s37
    ds_read_b64_tr_b16 a[226:227], v8 offset:6144
    v_med3_u32 v21, v20, v21, v45
    v_mfma_f32_16x16x32_bf16 v[232:235], a[236:239], a[212:215], v[232:235]
    s_sub_u32 s55, s36, 7864320
    ds_read_b64_tr_b16 a[228:229], v8 offset:12288
    v_max_u32 v20, v20, v45
    v_mfma_f32_16x16x32_bf16 v[232:235], a[232:235], a[196:199], v[232:235]
    s_min_u32 s36, s36, s55
    ds_read_b64_tr_b16 a[230:231], v8 offset:18432
    v_mov_b32_dpp v22, v20 row_ror:8 row_mask:0xf bank_mask:0xf
    v_mfma_f32_16x16x32_bf16 v[240:243], a[232:235], a[200:203], v[240:243]
    s_add_u32 s46, s45, 40960
    v_mov_b32_dpp v23, v21 row_ror:8 row_mask:0xf bank_mask:0xf
    v_min_u32 v24, v20, v22
    v_mfma_f32_16x16x32_bf16 v[240:243], a[236:239], a[216:219], v[240:243]
    s_sub_u32 s77, s46, 81920
    v_max_u32 v20, v20, v22
    v_max3_u32 v21, v24, v21, v23
    v_mfma_f32_16x16x32_bf16 v[248:251], a[236:239], a[220:223], v[248:251]
    s_min_u32 s46, s46, s77
    v_mov_b32_dpp v22, v20 row_ror:4 row_mask:0xf bank_mask:0xf
    v_mov_b32_dpp v23, v21 row_ror:4 row_mask:0xf bank_mask:0xf
    v_mfma_f32_16x16x32_bf16 v[248:251], a[232:235], a[204:207], v[248:251]
    buffer_load_dwordx4 a[32:35], v14, s[20:23], s46 offen sc1
    v_mfma_f32_16x16x32_bf16 v[252:255], a[240:243], a[204:207], v[252:255]
    s_xor_b32 s77, s46, 1024
    ds_read_b64_tr_b16 a[232:233], v9 offset:0
    v_min_u32 v24, v20, v22
    v_mfma_f32_16x16x32_bf16 v[252:255], a[244:247], a[220:223], v[252:255]
    ds_read_b64_tr_b16 a[234:235], v9 offset:6144
    v_max_u32 v20, v20, v22
    v_mfma_f32_16x16x32_bf16 v[244:247], a[244:247], a[216:219], v[244:247]
    ds_read_b64_tr_b16 a[236:237], v9 offset:12288
    v_max3_u32 v21, v24, v21, v23
    v_mfma_f32_16x16x32_bf16 v[244:247], a[240:243], a[200:203], v[244:247]
    ds_read_b64_tr_b16 a[238:239], v9 offset:18432
    v_mov_b32_dpp v22, v20 row_ror:2 row_mask:0xf bank_mask:0xf
    v_mfma_f32_16x16x32_bf16 v[236:239], a[240:243], a[196:199], v[236:239]
    buffer_load_dwordx4 a[36:39], v14, s[20:23], s77 offen sc1
    v_mfma_f32_16x16x32_bf16 v[236:239], a[244:247], a[212:215], v[236:239]
    s_waitcnt vmcnt(15) lgkmcnt(4)
    v_mov_b32_dpp v23, v21 row_ror:2 row_mask:0xf bank_mask:0xf
    v_min_u32 v24, v20, v22
    v_mfma_f32_16x16x32_bf16 v[228:231], a[244:247], a[208:211], v[228:231]
    s_waitcnt vmcnt(11)
    v_max_u32 v20, v20, v22
    v_max3_u32 v21, v24, v21, v23
    v_mfma_f32_16x16x32_bf16 v[228:231], a[240:243], a[192:195], v[228:231]
    s_waitcnt vmcnt(10)
    v_mov_b32_dpp v22, v20 row_ror:1 row_mask:0xf bank_mask:0xf
    v_mov_b32_dpp v23, v21 row_ror:1 row_mask:0xf bank_mask:0xf
    v_mfma_f32_16x16x32_bf16 v[64:67], a[224:227], a[0:3], v[64:67]
    v_min_u32 v24, v20, v22
    v_max_u32 v20, v20, v22
    v_mfma_f32_16x16x32_bf16 v[64:67], a[228:231], a[16:19], v[64:67]
    v_max3_u32 v21, v24, v21, v23
    v_mov_b32 v22, v20
    v_mfma_f32_16x16x32_bf16 v[72:75], a[228:231], a[20:23], v[72:75]
    buffer_load_dwordx4 a[40:43], v15, s[20:23], s46 offen sc1
    v_mfma_f32_16x16x32_bf16 v[72:75], a[224:227], a[4:7], v[72:75]
    s_waitcnt vmcnt(9)
    v_permlane16_swap_b32 v20, v22
    v_mfma_f32_16x16x32_bf16 v[80:83], a[224:227], a[8:11], v[80:83]
    v_mov_b32 v23, v21
    v_min_u32 v24, v20, v22
    v_mfma_f32_16x16x32_bf16 v[80:83], a[228:231], a[24:27], v[80:83]
    s_waitcnt lgkmcnt(0)
    v_permlane16_swap_b32 v21, v23
    v_mfma_f32_16x16x32_bf16 v[88:91], a[228:231], a[28:31], v[88:91]
    v_max_u32 v20, v20, v22
    v_max3_u32 v21, v24, v21, v23
    v_subrev_u32 v10, 98304, v10
    v_mfma_f32_16x16x32_bf16 v[88:91], a[224:227], a[12:15], v[88:91]
    ds_read_b64_tr_b16 a[240:241], v10 offset:0
    v_mov_b32 v22, v20
    v_mfma_f32_16x16x32_bf16 v[92:95], a[232:235], a[12:15], v[92:95]
    s_add_u32 s46, s45, 45056
    ds_read_b64_tr_b16 a[242:243], v10 offset:6144
    v_mov_b32 v23, v21
    v_mfma_f32_16x16x32_bf16 v[92:95], a[236:239], a[28:31], v[92:95]
    ds_read_b64_tr_b16 a[244:245], v10 offset:12288
    v_subrev_u32 v11, 98304, v11
    v_mfma_f32_16x16x32_bf16 v[84:87], a[236:239], a[24:27], v[84:87]
    ds_read_b64_tr_b16 a[246:247], v10 offset:18432
    v_mfma_f32_16x16x32_bf16 v[84:87], a[232:235], a[8:11], v[84:87]
    buffer_load_dwordx4 a[44:47], v15, s[20:23], s77 offen sc1
    v_mfma_f32_16x16x32_bf16 v[76:79], a[232:235], a[4:7], v[76:79]
    s_sub_u32 s77, s46, 81920
    ds_read_b64_tr_b16 a[224:225], v11 offset:0
    s_min_u32 s46, s46, s77
    v_mfma_f32_16x16x32_bf16 v[76:79], a[236:239], a[20:23], v[76:79]
    s_xor_b32 s77, s46, 1024
    ds_read_b64_tr_b16 a[226:227], v11 offset:6144
    v_mfma_f32_16x16x32_bf16 v[68:71], a[236:239], a[16:19], v[68:71]
    buffer_load_dwordx4 a[48:51], v14, s[20:23], s46 offen sc1
    v_mfma_f32_16x16x32_bf16 v[68:71], a[232:235], a[0:3], v[68:71]
    s_waitcnt lgkmcnt(4)
    ds_read_b64_tr_b16 a[228:229], v11 offset:12288
    v_mfma_f32_16x16x32_bf16 v[96:99], a[240:243], a[0:3], v[96:99]
    s_waitcnt lgkmcnt(3)
    ds_read_b64_tr_b16 a[230:231], v11 offset:18432
    v_mfma_f32_16x16x32_bf16 v[96:99], a[244:247], a[16:19], v[96:99]
    ds_read_b64_tr_b16 a[232:233], v8 offset:1024
    v_mfma_f32_16x16x32_bf16 v[104:107], a[244:247], a[20:23], v[104:107]
    ds_read_b64_tr_b16 a[234:235], v8 offset:7168
    v_mfma_f32_16x16x32_bf16 v[104:107], a[240:243], a[4:7], v[104:107]
    ds_read_b64_tr_b16 a[236:237], v8 offset:13312
    v_mfma_f32_16x16x32_bf16 v[112:115], a[240:243], a[8:11], v[112:115]
    buffer_load_dwordx4 a[52:55], v14, s[20:23], s77 offen sc1
    v_mfma_f32_16x16x32_bf16 v[112:115], a[244:247], a[24:27], v[112:115]
    s_waitcnt lgkmcnt(5)
    ds_read_b64_tr_b16 a[238:239], v8 offset:19456
    v_mfma_f32_16x16x32_bf16 v[120:123], a[244:247], a[28:31], v[120:123]
pg_2:
    s_cbranch_execz pg_6
    v_permlane32_swap_b32 v20, v22
    v_mfma_f32_16x16x32_bf16 v[120:123], a[240:243], a[12:15], v[120:123]
    s_waitcnt lgkmcnt(4)
    ds_read_b64_tr_b16 a[240:241], v9 offset:1024
    v_min_u32 v24, v20, v22
    v_mfma_f32_16x16x32_bf16 v[124:127], a[224:227], a[12:15], v[124:127]
    ds_read_b64_tr_b16 a[242:243], v9 offset:7168
    v_max_u32 v20, v20, v22
    v_mfma_f32_16x16x32_bf16 v[124:127], a[228:231], a[28:31], v[124:127]
    ds_read_b64_tr_b16 a[244:245], v9 offset:13312
    v_mov_b32 v22, s56
    v_mfma_f32_16x16x32_bf16 v[116:119], a[228:231], a[24:27], v[116:119]
    buffer_load_dwordx4 a[56:59], v15, s[20:23], s46 offen sc1
    v_mfma_f32_16x16x32_bf16 v[116:119], a[224:227], a[8:11], v[116:119]
    ds_read_b64_tr_b16 a[246:247], v9 offset:19456
    v_mfma_f32_16x16x32_bf16 v[108:111], a[224:227], a[4:7], v[108:111]
    v_permlane32_swap_b32 v21, v23
    v_mfma_f32_16x16x32_bf16 v[108:111], a[228:231], a[20:23], v[108:111]
    s_waitcnt lgkmcnt(4)
    v_max3_u32 v21, v24, v21, v23
    v_mov_b32 v23, 147456
    v_mfma_f32_16x16x32_bf16 v[100:103], a[228:231], a[16:19], v[100:103]
    ds_write_b64 v22, v[20:21]
    v_mfma_f32_16x16x32_bf16 v[100:103], a[224:227], a[0:3], v[100:103]
    ds_read_b64_tr_b16 a[224:225], v10 offset:1024
    v_mfma_f32_16x16x32_bf16 v[128:131], a[232:235], a[0:3], v[128:131]
    buffer_load_dwordx4 a[60:63], v15, s[20:23], s77 offen sc1
    v_mfma_f32_16x16x32_bf16 v[128:131], a[236:239], a[16:19], v[128:131]
    s_addk_i32 m0, 19712
    ds_read_b64_tr_b16 a[226:227], v10 offset:7168
    v_mfma_f32_16x16x32_bf16 v[136:139], a[236:239], a[20:23], v[136:139]
    ds_read_b64_tr_b16 a[228:229], v10 offset:13312
    v_mfma_f32_16x16x32_bf16 v[136:139], a[232:235], a[4:7], v[136:139]
    ds_read_b64_tr_b16 a[230:231], v10 offset:19456
    v_mfma_f32_16x16x32_bf16 v[144:147], a[232:235], a[8:11], v[144:147]
    v_mfma_f32_16x16x32_bf16 v[144:147], a[236:239], a[24:27], v[144:147]
    s_waitcnt lgkmcnt(4)
    v_mfma_f32_16x16x32_bf16 v[152:155], a[236:239], a[28:31], v[152:155]
    buffer_load_dwordx4 v2, s[8:11], s36 offen offset:0 lds
    v_mfma_f32_16x16x32_bf16 v[152:155], a[232:235], a[12:15], v[152:155]
    s_addk_i32 m0, 896
    ds_read_b64_tr_b16 a[232:233], v11 offset:1024
    v_mfma_f32_16x16x32_bf16 v[156:159], a[240:243], a[12:15], v[156:159]
    ds_read_b64_tr_b16 a[234:235], v11 offset:7168
    v_mfma_f32_16x16x32_bf16 v[156:159], a[244:247], a[28:31], v[156:159]
    ds_read_b64_tr_b16 a[236:237], v11 offset:13312
    v_mfma_f32_16x16x32_bf16 v[148:151], a[244:247], a[24:27], v[148:151]
    ds_read_b64_tr_b16 a[238:239], v11 offset:19456
    v_mfma_f32_16x16x32_bf16 v[148:151], a[240:243], a[8:11], v[148:151]
    v_mfma_f32_16x16x32_bf16 v[140:143], a[240:243], a[4:7], v[140:143]
    buffer_load_dwordx4 v2, s[8:11], s36 offen offset:128 lds
    v_mfma_f32_16x16x32_bf16 v[140:143], a[244:247], a[20:23], v[140:143]
    s_waitcnt lgkmcnt(4)
    s_addk_i32 m0, 896
    v_mfma_f32_16x16x32_bf16 v[132:135], a[244:247], a[16:19], v[132:135]
    v_mfma_f32_16x16x32_bf16 v[132:135], a[240:243], a[0:3], v[132:135]
    ds_read_b64_tr_b16 a[240:241], v8 offset:2048
    v_mfma_f32_16x16x32_bf16 v[160:163], a[224:227], a[0:3], v[160:163]
    ds_read_b64_tr_b16 a[242:243], v8 offset:8192
    v_mfma_f32_16x16x32_bf16 v[160:163], a[228:231], a[16:19], v[160:163]
    ds_read_b64_tr_b16 a[244:245], v8 offset:14336
    v_mfma_f32_16x16x32_bf16 v[168:171], a[228:231], a[20:23], v[168:171]
    buffer_load_dwordx4 v2, s[8:11], s36 offen offset:256 lds
    v_mfma_f32_16x16x32_bf16 v[168:171], a[224:227], a[4:7], v[168:171]
    s_addk_i32 m0, 1280
    ds_read_b64_tr_b16 a[246:247], v8 offset:20480
    v_mfma_f32_16x16x32_bf16 v[176:179], a[224:227], a[8:11], v[176:179]
    v_mfma_f32_16x16x32_bf16 v[176:179], a[228:231], a[24:27], v[176:179]
    s_waitcnt lgkmcnt(4)
    v_mfma_f32_16x16x32_bf16 v[184:187], a[228:231], a[28:31], v[184:187]
    v_mfma_f32_16x16x32_bf16 v[184:187], a[224:227], a[12:15], v[184:187]
    ds_read_b64_tr_b16 a[224:225], v9 offset:2048
    v_mfma_f32_16x16x32_bf16 v[188:191], a[232:235], a[12:15], v[188:191]
    buffer_load_dwordx4 v3, s[8:11], s36 offen offset:0 lds
    v_mfma_f32_16x16x32_bf16 v[188:191], a[236:239], a[28:31], v[188:191]
    s_addk_i32 m0, 896
    ds_read_b64_tr_b16 a[226:227], v9 offset:8192
    v_mfma_f32_16x16x32_bf16 v[180:183], a[236:239], a[24:27], v[180:183]
    ds_read_b64_tr_b16 a[228:229], v9 offset:14336
    v_mfma_f32_16x16x32_bf16 v[180:183], a[232:235], a[8:11], v[180:183]
    ds_read_b64_tr_b16 a[230:231], v9 offset:20480
    v_mfma_f32_16x16x32_bf16 v[172:175], a[232:235], a[4:7], v[172:175]
    v_mfma_f32_16x16x32_bf16 v[172:175], a[236:239], a[20:23], v[172:175]
    s_waitcnt lgkmcnt(4)
    v_mfma_f32_16x16x32_bf16 v[164:167], a[236:239], a[16:19], v[164:167]
    buffer_load_dwordx4 v3, s[8:11], s36 offen offset:128 lds
    v_mfma_f32_16x16x32_bf16 v[164:167], a[232:235], a[0:3], v[164:167]
    s_addk_i32 m0, 896
    ds_read_b64_tr_b16 a[232:233], v10 offset:2048
    v_mfma_f32_16x16x32_bf16 v[192:195], a[240:243], a[0:3], v[192:195]
    ds_read_b64_tr_b16 a[234:235], v10 offset:8192
    v_mfma_f32_16x16x32_bf16 v[192:195], a[244:247], a[16:19], v[192:195]
    ds_read_b64_tr_b16 a[236:237], v10 offset:14336
    v_mfma_f32_16x16x32_bf16 v[200:203], a[244:247], a[20:23], v[200:203]
    ds_read_b64_tr_b16 a[238:239], v10 offset:20480
    v_mfma_f32_16x16x32_bf16 v[200:203], a[240:243], a[4:7], v[200:203]
    v_mfma_f32_16x16x32_bf16 v[208:211], a[240:243], a[8:11], v[208:211]
    buffer_load_dwordx4 v3, s[8:11], s36 offen offset:256 lds
    v_mfma_f32_16x16x32_bf16 v[208:211], a[244:247], a[24:27], v[208:211]
    s_waitcnt lgkmcnt(4)
    s_add_u32 s36, s36, s37
    s_sub_u32 s55, s36, 7864320
    v_mfma_f32_16x16x32_bf16 v[216:219], a[244:247], a[28:31], v[216:219]
    s_min_u32 s36, s36, s55
    s_add_u32 s46, s45, 49152
    s_sub_u32 s77, s46, 81920
    v_mfma_f32_16x16x32_bf16 v[216:219], a[240:243], a[12:15], v[216:219]
    s_min_u32 s46, s46, s77
    ds_read_b64_tr_b16 a[240:241], v11 offset:2048
    s_xor_b32 s77, s46, 1024
    ds_read_b64_tr_b16 a[242:243], v11 offset:8192
    v_mfma_f32_16x16x32_bf16 v[220:223], a[224:227], a[12:15], v[220:223]
    ds_read_b64_tr_b16 a[244:245], v11 offset:14336
    ds_read_b64_tr_b16 a[246:247], v11 offset:20480
    v_mfma_f32_16x16x32_bf16 v[220:223], a[228:231], a[28:31], v[220:223]
    v_mfma_f32_16x16x32_bf16 v[212:215], a[228:231], a[24:27], v[212:215]
    buffer_load_dwordx4 a[64:67], v14, s[20:23], s46 offen sc1
    v_mfma_f32_16x16x32_bf16 v[212:215], a[224:227], a[8:11], v[212:215]
    v_mfma_f32_16x16x32_bf16 v[204:207], a[224:227], a[4:7], v[204:207]
    v_mfma_f32_16x16x32_bf16 v[204:207], a[228:231], a[20:23], v[204:207]
    s_waitcnt lgkmcnt(4)
    v_mfma_f32_16x16x32_bf16 v[196:199], a[228:231], a[16:19], v[196:199]
    s_waitcnt lgkmcnt(0)
    s_barrier
    v_mfma_f32_16x16x32_bf16 v[196:199], a[224:227], a[0:3], v[196:199]
    ds_read_b128 v[32:35], v23 offset:0
    v_mfma_f32_16x16x32_bf16 v[224:227], a[232:235], a[0:3], v[224:227]
    buffer_load_dwordx4 a[68:71], v14, s[20:23], s77 offen sc1
    v_mfma_f32_16x16x32_bf16 v[224:227], a[236:239], a[16:19], v[224:227]
    ds_read_b128 v[36:39], v23 offset:16
    v_and_b32 v22, 1, v1
    v_mfma_f32_16x16x32_bf16 v[232:235], a[236:239], a[20:23], v[232:235]
    ds_read_b64_tr_b16 a[224:225], v8 offset:24576
    v_cmp_eq_u32 vcc, 1, v22
    v_mfma_f32_16x16x32_bf16 v[232:235], a[232:235], a[4:7], v[232:235]
    ds_read_b64_tr_b16 a[226:227], v8 offset:30720
    v_lshrrev_b32 v24, 4, v1
    v_mfma_f32_16x16x32_bf16 v[240:243], a[232:235], a[8:11], v[240:243]
    ds_read_b64_tr_b16 a[228:229], v8 offset:36864
    v_bfe_u32 v26, v1, 2, 3
    v_mfma_f32_16x16x32_bf16 v[240:243], a[236:239], a[24:27], v[240:243]
    ds_read_b64_tr_b16 a[230:231], v8 offset:43008
    v_lshlrev_b32 v25, 7, v26
    v_mfma_f32_16x16x32_bf16 v[248:251], a[236:239], a[28:31], v[248:251]
    buffer_load_dwordx4 a[72:75], v15, s[20:23], s46 offen sc1
    v_mfma_f32_16x16x32_bf16 v[248:251], a[232:235], a[12:15], v[248:251]
    s_waitcnt lgkmcnt(5)
    ds_read_b64_tr_b16 a[232:233], v9 offset:24576
    v_max_u32 v20, v32, v33
    v_mfma_f32_16x16x32_bf16 v[252:255], a[240:243], a[12:15], v[252:255]
    ds_read_b64_tr_b16 a[234:235], v9 offset:30720
    v_min_u32 v21, v32, v33
    v_mfma_f32_16x16x32_bf16 v[252:255], a[244:247], a[28:31], v[252:255]
    ds_read_b64_tr_b16 a[236:237], v9 offset:36864
    v_med3_u32 v21, v20, v21, v34
    v_mfma_f32_16x16x32_bf16 v[244:247], a[244:247], a[24:27], v[244:247]
    ds_read_b64_tr_b16 a[238:239], v9 offset:43008
    v_max_u32 v20, v20, v34
    v_mfma_f32_16x16x32_bf16 v[244:247], a[240:243], a[8:11], v[244:247]
    v_med3_u32 v21, v20, v21, v35
    v_max_u32 v20, v20, v35
    v_mfma_f32_16x16x32_bf16 v[236:239], a[240:243], a[4:7], v[236:239]
    buffer_load_dwordx4 a[76:79], v15, s[20:23], s77 offen sc1
    v_mfma_f32_16x16x32_bf16 v[236:239], a[244:247], a[20:23], v[236:239]
    s_waitcnt vmcnt(17) lgkmcnt(4)
    v_med3_u32 v21, v20, v21, v36
    v_max_u32 v20, v20, v36
    v_mfma_f32_16x16x32_bf16 v[228:231], a[244:247], a[16:19], v[228:231]
    s_waitcnt vmcnt(13)
    v_med3_u32 v21, v20, v21, v37
    v_max_u32 v20, v20, v37
    v_mfma_f32_16x16x32_bf16 v[228:231], a[240:243], a[0:3], v[228:231]
    s_waitcnt vmcnt(12)
    ds_read_b64_tr_b16 a[240:241], v10 offset:24576
    v_med3_u32 v21, v20, v21, v38
    v_mfma_f32_16x16x32_bf16 v[64:67], a[224:227], a[32:35], v[64:67]
    s_add_u32 s46, s45, 53248
    ds_read_b64_tr_b16 a[242:243], v10 offset:30720
    v_max_u32 v20, v20, v38
    v_mfma_f32_16x16x32_bf16 v[64:67], a[228:231], a[48:51], v[64:67]
    s_sub_u32 s77, s46, 81920
    ds_read_b64_tr_b16 a[244:245], v10 offset:36864
    v_med3_u32 v21, v20, v21, v39
    v_mfma_f32_16x16x32_bf16 v[72:75], a[228:231], a[52:55], v[72:75]
    s_waitcnt vmcnt(11)
    ds_read_b64_tr_b16 a[246:247], v10 offset:43008
    v_max_u32 v20, v20, v39
    v_mfma_f32_16x16x32_bf16 v[72:75], a[224:227], a[36:39], v[72:75]
    s_waitcnt vmcnt(10)
    v_readfirstlane_b32 s70, v20
    v_readfirstlane_b32 s71, v21
    v_mfma_f32_16x16x32_bf16 v[80:83], a[224:227], a[40:43], v[80:83]
    s_min_u32 s46, s46, s77
    v_cndmask_b32 v22, v20, v21, vcc
    v_and_b32 v22, 0x7ff, v22
    v_mfma_f32_16x16x32_bf16 v[80:83], a[228:231], a[56:59], v[80:83]
    buffer_load_dwordx4 a[80:83], v14, s[20:23], s46 offen sc1
    v_mfma_f32_16x16x32_bf16 v[88:91], a[228:231], a[60:63], v[88:91]
    s_waitcnt lgkmcnt(3)
    v_sub_u32 v22, 2047, v22
    v_mul_u32_u24 v23, 1280, v22
    v_mfma_f32_16x16x32_bf16 v[88:91], a[224:227], a[44:47], v[88:91]
    s_xor_b32 s77, s46, 1024
    ds_read_b64_tr_b16 a[224:225], v11 offset:24576
    v_lshl_add_u32 v23, v24, 4, v23
    v_mfma_f32_16x16x32_bf16 v[92:95], a[232:235], a[44:47], v[92:95]
    buffer_load_dwordx4 a[84:87], v14, s[20:23], s77 offen sc1
    v_mfma_f32_16x16x32_bf16 v[92:95], a[236:239], a[60:63], v[92:95]
    ds_read_b64_tr_b16 a[226:227], v11 offset:30720
    v_add_u32 v23, s61, v23
    v_mfma_f32_16x16x32_bf16 v[84:87], a[236:239], a[56:59], v[84:87]
    ds_read_b64_tr_b16 a[228:229], v11 offset:36864
    v_lshlrev_b32 v24, 3, v22
    v_mfma_f32_16x16x32_bf16 v[84:87], a[232:235], a[40:43], v[84:87]
    ds_read_b64_tr_b16 a[230:231], v11 offset:43008
    v_add_u32 v24, 3211264, v24
    v_mfma_f32_16x16x32_bf16 v[76:79], a[232:235], a[36:39], v[76:79]
    v_lshrrev_b32 v26, 1, v26
    v_xor_b32 v26, s3, v26
    v_mfma_f32_16x16x32_bf16 v[76:79], a[236:239], a[52:55], v[76:79]
    s_waitcnt lgkmcnt(4)
    v_lshl_add_u32 v25, v26, 5, v25
    v_and_b32 v26, 3, v1
    v_mfma_f32_16x16x32_bf16 v[68:71], a[236:239], a[48:51], v[68:71]
    buffer_load_dwordx4 a[88:91], v15, s[20:23], s46 offen sc1
    v_mfma_f32_16x16x32_bf16 v[68:71], a[232:235], a[32:35], v[68:71]
    ds_read_b64_tr_b16 a[232:233], v8 offset:25600
    v_lshl_add_u32 v25, v26, 3, v25
    v_mfma_f32_16x16x32_bf16 v[96:99], a[240:243], a[32:35], v[96:99]
    ds_read_b64_tr_b16 a[234:235], v8 offset:31744
    v_lshrrev_b32 v26, 5, v1
    v_mfma_f32_16x16x32_bf16 v[96:99], a[244:247], a[48:51], v[96:99]
    ds_read_b64_tr_b16 a[236:237], v8 offset:37888
    v_mul_u32_u24 v26, 2048, v26
    v_mfma_f32_16x16x32_bf16 v[104:107], a[244:247], a[52:55], v[104:107]
    ds_read_b64_tr_b16 a[238:239], v8 offset:44032
    v_add_u32 v25, v25, v26
    v_mfma_f32_16x16x32_bf16 v[104:107], a[240:243], a[36:39], v[104:107]
    v_add_u32 v25, 147456, v25
    v_lshlrev_b32 v26, 4, v1
    v_mfma_f32_16x16x32_bf16 v[112:115], a[240:243], a[40:43], v[112:115]
    buffer_load_dwordx4 a[92:95], v15, s[20:23], s77 offen sc1
    v_mfma_f32_16x16x32_bf16 v[112:115], a[244:247], a[56:59], v[112:115]
    s_waitcnt lgkmcnt(4)
    v_cmp_gt_u32 vcc, 16, v1
    v_mov_b32 v27, 0x7ffffff0
    v_mfma_f32_16x16x32_bf16 v[120:123], a[244:247], a[60:63], v[120:123]
    s_addk_i32 m0, 19712
    v_cndmask_b32 v26, v27, v26, vcc
    v_mfma_f32_16x16x32_bf16 v[120:123], a[240:243], a[44:47], v[120:123]
    ds_read_b64_tr_b16 a[240:241], v9 offset:25600
    v_mfma_f32_16x16x32_bf16 v[124:127], a[224:227], a[44:47], v[124:127]
    ds_read_b64_tr_b16 a[242:243], v9 offset:31744
    v_mfma_f32_16x16x32_bf16 v[124:127], a[228:231], a[60:63], v[124:127]
    ds_read_b64_tr_b16 a[244:245], v9 offset:37888
    v_mfma_f32_16x16x32_bf16 v[116:119], a[228:231], a[56:59], v[116:119]
    buffer_load_dwordx4 v2, s[8:11], s36 offen offset:0 lds
    v_mfma_f32_16x16x32_bf16 v[116:119], a[224:227], a[40:43], v[116:119]
    s_addk_i32 m0, 896
    ds_read_b64_tr_b16 a[246:247], v9 offset:44032
    v_mfma_f32_16x16x32_bf16 v[108:111], a[224:227], a[36:39], v[108:111]
    v_min_u32 v27, 1, v1
    v_mfma_f32_16x16x32_bf16 v[108:111], a[228:231], a[52:55], v[108:111]
    s_waitcnt lgkmcnt(4)
    v_lshlrev_b32 v27, 30, v27
    v_mfma_f32_16x16x32_bf16 v[100:103], a[228:231], a[48:51], v[100:103]
    v_mfma_f32_16x16x32_bf16 v[100:103], a[224:227], a[32:35], v[100:103]
    ds_read_b64_tr_b16 a[224:225], v10 offset:25600
    v_mfma_f32_16x16x32_bf16 v[128:131], a[232:235], a[32:35], v[128:131]
    buffer_load_dwordx4 v2, s[8:11], s36 offen offset:128 lds
    v_mfma_f32_16x16x32_bf16 v[128:131], a[236:239], a[48:51], v[128:131]
    s_addk_i32 m0, 896
    ds_read_b64_tr_b16 a[226:227], v10 offset:31744
    v_mfma_f32_16x16x32_bf16 v[136:139], a[236:239], a[52:55], v[136:139]
    ds_read_b64_tr_b16 a[228:229], v10 offset:37888
    v_mfma_f32_16x16x32_bf16 v[136:139], a[232:235], a[36:39], v[136:139]
    ds_read_b64_tr_b16 a[230:231], v10 offset:44032
    v_mfma_f32_16x16x32_bf16 v[144:147], a[232:235], a[40:43], v[144:147]
    v_mfma_f32_16x16x32_bf16 v[144:147], a[236:239], a[56:59], v[144:147]
    s_waitcnt lgkmcnt(4)
    v_mfma_f32_16x16x32_bf16 v[152:155], a[236:239], a[60:63], v[152:155]
    buffer_load_dwordx4 v2, s[8:11], s36 offen offset:256 lds
    v_mfma_f32_16x16x32_bf16 v[152:155], a[232:235], a[44:47], v[152:155]
    s_addk_i32 m0, 1280
    ds_read_b64_tr_b16 a[232:233], v11 offset:25600
    v_mfma_f32_16x16x32_bf16 v[156:159], a[240:243], a[44:47], v[156:159]
    ds_read_b64_tr_b16 a[234:235], v11 offset:31744
    v_mfma_f32_16x16x32_bf16 v[156:159], a[244:247], a[60:63], v[156:159]
    ds_read_b64_tr_b16 a[236:237], v11 offset:37888
    v_mfma_f32_16x16x32_bf16 v[148:151], a[244:247], a[56:59], v[148:151]
    ds_read_b64_tr_b16 a[238:239], v11 offset:44032
    v_mfma_f32_16x16x32_bf16 v[148:151], a[240:243], a[40:43], v[148:151]
    v_mfma_f32_16x16x32_bf16 v[140:143], a[240:243], a[36:39], v[140:143]
    buffer_load_dwordx4 v3, s[8:11], s36 offen offset:0 lds
    v_mfma_f32_16x16x32_bf16 v[140:143], a[244:247], a[52:55], v[140:143]
    s_waitcnt lgkmcnt(4)
    s_addk_i32 m0, 896
    v_mfma_f32_16x16x32_bf16 v[132:135], a[244:247], a[48:51], v[132:135]
    v_mfma_f32_16x16x32_bf16 v[132:135], a[240:243], a[32:35], v[132:135]
    ds_read_b64_tr_b16 a[240:241], v8 offset:26624
    v_mfma_f32_16x16x32_bf16 v[160:163], a[224:227], a[32:35], v[160:163]
    ds_read_b64_tr_b16 a[242:243], v8 offset:32768
    v_mfma_f32_16x16x32_bf16 v[160:163], a[228:231], a[48:51], v[160:163]
    ds_read_b64_tr_b16 a[244:245], v8 offset:38912
    v_mfma_f32_16x16x32_bf16 v[168:171], a[228:231], a[52:55], v[168:171]
    global_load_dwordx4 v[48:51], v23, s[64:65]
    v_mfma_f32_16x16x32_bf16 v[168:171], a[224:227], a[36:39], v[168:171]
    global_load_dwordx4 v[52:55], v23, s[64:65] offset:64
    v_mfma_f32_16x16x32_bf16 v[176:179], a[224:227], a[40:43], v[176:179]
    buffer_load_dwordx2 v[40:41], v24, s[24:27], 0 offen sc1
    v_mfma_f32_16x16x32_bf16 v[176:179], a[228:231], a[56:59], v[176:179]
    buffer_load_dwordx4 v3, s[8:11], s36 offen offset:128 lds
    v_mfma_f32_16x16x32_bf16 v[184:187], a[228:231], a[60:63], v[184:187]
    s_waitcnt lgkmcnt(2)
    ds_read_b64_tr_b16 a[246:247], v8 offset:45056
    s_addk_i32 m0, 896
    v_mfma_f32_16x16x32_bf16 v[184:187], a[224:227], a[44:47], v[184:187]
    ds_read_b64_tr_b16 a[224:225], v9 offset:26624
    v_mfma_f32_16x16x32_bf16 v[188:191], a[232:235], a[44:47], v[188:191]
    buffer_load_dwordx4 v3, s[8:11], s36 offen offset:256 lds
    v_mfma_f32_16x16x32_bf16 v[188:191], a[236:239], a[60:63], v[188:191]
    s_add_u32 s36, s36, s37
    ds_read_b64_tr_b16 a[226:227], v9 offset:32768
    s_sub_u32 s55, s36, 7864320
    v_mfma_f32_16x16x32_bf16 v[180:183], a[236:239], a[56:59], v[180:183]
    s_min_u32 s36, s36, s55
    ds_read_b64_tr_b16 a[228:229], v9 offset:38912
    s_add_u32 s46, s45, 57344
    v_mfma_f32_16x16x32_bf16 v[180:183], a[232:235], a[40:43], v[180:183]
    s_sub_u32 s77, s46, 81920
    ds_read_b64_tr_b16 a[230:231], v9 offset:45056
    s_min_u32 s46, s46, s77
    v_mfma_f32_16x16x32_bf16 v[172:175], a[232:235], a[36:39], v[172:175]
    s_xor_b32 s77, s46, 1024
    v_add_u32 v8, 49152, v8
    v_mfma_f32_16x16x32_bf16 v[172:175], a[236:239], a[52:55], v[172:175]
    s_waitcnt lgkmcnt(4)
    v_add_u32 v9, 49152, v9
    v_mfma_f32_16x16x32_bf16 v[164:167], a[236:239], a[48:51], v[164:167]
    buffer_load_dwordx4 a[160:163], v14, s[20:23], s46 offen sc1
    v_mfma_f32_16x16x32_bf16 v[164:167], a[232:235], a[32:35], v[164:167]
    ds_read_b64_tr_b16 a[232:233], v10 offset:26624
    v_mfma_f32_16x16x32_bf16 v[192:195], a[240:243], a[32:35], v[192:195]
    ds_read_b64_tr_b16 a[234:235], v10 offset:32768
    v_mfma_f32_16x16x32_bf16 v[192:195], a[244:247], a[48:51], v[192:195]
    ds_read_b64_tr_b16 a[236:237], v10 offset:38912
    v_mfma_f32_16x16x32_bf16 v[200:203], a[244:247], a[52:55], v[200:203]
    ds_read_b64_tr_b16 a[238:239], v10 offset:45056
    v_mfma_f32_16x16x32_bf16 v[200:203], a[240:243], a[36:39], v[200:203]
    v_add_u32 v10, 49152, v10
    v_mfma_f32_16x16x32_bf16 v[208:211], a[240:243], a[40:43], v[208:211]
    buffer_load_dwordx4 a[164:167], v14, s[20:23], s77 offen sc1
    v_mfma_f32_16x16x32_bf16 v[208:211], a[244:247], a[56:59], v[208:211]
    s_waitcnt lgkmcnt(4)
    v_mfma_f32_16x16x32_bf16 v[216:219], a[244:247], a[60:63], v[216:219]
    v_mfma_f32_16x16x32_bf16 v[216:219], a[240:243], a[44:47], v[216:219]
    ds_read_b64_tr_b16 a[240:241], v11 offset:26624
    ds_read_b64_tr_b16 a[242:243], v11 offset:32768
    ds_read_b64_tr_b16 a[244:245], v11 offset:38912
    v_mfma_f32_16x16x32_bf16 v[220:223], a[224:227], a[44:47], v[220:223]
    ds_read_b64_tr_b16 a[246:247], v11 offset:45056
    v_mfma_f32_16x16x32_bf16 v[220:223], a[228:231], a[60:63], v[220:223]
    v_add_u32 v11, 49152, v11
    v_mfma_f32_16x16x32_bf16 v[212:215], a[228:231], a[56:59], v[212:215]
    buffer_load_dwordx4 a[168:171], v15, s[20:23], s46 offen sc1
    v_mfma_f32_16x16x32_bf16 v[212:215], a[224:227], a[40:43], v[212:215]
    v_mfma_f32_16x16x32_bf16 v[204:207], a[224:227], a[36:39], v[204:207]
    v_mfma_f32_16x16x32_bf16 v[204:207], a[228:231], a[52:55], v[204:207]
    s_waitcnt lgkmcnt(4)
    v_mfma_f32_16x16x32_bf16 v[196:199], a[228:231], a[48:51], v[196:199]
    s_waitcnt lgkmcnt(0)
    s_barrier
    v_mfma_f32_16x16x32_bf16 v[196:199], a[224:227], a[32:35], v[196:199]
    ds_read_b64_tr_b16 a[224:225], v8 offset:0
    v_mfma_f32_16x16x32_bf16 v[224:227], a[232:235], a[32:35], v[224:227]
    buffer_load_dwordx4 a[172:175], v15, s[20:23], s77 offen sc1
    v_mfma_f32_16x16x32_bf16 v[224:227], a[236:239], a[48:51], v[224:227]
    s_add_u32 m0, s44, 147456
    ds_read_b64_tr_b16 a[226:227], v8 offset:6144
    v_mfma_f32_16x16x32_bf16 v[232:235], a[236:239], a[52:55], v[232:235]
    ds_read_b64_tr_b16 a[228:229], v8 offset:12288
    v_mfma_f32_16x16x32_bf16 v[232:235], a[232:235], a[36:39], v[232:235]
    ds_read_b64_tr_b16 a[230:231], v8 offset:18432
    v_mfma_f32_16x16x32_bf16 v[240:243], a[232:235], a[40:43], v[240:243]
    v_mfma_f32_16x16x32_bf16 v[240:243], a[236:239], a[56:59], v[240:243]
    v_mfma_f32_16x16x32_bf16 v[248:251], a[236:239], a[60:63], v[248:251]
    buffer_load_dwordx4 v56, s[28:31], s60 offen lds
    v_mfma_f32_16x16x32_bf16 v[248:251], a[232:235], a[44:47], v[248:251]
    s_addk_i32 m0, 1024
    ds_read_b64_tr_b16 a[232:233], v9 offset:0
    v_mfma_f32_16x16x32_bf16 v[252:255], a[240:243], a[44:47], v[252:255]
    ds_read_b64_tr_b16 a[234:235], v9 offset:6144
    v_mfma_f32_16x16x32_bf16 v[252:255], a[244:247], a[60:63], v[252:255]
    ds_read_b64_tr_b16 a[236:237], v9 offset:12288
    v_mfma_f32_16x16x32_bf16 v[244:247], a[244:247], a[56:59], v[244:247]
    ds_read_b64_tr_b16 a[238:239], v9 offset:18432
    v_mfma_f32_16x16x32_bf16 v[244:247], a[240:243], a[40:43], v[244:247]
    v_mfma_f32_16x16x32_bf16 v[236:239], a[240:243], a[36:39], v[236:239]
    buffer_load_dwordx4 v56, s[32:35], s60 offen lds
    v_mfma_f32_16x16x32_bf16 v[236:239], a[244:247], a[52:55], v[236:239]
    s_waitcnt vmcnt(22) lgkmcnt(4)
    s_addk_i32 m0, 1024
    v_mfma_f32_16x16x32_bf16 v[228:231], a[244:247], a[48:51], v[228:231]
    s_waitcnt vmcnt(18)
    v_mfma_f32_16x16x32_bf16 v[228:231], a[240:243], a[32:35], v[228:231]
    s_waitcnt vmcnt(17)
    ds_read_b64_tr_b16 a[240:241], v10 offset:0
    v_mfma_f32_16x16x32_bf16 v[64:67], a[224:227], a[64:67], v[64:67]
    ds_read_b64_tr_b16 a[242:243], v10 offset:6144
    v_mfma_f32_16x16x32_bf16 v[64:67], a[228:231], a[80:83], v[64:67]
    ds_read_b64_tr_b16 a[244:245], v10 offset:12288
    v_mfma_f32_16x16x32_bf16 v[72:75], a[228:231], a[84:87], v[72:75]
    buffer_load_dwordx4 v57, s[28:31], s60 offen lds
    v_mfma_f32_16x16x32_bf16 v[72:75], a[224:227], a[68:71], v[72:75]
    s_waitcnt vmcnt(16)
    ds_read_b64_tr_b16 a[246:247], v10 offset:18432
    s_addk_i32 m0, 1024
    v_mfma_f32_16x16x32_bf16 v[80:83], a[224:227], a[72:75], v[80:83]
    v_mfma_f32_16x16x32_bf16 v[80:83], a[228:231], a[88:91], v[80:83]
    s_waitcnt lgkmcnt(4)
    v_mfma_f32_16x16x32_bf16 v[88:91], a[228:231], a[92:95], v[88:91]
    v_mfma_f32_16x16x32_bf16 v[88:91], a[224:227], a[76:79], v[88:91]
    ds_read_b64_tr_b16 a[224:225], v11 offset:0
    v_mfma_f32_16x16x32_bf16 v[92:95], a[232:235], a[76:79], v[92:95]
    buffer_load_dwordx4 v57, s[32:35], s60 offen lds
    v_mfma_f32_16x16x32_bf16 v[92:95], a[236:239], a[92:95], v[92:95]
    s_add_u32 s46, s45, 61440
    ds_read_b64_tr_b16 a[226:227], v11 offset:6144
    s_sub_u32 s77, s46, 81920
    v_mfma_f32_16x16x32_bf16 v[84:87], a[236:239], a[88:91], v[84:87]
    s_min_u32 s46, s46, s77
    ds_read_b64_tr_b16 a[228:229], v11 offset:12288
    s_xor_b32 s77, s46, 1024
    v_mfma_f32_16x16x32_bf16 v[84:87], a[232:235], a[72:75], v[84:87]
    ds_read_b64_tr_b16 a[230:231], v11 offset:18432
    v_mfma_f32_16x16x32_bf16 v[76:79], a[232:235], a[68:71], v[76:79]
    v_mfma_f32_16x16x32_bf16 v[76:79], a[236:239], a[84:87], v[76:79]
    s_waitcnt lgkmcnt(4)
    v_mfma_f32_16x16x32_bf16 v[68:71], a[236:239], a[80:83], v[68:71]
    buffer_load_dwordx4 a[176:179], v14, s[20:23], s46 offen sc1
    v_mfma_f32_16x16x32_bf16 v[68:71], a[232:235], a[64:67], v[68:71]
    ds_read_b64_tr_b16 a[232:233], v8 offset:1024
    v_mfma_f32_16x16x32_bf16 v[96:99], a[240:243], a[64:67], v[96:99]
    ds_read_b64_tr_b16 a[234:235], v8 offset:7168
    v_mfma_f32_16x16x32_bf16 v[96:99], a[244:247], a[80:83], v[96:99]
    ds_read_b64_tr_b16 a[236:237], v8 offset:13312
    v_mfma_f32_16x16x32_bf16 v[104:107], a[244:247], a[84:87], v[104:107]
    ds_read_b64_tr_b16 a[238:239], v8 offset:19456
    v_mfma_f32_16x16x32_bf16 v[104:107], a[240:243], a[68:71], v[104:107]
    v_mfma_f32_16x16x32_bf16 v[112:115], a[240:243], a[72:75], v[112:115]
    buffer_load_dwordx4 a[180:183], v14, s[20:23], s77 offen sc1
    v_mfma_f32_16x16x32_bf16 v[112:115], a[244:247], a[88:91], v[112:115]
    s_waitcnt lgkmcnt(4)
    v_mfma_f32_16x16x32_bf16 v[120:123], a[244:247], a[92:95], v[120:123]
    s_add_u32 s88, s88, 32768
    s_addc_u32 s89, s89, 0
    v_mfma_f32_16x16x32_bf16 v[120:123], a[240:243], a[76:79], v[120:123]
    ds_read_b64_tr_b16 a[240:241], v9 offset:1024
    v_mfma_f32_16x16x32_bf16 v[124:127], a[224:227], a[76:79], v[124:127]
    global_load_dword a252, v18, s[88:89]
    v_mfma_f32_16x16x32_bf16 v[124:127], a[228:231], a[92:95], v[124:127]
    ds_read_b64_tr_b16 a[242:243], v9 offset:7168
    v_mfma_f32_16x16x32_bf16 v[116:119], a[228:231], a[88:91], v[116:119]
    buffer_load_dwordx4 a[184:187], v15, s[20:23], s46 offen sc1
    v_mfma_f32_16x16x32_bf16 v[116:119], a[224:227], a[72:75], v[116:119]
    ds_read_b64_tr_b16 a[244:245], v9 offset:13312
    v_mfma_f32_16x16x32_bf16 v[108:111], a[224:227], a[68:71], v[108:111]
    ds_read_b64_tr_b16 a[246:247], v9 offset:19456
    v_mfma_f32_16x16x32_bf16 v[108:111], a[228:231], a[84:87], v[108:111]
    s_waitcnt lgkmcnt(4)
    v_mfma_f32_16x16x32_bf16 v[100:103], a[228:231], a[80:83], v[100:103]
    v_mfma_f32_16x16x32_bf16 v[100:103], a[224:227], a[64:67], v[100:103]
    ds_read_b64_tr_b16 a[224:225], v10 offset:1024
    v_mfma_f32_16x16x32_bf16 v[128:131], a[232:235], a[64:67], v[128:131]
    buffer_load_dwordx4 a[188:191], v15, s[20:23], s77 offen sc1
    v_mfma_f32_16x16x32_bf16 v[128:131], a[236:239], a[80:83], v[128:131]
    s_add_u32 s46, s45, 65536
    ds_read_b64_tr_b16 a[226:227], v10 offset:7168
    s_sub_u32 s77, s46, 81920
    v_mfma_f32_16x16x32_bf16 v[136:139], a[236:239], a[84:87], v[136:139]
    s_min_u32 s46, s46, s77
    ds_read_b64_tr_b16 a[228:229], v10 offset:13312
    s_xor_b32 s77, s46, 1024
    v_mfma_f32_16x16x32_bf16 v[136:139], a[232:235], a[68:71], v[136:139]
    ds_read_b64_tr_b16 a[230:231], v10 offset:19456
    v_mfma_f32_16x16x32_bf16 v[144:147], a[232:235], a[72:75], v[144:147]
    v_mfma_f32_16x16x32_bf16 v[144:147], a[236:239], a[88:91], v[144:147]
    s_waitcnt lgkmcnt(4)
    v_mfma_f32_16x16x32_bf16 v[152:155], a[236:239], a[92:95], v[152:155]
    buffer_load_dwordx4 a[96:99], v14, s[20:23], s46 offen sc1
    v_mfma_f32_16x16x32_bf16 v[152:155], a[232:235], a[76:79], v[152:155]
    ds_read_b64_tr_b16 a[232:233], v11 offset:1024
    v_mfma_f32_16x16x32_bf16 v[156:159], a[240:243], a[76:79], v[156:159]
    ds_read_b64_tr_b16 a[234:235], v11 offset:7168
    v_mfma_f32_16x16x32_bf16 v[156:159], a[244:247], a[92:95], v[156:159]
    ds_read_b64_tr_b16 a[236:237], v11 offset:13312
    v_mfma_f32_16x16x32_bf16 v[148:151], a[244:247], a[88:91], v[148:151]
    ds_read_b64_tr_b16 a[238:239], v11 offset:19456
    v_mfma_f32_16x16x32_bf16 v[148:151], a[240:243], a[72:75], v[148:151]
    v_mfma_f32_16x16x32_bf16 v[140:143], a[240:243], a[68:71], v[140:143]
    buffer_load_dwordx4 a[100:103], v14, s[20:23], s77 offen sc1
    v_mfma_f32_16x16x32_bf16 v[140:143], a[244:247], a[84:87], v[140:143]
    s_waitcnt lgkmcnt(4)
    v_mfma_f32_16x16x32_bf16 v[132:135], a[244:247], a[80:83], v[132:135]
    v_mfma_f32_16x16x32_bf16 v[132:135], a[240:243], a[64:67], v[132:135]
    ds_read_b64_tr_b16 a[240:241], v8 offset:2048
    v_mfma_f32_16x16x32_bf16 v[160:163], a[224:227], a[64:67], v[160:163]
    ds_read_b64_tr_b16 a[242:243], v8 offset:8192
    v_mfma_f32_16x16x32_bf16 v[160:163], a[228:231], a[80:83], v[160:163]
    ds_read_b64_tr_b16 a[244:245], v8 offset:14336
    v_mfma_f32_16x16x32_bf16 v[168:171], a[228:231], a[84:87], v[168:171]
    buffer_load_dwordx4 a[104:107], v15, s[20:23], s46 offen sc1
    v_mfma_f32_16x16x32_bf16 v[168:171], a[224:227], a[68:71], v[168:171]
    ds_read_b64_tr_b16 a[246:247], v8 offset:20480
    v_mfma_f32_16x16x32_bf16 v[176:179], a[224:227], a[72:75], v[176:179]
    v_mfma_f32_16x16x32_bf16 v[176:179], a[228:231], a[88:91], v[176:179]
    s_waitcnt lgkmcnt(4)
    v_mfma_f32_16x16x32_bf16 v[184:187], a[228:231], a[92:95], v[184:187]
    s_waitcnt vmcnt(20)
    v_lshlrev_b32 v42, 16, v48
    v_and_b32 v43, 0xffff0000, v48
    v_mfma_f32_16x16x32_bf16 v[184:187], a[224:227], a[76:79], v[184:187]
    ds_read_b64_tr_b16 a[224:225], v9 offset:2048
    v_mfma_f32_16x16x32_bf16 v[188:191], a[232:235], a[76:79], v[188:191]
    buffer_load_dwordx4 a[108:111], v15, s[20:23], s77 offen sc1
    v_mfma_f32_16x16x32_bf16 v[188:191], a[236:239], a[92:95], v[188:191]
    s_add_u32 s46, s45, 69632
    ds_read_b64_tr_b16 a[226:227], v9 offset:8192
    s_sub_u32 s77, s46, 81920
    v_mfma_f32_16x16x32_bf16 v[180:183], a[236:239], a[88:91], v[180:183]
    s_min_u32 s46, s46, s77
    ds_read_b64_tr_b16 a[228:229], v9 offset:14336
    s_xor_b32 s77, s46, 1024
    v_mfma_f32_16x16x32_bf16 v[180:183], a[232:235], a[72:75], v[180:183]
    s_waitcnt vmcnt(19)
    ds_read_b64_tr_b16 a[230:231], v9 offset:20480
    v_sub_f32 v42, v42, v40
    v_mfma_f32_16x16x32_bf16 v[172:175], a[232:235], a[68:71], v[172:175]
    v_sub_f32 v43, v43, v40
    v_cvt_pk_bf16_f32 v42, 0, v42
    v_mfma_f32_16x16x32_bf16 v[172:175], a[236:239], a[84:87], v[172:175]
    s_waitcnt lgkmcnt(4)
    v_cvt_pk_bf16_f32 v43, 0, v43
    v_mul_f32 v42, v42, v41
    v_mfma_f32_16x16x32_bf16 v[164:167], a[236:239], a[80:83], v[164:167]
    buffer_load_dwordx4 a[112:115], v14, s[20:23], s46 offen sc1
    v_mfma_f32_16x16x32_bf16 v[164:167], a[232:235], a[64:67], v[164:167]
    ds_read_b64_tr_b16 a[232:233], v10 offset:2048
    v_mul_f32 v43, v43, v41
    v_mfma_f32_16x16x32_bf16 v[192:195], a[240:243], a[64:67], v[192:195]
    ds_read_b64_tr_b16 a[234:235], v10 offset:8192
    v_cvt_pk_bf16_f32 v48, v42, v43
    v_mfma_f32_16x16x32_bf16 v[192:195], a[244:247], a[80:83], v[192:195]
    ds_read_b64_tr_b16 a[236:237], v10 offset:14336
    v_lshlrev_b32 v42, 16, v49
    v_mfma_f32_16x16x32_bf16 v[200:203], a[244:247], a[84:87], v[200:203]
    ds_read_b64_tr_b16 a[238:239], v10 offset:20480
    v_and_b32 v43, 0xffff0000, v49
    v_mfma_f32_16x16x32_bf16 v[200:203], a[240:243], a[68:71], v[200:203]
    v_sub_f32 v42, v42, v40
    v_sub_f32 v43, v43, v40
    v_mfma_f32_16x16x32_bf16 v[208:211], a[240:243], a[72:75], v[208:211]
    buffer_load_dwordx4 a[116:119], v14, s[20:23], s77 offen sc1
    v_mfma_f32_16x16x32_bf16 v[208:211], a[244:247], a[88:91], v[208:211]
    s_waitcnt lgkmcnt(4)
    v_cvt_pk_bf16_f32 v42, 0, v42
    v_cvt_pk_bf16_f32 v43, 0, v43
    v_mfma_f32_16x16x32_bf16 v[216:219], a[244:247], a[92:95], v[216:219]
pg_3:
    s_cbranch_execz pg_7
    v_mul_f32 v42, v42, v41
    v_mul_f32 v43, v43, v41
    v_mfma_f32_16x16x32_bf16 v[216:219], a[240:243], a[76:79], v[216:219]
    ds_read_b64_tr_b16 a[240:241], v11 offset:2048
    v_cvt_pk_bf16_f32 v49, v42, v43
    ds_read_b64_tr_b16 a[242:243], v11 offset:8192
    v_mfma_f32_16x16x32_bf16 v[220:223], a[224:227], a[76:79], v[220:223]
    ds_read_b64_tr_b16 a[244:245], v11 offset:14336
    v_lshlrev_b32 v42, 16, v50
    ds_read_b64_tr_b16 a[246:247], v11 offset:20480
    v_mfma_f32_16x16x32_bf16 v[220:223], a[228:231], a[92:95], v[220:223]
    v_and_b32 v43, 0xffff0000, v50
    v_sub_f32 v42, v42, v40
    v_mfma_f32_16x16x32_bf16 v[212:215], a[228:231], a[88:91], v[212:215]
    buffer_load_dwordx4 a[120:123], v15, s[20:23], s46 offen sc1
    v_mfma_f32_16x16x32_bf16 v[212:215], a[224:227], a[72:75], v[212:215]
    v_sub_f32 v43, v43, v40
    v_cvt_pk_bf16_f32 v42, 0, v42
    v_mfma_f32_16x16x32_bf16 v[204:207], a[224:227], a[68:71], v[204:207]
    v_cvt_pk_bf16_f32 v43, 0, v43
    v_mul_f32 v42, v42, v41
    v_mfma_f32_16x16x32_bf16 v[204:207], a[228:231], a[84:87], v[204:207]
    s_waitcnt lgkmcnt(4)
    v_mul_f32 v43, v43, v41
    v_cvt_pk_bf16_f32 v50, v42, v43
    v_mfma_f32_16x16x32_bf16 v[196:199], a[228:231], a[80:83], v[196:199]
    s_waitcnt vmcnt(12) lgkmcnt(0)
    s_barrier
    v_mfma_f32_16x16x32_bf16 v[196:199], a[224:227], a[64:67], v[196:199]
    ds_read_b64_tr_b16 a[224:225], v8 offset:24576
    v_lshlrev_b32 v42, 16, v51
    v_mfma_f32_16x16x32_bf16 v[224:227], a[232:235], a[64:67], v[224:227]
    buffer_load_dwordx4 a[124:127], v15, s[20:23], s77 offen sc1
    v_mfma_f32_16x16x32_bf16 v[224:227], a[236:239], a[80:83], v[224:227]
    s_add_u32 s46, s45, 73728
    ds_read_b64_tr_b16 a[226:227], v8 offset:30720
    v_and_b32 v43, 0xffff0000, v51
    v_mfma_f32_16x16x32_bf16 v[232:235], a[236:239], a[84:87], v[232:235]
    s_sub_u32 s77, s46, 81920
    ds_read_b64_tr_b16 a[228:229], v8 offset:36864
    v_sub_f32 v42, v42, v40
    v_mfma_f32_16x16x32_bf16 v[232:235], a[232:235], a[68:71], v[232:235]
    s_min_u32 s46, s46, s77
    ds_read_b64_tr_b16 a[230:231], v8 offset:43008
    v_sub_f32 v43, v43, v40
    v_mfma_f32_16x16x32_bf16 v[240:243], a[232:235], a[72:75], v[240:243]
    s_xor_b32 s77, s46, 1024
    v_cvt_pk_bf16_f32 v42, 0, v42
    v_cvt_pk_bf16_f32 v43, 0, v43
    v_mfma_f32_16x16x32_bf16 v[240:243], a[236:239], a[88:91], v[240:243]
    v_mul_f32 v42, v42, v41
    v_mul_f32 v43, v43, v41
    v_mfma_f32_16x16x32_bf16 v[248:251], a[236:239], a[92:95], v[248:251]
    buffer_load_dwordx4 a[128:131], v14, s[20:23], s46 offen sc1
    v_mfma_f32_16x16x32_bf16 v[248:251], a[232:235], a[76:79], v[248:251]
    ds_read_b64_tr_b16 a[232:233], v9 offset:24576
    v_cvt_pk_bf16_f32 v51, v42, v43
    v_mfma_f32_16x16x32_bf16 v[252:255], a[240:243], a[76:79], v[252:255]
    ds_read_b64_tr_b16 a[234:235], v9 offset:30720
    v_lshlrev_b32 v42, 16, v52
    v_mfma_f32_16x16x32_bf16 v[252:255], a[244:247], a[92:95], v[252:255]
    ds_read_b64_tr_b16 a[236:237], v9 offset:36864
    v_and_b32 v43, 0xffff0000, v52
    v_mfma_f32_16x16x32_bf16 v[244:247], a[244:247], a[88:91], v[244:247]
    ds_read_b64_tr_b16 a[238:239], v9 offset:43008
    v_sub_f32 v42, v42, v40
    v_mfma_f32_16x16x32_bf16 v[244:247], a[240:243], a[72:75], v[244:247]
    v_sub_f32 v43, v43, v40
    v_cvt_pk_bf16_f32 v42, 0, v42
    v_mfma_f32_16x16x32_bf16 v[236:239], a[240:243], a[68:71], v[236:239]
    buffer_load_dwordx4 a[132:135], v14, s[20:23], s77 offen sc1
    v_mfma_f32_16x16x32_bf16 v[236:239], a[244:247], a[84:87], v[236:239]
    s_waitcnt lgkmcnt(4)
    v_cvt_pk_bf16_f32 v43, 0, v43
    v_mul_f32 v42, v42, v41
    v_mfma_f32_16x16x32_bf16 v[228:231], a[244:247], a[80:83], v[228:231]
    s_waitcnt vmcnt(14)
    v_mul_f32 v43, v43, v41
    v_cvt_pk_bf16_f32 v52, v42, v43
    v_mfma_f32_16x16x32_bf16 v[228:231], a[240:243], a[64:67], v[228:231]
    s_waitcnt vmcnt(13)
    ds_read_b64_tr_b16 a[240:241], v10 offset:24576
    v_lshlrev_b32 v42, 16, v53
    v_mfma_f32_16x16x32_bf16 v[64:67], a[224:227], a[160:163], v[64:67]
    ds_read_b64_tr_b16 a[242:243], v10 offset:30720
    v_and_b32 v43, 0xffff0000, v53
    v_mfma_f32_16x16x32_bf16 v[64:67], a[228:231], a[176:179], v[64:67]
    ds_read_b64_tr_b16 a[244:245], v10 offset:36864
    v_sub_f32 v42, v42, v40
    v_mfma_f32_16x16x32_bf16 v[72:75], a[228:231], a[180:183], v[72:75]
    buffer_load_dwordx4 a[136:139], v15, s[20:23], s46 offen sc1
    v_mfma_f32_16x16x32_bf16 v[72:75], a[224:227], a[164:167], v[72:75]
    s_waitcnt vmcnt(11)
    ds_read_b64_tr_b16 a[246:247], v10 offset:43008
    v_sub_f32 v43, v43, v40
    v_mfma_f32_16x16x32_bf16 v[80:83], a[224:227], a[168:171], v[80:83]
    v_cvt_pk_bf16_f32 v42, 0, v42
    v_cvt_pk_bf16_f32 v43, 0, v43
    v_mfma_f32_16x16x32_bf16 v[80:83], a[228:231], a[184:187], v[80:83]
    s_waitcnt lgkmcnt(4)
    v_mul_f32 v42, v42, v41
    v_mul_f32 v43, v43, v41
    v_mfma_f32_16x16x32_bf16 v[88:91], a[228:231], a[188:191], v[88:91]
    v_cvt_pk_bf16_f32 v53, v42, v43
    v_lshlrev_b32 v42, 16, v54
    v_mfma_f32_16x16x32_bf16 v[88:91], a[224:227], a[172:175], v[88:91]
    ds_read_b64_tr_b16 a[224:225], v11 offset:24576
    v_and_b32 v43, 0xffff0000, v54
    v_mfma_f32_16x16x32_bf16 v[92:95], a[232:235], a[172:175], v[92:95]
    buffer_load_dwordx4 a[140:143], v15, s[20:23], s77 offen sc1
    v_mfma_f32_16x16x32_bf16 v[92:95], a[236:239], a[188:191], v[92:95]
    s_add_u32 s46, s45, 77824
    ds_read_b64_tr_b16 a[226:227], v11 offset:30720
    v_sub_f32 v42, v42, v40
    v_mfma_f32_16x16x32_bf16 v[84:87], a[236:239], a[184:187], v[84:87]
    s_sub_u32 s77, s46, 81920
    ds_read_b64_tr_b16 a[228:229], v11 offset:36864
    v_sub_f32 v43, v43, v40
    v_mfma_f32_16x16x32_bf16 v[84:87], a[232:235], a[168:171], v[84:87]
    s_min_u32 s46, s46, s77
    ds_read_b64_tr_b16 a[230:231], v11 offset:43008
    v_cvt_pk_bf16_f32 v42, 0, v42
    v_mfma_f32_16x16x32_bf16 v[76:79], a[232:235], a[164:167], v[76:79]
    s_xor_b32 s77, s46, 1024
    v_cvt_pk_bf16_f32 v43, 0, v43
    v_mul_f32 v42, v42, v41
    v_mfma_f32_16x16x32_bf16 v[76:79], a[236:239], a[180:183], v[76:79]
    s_waitcnt lgkmcnt(4)
    v_mul_f32 v43, v43, v41
    v_cvt_pk_bf16_f32 v54, v42, v43
    v_mfma_f32_16x16x32_bf16 v[68:71], a[236:239], a[176:179], v[68:71]
    buffer_load_dwordx4 a[144:147], v14, s[20:23], s46 offen sc1
    v_mfma_f32_16x16x32_bf16 v[68:71], a[232:235], a[160:163], v[68:71]
    ds_read_b64_tr_b16 a[232:233], v8 offset:25600
    v_lshlrev_b32 v42, 16, v55
    v_mfma_f32_16x16x32_bf16 v[96:99], a[240:243], a[160:163], v[96:99]
    ds_read_b64_tr_b16 a[234:235], v8 offset:31744
    v_and_b32 v43, 0xffff0000, v55
    v_mfma_f32_16x16x32_bf16 v[96:99], a[244:247], a[176:179], v[96:99]
    ds_read_b64_tr_b16 a[236:237], v8 offset:37888
    v_sub_f32 v42, v42, v40
    v_mfma_f32_16x16x32_bf16 v[104:107], a[244:247], a[180:183], v[104:107]
    ds_read_b64_tr_b16 a[238:239], v8 offset:44032
    v_sub_f32 v43, v43, v40
    v_mfma_f32_16x16x32_bf16 v[104:107], a[240:243], a[164:167], v[104:107]
    v_cvt_pk_bf16_f32 v42, 0, v42
    v_cvt_pk_bf16_f32 v43, 0, v43
    v_mfma_f32_16x16x32_bf16 v[112:115], a[240:243], a[168:171], v[112:115]
    buffer_load_dwordx4 a[148:151], v14, s[20:23], s77 offen sc1
    v_mfma_f32_16x16x32_bf16 v[112:115], a[244:247], a[184:187], v[112:115]
    s_waitcnt lgkmcnt(4)
    v_mul_f32 v42, v42, v41
    v_mul_f32 v43, v43, v41
    v_mfma_f32_16x16x32_bf16 v[120:123], a[244:247], a[188:191], v[120:123]
    v_cvt_pk_bf16_f32 v55, v42, v43
    v_mfma_f32_16x16x32_bf16 v[120:123], a[240:243], a[172:175], v[120:123]
    ds_read_b64_tr_b16 a[240:241], v9 offset:25600
    v_mfma_f32_16x16x32_bf16 v[124:127], a[224:227], a[172:175], v[124:127]
    ds_read_b64_tr_b16 a[242:243], v9 offset:31744
    v_mfma_f32_16x16x32_bf16 v[124:127], a[228:231], a[188:191], v[124:127]
    ds_read_b64_tr_b16 a[244:245], v9 offset:37888
    v_mfma_f32_16x16x32_bf16 v[116:119], a[228:231], a[184:187], v[116:119]
    buffer_load_dwordx4 a[152:155], v15, s[20:23], s46 offen sc1
    v_mfma_f32_16x16x32_bf16 v[116:119], a[224:227], a[168:171], v[116:119]
    ds_read_b64_tr_b16 a[246:247], v9 offset:44032
    v_mfma_f32_16x16x32_bf16 v[108:111], a[224:227], a[164:167], v[108:111]
    v_mfma_f32_16x16x32_bf16 v[108:111], a[228:231], a[180:183], v[108:111]
    s_waitcnt lgkmcnt(4)
    v_mfma_f32_16x16x32_bf16 v[100:103], a[228:231], a[176:179], v[100:103]
    v_mfma_f32_16x16x32_bf16 v[100:103], a[224:227], a[160:163], v[100:103]
    ds_read_b64_tr_b16 a[224:225], v10 offset:25600
    v_mfma_f32_16x16x32_bf16 v[128:131], a[232:235], a[160:163], v[128:131]
    buffer_load_dwordx4 a[156:159], v15, s[20:23], s77 offen sc1
    v_mfma_f32_16x16x32_bf16 v[128:131], a[236:239], a[176:179], v[128:131]
    s_add_u32 m0, s49, 0
    ds_read_b64_tr_b16 a[226:227], v10 offset:31744
    v_mfma_f32_16x16x32_bf16 v[136:139], a[236:239], a[180:183], v[136:139]
    ds_read_b64_tr_b16 a[228:229], v10 offset:37888
    v_mfma_f32_16x16x32_bf16 v[136:139], a[232:235], a[164:167], v[136:139]
    ds_read_b64_tr_b16 a[230:231], v10 offset:44032
    v_mfma_f32_16x16x32_bf16 v[144:147], a[232:235], a[168:171], v[144:147]
    v_mfma_f32_16x16x32_bf16 v[144:147], a[236:239], a[184:187], v[144:147]
    s_waitcnt lgkmcnt(4)
    v_mfma_f32_16x16x32_bf16 v[152:155], a[236:239], a[188:191], v[152:155]
    buffer_load_dwordx4 v4, s[12:15], s38 offen offset:0 lds
    v_mfma_f32_16x16x32_bf16 v[152:155], a[232:235], a[172:175], v[152:155]
    s_addk_i32 m0, 896
    ds_read_b64_tr_b16 a[232:233], v11 offset:25600
    v_mfma_f32_16x16x32_bf16 v[156:159], a[240:243], a[172:175], v[156:159]
    ds_read_b64_tr_b16 a[234:235], v11 offset:31744
    v_mfma_f32_16x16x32_bf16 v[156:159], a[244:247], a[188:191], v[156:159]
    ds_read_b64_tr_b16 a[236:237], v11 offset:37888
    v_mfma_f32_16x16x32_bf16 v[148:151], a[244:247], a[184:187], v[148:151]
    ds_read_b64_tr_b16 a[238:239], v11 offset:44032
    v_mfma_f32_16x16x32_bf16 v[148:151], a[240:243], a[168:171], v[148:151]
    v_mfma_f32_16x16x32_bf16 v[140:143], a[240:243], a[164:167], v[140:143]
    buffer_load_dwordx4 v4, s[12:15], s38 offen offset:128 lds
    v_mfma_f32_16x16x32_bf16 v[140:143], a[244:247], a[180:183], v[140:143]
    s_waitcnt lgkmcnt(4)
    s_addk_i32 m0, 896
    v_mfma_f32_16x16x32_bf16 v[132:135], a[244:247], a[176:179], v[132:135]
    v_mfma_f32_16x16x32_bf16 v[132:135], a[240:243], a[160:163], v[132:135]
    ds_read_b64_tr_b16 a[240:241], v8 offset:26624
    v_mfma_f32_16x16x32_bf16 v[160:163], a[224:227], a[160:163], v[160:163]
    ds_read_b64_tr_b16 a[242:243], v8 offset:32768
    v_mfma_f32_16x16x32_bf16 v[160:163], a[228:231], a[176:179], v[160:163]
    ds_read_b64_tr_b16 a[244:245], v8 offset:38912
    v_mfma_f32_16x16x32_bf16 v[168:171], a[228:231], a[180:183], v[168:171]
    buffer_load_dwordx4 v4, s[12:15], s38 offen offset:256 lds
    v_mfma_f32_16x16x32_bf16 v[168:171], a[224:227], a[164:167], v[168:171]
    s_addk_i32 m0, 1280
    ds_read_b64_tr_b16 a[246:247], v8 offset:45056
    v_mfma_f32_16x16x32_bf16 v[176:179], a[224:227], a[168:171], v[176:179]
    ds_read_b64_tr_b16 v[32:33], v25 offset:0
    v_mfma_f32_16x16x32_bf16 v[176:179], a[228:231], a[184:187], v[176:179]
    s_waitcnt lgkmcnt(5)
    ds_read_b64_tr_b16 v[34:35], v25 offset:4096
    v_mfma_f32_16x16x32_bf16 v[184:187], a[228:231], a[188:191], v[184:187]
    ds_read_b64_tr_b16 v[36:37], v25 offset:1024
    v_mfma_f32_16x16x32_bf16 v[184:187], a[224:227], a[172:175], v[184:187]
    ds_read_b64_tr_b16 v[38:39], v25 offset:5120
    v_mfma_f32_16x16x32_bf16 v[188:191], a[232:235], a[172:175], v[188:191]
    buffer_load_dwordx4 v5, s[12:15], s38 offen offset:0 lds
    v_mfma_f32_16x16x32_bf16 v[188:191], a[236:239], a[188:191], v[188:191]
    s_addk_i32 m0, 896
    ds_read_b64_tr_b16 v[40:41], v25 offset:8192
    v_mfma_f32_16x16x32_bf16 v[180:183], a[236:239], a[184:187], v[180:183]
    ds_read_b64_tr_b16 v[42:43], v25 offset:12288
    v_mfma_f32_16x16x32_bf16 v[180:183], a[232:235], a[168:171], v[180:183]
    ds_read_b64_tr_b16 v[44:45], v25 offset:9216
    v_mfma_f32_16x16x32_bf16 v[172:175], a[232:235], a[164:167], v[172:175]
    s_waitcnt lgkmcnt(5)
    ds_read_b64_tr_b16 v[46:47], v25 offset:13312
    ds_read_b64_tr_b16 a[224:225], v9 offset:26624
    v_mfma_f32_16x16x32_bf16 v[172:175], a[236:239], a[180:183], v[172:175]
    ds_read_b64_tr_b16 a[226:227], v9 offset:32768
    v_mfma_f32_16x16x32_bf16 v[164:167], a[236:239], a[176:179], v[164:167]
    ds_read_b64_tr_b16 a[228:229], v9 offset:38912
    v_mfma_f32_16x16x32_bf16 v[164:167], a[232:235], a[160:163], v[164:167]
    ds_read_b64_tr_b16 a[230:231], v9 offset:45056
    v_mfma_f32_16x16x32_bf16 v[192:195], a[240:243], a[160:163], v[192:195]
    ds_read_b64_tr_b16 a[232:233], v10 offset:26624
    v_mfma_f32_16x16x32_bf16 v[192:195], a[244:247], a[176:179], v[192:195]
    s_waitcnt lgkmcnt(7)
    ds_read_b64_tr_b16 a[234:235], v10 offset:32768
    v_mfma_f32_16x16x32_bf16 v[200:203], a[244:247], a[180:183], v[200:203]
    ds_read_b64_tr_b16 a[236:237], v10 offset:38912
    v_mfma_f32_16x16x32_bf16 v[200:203], a[240:243], a[164:167], v[200:203]
    ds_read_b64_tr_b16 a[238:239], v10 offset:45056
    v_mfma_f32_16x16x32_bf16 v[208:211], a[240:243], a[168:171], v[208:211]
    buffer_load_dwordx4 v5, s[12:15], s38 offen offset:128 lds
    v_mfma_f32_16x16x32_bf16 v[208:211], a[244:247], a[184:187], v[208:211]
    s_waitcnt lgkmcnt(5)
    v_add_u32 v8, 49152, v8
    s_addk_i32 m0, 896
    v_mfma_f32_16x16x32_bf16 v[216:219], a[244:247], a[188:191], v[216:219]
    buffer_load_dwordx4 v5, s[12:15], s38 offen offset:256 lds
    v_mfma_f32_16x16x32_bf16 v[216:219], a[240:243], a[172:175], v[216:219]
    s_waitcnt lgkmcnt(3)
    ds_read_b64_tr_b16 a[240:241], v11 offset:26624
    s_add_u32 s38, s38, 24576
    ds_read_b64_tr_b16 a[242:243], v11 offset:32768
    v_mfma_f32_16x16x32_bf16 v[220:223], a[224:227], a[172:175], v[220:223]
    s_addk_i32 m0, 19712
    ds_read_b64_tr_b16 a[244:245], v11 offset:38912
    ds_read_b64_tr_b16 a[246:247], v11 offset:45056
    v_mfma_f32_16x16x32_bf16 v[220:223], a[228:231], a[188:191], v[220:223]
    v_add_u32 v9, 49152, v9
    v_mfma_f32_16x16x32_bf16 v[212:215], a[228:231], a[184:187], v[212:215]
    buffer_load_dwordx4 v4, s[12:15], s38 offen offset:0 lds
    v_mfma_f32_16x16x32_bf16 v[212:215], a[224:227], a[168:171], v[212:215]
    s_addk_i32 m0, 896
    v_add_u32 v10, 49152, v10
    v_mfma_f32_16x16x32_bf16 v[204:207], a[224:227], a[164:167], v[204:207]
    v_add_u32 v11, 49152, v11
    v_mfma_f32_16x16x32_bf16 v[204:207], a[228:231], a[180:183], v[204:207]
    s_waitcnt lgkmcnt(4)
    v_mfma_f32_16x16x32_bf16 v[196:199], a[228:231], a[176:179], v[196:199]
    s_waitcnt lgkmcnt(0)
    s_barrier
    v_mfma_f32_16x16x32_bf16 v[196:199], a[224:227], a[160:163], v[196:199]
    ds_read_b64_tr_b16 a[224:225], v8 offset:0
    v_mfma_f32_16x16x32_bf16 v[224:227], a[232:235], a[160:163], v[224:227]
    buffer_load_dwordx4 v4, s[12:15], s38 offen offset:128 lds
    v_mfma_f32_16x16x32_bf16 v[224:227], a[236:239], a[176:179], v[224:227]
    s_addk_i32 m0, 896
    ds_read_b64_tr_b16 a[226:227], v8 offset:6144
    v_mfma_f32_16x16x32_bf16 v[232:235], a[236:239], a[180:183], v[232:235]
    ds_read_b64_tr_b16 a[228:229], v8 offset:12288
    v_mfma_f32_16x16x32_bf16 v[232:235], a[232:235], a[164:167], v[232:235]
    ds_read_b64_tr_b16 a[230:231], v8 offset:18432
    v_mfma_f32_16x16x32_bf16 v[240:243], a[232:235], a[168:171], v[240:243]
    v_mfma_f32_16x16x32_bf16 v[240:243], a[236:239], a[184:187], v[240:243]
    v_mfma_f32_16x16x32_bf16 v[248:251], a[236:239], a[188:191], v[248:251]
    buffer_load_dwordx4 v4, s[12:15], s38 offen offset:256 lds
    v_mfma_f32_16x16x32_bf16 v[248:251], a[232:235], a[172:175], v[248:251]
    s_addk_i32 m0, 1280
    ds_read_b64_tr_b16 a[232:233], v8 offset:24576
    v_mfma_f32_16x16x32_bf16 v[20:23], v[48:51], v[32:35], 0
    ds_read_b64_tr_b16 a[234:235], v8 offset:30720
    v_mfma_f32_16x16x32_bf16 v[58:61], v[48:51], v[36:39], 0
    ds_read_b64_tr_b16 a[236:237], v8 offset:36864
    v_mfma_f32_16x16x32_bf16 v[20:23], v[52:55], v[40:43], v[20:23]
    ds_read_b64_tr_b16 a[238:239], v8 offset:43008
    v_mfma_f32_16x16x32_bf16 v[58:61], v[52:55], v[44:47], v[58:61]
    v_mfma_f32_16x16x32_bf16 v[252:255], a[240:243], a[172:175], v[252:255]
    buffer_load_dwordx4 v5, s[12:15], s38 offen offset:0 lds
    v_mfma_f32_16x16x32_bf16 v[252:255], a[244:247], a[188:191], v[252:255]
    s_addk_i32 m0, 896
    v_lshlrev_b32 v14, 4, v1
    v_min_u32 v15, 1, v1
    v_mfma_f32_16x16x32_bf16 v[244:247], a[244:247], a[184:187], v[244:247]
    s_mul_i32 s56, s53, 983040
    v_mov_b32 v22, v58
    v_mov_b32 v23, v59
    v_mfma_f32_16x16x32_bf16 v[244:247], a[240:243], a[168:171], v[244:247]
    buffer_store_dwordx4 v[20:23], v26, s[24:27], s62 offen sc1
    v_mov_b32 v26, s7
    v_mfma_f32_16x16x32_bf16 v[236:239], a[240:243], a[164:167], v[236:239]
    s_mul_i32 s57, s51, 320
    v_lshrrev_b32 v21, 3, v1
    v_mul_u32_u24 v21, 1280, v21
    v_mfma_f32_16x16x32_bf16 v[236:239], a[244:247], a[180:183], v[236:239]
    s_waitcnt vmcnt(26) lgkmcnt(0)
    v_and_b32 v22, 16, v1
    v_lshlrev_b32 v22, 1, v22
    v_mfma_f32_16x16x32_bf16 v[228:231], a[244:247], a[176:179], v[228:231]
    buffer_load_dwordx4 v5, s[12:15], s38 offen offset:128 lds
    v_mfma_f32_16x16x32_bf16 v[228:231], a[240:243], a[160:163], v[228:231]
    s_waitcnt vmcnt(22)
    ds_read_b64_tr_b16 a[240:241], v9 offset:0
    v_lshlrev_b32 v15, 30, v15
    v_mfma_f32_16x16x32_bf16 v[64:67], a[224:227], a[96:99], v[64:67]
    s_addk_i32 m0, 896
    ds_read_b64_tr_b16 a[242:243], v9 offset:6144
    v_and_b32 v20, 1, v1
    v_mfma_f32_16x16x32_bf16 v[64:67], a[228:231], a[112:115], v[64:67]
    s_add_u32 s56, s56, s57
    ds_read_b64_tr_b16 a[244:245], v9 offset:12288
    v_mul_u32_u24 v20, 0xaaaa, v20
    v_mfma_f32_16x16x32_bf16 v[72:75], a[228:231], a[116:119], v[72:75]
    s_waitcnt vmcnt(21)
    ds_read_b64_tr_b16 a[246:247], v9 offset:18432
    v_add_u32 v20, 0x4444, v20
    v_mfma_f32_16x16x32_bf16 v[72:75], a[224:227], a[100:103], v[72:75]
    s_waitcnt vmcnt(20)
    s_add_u32 s39, s40, 0
    s_sub_u32 s57, 7864320, s56
    v_mfma_f32_16x16x32_bf16 v[80:83], a[224:227], a[104:107], v[80:83]
    buffer_load_dwordx4 v5, s[12:15], s38 offen offset:256 lds
    v_mfma_f32_16x16x32_bf16 v[80:83], a[228:231], a[120:123], v[80:83]
    s_waitcnt vmcnt(17)
    s_add_u32 s38, s38, 24576
    s_add_u32 m0, s63, 73728
    v_mfma_f32_16x16x32_bf16 v[88:91], a[228:231], a[124:127], v[88:91]
    s_waitcnt vmcnt(13)
    s_mov_b32 s10, s57
    s_mov_b32 s11, 0x00020000
    v_mfma_f32_16x16x32_bf16 v[88:91], a[224:227], a[108:111], v[88:91]
    s_add_u32 s8, s72, s56
    s_addc_u32 s9, s73, 0
    s_and_b32 s9, s9, 0xffff
    v_mfma_f32_16x16x32_bf16 v[88:91], a[232:235], a[140:143], v[88:91]
    s_mul_i32 s56, s53, 983040
    ds_read_b64_tr_b16 a[224:225], v9 offset:24576
    s_mov_b32 s34, 983040
    v_mfma_f32_16x16x32_bf16 v[88:91], a[236:239], a[156:159], v[88:91]
    s_add_u32 s32, s72, s56
    s_addc_u32 s33, s73, 0
    s_and_b32 s33, s33, 0xffff
    v_mfma_f32_16x16x32_bf16 v[80:83], a[236:239], a[152:155], v[80:83]
    buffer_load_dwordx4 v6, s[16:19], s39 offen lds
    v_mfma_f32_16x16x32_bf16 v[80:83], a[232:235], a[136:139], v[80:83]
    s_add_u32 s39, s40, 12288
    ds_read_b64_tr_b16 a[226:227], v9 offset:30720
    v_cvt_pk_bf16_f32 v88, v88, v89
    v_mfma_f32_16x16x32_bf16 v[72:75], a[232:235], a[132:135], v[72:75]
    s_addk_i32 m0, 4096
    ds_read_b64_tr_b16 a[228:229], v9 offset:36864
    v_cvt_pk_bf16_f32 v89, v90, v91
    v_mfma_f32_16x16x32_bf16 v[72:75], a[236:239], a[148:151], v[72:75]
    s_waitcnt lgkmcnt(3)
    ds_read_b64_tr_b16 a[230:231], v9 offset:43008
    v_cvt_pk_bf16_f32 v80, v80, v81
    v_mfma_f32_16x16x32_bf16 v[64:67], a[236:239], a[144:147], v[64:67]
    s_mov_b32 s35, 0x00020000
    v_cvt_pk_bf16_f32 v81, v82, v83
    s_mul_i32 s56, s53, 3145728
    v_mfma_f32_16x16x32_bf16 v[64:67], a[232:235], a[128:131], v[64:67]
    s_add_u32 s56, s56, 16777216
    ds_read_b64_tr_b16 a[232:233], v10 offset:0
    v_cvt_pk_bf16_f32 v72, v72, v73
    v_mfma_f32_16x16x32_bf16 v[68:71], a[240:243], a[96:99], v[68:71]
    buffer_load_dwordx4 v6, s[16:19], s39 offen lds
    v_mfma_f32_16x16x32_bf16 v[68:71], a[244:247], a[112:115], v[68:71]
    s_add_u32 s39, s40, 24576
    ds_read_b64_tr_b16 a[234:235], v10 offset:6144
    v_cvt_pk_bf16_f32 v64, v64, v65
    v_mfma_f32_16x16x32_bf16 v[76:79], a[244:247], a[116:119], v[76:79]
    s_addk_i32 m0, 4096
    ds_read_b64_tr_b16 a[236:237], v10 offset:12288
    v_cvt_pk_bf16_f32 v65, v66, v67
    v_mfma_f32_16x16x32_bf16 v[76:79], a[240:243], a[100:103], v[76:79]
    s_add_u32 s20, s86, s56
    s_addc_u32 s21, s87, 0
    v_cvt_pk_bf16_f32 v73, v74, v75
    v_mfma_f32_16x16x32_bf16 v[84:87], a[240:243], a[104:107], v[84:87]
    s_and_b32 s21, s21, 0xffff
    ds_read_b64_tr_b16 a[238:239], v10 offset:18432
    s_mov_b32 s22, 3145728
    v_mfma_f32_16x16x32_bf16 v[84:87], a[244:247], a[120:123], v[84:87]
    s_waitcnt lgkmcnt(4)
    s_mov_b32 s23, 0x00020000
    s_lshl_b32 s55, s51, 5
    v_mfma_f32_16x16x32_bf16 v[92:95], a[244:247], a[124:127], v[92:95]
    buffer_load_dwordx4 v6, s[16:19], s39 offen lds
    v_mfma_f32_16x16x32_bf16 v[92:95], a[240:243], a[108:111], v[92:95]
    s_add_u32 s39, s40, 36864
    ds_read_b64_tr_b16 a[240:241], v10 offset:24576
    s_addk_i32 m0, 4096
    v_mfma_f32_16x16x32_bf16 v[92:95], a[224:227], a[140:143], v[92:95]
    s_add_u32 s55, s55, s54
    ds_read_b64_tr_b16 a[242:243], v10 offset:30720
    s_mul_i32 s55, s55, 24576
    v_mfma_f32_16x16x32_bf16 v[92:95], a[228:231], a[156:159], v[92:95]
    s_lshr_b32 s50, s53, 1
    ds_read_b64_tr_b16 a[244:245], v10 offset:36864
    s_xor_b32 s67, s50, 3
    v_mfma_f32_16x16x32_bf16 v[84:87], a[228:231], a[152:155], v[84:87]
    s_lshl_b32 s67, s67, 10
    ds_read_b64_tr_b16 a[246:247], v10 offset:43008
    s_add_u32 s56, s51, 0
    v_mfma_f32_16x16x32_bf16 v[84:87], a[224:227], a[136:139], v[84:87]
    s_and_b32 s56, s56, 3
    v_cvt_pk_bf16_f32 v90, v92, v93
    v_cvt_pk_bf16_f32 v91, v94, v95
    v_mfma_f32_16x16x32_bf16 v[76:79], a[224:227], a[132:135], v[76:79]
    buffer_load_dwordx4 v6, s[16:19], s39 offen lds
    v_mfma_f32_16x16x32_bf16 v[76:79], a[228:231], a[148:151], v[76:79]
    s_waitcnt lgkmcnt(4)
    v_permlane16_swap_b32 v88, v90
    v_mfma_f32_16x16x32_bf16 v[68:71], a[228:231], a[144:147], v[68:71]
    s_mul_i32 s44, s56, 245760
    v_permlane16_swap_b32 v89, v91
    v_mfma_f32_16x16x32_bf16 v[68:71], a[224:227], a[128:131], v[68:71]
    s_add_u32 s56, s51, 1
    ds_read_b64_tr_b16 a[224:225], v11 offset:0
    v_cvt_pk_bf16_f32 v74, v76, v77
    v_mfma_f32_16x16x32_bf16 v[96:99], a[232:235], a[96:99], v[96:99]
    s_and_b32 s56, s56, 3
    ds_read_b64_tr_b16 a[226:227], v11 offset:6144
    v_cvt_pk_bf16_f32 v75, v78, v79
    v_mfma_f32_16x16x32_bf16 v[96:99], a[236:239], a[112:115], v[96:99]
    s_mul_i32 s45, s56, 245760
    ds_read_b64_tr_b16 a[228:229], v11 offset:12288
    v_cvt_pk_bf16_f32 v66, v68, v69
    v_mfma_f32_16x16x32_bf16 v[104:107], a[236:239], a[116:119], v[104:107]
    s_lshl_b32 s56, s56, 5
    ds_read_b64_tr_b16 a[230:231], v11 offset:18432
    v_cvt_pk_bf16_f32 v67, v70, v71
    v_mfma_f32_16x16x32_bf16 v[104:107], a[232:235], a[100:103], v[104:107]
    s_add_u32 s56, s56, s54
    v_permlane16_swap_b32 v64, v66
    v_mfma_f32_16x16x32_bf16 v[112:115], a[232:235], a[104:107], v[112:115]
    s_mul_i32 s59, s56, 24576
    v_permlane16_swap_b32 v65, v67
    v_mfma_f32_16x16x32_bf16 v[112:115], a[236:239], a[120:123], v[112:115]
    s_waitcnt lgkmcnt(4)
    v_permlane16_swap_b32 v72, v74
    v_mfma_f32_16x16x32_bf16 v[120:123], a[236:239], a[124:127], v[120:123]
    s_add_u32 s56, s51, 2
    v_permlane16_swap_b32 v73, v75
    v_mfma_f32_16x16x32_bf16 v[120:123], a[232:235], a[108:111], v[120:123]
    s_and_b32 s56, s56, 3
    ds_read_b64_tr_b16 a[232:233], v11 offset:24576
    v_cvt_pk_bf16_f32 v82, v84, v85
    v_mfma_f32_16x16x32_bf16 v[120:123], a[240:243], a[140:143], v[120:123]
    s_mul_i32 s46, s56, 245760
    ds_read_b64_tr_b16 a[234:235], v11 offset:30720
    v_cvt_pk_bf16_f32 v83, v86, v87
    v_mfma_f32_16x16x32_bf16 v[120:123], a[244:247], a[156:159], v[120:123]
    s_lshl_b32 s56, s56, 5
    ds_read_b64_tr_b16 a[236:237], v11 offset:36864
    v_accvgpr_write_b32 a0, v64
    v_mfma_f32_16x16x32_bf16 v[112:115], a[244:247], a[152:155], v[112:115]
    s_add_u32 s56, s56, s54
    ds_read_b64_tr_b16 a[238:239], v11 offset:43008
    v_accvgpr_write_b32 a1, v65
    v_mfma_f32_16x16x32_bf16 v[112:115], a[240:243], a[136:139], v[112:115]
    s_mul_i32 s60, s56, 24576
    v_permlane16_swap_b32 v80, v82
    v_mfma_f32_16x16x32_bf16 v[104:107], a[240:243], a[132:135], v[104:107]
    s_add_u32 s56, s51, 3
    v_permlane16_swap_b32 v81, v83
    v_mfma_f32_16x16x32_bf16 v[104:107], a[244:247], a[148:151], v[104:107]
    s_waitcnt lgkmcnt(4)
    v_accvgpr_write_b32 a2, v66
    v_accvgpr_write_b32 a3, v67
    v_mfma_f32_16x16x32_bf16 v[96:99], a[244:247], a[144:147], v[96:99]
    s_and_b32 s56, s56, 3
    v_accvgpr_write_b32 a4, v72
    v_accvgpr_write_b32 a5, v73
    v_mfma_f32_16x16x32_bf16 v[96:99], a[240:243], a[128:131], v[96:99]
    s_mul_i32 s47, s56, 245760
    ds_read_b64_tr_b16 a[240:241], v8 offset:1024
    v_accvgpr_write_b32 a6, v74
    v_mfma_f32_16x16x32_bf16 v[100:103], a[224:227], a[96:99], v[100:103]
    s_lshl_b32 s56, s56, 5
    ds_read_b64_tr_b16 a[242:243], v8 offset:7168
    v_accvgpr_write_b32 a7, v75
    v_mfma_f32_16x16x32_bf16 v[100:103], a[228:231], a[112:115], v[100:103]
    s_add_u32 s56, s56, s54
    ds_read_b64_tr_b16 a[244:245], v8 offset:13312
    v_accvgpr_write_b32 a8, v80
    v_mfma_f32_16x16x32_bf16 v[108:111], a[228:231], a[116:119], v[108:111]
    s_mul_i32 s61, s56, 24576
    ds_read_b64_tr_b16 a[246:247], v8 offset:19456
    v_accvgpr_write_b32 a9, v81
    v_mfma_f32_16x16x32_bf16 v[108:111], a[224:227], a[100:103], v[108:111]
    s_mov_b32 s72, s7
    v_accvgpr_write_b32 a10, v82
    v_accvgpr_write_b32 a11, v83
    v_mfma_f32_16x16x32_bf16 v[116:119], a[224:227], a[104:107], v[116:119]
    s_mov_b32 s73, s7
    v_accvgpr_write_b32 a12, v88
    v_accvgpr_write_b32 a13, v89
    v_mfma_f32_16x16x32_bf16 v[116:119], a[228:231], a[120:123], v[116:119]
    s_waitcnt lgkmcnt(4)
    v_accvgpr_write_b32 a14, v90
    v_accvgpr_write_b32 a15, v91
    v_mfma_f32_16x16x32_bf16 v[124:127], a[228:231], a[124:127], v[124:127]
    s_mov_b32 s74, s7
    v_cvt_pk_bf16_f32 v96, v96, v97
    v_cvt_pk_bf16_f32 v97, v98, v99
    v_mfma_f32_16x16x32_bf16 v[124:127], a[224:227], a[108:111], v[124:127]
    s_mov_b32 s75, s7
    ds_read_b64_tr_b16 a[224:225], v8 offset:25600
    v_cvt_pk_bf16_f32 v104, v104, v105
    v_mfma_f32_16x16x32_bf16 v[124:127], a[232:235], a[140:143], v[124:127]
    s_lshl_b32 s56, s50, 6
    ds_read_b64_tr_b16 a[226:227], v8 offset:31744
    v_cvt_pk_bf16_f32 v105, v106, v107
    v_mfma_f32_16x16x32_bf16 v[124:127], a[236:239], a[156:159], v[124:127]
    s_xor_b32 s56, s56, 192
    ds_read_b64_tr_b16 a[228:229], v8 offset:37888
    v_xor_b32 v2, s56, v7
    v_mfma_f32_16x16x32_bf16 v[116:119], a[236:239], a[152:155], v[116:119]
    s_and_b32 s56, s51, 1
    ds_read_b64_tr_b16 a[230:231], v8 offset:44032
    v_xor_b32 v3, 128, v2
    v_mfma_f32_16x16x32_bf16 v[116:119], a[232:235], a[136:139], v[116:119]
    s_lshl_b32 s56, s56, 6
    v_cvt_pk_bf16_f32 v112, v112, v113
    v_cvt_pk_bf16_f32 v113, v114, v115
    v_mfma_f32_16x16x32_bf16 v[108:111], a[232:235], a[132:135], v[108:111]
    s_mul_i32 s57, s3, 10240
    v_cvt_pk_bf16_f32 v120, v120, v121
    v_cvt_pk_bf16_f32 v121, v122, v123
    v_mfma_f32_16x16x32_bf16 v[108:111], a[236:239], a[148:151], v[108:111]
    s_waitcnt lgkmcnt(4)
    v_cvt_pk_bf16_f32 v114, v116, v117
    v_cvt_pk_bf16_f32 v115, v118, v119
    v_mfma_f32_16x16x32_bf16 v[100:103], a[236:239], a[144:147], v[100:103]
    s_add_u32 s56, s56, s57
    v_permlane16_swap_b32 v112, v114
    v_mfma_f32_16x16x32_bf16 v[100:103], a[232:235], a[128:131], v[100:103]
    s_and_b32 s57, s3, 1
    ds_read_b64_tr_b16 a[232:233], v9 offset:1024
    v_add_u32 v21, s56, v21
    v_mfma_f32_16x16x32_bf16 v[128:131], a[240:243], a[96:99], v[128:131]
    s_and_b32 s56, s51, 1
    ds_read_b64_tr_b16 a[234:235], v9 offset:7168
    v_add_u32 v2, v2, v21
    v_mfma_f32_16x16x32_bf16 v[128:131], a[244:247], a[112:115], v[128:131]
    s_xor_b32 s56, s56, 1
    ds_read_b64_tr_b16 a[236:237], v9 offset:13312
    v_add_u32 v3, v3, v21
    v_mfma_f32_16x16x32_bf16 v[136:139], a[244:247], a[116:119], v[136:139]
    s_lshl_b32 s56, s56, 8
    ds_read_b64_tr_b16 a[238:239], v9 offset:19456
    v_and_b32 v21, 3, v1
    v_mfma_f32_16x16x32_bf16 v[136:139], a[240:243], a[100:103], v[136:139]
pg_4:
    s_cbranch_execz pg_8
    s_mul_i32 s57, s57, 20480
    v_lshlrev_b32 v21, 4, v21
    v_xor_b32 v21, v21, v22
    v_mfma_f32_16x16x32_bf16 v[144:147], a[240:243], a[104:107], v[144:147]
    s_add_u32 s56, s56, s57
    v_lshrrev_b32 v22, 2, v1
    v_mul_u32_u24 v22, 1280, v22
    v_mfma_f32_16x16x32_bf16 v[144:147], a[244:247], a[120:123], v[144:147]
    s_waitcnt lgkmcnt(4)
    v_add_u32 v21, v21, v22
    v_add_u32 v7, s56, v21
    v_mfma_f32_16x16x32_bf16 v[152:155], a[244:247], a[124:127], v[152:155]
    s_lshr_b32 s42, s2, 3
    v_mov_b32 v21, 0x3f803f80
    v_accvgpr_write_b32 a248, v21
    v_mfma_f32_16x16x32_bf16 v[152:155], a[240:243], a[108:111], v[152:155]
    s_lshl_b32 s42, s42, 2
    ds_read_b64_tr_b16 a[240:241], v9 offset:25600
    v_accvgpr_write_b32 a249, v21
    v_mfma_f32_16x16x32_bf16 v[152:155], a[224:227], a[140:143], v[152:155]
    s_add_u32 s42, s42, s3
    ds_read_b64_tr_b16 a[242:243], v9 offset:31744
    v_accvgpr_write_b32 a250, v21
    v_mfma_f32_16x16x32_bf16 v[152:155], a[228:231], a[156:159], v[152:155]
    s_mul_i32 s42, s42, 7680
    ds_read_b64_tr_b16 a[244:245], v9 offset:37888
    v_accvgpr_write_b32 a251, v21
    v_mfma_f32_16x16x32_bf16 v[144:147], a[228:231], a[152:155], v[144:147]
    ds_read_b64_tr_b16 a[246:247], v9 offset:44032
    v_min_u32 v22, 11, v1
    v_mfma_f32_16x16x32_bf16 v[144:147], a[224:227], a[136:139], v[144:147]
    v_lshlrev_b32 v22, 7, v22
    v_cvt_pk_bf16_f32 v98, v100, v101
    v_mfma_f32_16x16x32_bf16 v[136:139], a[224:227], a[132:135], v[136:139]
    v_permlane16_swap_b32 v113, v115
    v_mfma_f32_16x16x32_bf16 v[136:139], a[228:231], a[148:151], v[136:139]
    s_waitcnt lgkmcnt(4)
    v_permlane16_swap_b32 v96, v98
    v_mfma_f32_16x16x32_bf16 v[128:131], a[228:231], a[144:147], v[128:131]
    v_cvt_pk_bf16_f32 v99, v102, v103
    v_cvt_pk_bf16_f32 v106, v108, v109
    v_mfma_f32_16x16x32_bf16 v[128:131], a[224:227], a[128:131], v[128:131]
    ds_read_b64_tr_b16 a[224:225], v10 offset:1024
    v_cvt_pk_bf16_f32 v107, v110, v111
    v_mfma_f32_16x16x32_bf16 v[132:135], a[232:235], a[96:99], v[132:135]
    ds_read_b64_tr_b16 a[226:227], v10 offset:7168
    v_accvgpr_write_b32 a16, v96
    v_mfma_f32_16x16x32_bf16 v[132:135], a[236:239], a[112:115], v[132:135]
    ds_read_b64_tr_b16 a[228:229], v10 offset:13312
    v_accvgpr_write_b32 a18, v98
    v_mfma_f32_16x16x32_bf16 v[140:143], a[236:239], a[116:119], v[140:143]
    ds_read_b64_tr_b16 a[230:231], v10 offset:19456
    v_cvt_pk_bf16_f32 v122, v124, v125
    v_mfma_f32_16x16x32_bf16 v[140:143], a[232:235], a[100:103], v[140:143]
    v_permlane16_swap_b32 v97, v99
    v_mfma_f32_16x16x32_bf16 v[148:151], a[232:235], a[104:107], v[148:151]
    v_permlane16_swap_b32 v104, v106
    v_mfma_f32_16x16x32_bf16 v[148:151], a[236:239], a[120:123], v[148:151]
    s_waitcnt lgkmcnt(4)
    v_permlane16_swap_b32 v105, v107
    v_mfma_f32_16x16x32_bf16 v[156:159], a[236:239], a[124:127], v[156:159]
    s_waitcnt vmcnt(6)
    v_permlane16_swap_b32 v120, v122
    v_mfma_f32_16x16x32_bf16 v[156:159], a[232:235], a[108:111], v[156:159]
    buffer_store_dword v26, v27, s[24:27], s4 offen offset:144 sc1
    v_mfma_f32_16x16x32_bf16 v[156:159], a[240:243], a[140:143], v[156:159]
    ds_read_b64_tr_b16 a[232:233], v10 offset:25600
    v_accvgpr_write_b32 a17, v97
    v_mfma_f32_16x16x32_bf16 v[156:159], a[244:247], a[156:159], v[156:159]
    ds_read_b64_tr_b16 a[234:235], v10 offset:31744
    v_accvgpr_write_b32 a19, v99
    v_mfma_f32_16x16x32_bf16 v[148:151], a[244:247], a[152:155], v[148:151]
    ds_read_b64_tr_b16 a[236:237], v10 offset:37888
    v_cvt_pk_bf16_f32 v123, v126, v127
    v_mfma_f32_16x16x32_bf16 v[148:151], a[240:243], a[136:139], v[148:151]
    ds_read_b64_tr_b16 a[238:239], v10 offset:44032
    v_accvgpr_write_b32 a20, v104
    v_mfma_f32_16x16x32_bf16 v[140:143], a[240:243], a[132:135], v[140:143]
    v_permlane16_swap_b32 v121, v123
    v_mfma_f32_16x16x32_bf16 v[140:143], a[244:247], a[148:151], v[140:143]
    s_waitcnt lgkmcnt(4)
    v_accvgpr_write_b32 a21, v105
    v_accvgpr_write_b32 a22, v106
    v_mfma_f32_16x16x32_bf16 v[132:135], a[244:247], a[144:147], v[132:135]
    v_accvgpr_write_b32 a23, v107
    v_accvgpr_write_b32 a24, v112
    v_mfma_f32_16x16x32_bf16 v[132:135], a[240:243], a[128:131], v[132:135]
    ds_read_b64_tr_b16 a[240:241], v11 offset:1024
    v_accvgpr_write_b32 a25, v113
    v_mfma_f32_16x16x32_bf16 v[160:163], a[224:227], a[96:99], v[160:163]
    ds_read_b64_tr_b16 a[242:243], v11 offset:7168
    v_accvgpr_write_b32 a26, v114
    v_mfma_f32_16x16x32_bf16 v[160:163], a[228:231], a[112:115], v[160:163]
    ds_read_b64_tr_b16 a[244:245], v11 offset:13312
    v_accvgpr_write_b32 a27, v115
    v_mfma_f32_16x16x32_bf16 v[168:171], a[228:231], a[116:119], v[168:171]
    ds_read_b64_tr_b16 a[246:247], v11 offset:19456
    v_accvgpr_write_b32 a28, v120
    v_mfma_f32_16x16x32_bf16 v[168:171], a[224:227], a[100:103], v[168:171]
    v_accvgpr_write_b32 a29, v121
    v_accvgpr_write_b32 a30, v122
    v_mfma_f32_16x16x32_bf16 v[176:179], a[224:227], a[104:107], v[176:179]
    v_accvgpr_write_b32 a31, v123
    v_cvt_pk_bf16_f32 v128, v128, v129
    v_mfma_f32_16x16x32_bf16 v[176:179], a[228:231], a[120:123], v[176:179]
    s_waitcnt lgkmcnt(4)
    v_cvt_pk_bf16_f32 v129, v130, v131
    v_cvt_pk_bf16_f32 v130, v132, v133
    v_mfma_f32_16x16x32_bf16 v[184:187], a[228:231], a[124:127], v[184:187]
    v_cvt_pk_bf16_f32 v131, v134, v135
    v_cvt_pk_bf16_f32 v136, v136, v137
    v_mfma_f32_16x16x32_bf16 v[184:187], a[224:227], a[108:111], v[184:187]
    ds_read_b64_tr_b16 a[224:225], v11 offset:25600
    v_cvt_pk_bf16_f32 v137, v138, v139
    v_mfma_f32_16x16x32_bf16 v[184:187], a[232:235], a[140:143], v[184:187]
    ds_read_b64_tr_b16 a[226:227], v11 offset:31744
    v_cvt_pk_bf16_f32 v138, v140, v141
    v_mfma_f32_16x16x32_bf16 v[184:187], a[236:239], a[156:159], v[184:187]
    ds_read_b64_tr_b16 a[228:229], v11 offset:37888
    v_cvt_pk_bf16_f32 v139, v142, v143
    v_mfma_f32_16x16x32_bf16 v[176:179], a[236:239], a[152:155], v[176:179]
    ds_read_b64_tr_b16 a[230:231], v11 offset:44032
    v_cvt_pk_bf16_f32 v144, v144, v145
    v_mfma_f32_16x16x32_bf16 v[176:179], a[232:235], a[136:139], v[176:179]
    v_permlane16_swap_b32 v128, v130
    v_mfma_f32_16x16x32_bf16 v[168:171], a[232:235], a[132:135], v[168:171]
    v_permlane16_swap_b32 v129, v131
    v_mfma_f32_16x16x32_bf16 v[168:171], a[236:239], a[148:151], v[168:171]
    s_waitcnt lgkmcnt(4)
    v_permlane16_swap_b32 v136, v138
    v_mfma_f32_16x16x32_bf16 v[160:163], a[236:239], a[144:147], v[160:163]
    v_permlane16_swap_b32 v137, v139
    v_mfma_f32_16x16x32_bf16 v[160:163], a[232:235], a[128:131], v[160:163]
    ds_read_b64_tr_b16 a[232:233], v8 offset:2048
    v_cvt_pk_bf16_f32 v145, v146, v147
    v_mfma_f32_16x16x32_bf16 v[164:167], a[240:243], a[96:99], v[164:167]
    ds_read_b64_tr_b16 a[234:235], v8 offset:8192
    v_cvt_pk_bf16_f32 v146, v148, v149
    v_mfma_f32_16x16x32_bf16 v[164:167], a[244:247], a[112:115], v[164:167]
    ds_read_b64_tr_b16 a[236:237], v8 offset:14336
    v_cvt_pk_bf16_f32 v147, v150, v151
    v_mfma_f32_16x16x32_bf16 v[172:175], a[244:247], a[116:119], v[172:175]
    ds_read_b64_tr_b16 a[238:239], v8 offset:20480
    v_accvgpr_write_b32 a32, v128
    v_mfma_f32_16x16x32_bf16 v[172:175], a[240:243], a[100:103], v[172:175]
    v_permlane16_swap_b32 v144, v146
    v_mfma_f32_16x16x32_bf16 v[180:183], a[240:243], a[104:107], v[180:183]
    v_permlane16_swap_b32 v145, v147
    v_mfma_f32_16x16x32_bf16 v[180:183], a[244:247], a[120:123], v[180:183]
    s_waitcnt lgkmcnt(4)
    v_accvgpr_write_b32 a33, v129
    v_accvgpr_write_b32 a34, v130
    v_mfma_f32_16x16x32_bf16 v[188:191], a[244:247], a[124:127], v[188:191]
    v_accvgpr_write_b32 a35, v131
    v_cvt_pk_bf16_f32 v152, v152, v153
    v_mfma_f32_16x16x32_bf16 v[188:191], a[240:243], a[108:111], v[188:191]
    ds_read_b64_tr_b16 a[240:241], v8 offset:26624
    v_cvt_pk_bf16_f32 v153, v154, v155
    v_mfma_f32_16x16x32_bf16 v[188:191], a[224:227], a[140:143], v[188:191]
    ds_read_b64_tr_b16 a[242:243], v8 offset:32768
    v_cvt_pk_bf16_f32 v154, v156, v157
    v_mfma_f32_16x16x32_bf16 v[188:191], a[228:231], a[156:159], v[188:191]
    ds_read_b64_tr_b16 a[244:245], v8 offset:38912
    v_cvt_pk_bf16_f32 v155, v158, v159
    v_mfma_f32_16x16x32_bf16 v[180:183], a[228:231], a[152:155], v[180:183]
    ds_read_b64_tr_b16 a[246:247], v8 offset:45056
    v_accvgpr_write_b32 a36, v136
    v_mfma_f32_16x16x32_bf16 v[180:183], a[224:227], a[136:139], v[180:183]
    v_permlane16_swap_b32 v152, v154
    v_mfma_f32_16x16x32_bf16 v[172:175], a[224:227], a[132:135], v[172:175]
    s_add_u32 s88, s88, code_end-code0-65536
    s_addc_u32 s89, s89, 0
    v_accvgpr_write_b32 a37, v137
    v_mfma_f32_16x16x32_bf16 v[172:175], a[228:231], a[148:151], v[172:175]
    s_waitcnt lgkmcnt(4)
    v_permlane16_swap_b32 v153, v155
    v_mfma_f32_16x16x32_bf16 v[164:167], a[228:231], a[144:147], v[164:167]
    v_accvgpr_write_b32 a38, v138
    v_accvgpr_write_b32 a39, v139
    v_mfma_f32_16x16x32_bf16 v[164:167], a[224:227], a[128:131], v[164:167]
    ds_read_b64_tr_b16 a[224:225], v9 offset:2048
    v_accvgpr_write_b32 a40, v144
    v_mfma_f32_16x16x32_bf16 v[192:195], a[232:235], a[96:99], v[192:195]
    global_load_dword a252, v18, s[88:89]
    v_mfma_f32_16x16x32_bf16 v[192:195], a[236:239], a[112:115], v[192:195]
    ds_read_b64_tr_b16 a[226:227], v9 offset:8192
    v_accvgpr_write_b32 a41, v145
    v_mfma_f32_16x16x32_bf16 v[200:203], a[236:239], a[116:119], v[200:203]
    ds_read_b64_tr_b16 a[228:229], v9 offset:14336
    v_accvgpr_write_b32 a42, v146
    v_mfma_f32_16x16x32_bf16 v[200:203], a[232:235], a[100:103], v[200:203]
    ds_read_b64_tr_b16 a[230:231], v9 offset:20480
    v_accvgpr_write_b32 a43, v147
    v_mfma_f32_16x16x32_bf16 v[208:211], a[232:235], a[104:107], v[208:211]
    v_accvgpr_write_b32 a44, v152
    v_accvgpr_write_b32 a45, v153
    v_mfma_f32_16x16x32_bf16 v[208:211], a[236:239], a[120:123], v[208:211]
    s_waitcnt lgkmcnt(4)
    v_accvgpr_write_b32 a46, v154
    v_accvgpr_write_b32 a47, v155
    v_mfma_f32_16x16x32_bf16 v[216:219], a[236:239], a[124:127], v[216:219]
    v_cvt_pk_bf16_f32 v160, v160, v161
    v_cvt_pk_bf16_f32 v161, v162, v163
    v_mfma_f32_16x16x32_bf16 v[216:219], a[232:235], a[108:111], v[216:219]
    ds_read_b64_tr_b16 a[232:233], v9 offset:26624
    v_cvt_pk_bf16_f32 v162, v164, v165
    v_mfma_f32_16x16x32_bf16 v[216:219], a[240:243], a[140:143], v[216:219]
    ds_read_b64_tr_b16 a[234:235], v9 offset:32768
    v_cvt_pk_bf16_f32 v163, v166, v167
    v_mfma_f32_16x16x32_bf16 v[216:219], a[244:247], a[156:159], v[216:219]
    ds_read_b64_tr_b16 a[236:237], v9 offset:38912
    v_cvt_pk_bf16_f32 v168, v168, v169
    v_mfma_f32_16x16x32_bf16 v[208:211], a[244:247], a[152:155], v[208:211]
    ds_read_b64_tr_b16 a[238:239], v9 offset:45056
    v_cvt_pk_bf16_f32 v169, v170, v171
    v_mfma_f32_16x16x32_bf16 v[208:211], a[240:243], a[136:139], v[208:211]
    v_permlane16_swap_b32 v160, v162
    v_mfma_f32_16x16x32_bf16 v[200:203], a[240:243], a[132:135], v[200:203]
    v_permlane16_swap_b32 v161, v163
    v_mfma_f32_16x16x32_bf16 v[200:203], a[244:247], a[148:151], v[200:203]
    s_waitcnt lgkmcnt(4)
    v_cvt_pk_bf16_f32 v170, v172, v173
    v_cvt_pk_bf16_f32 v171, v174, v175
    v_mfma_f32_16x16x32_bf16 v[192:195], a[244:247], a[144:147], v[192:195]
    v_permlane16_swap_b32 v168, v170
    v_mfma_f32_16x16x32_bf16 v[192:195], a[240:243], a[128:131], v[192:195]
    ds_read_b64_tr_b16 a[240:241], v10 offset:2048
    v_cvt_pk_bf16_f32 v176, v176, v177
    v_mfma_f32_16x16x32_bf16 v[196:199], a[224:227], a[96:99], v[196:199]
    ds_read_b64_tr_b16 a[242:243], v10 offset:8192
    v_cvt_pk_bf16_f32 v177, v178, v179
    v_mfma_f32_16x16x32_bf16 v[196:199], a[228:231], a[112:115], v[196:199]
    ds_read_b64_tr_b16 a[244:245], v10 offset:14336
    v_cvt_pk_bf16_f32 v178, v180, v181
    v_mfma_f32_16x16x32_bf16 v[204:207], a[228:231], a[116:119], v[204:207]
    ds_read_b64_tr_b16 a[246:247], v10 offset:20480
    v_cvt_pk_bf16_f32 v179, v182, v183
    v_mfma_f32_16x16x32_bf16 v[204:207], a[224:227], a[100:103], v[204:207]
    v_permlane16_swap_b32 v169, v171
    v_mfma_f32_16x16x32_bf16 v[212:215], a[224:227], a[104:107], v[212:215]
    v_permlane16_swap_b32 v176, v178
    v_mfma_f32_16x16x32_bf16 v[212:215], a[228:231], a[120:123], v[212:215]
    s_waitcnt lgkmcnt(4)
    v_permlane16_swap_b32 v177, v179
    v_mfma_f32_16x16x32_bf16 v[220:223], a[228:231], a[124:127], v[220:223]
    v_accvgpr_write_b32 a48, v160
    v_accvgpr_write_b32 a49, v161
    v_mfma_f32_16x16x32_bf16 v[220:223], a[224:227], a[108:111], v[220:223]
    ds_read_b64_tr_b16 a[224:225], v10 offset:26624
    v_accvgpr_write_b32 a50, v162
    v_mfma_f32_16x16x32_bf16 v[220:223], a[232:235], a[140:143], v[220:223]
    ds_read_b64_tr_b16 a[226:227], v10 offset:32768
    v_accvgpr_write_b32 a51, v163
    v_mfma_f32_16x16x32_bf16 v[220:223], a[236:239], a[156:159], v[220:223]
    ds_read_b64_tr_b16 a[228:229], v10 offset:38912
    v_cvt_pk_bf16_f32 v184, v184, v185
    v_mfma_f32_16x16x32_bf16 v[212:215], a[236:239], a[152:155], v[212:215]
    ds_read_b64_tr_b16 a[230:231], v10 offset:45056
    v_cvt_pk_bf16_f32 v185, v186, v187
    v_mfma_f32_16x16x32_bf16 v[212:215], a[232:235], a[136:139], v[212:215]
    v_cvt_pk_bf16_f32 v186, v188, v189
    v_cvt_pk_bf16_f32 v187, v190, v191
    v_mfma_f32_16x16x32_bf16 v[204:207], a[232:235], a[132:135], v[204:207]
    v_permlane16_swap_b32 v184, v186
    v_mfma_f32_16x16x32_bf16 v[204:207], a[236:239], a[148:151], v[204:207]
    s_waitcnt lgkmcnt(4)
    v_permlane16_swap_b32 v185, v187
    v_mfma_f32_16x16x32_bf16 v[196:199], a[236:239], a[144:147], v[196:199]
    v_accvgpr_write_b32 a52, v168
    v_accvgpr_write_b32 a53, v169
    v_mfma_f32_16x16x32_bf16 v[196:199], a[232:235], a[128:131], v[196:199]
    ds_read_b64_tr_b16 a[232:233], v11 offset:2048
    v_accvgpr_write_b32 a54, v170
    ds_read_b64_tr_b16 a[234:235], v11 offset:8192
    v_mfma_f32_16x16x32_bf16 v[224:227], a[240:243], a[96:99], v[224:227]
    ds_read_b64_tr_b16 a[236:237], v11 offset:14336
    v_accvgpr_write_b32 a55, v171
    ds_read_b64_tr_b16 a[238:239], v11 offset:20480
    v_mfma_f32_16x16x32_bf16 v[224:227], a[244:247], a[112:115], v[224:227]
    v_accvgpr_write_b32 a56, v176
    v_accvgpr_write_b32 a57, v177
    v_mfma_f32_16x16x32_bf16 v[232:235], a[244:247], a[116:119], v[232:235]
    v_accvgpr_write_b32 a58, v178
    v_accvgpr_write_b32 a59, v179
    v_mfma_f32_16x16x32_bf16 v[232:235], a[240:243], a[100:103], v[232:235]
    v_accvgpr_write_b32 a60, v184
    v_accvgpr_write_b32 a61, v185
    v_mfma_f32_16x16x32_bf16 v[240:243], a[240:243], a[104:107], v[240:243]
    v_accvgpr_write_b32 a62, v186
    v_accvgpr_write_b32 a63, v187
    v_mfma_f32_16x16x32_bf16 v[240:243], a[244:247], a[120:123], v[240:243]
    s_waitcnt lgkmcnt(4)
    v_cvt_pk_bf16_f32 v192, v192, v193
    v_cvt_pk_bf16_f32 v193, v194, v195
    v_mfma_f32_16x16x32_bf16 v[248:251], a[244:247], a[124:127], v[248:251]
    s_waitcnt lgkmcnt(0)
    s_barrier
    v_mfma_f32_16x16x32_bf16 v[248:251], a[240:243], a[108:111], v[248:251]
    s_add_u32 m0, s49, 49152
    ds_read_b128 a[184:187], v12 offset:0
    v_cvt_pk_bf16_f32 v194, v196, v197
    v_mfma_f32_16x16x32_bf16 v[248:251], a[224:227], a[140:143], v[248:251]
    ds_read_b128 a[188:191], v13 offset:0
    v_cvt_pk_bf16_f32 v195, v198, v199
    v_mfma_f32_16x16x32_bf16 v[248:251], a[228:231], a[156:159], v[248:251]
    ds_read_b128 a[192:195], v12 offset:1024
    v_cvt_pk_bf16_f32 v200, v200, v201
    v_mfma_f32_16x16x32_bf16 v[240:243], a[228:231], a[152:155], v[240:243]
    ds_read_b128 a[196:199], v13 offset:1024
    v_cvt_pk_bf16_f32 v201, v202, v203
    v_mfma_f32_16x16x32_bf16 v[240:243], a[224:227], a[136:139], v[240:243]
    ds_read_b128 a[200:203], v12 offset:2048
    v_cvt_pk_bf16_f32 v202, v204, v205
    v_mfma_f32_16x16x32_bf16 v[232:235], a[224:227], a[132:135], v[232:235]
    buffer_load_dwordx4 v4, s[12:15], s38 offen offset:0 lds
    v_mfma_f32_16x16x32_bf16 v[232:235], a[228:231], a[148:151], v[232:235]
    ds_read_b64_tr_b16 a[240:241], v11 offset:26624
    v_cvt_pk_bf16_f32 v203, v206, v207
    v_mfma_f32_16x16x32_bf16 v[224:227], a[228:231], a[144:147], v[224:227]
    ds_read_b64_tr_b16 a[242:243], v11 offset:32768
    v_cvt_pk_bf16_f32 v208, v208, v209
    v_mfma_f32_16x16x32_bf16 v[224:227], a[224:227], a[128:131], v[224:227]
    ds_read_b64_tr_b16 a[244:245], v11 offset:38912
    v_cvt_pk_bf16_f32 v209, v210, v211
    v_mfma_f32_16x16x32_bf16 v[228:231], a[232:235], a[96:99], v[228:231]
    ds_read_b64_tr_b16 a[246:247], v11 offset:45056
    v_cvt_pk_bf16_f32 v210, v212, v213
    v_mfma_f32_16x16x32_bf16 v[228:231], a[236:239], a[112:115], v[228:231]
    v_permlane16_swap_b32 v192, v194
    v_mfma_f32_16x16x32_bf16 v[236:239], a[236:239], a[116:119], v[236:239]
    s_addk_i32 m0, 896
    v_permlane16_swap_b32 v193, v195
    v_mfma_f32_16x16x32_bf16 v[236:239], a[232:235], a[100:103], v[236:239]
    v_permlane16_swap_b32 v200, v202
    v_mfma_f32_16x16x32_bf16 v[244:247], a[232:235], a[104:107], v[244:247]
    v_permlane16_swap_b32 v201, v203
    v_mfma_f32_16x16x32_bf16 v[244:247], a[236:239], a[120:123], v[244:247]
    s_waitcnt lgkmcnt(2)
    v_permlane16_swap_b32 v208, v210
    v_mfma_f32_16x16x32_bf16 v[252:255], a[236:239], a[124:127], v[252:255]
    ds_read_b128 a[204:207], v13 offset:2048
    v_cvt_pk_bf16_f32 v211, v214, v215
    v_mfma_f32_16x16x32_bf16 v[252:255], a[232:235], a[108:111], v[252:255]
    s_waitcnt lgkmcnt(1)
    v_permlane16_swap_b32 v209, v211
    v_mfma_f32_16x16x32_bf16 v[252:255], a[240:243], a[140:143], v[252:255]
    buffer_load_dwordx4 v4, s[12:15], s38 offen offset:128 lds
    v_mfma_f32_16x16x32_bf16 v[252:255], a[244:247], a[156:159], v[252:255]
    v_accvgpr_write_b32 a64, v192
    v_accvgpr_write_b32 a65, v193
    v_mfma_f32_16x16x32_bf16 v[244:247], a[244:247], a[152:155], v[244:247]
    ds_read_b128 a[208:211], v12 offset:6144
    v_accvgpr_write_b32 a66, v194
    v_mfma_f32_16x16x32_bf16 v[244:247], a[240:243], a[136:139], v[244:247]
    ds_read_b128 a[212:215], v13 offset:6144
    v_accvgpr_write_b32 a67, v195
    v_mfma_f32_16x16x32_bf16 v[236:239], a[240:243], a[132:135], v[236:239]
    ds_read_b128 a[216:219], v12 offset:7168
    v_cvt_pk_bf16_f32 v216, v216, v217
    v_mfma_f32_16x16x32_bf16 v[236:239], a[244:247], a[148:151], v[236:239]
    ds_read_b128 a[220:223], v13 offset:7168
    v_cvt_pk_bf16_f32 v217, v218, v219
    v_mfma_f32_16x16x32_bf16 v[228:231], a[244:247], a[144:147], v[228:231]
    s_addk_i32 m0, 896
    ds_read_b128 a[224:227], v12 offset:8192
    v_cvt_pk_bf16_f32 v218, v220, v221
    v_mfma_f32_16x16x32_bf16 v[228:231], a[240:243], a[128:131], v[228:231]
    ds_read_b128 a[228:231], v13 offset:8192
    v_cvt_pk_bf16_f32 v219, v222, v223
    v_mfma_f32_16x16x32_bf16 v[64:67], a[184:187], a[0:3], 0
    v_permlane16_swap_b32 v216, v218
    v_mfma_f32_16x16x32_bf16 v[64:67], a[188:191], a[16:19], v[64:67]
    v_permlane16_swap_b32 v217, v219
    v_mfma_f32_16x16x32_bf16 v[64:67], a[192:195], a[32:35], v[64:67]
    v_accvgpr_write_b32 a68, v200
    v_accvgpr_write_b32 a69, v201
    v_mfma_f32_16x16x32_bf16 v[64:67], a[196:199], a[48:51], v[64:67]
    v_accvgpr_write_b32 a70, v202
    v_accvgpr_write_b32 a71, v203
    v_mfma_f32_16x16x32_bf16 v[64:67], a[200:203], a[64:67], v[64:67]
    buffer_load_dwordx4 v4, s[12:15], s38 offen offset:256 lds
    v_mfma_f32_16x16x32_bf16 v[72:75], a[200:203], a[68:71], 0
    v_accvgpr_write_b32 a72, v208
    v_accvgpr_write_b32 a73, v209
    v_mfma_f32_16x16x32_bf16 v[72:75], a[196:199], a[52:55], v[72:75]
    v_accvgpr_write_b32 a74, v210
    v_accvgpr_write_b32 a75, v211
    v_mfma_f32_16x16x32_bf16 v[72:75], a[192:195], a[36:39], v[72:75]
    v_accvgpr_write_b32 a76, v216
    v_accvgpr_write_b32 a77, v217
    v_mfma_f32_16x16x32_bf16 v[72:75], a[188:191], a[20:23], v[72:75]
    v_accvgpr_write_b32 a78, v218
    v_accvgpr_write_b32 a79, v219
    v_mfma_f32_16x16x32_bf16 v[72:75], a[184:187], a[4:7], v[72:75]
    v_cvt_pk_bf16_f32 v224, v224, v225
    v_cvt_pk_bf16_f32 v225, v226, v227
    v_mfma_f32_16x16x32_bf16 v[80:83], a[184:187], a[8:11], 0
    s_addk_i32 m0, 1280
    v_cvt_pk_bf16_f32 v226, v228, v229
    v_cvt_pk_bf16_f32 v227, v230, v231
    v_mfma_f32_16x16x32_bf16 v[80:83], a[188:191], a[24:27], v[80:83]
    v_permlane16_swap_b32 v224, v226
    v_mfma_f32_16x16x32_bf16 v[80:83], a[192:195], a[40:43], v[80:83]
    v_permlane16_swap_b32 v225, v227
    v_mfma_f32_16x16x32_bf16 v[80:83], a[196:199], a[56:59], v[80:83]
    v_cvt_pk_bf16_f32 v232, v232, v233
    v_cvt_pk_bf16_f32 v233, v234, v235
    v_mfma_f32_16x16x32_bf16 v[80:83], a[200:203], a[72:75], v[80:83]
    v_cvt_pk_bf16_f32 v234, v236, v237
    v_cvt_pk_bf16_f32 v235, v238, v239
    v_mfma_f32_16x16x32_bf16 v[88:91], a[200:203], a[76:79], 0
    v_permlane16_swap_b32 v232, v234
    v_mfma_f32_16x16x32_bf16 v[88:91], a[196:199], a[60:63], v[88:91]
    buffer_load_dwordx4 v5, s[12:15], s38 offen offset:0 lds
    v_mfma_f32_16x16x32_bf16 v[88:91], a[192:195], a[44:47], v[88:91]
    s_waitcnt lgkmcnt(0)
    v_permlane16_swap_b32 v233, v235
    v_mfma_f32_16x16x32_bf16 v[88:91], a[188:191], a[28:31], v[88:91]
    v_cvt_pk_bf16_f32 v240, v240, v241
    v_cvt_pk_bf16_f32 v241, v242, v243
    v_mfma_f32_16x16x32_bf16 v[88:91], a[184:187], a[12:15], v[88:91]
    ds_read_b128 a[184:187], v12 offset:12288
    v_cvt_pk_bf16_f32 v242, v244, v245
    v_mfma_f32_16x16x32_bf16 v[64:67], a[204:207], v[224:227], v[64:67]
    ds_read_b128 a[188:191], v13 offset:12288
    v_cvt_pk_bf16_f32 v243, v246, v247
    v_cvt_pk_bf16_f32 v248, v248, v249
    v_cvt_pk_bf16_f32 v249, v250, v251
    v_mfma_f32_16x16x32_bf16 v[72:75], a[204:207], v[232:235], v[72:75]
    ds_read_b128 a[192:195], v12 offset:13312
    v_cvt_pk_bf16_f32 v250, v252, v253
    v_permlane16_swap_b32 v240, v242
    v_permlane16_swap_b32 v241, v243
    s_nop 1
    v_mfma_f32_16x16x32_bf16 v[80:83], a[204:207], v[240:243], v[80:83]
    s_addk_i32 m0, 896
    ds_read_b128 a[196:199], v13 offset:13312
    v_cvt_pk_bf16_f32 v251, v254, v255
    v_permlane16_swap_b32 v248, v250
    v_accvgpr_write_b32 a80, v224
    v_permlane16_swap_b32 v249, v251
    s_nop 1
    v_mfma_f32_16x16x32_bf16 v[88:91], a[204:207], v[248:251], v[88:91]
    ds_read_b128 a[200:203], v12 offset:14336
    v_accvgpr_write_b32 a81, v225
    v_mfma_f32_16x16x32_bf16 v[24:27], a[208:211], a[0:3], 0
    ds_read_b128 a[204:207], v13 offset:14336
    v_accvgpr_write_b32 a82, v226
    v_mfma_f32_16x16x32_bf16 v[24:27], a[212:215], a[16:19], v[24:27]
    v_exp_f32 v64, v64
    v_mfma_f32_16x16x32_bf16 v[24:27], a[216:219], a[32:35], v[24:27]
    v_exp_f32 v65, v65
    v_mfma_f32_16x16x32_bf16 v[24:27], a[220:223], a[48:51], v[24:27]
    v_exp_f32 v66, v66
    v_mfma_f32_16x16x32_bf16 v[24:27], a[224:227], a[64:67], v[24:27]
    buffer_load_dwordx4 v5, s[12:15], s38 offen offset:128 lds
    v_accvgpr_write_b32 a83, v227
    s_nop 1
    v_mfma_f32_16x16x32_bf16 v[24:27], a[228:231], a[80:83], v[24:27]
    v_exp_f32 v67, v67
    v_accvgpr_write_b32 a84, v232
    v_accvgpr_write_b32 a85, v233
    v_accvgpr_write_b32 a86, v234
    v_accvgpr_write_b32 a87, v235
    s_nop 1
    v_mfma_f32_16x16x32_bf16 v[28:31], a[228:231], a[84:87], 0
    v_exp_f32 v72, v72
    v_mfma_f32_16x16x32_bf16 v[28:31], a[224:227], a[68:71], v[28:31]
    v_exp_f32 v73, v73
    v_mfma_f32_16x16x32_bf16 v[28:31], a[220:223], a[52:55], v[28:31]
    v_exp_f32 v74, v74
    v_mfma_f32_16x16x32_bf16 v[28:31], a[216:219], a[36:39], v[28:31]
    v_exp_f32 v75, v75
    v_mfma_f32_16x16x32_bf16 v[28:31], a[212:215], a[20:23], v[28:31]
    s_addk_i32 m0, 896
    v_exp_f32 v80, v80
    v_mfma_f32_16x16x32_bf16 v[28:31], a[208:211], a[4:7], v[28:31]
    v_exp_f32 v81, v81
    v_mfma_f32_16x16x32_bf16 v[32:35], a[208:211], a[8:11], 0
    v_exp_f32 v82, v82
    v_mfma_f32_16x16x32_bf16 v[32:35], a[212:215], a[24:27], v[32:35]
    v_exp_f32 v83, v83
    v_mfma_f32_16x16x32_bf16 v[32:35], a[216:219], a[40:43], v[32:35]
    v_exp_f32 v88, v88
    v_mfma_f32_16x16x32_bf16 v[32:35], a[220:223], a[56:59], v[32:35]
    v_exp_f32 v89, v89
    v_mfma_f32_16x16x32_bf16 v[32:35], a[224:227], a[72:75], v[32:35]
    buffer_load_dwordx4 v5, s[12:15], s38 offen offset:256 lds
    v_accvgpr_write_b32 a88, v240
    v_accvgpr_write_b32 a89, v241
    v_accvgpr_write_b32 a90, v242
    v_accvgpr_write_b32 a91, v243
    s_nop 1
    v_mfma_f32_16x16x32_bf16 v[32:35], a[228:231], a[88:91], v[32:35]
    s_add_u32 s38, s38, 24576
    v_exp_f32 v90, v90
    v_accvgpr_write_b32 a92, v248
    v_accvgpr_write_b32 a93, v249
    v_accvgpr_write_b32 a94, v250
    v_accvgpr_write_b32 a95, v251
    s_nop 1
    v_mfma_f32_16x16x32_bf16 v[36:39], a[228:231], a[92:95], 0
    v_exp_f32 v91, v91
    v_mfma_f32_16x16x32_bf16 v[36:39], a[224:227], a[76:79], v[36:39]
    v_cvt_pk_bf16_f32 v64, v64, v65
    v_cvt_pk_bf16_f32 v65, v66, v67
    v_mfma_f32_16x16x32_bf16 v[36:39], a[220:223], a[60:63], v[36:39]
    s_add_u32 s39, s40, 49152
    v_exp_f32 v24, v24
    v_mfma_f32_16x16x32_bf16 v[36:39], a[216:219], a[44:47], v[36:39]
    s_waitcnt lgkmcnt(0)
    v_exp_f32 v25, v25
    v_mfma_f32_16x16x32_bf16 v[36:39], a[212:215], a[28:31], v[36:39]
    s_add_u32 m0, s63, 90112
    ds_read_b128 a[212:215], v13 offset:18432
    v_cvt_pk_bf16_f32 v72, v72, v73
    v_mfma_f32_16x16x32_bf16 v[36:39], a[208:211], a[12:15], v[36:39]
    ds_read_b128 a[220:223], v13 offset:19456
    v_cvt_pk_bf16_f32 v73, v74, v75
    v_mfma_f32_16x16x32_bf16 v[68:71], a[184:187], a[0:3], 0
    ds_read_b128 a[208:211], v12 offset:18432
    v_cvt_pk_bf16_f32 v80, v80, v81
    v_mfma_f32_16x16x32_bf16 v[68:71], a[188:191], a[16:19], v[68:71]
    ds_read_b128 a[216:219], v12 offset:19456
    v_cvt_pk_bf16_f32 v81, v82, v83
    v_mfma_f32_16x16x32_bf16 v[68:71], a[192:195], a[32:35], v[68:71]
    ds_read_b128 a[224:227], v12 offset:20480
    v_cvt_pk_bf16_f32 v88, v88, v89
    v_mfma_f32_16x16x32_bf16 v[68:71], a[196:199], a[48:51], v[68:71]
    ds_read_b128 a[228:231], v13 offset:20480
    v_cvt_pk_bf16_f32 v89, v90, v91
    v_mfma_f32_16x16x32_bf16 v[68:71], a[200:203], a[64:67], v[68:71]
    buffer_load_dwordx4 v6, s[16:19], s39 offen lds
    v_mfma_f32_16x16x32_bf16 v[68:71], a[204:207], a[80:83], v[68:71]
    v_exp_f32 v26, v26
    v_mfma_f32_16x16x32_bf16 v[76:79], a[204:207], a[84:87], 0
    v_exp_f32 v27, v27
    v_mfma_f32_16x16x32_bf16 v[76:79], a[200:203], a[68:71], v[76:79]
    v_exp_f32 v28, v28
    v_mfma_f32_16x16x32_bf16 v[76:79], a[196:199], a[52:55], v[76:79]
    s_add_u32 s39, s40, 61440
    v_exp_f32 v29, v29
    v_mfma_f32_16x16x32_bf16 v[76:79], a[192:195], a[36:39], v[76:79]
    v_exp_f32 v30, v30
    v_mfma_f32_16x16x32_bf16 v[76:79], a[188:191], a[20:23], v[76:79]
    s_addk_i32 m0, 4096
    v_exp_f32 v31, v31
    v_mfma_f32_16x16x32_bf16 v[76:79], a[184:187], a[4:7], v[76:79]
    v_cvt_pk_bf16_f32 v66, v24, v25
    v_cvt_pk_bf16_f32 v67, v26, v27
    v_mfma_f32_16x16x32_bf16 v[84:87], a[184:187], a[8:11], 0
    v_exp_f32 v32, v32
    v_mfma_f32_16x16x32_bf16 v[84:87], a[188:191], a[24:27], v[84:87]
    v_exp_f32 v33, v33
    v_mfma_f32_16x16x32_bf16 v[84:87], a[192:195], a[40:43], v[84:87]
    v_exp_f32 v34, v34
    v_mfma_f32_16x16x32_bf16 v[84:87], a[196:199], a[56:59], v[84:87]
    v_exp_f32 v35, v35
    v_mfma_f32_16x16x32_bf16 v[84:87], a[200:203], a[72:75], v[84:87]
    buffer_load_dwordx4 v6, s[16:19], s39 offen lds
    v_mfma_f32_16x16x32_bf16 v[84:87], a[204:207], a[88:91], v[84:87]
    v_cvt_pk_bf16_f32 v74, v28, v29
    v_cvt_pk_bf16_f32 v75, v30, v31
    v_mfma_f32_16x16x32_bf16 v[92:95], a[204:207], a[92:95], 0
    v_exp_f32 v36, v36
    v_mfma_f32_16x16x32_bf16 v[92:95], a[200:203], a[76:79], v[92:95]
    v_exp_f32 v37, v37
    v_mfma_f32_16x16x32_bf16 v[92:95], a[196:199], a[60:63], v[92:95]
pg_5:
    s_cbranch_execz pg_9
    v_exp_f32 v38, v38
    v_mfma_f32_16x16x32_bf16 v[92:95], a[192:195], a[44:47], v[92:95]
    s_waitcnt lgkmcnt(0)
    v_exp_f32 v39, v39
    v_mfma_f32_16x16x32_bf16 v[92:95], a[188:191], a[28:31], v[92:95]
    s_add_u32 m0, s49, 0
    v_add_u32 v8, v19, v8
    v_add_u32 v9, v19, v9
    v_mfma_f32_16x16x32_bf16 v[92:95], a[184:187], a[12:15], v[92:95]
    v_add_u32 v10, v19, v10
    v_add_u32 v11, v19, v11
    v_mfma_f32_16x16x32_bf16 v[40:43], a[208:211], a[0:3], 0
    s_waitcnt vmcnt(13)
    v_cvt_pk_bf16_f32 v82, v32, v33
    v_cvt_pk_bf16_f32 v83, v34, v35
    v_mfma_f32_16x16x32_bf16 v[40:43], a[212:215], a[16:19], v[40:43]
    s_barrier
    v_mfma_f32_16x16x32_bf16 v[40:43], a[216:219], a[32:35], v[40:43]
    ds_read_b128 a[184:187], v12 offset:24576
    v_cvt_pk_bf16_f32 v90, v36, v37
    v_mfma_f32_16x16x32_bf16 v[40:43], a[220:223], a[48:51], v[40:43]
    ds_read_b128 a[188:191], v13 offset:24576
    v_cvt_pk_bf16_f32 v91, v38, v39
    v_mfma_f32_16x16x32_bf16 v[40:43], a[224:227], a[64:67], v[40:43]
    buffer_load_dwordx4 v4, s[12:15], s38 offen offset:0 lds
    v_mfma_f32_16x16x32_bf16 v[40:43], a[228:231], a[80:83], v[40:43]
    v_exp_f32 v68, v68
    v_mfma_f32_16x16x32_bf16 v[44:47], a[228:231], a[84:87], 0
    v_exp_f32 v69, v69
    v_mfma_f32_16x16x32_bf16 v[44:47], a[224:227], a[68:71], v[44:47]
    ds_read_b128 a[192:195], v12 offset:25600
    v_cvt_pk_bf16_f32 v68, v68, v69
    v_mfma_f32_16x16x32_bf16 v[44:47], a[220:223], a[52:55], v[44:47]
    v_exp_f32 v70, v70
    v_mfma_f32_16x16x32_bf16 v[44:47], a[216:219], a[36:39], v[44:47]
    v_exp_f32 v71, v71
    v_mfma_f32_16x16x32_bf16 v[44:47], a[212:215], a[20:23], v[44:47]
    s_addk_i32 m0, 896
    ds_read_b128 a[196:199], v13 offset:25600
    v_cvt_pk_bf16_f32 v69, v70, v71
    v_mfma_f32_16x16x32_bf16 v[44:47], a[208:211], a[4:7], v[44:47]
    v_exp_f32 v76, v76
    v_mfma_f32_16x16x32_bf16 v[48:51], a[208:211], a[8:11], 0
    buffer_load_dword a252, v22, s[32:35], s42 offen offset:0
    v_mfma_f32_16x16x32_bf16 v[48:51], a[212:215], a[24:27], v[48:51]
    v_exp_f32 v77, v77
    v_mfma_f32_16x16x32_bf16 v[48:51], a[216:219], a[40:43], v[48:51]
    ds_read_b128 a[200:203], v12 offset:26624
    v_cvt_pk_bf16_f32 v76, v76, v77
    v_mfma_f32_16x16x32_bf16 v[48:51], a[220:223], a[56:59], v[48:51]
    v_exp_f32 v78, v78
    v_mfma_f32_16x16x32_bf16 v[48:51], a[224:227], a[72:75], v[48:51]
    buffer_load_dwordx4 v4, s[12:15], s38 offen offset:128 lds
    v_mfma_f32_16x16x32_bf16 v[48:51], a[228:231], a[88:91], v[48:51]
    v_exp_f32 v79, v79
    v_mfma_f32_16x16x32_bf16 v[52:55], a[228:231], a[92:95], 0
    ds_read_b128 a[204:207], v13 offset:26624
    v_cvt_pk_bf16_f32 v77, v78, v79
    v_mfma_f32_16x16x32_bf16 v[52:55], a[224:227], a[76:79], v[52:55]
    v_exp_f32 v84, v84
    v_mfma_f32_16x16x32_bf16 v[52:55], a[220:223], a[60:63], v[52:55]
    v_exp_f32 v85, v85
    v_mfma_f32_16x16x32_bf16 v[52:55], a[216:219], a[44:47], v[52:55]
    s_waitcnt lgkmcnt(1)
    v_exp_f32 v86, v86
    v_mfma_f32_16x16x32_bf16 v[52:55], a[212:215], a[28:31], v[52:55]
    s_addk_i32 m0, 896
    ds_read_b128 a[212:215], v13 offset:30720
    v_cvt_pk_bf16_f32 v84, v84, v85
    v_mfma_f32_16x16x32_bf16 v[52:55], a[208:211], a[12:15], v[52:55]
    v_exp_f32 v87, v87
    v_mfma_f32_16x16x32_bf16 v[96:99], a[184:187], a[0:3], 0
    ds_read_b128 a[220:223], v13 offset:31744
    v_cvt_pk_bf16_f32 v85, v86, v87
    v_mfma_f32_16x16x32_bf16 v[96:99], a[188:191], a[16:19], v[96:99]
    v_exp_f32 v92, v92
    v_mfma_f32_16x16x32_bf16 v[96:99], a[192:195], a[32:35], v[96:99]
    s_waitcnt lgkmcnt(2)
    v_exp_f32 v93, v93
    v_mfma_f32_16x16x32_bf16 v[96:99], a[196:199], a[48:51], v[96:99]
    ds_read_b128 a[208:211], v12 offset:30720
    v_cvt_pk_bf16_f32 v92, v92, v93
    v_mfma_f32_16x16x32_bf16 v[96:99], a[200:203], a[64:67], v[96:99]
    buffer_load_dwordx4 v4, s[12:15], s38 offen offset:256 lds
    v_mfma_f32_16x16x32_bf16 v[96:99], a[204:207], a[80:83], v[96:99]
    v_exp_f32 v94, v94
    v_mfma_f32_16x16x32_bf16 v[104:107], a[204:207], a[84:87], 0
    v_exp_f32 v95, v95
    v_mfma_f32_16x16x32_bf16 v[104:107], a[200:203], a[68:71], v[104:107]
    ds_read_b128 a[216:219], v12 offset:31744
    v_cvt_pk_bf16_f32 v93, v94, v95
    v_mfma_f32_16x16x32_bf16 v[104:107], a[196:199], a[52:55], v[104:107]
    v_exp_f32 v40, v40
    v_mfma_f32_16x16x32_bf16 v[104:107], a[192:195], a[36:39], v[104:107]
    v_exp_f32 v41, v41
    v_mfma_f32_16x16x32_bf16 v[104:107], a[188:191], a[20:23], v[104:107]
    s_addk_i32 m0, 1280
    ds_read_b128 a[224:227], v12 offset:32768
    v_cvt_pk_bf16_f32 v70, v40, v41
    v_mfma_f32_16x16x32_bf16 v[104:107], a[184:187], a[4:7], v[104:107]
    v_exp_f32 v42, v42
    v_mfma_f32_16x16x32_bf16 v[112:115], a[184:187], a[8:11], 0
    v_exp_f32 v43, v43
    v_mfma_f32_16x16x32_bf16 v[112:115], a[188:191], a[24:27], v[112:115]
    ds_read_b128 a[228:231], v13 offset:32768
    v_cvt_pk_bf16_f32 v71, v42, v43
    v_mfma_f32_16x16x32_bf16 v[112:115], a[192:195], a[40:43], v[112:115]
    v_exp_f32 v44, v44
    v_mfma_f32_16x16x32_bf16 v[112:115], a[196:199], a[56:59], v[112:115]
    v_exp_f32 v45, v45
    v_mfma_f32_16x16x32_bf16 v[112:115], a[200:203], a[72:75], v[112:115]
    buffer_load_dwordx4 v5, s[12:15], s38 offen offset:0 lds
    v_mfma_f32_16x16x32_bf16 v[112:115], a[204:207], a[88:91], v[112:115]
    v_exp_f32 v46, v46
    v_mfma_f32_16x16x32_bf16 v[120:123], a[204:207], a[92:95], 0
    ds_read_b64_tr_b16 a[232:233], v8 offset:0
    v_cvt_pk_bf16_f32 v78, v44, v45
    v_mfma_f32_16x16x32_bf16 v[120:123], a[200:203], a[76:79], v[120:123]
    v_exp_f32 v47, v47
    v_mfma_f32_16x16x32_bf16 v[120:123], a[196:199], a[60:63], v[120:123]
    ds_read_b64_tr_b16 a[234:235], v8 offset:2048
    v_cvt_pk_bf16_f32 v79, v46, v47
    v_mfma_f32_16x16x32_bf16 v[120:123], a[192:195], a[44:47], v[120:123]
    s_waitcnt lgkmcnt(2)
    v_exp_f32 v48, v48
    v_mfma_f32_16x16x32_bf16 v[120:123], a[188:191], a[28:31], v[120:123]
    s_addk_i32 m0, 896
    v_exp_f32 v49, v49
    v_mfma_f32_16x16x32_bf16 v[120:123], a[184:187], a[12:15], v[120:123]
    ds_read_b64_tr_b16 a[236:237], v9 offset:0
    v_cvt_pk_bf16_f32 v86, v48, v49
    v_mfma_f32_16x16x32_bf16 v[24:27], a[208:211], a[0:3], 0
    v_exp_f32 v50, v50
    v_mfma_f32_16x16x32_bf16 v[24:27], a[212:215], a[16:19], v[24:27]
    v_exp_f32 v51, v51
    v_mfma_f32_16x16x32_bf16 v[24:27], a[216:219], a[32:35], v[24:27]
    ds_read_b64_tr_b16 a[238:239], v9 offset:2048
    v_cvt_pk_bf16_f32 v87, v50, v51
    v_mfma_f32_16x16x32_bf16 v[24:27], a[220:223], a[48:51], v[24:27]
    v_exp_f32 v52, v52
    v_mfma_f32_16x16x32_bf16 v[24:27], a[224:227], a[64:67], v[24:27]
    buffer_load_dwordx4 v5, s[12:15], s38 offen offset:128 lds
    v_mfma_f32_16x16x32_bf16 v[24:27], a[228:231], a[80:83], v[24:27]
    v_exp_f32 v53, v53
    v_mfma_f32_16x16x32_bf16 v[28:31], a[228:231], a[84:87], 0
    ds_read_b128 a[184:187], v12 offset:36864
    v_cvt_pk_bf16_f32 v94, v52, v53
    v_mfma_f32_16x16x32_bf16 v[28:31], a[224:227], a[68:71], v[28:31]
    v_exp_f32 v54, v54
    v_mfma_f32_16x16x32_bf16 v[28:31], a[220:223], a[52:55], v[28:31]
    v_exp_f32 v55, v55
    v_mfma_f32_16x16x32_bf16 v[28:31], a[216:219], a[36:39], v[28:31]
    ds_read_b128 a[188:191], v13 offset:36864
    v_cvt_pk_bf16_f32 v95, v54, v55
    v_mfma_f32_16x16x32_bf16 v[28:31], a[212:215], a[20:23], v[28:31]
    s_addk_i32 m0, 896
    v_exp_f32 v96, v96
    v_mfma_f32_16x16x32_bf16 v[28:31], a[208:211], a[4:7], v[28:31]
    v_exp_f32 v97, v97
    v_mfma_f32_16x16x32_bf16 v[32:35], a[208:211], a[8:11], 0
    ds_read_b128 a[192:195], v12 offset:37888
    v_cvt_pk_bf16_f32 v96, v96, v97
    v_mfma_f32_16x16x32_bf16 v[32:35], a[212:215], a[24:27], v[32:35]
    v_exp_f32 v98, v98
    v_mfma_f32_16x16x32_bf16 v[32:35], a[216:219], a[40:43], v[32:35]
    v_exp_f32 v99, v99
    v_mfma_f32_16x16x32_bf16 v[32:35], a[220:223], a[56:59], v[32:35]
    ds_read_b128 a[196:199], v13 offset:37888
    v_cvt_pk_bf16_f32 v97, v98, v99
    v_mfma_f32_16x16x32_bf16 v[32:35], a[224:227], a[72:75], v[32:35]
    buffer_load_dwordx4 v5, s[12:15], s38 offen offset:256 lds
    v_mfma_f32_16x16x32_bf16 v[32:35], a[228:231], a[88:91], v[32:35]
    s_add_u32 s38, s38, 24576
    v_exp_f32 v104, v104
    v_mfma_f32_16x16x32_bf16 v[36:39], a[228:231], a[92:95], 0
    v_exp_f32 v105, v105
    v_mfma_f32_16x16x32_bf16 v[36:39], a[224:227], a[76:79], v[36:39]
    ds_read_b128 a[200:203], v12 offset:38912
    v_cvt_pk_bf16_f32 v104, v104, v105
    v_mfma_f32_16x16x32_bf16 v[36:39], a[220:223], a[60:63], v[36:39]
    s_add_u32 s39, s40, 73728
    v_exp_f32 v106, v106
    v_mfma_f32_16x16x32_bf16 v[36:39], a[216:219], a[44:47], v[36:39]
    s_waitcnt lgkmcnt(2)
    v_exp_f32 v107, v107
    v_mfma_f32_16x16x32_bf16 v[36:39], a[212:215], a[28:31], v[36:39]
    s_add_u32 m0, s63, 98304
    ds_read_b128 a[204:207], v13 offset:38912
    v_cvt_pk_bf16_f32 v105, v106, v107
    v_mfma_f32_16x16x32_bf16 v[36:39], a[208:211], a[12:15], v[36:39]
    v_exp_f32 v112, v112
    v_mfma_f32_16x16x32_bf16 a[152:155], a[232:235], v[64:67], 0
    v_exp_f32 v113, v113
    v_mfma_f32_16x16x32_bf16 a[168:171], a[236:239], v[64:67], 0
    v_exp_f32 v114, v114
    v_mfma_f32_16x16x32_bf16 a[172:175], a[236:239], v[72:75], 0
    ds_read_b128 a[208:211], v12 offset:43008
    v_cvt_pk_bf16_f32 v112, v112, v113
    v_mfma_f32_16x16x32_bf16 a[156:159], a[232:235], v[72:75], 0
    v_exp_f32 v115, v115
    v_mfma_f32_16x16x32_bf16 a[160:163], a[232:235], v[80:83], 0
    buffer_load_dwordx4 v6, s[16:19], s39 offen lds
    v_mfma_f32_16x16x32_bf16 a[176:179], a[236:239], v[80:83], 0
    ds_read_b128 a[212:215], v13 offset:43008
    v_cvt_pk_bf16_f32 v113, v114, v115
    v_mfma_f32_16x16x32_bf16 a[180:183], a[236:239], v[88:91], 0
    v_exp_f32 v120, v120
    v_mfma_f32_16x16x32_bf16 a[164:167], a[232:235], v[88:91], 0
    v_exp_f32 v121, v121
    v_mfma_f32_16x16x32_bf16 v[100:103], a[184:187], a[0:3], 0
    s_waitcnt lgkmcnt(2)
    ds_read_b128 a[216:219], v12 offset:44032
    v_cvt_pk_bf16_f32 v120, v120, v121
    v_mfma_f32_16x16x32_bf16 v[100:103], a[188:191], a[16:19], v[100:103]
    s_add_u32 s39, s40, 86016
    v_exp_f32 v122, v122
    v_mfma_f32_16x16x32_bf16 v[100:103], a[192:195], a[32:35], v[100:103]
    s_addk_i32 m0, 4096
    v_exp_f32 v123, v123
    v_mfma_f32_16x16x32_bf16 v[100:103], a[196:199], a[48:51], v[100:103]
    ds_read_b128 a[220:223], v13 offset:44032
    v_cvt_pk_bf16_f32 v121, v122, v123
    v_mfma_f32_16x16x32_bf16 v[100:103], a[200:203], a[64:67], v[100:103]
    v_exp_f32 v24, v24
    v_mfma_f32_16x16x32_bf16 v[100:103], a[204:207], a[80:83], v[100:103]
    v_exp_f32 v25, v25
    v_mfma_f32_16x16x32_bf16 v[108:111], a[204:207], a[84:87], 0
    ds_read_b128 a[224:227], v12 offset:45056
    v_cvt_pk_bf16_f32 v98, v24, v25
    v_mfma_f32_16x16x32_bf16 v[108:111], a[200:203], a[68:71], v[108:111]
    v_exp_f32 v26, v26
    v_mfma_f32_16x16x32_bf16 v[108:111], a[196:199], a[52:55], v[108:111]
    buffer_load_dwordx4 v6, s[16:19], s39 offen lds
    v_mfma_f32_16x16x32_bf16 v[108:111], a[192:195], a[36:39], v[108:111]
    v_exp_f32 v27, v27
    v_mfma_f32_16x16x32_bf16 v[108:111], a[188:191], a[20:23], v[108:111]
    ds_read_b128 a[228:231], v13 offset:45056
    v_cvt_pk_bf16_f32 v99, v26, v27
    v_mfma_f32_16x16x32_bf16 v[108:111], a[184:187], a[4:7], v[108:111]
    v_exp_f32 v28, v28
    v_mfma_f32_16x16x32_bf16 v[116:119], a[184:187], a[8:11], 0
    v_exp_f32 v29, v29
    v_mfma_f32_16x16x32_bf16 v[116:119], a[188:191], a[24:27], v[116:119]
    v_exp_f32 v30, v30
    v_mfma_f32_16x16x32_bf16 v[116:119], a[192:195], a[40:43], v[116:119]
    v_exp_f32 v31, v31
    v_mfma_f32_16x16x32_bf16 v[116:119], a[196:199], a[56:59], v[116:119]
    v_exp_f32 v32, v32
    v_mfma_f32_16x16x32_bf16 v[116:119], a[200:203], a[72:75], v[116:119]
    v_exp_f32 v33, v33
    v_mfma_f32_16x16x32_bf16 v[116:119], a[204:207], a[88:91], v[116:119]
    v_exp_f32 v34, v34
    v_mfma_f32_16x16x32_bf16 v[124:127], a[204:207], a[92:95], 0
    v_exp_f32 v35, v35
    v_mfma_f32_16x16x32_bf16 v[124:127], a[200:203], a[76:79], v[124:127]
    v_cvt_pk_bf16_f32 v106, v28, v29
    v_cvt_pk_bf16_f32 v107, v30, v31
    v_mfma_f32_16x16x32_bf16 v[124:127], a[196:199], a[60:63], v[124:127]
    s_add_u32 m0, s49, 24576
    v_exp_f32 v36, v36
    v_mfma_f32_16x16x32_bf16 v[124:127], a[192:195], a[44:47], v[124:127]
    s_waitcnt lgkmcnt(0)
    v_exp_f32 v37, v37
    v_mfma_f32_16x16x32_bf16 v[124:127], a[188:191], a[28:31], v[124:127]
    v_exp_f32 v38, v38
    v_mfma_f32_16x16x32_bf16 v[124:127], a[184:187], a[12:15], v[124:127]
    v_exp_f32 v39, v39
    v_mfma_f32_16x16x32_bf16 v[40:43], a[208:211], a[0:3], 0
    s_waitcnt vmcnt(11)
    v_cvt_pk_bf16_f32 v114, v32, v33
    v_cvt_pk_bf16_f32 v115, v34, v35
    v_mfma_f32_16x16x32_bf16 v[40:43], a[212:215], a[16:19], v[40:43]
    s_barrier
    v_mfma_f32_16x16x32_bf16 v[40:43], a[216:219], a[32:35], v[40:43]
    buffer_load_dwordx4 v4, s[12:15], s38 offen offset:0 lds
    v_mfma_f32_16x16x32_bf16 v[40:43], a[220:223], a[48:51], v[40:43]
    ds_read_b64_tr_b16 a[240:241], v8 offset:4096
    v_cvt_pk_bf16_f32 v122, v36, v37
    v_mfma_f32_16x16x32_bf16 v[40:43], a[224:227], a[64:67], v[40:43]
    ds_read_b64_tr_b16 a[242:243], v8 offset:6144
    v_cvt_pk_bf16_f32 v123, v38, v39
    v_mfma_f32_16x16x32_bf16 v[40:43], a[228:231], a[80:83], v[40:43]
    v_exp_f32 v100, v100
    v_mfma_f32_16x16x32_bf16 v[44:47], a[228:231], a[84:87], 0
    v_exp_f32 v101, v101
    v_mfma_f32_16x16x32_bf16 v[44:47], a[224:227], a[68:71], v[44:47]
    ds_read_b64_tr_b16 a[244:245], v9 offset:4096
    v_cvt_pk_bf16_f32 v100, v100, v101
    v_mfma_f32_16x16x32_bf16 v[44:47], a[220:223], a[52:55], v[44:47]
    s_addk_i32 m0, 896
    v_exp_f32 v102, v102
    v_mfma_f32_16x16x32_bf16 v[44:47], a[216:219], a[36:39], v[44:47]
    v_exp_f32 v103, v103
    v_mfma_f32_16x16x32_bf16 v[44:47], a[212:215], a[20:23], v[44:47]
    ds_read_b64_tr_b16 a[246:247], v9 offset:6144
    v_cvt_pk_bf16_f32 v101, v102, v103
    v_mfma_f32_16x16x32_bf16 v[44:47], a[208:211], a[4:7], v[44:47]
    v_exp_f32 v108, v108
    v_mfma_f32_16x16x32_bf16 v[48:51], a[208:211], a[8:11], 0
    buffer_load_dword a252, v22, s[32:35], s42 offen offset:1536
    s_add_u32 s42, s42, 3072
    v_mfma_f32_16x16x32_bf16 v[48:51], a[212:215], a[24:27], v[48:51]
    v_exp_f32 v109, v109
    v_mfma_f32_16x16x32_bf16 v[48:51], a[216:219], a[40:43], v[48:51]
    buffer_load_dwordx4 v4, s[12:15], s38 offen offset:128 lds
    v_mfma_f32_16x16x32_bf16 v[48:51], a[220:223], a[56:59], v[48:51]
    ds_read_b128 a[184:187], v12 offset:49152
    v_cvt_pk_bf16_f32 v108, v108, v109
    v_mfma_f32_16x16x32_bf16 v[48:51], a[224:227], a[72:75], v[48:51]
    v_exp_f32 v110, v110
    v_mfma_f32_16x16x32_bf16 v[48:51], a[228:231], a[88:91], v[48:51]
    v_exp_f32 v111, v111
    v_mfma_f32_16x16x32_bf16 v[52:55], a[228:231], a[92:95], 0
    ds_read_b128 a[188:191], v13 offset:49152
    v_cvt_pk_bf16_f32 v109, v110, v111
    v_mfma_f32_16x16x32_bf16 v[52:55], a[224:227], a[76:79], v[52:55]
    v_exp_f32 v116, v116
    v_mfma_f32_16x16x32_bf16 v[52:55], a[220:223], a[60:63], v[52:55]
    s_addk_i32 m0, 896
    ds_read_b128 a[192:195], v12 offset:50176
    v_accvgpr_write_b32 a96, v64
    v_mfma_f32_16x16x32_bf16 v[52:55], a[216:219], a[44:47], v[52:55]
    s_waitcnt lgkmcnt(3)
    v_exp_f32 v117, v117
    v_mfma_f32_16x16x32_bf16 v[52:55], a[212:215], a[28:31], v[52:55]
    ds_read_b128 a[196:199], v13 offset:50176
    v_cvt_pk_bf16_f32 v116, v116, v117
    v_mfma_f32_16x16x32_bf16 v[52:55], a[208:211], a[12:15], v[52:55]
    v_exp_f32 v118, v118
    v_mfma_f32_16x16x32_bf16 a[164:167], a[240:243], v[92:95], a[164:167]
    v_exp_f32 v119, v119
    v_mfma_f32_16x16x32_bf16 a[180:183], a[244:247], v[92:95], a[180:183]
    ds_read_b128 a[200:203], v12 offset:51200
    v_cvt_pk_bf16_f32 v117, v118, v119
    v_mfma_f32_16x16x32_bf16 a[176:179], a[244:247], v[84:87], a[176:179]
    buffer_load_dwordx4 v4, s[12:15], s38 offen offset:256 lds
    v_mfma_f32_16x16x32_bf16 a[160:163], a[240:243], v[84:87], a[160:163]
    ds_read_b128 a[204:207], v13 offset:51200
    v_accvgpr_write_b32 a97, v65
    v_mfma_f32_16x16x32_bf16 a[156:159], a[240:243], v[76:79], a[156:159]
    v_exp_f32 v124, v124
    v_mfma_f32_16x16x32_bf16 a[172:175], a[244:247], v[76:79], a[172:175]
    s_waitcnt lgkmcnt(2)
    v_exp_f32 v125, v125
    v_mfma_f32_16x16x32_bf16 a[168:171], a[244:247], v[68:71], a[168:171]
    ds_read_b128 a[208:211], v12 offset:55296
    v_cvt_pk_bf16_f32 v124, v124, v125
    v_mfma_f32_16x16x32_bf16 a[152:155], a[240:243], v[68:71], a[152:155]
    v_exp_f32 v126, v126
    v_mfma_f32_16x16x32_bf16 v[128:131], a[184:187], a[0:3], 0
    s_addk_i32 m0, 1280
    v_exp_f32 v127, v127
    v_mfma_f32_16x16x32_bf16 v[128:131], a[188:191], a[16:19], v[128:131]
    s_waitcnt lgkmcnt(2)
    ds_read_b128 a[212:215], v13 offset:55296
    v_cvt_pk_bf16_f32 v125, v126, v127
    v_mfma_f32_16x16x32_bf16 v[128:131], a[192:195], a[32:35], v[128:131]
    s_waitcnt lgkmcnt(2)
    v_exp_f32 v40, v40
    v_mfma_f32_16x16x32_bf16 v[128:131], a[196:199], a[48:51], v[128:131]
    ds_read_b128 a[216:219], v12 offset:56320
    v_accvgpr_write_b32 a98, v66
    v_mfma_f32_16x16x32_bf16 v[128:131], a[200:203], a[64:67], v[128:131]
    v_exp_f32 v41, v41
    v_mfma_f32_16x16x32_bf16 v[128:131], a[204:207], a[80:83], v[128:131]
    ds_read_b128 a[220:223], v13 offset:56320
    v_cvt_pk_bf16_f32 v102, v40, v41
    v_mfma_f32_16x16x32_bf16 v[136:139], a[204:207], a[84:87], 0
    buffer_load_dwordx4 v5, s[12:15], s38 offen offset:0 lds
    v_mfma_f32_16x16x32_bf16 v[136:139], a[200:203], a[68:71], v[136:139]
    v_exp_f32 v42, v42
    v_mfma_f32_16x16x32_bf16 v[136:139], a[196:199], a[52:55], v[136:139]
    v_exp_f32 v43, v43
    v_mfma_f32_16x16x32_bf16 v[136:139], a[192:195], a[36:39], v[136:139]
    ds_read_b128 a[224:227], v12 offset:57344
    v_cvt_pk_bf16_f32 v103, v42, v43
    v_mfma_f32_16x16x32_bf16 v[136:139], a[188:191], a[20:23], v[136:139]
    v_exp_f32 v44, v44
    v_mfma_f32_16x16x32_bf16 v[136:139], a[184:187], a[4:7], v[136:139]
    ds_read_b128 a[228:231], v13 offset:57344
    v_accvgpr_write_b32 a99, v67
    v_mfma_f32_16x16x32_bf16 v[144:147], a[184:187], a[8:11], 0
    s_addk_i32 m0, 896
    v_exp_f32 v45, v45
    v_mfma_f32_16x16x32_bf16 v[144:147], a[188:191], a[24:27], v[144:147]
    v_exp_f32 v46, v46
    v_mfma_f32_16x16x32_bf16 v[144:147], a[192:195], a[40:43], v[144:147]
    v_exp_f32 v47, v47
    v_mfma_f32_16x16x32_bf16 v[144:147], a[196:199], a[56:59], v[144:147]
    v_exp_f32 v48, v48
    v_mfma_f32_16x16x32_bf16 v[144:147], a[200:203], a[72:75], v[144:147]
    v_exp_f32 v49, v49
    v_mfma_f32_16x16x32_bf16 v[144:147], a[204:207], a[88:91], v[144:147]
    v_exp_f32 v50, v50
    v_mfma_f32_16x16x32_bf16 v[152:155], a[204:207], a[92:95], 0
    buffer_load_dwordx4 v5, s[12:15], s38 offen offset:128 lds
    v_mfma_f32_16x16x32_bf16 v[152:155], a[200:203], a[76:79], v[152:155]
    ds_read_b64_tr_b16 a[232:233], v8 offset:8192
    v_cvt_pk_bf16_f32 v110, v44, v45
    v_mfma_f32_16x16x32_bf16 v[152:155], a[196:199], a[60:63], v[152:155]
    ds_read_b64_tr_b16 a[234:235], v8 offset:10240
    v_cvt_pk_bf16_f32 v111, v46, v47
    v_mfma_f32_16x16x32_bf16 v[152:155], a[192:195], a[44:47], v[152:155]
    s_waitcnt lgkmcnt(2)
    ds_read_b64_tr_b16 a[236:237], v9 offset:8192
    v_cvt_pk_bf16_f32 v118, v48, v49
    v_mfma_f32_16x16x32_bf16 v[152:155], a[188:191], a[28:31], v[152:155]
    ds_read_b64_tr_b16 a[238:239], v9 offset:10240
    v_accvgpr_write_b32 a100, v68
    v_mfma_f32_16x16x32_bf16 v[152:155], a[184:187], a[12:15], v[152:155]
    v_exp_f32 v51, v51
    v_mfma_f32_16x16x32_bf16 v[24:27], a[208:211], a[0:3], 0
    s_addk_i32 m0, 896
    v_exp_f32 v52, v52
    v_mfma_f32_16x16x32_bf16 v[24:27], a[212:215], a[16:19], v[24:27]
    v_exp_f32 v53, v53
    v_mfma_f32_16x16x32_bf16 v[24:27], a[216:219], a[32:35], v[24:27]
    ds_read_b128 a[184:187], v12 offset:61440
    v_cvt_pk_bf16_f32 v119, v50, v51
    v_mfma_f32_16x16x32_bf16 v[24:27], a[220:223], a[48:51], v[24:27]
    ds_read_b128 a[188:191], v13 offset:61440
    v_cvt_pk_bf16_f32 v126, v52, v53
    v_mfma_f32_16x16x32_bf16 v[24:27], a[224:227], a[64:67], v[24:27]
    ds_read_b128 a[192:195], v12 offset:62464
    v_accvgpr_write_b32 a101, v69
    v_mfma_f32_16x16x32_bf16 v[24:27], a[228:231], a[80:83], v[24:27]
    v_exp_f32 v54, v54
    v_mfma_f32_16x16x32_bf16 v[28:31], a[228:231], a[84:87], 0
    buffer_load_dwordx4 v5, s[12:15], s38 offen offset:256 lds
    v_mfma_f32_16x16x32_bf16 v[28:31], a[224:227], a[68:71], v[28:31]
    s_add_u32 s38, s38, 24576
    v_exp_f32 v55, v55
    v_mfma_f32_16x16x32_bf16 v[28:31], a[220:223], a[52:55], v[28:31]
    ds_read_b128 a[196:199], v13 offset:62464
    v_cvt_pk_bf16_f32 v127, v54, v55
    v_mfma_f32_16x16x32_bf16 v[28:31], a[216:219], a[36:39], v[28:31]
    v_exp_f32 v128, v128
    v_mfma_f32_16x16x32_bf16 v[28:31], a[212:215], a[20:23], v[28:31]
    s_add_u32 s39, s40, 98304
    ds_read_b128 a[200:203], v12 offset:63488
    v_add_u32 v12, 67584, v12
    v_mfma_f32_16x16x32_bf16 v[28:31], a[208:211], a[4:7], v[28:31]
    ds_read_b128 a[204:207], v13 offset:63488
    v_add_u32 v13, 67584, v13
    v_mfma_f32_16x16x32_bf16 v[32:35], a[208:211], a[8:11], 0
    s_add_u32 m0, s63, 106496
    v_exp_f32 v129, v129
    v_mfma_f32_16x16x32_bf16 v[32:35], a[212:215], a[24:27], v[32:35]
    v_exp_f32 v130, v130
    v_mfma_f32_16x16x32_bf16 v[32:35], a[216:219], a[40:43], v[32:35]
    v_exp_f32 v131, v131
    v_mfma_f32_16x16x32_bf16 v[32:35], a[220:223], a[56:59], v[32:35]
    v_exp_f32 v136, v136
    v_mfma_f32_16x16x32_bf16 v[32:35], a[224:227], a[72:75], v[32:35]
    v_exp_f32 v137, v137
    v_mfma_f32_16x16x32_bf16 v[32:35], a[228:231], a[88:91], v[32:35]
    v_exp_f32 v138, v138
    v_mfma_f32_16x16x32_bf16 v[36:39], a[228:231], a[92:95], 0
    buffer_load_dwordx4 v6, s[16:19], s39 offen lds
    v_mfma_f32_16x16x32_bf16 v[36:39], a[224:227], a[76:79], v[36:39]
    v_exp_f32 v139, v139
    v_mfma_f32_16x16x32_bf16 v[36:39], a[220:223], a[60:63], v[36:39]
    v_cvt_pk_bf16_f32 v128, v128, v129
    v_cvt_pk_bf16_f32 v129, v130, v131
    v_mfma_f32_16x16x32_bf16 v[36:39], a[216:219], a[44:47], v[36:39]
    s_waitcnt lgkmcnt(0)
    v_exp_f32 v144, v144
    v_mfma_f32_16x16x32_bf16 v[36:39], a[212:215], a[28:31], v[36:39]
    s_add_u32 s39, s40, 110592
    v_exp_f32 v145, v145
    v_mfma_f32_16x16x32_bf16 v[36:39], a[208:211], a[12:15], v[36:39]
    v_exp_f32 v146, v146
    v_mfma_f32_16x16x32_bf16 a[152:155], a[232:235], v[96:99], a[152:155]
    s_addk_i32 m0, 4096
    v_exp_f32 v147, v147
    v_mfma_f32_16x16x32_bf16 a[168:171], a[236:239], v[96:99], a[168:171]
    v_cvt_pk_bf16_f32 v136, v136, v137
    v_cvt_pk_bf16_f32 v137, v138, v139
    v_mfma_f32_16x16x32_bf16 a[172:175], a[236:239], v[104:107], a[172:175]
    ds_read_b128 a[208:211], v12 offset:0
    v_cvt_pk_bf16_f32 v144, v144, v145
    v_mfma_f32_16x16x32_bf16 a[156:159], a[232:235], v[104:107], a[156:159]
    ds_read_b128 a[212:215], v13 offset:0
    v_cvt_pk_bf16_f32 v145, v146, v147
    v_mfma_f32_16x16x32_bf16 a[160:163], a[232:235], v[112:115], a[160:163]
    ds_read_b128 a[216:219], v12 offset:1024
    v_accvgpr_write_b32 a102, v70
    v_mfma_f32_16x16x32_bf16 a[176:179], a[236:239], v[112:115], a[176:179]
    ds_read_b128 a[220:223], v13 offset:1024
    v_accvgpr_write_b32 a103, v71
    v_mfma_f32_16x16x32_bf16 a[180:183], a[236:239], v[120:123], a[180:183]
    buffer_load_dwordx4 v6, s[16:19], s39 offen lds
    v_mfma_f32_16x16x32_bf16 a[164:167], a[232:235], v[120:123], a[164:167]
    ds_read_b128 a[224:227], v12 offset:2048
    v_accvgpr_write_b32 a104, v72
    v_mfma_f32_16x16x32_bf16 v[132:135], a[184:187], a[0:3], 0
    ds_read_b128 a[228:231], v13 offset:2048
    v_subrev_u32 v12, 67584, v12
    v_mfma_f32_16x16x32_bf16 v[132:135], a[188:191], a[16:19], v[132:135]
    v_exp_f32 v152, v152
    v_mfma_f32_16x16x32_bf16 v[132:135], a[192:195], a[32:35], v[132:135]
    v_exp_f32 v153, v153
    v_mfma_f32_16x16x32_bf16 v[132:135], a[196:199], a[48:51], v[132:135]
    v_exp_f32 v154, v154
    v_mfma_f32_16x16x32_bf16 v[132:135], a[200:203], a[64:67], v[132:135]
    v_exp_f32 v155, v155
    v_mfma_f32_16x16x32_bf16 v[132:135], a[204:207], a[80:83], v[132:135]
    v_exp_f32 v24, v24
    v_mfma_f32_16x16x32_bf16 v[140:143], a[204:207], a[84:87], 0
    v_exp_f32 v25, v25
    v_mfma_f32_16x16x32_bf16 v[140:143], a[200:203], a[68:71], v[140:143]
    v_exp_f32 v26, v26
    v_mfma_f32_16x16x32_bf16 v[140:143], a[196:199], a[52:55], v[140:143]
    v_exp_f32 v27, v27
    v_mfma_f32_16x16x32_bf16 v[140:143], a[192:195], a[36:39], v[140:143]
    v_cvt_pk_bf16_f32 v152, v152, v153
    v_cvt_pk_bf16_f32 v153, v154, v155
    v_mfma_f32_16x16x32_bf16 v[140:143], a[188:191], a[20:23], v[140:143]
    v_exp_f32 v28, v28
    v_mfma_f32_16x16x32_bf16 v[140:143], a[184:187], a[4:7], v[140:143]
    v_exp_f32 v29, v29
    v_mfma_f32_16x16x32_bf16 v[148:151], a[184:187], a[8:11], 0
    v_exp_f32 v30, v30
    v_mfma_f32_16x16x32_bf16 v[148:151], a[188:191], a[24:27], v[148:151]
    v_exp_f32 v31, v31
    v_mfma_f32_16x16x32_bf16 v[148:151], a[192:195], a[40:43], v[148:151]
    v_cvt_pk_bf16_f32 v130, v24, v25
    v_cvt_pk_bf16_f32 v131, v26, v27
    v_mfma_f32_16x16x32_bf16 v[148:151], a[196:199], a[56:59], v[148:151]
    v_exp_f32 v32, v32
    v_mfma_f32_16x16x32_bf16 v[148:151], a[200:203], a[72:75], v[148:151]
    v_exp_f32 v33, v33
    v_mfma_f32_16x16x32_bf16 v[148:151], a[204:207], a[88:91], v[148:151]
    v_exp_f32 v34, v34
    v_mfma_f32_16x16x32_bf16 v[156:159], a[204:207], a[92:95], 0
    v_exp_f32 v35, v35
    v_mfma_f32_16x16x32_bf16 v[156:159], a[200:203], a[76:79], v[156:159]
    v_cvt_pk_bf16_f32 v138, v28, v29
    v_cvt_pk_bf16_f32 v139, v30, v31
    v_mfma_f32_16x16x32_bf16 v[156:159], a[196:199], a[60:63], v[156:159]
    s_add_u32 m0, s49, 49152
    v_exp_f32 v36, v36
    v_mfma_f32_16x16x32_bf16 v[156:159], a[192:195], a[44:47], v[156:159]
    s_waitcnt lgkmcnt(0)
    v_exp_f32 v37, v37
    v_mfma_f32_16x16x32_bf16 v[156:159], a[188:191], a[28:31], v[156:159]
    v_exp_f32 v38, v38
    v_mfma_f32_16x16x32_bf16 v[156:159], a[184:187], a[12:15], v[156:159]
    v_exp_f32 v39, v39
    v_mfma_f32_16x16x32_bf16 v[40:43], a[208:211], a[0:3], 0
    s_waitcnt vmcnt(11)
    v_cvt_pk_bf16_f32 v146, v32, v33
    v_cvt_pk_bf16_f32 v147, v34, v35
    v_mfma_f32_16x16x32_bf16 v[40:43], a[212:215], a[16:19], v[40:43]
    s_barrier
    v_mfma_f32_16x16x32_bf16 v[40:43], a[216:219], a[32:35], v[40:43]
    buffer_load_dwordx4 v4, s[12:15], s38 offen offset:0 lds
    v_mfma_f32_16x16x32_bf16 v[40:43], a[220:223], a[48:51], v[40:43]
    ds_read_b64_tr_b16 a[240:241], v8 offset:12288
    v_cvt_pk_bf16_f32 v154, v36, v37
    v_mfma_f32_16x16x32_bf16 v[40:43], a[224:227], a[64:67], v[40:43]
    ds_read_b64_tr_b16 a[242:243], v8 offset:14336
    v_cvt_pk_bf16_f32 v155, v38, v39
    v_mfma_f32_16x16x32_bf16 v[40:43], a[228:231], a[80:83], v[40:43]
    ds_read_b64_tr_b16 a[244:245], v9 offset:12288
    v_accvgpr_write_b32 a105, v73
    v_mfma_f32_16x16x32_bf16 v[44:47], a[228:231], a[84:87], 0
    ds_read_b64_tr_b16 a[246:247], v9 offset:14336
    v_subrev_u32 v13, 67584, v13
    v_mfma_f32_16x16x32_bf16 v[44:47], a[224:227], a[68:71], v[44:47]
    ds_read_b128 a[184:187], v12 offset:0
    v_accvgpr_write_b32 a106, v74
    v_mfma_f32_16x16x32_bf16 v[44:47], a[220:223], a[52:55], v[44:47]
    s_addk_i32 m0, 896
    ds_read_b128 a[188:191], v13 offset:0
    v_accvgpr_write_b32 a107, v75
    v_mfma_f32_16x16x32_bf16 v[44:47], a[216:219], a[36:39], v[44:47]
    ds_read_b128 a[192:195], v12 offset:1024
    v_accvgpr_write_b32 a108, v76
    v_mfma_f32_16x16x32_bf16 v[44:47], a[212:215], a[20:23], v[44:47]
    ds_read_b128 a[196:199], v13 offset:1024
    v_accvgpr_write_b32 a109, v77
    v_mfma_f32_16x16x32_bf16 v[44:47], a[208:211], a[4:7], v[44:47]
    v_exp_f32 v132, v132
    v_mfma_f32_16x16x32_bf16 v[48:51], a[208:211], a[8:11], 0
    buffer_load_dword a252, v22, s[32:35], s42 offen offset:0
    v_mfma_f32_16x16x32_bf16 v[48:51], a[212:215], a[24:27], v[48:51]
    v_exp_f32 v133, v133
    v_mfma_f32_16x16x32_bf16 v[48:51], a[216:219], a[40:43], v[48:51]
    buffer_load_dwordx4 v4, s[12:15], s38 offen offset:128 lds
    v_mfma_f32_16x16x32_bf16 v[48:51], a[220:223], a[56:59], v[48:51]
    ds_read_b128 a[200:203], v12 offset:2048
    v_cvt_pk_bf16_f32 v132, v132, v133
    v_mfma_f32_16x16x32_bf16 v[48:51], a[224:227], a[72:75], v[48:51]
    v_exp_f32 v134, v134
    v_mfma_f32_16x16x32_bf16 v[48:51], a[228:231], a[88:91], v[48:51]
    ds_read_b128 a[204:207], v13 offset:2048
    v_accvgpr_write_b32 a110, v78
    v_mfma_f32_16x16x32_bf16 v[52:55], a[228:231], a[92:95], 0
pg_6:
    s_cbranch_execz pg_10
    v_exp_f32 v135, v135
    v_mfma_f32_16x16x32_bf16 v[52:55], a[224:227], a[76:79], v[52:55]
    v_exp_f32 v140, v140
    v_mfma_f32_16x16x32_bf16 v[52:55], a[220:223], a[60:63], v[52:55]
    s_addk_i32 m0, 896
    v_exp_f32 v141, v141
    v_mfma_f32_16x16x32_bf16 v[52:55], a[216:219], a[44:47], v[52:55]
    s_waitcnt lgkmcnt(2)
    v_exp_f32 v142, v142
    v_mfma_f32_16x16x32_bf16 v[52:55], a[212:215], a[28:31], v[52:55]
    v_exp_f32 v143, v143
    v_mfma_f32_16x16x32_bf16 v[52:55], a[208:211], a[12:15], v[52:55]
    v_exp_f32 v148, v148
    v_mfma_f32_16x16x32_bf16 a[164:167], a[240:243], v[124:127], a[164:167]
    v_exp_f32 v149, v149
    v_mfma_f32_16x16x32_bf16 a[180:183], a[244:247], v[124:127], a[180:183]
    v_cvt_pk_bf16_f32 v133, v134, v135
    v_cvt_pk_bf16_f32 v140, v140, v141
    v_mfma_f32_16x16x32_bf16 a[176:179], a[244:247], v[116:119], a[176:179]
    buffer_load_dwordx4 v4, s[12:15], s38 offen offset:256 lds
    v_mfma_f32_16x16x32_bf16 a[160:163], a[240:243], v[116:119], a[160:163]
    ds_read_b128 a[208:211], v12 offset:6144
    v_cvt_pk_bf16_f32 v141, v142, v143
    v_mfma_f32_16x16x32_bf16 a[156:159], a[240:243], v[108:111], a[156:159]
    ds_read_b128 a[212:215], v13 offset:6144
    v_cvt_pk_bf16_f32 v148, v148, v149
    v_mfma_f32_16x16x32_bf16 a[172:175], a[244:247], v[108:111], a[172:175]
    ds_read_b128 a[216:219], v12 offset:7168
    v_accvgpr_write_b32 a111, v79
    v_mfma_f32_16x16x32_bf16 a[168:171], a[244:247], v[100:103], a[168:171]
    v_exp_f32 v150, v150
    v_mfma_f32_16x16x32_bf16 a[152:155], a[240:243], v[100:103], a[152:155]
    v_exp_f32 v151, v151
    v_mfma_f32_16x16x32_bf16 v[160:163], a[184:187], a[0:3], 0
    s_addk_i32 m0, 1280
    ds_read_b128 a[220:223], v13 offset:7168
    v_cvt_pk_bf16_f32 v149, v150, v151
    v_mfma_f32_16x16x32_bf16 v[160:163], a[188:191], a[16:19], v[160:163]
    s_waitcnt lgkmcnt(4)
    ds_read_b128 a[224:227], v12 offset:8192
    v_accvgpr_write_b32 a112, v80
    v_mfma_f32_16x16x32_bf16 v[160:163], a[192:195], a[32:35], v[160:163]
    v_exp_f32 v156, v156
    v_mfma_f32_16x16x32_bf16 v[160:163], a[196:199], a[48:51], v[160:163]
    v_exp_f32 v157, v157
    v_mfma_f32_16x16x32_bf16 v[160:163], a[200:203], a[64:67], v[160:163]
    ds_read_b128 a[228:231], v13 offset:8192
    v_cvt_pk_bf16_f32 v156, v156, v157
    v_mfma_f32_16x16x32_bf16 v[160:163], a[204:207], a[80:83], v[160:163]
    v_exp_f32 v158, v158
    v_mfma_f32_16x16x32_bf16 v[168:171], a[204:207], a[84:87], 0
    buffer_load_dwordx4 v5, s[12:15], s38 offen offset:0 lds
    v_mfma_f32_16x16x32_bf16 v[168:171], a[200:203], a[68:71], v[168:171]
    v_exp_f32 v159, v159
    v_mfma_f32_16x16x32_bf16 v[168:171], a[196:199], a[52:55], v[168:171]
    v_exp_f32 v40, v40
    v_mfma_f32_16x16x32_bf16 v[168:171], a[192:195], a[36:39], v[168:171]
    v_exp_f32 v41, v41
    v_mfma_f32_16x16x32_bf16 v[168:171], a[188:191], a[20:23], v[168:171]
    v_exp_f32 v42, v42
    v_mfma_f32_16x16x32_bf16 v[168:171], a[184:187], a[4:7], v[168:171]
    v_exp_f32 v43, v43
    v_mfma_f32_16x16x32_bf16 v[176:179], a[184:187], a[8:11], 0
    s_addk_i32 m0, 896
    v_cvt_pk_bf16_f32 v157, v158, v159
    v_cvt_pk_bf16_f32 v134, v40, v41
    v_mfma_f32_16x16x32_bf16 v[176:179], a[188:191], a[24:27], v[176:179]
    v_exp_f32 v44, v44
    v_mfma_f32_16x16x32_bf16 v[176:179], a[192:195], a[40:43], v[176:179]
    v_exp_f32 v45, v45
    v_mfma_f32_16x16x32_bf16 v[176:179], a[196:199], a[56:59], v[176:179]
    v_exp_f32 v46, v46
    v_mfma_f32_16x16x32_bf16 v[176:179], a[200:203], a[72:75], v[176:179]
    v_exp_f32 v47, v47
    v_mfma_f32_16x16x32_bf16 v[176:179], a[204:207], a[88:91], v[176:179]
    v_cvt_pk_bf16_f32 v135, v42, v43
    v_cvt_pk_bf16_f32 v142, v44, v45
    v_mfma_f32_16x16x32_bf16 v[184:187], a[204:207], a[92:95], 0
    buffer_load_dwordx4 v5, s[12:15], s38 offen offset:128 lds
    v_mfma_f32_16x16x32_bf16 v[184:187], a[200:203], a[76:79], v[184:187]
    ds_read_b64_tr_b16 a[232:233], v8 offset:16384
    v_cvt_pk_bf16_f32 v143, v46, v47
    v_mfma_f32_16x16x32_bf16 v[184:187], a[196:199], a[60:63], v[184:187]
    ds_read_b64_tr_b16 a[234:235], v8 offset:18432
    v_accvgpr_write_b32 a113, v81
    v_mfma_f32_16x16x32_bf16 v[184:187], a[192:195], a[44:47], v[184:187]
    s_waitcnt lgkmcnt(2)
    ds_read_b64_tr_b16 a[236:237], v9 offset:16384
    v_accvgpr_write_b32 a114, v82
    v_mfma_f32_16x16x32_bf16 v[184:187], a[188:191], a[28:31], v[184:187]
    v_exp_f32 v48, v48
    v_mfma_f32_16x16x32_bf16 v[184:187], a[184:187], a[12:15], v[184:187]
    v_exp_f32 v49, v49
    v_mfma_f32_16x16x32_bf16 v[24:27], a[208:211], a[0:3], 0
    s_addk_i32 m0, 896
    ds_read_b64_tr_b16 a[238:239], v9 offset:18432
    v_cvt_pk_bf16_f32 v150, v48, v49
    v_mfma_f32_16x16x32_bf16 v[24:27], a[212:215], a[16:19], v[24:27]
    v_exp_f32 v50, v50
    v_mfma_f32_16x16x32_bf16 v[24:27], a[216:219], a[32:35], v[24:27]
    ds_read_b128 a[184:187], v12 offset:12288
    v_accvgpr_write_b32 a115, v83
    v_mfma_f32_16x16x32_bf16 v[24:27], a[220:223], a[48:51], v[24:27]
    v_exp_f32 v51, v51
    v_mfma_f32_16x16x32_bf16 v[24:27], a[224:227], a[64:67], v[24:27]
    ds_read_b128 a[188:191], v13 offset:12288
    v_cvt_pk_bf16_f32 v151, v50, v51
    v_mfma_f32_16x16x32_bf16 v[24:27], a[228:231], a[80:83], v[24:27]
    v_exp_f32 v52, v52
    v_mfma_f32_16x16x32_bf16 v[28:31], a[228:231], a[84:87], 0
    buffer_load_dwordx4 v5, s[12:15], s38 offen offset:256 lds
    v_mfma_f32_16x16x32_bf16 v[28:31], a[224:227], a[68:71], v[28:31]
    s_add_u32 s38, s38, 24576
    v_exp_f32 v53, v53
    v_mfma_f32_16x16x32_bf16 v[28:31], a[220:223], a[52:55], v[28:31]
    ds_read_b128 a[192:195], v12 offset:13312
    v_cvt_pk_bf16_f32 v158, v52, v53
    v_mfma_f32_16x16x32_bf16 v[28:31], a[216:219], a[36:39], v[28:31]
    ds_read_b128 a[196:199], v13 offset:13312
    v_accvgpr_write_b32 a116, v84
    v_mfma_f32_16x16x32_bf16 v[28:31], a[212:215], a[20:23], v[28:31]
    s_add_u32 s39, s40, 122880
    v_exp_f32 v54, v54
    v_mfma_f32_16x16x32_bf16 v[28:31], a[208:211], a[4:7], v[28:31]
    v_exp_f32 v55, v55
    v_mfma_f32_16x16x32_bf16 v[32:35], a[208:211], a[8:11], 0
    s_add_u32 m0, s63, 114688
    ds_read_b128 a[200:203], v12 offset:14336
    v_cvt_pk_bf16_f32 v159, v54, v55
    v_mfma_f32_16x16x32_bf16 v[32:35], a[212:215], a[24:27], v[32:35]
    v_exp_f32 v160, v160
    v_mfma_f32_16x16x32_bf16 v[32:35], a[216:219], a[40:43], v[32:35]
    v_exp_f32 v161, v161
    v_mfma_f32_16x16x32_bf16 v[32:35], a[220:223], a[56:59], v[32:35]
    ds_read_b128 a[204:207], v13 offset:14336
    v_cvt_pk_bf16_f32 v160, v160, v161
    v_mfma_f32_16x16x32_bf16 v[32:35], a[224:227], a[72:75], v[32:35]
    v_exp_f32 v162, v162
    v_mfma_f32_16x16x32_bf16 v[32:35], a[228:231], a[88:91], v[32:35]
    v_exp_f32 v163, v163
    v_mfma_f32_16x16x32_bf16 v[36:39], a[228:231], a[92:95], 0
    buffer_load_dwordx4 v6, s[16:19], s39 offen lds
    v_mfma_f32_16x16x32_bf16 v[36:39], a[224:227], a[76:79], v[36:39]
    v_exp_f32 v168, v168
    v_mfma_f32_16x16x32_bf16 v[36:39], a[220:223], a[60:63], v[36:39]
    v_exp_f32 v169, v169
    v_mfma_f32_16x16x32_bf16 v[36:39], a[216:219], a[44:47], v[36:39]
    s_waitcnt lgkmcnt(1)
    v_exp_f32 v170, v170
    v_mfma_f32_16x16x32_bf16 v[36:39], a[212:215], a[28:31], v[36:39]
    s_add_u32 s39, s40, 135168
    v_exp_f32 v171, v171
    v_mfma_f32_16x16x32_bf16 v[36:39], a[208:211], a[12:15], v[36:39]
    v_exp_f32 v176, v176
    v_mfma_f32_16x16x32_bf16 a[152:155], a[232:235], v[128:131], a[152:155]
    s_addk_i32 m0, 4096
    v_cvt_pk_bf16_f32 v161, v162, v163
    v_cvt_pk_bf16_f32 v168, v168, v169
    v_mfma_f32_16x16x32_bf16 a[168:171], a[236:239], v[128:131], a[168:171]
    v_exp_f32 v177, v177
    v_mfma_f32_16x16x32_bf16 a[172:175], a[236:239], v[136:139], a[172:175]
    ds_read_b128 a[208:211], v12 offset:18432
    v_cvt_pk_bf16_f32 v169, v170, v171
    v_mfma_f32_16x16x32_bf16 a[156:159], a[232:235], v[136:139], a[156:159]
    ds_read_b128 a[212:215], v13 offset:18432
    v_cvt_pk_bf16_f32 v176, v176, v177
    v_mfma_f32_16x16x32_bf16 a[160:163], a[232:235], v[144:147], a[160:163]
    ds_read_b128 a[216:219], v12 offset:19456
    v_accvgpr_write_b32 a117, v85
    v_mfma_f32_16x16x32_bf16 a[176:179], a[236:239], v[144:147], a[176:179]
    ds_read_b128 a[220:223], v13 offset:19456
    v_accvgpr_write_b32 a118, v86
    v_mfma_f32_16x16x32_bf16 a[180:183], a[236:239], v[152:155], a[180:183]
    buffer_load_dwordx4 v6, s[16:19], s39 offen lds
    v_mfma_f32_16x16x32_bf16 a[164:167], a[232:235], v[152:155], a[164:167]
    ds_read_b128 a[224:227], v12 offset:20480
    v_accvgpr_write_b32 a119, v87
    v_mfma_f32_16x16x32_bf16 v[164:167], a[184:187], a[0:3], 0
    v_exp_f32 v178, v178
    v_mfma_f32_16x16x32_bf16 v[164:167], a[188:191], a[16:19], v[164:167]
    v_exp_f32 v179, v179
    v_mfma_f32_16x16x32_bf16 v[164:167], a[192:195], a[32:35], v[164:167]
    s_waitcnt lgkmcnt(3)
    ds_read_b128 a[228:231], v13 offset:20480
    v_cvt_pk_bf16_f32 v177, v178, v179
    v_mfma_f32_16x16x32_bf16 v[164:167], a[196:199], a[48:51], v[164:167]
    v_exp_f32 v184, v184
    v_mfma_f32_16x16x32_bf16 v[164:167], a[200:203], a[64:67], v[164:167]
    v_exp_f32 v185, v185
    v_mfma_f32_16x16x32_bf16 v[164:167], a[204:207], a[80:83], v[164:167]
    v_exp_f32 v186, v186
    v_mfma_f32_16x16x32_bf16 v[172:175], a[204:207], a[84:87], 0
    v_exp_f32 v187, v187
    v_mfma_f32_16x16x32_bf16 v[172:175], a[200:203], a[68:71], v[172:175]
    v_exp_f32 v24, v24
    v_mfma_f32_16x16x32_bf16 v[172:175], a[196:199], a[52:55], v[172:175]
    v_exp_f32 v25, v25
    v_mfma_f32_16x16x32_bf16 v[172:175], a[192:195], a[36:39], v[172:175]
    v_exp_f32 v26, v26
    v_mfma_f32_16x16x32_bf16 v[172:175], a[188:191], a[20:23], v[172:175]
    v_exp_f32 v27, v27
    v_mfma_f32_16x16x32_bf16 v[172:175], a[184:187], a[4:7], v[172:175]
    v_cvt_pk_bf16_f32 v184, v184, v185
    v_cvt_pk_bf16_f32 v185, v186, v187
    v_mfma_f32_16x16x32_bf16 v[180:183], a[184:187], a[8:11], 0
    v_exp_f32 v28, v28
    v_mfma_f32_16x16x32_bf16 v[180:183], a[188:191], a[24:27], v[180:183]
    v_exp_f32 v29, v29
    v_mfma_f32_16x16x32_bf16 v[180:183], a[192:195], a[40:43], v[180:183]
    v_exp_f32 v30, v30
    v_mfma_f32_16x16x32_bf16 v[180:183], a[196:199], a[56:59], v[180:183]
    v_exp_f32 v31, v31
    v_mfma_f32_16x16x32_bf16 v[180:183], a[200:203], a[72:75], v[180:183]
    v_cvt_pk_bf16_f32 v162, v24, v25
    v_cvt_pk_bf16_f32 v163, v26, v27
    v_mfma_f32_16x16x32_bf16 v[180:183], a[204:207], a[88:91], v[180:183]
    v_exp_f32 v32, v32
    v_mfma_f32_16x16x32_bf16 v[188:191], a[204:207], a[92:95], 0
    v_exp_f32 v33, v33
    v_mfma_f32_16x16x32_bf16 v[188:191], a[200:203], a[76:79], v[188:191]
    v_exp_f32 v34, v34
    v_mfma_f32_16x16x32_bf16 v[188:191], a[196:199], a[60:63], v[188:191]
    s_add_u32 m0, s49, 0
    v_exp_f32 v35, v35
    v_mfma_f32_16x16x32_bf16 v[188:191], a[192:195], a[44:47], v[188:191]
    v_cvt_pk_bf16_f32 v170, v28, v29
    v_cvt_pk_bf16_f32 v171, v30, v31
    v_mfma_f32_16x16x32_bf16 v[188:191], a[188:191], a[28:31], v[188:191]
    v_exp_f32 v36, v36
    v_mfma_f32_16x16x32_bf16 v[188:191], a[184:187], a[12:15], v[188:191]
    s_waitcnt lgkmcnt(0)
    v_exp_f32 v37, v37
    v_mfma_f32_16x16x32_bf16 v[40:43], a[208:211], a[0:3], 0
    s_waitcnt vmcnt(11)
    v_exp_f32 v38, v38
    v_mfma_f32_16x16x32_bf16 v[40:43], a[212:215], a[16:19], v[40:43]
    s_barrier
    v_mfma_f32_16x16x32_bf16 v[40:43], a[216:219], a[32:35], v[40:43]
    buffer_load_dwordx4 v4, s[12:15], s38 offen offset:0 lds
    v_mfma_f32_16x16x32_bf16 v[40:43], a[220:223], a[48:51], v[40:43]
    ds_read_b64_tr_b16 a[240:241], v8 offset:20480
    v_cvt_pk_bf16_f32 v178, v32, v33
    v_mfma_f32_16x16x32_bf16 v[40:43], a[224:227], a[64:67], v[40:43]
    ds_read_b64_tr_b16 a[242:243], v8 offset:22528
    v_cvt_pk_bf16_f32 v179, v34, v35
    v_mfma_f32_16x16x32_bf16 v[40:43], a[228:231], a[80:83], v[40:43]
    ds_read_b64_tr_b16 a[244:245], v9 offset:20480
    v_cvt_pk_bf16_f32 v186, v36, v37
    v_mfma_f32_16x16x32_bf16 v[44:47], a[228:231], a[84:87], 0
    ds_read_b64_tr_b16 a[246:247], v9 offset:22528
    v_accvgpr_write_b32 a120, v88
    v_mfma_f32_16x16x32_bf16 v[44:47], a[224:227], a[68:71], v[44:47]
    ds_read_b128 a[184:187], v12 offset:24576
    v_accvgpr_write_b32 a121, v89
    v_mfma_f32_16x16x32_bf16 v[44:47], a[220:223], a[52:55], v[44:47]
    s_addk_i32 m0, 896
    ds_read_b128 a[188:191], v13 offset:24576
    v_accvgpr_write_b32 a122, v90
    v_mfma_f32_16x16x32_bf16 v[44:47], a[216:219], a[36:39], v[44:47]
    ds_read_b128 a[192:195], v12 offset:25600
    v_accvgpr_write_b32 a123, v91
    v_mfma_f32_16x16x32_bf16 v[44:47], a[212:215], a[20:23], v[44:47]
    v_exp_f32 v39, v39
    v_mfma_f32_16x16x32_bf16 v[44:47], a[208:211], a[4:7], v[44:47]
    ds_read_b128 a[196:199], v13 offset:25600
    v_cvt_pk_bf16_f32 v187, v38, v39
    v_mfma_f32_16x16x32_bf16 v[48:51], a[208:211], a[8:11], 0
    buffer_load_dword a252, v22, s[32:35], s42 offen offset:1536
    s_add_u32 s42, s42, 3072
    v_mfma_f32_16x16x32_bf16 v[48:51], a[212:215], a[24:27], v[48:51]
    v_exp_f32 v164, v164
    v_mfma_f32_16x16x32_bf16 v[48:51], a[216:219], a[40:43], v[48:51]
    buffer_load_dwordx4 v4, s[12:15], s38 offen offset:128 lds
    v_mfma_f32_16x16x32_bf16 v[48:51], a[220:223], a[56:59], v[48:51]
    ds_read_b128 a[200:203], v12 offset:26624
    v_accvgpr_write_b32 a124, v92
    v_mfma_f32_16x16x32_bf16 v[48:51], a[224:227], a[72:75], v[48:51]
    v_exp_f32 v165, v165
    v_mfma_f32_16x16x32_bf16 v[48:51], a[228:231], a[88:91], v[48:51]
    ds_read_b128 a[204:207], v13 offset:26624
    v_cvt_pk_bf16_f32 v164, v164, v165
    v_mfma_f32_16x16x32_bf16 v[52:55], a[228:231], a[92:95], 0
    v_exp_f32 v166, v166
    v_mfma_f32_16x16x32_bf16 v[52:55], a[224:227], a[76:79], v[52:55]
    v_exp_f32 v167, v167
    v_mfma_f32_16x16x32_bf16 v[52:55], a[220:223], a[60:63], v[52:55]
    s_addk_i32 m0, 896
    v_exp_f32 v172, v172
    v_mfma_f32_16x16x32_bf16 v[52:55], a[216:219], a[44:47], v[52:55]
    s_waitcnt lgkmcnt(2)
    v_exp_f32 v173, v173
    v_mfma_f32_16x16x32_bf16 v[52:55], a[212:215], a[28:31], v[52:55]
    v_exp_f32 v174, v174
    v_mfma_f32_16x16x32_bf16 v[52:55], a[208:211], a[12:15], v[52:55]
    v_exp_f32 v175, v175
    v_mfma_f32_16x16x32_bf16 a[164:167], a[240:243], v[156:159], a[164:167]
    v_exp_f32 v180, v180
    v_mfma_f32_16x16x32_bf16 a[180:183], a[244:247], v[156:159], a[180:183]
    v_exp_f32 v181, v181
    v_mfma_f32_16x16x32_bf16 a[176:179], a[244:247], v[148:151], a[176:179]
    buffer_load_dwordx4 v4, s[12:15], s38 offen offset:256 lds
    v_mfma_f32_16x16x32_bf16 a[160:163], a[240:243], v[148:151], a[160:163]
    ds_read_b128 a[208:211], v12 offset:30720
    v_cvt_pk_bf16_f32 v165, v166, v167
    v_mfma_f32_16x16x32_bf16 a[156:159], a[240:243], v[140:143], a[156:159]
    ds_read_b128 a[212:215], v13 offset:30720
    v_cvt_pk_bf16_f32 v172, v172, v173
    v_mfma_f32_16x16x32_bf16 a[172:175], a[244:247], v[140:143], a[172:175]
    ds_read_b128 a[216:219], v12 offset:31744
    v_cvt_pk_bf16_f32 v173, v174, v175
    v_mfma_f32_16x16x32_bf16 a[168:171], a[244:247], v[132:135], a[168:171]
    ds_read_b128 a[220:223], v13 offset:31744
    v_cvt_pk_bf16_f32 v180, v180, v181
    v_mfma_f32_16x16x32_bf16 a[152:155], a[240:243], v[132:135], a[152:155]
    ds_read_b128 a[224:227], v12 offset:32768
    v_accvgpr_write_b32 a125, v93
    v_mfma_f32_16x16x32_bf16 v[192:195], a[184:187], a[0:3], 0
    s_addk_i32 m0, 1280
    ds_read_b128 a[228:231], v13 offset:32768
    v_accvgpr_write_b32 a126, v94
    v_mfma_f32_16x16x32_bf16 v[192:195], a[188:191], a[16:19], v[192:195]
    s_waitcnt lgkmcnt(6)
    v_exp_f32 v182, v182
    v_mfma_f32_16x16x32_bf16 v[192:195], a[192:195], a[32:35], v[192:195]
    v_exp_f32 v183, v183
    v_mfma_f32_16x16x32_bf16 v[192:195], a[196:199], a[48:51], v[192:195]
    v_exp_f32 v188, v188
    v_mfma_f32_16x16x32_bf16 v[192:195], a[200:203], a[64:67], v[192:195]
    v_exp_f32 v189, v189
    v_mfma_f32_16x16x32_bf16 v[192:195], a[204:207], a[80:83], v[192:195]
    v_exp_f32 v190, v190
    v_mfma_f32_16x16x32_bf16 v[200:203], a[204:207], a[84:87], 0
    buffer_load_dwordx4 v5, s[12:15], s38 offen offset:0 lds
    v_mfma_f32_16x16x32_bf16 v[200:203], a[200:203], a[68:71], v[200:203]
    v_exp_f32 v191, v191
    v_mfma_f32_16x16x32_bf16 v[200:203], a[196:199], a[52:55], v[200:203]
    v_exp_f32 v40, v40
    v_mfma_f32_16x16x32_bf16 v[200:203], a[192:195], a[36:39], v[200:203]
    v_exp_f32 v41, v41
    v_mfma_f32_16x16x32_bf16 v[200:203], a[188:191], a[20:23], v[200:203]
    v_cvt_pk_bf16_f32 v181, v182, v183
    v_cvt_pk_bf16_f32 v188, v188, v189
    v_mfma_f32_16x16x32_bf16 v[200:203], a[184:187], a[4:7], v[200:203]
    v_exp_f32 v42, v42
    v_mfma_f32_16x16x32_bf16 v[208:211], a[184:187], a[8:11], 0
    s_addk_i32 m0, 896
    v_exp_f32 v43, v43
    v_mfma_f32_16x16x32_bf16 v[208:211], a[188:191], a[24:27], v[208:211]
    v_cvt_pk_bf16_f32 v189, v190, v191
    v_cvt_pk_bf16_f32 v166, v40, v41
    v_mfma_f32_16x16x32_bf16 v[208:211], a[192:195], a[40:43], v[208:211]
    v_exp_f32 v44, v44
    v_mfma_f32_16x16x32_bf16 v[208:211], a[196:199], a[56:59], v[208:211]
    v_exp_f32 v45, v45
    v_mfma_f32_16x16x32_bf16 v[208:211], a[200:203], a[72:75], v[208:211]
    v_exp_f32 v46, v46
    v_mfma_f32_16x16x32_bf16 v[208:211], a[204:207], a[88:91], v[208:211]
    v_exp_f32 v47, v47
    v_mfma_f32_16x16x32_bf16 v[216:219], a[204:207], a[92:95], 0
    buffer_load_dwordx4 v5, s[12:15], s38 offen offset:128 lds
    v_mfma_f32_16x16x32_bf16 v[216:219], a[200:203], a[76:79], v[216:219]
    ds_read_b64_tr_b16 a[232:233], v8 offset:24576
    v_cvt_pk_bf16_f32 v167, v42, v43
    v_mfma_f32_16x16x32_bf16 v[216:219], a[196:199], a[60:63], v[216:219]
    ds_read_b64_tr_b16 a[234:235], v8 offset:26624
    v_cvt_pk_bf16_f32 v174, v44, v45
    v_mfma_f32_16x16x32_bf16 v[216:219], a[192:195], a[44:47], v[216:219]
    s_waitcnt lgkmcnt(2)
    ds_read_b64_tr_b16 a[236:237], v9 offset:24576
    v_cvt_pk_bf16_f32 v175, v46, v47
    v_mfma_f32_16x16x32_bf16 v[216:219], a[188:191], a[28:31], v[216:219]
    ds_read_b64_tr_b16 a[238:239], v9 offset:26624
    v_accvgpr_write_b32 a127, v95
    v_mfma_f32_16x16x32_bf16 v[216:219], a[184:187], a[12:15], v[216:219]
    v_exp_f32 v48, v48
    v_mfma_f32_16x16x32_bf16 v[24:27], a[208:211], a[0:3], 0
    s_addk_i32 m0, 896
    v_exp_f32 v49, v49
    v_mfma_f32_16x16x32_bf16 v[24:27], a[212:215], a[16:19], v[24:27]
    v_exp_f32 v50, v50
    v_mfma_f32_16x16x32_bf16 v[24:27], a[216:219], a[32:35], v[24:27]
    ds_read_b128 a[184:187], v12 offset:36864
    v_cvt_pk_bf16_f32 v182, v48, v49
    v_mfma_f32_16x16x32_bf16 v[24:27], a[220:223], a[48:51], v[24:27]
    ds_read_b128 a[188:191], v13 offset:36864
    v_accvgpr_write_b32 a128, v96
    v_mfma_f32_16x16x32_bf16 v[24:27], a[224:227], a[64:67], v[24:27]
    ds_read_b128 a[192:195], v12 offset:37888
    v_accvgpr_write_b32 a129, v97
    v_mfma_f32_16x16x32_bf16 v[24:27], a[228:231], a[80:83], v[24:27]
    ds_read_b128 a[196:199], v13 offset:37888
    v_accvgpr_write_b32 a130, v98
    v_mfma_f32_16x16x32_bf16 v[28:31], a[228:231], a[84:87], 0
    buffer_load_dwordx4 v5, s[12:15], s38 offen offset:256 lds
    v_mfma_f32_16x16x32_bf16 v[28:31], a[224:227], a[68:71], v[28:31]
    s_add_u32 s38, s38, 24576
    v_exp_f32 v51, v51
    v_mfma_f32_16x16x32_bf16 v[28:31], a[220:223], a[52:55], v[28:31]
    ds_read_b128 a[200:203], v12 offset:38912
    v_cvt_pk_bf16_f32 v183, v50, v51
    v_mfma_f32_16x16x32_bf16 v[28:31], a[216:219], a[36:39], v[28:31]
    v_exp_f32 v52, v52
    v_mfma_f32_16x16x32_bf16 v[28:31], a[212:215], a[20:23], v[28:31]
    s_add_u32 s39, s40, 147456
    v_exp_f32 v53, v53
    v_mfma_f32_16x16x32_bf16 v[28:31], a[208:211], a[4:7], v[28:31]
    ds_read_b128 a[204:207], v13 offset:38912
    v_cvt_pk_bf16_f32 v190, v52, v53
    v_mfma_f32_16x16x32_bf16 v[32:35], a[208:211], a[8:11], 0
    s_add_u32 m0, s63, 122880
    v_exp_f32 v54, v54
    v_mfma_f32_16x16x32_bf16 v[32:35], a[212:215], a[24:27], v[32:35]
    v_exp_f32 v55, v55
    v_mfma_f32_16x16x32_bf16 v[32:35], a[216:219], a[40:43], v[32:35]
    v_exp_f32 v192, v192
    v_mfma_f32_16x16x32_bf16 v[32:35], a[220:223], a[56:59], v[32:35]
    v_exp_f32 v193, v193
    v_mfma_f32_16x16x32_bf16 v[32:35], a[224:227], a[72:75], v[32:35]
    v_exp_f32 v194, v194
    v_mfma_f32_16x16x32_bf16 v[32:35], a[228:231], a[88:91], v[32:35]
    v_exp_f32 v195, v195
    v_mfma_f32_16x16x32_bf16 v[36:39], a[228:231], a[92:95], 0
    buffer_load_dwordx4 v6, s[16:19], s39 offen lds
    v_mfma_f32_16x16x32_bf16 v[36:39], a[224:227], a[76:79], v[36:39]
    v_exp_f32 v200, v200
    v_mfma_f32_16x16x32_bf16 v[36:39], a[220:223], a[60:63], v[36:39]
    v_exp_f32 v201, v201
    v_mfma_f32_16x16x32_bf16 v[36:39], a[216:219], a[44:47], v[36:39]
    s_waitcnt lgkmcnt(0)
    v_cvt_pk_bf16_f32 v191, v54, v55
    v_cvt_pk_bf16_f32 v192, v192, v193
    v_mfma_f32_16x16x32_bf16 v[36:39], a[212:215], a[28:31], v[36:39]
    s_add_u32 s39, s40, 159744
    v_exp_f32 v202, v202
    v_mfma_f32_16x16x32_bf16 v[36:39], a[208:211], a[12:15], v[36:39]
    v_exp_f32 v203, v203
    v_mfma_f32_16x16x32_bf16 a[152:155], a[232:235], v[160:163], a[152:155]
    s_addk_i32 m0, 4096
    v_cvt_pk_bf16_f32 v193, v194, v195
    v_cvt_pk_bf16_f32 v200, v200, v201
    v_mfma_f32_16x16x32_bf16 a[168:171], a[236:239], v[160:163], a[168:171]
    v_exp_f32 v208, v208
    v_mfma_f32_16x16x32_bf16 a[172:175], a[236:239], v[168:171], a[172:175]
    ds_read_b128 a[208:211], v12 offset:43008
    v_cvt_pk_bf16_f32 v201, v202, v203
    v_mfma_f32_16x16x32_bf16 a[156:159], a[232:235], v[168:171], a[156:159]
    ds_read_b128 a[212:215], v13 offset:43008
    v_accvgpr_write_b32 a131, v99
    v_mfma_f32_16x16x32_bf16 a[160:163], a[232:235], v[176:179], a[160:163]
    ds_read_b128 a[216:219], v12 offset:44032
    v_accvgpr_write_b32 a132, v100
    v_mfma_f32_16x16x32_bf16 a[176:179], a[236:239], v[176:179], a[176:179]
    ds_read_b128 a[220:223], v13 offset:44032
    v_accvgpr_write_b32 a133, v101
    v_mfma_f32_16x16x32_bf16 a[180:183], a[236:239], v[184:187], a[180:183]
    buffer_load_dwordx4 v6, s[16:19], s39 offen lds
    v_mfma_f32_16x16x32_bf16 a[164:167], a[232:235], v[184:187], a[164:167]
    v_exp_f32 v209, v209
    v_mfma_f32_16x16x32_bf16 v[196:199], a[184:187], a[0:3], 0
    ds_read_b128 a[224:227], v12 offset:45056
    v_cvt_pk_bf16_f32 v208, v208, v209
    v_mfma_f32_16x16x32_bf16 v[196:199], a[188:191], a[16:19], v[196:199]
    v_exp_f32 v210, v210
    v_mfma_f32_16x16x32_bf16 v[196:199], a[192:195], a[32:35], v[196:199]
    v_exp_f32 v211, v211
    v_mfma_f32_16x16x32_bf16 v[196:199], a[196:199], a[48:51], v[196:199]
    ds_read_b128 a[228:231], v13 offset:45056
    v_cvt_pk_bf16_f32 v209, v210, v211
    v_mfma_f32_16x16x32_bf16 v[196:199], a[200:203], a[64:67], v[196:199]
    v_exp_f32 v216, v216
    v_mfma_f32_16x16x32_bf16 v[196:199], a[204:207], a[80:83], v[196:199]
    v_exp_f32 v217, v217
    v_mfma_f32_16x16x32_bf16 v[204:207], a[204:207], a[84:87], 0
    v_exp_f32 v218, v218
    v_mfma_f32_16x16x32_bf16 v[204:207], a[200:203], a[68:71], v[204:207]
    v_exp_f32 v219, v219
    v_mfma_f32_16x16x32_bf16 v[204:207], a[196:199], a[52:55], v[204:207]
    v_exp_f32 v24, v24
    v_mfma_f32_16x16x32_bf16 v[204:207], a[192:195], a[36:39], v[204:207]
    v_exp_f32 v25, v25
    v_mfma_f32_16x16x32_bf16 v[204:207], a[188:191], a[20:23], v[204:207]
    v_exp_f32 v26, v26
    v_mfma_f32_16x16x32_bf16 v[204:207], a[184:187], a[4:7], v[204:207]
    v_exp_f32 v27, v27
    v_mfma_f32_16x16x32_bf16 v[212:215], a[184:187], a[8:11], 0
    v_cvt_pk_bf16_f32 v216, v216, v217
    v_cvt_pk_bf16_f32 v217, v218, v219
    v_mfma_f32_16x16x32_bf16 v[212:215], a[188:191], a[24:27], v[212:215]
    v_exp_f32 v28, v28
    v_mfma_f32_16x16x32_bf16 v[212:215], a[192:195], a[40:43], v[212:215]
    v_exp_f32 v29, v29
    v_mfma_f32_16x16x32_bf16 v[212:215], a[196:199], a[56:59], v[212:215]
    v_exp_f32 v30, v30
    v_mfma_f32_16x16x32_bf16 v[212:215], a[200:203], a[72:75], v[212:215]
    v_exp_f32 v31, v31
    v_mfma_f32_16x16x32_bf16 v[212:215], a[204:207], a[88:91], v[212:215]
    v_cvt_pk_bf16_f32 v194, v24, v25
    v_cvt_pk_bf16_f32 v195, v26, v27
    v_mfma_f32_16x16x32_bf16 v[220:223], a[204:207], a[92:95], 0
    v_exp_f32 v32, v32
    v_mfma_f32_16x16x32_bf16 v[220:223], a[200:203], a[76:79], v[220:223]
    v_exp_f32 v33, v33
    v_mfma_f32_16x16x32_bf16 v[220:223], a[196:199], a[60:63], v[220:223]
    s_add_u32 m0, s49, 24576
    v_exp_f32 v34, v34
    v_mfma_f32_16x16x32_bf16 v[220:223], a[192:195], a[44:47], v[220:223]
    s_waitcnt lgkmcnt(0)
    v_exp_f32 v35, v35
    v_mfma_f32_16x16x32_bf16 v[220:223], a[188:191], a[28:31], v[220:223]
    v_cvt_pk_bf16_f32 v202, v28, v29
    v_cvt_pk_bf16_f32 v203, v30, v31
    v_mfma_f32_16x16x32_bf16 v[220:223], a[184:187], a[12:15], v[220:223]
    v_exp_f32 v36, v36
    v_mfma_f32_16x16x32_bf16 v[40:43], a[208:211], a[0:3], 0
    s_waitcnt vmcnt(11)
    v_exp_f32 v37, v37
    v_mfma_f32_16x16x32_bf16 v[40:43], a[212:215], a[16:19], v[40:43]
    s_barrier
    v_mfma_f32_16x16x32_bf16 v[40:43], a[216:219], a[32:35], v[40:43]
    buffer_load_dwordx4 v4, s[12:15], s38 offen offset:0 lds
    v_mfma_f32_16x16x32_bf16 v[40:43], a[220:223], a[48:51], v[40:43]
    ds_read_b64_tr_b16 a[240:241], v8 offset:28672
    v_cvt_pk_bf16_f32 v210, v32, v33
    v_mfma_f32_16x16x32_bf16 v[40:43], a[224:227], a[64:67], v[40:43]
    ds_read_b64_tr_b16 a[242:243], v8 offset:30720
    v_cvt_pk_bf16_f32 v211, v34, v35
    v_mfma_f32_16x16x32_bf16 v[40:43], a[228:231], a[80:83], v[40:43]
    ds_read_b64_tr_b16 a[244:245], v9 offset:28672
    v_cvt_pk_bf16_f32 v218, v36, v37
    v_mfma_f32_16x16x32_bf16 v[44:47], a[228:231], a[84:87], 0
    ds_read_b64_tr_b16 a[246:247], v9 offset:30720
    v_accvgpr_write_b32 a134, v102
    v_mfma_f32_16x16x32_bf16 v[44:47], a[224:227], a[68:71], v[44:47]
    ds_read_b128 a[184:187], v12 offset:49152
    v_accvgpr_write_b32 a135, v103
    v_mfma_f32_16x16x32_bf16 v[44:47], a[220:223], a[52:55], v[44:47]
    s_addk_i32 m0, 896
    ds_read_b128 a[188:191], v13 offset:49152
    v_accvgpr_write_b32 a136, v104
    v_mfma_f32_16x16x32_bf16 v[44:47], a[216:219], a[36:39], v[44:47]
    ds_read_b128 a[192:195], v12 offset:50176
    v_accvgpr_write_b32 a137, v105
    v_mfma_f32_16x16x32_bf16 v[44:47], a[212:215], a[20:23], v[44:47]
    v_exp_f32 v38, v38
    v_mfma_f32_16x16x32_bf16 v[44:47], a[208:211], a[4:7], v[44:47]
    v_exp_f32 v39, v39
    v_mfma_f32_16x16x32_bf16 v[48:51], a[208:211], a[8:11], 0
    buffer_load_dword a252, v22, s[32:35], s42 offen offset:0
    v_mfma_f32_16x16x32_bf16 v[48:51], a[212:215], a[24:27], v[48:51]
    ds_read_b128 a[196:199], v13 offset:50176
    v_cvt_pk_bf16_f32 v219, v38, v39
    v_mfma_f32_16x16x32_bf16 v[48:51], a[216:219], a[40:43], v[48:51]
    buffer_load_dwordx4 v4, s[12:15], s38 offen offset:128 lds
    v_mfma_f32_16x16x32_bf16 v[48:51], a[220:223], a[56:59], v[48:51]
    ds_read_b128 a[200:203], v12 offset:51200
    v_accvgpr_write_b32 a138, v106
    v_mfma_f32_16x16x32_bf16 v[48:51], a[224:227], a[72:75], v[48:51]
    v_exp_f32 v196, v196
    v_mfma_f32_16x16x32_bf16 v[48:51], a[228:231], a[88:91], v[48:51]
    v_exp_f32 v197, v197
    v_mfma_f32_16x16x32_bf16 v[52:55], a[228:231], a[92:95], 0
    ds_read_b128 a[204:207], v13 offset:51200
    v_cvt_pk_bf16_f32 v196, v196, v197
    v_mfma_f32_16x16x32_bf16 v[52:55], a[224:227], a[76:79], v[52:55]
    v_exp_f32 v198, v198
    v_mfma_f32_16x16x32_bf16 v[52:55], a[220:223], a[60:63], v[52:55]
    s_addk_i32 m0, 896
    v_exp_f32 v199, v199
    v_mfma_f32_16x16x32_bf16 v[52:55], a[216:219], a[44:47], v[52:55]
    s_waitcnt lgkmcnt(2)
    v_exp_f32 v204, v204
    v_mfma_f32_16x16x32_bf16 v[52:55], a[212:215], a[28:31], v[52:55]
    v_exp_f32 v205, v205
    v_mfma_f32_16x16x32_bf16 v[52:55], a[208:211], a[12:15], v[52:55]
    v_exp_f32 v206, v206
    v_mfma_f32_16x16x32_bf16 a[164:167], a[240:243], v[188:191], a[164:167]
    v_exp_f32 v207, v207
    v_mfma_f32_16x16x32_bf16 a[180:183], a[244:247], v[188:191], a[180:183]
    v_exp_f32 v212, v212
    v_mfma_f32_16x16x32_bf16 a[176:179], a[244:247], v[180:183], a[176:179]
    buffer_load_dwordx4 v4, s[12:15], s38 offen offset:256 lds
    v_mfma_f32_16x16x32_bf16 a[160:163], a[240:243], v[180:183], a[160:163]
    ds_read_b128 a[208:211], v12 offset:55296
    v_cvt_pk_bf16_f32 v197, v198, v199
    v_mfma_f32_16x16x32_bf16 a[156:159], a[240:243], v[172:175], a[156:159]
    ds_read_b128 a[212:215], v13 offset:55296
    v_cvt_pk_bf16_f32 v204, v204, v205
    v_mfma_f32_16x16x32_bf16 a[172:175], a[244:247], v[172:175], a[172:175]
    ds_read_b128 a[216:219], v12 offset:56320
    v_cvt_pk_bf16_f32 v205, v206, v207
    v_mfma_f32_16x16x32_bf16 a[168:171], a[244:247], v[164:167], a[168:171]
    ds_read_b128 a[220:223], v13 offset:56320
    v_accvgpr_write_b32 a139, v107
    v_mfma_f32_16x16x32_bf16 a[152:155], a[240:243], v[164:167], a[152:155]
pg_7:
    s_cbranch_execz pg_11
    ds_read_b128 a[224:227], v12 offset:57344
    v_accvgpr_write_b32 a140, v108
    v_mfma_f32_16x16x32_bf16 v[224:227], a[184:187], a[0:3], 0
    s_addk_i32 m0, 1280
    v_exp_f32 v213, v213
    v_mfma_f32_16x16x32_bf16 v[224:227], a[188:191], a[16:19], v[224:227]
    s_waitcnt lgkmcnt(5)
    ds_read_b128 a[228:231], v13 offset:57344
    v_cvt_pk_bf16_f32 v212, v212, v213
    v_mfma_f32_16x16x32_bf16 v[224:227], a[192:195], a[32:35], v[224:227]
    v_exp_f32 v214, v214
    v_mfma_f32_16x16x32_bf16 v[224:227], a[196:199], a[48:51], v[224:227]
    v_exp_f32 v215, v215
    v_mfma_f32_16x16x32_bf16 v[224:227], a[200:203], a[64:67], v[224:227]
    v_exp_f32 v220, v220
    v_mfma_f32_16x16x32_bf16 v[224:227], a[204:207], a[80:83], v[224:227]
    v_exp_f32 v221, v221
    v_mfma_f32_16x16x32_bf16 v[232:235], a[204:207], a[84:87], 0
    buffer_load_dwordx4 v5, s[12:15], s38 offen offset:0 lds
    v_mfma_f32_16x16x32_bf16 v[232:235], a[200:203], a[68:71], v[232:235]
    v_exp_f32 v222, v222
    v_mfma_f32_16x16x32_bf16 v[232:235], a[196:199], a[52:55], v[232:235]
    v_exp_f32 v223, v223
    v_mfma_f32_16x16x32_bf16 v[232:235], a[192:195], a[36:39], v[232:235]
    v_exp_f32 v40, v40
    v_mfma_f32_16x16x32_bf16 v[232:235], a[188:191], a[20:23], v[232:235]
    v_exp_f32 v41, v41
    v_mfma_f32_16x16x32_bf16 v[232:235], a[184:187], a[4:7], v[232:235]
    v_cvt_pk_bf16_f32 v213, v214, v215
    v_cvt_pk_bf16_f32 v220, v220, v221
    v_mfma_f32_16x16x32_bf16 v[240:243], a[184:187], a[8:11], 0
    s_addk_i32 m0, 896
    v_exp_f32 v42, v42
    v_mfma_f32_16x16x32_bf16 v[240:243], a[188:191], a[24:27], v[240:243]
    v_exp_f32 v43, v43
    v_mfma_f32_16x16x32_bf16 v[240:243], a[192:195], a[40:43], v[240:243]
    v_cvt_pk_bf16_f32 v221, v222, v223
    v_cvt_pk_bf16_f32 v198, v40, v41
    v_mfma_f32_16x16x32_bf16 v[240:243], a[196:199], a[56:59], v[240:243]
    v_exp_f32 v44, v44
    v_mfma_f32_16x16x32_bf16 v[240:243], a[200:203], a[72:75], v[240:243]
    v_exp_f32 v45, v45
    v_mfma_f32_16x16x32_bf16 v[240:243], a[204:207], a[88:91], v[240:243]
    v_exp_f32 v46, v46
    v_mfma_f32_16x16x32_bf16 v[248:251], a[204:207], a[92:95], 0
    buffer_load_dwordx4 v5, s[12:15], s38 offen offset:128 lds
    v_mfma_f32_16x16x32_bf16 v[248:251], a[200:203], a[76:79], v[248:251]
    ds_read_b64_tr_b16 a[232:233], v8 offset:32768
    v_cvt_pk_bf16_f32 v199, v42, v43
    v_mfma_f32_16x16x32_bf16 v[248:251], a[196:199], a[60:63], v[248:251]
    ds_read_b64_tr_b16 a[234:235], v8 offset:34816
    v_cvt_pk_bf16_f32 v206, v44, v45
    v_mfma_f32_16x16x32_bf16 v[248:251], a[192:195], a[44:47], v[248:251]
    s_waitcnt lgkmcnt(2)
    ds_read_b64_tr_b16 a[236:237], v9 offset:32768
    v_accvgpr_write_b32 a141, v109
    v_mfma_f32_16x16x32_bf16 v[248:251], a[188:191], a[28:31], v[248:251]
    ds_read_b64_tr_b16 a[238:239], v9 offset:34816
    v_accvgpr_write_b32 a142, v110
    v_mfma_f32_16x16x32_bf16 v[248:251], a[184:187], a[12:15], v[248:251]
    v_exp_f32 v47, v47
    v_mfma_f32_16x16x32_bf16 v[24:27], a[208:211], a[0:3], 0
    s_addk_i32 m0, 896
    v_exp_f32 v48, v48
    v_mfma_f32_16x16x32_bf16 v[24:27], a[212:215], a[16:19], v[24:27]
    v_exp_f32 v49, v49
    v_mfma_f32_16x16x32_bf16 v[24:27], a[216:219], a[32:35], v[24:27]
    ds_read_b128 a[184:187], v12 offset:61440
    v_cvt_pk_bf16_f32 v207, v46, v47
    v_mfma_f32_16x16x32_bf16 v[24:27], a[220:223], a[48:51], v[24:27]
    ds_read_b128 a[188:191], v13 offset:61440
    v_cvt_pk_bf16_f32 v214, v48, v49
    v_mfma_f32_16x16x32_bf16 v[24:27], a[224:227], a[64:67], v[24:27]
    ds_read_b128 a[192:195], v12 offset:62464
    v_accvgpr_write_b32 a143, v111
    v_mfma_f32_16x16x32_bf16 v[24:27], a[228:231], a[80:83], v[24:27]
    ds_read_b128 a[196:199], v13 offset:62464
    v_accvgpr_write_b32 a144, v112
    v_mfma_f32_16x16x32_bf16 v[28:31], a[228:231], a[84:87], 0
    buffer_load_dwordx4 v5, s[12:15], s38 offen offset:256 lds
    v_mfma_f32_16x16x32_bf16 v[28:31], a[224:227], a[68:71], v[28:31]
    s_add_u32 s38, s38, 24576
    v_exp_f32 v50, v50
    v_mfma_f32_16x16x32_bf16 v[28:31], a[220:223], a[52:55], v[28:31]
    v_exp_f32 v51, v51
    v_mfma_f32_16x16x32_bf16 v[28:31], a[216:219], a[36:39], v[28:31]
    ds_read_b128 a[200:203], v12 offset:63488
    v_cvt_pk_bf16_f32 v215, v50, v51
    v_mfma_f32_16x16x32_bf16 v[28:31], a[212:215], a[20:23], v[28:31]
    s_add_u32 s39, s40, 172032
    ds_read_b128 a[204:207], v13 offset:63488
    v_add_u32 v12, 67584, v12
    v_mfma_f32_16x16x32_bf16 v[28:31], a[208:211], a[4:7], v[28:31]
    v_exp_f32 v52, v52
    v_mfma_f32_16x16x32_bf16 v[32:35], a[208:211], a[8:11], 0
    s_add_u32 m0, s63, 131072
    v_exp_f32 v53, v53
    v_mfma_f32_16x16x32_bf16 v[32:35], a[212:215], a[24:27], v[32:35]
    v_exp_f32 v54, v54
    v_mfma_f32_16x16x32_bf16 v[32:35], a[216:219], a[40:43], v[32:35]
    v_exp_f32 v55, v55
    v_mfma_f32_16x16x32_bf16 v[32:35], a[220:223], a[56:59], v[32:35]
    v_cvt_pk_bf16_f32 v222, v52, v53
    v_cvt_pk_bf16_f32 v223, v54, v55
    v_mfma_f32_16x16x32_bf16 v[32:35], a[224:227], a[72:75], v[32:35]
    v_exp_f32 v224, v224
    v_mfma_f32_16x16x32_bf16 v[32:35], a[228:231], a[88:91], v[32:35]
    v_exp_f32 v225, v225
    v_mfma_f32_16x16x32_bf16 v[36:39], a[228:231], a[92:95], 0
    buffer_load_dwordx4 v6, s[16:19], s39 offen lds
    v_mfma_f32_16x16x32_bf16 v[36:39], a[224:227], a[76:79], v[36:39]
    v_exp_f32 v226, v226
    v_mfma_f32_16x16x32_bf16 v[36:39], a[220:223], a[60:63], v[36:39]
    v_exp_f32 v227, v227
    v_mfma_f32_16x16x32_bf16 v[36:39], a[216:219], a[44:47], v[36:39]
    s_waitcnt lgkmcnt(0)
    v_exp_f32 v232, v232
    v_mfma_f32_16x16x32_bf16 v[36:39], a[212:215], a[28:31], v[36:39]
    s_add_u32 s39, s40, 184320
    v_exp_f32 v233, v233
    v_mfma_f32_16x16x32_bf16 v[36:39], a[208:211], a[12:15], v[36:39]
    v_exp_f32 v234, v234
    v_mfma_f32_16x16x32_bf16 a[152:155], a[232:235], v[192:195], a[152:155]
    s_addk_i32 m0, 4096
    v_exp_f32 v235, v235
    v_mfma_f32_16x16x32_bf16 a[168:171], a[236:239], v[192:195], a[168:171]
    v_cvt_pk_bf16_f32 v224, v224, v225
    v_cvt_pk_bf16_f32 v225, v226, v227
    v_mfma_f32_16x16x32_bf16 a[172:175], a[236:239], v[200:203], a[172:175]
    ds_read_b128 a[208:211], v12 offset:0
    v_cvt_pk_bf16_f32 v232, v232, v233
    v_mfma_f32_16x16x32_bf16 a[156:159], a[232:235], v[200:203], a[156:159]
    v_exp_f32 v240, v240
    v_mfma_f32_16x16x32_bf16 a[160:163], a[232:235], v[208:211], a[160:163]
    v_exp_f32 v241, v241
    v_mfma_f32_16x16x32_bf16 a[176:179], a[236:239], v[208:211], a[176:179]
    v_exp_f32 v242, v242
    v_mfma_f32_16x16x32_bf16 a[180:183], a[236:239], v[216:219], a[180:183]
    buffer_load_dwordx4 v6, s[16:19], s39 offen lds
    v_mfma_f32_16x16x32_bf16 a[164:167], a[232:235], v[216:219], a[164:167]
    v_exp_f32 v243, v243
    v_mfma_f32_16x16x32_bf16 v[228:231], a[184:187], a[0:3], 0
    v_cvt_pk_bf16_f32 v233, v234, v235
    v_cvt_pk_bf16_f32 v240, v240, v241
    v_mfma_f32_16x16x32_bf16 v[228:231], a[188:191], a[16:19], v[228:231]
    v_exp_f32 v248, v248
    v_mfma_f32_16x16x32_bf16 v[228:231], a[192:195], a[32:35], v[228:231]
    v_exp_f32 v249, v249
    v_mfma_f32_16x16x32_bf16 v[228:231], a[196:199], a[48:51], v[228:231]
    v_exp_f32 v250, v250
    v_mfma_f32_16x16x32_bf16 v[228:231], a[200:203], a[64:67], v[228:231]
    v_exp_f32 v251, v251
    v_mfma_f32_16x16x32_bf16 v[228:231], a[204:207], a[80:83], v[228:231]
    v_cvt_pk_bf16_f32 v241, v242, v243
    v_cvt_pk_bf16_f32 v248, v248, v249
    v_mfma_f32_16x16x32_bf16 v[236:239], a[204:207], a[84:87], 0
    v_exp_f32 v24, v24
    v_mfma_f32_16x16x32_bf16 v[236:239], a[200:203], a[68:71], v[236:239]
    v_exp_f32 v25, v25
    v_mfma_f32_16x16x32_bf16 v[236:239], a[196:199], a[52:55], v[236:239]
    v_exp_f32 v26, v26
    v_mfma_f32_16x16x32_bf16 v[236:239], a[192:195], a[36:39], v[236:239]
    v_exp_f32 v27, v27
    v_mfma_f32_16x16x32_bf16 v[236:239], a[188:191], a[20:23], v[236:239]
    v_cvt_pk_bf16_f32 v249, v250, v251
    v_cvt_pk_bf16_f32 v226, v24, v25
    v_mfma_f32_16x16x32_bf16 v[236:239], a[184:187], a[4:7], v[236:239]
    v_exp_f32 v28, v28
    v_mfma_f32_16x16x32_bf16 v[244:247], a[184:187], a[8:11], 0
    v_exp_f32 v29, v29
    v_mfma_f32_16x16x32_bf16 v[244:247], a[188:191], a[24:27], v[244:247]
    v_exp_f32 v30, v30
    v_add_u32 v13, 67584, v13
    v_mfma_f32_16x16x32_bf16 v[244:247], a[192:195], a[40:43], v[244:247]
    ds_read_b128 a[212:215], v13 offset:0
    v_cvt_pk_bf16_f32 v227, v26, v27
    v_mfma_f32_16x16x32_bf16 v[244:247], a[196:199], a[56:59], v[244:247]
    ds_read_b128 a[216:219], v12 offset:1024
    v_cvt_pk_bf16_f32 v234, v28, v29
    v_mfma_f32_16x16x32_bf16 v[244:247], a[200:203], a[72:75], v[244:247]
    ds_read_b128 a[220:223], v13 offset:1024
    v_accvgpr_write_b32 a145, v113
    v_mfma_f32_16x16x32_bf16 v[244:247], a[204:207], a[88:91], v[244:247]
    ds_read_b128 a[224:227], v12 offset:2048
    v_accvgpr_write_b32 a146, v114
    v_mfma_f32_16x16x32_bf16 v[252:255], a[204:207], a[92:95], 0
    s_add_u32 s39, s40, 128
    ds_read_b128 a[228:231], v13 offset:2048
    v_accvgpr_write_b32 a147, v115
    v_mfma_f32_16x16x32_bf16 v[252:255], a[200:203], a[76:79], v[252:255]
    v_exp_f32 v31, v31
    v_mfma_f32_16x16x32_bf16 v[252:255], a[196:199], a[60:63], v[252:255]
    s_add_u32 m0, s63, 49152
    v_exp_f32 v32, v32
    v_mfma_f32_16x16x32_bf16 v[252:255], a[192:195], a[44:47], v[252:255]
    s_waitcnt lgkmcnt(4)
    v_exp_f32 v33, v33
    v_mfma_f32_16x16x32_bf16 v[252:255], a[188:191], a[28:31], v[252:255]
    v_exp_f32 v34, v34
    v_mfma_f32_16x16x32_bf16 v[252:255], a[184:187], a[12:15], v[252:255]
    s_waitcnt lgkmcnt(2)
    v_exp_f32 v35, v35
    v_mfma_f32_16x16x32_bf16 v[40:43], a[208:211], a[0:3], 0
    s_waitcnt vmcnt(11) lgkmcnt(0)
    v_cvt_pk_bf16_f32 v235, v30, v31
    v_cvt_pk_bf16_f32 v242, v32, v33
    v_mfma_f32_16x16x32_bf16 v[40:43], a[212:215], a[16:19], v[40:43]
    s_barrier
    v_mfma_f32_16x16x32_bf16 v[40:43], a[216:219], a[32:35], v[40:43]
    buffer_load_dwordx4 v6, s[16:19], s39 offen lds
    v_mfma_f32_16x16x32_bf16 v[40:43], a[220:223], a[48:51], v[40:43]
    ds_read_b64_tr_b16 a[240:241], v8 offset:36864
    v_cvt_pk_bf16_f32 v243, v34, v35
    v_mfma_f32_16x16x32_bf16 v[40:43], a[224:227], a[64:67], v[40:43]
    ds_read_b64_tr_b16 a[242:243], v8 offset:38912
    v_subrev_u32 v12, 67584, v12
    v_mfma_f32_16x16x32_bf16 v[40:43], a[228:231], a[80:83], v[40:43]
    ds_read_b64_tr_b16 a[244:245], v9 offset:36864
    v_accvgpr_write_b32 a148, v116
    v_mfma_f32_16x16x32_bf16 v[44:47], a[228:231], a[84:87], 0
    s_add_u32 s39, s40, 12416
    ds_read_b64_tr_b16 a[246:247], v9 offset:38912
    v_subrev_u32 v13, 67584, v13
    v_mfma_f32_16x16x32_bf16 v[44:47], a[224:227], a[68:71], v[44:47]
    ds_read_b128 a[184:187], v12 offset:0
    v_accvgpr_write_b32 a149, v117
    v_mfma_f32_16x16x32_bf16 v[44:47], a[220:223], a[52:55], v[44:47]
    s_addk_i32 m0, 4096
    ds_read_b128 a[188:191], v13 offset:0
    v_accvgpr_write_b32 a150, v118
    v_mfma_f32_16x16x32_bf16 v[44:47], a[216:219], a[36:39], v[44:47]
    ds_read_b128 a[192:195], v12 offset:1024
    v_accvgpr_write_b32 a151, v119
    v_mfma_f32_16x16x32_bf16 v[44:47], a[212:215], a[20:23], v[44:47]
    v_exp_f32 v36, v36
    v_mfma_f32_16x16x32_bf16 v[44:47], a[208:211], a[4:7], v[44:47]
    v_exp_f32 v37, v37
    v_mfma_f32_16x16x32_bf16 v[48:51], a[208:211], a[8:11], 0
    s_lshl_b32 s42, s54, 4
    ds_read_b128 a[196:199], v13 offset:1024
    v_cvt_pk_bf16_f32 v250, v36, v37
    v_mfma_f32_16x16x32_bf16 v[48:51], a[212:215], a[24:27], v[48:51]
    s_mul_i32 s42, s42, 384
    ds_read_b128 a[200:203], v12 offset:2048
    v_and_b32 v22, 15, v1
    v_mfma_f32_16x16x32_bf16 v[48:51], a[216:219], a[40:43], v[48:51]
    buffer_load_dwordx4 v6, s[16:19], s39 offen lds
    v_mfma_f32_16x16x32_bf16 v[48:51], a[220:223], a[56:59], v[48:51]
    ds_read_b128 a[204:207], v13 offset:2048
    v_mul_u32_u24 v22, 384, v22
    v_mfma_f32_16x16x32_bf16 v[48:51], a[224:227], a[72:75], v[48:51]
    buffer_load_dword a252, v22, s[16:19], s42 offen offset:256
    v_mfma_f32_16x16x32_bf16 v[48:51], a[228:231], a[88:91], v[48:51]
    v_exp_f32 v38, v38
    v_mfma_f32_16x16x32_bf16 v[52:55], a[228:231], a[92:95], 0
    s_add_u32 s39, s40, 24704
    v_exp_f32 v39, v39
    v_mfma_f32_16x16x32_bf16 v[52:55], a[224:227], a[76:79], v[52:55]
    v_exp_f32 v228, v228
    v_mfma_f32_16x16x32_bf16 v[52:55], a[220:223], a[60:63], v[52:55]
    s_addk_i32 m0, 4096
    v_exp_f32 v229, v229
    v_mfma_f32_16x16x32_bf16 v[52:55], a[216:219], a[44:47], v[52:55]
    s_waitcnt lgkmcnt(1)
    v_exp_f32 v230, v230
    v_mfma_f32_16x16x32_bf16 v[52:55], a[212:215], a[28:31], v[52:55]
    v_exp_f32 v231, v231
    v_mfma_f32_16x16x32_bf16 v[52:55], a[208:211], a[12:15], v[52:55]
    v_exp_f32 v236, v236
    v_mfma_f32_16x16x32_bf16 a[164:167], a[240:243], v[220:223], a[164:167]
    v_exp_f32 v237, v237
    v_mfma_f32_16x16x32_bf16 a[180:183], a[244:247], v[220:223], a[180:183]
    v_exp_f32 v238, v238
    v_mfma_f32_16x16x32_bf16 a[176:179], a[244:247], v[212:215], a[176:179]
    buffer_load_dwordx4 v6, s[16:19], s39 offen lds
    v_mfma_f32_16x16x32_bf16 a[160:163], a[240:243], v[212:215], a[160:163]
    ds_read_b128 a[208:211], v12 offset:6144
    v_cvt_pk_bf16_f32 v251, v38, v39
    v_mfma_f32_16x16x32_bf16 a[156:159], a[240:243], v[204:207], a[156:159]
    ds_read_b128 a[212:215], v13 offset:6144
    v_cvt_pk_bf16_f32 v228, v228, v229
    v_mfma_f32_16x16x32_bf16 a[172:175], a[244:247], v[204:207], a[172:175]
    ds_read_b128 a[216:219], v12 offset:7168
    v_cvt_pk_bf16_f32 v229, v230, v231
    v_mfma_f32_16x16x32_bf16 a[168:171], a[244:247], v[196:199], a[168:171]
    s_add_u32 s39, s40, 36992
    ds_read_b128 a[220:223], v13 offset:7168
    v_cvt_pk_bf16_f32 v236, v236, v237
    v_mfma_f32_16x16x32_bf16 a[152:155], a[240:243], v[196:199], a[152:155]
    v_exp_f32 v239, v239
    v_mfma_f32_16x16x32_bf16 v[56:59], a[184:187], a[0:3], 0
    s_addk_i32 m0, 4096
    ds_read_b128 a[224:227], v12 offset:8192
    v_cvt_pk_bf16_f32 v237, v238, v239
    v_mfma_f32_16x16x32_bf16 v[56:59], a[188:191], a[16:19], v[56:59]
    v_exp_f32 v244, v244
    v_mfma_f32_16x16x32_bf16 v[56:59], a[192:195], a[32:35], v[56:59]
    s_waitcnt lgkmcnt(4)
    v_exp_f32 v245, v245
    v_mfma_f32_16x16x32_bf16 v[56:59], a[196:199], a[48:51], v[56:59]
    ds_read_b128 a[228:231], v13 offset:8192
    v_cvt_pk_bf16_f32 v244, v244, v245
    v_mfma_f32_16x16x32_bf16 v[56:59], a[200:203], a[64:67], v[56:59]
    v_exp_f32 v246, v246
    v_mfma_f32_16x16x32_bf16 v[56:59], a[204:207], a[80:83], v[56:59]
    v_exp_f32 v247, v247
    v_mfma_f32_16x16x32_bf16 v[64:67], a[204:207], a[84:87], 0
    buffer_load_dwordx4 v6, s[16:19], s39 offen lds
    v_mfma_f32_16x16x32_bf16 v[64:67], a[200:203], a[68:71], v[64:67]
    v_exp_f32 v252, v252
    v_mfma_f32_16x16x32_bf16 v[64:67], a[196:199], a[52:55], v[64:67]
    v_exp_f32 v253, v253
    v_mfma_f32_16x16x32_bf16 v[64:67], a[192:195], a[36:39], v[64:67]
    v_exp_f32 v254, v254
    v_mfma_f32_16x16x32_bf16 v[64:67], a[188:191], a[20:23], v[64:67]
    v_exp_f32 v255, v255
    v_mfma_f32_16x16x32_bf16 v[64:67], a[184:187], a[4:7], v[64:67]
    v_exp_f32 v40, v40
    v_mfma_f32_16x16x32_bf16 v[72:75], a[184:187], a[8:11], 0
    v_exp_f32 v41, v41
    v_mfma_f32_16x16x32_bf16 v[72:75], a[188:191], a[24:27], v[72:75]
    v_exp_f32 v42, v42
    v_mfma_f32_16x16x32_bf16 v[72:75], a[192:195], a[40:43], v[72:75]
    v_exp_f32 v43, v43
    v_mfma_f32_16x16x32_bf16 v[72:75], a[196:199], a[56:59], v[72:75]
    v_cvt_pk_bf16_f32 v245, v246, v247
    v_cvt_pk_bf16_f32 v252, v252, v253
    v_mfma_f32_16x16x32_bf16 v[72:75], a[200:203], a[72:75], v[72:75]
    v_exp_f32 v44, v44
    v_mfma_f32_16x16x32_bf16 v[72:75], a[204:207], a[88:91], v[72:75]
    v_exp_f32 v45, v45
    v_mfma_f32_16x16x32_bf16 v[80:83], a[204:207], a[92:95], 0
    ds_read_b64_tr_b16 a[232:233], v8 offset:40960
    v_cvt_pk_bf16_f32 v253, v254, v255
    v_mfma_f32_16x16x32_bf16 v[80:83], a[200:203], a[76:79], v[80:83]
    ds_read_b64_tr_b16 a[234:235], v8 offset:43008
    v_cvt_pk_bf16_f32 v230, v40, v41
    v_mfma_f32_16x16x32_bf16 v[80:83], a[196:199], a[60:63], v[80:83]
    ds_read_b64_tr_b16 a[236:237], v9 offset:40960
    v_cvt_pk_bf16_f32 v231, v42, v43
    v_mfma_f32_16x16x32_bf16 v[80:83], a[192:195], a[44:47], v[80:83]
    ds_read_b64_tr_b16 a[238:239], v9 offset:43008
    v_cvt_pk_bf16_f32 v238, v44, v45
    v_mfma_f32_16x16x32_bf16 v[80:83], a[188:191], a[28:31], v[80:83]
    s_waitcnt lgkmcnt(4)
    v_exp_f32 v46, v46
    v_mfma_f32_16x16x32_bf16 v[80:83], a[184:187], a[12:15], v[80:83]
    v_exp_f32 v47, v47
    v_mfma_f32_16x16x32_bf16 v[24:27], a[208:211], a[0:3], 0
    v_exp_f32 v48, v48
    v_mfma_f32_16x16x32_bf16 v[24:27], a[212:215], a[16:19], v[24:27]
    v_exp_f32 v49, v49
    v_mfma_f32_16x16x32_bf16 v[24:27], a[216:219], a[32:35], v[24:27]
    ds_read_b128 a[184:187], v12 offset:12288
    v_cvt_pk_bf16_f32 v239, v46, v47
    v_mfma_f32_16x16x32_bf16 v[24:27], a[220:223], a[48:51], v[24:27]
    ds_read_b128 a[188:191], v13 offset:12288
    v_cvt_pk_bf16_f32 v246, v48, v49
    v_mfma_f32_16x16x32_bf16 v[24:27], a[224:227], a[64:67], v[24:27]
    v_exp_f32 v50, v50
    v_mfma_f32_16x16x32_bf16 v[24:27], a[228:231], a[80:83], v[24:27]
    v_exp_f32 v51, v51
    v_mfma_f32_16x16x32_bf16 v[28:31], a[228:231], a[84:87], 0
    ds_read_b128 a[192:195], v12 offset:13312
    v_cvt_pk_bf16_f32 v247, v50, v51
    v_mfma_f32_16x16x32_bf16 v[28:31], a[224:227], a[68:71], v[28:31]
    v_exp_f32 v52, v52
    v_mfma_f32_16x16x32_bf16 v[28:31], a[220:223], a[52:55], v[28:31]
    v_exp_f32 v53, v53
    v_mfma_f32_16x16x32_bf16 v[28:31], a[216:219], a[36:39], v[28:31]
    ds_read_b128 a[196:199], v13 offset:13312
    v_cvt_pk_bf16_f32 v254, v52, v53
    v_mfma_f32_16x16x32_bf16 v[28:31], a[212:215], a[20:23], v[28:31]
    v_exp_f32 v54, v54
    v_mfma_f32_16x16x32_bf16 v[28:31], a[208:211], a[4:7], v[28:31]
    v_exp_f32 v55, v55
    v_mfma_f32_16x16x32_bf16 v[32:35], a[208:211], a[8:11], 0
    ds_read_b128 a[200:203], v12 offset:14336
    v_cvt_pk_bf16_f32 v255, v54, v55
    v_mfma_f32_16x16x32_bf16 v[32:35], a[212:215], a[24:27], v[32:35]
    v_exp_f32 v56, v56
    v_mfma_f32_16x16x32_bf16 v[32:35], a[216:219], a[40:43], v[32:35]
    v_exp_f32 v57, v57
    v_mfma_f32_16x16x32_bf16 v[32:35], a[220:223], a[56:59], v[32:35]
    ds_read_b128 a[204:207], v13 offset:14336
    v_cvt_pk_bf16_f32 v56, v56, v57
    v_mfma_f32_16x16x32_bf16 v[32:35], a[224:227], a[72:75], v[32:35]
    v_exp_f32 v58, v58
    v_mfma_f32_16x16x32_bf16 v[32:35], a[228:231], a[88:91], v[32:35]
    v_exp_f32 v59, v59
    v_mfma_f32_16x16x32_bf16 v[36:39], a[228:231], a[92:95], 0
    v_exp_f32 v64, v64
    v_mfma_f32_16x16x32_bf16 v[36:39], a[224:227], a[76:79], v[36:39]
    v_exp_f32 v65, v65
    v_mfma_f32_16x16x32_bf16 v[36:39], a[220:223], a[60:63], v[36:39]
    v_exp_f32 v66, v66
    v_mfma_f32_16x16x32_bf16 v[36:39], a[216:219], a[44:47], v[36:39]
    s_waitcnt lgkmcnt(1)
    v_exp_f32 v67, v67
    v_mfma_f32_16x16x32_bf16 v[36:39], a[212:215], a[28:31], v[36:39]
    v_exp_f32 v72, v72
    v_mfma_f32_16x16x32_bf16 v[36:39], a[208:211], a[12:15], v[36:39]
    v_exp_f32 v73, v73
    v_mfma_f32_16x16x32_bf16 a[152:155], a[232:235], v[224:227], a[152:155]
    v_exp_f32 v74, v74
    v_mfma_f32_16x16x32_bf16 a[168:171], a[236:239], v[224:227], a[168:171]
    v_exp_f32 v75, v75
    v_mfma_f32_16x16x32_bf16 a[172:175], a[236:239], v[232:235], a[172:175]
    ds_read_b128 a[208:211], v12 offset:18432
    v_cvt_pk_bf16_f32 v57, v58, v59
    v_mfma_f32_16x16x32_bf16 a[156:159], a[232:235], v[232:235], a[156:159]
    ds_read_b128 a[212:215], v13 offset:18432
    v_cvt_pk_bf16_f32 v64, v64, v65
    v_mfma_f32_16x16x32_bf16 a[160:163], a[232:235], v[240:243], a[160:163]
    ds_read_b128 a[216:219], v12 offset:19456
    v_cvt_pk_bf16_f32 v65, v66, v67
    v_mfma_f32_16x16x32_bf16 a[176:179], a[236:239], v[240:243], a[176:179]
    ds_read_b128 a[220:223], v13 offset:19456
    v_cvt_pk_bf16_f32 v72, v72, v73
    v_mfma_f32_16x16x32_bf16 a[180:183], a[236:239], v[248:251], a[180:183]
    ds_read_b128 a[224:227], v12 offset:20480
    v_cvt_pk_bf16_f32 v73, v74, v75
    v_mfma_f32_16x16x32_bf16 a[164:167], a[232:235], v[248:251], a[164:167]
    v_exp_f32 v80, v80
    v_mfma_f32_16x16x32_bf16 v[60:63], a[184:187], a[0:3], 0
    v_exp_f32 v81, v81
    v_mfma_f32_16x16x32_bf16 v[60:63], a[188:191], a[16:19], v[60:63]
    ds_read_b128 a[228:231], v13 offset:20480
    v_cvt_pk_bf16_f32 v80, v80, v81
    v_mfma_f32_16x16x32_bf16 v[60:63], a[192:195], a[32:35], v[60:63]
    s_waitcnt lgkmcnt(4)
    v_exp_f32 v82, v82
    v_mfma_f32_16x16x32_bf16 v[60:63], a[196:199], a[48:51], v[60:63]
    v_exp_f32 v83, v83
    v_mfma_f32_16x16x32_bf16 v[60:63], a[200:203], a[64:67], v[60:63]
    v_exp_f32 v24, v24
    v_mfma_f32_16x16x32_bf16 v[60:63], a[204:207], a[80:83], v[60:63]
    v_exp_f32 v25, v25
    v_mfma_f32_16x16x32_bf16 v[68:71], a[204:207], a[84:87], 0
    v_exp_f32 v26, v26
    v_mfma_f32_16x16x32_bf16 v[68:71], a[200:203], a[68:71], v[68:71]
    v_exp_f32 v27, v27
    v_mfma_f32_16x16x32_bf16 v[68:71], a[196:199], a[52:55], v[68:71]
    v_exp_f32 v28, v28
    v_mfma_f32_16x16x32_bf16 v[68:71], a[192:195], a[36:39], v[68:71]
    v_exp_f32 v29, v29
    v_mfma_f32_16x16x32_bf16 v[68:71], a[188:191], a[20:23], v[68:71]
    v_cvt_pk_bf16_f32 v81, v82, v83
    v_cvt_pk_bf16_f32 v58, v24, v25
    v_mfma_f32_16x16x32_bf16 v[68:71], a[184:187], a[4:7], v[68:71]
    v_exp_f32 v30, v30
    v_mfma_f32_16x16x32_bf16 v[76:79], a[184:187], a[8:11], 0
    v_exp_f32 v31, v31
    v_mfma_f32_16x16x32_bf16 v[76:79], a[188:191], a[24:27], v[76:79]
    v_exp_f32 v32, v32
    v_mfma_f32_16x16x32_bf16 v[76:79], a[192:195], a[40:43], v[76:79]
    v_exp_f32 v33, v33
    v_mfma_f32_16x16x32_bf16 v[76:79], a[196:199], a[56:59], v[76:79]
    v_cvt_pk_bf16_f32 v59, v26, v27
    v_cvt_pk_bf16_f32 v66, v28, v29
    v_mfma_f32_16x16x32_bf16 v[76:79], a[200:203], a[72:75], v[76:79]
    v_exp_f32 v34, v34
    v_mfma_f32_16x16x32_bf16 v[76:79], a[204:207], a[88:91], v[76:79]
    v_exp_f32 v35, v35
    v_mfma_f32_16x16x32_bf16 v[84:87], a[204:207], a[92:95], 0
    s_add_u32 s39, s40, 49280
    v_exp_f32 v36, v36
    v_mfma_f32_16x16x32_bf16 v[84:87], a[200:203], a[76:79], v[84:87]
    v_exp_f32 v37, v37
    v_mfma_f32_16x16x32_bf16 v[84:87], a[196:199], a[60:63], v[84:87]
    s_add_u32 m0, s63, 0
    v_cvt_pk_bf16_f32 v67, v30, v31
    v_cvt_pk_bf16_f32 v74, v32, v33
    v_mfma_f32_16x16x32_bf16 v[84:87], a[192:195], a[44:47], v[84:87]
    v_exp_f32 v38, v38
    v_mfma_f32_16x16x32_bf16 v[84:87], a[188:191], a[28:31], v[84:87]
    v_exp_f32 v39, v39
    v_mfma_f32_16x16x32_bf16 v[84:87], a[184:187], a[12:15], v[84:87]
    s_waitcnt lgkmcnt(0)
    v_exp_f32 v60, v60
    v_mfma_f32_16x16x32_bf16 v[40:43], a[208:211], a[0:3], 0
    s_waitcnt vmcnt(7)
    v_exp_f32 v61, v61
    v_mfma_f32_16x16x32_bf16 v[40:43], a[212:215], a[16:19], v[40:43]
    s_barrier
    v_mfma_f32_16x16x32_bf16 v[40:43], a[216:219], a[32:35], v[40:43]
    buffer_load_dwordx4 v6, s[16:19], s39 offen lds
    v_mfma_f32_16x16x32_bf16 v[40:43], a[220:223], a[48:51], v[40:43]
    ds_read_b64_tr_b16 a[240:241], v8 offset:45056
    v_cvt_pk_bf16_f32 v75, v34, v35
    v_mfma_f32_16x16x32_bf16 v[40:43], a[224:227], a[64:67], v[40:43]
    ds_read_b64_tr_b16 a[242:243], v8 offset:47104
    v_cvt_pk_bf16_f32 v82, v36, v37
    v_mfma_f32_16x16x32_bf16 v[40:43], a[228:231], a[80:83], v[40:43]
    ds_read_b64_tr_b16 a[244:245], v9 offset:45056
    v_cvt_pk_bf16_f32 v83, v38, v39
    v_mfma_f32_16x16x32_bf16 v[44:47], a[228:231], a[84:87], 0
    s_add_u32 s39, s40, 61568
    ds_read_b64_tr_b16 a[246:247], v9 offset:47104
    v_cvt_pk_bf16_f32 v60, v60, v61
    v_mfma_f32_16x16x32_bf16 v[44:47], a[224:227], a[68:71], v[44:47]
    v_exp_f32 v62, v62
    v_mfma_f32_16x16x32_bf16 v[44:47], a[220:223], a[52:55], v[44:47]
    s_addk_i32 m0, 4096
    v_exp_f32 v63, v63
    v_mfma_f32_16x16x32_bf16 v[44:47], a[216:219], a[36:39], v[44:47]
    ds_read_b128 a[184:187], v12 offset:24576
    v_cvt_pk_bf16_f32 v61, v62, v63
    v_mfma_f32_16x16x32_bf16 v[44:47], a[212:215], a[20:23], v[44:47]
    v_exp_f32 v68, v68
    v_mfma_f32_16x16x32_bf16 v[44:47], a[208:211], a[4:7], v[44:47]
    v_exp_f32 v69, v69
    v_mfma_f32_16x16x32_bf16 v[48:51], a[208:211], a[8:11], 0
    s_mov_b32 s28, s82
    ds_read_b128 a[188:191], v13 offset:24576
    v_cvt_pk_bf16_f32 v68, v68, v69
    v_mfma_f32_16x16x32_bf16 v[48:51], a[212:215], a[24:27], v[48:51]
    s_and_b32 s29, s83, 0xffff
    ds_read_b128 a[192:195], v12 offset:25600
    v_and_b32 v22, 15, v1
    v_mfma_f32_16x16x32_bf16 v[48:51], a[216:219], a[40:43], v[48:51]
    buffer_load_dwordx4 v6, s[16:19], s39 offen lds
    v_mfma_f32_16x16x32_bf16 v[48:51], a[220:223], a[56:59], v[48:51]
    s_mov_b32 s30, 1966080
    ds_read_b128 a[196:199], v13 offset:25600
    v_mul_u32_u24 v22, 1280, v22
    v_mfma_f32_16x16x32_bf16 v[48:51], a[224:227], a[72:75], v[48:51]
    s_mov_b32 s31, 0x00020000
    v_exp_f32 v70, v70
    v_mfma_f32_16x16x32_bf16 v[48:51], a[228:231], a[88:91], v[48:51]
    s_mul_hi_u32 s48, s58, 429496730
    v_exp_f32 v71, v71
    v_mfma_f32_16x16x32_bf16 v[52:55], a[228:231], a[92:95], 0
    s_add_u32 s39, s40, 73856
    ds_read_b128 a[200:203], v12 offset:26624
    v_cvt_pk_bf16_f32 v69, v70, v71
    v_mfma_f32_16x16x32_bf16 v[52:55], a[224:227], a[76:79], v[52:55]
    s_mul_i32 s42, s48, 80640
    v_exp_f32 v76, v76
    v_mfma_f32_16x16x32_bf16 v[52:55], a[220:223], a[60:63], v[52:55]
    s_addk_i32 m0, 4096
    v_exp_f32 v77, v77
    v_mfma_f32_16x16x32_bf16 v[52:55], a[216:219], a[44:47], v[52:55]
    s_waitcnt lgkmcnt(2)
    ds_read_b128 a[204:207], v13 offset:26624
    v_cvt_pk_bf16_f32 v76, v76, v77
    v_mfma_f32_16x16x32_bf16 v[52:55], a[212:215], a[28:31], v[52:55]
    s_lshl_b32 s56, s58, 7
    v_exp_f32 v78, v78
    v_mfma_f32_16x16x32_bf16 v[52:55], a[208:211], a[12:15], v[52:55]
    s_add_u32 s42, s42, s56
    v_exp_f32 v79, v79
    v_mfma_f32_16x16x32_bf16 a[164:167], a[240:243], v[252:255], a[164:167]
    s_mul_i32 s56, s3, 20480
    v_exp_f32 v84, v84
    v_mfma_f32_16x16x32_bf16 a[180:183], a[244:247], v[252:255], a[180:183]
    s_add_u32 s42, s42, s56
    v_exp_f32 v85, v85
    v_mfma_f32_16x16x32_bf16 a[176:179], a[244:247], v[244:247], a[176:179]
    buffer_load_dword a252, v22, s[28:31], s42 offen
    v_mfma_f32_16x16x32_bf16 a[160:163], a[240:243], v[244:247], a[160:163]
    buffer_load_dwordx4 v6, s[16:19], s39 offen lds
    v_mfma_f32_16x16x32_bf16 a[156:159], a[240:243], v[236:239], a[156:159]
    s_add_u32 s56, s7, 1
    ds_read_b128 a[208:211], v12 offset:30720
    v_cvt_pk_bf16_f32 v77, v78, v79
    v_mfma_f32_16x16x32_bf16 a[172:175], a[244:247], v[236:239], a[172:175]
    ds_read_b128 a[212:215], v13 offset:30720
    v_cvt_pk_bf16_f32 v84, v84, v85
    v_mfma_f32_16x16x32_bf16 a[168:171], a[244:247], v[228:231], a[168:171]
    s_add_u32 s39, s40, 86144
    ds_read_b128 a[216:219], v12 offset:31744
    v_mov_b32 v4, s56
    v_mfma_f32_16x16x32_bf16 a[152:155], a[240:243], v[228:231], a[152:155]
    s_add_u32 s56, s7, 2
    v_exp_f32 v86, v86
    v_mfma_f32_16x16x32_bf16 v[88:91], a[184:187], a[0:3], 0
    s_waitcnt lgkmcnt(3)
    v_exp_f32 v87, v87
    v_mfma_f32_16x16x32_bf16 v[88:91], a[188:191], a[16:19], v[88:91]
    s_addk_i32 m0, 4096
    ds_read_b128 a[220:223], v13 offset:31744
    v_cvt_pk_bf16_f32 v85, v86, v87
    v_mfma_f32_16x16x32_bf16 v[88:91], a[192:195], a[32:35], v[88:91]
    v_exp_f32 v40, v40
    v_mfma_f32_16x16x32_bf16 v[88:91], a[196:199], a[48:51], v[88:91]
    v_exp_f32 v41, v41
    v_mfma_f32_16x16x32_bf16 v[88:91], a[200:203], a[64:67], v[88:91]
    ds_read_b128 a[224:227], v12 offset:32768
    v_cvt_pk_bf16_f32 v62, v40, v41
    v_mfma_f32_16x16x32_bf16 v[88:91], a[204:207], a[80:83], v[88:91]
    v_exp_f32 v42, v42
    v_mfma_f32_16x16x32_bf16 v[96:99], a[204:207], a[84:87], 0
    buffer_load_dwordx4 v6, s[16:19], s39 offen lds
    v_mfma_f32_16x16x32_bf16 v[96:99], a[200:203], a[68:71], v[96:99]
    v_exp_f32 v43, v43
    v_mfma_f32_16x16x32_bf16 v[96:99], a[196:199], a[52:55], v[96:99]
    ds_read_b128 a[228:231], v13 offset:32768
    v_cvt_pk_bf16_f32 v63, v42, v43
    v_mfma_f32_16x16x32_bf16 v[96:99], a[192:195], a[36:39], v[96:99]
pg_8:
    s_cbranch_execz pg_12
    v_exp_f32 v44, v44
    v_mfma_f32_16x16x32_bf16 v[96:99], a[188:191], a[20:23], v[96:99]
    s_add_u32 s39, s40, 98432
    v_exp_f32 v45, v45
    v_mfma_f32_16x16x32_bf16 v[96:99], a[184:187], a[4:7], v[96:99]
    v_exp_f32 v46, v46
    v_mfma_f32_16x16x32_bf16 v[104:107], a[184:187], a[8:11], 0
    s_addk_i32 m0, 4096
    v_exp_f32 v47, v47
    v_mfma_f32_16x16x32_bf16 v[104:107], a[188:191], a[24:27], v[104:107]
    v_exp_f32 v48, v48
    v_mfma_f32_16x16x32_bf16 v[104:107], a[192:195], a[40:43], v[104:107]
    v_exp_f32 v49, v49
    v_mfma_f32_16x16x32_bf16 v[104:107], a[196:199], a[56:59], v[104:107]
    v_exp_f32 v50, v50
    v_mfma_f32_16x16x32_bf16 v[104:107], a[200:203], a[72:75], v[104:107]
    v_exp_f32 v51, v51
    v_mfma_f32_16x16x32_bf16 v[104:107], a[204:207], a[88:91], v[104:107]
    v_cvt_pk_bf16_f32 v70, v44, v45
    v_cvt_pk_bf16_f32 v71, v46, v47
    v_mfma_f32_16x16x32_bf16 v[112:115], a[204:207], a[92:95], 0
    buffer_load_dwordx4 v6, s[16:19], s39 offen lds
    v_mfma_f32_16x16x32_bf16 v[112:115], a[200:203], a[76:79], v[112:115]
    ds_read_b64_tr_b16 a[232:233], v8 offset:49152
    v_cvt_pk_bf16_f32 v78, v48, v49
    v_mfma_f32_16x16x32_bf16 v[112:115], a[196:199], a[60:63], v[112:115]
    ds_read_b64_tr_b16 a[234:235], v8 offset:51200
    v_cvt_pk_bf16_f32 v79, v50, v51
    v_mfma_f32_16x16x32_bf16 v[112:115], a[192:195], a[44:47], v[112:115]
    s_waitcnt lgkmcnt(2)
    v_exp_f32 v52, v52
    v_mfma_f32_16x16x32_bf16 v[112:115], a[188:191], a[28:31], v[112:115]
    s_add_u32 s39, s40, 110720
    v_exp_f32 v53, v53
    v_mfma_f32_16x16x32_bf16 v[112:115], a[184:187], a[12:15], v[112:115]
    ds_read_b64_tr_b16 a[236:237], v9 offset:49152
    v_cvt_pk_bf16_f32 v86, v52, v53
    v_mfma_f32_16x16x32_bf16 v[24:27], a[208:211], a[0:3], 0
    s_addk_i32 m0, 4096
    v_exp_f32 v54, v54
    v_mfma_f32_16x16x32_bf16 v[24:27], a[212:215], a[16:19], v[24:27]
    v_exp_f32 v55, v55
    v_mfma_f32_16x16x32_bf16 v[24:27], a[216:219], a[32:35], v[24:27]
    ds_read_b64_tr_b16 a[238:239], v9 offset:51200
    v_cvt_pk_bf16_f32 v87, v54, v55
    v_mfma_f32_16x16x32_bf16 v[24:27], a[220:223], a[48:51], v[24:27]
    v_exp_f32 v88, v88
    v_mfma_f32_16x16x32_bf16 v[24:27], a[224:227], a[64:67], v[24:27]
    v_exp_f32 v89, v89
    v_mfma_f32_16x16x32_bf16 v[24:27], a[228:231], a[80:83], v[24:27]
    ds_read_b128 a[184:187], v12 offset:36864
    v_cvt_pk_bf16_f32 v88, v88, v89
    v_mfma_f32_16x16x32_bf16 v[28:31], a[228:231], a[84:87], 0
    buffer_load_dwordx4 v6, s[16:19], s39 offen lds
    v_mfma_f32_16x16x32_bf16 v[28:31], a[224:227], a[68:71], v[28:31]
    v_exp_f32 v90, v90
    v_mfma_f32_16x16x32_bf16 v[28:31], a[220:223], a[52:55], v[28:31]
    v_exp_f32 v91, v91
    v_mfma_f32_16x16x32_bf16 v[28:31], a[216:219], a[36:39], v[28:31]
    ds_read_b128 a[188:191], v13 offset:36864
    v_cvt_pk_bf16_f32 v89, v90, v91
    v_mfma_f32_16x16x32_bf16 v[28:31], a[212:215], a[20:23], v[28:31]
    v_exp_f32 v96, v96
    v_mfma_f32_16x16x32_bf16 v[28:31], a[208:211], a[4:7], v[28:31]
    v_exp_f32 v97, v97
    v_mfma_f32_16x16x32_bf16 v[32:35], a[208:211], a[8:11], 0
    ds_read_b128 a[192:195], v12 offset:37888
    v_cvt_pk_bf16_f32 v96, v96, v97
    v_mfma_f32_16x16x32_bf16 v[32:35], a[212:215], a[24:27], v[32:35]
    v_exp_f32 v98, v98
    v_mfma_f32_16x16x32_bf16 v[32:35], a[216:219], a[40:43], v[32:35]
    v_exp_f32 v99, v99
    v_mfma_f32_16x16x32_bf16 v[32:35], a[220:223], a[56:59], v[32:35]
    ds_read_b128 a[196:199], v13 offset:37888
    v_cvt_pk_bf16_f32 v97, v98, v99
    v_mfma_f32_16x16x32_bf16 v[32:35], a[224:227], a[72:75], v[32:35]
    v_exp_f32 v104, v104
    v_mfma_f32_16x16x32_bf16 v[32:35], a[228:231], a[88:91], v[32:35]
    v_exp_f32 v105, v105
    v_mfma_f32_16x16x32_bf16 v[36:39], a[228:231], a[92:95], 0
    ds_read_b128 a[200:203], v12 offset:38912
    v_cvt_pk_bf16_f32 v104, v104, v105
    v_mfma_f32_16x16x32_bf16 v[36:39], a[224:227], a[76:79], v[36:39]
    v_exp_f32 v106, v106
    v_mfma_f32_16x16x32_bf16 v[36:39], a[220:223], a[60:63], v[36:39]
    v_exp_f32 v107, v107
    v_mfma_f32_16x16x32_bf16 v[36:39], a[216:219], a[44:47], v[36:39]
    s_waitcnt lgkmcnt(2)
    ds_read_b128 a[204:207], v13 offset:38912
    v_cvt_pk_bf16_f32 v105, v106, v107
    v_mfma_f32_16x16x32_bf16 v[36:39], a[212:215], a[28:31], v[36:39]
    v_exp_f32 v112, v112
    v_mfma_f32_16x16x32_bf16 v[36:39], a[208:211], a[12:15], v[36:39]
    v_exp_f32 v113, v113
    v_mfma_f32_16x16x32_bf16 a[152:155], a[232:235], v[56:59], a[152:155]
    v_exp_f32 v114, v114
    v_mfma_f32_16x16x32_bf16 a[168:171], a[236:239], v[56:59], a[168:171]
    v_exp_f32 v115, v115
    v_mfma_f32_16x16x32_bf16 a[172:175], a[236:239], v[64:67], a[172:175]
    ds_read_b128 a[208:211], v12 offset:43008
    v_cvt_pk_bf16_f32 v112, v112, v113
    v_mfma_f32_16x16x32_bf16 a[156:159], a[232:235], v[64:67], a[156:159]
    ds_read_b128 a[212:215], v13 offset:43008
    v_cvt_pk_bf16_f32 v113, v114, v115
    v_mfma_f32_16x16x32_bf16 a[160:163], a[232:235], v[72:75], a[160:163]
    v_exp_f32 v24, v24
    v_mfma_f32_16x16x32_bf16 a[176:179], a[236:239], v[72:75], a[176:179]
    v_exp_f32 v25, v25
    v_mfma_f32_16x16x32_bf16 a[180:183], a[236:239], v[80:83], a[180:183]
    ds_read_b128 a[216:219], v12 offset:44032
    v_cvt_pk_bf16_f32 v90, v24, v25
    v_mfma_f32_16x16x32_bf16 a[164:167], a[232:235], v[80:83], a[164:167]
    ds_read_b128 a[220:223], v13 offset:44032
    v_mov_b32 v24, 0
    v_mfma_f32_16x16x32_bf16 v[92:95], a[184:187], a[0:3], 0
    s_waitcnt lgkmcnt(4)
    ds_read_b128 a[224:227], v12 offset:45056
    v_mov_b32 v25, 0
    v_mfma_f32_16x16x32_bf16 v[92:95], a[188:191], a[16:19], v[92:95]
    v_exp_f32 v26, v26
    v_mfma_f32_16x16x32_bf16 v[92:95], a[192:195], a[32:35], v[92:95]
    v_exp_f32 v27, v27
    v_mfma_f32_16x16x32_bf16 v[92:95], a[196:199], a[48:51], v[92:95]
    ds_read_b128 a[228:231], v13 offset:45056
    v_cvt_pk_bf16_f32 v91, v26, v27
    v_mfma_f32_16x16x32_bf16 v[92:95], a[200:203], a[64:67], v[92:95]
    v_exp_f32 v28, v28
    v_mfma_f32_16x16x32_bf16 v[92:95], a[204:207], a[80:83], v[92:95]
    v_exp_f32 v29, v29
    v_mfma_f32_16x16x32_bf16 v[100:103], a[204:207], a[84:87], 0
    v_exp_f32 v30, v30
    v_mfma_f32_16x16x32_bf16 v[100:103], a[200:203], a[68:71], v[100:103]
    v_exp_f32 v31, v31
    v_mfma_f32_16x16x32_bf16 v[100:103], a[196:199], a[52:55], v[100:103]
    v_exp_f32 v32, v32
    v_mfma_f32_16x16x32_bf16 v[100:103], a[192:195], a[36:39], v[100:103]
    v_exp_f32 v33, v33
    v_mfma_f32_16x16x32_bf16 v[100:103], a[188:191], a[20:23], v[100:103]
    v_exp_f32 v34, v34
    v_mfma_f32_16x16x32_bf16 v[100:103], a[184:187], a[4:7], v[100:103]
    v_exp_f32 v35, v35
    v_mfma_f32_16x16x32_bf16 v[108:111], a[184:187], a[8:11], 0
    v_cvt_pk_bf16_f32 v98, v28, v29
    v_cvt_pk_bf16_f32 v99, v30, v31
    v_mfma_f32_16x16x32_bf16 v[108:111], a[188:191], a[24:27], v[108:111]
    v_exp_f32 v36, v36
    v_mfma_f32_16x16x32_bf16 v[108:111], a[192:195], a[40:43], v[108:111]
    v_exp_f32 v37, v37
    v_mfma_f32_16x16x32_bf16 v[108:111], a[196:199], a[56:59], v[108:111]
    v_exp_f32 v38, v38
    v_mfma_f32_16x16x32_bf16 v[108:111], a[200:203], a[72:75], v[108:111]
    v_exp_f32 v39, v39
    v_mfma_f32_16x16x32_bf16 v[108:111], a[204:207], a[88:91], v[108:111]
    v_cvt_pk_bf16_f32 v106, v32, v33
    v_cvt_pk_bf16_f32 v107, v34, v35
    v_mfma_f32_16x16x32_bf16 v[116:119], a[204:207], a[92:95], 0
    s_add_u32 s39, s40, 123008
    v_cvt_pk_bf16_f32 v114, v36, v37
    v_cvt_pk_bf16_f32 v115, v38, v39
    v_mfma_f32_16x16x32_bf16 v[116:119], a[200:203], a[76:79], v[116:119]
    v_exp_f32 v92, v92
    v_mfma_f32_16x16x32_bf16 v[116:119], a[196:199], a[60:63], v[116:119]
    s_addk_i32 m0, 4096
    v_exp_f32 v93, v93
    v_mfma_f32_16x16x32_bf16 v[116:119], a[192:195], a[44:47], v[116:119]
    s_waitcnt lgkmcnt(0)
    v_exp_f32 v94, v94
    v_mfma_f32_16x16x32_bf16 v[116:119], a[188:191], a[28:31], v[116:119]
    v_exp_f32 v95, v95
    v_mfma_f32_16x16x32_bf16 v[116:119], a[184:187], a[12:15], v[116:119]
    v_exp_f32 v100, v100
    v_mfma_f32_16x16x32_bf16 v[40:43], a[208:211], a[0:3], 0
    s_waitcnt vmcnt(12)
    v_exp_f32 v101, v101
    v_mfma_f32_16x16x32_bf16 v[40:43], a[212:215], a[16:19], v[40:43]
    s_barrier
    v_mfma_f32_16x16x32_bf16 v[40:43], a[216:219], a[32:35], v[40:43]
    buffer_load_dwordx4 v6, s[16:19], s39 offen lds
    v_mfma_f32_16x16x32_bf16 v[40:43], a[220:223], a[48:51], v[40:43]
    s_add_u32 s39, s40, 135296
    ds_read_b64_tr_b16 a[240:241], v8 offset:53248
    v_cvt_pk_bf16_f32 v92, v92, v93
    v_mfma_f32_16x16x32_bf16 v[40:43], a[224:227], a[64:67], v[40:43]
    s_addk_i32 m0, 4096
    ds_read_b64_tr_b16 a[242:243], v8 offset:55296
    v_cvt_pk_bf16_f32 v93, v94, v95
    v_mfma_f32_16x16x32_bf16 v[40:43], a[228:231], a[80:83], v[40:43]
    ds_read_b64_tr_b16 a[244:245], v9 offset:53248
    v_cvt_pk_bf16_f32 v100, v100, v101
    v_mfma_f32_16x16x32_bf16 v[44:47], a[228:231], a[84:87], 0
    ds_read_b64_tr_b16 a[246:247], v9 offset:55296
    v_mov_b32 v28, 0
    v_mfma_f32_16x16x32_bf16 v[44:47], a[224:227], a[68:71], v[44:47]
    v_exp_f32 v102, v102
    v_mfma_f32_16x16x32_bf16 v[44:47], a[220:223], a[52:55], v[44:47]
    v_exp_f32 v103, v103
    v_mfma_f32_16x16x32_bf16 v[44:47], a[216:219], a[36:39], v[44:47]
    v_exp_f32 v108, v108
    v_mfma_f32_16x16x32_bf16 v[44:47], a[212:215], a[20:23], v[44:47]
    buffer_load_dwordx4 v6, s[16:19], s39 offen lds
    v_mfma_f32_16x16x32_bf16 v[44:47], a[208:211], a[4:7], v[44:47]
    s_add_u32 s39, s40, 147584
    v_exp_f32 v109, v109
    v_mfma_f32_16x16x32_bf16 v[48:51], a[208:211], a[8:11], 0
    s_addk_i32 m0, 4096
    v_exp_f32 v110, v110
    v_mfma_f32_16x16x32_bf16 v[48:51], a[212:215], a[24:27], v[48:51]
    v_exp_f32 v111, v111
    v_mfma_f32_16x16x32_bf16 v[48:51], a[216:219], a[40:43], v[48:51]
    v_cvt_pk_bf16_f32 v101, v102, v103
    v_cvt_pk_bf16_f32 v108, v108, v109
    v_mfma_f32_16x16x32_bf16 v[48:51], a[220:223], a[56:59], v[48:51]
    v_exp_f32 v116, v116
    v_mfma_f32_16x16x32_bf16 v[48:51], a[224:227], a[72:75], v[48:51]
    v_exp_f32 v117, v117
    v_mfma_f32_16x16x32_bf16 v[48:51], a[228:231], a[88:91], v[48:51]
    v_exp_f32 v118, v118
    v_mfma_f32_16x16x32_bf16 v[52:55], a[228:231], a[92:95], 0
    buffer_load_dwordx4 v6, s[16:19], s39 offen lds
    v_mfma_f32_16x16x32_bf16 v[52:55], a[224:227], a[76:79], v[52:55]
    s_add_u32 s39, s40, 159872
    v_exp_f32 v119, v119
    v_mfma_f32_16x16x32_bf16 v[52:55], a[220:223], a[60:63], v[52:55]
    s_addk_i32 m0, 4096
    v_cvt_pk_bf16_f32 v109, v110, v111
    v_cvt_pk_bf16_f32 v116, v116, v117
    v_mfma_f32_16x16x32_bf16 v[52:55], a[216:219], a[44:47], v[52:55]
    s_waitcnt lgkmcnt(0)
    v_exp_f32 v40, v40
    v_mfma_f32_16x16x32_bf16 v[52:55], a[212:215], a[28:31], v[52:55]
    v_exp_f32 v41, v41
    v_mfma_f32_16x16x32_bf16 v[52:55], a[208:211], a[12:15], v[52:55]
    v_exp_f32 v42, v42
    v_mfma_f32_16x16x32_bf16 a[164:167], a[240:243], v[84:87], a[164:167]
    v_exp_f32 v43, v43
    v_mfma_f32_16x16x32_bf16 a[180:183], a[244:247], v[84:87], a[180:183]
    v_cvt_pk_bf16_f32 v117, v118, v119
    v_cvt_pk_bf16_f32 v94, v40, v41
    v_mfma_f32_16x16x32_bf16 a[176:179], a[244:247], v[76:79], a[176:179]
    buffer_load_dwordx4 v6, s[16:19], s39 offen lds
    v_mfma_f32_16x16x32_bf16 a[160:163], a[240:243], v[76:79], a[160:163]
    s_add_u32 s39, s40, 172160
    v_exp_f32 v44, v44
    v_mfma_f32_16x16x32_bf16 a[156:159], a[240:243], v[68:71], a[156:159]
    s_addk_i32 m0, 4096
    v_exp_f32 v45, v45
    v_mfma_f32_16x16x32_bf16 a[172:175], a[244:247], v[68:71], a[172:175]
    v_exp_f32 v46, v46
    v_mfma_f32_16x16x32_bf16 a[168:171], a[244:247], v[60:63], a[168:171]
    v_exp_f32 v47, v47
    v_mfma_f32_16x16x32_bf16 a[152:155], a[240:243], v[60:63], a[152:155]
    v_cvt_pk_bf16_f32 v95, v42, v43
    v_cvt_pk_bf16_f32 v102, v44, v45
    v_smfmac_f32_16x16x64_bf16 v[24:27], a[248:251], a[96:103], v20
    v_cvt_pk_bf16_f32 v103, v46, v47
    v_mov_b32 v29, 0
    s_nop 1
    v_smfmac_f32_16x16x64_bf16 v[28:31], a[248:251], a[104:111], v20
    v_mov_b32 v32, 0
    v_mov_b32 v33, 0
    s_nop 1
    v_smfmac_f32_16x16x64_bf16 v[32:35], a[248:251], a[112:119], v20
    buffer_load_dwordx4 v6, s[16:19], s39 offen lds
    v_mov_b32 v36, 0
    v_mov_b32 v37, 0
    s_nop 1
    v_smfmac_f32_16x16x64_bf16 v[36:39], a[248:251], a[120:127], v20
    s_add_u32 s39, s40, 184448
    ds_read_b64_tr_b16 a[232:233], v8 offset:57344
    v_smfmac_f32_16x16x64_bf16 v[24:27], a[248:251], a[128:135], v20
    s_addk_i32 m0, 4096
    ds_read_b64_tr_b16 a[234:235], v8 offset:59392
    v_smfmac_f32_16x16x64_bf16 v[28:31], a[248:251], a[136:143], v20
    ds_read_b64_tr_b16 a[236:237], v9 offset:57344
    v_smfmac_f32_16x16x64_bf16 v[32:35], a[248:251], a[144:151], v20
    ds_read_b64_tr_b16 a[238:239], v9 offset:59392
    v_smfmac_f32_16x16x64_bf16 v[36:39], a[248:251], v[120:127], v20
    v_smfmac_f32_16x16x64_bf16 v[24:27], a[248:251], v[128:135], v20
    v_smfmac_f32_16x16x64_bf16 v[28:31], a[248:251], v[136:143], v20
    v_smfmac_f32_16x16x64_bf16 v[32:35], a[248:251], v[144:151], v20
    buffer_load_dwordx4 v6, s[16:19], s39 offen lds
    v_smfmac_f32_16x16x64_bf16 v[36:39], a[248:251], v[152:159], v20
    s_add_u32 s38, s44, 0
    ds_read_b64_tr_b16 a[240:241], v8 offset:61440
    s_add_u32 s36, s44, 40960
    v_smfmac_f32_16x16x64_bf16 v[24:27], a[248:251], v[160:167], v20
    s_cmp_lt_u32 s3, 2
    s_cselect_b32 s38, s38, s36
    s_add_u32 m0, s63, 155648
    v_smfmac_f32_16x16x64_bf16 v[28:31], a[248:251], v[168:175], v20
    ds_read_b64_tr_b16 a[242:243], v8 offset:63488
    v_smfmac_f32_16x16x64_bf16 v[32:35], a[248:251], v[176:183], v20
    ds_read_b64_tr_b16 a[244:245], v9 offset:61440
    v_smfmac_f32_16x16x64_bf16 v[36:39], a[248:251], v[184:191], v20
    ds_read_b64_tr_b16 a[246:247], v9 offset:63488
    v_smfmac_f32_16x16x64_bf16 v[24:27], a[248:251], v[192:199], v20
    v_smfmac_f32_16x16x64_bf16 v[28:31], a[248:251], v[200:207], v20
    v_smfmac_f32_16x16x64_bf16 v[32:35], a[248:251], v[208:215], v20
    buffer_load_dwordx4 v7, s[8:11], s38 offen lds
    v_smfmac_f32_16x16x64_bf16 v[36:39], a[248:251], v[216:223], v20
    s_add_u32 s38, s44, 0
    ds_read_b64_tr_b16 a[184:185], v10 offset:0
    v_smfmac_f32_16x16x64_bf16 v[24:27], a[248:251], v[224:231], v20
    s_addk_i32 m0, -16384
    ds_read_b64_tr_b16 a[186:187], v10 offset:2048
    v_smfmac_f32_16x16x64_bf16 v[28:31], a[248:251], v[232:239], v20
    ds_read_b64_tr_b16 a[188:189], v10 offset:4096
    v_smfmac_f32_16x16x64_bf16 v[32:35], a[248:251], v[240:247], v20
    s_waitcnt lgkmcnt(3)
    ds_read_b64_tr_b16 a[190:191], v10 offset:6144
    v_smfmac_f32_16x16x64_bf16 v[36:39], a[248:251], v[248:255], v20
    v_smfmac_f32_16x16x64_bf16 v[24:27], a[248:251], v[56:63], v20
    v_smfmac_f32_16x16x64_bf16 v[28:31], a[248:251], v[64:71], v20
    v_smfmac_f32_16x16x64_bf16 v[32:35], a[248:251], v[72:79], v20
    buffer_load_dwordx4 v2, s[8:11], s38 offen lds
    v_smfmac_f32_16x16x64_bf16 v[36:39], a[248:251], v[80:87], v20
    s_add_u32 s38, s44, 0
    ds_read_b64_tr_b16 a[192:193], v10 offset:8192
    v_smfmac_f32_16x16x64_bf16 v[24:27], a[248:251], v[88:95], v20
    s_addk_i32 m0, 4096
    ds_read_b64_tr_b16 a[194:195], v10 offset:10240
    v_smfmac_f32_16x16x64_bf16 v[28:31], a[248:251], v[96:103], v20
    ds_read_b64_tr_b16 a[196:197], v10 offset:12288
    v_exp_f32 v48, v48
    v_exp_f32 v49, v49
    v_exp_f32 v50, v50
    v_exp_f32 v51, v51
    v_cvt_pk_bf16_f32 v110, v48, v49
    v_cvt_pk_bf16_f32 v111, v50, v51
    s_nop 1
    v_smfmac_f32_16x16x64_bf16 v[32:35], a[248:251], v[104:111], v20
    ds_read_b64_tr_b16 a[198:199], v10 offset:14336
    v_add_f32 v24, v24, v25
    v_exp_f32 v52, v52
    v_exp_f32 v53, v53
    v_exp_f32 v54, v54
    v_exp_f32 v55, v55
    v_cvt_pk_bf16_f32 v118, v52, v53
    v_cvt_pk_bf16_f32 v119, v54, v55
    s_nop 1
    v_smfmac_f32_16x16x64_bf16 v[36:39], a[248:251], v[112:119], v20
    v_add_f32 v28, v28, v29
    v_mfma_f32_16x16x32_bf16 a[152:155], a[232:235], v[88:91], a[152:155]
    v_rcp_f32 v16, v24
    v_mfma_f32_16x16x32_bf16 a[168:171], a[236:239], v[88:91], a[168:171]
    v_rcp_f32 v17, v28
    v_mfma_f32_16x16x32_bf16 a[172:175], a[236:239], v[96:99], a[172:175]
    buffer_load_dwordx4 v3, s[8:11], s38 offen lds
    v_mfma_f32_16x16x32_bf16 a[156:159], a[232:235], v[96:99], a[156:159]
    s_add_u32 s38, s44, 40960
    ds_read_b64_tr_b16 a[200:201], v10 offset:16384
    v_add_f32 v32, v32, v33
    v_mfma_f32_16x16x32_bf16 a[160:163], a[232:235], v[104:107], a[160:163]
    s_addk_i32 m0, 4096
    ds_read_b64_tr_b16 a[202:203], v10 offset:18432
    v_add_f32 v36, v36, v37
    v_mfma_f32_16x16x32_bf16 a[176:179], a[236:239], v[104:107], a[176:179]
    ds_read_b64_tr_b16 a[204:205], v10 offset:20480
    v_max3_f32 v21, v24, v28, v32
    v_mfma_f32_16x16x32_bf16 a[180:183], a[236:239], v[112:115], a[180:183]
    s_waitcnt lgkmcnt(3)
    ds_read_b64_tr_b16 a[206:207], v10 offset:22528
    v_max3_f32 v21, v21, v36, v16
    v_mfma_f32_16x16x32_bf16 a[164:167], a[232:235], v[112:115], a[164:167]
    v_rcp_f32 v18, v32
    v_mfma_f32_16x16x32_bf16 a[164:167], a[240:243], v[116:119], a[164:167]
    v_rcp_f32 v19, v36
    v_mfma_f32_16x16x32_bf16 a[180:183], a[244:247], v[116:119], a[180:183]
    v_max3_f32 v21, v21, v17, v18
    v_max_f32 v21, v21, v19
    v_mfma_f32_16x16x32_bf16 a[176:179], a[244:247], v[108:111], a[176:179]
    buffer_load_dwordx4 v2, s[8:11], s38 offen lds
    v_mfma_f32_16x16x32_bf16 a[160:163], a[240:243], v[108:111], a[160:163]
    s_add_u32 s38, s44, 40960
    ds_read_b64_tr_b16 a[208:209], v10 offset:24576
    v_cmp_nge_f32 vcc, 0x5f800000, v21
    v_mfma_f32_16x16x32_bf16 a[156:159], a[240:243], v[100:103], a[156:159]
    s_addk_i32 m0, 4096
    ds_read_b64_tr_b16 a[210:211], v10 offset:26624
    v_mfma_f32_16x16x32_bf16 a[172:175], a[244:247], v[100:103], a[172:175]
    ds_read_b64_tr_b16 a[212:213], v10 offset:28672
    v_mfma_f32_16x16x32_bf16 a[168:171], a[244:247], v[92:95], a[168:171]
    ds_read_b64_tr_b16 a[214:215], v10 offset:30720
    v_mfma_f32_16x16x32_bf16 a[152:155], a[240:243], v[92:95], a[152:155]
    s_cbranch_vccnz rare
rare_ret:
    v_mfma_f32_16x16x32_bf16 v[40:43], a[184:187], a[96:99], 0
    v_subrev_u32 v8, 73728, v8
    v_subrev_u32 v9, 73728, v9
    v_mfma_f32_16x16x32_bf16 v[40:43], a[188:191], a[100:103], v[40:43]
    v_mfma_f32_16x16x32_bf16 v[44:47], a[188:191], a[108:111], 0
    s_barrier
    v_mfma_f32_16x16x32_bf16 v[44:47], a[184:187], a[104:107], v[44:47]
    buffer_load_dwordx4 v3, s[8:11], s38 offen lds
    v_mfma_f32_16x16x32_bf16 v[48:51], a[184:187], a[112:115], 0
    v_accvgpr_read_b32 v21, a152
    v_accvgpr_read_b32 v22, a153
    v_mfma_f32_16x16x32_bf16 v[48:51], a[188:191], a[116:119], v[48:51]
    v_accvgpr_read_b32 v23, a154
    v_accvgpr_read_b32 v5, a155
    v_mfma_f32_16x16x32_bf16 v[52:55], a[188:191], a[124:127], 0
    v_mul_f32 v21, v16, v21
    v_mul_f32 v22, v16, v22
    v_mfma_f32_16x16x32_bf16 v[52:55], a[184:187], a[120:123], v[52:55]
    ds_read_b64_tr_b16 a[184:185], v10 offset:32768
    v_mul_f32 v23, v16, v23
    v_mfma_f32_16x16x32_bf16 v[52:55], a[192:195], v[120:123], v[52:55]
    ds_read_b64_tr_b16 a[186:187], v10 offset:34816
    v_mul_f32 v5, v16, v5
    v_mfma_f32_16x16x32_bf16 v[52:55], a[196:199], v[124:127], v[52:55]
    ds_read_b64_tr_b16 a[188:189], v10 offset:36864
    v_cvt_pk_bf16_f32 v21, v21, v22
    v_mfma_f32_16x16x32_bf16 v[48:51], a[196:199], a[148:151], v[48:51]
    s_waitcnt lgkmcnt(3)
    ds_read_b64_tr_b16 a[190:191], v10 offset:38912
    v_cvt_pk_bf16_f32 v22, v23, v5
    v_mfma_f32_16x16x32_bf16 v[48:51], a[192:195], a[144:147], v[48:51]
    v_accvgpr_write_b32 a0, v21
    v_accvgpr_write_b32 a1, v22
    v_mfma_f32_16x16x32_bf16 v[44:47], a[192:195], a[136:139], v[44:47]
    v_accvgpr_read_b32 v21, a168
    v_accvgpr_read_b32 v22, a169
    v_mfma_f32_16x16x32_bf16 v[44:47], a[196:199], a[140:143], v[44:47]
    v_accvgpr_read_b32 v23, a170
    v_accvgpr_read_b32 v5, a171
    v_mfma_f32_16x16x32_bf16 v[40:43], a[196:199], a[132:135], v[40:43]
    v_mul_f32 v21, v16, v21
    v_mul_f32 v22, v16, v22
    v_mfma_f32_16x16x32_bf16 v[40:43], a[192:195], a[128:131], v[40:43]
    ds_read_b64_tr_b16 a[192:193], v10 offset:40960
    v_mul_f32 v23, v16, v23
    v_mfma_f32_16x16x32_bf16 v[40:43], a[200:203], v[128:131], v[40:43]
    ds_read_b64_tr_b16 a[194:195], v10 offset:43008
    v_mul_f32 v5, v16, v5
    v_mfma_f32_16x16x32_bf16 v[40:43], a[204:207], v[132:135], v[40:43]
    ds_read_b64_tr_b16 a[196:197], v10 offset:45056
    v_cvt_pk_bf16_f32 v21, v21, v22
    v_mfma_f32_16x16x32_bf16 v[44:47], a[204:207], v[140:143], v[44:47]
    ds_read_b64_tr_b16 a[198:199], v10 offset:47104
    v_cvt_pk_bf16_f32 v22, v23, v5
    v_mfma_f32_16x16x32_bf16 v[44:47], a[200:203], v[136:139], v[44:47]
    v_accvgpr_write_b32 a2, v21
    v_accvgpr_write_b32 a3, v22
    v_mfma_f32_16x16x32_bf16 v[48:51], a[200:203], v[144:147], v[48:51]
    buffer_store_dwordx4 a[0:3], v14, s[20:23], s55 offen offset:0 sc1
    v_accvgpr_read_b32 v21, a156
    v_mfma_f32_16x16x32_bf16 v[48:51], a[204:207], v[148:151], v[48:51]
    v_accvgpr_read_b32 v22, a157
    v_accvgpr_read_b32 v23, a158
    v_mfma_f32_16x16x32_bf16 v[52:55], a[204:207], v[156:159], v[52:55]
    v_accvgpr_read_b32 v5, a159
    v_mul_f32 v21, v17, v21
    v_mfma_f32_16x16x32_bf16 v[52:55], a[200:203], v[152:155], v[52:55]
    ds_read_b64_tr_b16 a[200:201], v10 offset:49152
    v_mul_f32 v22, v17, v22
    v_mfma_f32_16x16x32_bf16 v[52:55], a[208:211], v[184:187], v[52:55]
    ds_read_b64_tr_b16 a[202:203], v10 offset:51200
    v_mul_f32 v23, v17, v23
    v_mfma_f32_16x16x32_bf16 v[52:55], a[212:215], v[188:191], v[52:55]
    ds_read_b64_tr_b16 a[204:205], v10 offset:53248
    v_mul_f32 v5, v17, v5
    v_mfma_f32_16x16x32_bf16 v[48:51], a[212:215], v[180:183], v[48:51]
    s_waitcnt lgkmcnt(3)
    ds_read_b64_tr_b16 a[206:207], v10 offset:55296
    v_cvt_pk_bf16_f32 v21, v21, v22
    v_mfma_f32_16x16x32_bf16 v[48:51], a[208:211], v[176:179], v[48:51]
    v_cvt_pk_bf16_f32 v22, v23, v5
    v_accvgpr_write_b32 a4, v21
    v_mfma_f32_16x16x32_bf16 v[44:47], a[208:211], v[168:171], v[44:47]
    v_accvgpr_write_b32 a5, v22
    v_accvgpr_read_b32 v21, a172
    v_mfma_f32_16x16x32_bf16 v[44:47], a[212:215], v[172:175], v[44:47]
    v_accvgpr_read_b32 v22, a173
    v_accvgpr_read_b32 v23, a174
    v_mfma_f32_16x16x32_bf16 v[40:43], a[212:215], v[164:167], v[40:43]
    v_accvgpr_read_b32 v5, a175
    v_mul_f32 v21, v17, v21
    v_mfma_f32_16x16x32_bf16 v[40:43], a[208:211], v[160:163], v[40:43]
    ds_read_b64_tr_b16 a[208:209], v10 offset:57344
    v_mul_f32 v22, v17, v22
    v_mfma_f32_16x16x32_bf16 v[40:43], a[184:187], v[192:195], v[40:43]
    ds_read_b64_tr_b16 a[210:211], v10 offset:59392
    v_mul_f32 v23, v17, v23
    v_mfma_f32_16x16x32_bf16 v[40:43], a[188:191], v[196:199], v[40:43]
    ds_read_b64_tr_b16 a[212:213], v10 offset:61440
    v_mul_f32 v5, v17, v5
    v_mfma_f32_16x16x32_bf16 v[44:47], a[188:191], v[204:207], v[44:47]
    ds_read_b64_tr_b16 a[214:215], v10 offset:63488
    v_subrev_u32 v10, 73728, v10
    v_mfma_f32_16x16x32_bf16 v[44:47], a[184:187], v[200:203], v[44:47]
    v_cvt_pk_bf16_f32 v21, v21, v22
    v_cvt_pk_bf16_f32 v22, v23, v5
    v_mfma_f32_16x16x32_bf16 v[48:51], a[184:187], v[208:211], v[48:51]
    v_accvgpr_write_b32 a6, v21
    v_accvgpr_write_b32 a7, v22
    v_mfma_f32_16x16x32_bf16 v[48:51], a[188:191], v[212:215], v[48:51]
    buffer_store_dwordx4 a[4:7], v14, s[20:23], s55 offen offset:1024 sc1
    v_accvgpr_read_b32 v21, a160
    v_mfma_f32_16x16x32_bf16 v[52:55], a[188:191], v[220:223], v[52:55]
    v_accvgpr_read_b32 v22, a161
    v_accvgpr_read_b32 v23, a162
    v_mfma_f32_16x16x32_bf16 v[52:55], a[184:187], v[216:219], v[52:55]
    ds_read_b64_tr_b16 a[184:185], v11 offset:0
    v_accvgpr_read_b32 v5, a163
    v_mfma_f32_16x16x32_bf16 v[52:55], a[192:195], v[248:251], v[52:55]
    ds_read_b64_tr_b16 a[186:187], v11 offset:2048
    v_mul_f32 v21, v18, v21
    v_mfma_f32_16x16x32_bf16 v[52:55], a[196:199], v[252:255], v[52:55]
    ds_read_b64_tr_b16 a[188:189], v11 offset:4096
    v_mul_f32 v22, v18, v22
    v_mfma_f32_16x16x32_bf16 v[48:51], a[196:199], v[244:247], v[48:51]
    s_waitcnt lgkmcnt(3)
    ds_read_b64_tr_b16 a[190:191], v11 offset:6144
    v_mul_f32 v23, v18, v23
    v_mfma_f32_16x16x32_bf16 v[48:51], a[192:195], v[240:243], v[48:51]
    v_mul_f32 v5, v18, v5
    v_cvt_pk_bf16_f32 v21, v21, v22
    v_mfma_f32_16x16x32_bf16 v[44:47], a[192:195], v[232:235], v[44:47]
    v_cvt_pk_bf16_f32 v22, v23, v5
    v_accvgpr_write_b32 a8, v21
    v_mfma_f32_16x16x32_bf16 v[44:47], a[196:199], v[236:239], v[44:47]
    v_accvgpr_write_b32 a9, v22
    v_accvgpr_read_b32 v21, a176
    v_mfma_f32_16x16x32_bf16 v[40:43], a[196:199], v[228:231], v[40:43]
    v_accvgpr_read_b32 v22, a177
    v_accvgpr_read_b32 v23, a178
    v_mfma_f32_16x16x32_bf16 v[40:43], a[192:195], v[224:227], v[40:43]
    ds_read_b64_tr_b16 a[192:193], v11 offset:8192
    v_accvgpr_read_b32 v5, a179
    v_mfma_f32_16x16x32_bf16 v[40:43], a[200:203], v[56:59], v[40:43]
    ds_read_b64_tr_b16 a[194:195], v11 offset:10240
    v_mul_f32 v21, v18, v21
    v_mfma_f32_16x16x32_bf16 v[40:43], a[204:207], v[60:63], v[40:43]
    ds_read_b64_tr_b16 a[196:197], v11 offset:12288
    v_mul_f32 v22, v18, v22
    v_mfma_f32_16x16x32_bf16 v[44:47], a[204:207], v[68:71], v[44:47]
    ds_read_b64_tr_b16 a[198:199], v11 offset:14336
    v_mul_f32 v23, v18, v23
    v_mfma_f32_16x16x32_bf16 v[44:47], a[200:203], v[64:67], v[44:47]
    v_mul_f32 v5, v18, v5
    v_cvt_pk_bf16_f32 v21, v21, v22
    v_mfma_f32_16x16x32_bf16 v[48:51], a[200:203], v[72:75], v[48:51]
    v_cvt_pk_bf16_f32 v22, v23, v5
    v_accvgpr_write_b32 a10, v21
    v_mfma_f32_16x16x32_bf16 v[48:51], a[204:207], v[76:79], v[48:51]
    v_accvgpr_write_b32 a11, v22
    v_accvgpr_read_b32 v21, a164
    v_mfma_f32_16x16x32_bf16 v[52:55], a[204:207], v[84:87], v[52:55]
    buffer_store_dwordx4 a[8:11], v14, s[20:23], s55 offen offset:2048 sc1
    v_accvgpr_read_b32 v22, a165
    v_mfma_f32_16x16x32_bf16 v[52:55], a[200:203], v[80:83], v[52:55]
    ds_read_b64_tr_b16 a[200:201], v11 offset:16384
    v_accvgpr_read_b32 v23, a166
    v_mfma_f32_16x16x32_bf16 v[52:55], a[208:211], v[112:115], v[52:55]
    ds_read_b64_tr_b16 a[202:203], v11 offset:18432
    v_accvgpr_read_b32 v5, a167
    v_mfma_f32_16x16x32_bf16 v[52:55], a[212:215], v[116:119], v[52:55]
    ds_read_b64_tr_b16 a[204:205], v11 offset:20480
    v_mul_f32 v21, v19, v21
    v_mfma_f32_16x16x32_bf16 v[48:51], a[212:215], v[108:111], v[48:51]
    s_waitcnt lgkmcnt(3)
    ds_read_b64_tr_b16 a[206:207], v11 offset:22528
    v_mul_f32 v22, v19, v22
    v_mfma_f32_16x16x32_bf16 v[48:51], a[208:211], v[104:107], v[48:51]
    v_mul_f32 v23, v19, v23
    v_mul_f32 v5, v19, v5
    v_mfma_f32_16x16x32_bf16 v[44:47], a[208:211], v[96:99], v[44:47]
    v_cvt_pk_bf16_f32 v21, v21, v22
    v_cvt_pk_bf16_f32 v22, v23, v5
    v_mfma_f32_16x16x32_bf16 v[44:47], a[212:215], v[100:103], v[44:47]
    v_accvgpr_write_b32 a12, v21
    v_accvgpr_write_b32 a13, v22
    v_mfma_f32_16x16x32_bf16 v[40:43], a[212:215], v[92:95], v[40:43]
    v_accvgpr_read_b32 v21, a180
    v_accvgpr_read_b32 v22, a181
    v_mfma_f32_16x16x32_bf16 v[40:43], a[208:211], v[88:91], v[40:43]
    ds_read_b64_tr_b16 a[208:209], v11 offset:24576
    v_accvgpr_read_b32 v23, a182
    v_mfma_f32_16x16x32_bf16 v[24:27], a[184:187], a[96:99], 0
    ds_read_b64_tr_b16 a[210:211], v11 offset:26624
    v_accvgpr_read_b32 v5, a183
    v_mfma_f32_16x16x32_bf16 v[24:27], a[188:191], a[100:103], v[24:27]
    ds_read_b64_tr_b16 a[212:213], v11 offset:28672
    v_mul_f32 v21, v19, v21
    v_mfma_f32_16x16x32_bf16 v[28:31], a[188:191], a[108:111], 0
    ds_read_b64_tr_b16 a[214:215], v11 offset:30720
    v_mul_f32 v22, v19, v22
    v_mfma_f32_16x16x32_bf16 v[28:31], a[184:187], a[104:107], v[28:31]
    v_mul_f32 v23, v19, v23
    v_mul_f32 v5, v19, v5
    v_mfma_f32_16x16x32_bf16 v[32:35], a[184:187], a[112:115], 0
pg_9:
    s_cbranch_execz pg_13
    v_cvt_pk_bf16_f32 v21, v21, v22
    v_cvt_pk_bf16_f32 v22, v23, v5
    v_mfma_f32_16x16x32_bf16 v[32:35], a[188:191], a[116:119], v[32:35]
    v_accvgpr_write_b32 a14, v21
    v_accvgpr_write_b32 a15, v22
    v_mfma_f32_16x16x32_bf16 v[36:39], a[188:191], a[124:127], 0
    buffer_store_dwordx4 a[12:15], v14, s[20:23], s55 offen offset:3072 sc1
    v_mul_f32 v40, v16, v40
    v_mfma_f32_16x16x32_bf16 v[36:39], a[184:187], a[120:123], v[36:39]
    s_add_u32 s55, s55, 4096
    ds_read_b64_tr_b16 a[184:185], v11 offset:32768
    v_mul_f32 v41, v16, v41
    v_mfma_f32_16x16x32_bf16 v[36:39], a[192:195], v[120:123], v[36:39]
    ds_read_b64_tr_b16 a[186:187], v11 offset:34816
    v_mul_f32 v42, v16, v42
    v_mfma_f32_16x16x32_bf16 v[36:39], a[196:199], v[124:127], v[36:39]
    ds_read_b64_tr_b16 a[188:189], v11 offset:36864
    v_mul_f32 v43, v16, v43
    v_mfma_f32_16x16x32_bf16 v[32:35], a[196:199], a[148:151], v[32:35]
    s_waitcnt lgkmcnt(3)
    ds_read_b64_tr_b16 a[190:191], v11 offset:38912
    v_cvt_pk_bf16_f32 v40, v40, v41
    v_mfma_f32_16x16x32_bf16 v[32:35], a[192:195], a[144:147], v[32:35]
    v_cvt_pk_bf16_f32 v41, v42, v43
    v_accvgpr_write_b32 a16, v40
    v_mfma_f32_16x16x32_bf16 v[28:31], a[192:195], a[136:139], v[28:31]
    v_accvgpr_write_b32 a17, v41
    v_mul_f32 v44, v17, v44
    v_mfma_f32_16x16x32_bf16 v[28:31], a[196:199], a[140:143], v[28:31]
    v_mul_f32 v45, v17, v45
    v_mul_f32 v46, v17, v46
    v_mfma_f32_16x16x32_bf16 v[24:27], a[196:199], a[132:135], v[24:27]
    v_mul_f32 v47, v17, v47
    v_cvt_pk_bf16_f32 v44, v44, v45
    v_mfma_f32_16x16x32_bf16 v[24:27], a[192:195], a[128:131], v[24:27]
    ds_read_b64_tr_b16 a[192:193], v11 offset:40960
    v_cvt_pk_bf16_f32 v45, v46, v47
    v_mfma_f32_16x16x32_bf16 v[24:27], a[200:203], v[128:131], v[24:27]
    ds_read_b64_tr_b16 a[194:195], v11 offset:43008
    v_accvgpr_write_b32 a20, v44
    v_mfma_f32_16x16x32_bf16 v[24:27], a[204:207], v[132:135], v[24:27]
    ds_read_b64_tr_b16 a[196:197], v11 offset:45056
    v_accvgpr_write_b32 a21, v45
    v_mfma_f32_16x16x32_bf16 v[28:31], a[204:207], v[140:143], v[28:31]
    ds_read_b64_tr_b16 a[198:199], v11 offset:47104
    v_mul_f32 v48, v18, v48
    v_mfma_f32_16x16x32_bf16 v[28:31], a[200:203], v[136:139], v[28:31]
    v_mul_f32 v49, v18, v49
    v_mul_f32 v50, v18, v50
    v_mfma_f32_16x16x32_bf16 v[32:35], a[200:203], v[144:147], v[32:35]
    v_mul_f32 v51, v18, v51
    v_cvt_pk_bf16_f32 v48, v48, v49
    v_mfma_f32_16x16x32_bf16 v[32:35], a[204:207], v[148:151], v[32:35]
    v_cvt_pk_bf16_f32 v49, v50, v51
    v_accvgpr_write_b32 a24, v48
    v_mfma_f32_16x16x32_bf16 v[36:39], a[204:207], v[156:159], v[36:39]
    v_accvgpr_write_b32 a25, v49
    v_mul_f32 v52, v19, v52
    v_mfma_f32_16x16x32_bf16 v[36:39], a[200:203], v[152:155], v[36:39]
    ds_read_b64_tr_b16 a[200:201], v11 offset:49152
    v_mul_f32 v53, v19, v53
    v_mfma_f32_16x16x32_bf16 v[36:39], a[208:211], v[184:187], v[36:39]
    ds_read_b64_tr_b16 a[202:203], v11 offset:51200
    v_mul_f32 v54, v19, v54
    v_mfma_f32_16x16x32_bf16 v[36:39], a[212:215], v[188:191], v[36:39]
    ds_read_b64_tr_b16 a[204:205], v11 offset:53248
    v_mul_f32 v55, v19, v55
    v_mfma_f32_16x16x32_bf16 v[32:35], a[212:215], v[180:183], v[32:35]
    s_waitcnt lgkmcnt(3)
    ds_read_b64_tr_b16 a[206:207], v11 offset:55296
    v_cvt_pk_bf16_f32 v52, v52, v53
    v_mfma_f32_16x16x32_bf16 v[32:35], a[208:211], v[176:179], v[32:35]
    v_cvt_pk_bf16_f32 v53, v54, v55
    v_accvgpr_write_b32 a28, v52
    v_mfma_f32_16x16x32_bf16 v[28:31], a[208:211], v[168:171], v[28:31]
    v_accvgpr_write_b32 a29, v53
    v_mfma_f32_16x16x32_bf16 v[28:31], a[212:215], v[172:175], v[28:31]
    v_mfma_f32_16x16x32_bf16 v[24:27], a[212:215], v[164:167], v[24:27]
    v_mfma_f32_16x16x32_bf16 v[24:27], a[208:211], v[160:163], v[24:27]
    ds_read_b64_tr_b16 a[208:209], v11 offset:57344
    v_mfma_f32_16x16x32_bf16 v[24:27], a[184:187], v[192:195], v[24:27]
    ds_read_b64_tr_b16 a[210:211], v11 offset:59392
    v_mfma_f32_16x16x32_bf16 v[24:27], a[188:191], v[196:199], v[24:27]
    ds_read_b64_tr_b16 a[212:213], v11 offset:61440
    v_mfma_f32_16x16x32_bf16 v[28:31], a[188:191], v[204:207], v[28:31]
    ds_read_b64_tr_b16 a[214:215], v11 offset:63488
    v_subrev_u32 v11, 73728, v11
    v_mfma_f32_16x16x32_bf16 v[28:31], a[184:187], v[200:203], v[28:31]
    s_add_u32 s39, s40, 256
    v_mfma_f32_16x16x32_bf16 v[32:35], a[184:187], v[208:211], v[32:35]
    v_mfma_f32_16x16x32_bf16 v[32:35], a[188:191], v[212:215], v[32:35]
    s_add_u32 m0, s63, 73728
    v_mfma_f32_16x16x32_bf16 v[36:39], a[188:191], v[220:223], v[36:39]
    v_mfma_f32_16x16x32_bf16 v[36:39], a[184:187], v[216:219], v[36:39]
    v_mfma_f32_16x16x32_bf16 v[36:39], a[192:195], v[248:251], v[36:39]
    v_mfma_f32_16x16x32_bf16 v[36:39], a[196:199], v[252:255], v[36:39]
    s_waitcnt vmcnt(17) lgkmcnt(0)
    v_mfma_f32_16x16x32_bf16 v[32:35], a[196:199], v[244:247], v[32:35]
    s_barrier
    v_mfma_f32_16x16x32_bf16 v[32:35], a[192:195], v[240:243], v[32:35]
    buffer_load_dwordx4 v6, s[16:19], s39 offen lds
    v_mfma_f32_16x16x32_bf16 v[28:31], a[192:195], v[232:235], v[28:31]
    s_add_u32 s39, s40, 12544
    ds_read_b64_tr_b16 a[184:185], v8 offset:49152
    v_mfma_f32_16x16x32_bf16 v[28:31], a[196:199], v[236:239], v[28:31]
    ds_read_b64_tr_b16 a[186:187], v8 offset:51200
    v_mfma_f32_16x16x32_bf16 v[24:27], a[196:199], v[228:231], v[24:27]
    s_addk_i32 m0, 4096
    ds_read_b64_tr_b16 a[188:189], v8 offset:53248
    v_mfma_f32_16x16x32_bf16 v[24:27], a[192:195], v[224:227], v[24:27]
    ds_read_b64_tr_b16 a[190:191], v8 offset:55296
    v_mfma_f32_16x16x32_bf16 v[24:27], a[200:203], v[56:59], v[24:27]
    ds_read_b64_tr_b16 a[192:193], v8 offset:57344
    v_mfma_f32_16x16x32_bf16 v[24:27], a[204:207], v[60:63], v[24:27]
    ds_read_b64_tr_b16 a[194:195], v8 offset:59392
    v_mfma_f32_16x16x32_bf16 v[28:31], a[204:207], v[68:71], v[28:31]
    ds_read_b64_tr_b16 a[196:197], v8 offset:61440
    v_mfma_f32_16x16x32_bf16 v[28:31], a[200:203], v[64:67], v[28:31]
    ds_read_b64_tr_b16 a[198:199], v8 offset:63488
    v_mfma_f32_16x16x32_bf16 v[32:35], a[200:203], v[72:75], v[32:35]
    buffer_load_dwordx4 v6, s[16:19], s39 offen lds
    v_mfma_f32_16x16x32_bf16 v[32:35], a[204:207], v[76:79], v[32:35]
    s_add_u32 s39, s40, 24832
    v_mfma_f32_16x16x32_bf16 v[36:39], a[204:207], v[84:87], v[36:39]
    v_mfma_f32_16x16x32_bf16 v[36:39], a[200:203], v[80:83], v[36:39]
    s_addk_i32 m0, 4096
    ds_read_b64_tr_b16 a[200:201], v8 offset:0
    v_mfma_f32_16x16x32_bf16 v[36:39], a[208:211], v[112:115], v[36:39]
    ds_read_b64_tr_b16 a[202:203], v8 offset:2048
    v_mfma_f32_16x16x32_bf16 v[36:39], a[212:215], v[116:119], v[36:39]
    ds_read_b64_tr_b16 a[204:205], v8 offset:4096
    v_mfma_f32_16x16x32_bf16 v[32:35], a[212:215], v[108:111], v[32:35]
    s_waitcnt lgkmcnt(3)
    ds_read_b64_tr_b16 a[206:207], v8 offset:6144
    v_mfma_f32_16x16x32_bf16 v[32:35], a[208:211], v[104:107], v[32:35]
    v_mfma_f32_16x16x32_bf16 v[28:31], a[208:211], v[96:99], v[28:31]
    v_mfma_f32_16x16x32_bf16 v[28:31], a[212:215], v[100:103], v[28:31]
    buffer_load_dwordx4 v6, s[16:19], s39 offen lds
    v_mfma_f32_16x16x32_bf16 v[24:27], a[212:215], v[92:95], v[24:27]
    s_add_u32 s39, s40, 37120
    v_mul_f32 v36, v19, v36
    v_mfma_f32_16x16x32_bf16 v[24:27], a[208:211], v[88:91], v[24:27]
    ds_read_b64_tr_b16 a[208:209], v8 offset:8192
    v_mul_f32 v32, v18, v32
    v_mfma_f32_16x16x32_bf16 v[40:43], a[184:187], a[96:99], 0
    s_addk_i32 m0, 4096
    ds_read_b64_tr_b16 a[210:211], v8 offset:10240
    v_mul_f32 v28, v17, v28
    v_mfma_f32_16x16x32_bf16 v[40:43], a[188:191], a[100:103], v[40:43]
    ds_read_b64_tr_b16 a[212:213], v8 offset:12288
    v_mul_f32 v24, v16, v24
    v_mfma_f32_16x16x32_bf16 v[44:47], a[188:191], a[108:111], 0
    s_waitcnt vmcnt(3)
    ds_read_b64_tr_b16 a[214:215], v8 offset:14336
    v_mul_f32 v25, v16, v25
    v_mfma_f32_16x16x32_bf16 v[44:47], a[184:187], a[104:107], v[44:47]
    buffer_store_dword v4, v15, s[24:27], s76 offen sc1
    v_mfma_f32_16x16x32_bf16 v[48:51], a[184:187], a[112:115], 0
    v_mov_b32 v4, s56
    v_mul_f32 v26, v16, v26
    v_mfma_f32_16x16x32_bf16 v[48:51], a[188:191], a[116:119], v[48:51]
    s_add_u32 s56, s7, 3
    v_mul_f32 v27, v16, v27
    v_cvt_pk_bf16_f32 v24, v24, v25
    v_mfma_f32_16x16x32_bf16 v[52:55], a[188:191], a[124:127], 0
    buffer_load_dwordx4 v6, s[16:19], s39 offen lds
    v_mfma_f32_16x16x32_bf16 v[52:55], a[184:187], a[120:123], v[52:55]
    s_add_u32 s39, s40, 49408
    v_cvt_pk_bf16_f32 v25, v26, v27
    v_accvgpr_write_b32 a18, v24
    v_mfma_f32_16x16x32_bf16 v[52:55], a[192:195], v[120:123], v[52:55]
    v_accvgpr_write_b32 a19, v25
    v_mul_f32 v29, v17, v29
    v_mfma_f32_16x16x32_bf16 v[52:55], a[196:199], v[124:127], v[52:55]
    buffer_store_dwordx4 a[16:19], v14, s[20:23], s55 offen offset:0 sc1
    v_mul_f32 v30, v17, v30
    v_mfma_f32_16x16x32_bf16 v[48:51], a[196:199], a[148:151], v[48:51]
    s_addk_i32 m0, 4096
    v_mul_f32 v31, v17, v31
    v_cvt_pk_bf16_f32 v28, v28, v29
    v_mfma_f32_16x16x32_bf16 v[48:51], a[192:195], a[144:147], v[48:51]
    v_cvt_pk_bf16_f32 v29, v30, v31
    v_accvgpr_write_b32 a22, v28
    v_mfma_f32_16x16x32_bf16 v[44:47], a[192:195], a[136:139], v[44:47]
    v_accvgpr_write_b32 a23, v29
    v_mfma_f32_16x16x32_bf16 v[44:47], a[196:199], a[140:143], v[44:47]
    buffer_store_dwordx4 a[20:23], v14, s[20:23], s55 offen offset:1024 sc1
    v_mul_f32 v33, v18, v33
    v_mfma_f32_16x16x32_bf16 v[40:43], a[196:199], a[132:135], v[40:43]
    s_waitcnt lgkmcnt(0)
    v_mul_f32 v34, v18, v34
    v_mul_f32 v35, v18, v35
    v_mfma_f32_16x16x32_bf16 v[40:43], a[192:195], a[128:131], v[40:43]
    buffer_load_dwordx4 v6, s[16:19], s39 offen lds
    v_mfma_f32_16x16x32_bf16 v[40:43], a[200:203], v[128:131], v[40:43]
    s_add_u32 s39, s40, 61696
    v_cvt_pk_bf16_f32 v32, v32, v33
    v_cvt_pk_bf16_f32 v33, v34, v35
    v_mfma_f32_16x16x32_bf16 v[40:43], a[204:207], v[132:135], v[40:43]
    v_accvgpr_write_b32 a26, v32
    v_accvgpr_write_b32 a27, v33
    v_mfma_f32_16x16x32_bf16 v[44:47], a[204:207], v[140:143], v[44:47]
    buffer_store_dwordx4 a[24:27], v14, s[20:23], s55 offen offset:2048 sc1
    v_mul_f32 v37, v19, v37
    v_mfma_f32_16x16x32_bf16 v[44:47], a[200:203], v[136:139], v[44:47]
    s_addk_i32 m0, 4096
    v_mul_f32 v38, v19, v38
    v_mfma_f32_16x16x32_bf16 v[48:51], a[200:203], v[144:147], v[48:51]
    s_barrier
    v_mfma_f32_16x16x32_bf16 v[48:51], a[204:207], v[148:151], v[48:51]
    ds_read_b64_tr_b16 a[184:185], v8 offset:16384
    v_mul_f32 v39, v19, v39
    v_mfma_f32_16x16x32_bf16 v[52:55], a[204:207], v[156:159], v[52:55]
    ds_read_b64_tr_b16 a[186:187], v8 offset:18432
    v_cvt_pk_bf16_f32 v36, v36, v37
    v_mfma_f32_16x16x32_bf16 v[52:55], a[200:203], v[152:155], v[52:55]
    ds_read_b64_tr_b16 a[188:189], v8 offset:20480
    v_cvt_pk_bf16_f32 v37, v38, v39
    v_mfma_f32_16x16x32_bf16 v[52:55], a[208:211], v[184:187], v[52:55]
    buffer_load_dwordx4 v6, s[16:19], s39 offen lds
    v_mfma_f32_16x16x32_bf16 v[52:55], a[212:215], v[188:191], v[52:55]
    s_add_u32 s39, s40, 73984
    ds_read_b64_tr_b16 a[190:191], v8 offset:22528
    v_accvgpr_write_b32 a30, v36
    v_mfma_f32_16x16x32_bf16 v[48:51], a[212:215], v[180:183], v[48:51]
    ds_read_b64_tr_b16 a[192:193], v8 offset:24576
    v_accvgpr_write_b32 a31, v37
    v_mfma_f32_16x16x32_bf16 v[48:51], a[208:211], v[176:179], v[48:51]
    buffer_store_dwordx4 a[28:31], v14, s[20:23], s55 offen offset:3072 sc1
    v_mfma_f32_16x16x32_bf16 v[44:47], a[208:211], v[168:171], v[44:47]
    s_addk_i32 m0, 4096
    ds_read_b64_tr_b16 a[194:195], v8 offset:26624
    s_add_u32 s55, s55, 4096
    v_mfma_f32_16x16x32_bf16 v[44:47], a[212:215], v[172:175], v[44:47]
    s_waitcnt lgkmcnt(4)
    ds_read_b64_tr_b16 a[196:197], v8 offset:28672
    v_mfma_f32_16x16x32_bf16 v[40:43], a[212:215], v[164:167], v[40:43]
    ds_read_b64_tr_b16 a[198:199], v8 offset:30720
    v_mfma_f32_16x16x32_bf16 v[40:43], a[208:211], v[160:163], v[40:43]
    ds_read_b64_tr_b16 a[200:201], v8 offset:32768
    v_mfma_f32_16x16x32_bf16 v[40:43], a[184:187], v[192:195], v[40:43]
    s_waitcnt lgkmcnt(5)
    ds_read_b64_tr_b16 a[202:203], v8 offset:34816
    v_mfma_f32_16x16x32_bf16 v[40:43], a[188:191], v[196:199], v[40:43]
    buffer_load_dwordx4 v6, s[16:19], s39 offen lds
    v_mfma_f32_16x16x32_bf16 v[44:47], a[188:191], v[204:207], v[44:47]
    s_add_u32 s39, s40, 86272
    ds_read_b64_tr_b16 a[204:205], v8 offset:36864
    v_mfma_f32_16x16x32_bf16 v[44:47], a[184:187], v[200:203], v[44:47]
    ds_read_b64_tr_b16 a[206:207], v8 offset:38912
    v_mfma_f32_16x16x32_bf16 v[48:51], a[184:187], v[208:211], v[48:51]
    s_addk_i32 m0, 4096
    ds_read_b64_tr_b16 a[208:209], v8 offset:40960
    v_mfma_f32_16x16x32_bf16 v[48:51], a[188:191], v[212:215], v[48:51]
    s_waitcnt lgkmcnt(5)
    ds_read_b64_tr_b16 a[210:211], v8 offset:43008
    v_mfma_f32_16x16x32_bf16 v[52:55], a[188:191], v[220:223], v[52:55]
    ds_read_b64_tr_b16 a[212:213], v8 offset:45056
    v_mfma_f32_16x16x32_bf16 v[52:55], a[184:187], v[216:219], v[52:55]
    ds_read_b64_tr_b16 a[214:215], v8 offset:47104
    v_add_u32 v8, 73728, v8
    v_mfma_f32_16x16x32_bf16 v[52:55], a[192:195], v[248:251], v[52:55]
    ds_read_b64_tr_b16 a[184:185], v9 offset:49152
    v_mfma_f32_16x16x32_bf16 v[52:55], a[196:199], v[252:255], v[52:55]
    ds_read_b64_tr_b16 a[186:187], v9 offset:51200
    v_mfma_f32_16x16x32_bf16 v[48:51], a[196:199], v[244:247], v[48:51]
    buffer_load_dwordx4 v6, s[16:19], s39 offen lds
    v_mfma_f32_16x16x32_bf16 v[48:51], a[192:195], v[240:243], v[48:51]
    s_add_u32 s39, s40, 98560
    ds_read_b64_tr_b16 a[188:189], v9 offset:53248
    v_mfma_f32_16x16x32_bf16 v[44:47], a[192:195], v[232:235], v[44:47]
    s_waitcnt lgkmcnt(5)
    ds_read_b64_tr_b16 a[190:191], v9 offset:55296
    v_mfma_f32_16x16x32_bf16 v[44:47], a[196:199], v[236:239], v[44:47]
    s_addk_i32 m0, 4096
    v_mfma_f32_16x16x32_bf16 v[40:43], a[196:199], v[228:231], v[40:43]
    v_mfma_f32_16x16x32_bf16 v[40:43], a[192:195], v[224:227], v[40:43]
    ds_read_b64_tr_b16 a[192:193], v9 offset:57344
    v_mfma_f32_16x16x32_bf16 v[40:43], a[200:203], v[56:59], v[40:43]
    ds_read_b64_tr_b16 a[194:195], v9 offset:59392
    v_mfma_f32_16x16x32_bf16 v[40:43], a[204:207], v[60:63], v[40:43]
    ds_read_b64_tr_b16 a[196:197], v9 offset:61440
    v_mfma_f32_16x16x32_bf16 v[44:47], a[204:207], v[68:71], v[44:47]
    ds_read_b64_tr_b16 a[198:199], v9 offset:63488
    v_mfma_f32_16x16x32_bf16 v[44:47], a[200:203], v[64:67], v[44:47]
    buffer_load_dwordx4 v6, s[16:19], s39 offen lds
    v_mfma_f32_16x16x32_bf16 v[48:51], a[200:203], v[72:75], v[48:51]
    s_add_u32 s39, s40, 110848
    v_mfma_f32_16x16x32_bf16 v[48:51], a[204:207], v[76:79], v[48:51]
    v_mfma_f32_16x16x32_bf16 v[52:55], a[204:207], v[84:87], v[52:55]
    s_waitcnt lgkmcnt(3)
    s_addk_i32 m0, 4096
    v_mfma_f32_16x16x32_bf16 v[52:55], a[200:203], v[80:83], v[52:55]
    ds_read_b64_tr_b16 a[200:201], v9 offset:0
    v_mfma_f32_16x16x32_bf16 v[52:55], a[208:211], v[112:115], v[52:55]
    ds_read_b64_tr_b16 a[202:203], v9 offset:2048
    v_mfma_f32_16x16x32_bf16 v[52:55], a[212:215], v[116:119], v[52:55]
    ds_read_b64_tr_b16 a[204:205], v9 offset:4096
    v_mfma_f32_16x16x32_bf16 v[48:51], a[212:215], v[108:111], v[48:51]
    ds_read_b64_tr_b16 a[206:207], v9 offset:6144
    v_mfma_f32_16x16x32_bf16 v[48:51], a[208:211], v[104:107], v[48:51]
    v_mfma_f32_16x16x32_bf16 v[44:47], a[208:211], v[96:99], v[44:47]
    buffer_load_dwordx4 v6, s[16:19], s39 offen lds
    v_mfma_f32_16x16x32_bf16 v[44:47], a[212:215], v[100:103], v[44:47]
    s_add_u32 s39, s40, 123136
    v_mul_f32 v52, v19, v52
    v_mfma_f32_16x16x32_bf16 v[40:43], a[212:215], v[92:95], v[40:43]
    v_mul_f32 v53, v19, v53
    v_mfma_f32_16x16x32_bf16 v[40:43], a[208:211], v[88:91], v[40:43]
    s_addk_i32 m0, 4096
    ds_read_b64_tr_b16 a[208:209], v9 offset:8192
    v_mul_f32 v48, v18, v48
    v_mfma_f32_16x16x32_bf16 v[24:27], a[184:187], a[96:99], 0
    ds_read_b64_tr_b16 a[210:211], v9 offset:10240
    v_mul_f32 v44, v17, v44
    v_mfma_f32_16x16x32_bf16 v[24:27], a[188:191], a[100:103], v[24:27]
    ds_read_b64_tr_b16 a[212:213], v9 offset:12288
    v_mul_f32 v40, v16, v40
    v_mfma_f32_16x16x32_bf16 v[28:31], a[188:191], a[108:111], 0
    ds_read_b64_tr_b16 a[214:215], v9 offset:14336
    v_mul_f32 v41, v16, v41
    v_mfma_f32_16x16x32_bf16 v[28:31], a[184:187], a[104:107], v[28:31]
    s_waitcnt lgkmcnt(4)
    v_mul_f32 v42, v16, v42
    v_mul_f32 v43, v16, v43
    v_mfma_f32_16x16x32_bf16 v[32:35], a[184:187], a[112:115], 0
    v_cvt_pk_bf16_f32 v40, v40, v41
    v_cvt_pk_bf16_f32 v41, v42, v43
    v_mfma_f32_16x16x32_bf16 v[32:35], a[188:191], a[116:119], v[32:35]
    buffer_load_dwordx4 v6, s[16:19], s39 offen lds
    v_mfma_f32_16x16x32_bf16 v[36:39], a[188:191], a[124:127], 0
    s_add_u32 s39, s40, 135424
    v_accvgpr_write_b32 a32, v40
    v_accvgpr_write_b32 a33, v41
    v_mfma_f32_16x16x32_bf16 v[36:39], a[184:187], a[120:123], v[36:39]
    ds_read_b64_tr_b16 a[184:185], v9 offset:16384
    v_mul_f32 v45, v17, v45
    v_mfma_f32_16x16x32_bf16 v[36:39], a[192:195], v[120:123], v[36:39]
    s_addk_i32 m0, 4096
    ds_read_b64_tr_b16 a[186:187], v9 offset:18432
    v_mul_f32 v46, v17, v46
    v_mfma_f32_16x16x32_bf16 v[36:39], a[196:199], v[124:127], v[36:39]
    ds_read_b64_tr_b16 a[188:189], v9 offset:20480
    v_mul_f32 v47, v17, v47
    v_mfma_f32_16x16x32_bf16 v[32:35], a[196:199], a[148:151], v[32:35]
    ds_read_b64_tr_b16 a[190:191], v9 offset:22528
    v_cvt_pk_bf16_f32 v44, v44, v45
    v_mfma_f32_16x16x32_bf16 v[32:35], a[192:195], a[144:147], v[32:35]
    v_cvt_pk_bf16_f32 v45, v46, v47
    v_accvgpr_write_b32 a36, v44
    v_mfma_f32_16x16x32_bf16 v[28:31], a[192:195], a[136:139], v[28:31]
    v_accvgpr_write_b32 a37, v45
    v_mfma_f32_16x16x32_bf16 v[28:31], a[196:199], a[140:143], v[28:31]
    v_mul_f32 v49, v18, v49
    v_mfma_f32_16x16x32_bf16 v[24:27], a[196:199], a[132:135], v[24:27]
    buffer_load_dwordx4 v6, s[16:19], s39 offen lds
    v_mfma_f32_16x16x32_bf16 v[24:27], a[192:195], a[128:131], v[24:27]
    s_add_u32 s39, s40, 147712
    ds_read_b64_tr_b16 a[192:193], v9 offset:24576
    v_mul_f32 v50, v18, v50
    v_mfma_f32_16x16x32_bf16 v[24:27], a[200:203], v[128:131], v[24:27]
    ds_read_b64_tr_b16 a[194:195], v9 offset:26624
    v_mul_f32 v51, v18, v51
    v_mfma_f32_16x16x32_bf16 v[24:27], a[204:207], v[132:135], v[24:27]
    s_addk_i32 m0, 4096
    ds_read_b64_tr_b16 a[196:197], v9 offset:28672
    v_cvt_pk_bf16_f32 v48, v48, v49
    v_mfma_f32_16x16x32_bf16 v[28:31], a[204:207], v[140:143], v[28:31]
    s_waitcnt lgkmcnt(3)
    ds_read_b64_tr_b16 a[198:199], v9 offset:30720
    v_cvt_pk_bf16_f32 v49, v50, v51
    v_mfma_f32_16x16x32_bf16 v[28:31], a[200:203], v[136:139], v[28:31]
    v_accvgpr_write_b32 a40, v48
    v_accvgpr_write_b32 a41, v49
    v_mfma_f32_16x16x32_bf16 v[32:35], a[200:203], v[144:147], v[32:35]
    v_mul_f32 v54, v19, v54
    v_mul_f32 v55, v19, v55
    v_mfma_f32_16x16x32_bf16 v[32:35], a[204:207], v[148:151], v[32:35]
    v_cvt_pk_bf16_f32 v52, v52, v53
    v_cvt_pk_bf16_f32 v53, v54, v55
    v_mfma_f32_16x16x32_bf16 v[36:39], a[204:207], v[156:159], v[36:39]
    v_accvgpr_write_b32 a44, v52
    v_accvgpr_write_b32 a45, v53
    v_mfma_f32_16x16x32_bf16 v[36:39], a[200:203], v[152:155], v[36:39]
    buffer_load_dwordx4 v6, s[16:19], s39 offen lds
    v_mfma_f32_16x16x32_bf16 v[36:39], a[208:211], v[184:187], v[36:39]
    s_add_u32 s39, s40, 160000
    ds_read_b64_tr_b16 a[200:201], v9 offset:32768
    v_mfma_f32_16x16x32_bf16 v[36:39], a[212:215], v[188:191], v[36:39]
    s_waitcnt vmcnt(7)
    ds_read_b64_tr_b16 a[202:203], v9 offset:34816
    v_mfma_f32_16x16x32_bf16 v[32:35], a[212:215], v[180:183], v[32:35]
    buffer_store_dword v4, v15, s[24:27], s76 offen sc1
    v_mfma_f32_16x16x32_bf16 v[32:35], a[208:211], v[176:179], v[32:35]
    s_addk_i32 m0, 4096
    ds_read_b64_tr_b16 a[204:205], v9 offset:36864
    v_mfma_f32_16x16x32_bf16 v[28:31], a[208:211], v[168:171], v[28:31]
    ds_read_b64_tr_b16 a[206:207], v9 offset:38912
    v_mfma_f32_16x16x32_bf16 v[28:31], a[212:215], v[172:175], v[28:31]
    v_mov_b32 v4, s56
    v_mfma_f32_16x16x32_bf16 v[24:27], a[212:215], v[164:167], v[24:27]
    s_add_u32 s56, s7, 4
    v_mfma_f32_16x16x32_bf16 v[24:27], a[208:211], v[160:163], v[24:27]
    ds_read_b64_tr_b16 a[208:209], v9 offset:40960
    v_mfma_f32_16x16x32_bf16 v[24:27], a[184:187], v[192:195], v[24:27]
    buffer_load_dwordx4 v6, s[16:19], s39 offen lds
    v_mfma_f32_16x16x32_bf16 v[24:27], a[188:191], v[196:199], v[24:27]
    s_load_dwordx4 s[72:75], s[86:87], s5 glc
    ds_read_b64_tr_b16 a[210:211], v9 offset:43008
    s_add_u32 s39, s40, 172288
    v_mfma_f32_16x16x32_bf16 v[28:31], a[188:191], v[204:207], v[28:31]
    ds_read_b64_tr_b16 a[212:213], v9 offset:45056
    v_mfma_f32_16x16x32_bf16 v[28:31], a[184:187], v[200:203], v[28:31]
    s_waitcnt lgkmcnt(5)
    ds_read_b64_tr_b16 a[214:215], v9 offset:47104
    v_add_u32 v9, 73728, v9
    v_mfma_f32_16x16x32_bf16 v[32:35], a[184:187], v[208:211], v[32:35]
    s_add_u32 m0, s63, 131072
    v_mfma_f32_16x16x32_bf16 v[32:35], a[188:191], v[212:215], v[32:35]
    v_mfma_f32_16x16x32_bf16 v[36:39], a[188:191], v[220:223], v[36:39]
    v_mfma_f32_16x16x32_bf16 v[36:39], a[184:187], v[216:219], v[36:39]
    ds_read_b64_tr_b16 a[184:185], v10 offset:49152
    v_mfma_f32_16x16x32_bf16 v[36:39], a[192:195], v[248:251], v[36:39]
    ds_read_b64_tr_b16 a[186:187], v10 offset:51200
    v_mfma_f32_16x16x32_bf16 v[36:39], a[196:199], v[252:255], v[36:39]
    buffer_load_dwordx4 v6, s[16:19], s39 offen lds
    v_mfma_f32_16x16x32_bf16 v[32:35], a[196:199], v[244:247], v[32:35]
    s_add_u32 s39, s40, 184576
    ds_read_b64_tr_b16 a[188:189], v10 offset:53248
    v_mfma_f32_16x16x32_bf16 v[32:35], a[192:195], v[240:243], v[32:35]
    ds_read_b64_tr_b16 a[190:191], v10 offset:55296
    v_mfma_f32_16x16x32_bf16 v[28:31], a[192:195], v[232:235], v[28:31]
    s_addk_i32 m0, 4096
    v_mfma_f32_16x16x32_bf16 v[28:31], a[196:199], v[236:239], v[28:31]
    v_mfma_f32_16x16x32_bf16 v[24:27], a[196:199], v[228:231], v[24:27]
    s_waitcnt lgkmcnt(5)
    v_mfma_f32_16x16x32_bf16 v[24:27], a[192:195], v[224:227], v[24:27]
    ds_read_b64_tr_b16 a[192:193], v10 offset:57344
    v_mfma_f32_16x16x32_bf16 v[24:27], a[200:203], v[56:59], v[24:27]
    ds_read_b64_tr_b16 a[194:195], v10 offset:59392
    v_mfma_f32_16x16x32_bf16 v[24:27], a[204:207], v[60:63], v[24:27]
    ds_read_b64_tr_b16 a[196:197], v10 offset:61440
    v_mfma_f32_16x16x32_bf16 v[28:31], a[204:207], v[68:71], v[28:31]
    buffer_load_dwordx4 v6, s[16:19], s39 offen lds
    v_mfma_f32_16x16x32_bf16 v[28:31], a[200:203], v[64:67], v[28:31]
    ds_read_b64_tr_b16 a[198:199], v10 offset:63488
    v_mfma_f32_16x16x32_bf16 v[32:35], a[200:203], v[72:75], v[32:35]
    v_mov_b32 v6, s7
    v_mfma_f32_16x16x32_bf16 v[32:35], a[204:207], v[76:79], v[32:35]
    v_mfma_f32_16x16x32_bf16 v[36:39], a[204:207], v[84:87], v[36:39]
    s_waitcnt lgkmcnt(5)
    v_mfma_f32_16x16x32_bf16 v[36:39], a[200:203], v[80:83], v[36:39]
    ds_read_b64_tr_b16 a[200:201], v10 offset:0
    v_mfma_f32_16x16x32_bf16 v[36:39], a[208:211], v[112:115], v[36:39]
    ds_read_b64_tr_b16 a[202:203], v10 offset:2048
    v_mfma_f32_16x16x32_bf16 v[36:39], a[212:215], v[116:119], v[36:39]
    ds_read_b64_tr_b16 a[204:205], v10 offset:4096
    v_mfma_f32_16x16x32_bf16 v[32:35], a[212:215], v[108:111], v[32:35]
    s_add_u32 s77, s7, 1
    ds_read_b64_tr_b16 a[206:207], v10 offset:6144
    v_mfma_f32_16x16x32_bf16 v[32:35], a[208:211], v[104:107], v[32:35]
    v_mfma_f32_16x16x32_bf16 v[28:31], a[208:211], v[96:99], v[28:31]
    v_mfma_f32_16x16x32_bf16 v[28:31], a[212:215], v[100:103], v[28:31]
    v_mfma_f32_16x16x32_bf16 v[24:27], a[212:215], v[92:95], v[24:27]
    s_waitcnt lgkmcnt(5)
    v_mul_f32 v36, v19, v36
    v_mfma_f32_16x16x32_bf16 v[24:27], a[208:211], v[88:91], v[24:27]
    ds_read_b64_tr_b16 a[208:209], v10 offset:8192
    v_mfma_f32_16x16x32_bf16 v[40:43], a[184:187], a[96:99], 0
    s_lshl_b32 s42, s48, 8
    ds_read_b64_tr_b16 a[210:211], v10 offset:10240
    v_lshrrev_b32 v22, 2, v1
    v_mfma_f32_16x16x32_bf16 v[40:43], a[188:191], a[100:103], v[40:43]
    s_add_u32 s42, s42, 3932304
    ds_read_b64_tr_b16 a[212:213], v10 offset:12288
    v_min_u32 v22, 9, v22
    v_mfma_f32_16x16x32_bf16 v[44:47], a[188:191], a[108:111], 0
    ds_read_b64_tr_b16 a[214:215], v10 offset:14336
    v_mul_u32_u24 v22, 6144, v22
    v_mfma_f32_16x16x32_bf16 v[44:47], a[184:187], a[104:107], v[44:47]
    v_and_b32 v23, 3, v1
    v_lshl_add_u32 v22, v23, 2, v22
    v_mfma_f32_16x16x32_bf16 v[48:51], a[184:187], a[112:115], 0
    buffer_load_dword v23, v22, s[24:27], s42 offen sc1
    v_mfma_f32_16x16x32_bf16 v[48:51], a[188:191], a[116:119], v[48:51]
    v_mul_f32 v24, v16, v24
    v_mul_f32 v25, v16, v25
    v_mfma_f32_16x16x32_bf16 v[52:55], a[188:191], a[124:127], 0
    s_waitcnt lgkmcnt(5)
    v_mul_f32 v26, v16, v26
    v_mul_f32 v27, v16, v27
    v_mfma_f32_16x16x32_bf16 v[52:55], a[184:187], a[120:123], v[52:55]
    ds_read_b64_tr_b16 a[184:185], v10 offset:16384
    v_cvt_pk_bf16_f32 v24, v24, v25
    v_mfma_f32_16x16x32_bf16 v[52:55], a[192:195], v[120:123], v[52:55]
    ds_read_b64_tr_b16 a[186:187], v10 offset:18432
    v_cvt_pk_bf16_f32 v25, v26, v27
    v_mfma_f32_16x16x32_bf16 v[52:55], a[196:199], v[124:127], v[52:55]
    ds_read_b64_tr_b16 a[188:189], v10 offset:20480
    v_accvgpr_write_b32 a34, v24
    v_mfma_f32_16x16x32_bf16 v[48:51], a[196:199], a[148:151], v[48:51]
    ds_read_b64_tr_b16 a[190:191], v10 offset:22528
    v_accvgpr_write_b32 a35, v25
    v_mfma_f32_16x16x32_bf16 v[48:51], a[192:195], a[144:147], v[48:51]
    buffer_store_dwordx4 a[32:35], v14, s[20:23], s55 offen offset:0 sc1
    v_mul_f32 v28, v17, v28
    v_mfma_f32_16x16x32_bf16 v[44:47], a[192:195], a[136:139], v[44:47]
    v_mul_f32 v29, v17, v29
    v_mul_f32 v30, v17, v30
    v_mfma_f32_16x16x32_bf16 v[44:47], a[196:199], a[140:143], v[44:47]
    v_mul_f32 v31, v17, v31
    v_cvt_pk_bf16_f32 v28, v28, v29
    v_mfma_f32_16x16x32_bf16 v[40:43], a[196:199], a[132:135], v[40:43]
    s_waitcnt lgkmcnt(5)
    v_cvt_pk_bf16_f32 v29, v30, v31
    v_accvgpr_write_b32 a38, v28
    v_mfma_f32_16x16x32_bf16 v[40:43], a[192:195], a[128:131], v[40:43]
    s_sub_u32 s78, s72, s77
    ds_read_b64_tr_b16 a[192:193], v10 offset:24576
    v_accvgpr_write_b32 a39, v29
    v_mfma_f32_16x16x32_bf16 v[40:43], a[200:203], v[128:131], v[40:43]
    buffer_store_dwordx4 a[36:39], v14, s[20:23], s55 offen offset:1024 sc1
    v_mul_f32 v32, v18, v32
    v_mfma_f32_16x16x32_bf16 v[40:43], a[204:207], v[132:135], v[40:43]
    s_sub_u32 s79, s73, s77
    ds_read_b64_tr_b16 a[194:195], v10 offset:26624
    v_mul_f32 v33, v18, v33
    v_mfma_f32_16x16x32_bf16 v[44:47], a[204:207], v[140:143], v[44:47]
    s_max_u32 s78, s78, s79
    ds_read_b64_tr_b16 a[196:197], v10 offset:28672
    v_mul_f32 v34, v18, v34
    v_mfma_f32_16x16x32_bf16 v[44:47], a[200:203], v[136:139], v[44:47]
    s_sub_u32 s79, s74, s77
    ds_read_b64_tr_b16 a[198:199], v10 offset:30720
    v_mul_f32 v35, v18, v35
    v_mfma_f32_16x16x32_bf16 v[48:51], a[200:203], v[144:147], v[48:51]
    s_max_u32 s78, s78, s79
    v_cvt_pk_bf16_f32 v32, v32, v33
    v_cvt_pk_bf16_f32 v33, v34, v35
    v_mfma_f32_16x16x32_bf16 v[48:51], a[204:207], v[148:151], v[48:51]
    s_sub_u32 s79, s75, s77
    v_accvgpr_write_b32 a42, v32
    v_accvgpr_write_b32 a43, v33
    v_mfma_f32_16x16x32_bf16 v[52:55], a[204:207], v[156:159], v[52:55]
    buffer_store_dwordx4 a[40:43], v14, s[20:23], s55 offen offset:2048 sc1
    v_mul_f32 v37, v19, v37
    v_mfma_f32_16x16x32_bf16 v[52:55], a[200:203], v[152:155], v[52:55]
    s_waitcnt lgkmcnt(3)
    ds_read_b64_tr_b16 a[200:201], v10 offset:32768
    v_mul_f32 v38, v19, v38
    v_mfma_f32_16x16x32_bf16 v[52:55], a[208:211], v[184:187], v[52:55]
    s_max_u32 s78, s78, s79
    ds_read_b64_tr_b16 a[202:203], v10 offset:34816
    v_mul_f32 v39, v19, v39
    v_mfma_f32_16x16x32_bf16 v[52:55], a[212:215], v[188:191], v[52:55]
    s_cmp_gt_u32 s78, 5
    s_cbranch_scc1 spin_o0
spin_o0_ret:
    v_cvt_pk_bf16_f32 v36, v36, v37
    v_mfma_f32_16x16x32_bf16 v[48:51], a[212:215], v[180:183], v[48:51]
    s_add_u32 s37, s59, 0
    ds_read_b64_tr_b16 a[204:205], v10 offset:36864
    v_cvt_pk_bf16_f32 v37, v38, v39
    v_mfma_f32_16x16x32_bf16 v[48:51], a[208:211], v[176:179], v[48:51]
    buffer_load_dwordx4 a[216:219], v14, s[20:23], s37 offen offset:0 sc1
    v_mfma_f32_16x16x32_bf16 v[44:47], a[208:211], v[168:171], v[44:47]
    ds_read_b64_tr_b16 a[206:207], v10 offset:38912
    v_accvgpr_write_b32 a46, v36
    v_mfma_f32_16x16x32_bf16 v[44:47], a[212:215], v[172:175], v[44:47]
    v_accvgpr_write_b32 a47, v37
    v_mfma_f32_16x16x32_bf16 v[40:43], a[212:215], v[164:167], v[40:43]
    buffer_store_dwordx4 a[44:47], v14, s[20:23], s55 offen offset:3072 sc1
    v_mfma_f32_16x16x32_bf16 v[40:43], a[208:211], v[160:163], v[40:43]
pg_10:
    s_cbranch_execz pg_14
    s_add_u32 s55, s55, 4096
    ds_read_b64_tr_b16 a[208:209], v10 offset:40960
    v_mfma_f32_16x16x32_bf16 v[40:43], a[184:187], v[192:195], v[40:43]
    ds_read_b64_tr_b16 a[210:211], v10 offset:43008
    v_mfma_f32_16x16x32_bf16 v[40:43], a[188:191], v[196:199], v[40:43]
    buffer_load_dwordx4 a[220:223], v14, s[20:23], s37 offen offset:1024 sc1
    v_mfma_f32_16x16x32_bf16 v[44:47], a[188:191], v[204:207], v[44:47]
    ds_read_b64_tr_b16 a[212:213], v10 offset:45056
    v_mfma_f32_16x16x32_bf16 v[44:47], a[184:187], v[200:203], v[44:47]
    ds_read_b64_tr_b16 a[214:215], v10 offset:47104
    v_add_u32 v10, 73728, v10
    v_mfma_f32_16x16x32_bf16 v[48:51], a[184:187], v[208:211], v[48:51]
    s_waitcnt lgkmcnt(4)
    v_mfma_f32_16x16x32_bf16 v[48:51], a[188:191], v[212:215], v[48:51]
    v_mfma_f32_16x16x32_bf16 v[52:55], a[188:191], v[220:223], v[52:55]
    v_mfma_f32_16x16x32_bf16 v[52:55], a[184:187], v[216:219], v[52:55]
    ds_read_b64_tr_b16 a[184:185], v11 offset:49152
    v_mfma_f32_16x16x32_bf16 v[52:55], a[192:195], v[248:251], v[52:55]
    ds_read_b64_tr_b16 a[186:187], v11 offset:51200
    v_mfma_f32_16x16x32_bf16 v[52:55], a[196:199], v[252:255], v[52:55]
    ds_read_b64_tr_b16 a[188:189], v11 offset:53248
    v_mfma_f32_16x16x32_bf16 v[48:51], a[196:199], v[244:247], v[48:51]
    buffer_load_dwordx4 a[224:227], v14, s[20:23], s37 offen offset:2048 sc1
    v_mfma_f32_16x16x32_bf16 v[48:51], a[192:195], v[240:243], v[48:51]
    ds_read_b64_tr_b16 a[190:191], v11 offset:55296
    v_mfma_f32_16x16x32_bf16 v[44:47], a[192:195], v[232:235], v[44:47]
    v_mfma_f32_16x16x32_bf16 v[44:47], a[196:199], v[236:239], v[44:47]
    v_mfma_f32_16x16x32_bf16 v[40:43], a[196:199], v[228:231], v[40:43]
    v_mfma_f32_16x16x32_bf16 v[40:43], a[192:195], v[224:227], v[40:43]
    ds_read_b64_tr_b16 a[192:193], v11 offset:57344
    v_mfma_f32_16x16x32_bf16 v[40:43], a[200:203], v[56:59], v[40:43]
    ds_read_b64_tr_b16 a[194:195], v11 offset:59392
    v_mfma_f32_16x16x32_bf16 v[40:43], a[204:207], v[60:63], v[40:43]
    ds_read_b64_tr_b16 a[196:197], v11 offset:61440
    v_mfma_f32_16x16x32_bf16 v[44:47], a[204:207], v[68:71], v[44:47]
    s_waitcnt lgkmcnt(3)
    ds_read_b64_tr_b16 a[198:199], v11 offset:63488
    v_mfma_f32_16x16x32_bf16 v[44:47], a[200:203], v[64:67], v[44:47]
    buffer_load_dwordx4 a[228:231], v14, s[20:23], s37 offen offset:3072 sc1
    v_mfma_f32_16x16x32_bf16 v[48:51], a[200:203], v[72:75], v[48:51]
    v_mfma_f32_16x16x32_bf16 v[48:51], a[204:207], v[76:79], v[48:51]
    v_mfma_f32_16x16x32_bf16 v[52:55], a[204:207], v[84:87], v[52:55]
    v_mfma_f32_16x16x32_bf16 v[52:55], a[200:203], v[80:83], v[52:55]
    ds_read_b64_tr_b16 a[200:201], v11 offset:0
    v_mfma_f32_16x16x32_bf16 v[52:55], a[208:211], v[112:115], v[52:55]
    ds_read_b64_tr_b16 a[202:203], v11 offset:2048
    v_mfma_f32_16x16x32_bf16 v[52:55], a[212:215], v[116:119], v[52:55]
    ds_read_b64_tr_b16 a[204:205], v11 offset:4096
    v_mfma_f32_16x16x32_bf16 v[48:51], a[212:215], v[108:111], v[48:51]
    ds_read_b64_tr_b16 a[206:207], v11 offset:6144
    v_mfma_f32_16x16x32_bf16 v[48:51], a[208:211], v[104:107], v[48:51]
    v_mfma_f32_16x16x32_bf16 v[44:47], a[208:211], v[96:99], v[44:47]
    v_mfma_f32_16x16x32_bf16 v[44:47], a[212:215], v[100:103], v[44:47]
    v_mfma_f32_16x16x32_bf16 v[40:43], a[212:215], v[92:95], v[40:43]
    s_add_u32 s37, s60, 0
    v_mul_f32 v52, v19, v52
    v_mfma_f32_16x16x32_bf16 v[40:43], a[208:211], v[88:91], v[40:43]
    ds_read_b64_tr_b16 a[208:209], v11 offset:8192
    v_mfma_f32_16x16x32_bf16 v[24:27], a[184:187], a[96:99], 0
    s_waitcnt vmcnt(8)
    ds_read_b64_tr_b16 a[210:211], v11 offset:10240
    v_cmp_ne_u32 vcc, s7, v23
    v_mfma_f32_16x16x32_bf16 v[24:27], a[188:191], a[100:103], v[24:27]
    s_cbranch_vccnz spin_gu
spin_gu_ret:
    v_mul_f32 v44, v17, v44
    v_mfma_f32_16x16x32_bf16 v[28:31], a[188:191], a[108:111], 0
    ds_read_b64_tr_b16 a[212:213], v11 offset:12288
    v_mul_f32 v40, v16, v40
    v_mfma_f32_16x16x32_bf16 v[28:31], a[184:187], a[104:107], v[28:31]
    s_waitcnt lgkmcnt(3)
    ds_read_b64_tr_b16 a[214:215], v11 offset:14336
    v_mul_f32 v41, v16, v41
    v_mfma_f32_16x16x32_bf16 v[32:35], a[184:187], a[112:115], 0
    buffer_load_dwordx4 a[232:235], v14, s[20:23], s37 offen offset:0 sc1
    v_mfma_f32_16x16x32_bf16 v[32:35], a[188:191], a[116:119], v[32:35]
    v_mul_f32 v42, v16, v42
    v_mul_f32 v43, v16, v43
    v_mfma_f32_16x16x32_bf16 v[36:39], a[188:191], a[124:127], 0
    v_cvt_pk_bf16_f32 v40, v40, v41
    v_cvt_pk_bf16_f32 v41, v42, v43
    v_mfma_f32_16x16x32_bf16 v[36:39], a[184:187], a[120:123], v[36:39]
    ds_read_b64_tr_b16 a[184:185], v11 offset:16384
    v_accvgpr_write_b32 a48, v40
    v_mfma_f32_16x16x32_bf16 v[36:39], a[192:195], v[120:123], v[36:39]
    ds_read_b64_tr_b16 a[186:187], v11 offset:18432
    v_accvgpr_write_b32 a49, v41
    v_mfma_f32_16x16x32_bf16 v[36:39], a[196:199], v[124:127], v[36:39]
    ds_read_b64_tr_b16 a[188:189], v11 offset:20480
    v_mul_f32 v45, v17, v45
    v_mfma_f32_16x16x32_bf16 v[32:35], a[196:199], a[148:151], v[32:35]
    ds_read_b64_tr_b16 a[190:191], v11 offset:22528
    v_mul_f32 v46, v17, v46
    v_mfma_f32_16x16x32_bf16 v[32:35], a[192:195], a[144:147], v[32:35]
    v_mul_f32 v47, v17, v47
    v_cvt_pk_bf16_f32 v44, v44, v45
    v_mfma_f32_16x16x32_bf16 v[28:31], a[192:195], a[136:139], v[28:31]
    v_cvt_pk_bf16_f32 v45, v46, v47
    v_accvgpr_write_b32 a52, v44
    v_mfma_f32_16x16x32_bf16 v[28:31], a[196:199], a[140:143], v[28:31]
    buffer_load_dwordx4 a[236:239], v14, s[20:23], s37 offen offset:1024 sc1
    v_mfma_f32_16x16x32_bf16 v[24:27], a[196:199], a[132:135], v[24:27]
    v_accvgpr_write_b32 a53, v45
    v_mul_f32 v48, v18, v48
    v_mfma_f32_16x16x32_bf16 v[24:27], a[192:195], a[128:131], v[24:27]
    ds_read_b64_tr_b16 a[192:193], v11 offset:24576
    v_mul_f32 v49, v18, v49
    v_mfma_f32_16x16x32_bf16 v[24:27], a[200:203], v[128:131], v[24:27]
    ds_read_b64_tr_b16 a[194:195], v11 offset:26624
    v_mul_f32 v50, v18, v50
    v_mfma_f32_16x16x32_bf16 v[24:27], a[204:207], v[132:135], v[24:27]
    ds_read_b64_tr_b16 a[196:197], v11 offset:28672
    v_mul_f32 v51, v18, v51
    v_mfma_f32_16x16x32_bf16 v[28:31], a[204:207], v[140:143], v[28:31]
    s_waitcnt lgkmcnt(3)
    ds_read_b64_tr_b16 a[198:199], v11 offset:30720
    v_cvt_pk_bf16_f32 v48, v48, v49
    v_mfma_f32_16x16x32_bf16 v[28:31], a[200:203], v[136:139], v[28:31]
    v_cvt_pk_bf16_f32 v49, v50, v51
    v_accvgpr_write_b32 a56, v48
    v_mfma_f32_16x16x32_bf16 v[32:35], a[200:203], v[144:147], v[32:35]
    v_accvgpr_write_b32 a57, v49
    v_mul_f32 v53, v19, v53
    v_mfma_f32_16x16x32_bf16 v[32:35], a[204:207], v[148:151], v[32:35]
    v_mul_f32 v54, v19, v54
    v_mul_f32 v55, v19, v55
    v_mfma_f32_16x16x32_bf16 v[36:39], a[204:207], v[156:159], v[36:39]
    buffer_load_dwordx4 a[240:243], v14, s[20:23], s37 offen offset:2048 sc1
    v_mfma_f32_16x16x32_bf16 v[36:39], a[200:203], v[152:155], v[36:39]
    ds_read_b64_tr_b16 a[200:201], v11 offset:32768
    v_cvt_pk_bf16_f32 v52, v52, v53
    v_mfma_f32_16x16x32_bf16 v[36:39], a[208:211], v[184:187], v[36:39]
    ds_read_b64_tr_b16 a[202:203], v11 offset:34816
    v_cvt_pk_bf16_f32 v53, v54, v55
    v_mfma_f32_16x16x32_bf16 v[36:39], a[212:215], v[188:191], v[36:39]
    ds_read_b64_tr_b16 a[204:205], v11 offset:36864
    v_accvgpr_write_b32 a60, v52
    v_mfma_f32_16x16x32_bf16 v[32:35], a[212:215], v[180:183], v[32:35]
    s_waitcnt vmcnt(6)
    ds_read_b64_tr_b16 a[206:207], v11 offset:38912
    v_accvgpr_write_b32 a61, v53
    v_mfma_f32_16x16x32_bf16 v[32:35], a[208:211], v[176:179], v[32:35]
    buffer_store_dword v4, v15, s[24:27], s76 offen sc1
    v_mfma_f32_16x16x32_bf16 v[28:31], a[208:211], v[168:171], v[28:31]
    v_mov_b32 v4, s56
    v_mfma_f32_16x16x32_bf16 v[28:31], a[212:215], v[172:175], v[28:31]
    v_cmp_gt_u32 vcc, 16, v1
    v_mfma_f32_16x16x32_bf16 v[24:27], a[212:215], v[164:167], v[24:27]
    v_mfma_f32_16x16x32_bf16 v[24:27], a[208:211], v[160:163], v[24:27]
    buffer_load_dwordx4 a[244:247], v14, s[20:23], s37 offen offset:3072 sc1
    v_mfma_f32_16x16x32_bf16 v[24:27], a[184:187], v[192:195], v[24:27]
    ds_read_b64_tr_b16 a[208:209], v11 offset:40960
    v_mfma_f32_16x16x32_bf16 v[24:27], a[188:191], v[196:199], v[24:27]
    ds_read_b64_tr_b16 a[210:211], v11 offset:43008
    v_mfma_f32_16x16x32_bf16 v[28:31], a[188:191], v[204:207], v[28:31]
    s_add_u32 s37, s61, 0
    ds_read_b64_tr_b16 a[212:213], v11 offset:45056
    v_mfma_f32_16x16x32_bf16 v[28:31], a[184:187], v[200:203], v[28:31]
    s_waitcnt lgkmcnt(3)
    ds_read_b64_tr_b16 a[214:215], v11 offset:47104
    v_add_u32 v11, 73728, v11
    v_mfma_f32_16x16x32_bf16 v[32:35], a[184:187], v[208:211], v[32:35]
    s_add_u32 s38, s44, 81920
    s_add_u32 s36, s44, 122880
    v_mfma_f32_16x16x32_bf16 v[32:35], a[188:191], v[212:215], v[32:35]
    s_cmp_lt_u32 s3, 2
    s_cselect_b32 s38, s38, s36
    s_add_u32 m0, s63, 16384
    v_mfma_f32_16x16x32_bf16 v[36:39], a[188:191], v[220:223], v[36:39]
    v_mfma_f32_16x16x32_bf16 v[36:39], a[184:187], v[216:219], v[36:39]
    v_mfma_f32_16x16x32_bf16 v[36:39], a[192:195], v[248:251], v[36:39]
    buffer_load_dwordx4 a[152:155], v14, s[20:23], s37 offen offset:0 sc1
    v_mfma_f32_16x16x32_bf16 v[36:39], a[196:199], v[252:255], v[36:39]
    s_waitcnt lgkmcnt(0)
    v_mfma_f32_16x16x32_bf16 v[32:35], a[196:199], v[244:247], v[32:35]
    s_barrier
    v_mfma_f32_16x16x32_bf16 v[32:35], a[192:195], v[240:243], v[32:35]
    buffer_load_dwordx4 v7, s[8:11], s38 offen lds
    v_mfma_f32_16x16x32_bf16 v[28:31], a[192:195], v[232:235], v[28:31]
    ds_read_b64_tr_b16 a[184:185], v8 offset:0
    v_mfma_f32_16x16x32_bf16 v[28:31], a[196:199], v[236:239], v[28:31]
    ds_read_b64_tr_b16 a[186:187], v8 offset:2048
    v_mfma_f32_16x16x32_bf16 v[24:27], a[196:199], v[228:231], v[24:27]
    ds_read_b64_tr_b16 a[188:189], v8 offset:4096
    v_mfma_f32_16x16x32_bf16 v[24:27], a[192:195], v[224:227], v[24:27]
    s_add_u32 s38, s44, 81920
    ds_read_b64_tr_b16 a[190:191], v8 offset:6144
    v_mfma_f32_16x16x32_bf16 v[24:27], a[200:203], v[56:59], v[24:27]
    ds_read_b64_tr_b16 a[192:193], v8 offset:8192
    v_mfma_f32_16x16x32_bf16 v[24:27], a[204:207], v[60:63], v[24:27]
    buffer_load_dwordx4 a[156:159], v14, s[20:23], s37 offen offset:1024 sc1
    v_mfma_f32_16x16x32_bf16 v[28:31], a[204:207], v[68:71], v[28:31]
    s_addk_i32 m0, -16384
    ds_read_b64_tr_b16 a[194:195], v8 offset:10240
    v_mfma_f32_16x16x32_bf16 v[28:31], a[200:203], v[64:67], v[28:31]
    ds_read_b64_tr_b16 a[196:197], v8 offset:12288
    v_mfma_f32_16x16x32_bf16 v[32:35], a[200:203], v[72:75], v[32:35]
    ds_read_b64_tr_b16 a[198:199], v8 offset:14336
    v_mfma_f32_16x16x32_bf16 v[32:35], a[204:207], v[76:79], v[32:35]
    v_mfma_f32_16x16x32_bf16 v[36:39], a[204:207], v[84:87], v[36:39]
    v_mfma_f32_16x16x32_bf16 v[36:39], a[200:203], v[80:83], v[36:39]
    buffer_load_dwordx4 v2, s[8:11], s38 offen lds
    v_mfma_f32_16x16x32_bf16 v[36:39], a[208:211], v[112:115], v[36:39]
    ds_read_b64_tr_b16 a[200:201], v8 offset:16384
    v_mfma_f32_16x16x32_bf16 v[36:39], a[212:215], v[116:119], v[36:39]
    ds_read_b64_tr_b16 a[202:203], v8 offset:18432
    v_mfma_f32_16x16x32_bf16 v[32:35], a[212:215], v[108:111], v[32:35]
    buffer_load_dwordx4 a[160:163], v14, s[20:23], s37 offen offset:2048 sc1
    v_mfma_f32_16x16x32_bf16 v[32:35], a[208:211], v[104:107], v[32:35]
    s_load_dwordx4 s[72:75], s[86:87], s5 glc
    ds_read_b64_tr_b16 a[204:205], v8 offset:20480
    s_add_u32 s38, s44, 81920
    v_mfma_f32_16x16x32_bf16 v[28:31], a[208:211], v[96:99], v[28:31]
    s_waitcnt lgkmcnt(5)
    ds_read_b64_tr_b16 a[206:207], v8 offset:22528
    v_mfma_f32_16x16x32_bf16 v[28:31], a[212:215], v[100:103], v[28:31]
    s_add_u32 m0, s63, 4096
    v_mul_f32 v32, v18, v32
    v_mul_f32 v33, v18, v33
    v_mfma_f32_16x16x32_bf16 v[24:27], a[212:215], v[92:95], v[24:27]
    v_mul_f32 v34, v18, v34
    v_mfma_f32_16x16x32_bf16 v[24:27], a[208:211], v[88:91], v[24:27]
    ds_read_b64_tr_b16 a[208:209], v8 offset:24576
    v_mfma_f32_16x16x32_bf16 v[40:43], a[184:187], a[96:99], 0
    ds_read_b64_tr_b16 a[210:211], v8 offset:26624
    v_mul_f32 v28, v17, v28
    v_mfma_f32_16x16x32_bf16 v[40:43], a[188:191], a[100:103], v[40:43]
    ds_read_b64_tr_b16 a[212:213], v8 offset:28672
    v_mul_f32 v29, v17, v29
    v_mfma_f32_16x16x32_bf16 v[44:47], a[188:191], a[108:111], 0
    ds_read_b64_tr_b16 a[214:215], v8 offset:30720
    v_mul_f32 v24, v16, v24
    v_mfma_f32_16x16x32_bf16 v[44:47], a[184:187], a[104:107], v[44:47]
    buffer_load_dwordx4 a[164:167], v14, s[20:23], s37 offen offset:3072 sc1
    v_mfma_f32_16x16x32_bf16 v[48:51], a[184:187], a[112:115], 0
    buffer_load_dwordx4 v3, s[8:11], s38 offen lds
    v_mfma_f32_16x16x32_bf16 v[48:51], a[188:191], a[116:119], v[48:51]
    v_mul_f32 v25, v16, v25
    v_mul_f32 v26, v16, v26
    v_mfma_f32_16x16x32_bf16 v[52:55], a[188:191], a[124:127], 0
    s_waitcnt lgkmcnt(5)
    v_mul_f32 v27, v16, v27
    v_cvt_pk_bf16_f32 v24, v24, v25
    v_mfma_f32_16x16x32_bf16 v[52:55], a[184:187], a[120:123], v[52:55]
    s_add_u32 s38, s44, 122880
    ds_read_b64_tr_b16 a[184:185], v8 offset:32768
    v_cvt_pk_bf16_f32 v25, v26, v27
    v_mfma_f32_16x16x32_bf16 v[52:55], a[192:195], v[120:123], v[52:55]
    ds_read_b64_tr_b16 a[186:187], v8 offset:34816
    v_accvgpr_write_b32 a50, v24
    v_mfma_f32_16x16x32_bf16 v[52:55], a[196:199], v[124:127], v[52:55]
    s_addk_i32 m0, 4096
    ds_read_b64_tr_b16 a[188:189], v8 offset:36864
    v_accvgpr_write_b32 a51, v25
    v_mfma_f32_16x16x32_bf16 v[48:51], a[196:199], a[148:151], v[48:51]
    buffer_store_dwordx4 a[48:51], v14, s[20:23], s55 offen offset:0 sc1
    v_mul_f32 v30, v17, v30
    v_mfma_f32_16x16x32_bf16 v[48:51], a[192:195], a[144:147], v[48:51]
    ds_read_b64_tr_b16 a[190:191], v8 offset:38912
    v_mul_f32 v31, v17, v31
    v_mfma_f32_16x16x32_bf16 v[44:47], a[192:195], a[136:139], v[44:47]
    v_cvt_pk_bf16_f32 v28, v28, v29
    v_cvt_pk_bf16_f32 v29, v30, v31
    v_mfma_f32_16x16x32_bf16 v[44:47], a[196:199], a[140:143], v[44:47]
    v_accvgpr_write_b32 a54, v28
    v_accvgpr_write_b32 a55, v29
    v_mfma_f32_16x16x32_bf16 v[40:43], a[196:199], a[132:135], v[40:43]
    buffer_store_dwordx4 a[52:55], v14, s[20:23], s55 offen offset:1024 sc1
    v_mul_f32 v35, v18, v35
    v_mfma_f32_16x16x32_bf16 v[40:43], a[192:195], a[128:131], v[40:43]
    buffer_load_dwordx4 v2, s[8:11], s38 offen lds
    v_mfma_f32_16x16x32_bf16 v[40:43], a[200:203], v[128:131], v[40:43]
    s_waitcnt lgkmcnt(3)
    ds_read_b64_tr_b16 a[192:193], v8 offset:40960
    v_cvt_pk_bf16_f32 v32, v32, v33
    v_mfma_f32_16x16x32_bf16 v[40:43], a[204:207], v[132:135], v[40:43]
    ds_read_b64_tr_b16 a[194:195], v8 offset:43008
    v_cvt_pk_bf16_f32 v33, v34, v35
    v_mfma_f32_16x16x32_bf16 v[44:47], a[204:207], v[140:143], v[44:47]
    ds_read_b64_tr_b16 a[196:197], v8 offset:45056
    v_accvgpr_write_b32 a58, v32
    v_mfma_f32_16x16x32_bf16 v[44:47], a[200:203], v[136:139], v[44:47]
    s_add_u32 s38, s44, 122880
    ds_read_b64_tr_b16 a[198:199], v8 offset:47104
    v_accvgpr_write_b32 a59, v33
    v_mfma_f32_16x16x32_bf16 v[48:51], a[200:203], v[144:147], v[48:51]
    buffer_store_dwordx4 a[56:59], v14, s[20:23], s55 offen offset:2048 sc1
    v_mul_f32 v36, v19, v36
    v_mfma_f32_16x16x32_bf16 v[48:51], a[204:207], v[148:151], v[48:51]
    s_addk_i32 m0, 4096
    v_mul_f32 v37, v19, v37
    v_mul_f32 v38, v19, v38
    v_mfma_f32_16x16x32_bf16 v[52:55], a[204:207], v[156:159], v[52:55]
    v_mul_f32 v39, v19, v39
    v_cvt_pk_bf16_f32 v36, v36, v37
    v_mfma_f32_16x16x32_bf16 v[52:55], a[200:203], v[152:155], v[52:55]
    ds_read_b64_tr_b16 a[200:201], v8 offset:49152
    v_cvt_pk_bf16_f32 v37, v38, v39
    v_mfma_f32_16x16x32_bf16 v[52:55], a[208:211], v[184:187], v[52:55]
    ds_read_b64_tr_b16 a[202:203], v8 offset:51200
    v_accvgpr_write_b32 a62, v36
    v_mfma_f32_16x16x32_bf16 v[52:55], a[212:215], v[188:191], v[52:55]
    ds_read_b64_tr_b16 a[204:205], v8 offset:53248
    v_accvgpr_write_b32 a63, v37
    v_mfma_f32_16x16x32_bf16 v[48:51], a[212:215], v[180:183], v[48:51]
    buffer_store_dwordx4 a[60:63], v14, s[20:23], s55 offen offset:3072 sc1
    v_mfma_f32_16x16x32_bf16 v[48:51], a[208:211], v[176:179], v[48:51]
    buffer_load_dwordx4 v3, s[8:11], s38 offen lds
    v_mfma_f32_16x16x32_bf16 v[44:47], a[208:211], v[168:171], v[44:47]
    s_add_u32 s55, s55, 4096
    ds_read_b64_tr_b16 a[206:207], v8 offset:55296
    v_mfma_f32_16x16x32_bf16 v[44:47], a[212:215], v[172:175], v[44:47]
    s_waitcnt lgkmcnt(6)
    v_mfma_f32_16x16x32_bf16 v[40:43], a[212:215], v[164:167], v[40:43]
    s_add_u32 s77, s7, 2
    v_mfma_f32_16x16x32_bf16 v[40:43], a[208:211], v[160:163], v[40:43]
    s_add_u32 s38, s44, 163840
    ds_read_b64_tr_b16 a[208:209], v8 offset:57344
    s_add_u32 s36, s45, 0
    v_mfma_f32_16x16x32_bf16 v[40:43], a[184:187], v[192:195], v[40:43]
    s_cmp_lt_u32 s3, 2
    s_cselect_b32 s38, s38, s36
    v_mfma_f32_16x16x32_bf16 v[40:43], a[188:191], v[196:199], v[40:43]
    s_addk_i32 m0, 24576
    ds_read_b64_tr_b16 a[210:211], v8 offset:59392
    v_mfma_f32_16x16x32_bf16 v[44:47], a[188:191], v[204:207], v[44:47]
    ds_read_b64_tr_b16 a[212:213], v8 offset:61440
    v_mfma_f32_16x16x32_bf16 v[44:47], a[184:187], v[200:203], v[44:47]
    ds_read_b64_tr_b16 a[214:215], v8 offset:63488
    v_add_u32 v8, 65536, v8
    v_mfma_f32_16x16x32_bf16 v[48:51], a[184:187], v[208:211], v[48:51]
    v_mfma_f32_16x16x32_bf16 v[48:51], a[188:191], v[212:215], v[48:51]
    v_mfma_f32_16x16x32_bf16 v[52:55], a[188:191], v[220:223], v[52:55]
    s_waitcnt lgkmcnt(5)
    v_mfma_f32_16x16x32_bf16 v[52:55], a[184:187], v[216:219], v[52:55]
    buffer_load_dwordx4 v7, s[8:11], s38 offen lds
    v_mfma_f32_16x16x32_bf16 v[52:55], a[192:195], v[248:251], v[52:55]
    ds_read_b64_tr_b16 a[184:185], v9 offset:0
    v_mfma_f32_16x16x32_bf16 v[52:55], a[196:199], v[252:255], v[52:55]
    ds_read_b64_tr_b16 a[186:187], v9 offset:2048
    v_mfma_f32_16x16x32_bf16 v[48:51], a[196:199], v[244:247], v[48:51]
    ds_read_b64_tr_b16 a[188:189], v9 offset:4096
    v_mfma_f32_16x16x32_bf16 v[48:51], a[192:195], v[240:243], v[48:51]
    s_add_u32 s38, s44, 163840
    ds_read_b64_tr_b16 a[190:191], v9 offset:6144
    v_mfma_f32_16x16x32_bf16 v[44:47], a[192:195], v[232:235], v[44:47]
    v_mfma_f32_16x16x32_bf16 v[44:47], a[196:199], v[236:239], v[44:47]
    s_addk_i32 m0, -16384
    v_mfma_f32_16x16x32_bf16 v[40:43], a[196:199], v[228:231], v[40:43]
    s_waitcnt lgkmcnt(4)
    s_sub_u32 s78, s72, s77
    s_sub_u32 s79, s73, s77
    v_mfma_f32_16x16x32_bf16 v[40:43], a[192:195], v[224:227], v[40:43]
    s_max_u32 s78, s78, s79
    ds_read_b64_tr_b16 a[192:193], v9 offset:8192
    s_sub_u32 s79, s74, s77
    v_mfma_f32_16x16x32_bf16 v[40:43], a[200:203], v[56:59], v[40:43]
    s_max_u32 s78, s78, s79
    ds_read_b64_tr_b16 a[194:195], v9 offset:10240
    s_sub_u32 s79, s75, s77
    v_mfma_f32_16x16x32_bf16 v[40:43], a[204:207], v[60:63], v[40:43]
    s_max_u32 s78, s78, s79
    ds_read_b64_tr_b16 a[196:197], v9 offset:12288
    v_mfma_f32_16x16x32_bf16 v[44:47], a[204:207], v[68:71], v[44:47]
    s_cmp_gt_u32 s78, 4
    s_cbranch_scc1 spin_o1
spin_o1_ret:
    s_add_u32 s37, s59, 4096
    v_mfma_f32_16x16x32_bf16 v[44:47], a[200:203], v[64:67], v[44:47]
    buffer_load_dwordx4 v2, s[8:11], s38 offen lds
    v_mfma_f32_16x16x32_bf16 v[48:51], a[200:203], v[72:75], v[48:51]
    ds_read_b64_tr_b16 a[198:199], v9 offset:14336
    v_mfma_f32_16x16x32_bf16 v[48:51], a[204:207], v[76:79], v[48:51]
    v_mfma_f32_16x16x32_bf16 v[52:55], a[204:207], v[84:87], v[52:55]
    v_mfma_f32_16x16x32_bf16 v[52:55], a[200:203], v[80:83], v[52:55]
    s_add_u32 s38, s44, 163840
    ds_read_b64_tr_b16 a[200:201], v9 offset:16384
    v_mfma_f32_16x16x32_bf16 v[52:55], a[208:211], v[112:115], v[52:55]
    buffer_load_dwordx4 a[168:171], v14, s[20:23], s37 offen offset:0 sc1
    v_mfma_f32_16x16x32_bf16 v[52:55], a[212:215], v[116:119], v[52:55]
    s_addk_i32 m0, 4096
    ds_read_b64_tr_b16 a[202:203], v9 offset:18432
    v_mfma_f32_16x16x32_bf16 v[48:51], a[212:215], v[108:111], v[48:51]
    ds_read_b64_tr_b16 a[204:205], v9 offset:20480
    v_mfma_f32_16x16x32_bf16 v[48:51], a[208:211], v[104:107], v[48:51]
    s_waitcnt lgkmcnt(3)
    ds_read_b64_tr_b16 a[206:207], v9 offset:22528
    v_mfma_f32_16x16x32_bf16 v[44:47], a[208:211], v[96:99], v[44:47]
    v_mul_f32 v52, v19, v52
    v_mfma_f32_16x16x32_bf16 v[44:47], a[212:215], v[100:103], v[44:47]
    v_mul_f32 v53, v19, v53
    v_mfma_f32_16x16x32_bf16 v[40:43], a[212:215], v[92:95], v[40:43]
    v_mul_f32 v54, v19, v54
    v_mfma_f32_16x16x32_bf16 v[40:43], a[208:211], v[88:91], v[40:43]
    buffer_load_dwordx4 v3, s[8:11], s38 offen lds
    v_mfma_f32_16x16x32_bf16 v[24:27], a[184:187], a[96:99], 0
    ds_read_b64_tr_b16 a[208:209], v9 offset:24576
    v_mfma_f32_16x16x32_bf16 v[24:27], a[188:191], a[100:103], v[24:27]
    buffer_load_dwordx4 a[172:175], v14, s[20:23], s37 offen offset:1024 sc1
    v_mfma_f32_16x16x32_bf16 v[28:31], a[188:191], a[108:111], 0
    ds_read_b64_tr_b16 a[210:211], v9 offset:26624
    v_mul_f32 v44, v17, v44
    v_mfma_f32_16x16x32_bf16 v[28:31], a[184:187], a[104:107], v[28:31]
    s_add_u32 s38, s45, 0
    ds_read_b64_tr_b16 a[212:213], v9 offset:28672
    v_mul_f32 v40, v16, v40
    v_mfma_f32_16x16x32_bf16 v[32:35], a[184:187], a[112:115], 0
    ds_read_b64_tr_b16 a[214:215], v9 offset:30720
    v_mul_f32 v41, v16, v41
    v_mfma_f32_16x16x32_bf16 v[32:35], a[188:191], a[116:119], v[32:35]
    s_addk_i32 m0, 4096
    v_mul_f32 v42, v16, v42
    v_mul_f32 v43, v16, v43
    v_mfma_f32_16x16x32_bf16 v[36:39], a[188:191], a[124:127], 0
    v_cvt_pk_bf16_f32 v40, v40, v41
    v_cvt_pk_bf16_f32 v41, v42, v43
    v_mfma_f32_16x16x32_bf16 v[36:39], a[184:187], a[120:123], v[36:39]
    ds_read_b64_tr_b16 a[184:185], v9 offset:32768
    v_accvgpr_write_b32 a64, v40
    v_mfma_f32_16x16x32_bf16 v[36:39], a[192:195], v[120:123], v[36:39]
    ds_read_b64_tr_b16 a[186:187], v9 offset:34816
    v_accvgpr_write_b32 a65, v41
    v_mfma_f32_16x16x32_bf16 v[36:39], a[196:199], v[124:127], v[36:39]
    ds_read_b64_tr_b16 a[188:189], v9 offset:36864
    v_mul_f32 v45, v17, v45
    v_mfma_f32_16x16x32_bf16 v[32:35], a[196:199], a[148:151], v[32:35]
    s_waitcnt lgkmcnt(4)
    ds_read_b64_tr_b16 a[190:191], v9 offset:38912
    v_mul_f32 v46, v17, v46
    v_mfma_f32_16x16x32_bf16 v[32:35], a[192:195], a[144:147], v[32:35]
    buffer_load_dwordx4 a[176:179], v14, s[20:23], s37 offen offset:2048 sc1
    v_mfma_f32_16x16x32_bf16 v[28:31], a[192:195], a[136:139], v[28:31]
    buffer_load_dwordx4 v2, s[8:11], s38 offen lds
    v_mfma_f32_16x16x32_bf16 v[28:31], a[196:199], a[140:143], v[28:31]
    s_mov_b32 s12, s64
    v_mul_f32 v47, v17, v47
    v_cvt_pk_bf16_f32 v44, v44, v45
    v_mfma_f32_16x16x32_bf16 v[24:27], a[196:199], a[132:135], v[24:27]
    s_and_b32 s13, s65, 0xffff
    v_cvt_pk_bf16_f32 v45, v46, v47
    v_accvgpr_write_b32 a68, v44
    v_mfma_f32_16x16x32_bf16 v[24:27], a[192:195], a[128:131], v[24:27]
    s_add_u32 s38, s45, 0
    ds_read_b64_tr_b16 a[192:193], v9 offset:40960
    v_accvgpr_write_b32 a69, v45
    v_mfma_f32_16x16x32_bf16 v[24:27], a[200:203], v[128:131], v[24:27]
    s_mov_b32 s14, 2621440
    ds_read_b64_tr_b16 a[194:195], v9 offset:43008
    v_mul_f32 v48, v18, v48
    v_mfma_f32_16x16x32_bf16 v[24:27], a[204:207], v[132:135], v[24:27]
    s_addk_i32 m0, 4096
    ds_read_b64_tr_b16 a[196:197], v9 offset:45056
    v_mul_f32 v49, v18, v49
    v_mfma_f32_16x16x32_bf16 v[28:31], a[204:207], v[140:143], v[28:31]
    s_mov_b32 s15, 0x00020000
    ds_read_b64_tr_b16 a[198:199], v9 offset:47104
    v_mul_f32 v50, v18, v50
    v_mfma_f32_16x16x32_bf16 v[28:31], a[200:203], v[136:139], v[28:31]
    buffer_load_dwordx4 a[180:183], v14, s[20:23], s37 offen offset:3072 sc1
    v_mfma_f32_16x16x32_bf16 v[32:35], a[200:203], v[144:147], v[32:35]
    s_lshl_b32 s56, s54, 1
    v_mul_f32 v51, v18, v51
    v_cvt_pk_bf16_f32 v48, v48, v49
    v_mfma_f32_16x16x32_bf16 v[32:35], a[204:207], v[148:151], v[32:35]
    s_and_b32 s57, s53, 1
    v_cvt_pk_bf16_f32 v49, v50, v51
    v_accvgpr_write_b32 a72, v48
    v_mfma_f32_16x16x32_bf16 v[36:39], a[204:207], v[156:159], v[36:39]
    s_waitcnt lgkmcnt(3)
    v_accvgpr_write_b32 a73, v49
    v_mul_f32 v55, v19, v55
    v_mfma_f32_16x16x32_bf16 v[36:39], a[200:203], v[152:155], v[36:39]
    buffer_load_dwordx4 v3, s[8:11], s38 offen lds
    v_mfma_f32_16x16x32_bf16 v[36:39], a[208:211], v[184:187], v[36:39]
    s_waitcnt vmcnt(10)
    ds_read_b64_tr_b16 a[200:201], v9 offset:49152
    v_cvt_pk_bf16_f32 v52, v52, v53
    v_mfma_f32_16x16x32_bf16 v[36:39], a[212:215], v[188:191], v[36:39]
    buffer_store_dword v4, v15, s[24:27], s76 offen sc1
    v_mfma_f32_16x16x32_bf16 v[32:35], a[212:215], v[180:183], v[32:35]
    s_add_u32 s56, s56, s57
    ds_read_b64_tr_b16 a[202:203], v9 offset:51200
    v_cvt_pk_bf16_f32 v53, v54, v55
    v_mfma_f32_16x16x32_bf16 v[32:35], a[208:211], v[176:179], v[32:35]
    s_add_u32 s38, s46, 0
    ds_read_b64_tr_b16 a[204:205], v9 offset:53248
    v_accvgpr_write_b32 a76, v52
    v_mfma_f32_16x16x32_bf16 v[28:31], a[208:211], v[168:171], v[28:31]
    s_add_u32 s36, s47, 0
    ds_read_b64_tr_b16 a[206:207], v9 offset:55296
    v_accvgpr_write_b32 a77, v53
    v_mfma_f32_16x16x32_bf16 v[28:31], a[212:215], v[172:175], v[28:31]
    s_cmp_lt_u32 s3, 2
    s_cselect_b32 s38, s38, s36
    s_addk_i32 m0, 24576
    v_mfma_f32_16x16x32_bf16 v[24:27], a[212:215], v[164:167], v[24:27]
    s_lshl_b32 s6, s56, 5
    s_andn2_b32 s56, 2, s53
    s_lshl3_add_u32 s6, s56, s6
    v_mfma_f32_16x16x32_bf16 v[24:27], a[208:211], v[160:163], v[24:27]
    s_mul_i32 s56, s51, 320
    ds_read_b64_tr_b16 a[208:209], v9 offset:57344
    s_and_b32 s57, s51, 1
    v_mfma_f32_16x16x32_bf16 v[24:27], a[184:187], v[192:195], v[24:27]
    s_add_u32 s64, s57, s50
    ds_read_b64_tr_b16 a[210:211], v9 offset:59392
    s_lshl_b32 s64, s64, 6
    v_mfma_f32_16x16x32_bf16 v[24:27], a[188:191], v[196:199], v[24:27]
    s_add_u32 s64, s64, s56
    ds_read_b64_tr_b16 a[212:213], v9 offset:61440
    s_xor_b32 s57, s57, 1
    v_mfma_f32_16x16x32_bf16 v[28:31], a[188:191], v[204:207], v[28:31]
    s_lshl_b32 s57, s57, 8
    ds_read_b64_tr_b16 a[214:215], v9 offset:63488
    v_add_u32 v9, 65536, v9
    v_mfma_f32_16x16x32_bf16 v[28:31], a[184:187], v[200:203], v[28:31]
    s_waitcnt lgkmcnt(4)
    s_add_u32 s68, s56, s57
    v_mfma_f32_16x16x32_bf16 v[32:35], a[184:187], v[208:211], v[32:35]
    buffer_load_dwordx4 v7, s[8:11], s38 offen lds
    v_mfma_f32_16x16x32_bf16 v[32:35], a[188:191], v[212:215], v[32:35]
    s_add_u32 s56, s7, 5
    v_mov_b32 v4, s56
    v_mfma_f32_16x16x32_bf16 v[36:39], a[188:191], v[220:223], v[36:39]
    v_mfma_f32_16x16x32_bf16 v[36:39], a[184:187], v[216:219], v[36:39]
    s_add_u32 s38, s46, 0
    ds_read_b64_tr_b16 a[184:185], v10 offset:0
    v_mfma_f32_16x16x32_bf16 v[36:39], a[192:195], v[248:251], v[36:39]
    ds_read_b64_tr_b16 a[186:187], v10 offset:2048
    v_mfma_f32_16x16x32_bf16 v[36:39], a[196:199], v[252:255], v[36:39]
    s_addk_i32 m0, -16384
    ds_read_b64_tr_b16 a[188:189], v10 offset:4096
    v_mfma_f32_16x16x32_bf16 v[32:35], a[196:199], v[244:247], v[32:35]
    ds_read_b64_tr_b16 a[190:191], v10 offset:6144
    v_mfma_f32_16x16x32_bf16 v[32:35], a[192:195], v[240:243], v[32:35]
    v_mfma_f32_16x16x32_bf16 v[28:31], a[192:195], v[232:235], v[28:31]
    v_mfma_f32_16x16x32_bf16 v[28:31], a[196:199], v[236:239], v[28:31]
    v_mfma_f32_16x16x32_bf16 v[24:27], a[196:199], v[228:231], v[24:27]
    v_mfma_f32_16x16x32_bf16 v[24:27], a[192:195], v[224:227], v[24:27]
    buffer_load_dwordx4 v2, s[8:11], s38 offen lds
    v_mfma_f32_16x16x32_bf16 v[24:27], a[200:203], v[56:59], v[24:27]
    ds_read_b64_tr_b16 a[192:193], v10 offset:8192
    v_mfma_f32_16x16x32_bf16 v[24:27], a[204:207], v[60:63], v[24:27]
    ds_read_b64_tr_b16 a[194:195], v10 offset:10240
    v_mfma_f32_16x16x32_bf16 v[28:31], a[204:207], v[68:71], v[28:31]
    ds_read_b64_tr_b16 a[196:197], v10 offset:12288
    v_mfma_f32_16x16x32_bf16 v[28:31], a[200:203], v[64:67], v[28:31]
    s_waitcnt lgkmcnt(3)
    ds_read_b64_tr_b16 a[198:199], v10 offset:14336
    s_add_u32 s38, s46, 0
    v_mfma_f32_16x16x32_bf16 v[32:35], a[200:203], v[72:75], v[32:35]
    v_mfma_f32_16x16x32_bf16 v[32:35], a[204:207], v[76:79], v[32:35]
    s_addk_i32 m0, 4096
    v_mfma_f32_16x16x32_bf16 v[36:39], a[204:207], v[84:87], v[36:39]
    v_mfma_f32_16x16x32_bf16 v[36:39], a[200:203], v[80:83], v[36:39]
    ds_read_b64_tr_b16 a[200:201], v10 offset:16384
    v_mfma_f32_16x16x32_bf16 v[36:39], a[208:211], v[112:115], v[36:39]
    ds_read_b64_tr_b16 a[202:203], v10 offset:18432
    v_mfma_f32_16x16x32_bf16 v[36:39], a[212:215], v[116:119], v[36:39]
    ds_read_b64_tr_b16 a[204:205], v10 offset:20480
    v_mfma_f32_16x16x32_bf16 v[32:35], a[212:215], v[108:111], v[32:35]
    ds_read_b64_tr_b16 a[206:207], v10 offset:22528
    v_mfma_f32_16x16x32_bf16 v[32:35], a[208:211], v[104:107], v[32:35]
    buffer_load_dwordx4 v3, s[8:11], s38 offen lds
    v_mfma_f32_16x16x32_bf16 v[28:31], a[208:211], v[96:99], v[28:31]
    v_mfma_f32_16x16x32_bf16 v[28:31], a[212:215], v[100:103], v[28:31]
    v_mfma_f32_16x16x32_bf16 v[24:27], a[212:215], v[92:95], v[24:27]
    v_mul_f32 v36, v19, v36
    v_mfma_f32_16x16x32_bf16 v[24:27], a[208:211], v[88:91], v[24:27]
    s_add_u32 s38, s47, 0
    ds_read_b64_tr_b16 a[208:209], v10 offset:24576
    v_mul_f32 v32, v18, v32
    v_mfma_f32_16x16x32_bf16 v[40:43], a[184:187], a[96:99], 0
    s_mul_i32 s57, s48, 10
    ds_read_b64_tr_b16 a[210:211], v10 offset:26624
    v_lshrrev_b32 v5, 5, v1
    v_mfma_f32_16x16x32_bf16 v[40:43], a[188:191], a[100:103], v[40:43]
    s_addk_i32 m0, 4096
    ds_read_b64_tr_b16 a[212:213], v10 offset:28672
    v_lshlrev_b32 v5, 3, v5
    v_mfma_f32_16x16x32_bf16 v[44:47], a[188:191], a[108:111], 0
pg_11:
    s_cbranch_execz pg_15
    s_waitcnt lgkmcnt(3)
    ds_read_b64_tr_b16 a[214:215], v10 offset:30720
    v_bfe_u32 v22, v1, 3, 2
    v_mfma_f32_16x16x32_bf16 v[44:47], a[184:187], a[104:107], v[44:47]
    s_sub_u32 s57, s58, s57
    v_add_u32 v22, v22, v5
    v_mul_u32_u24 v22, 1280, v22
    v_mfma_f32_16x16x32_bf16 v[48:51], a[184:187], a[112:115], 0
    s_mul_i32 s62, s48, 1280
    v_lshrrev_b32 v5, 4, v1
    v_lshlrev_b32 v5, 1, v5
    v_mfma_f32_16x16x32_bf16 v[48:51], a[188:191], a[116:119], v[48:51]
    s_lshl_b32 s56, s57, 6
    v_and_b32 v23, 7, v1
    v_xor_b32 v23, v23, v5
    v_mfma_f32_16x16x32_bf16 v[52:55], a[188:191], a[124:127], 0
    s_add_u32 s62, s62, s56
    v_lshlrev_b32 v23, 4, v23
    v_add_u32 v22, v22, v23
    v_mfma_f32_16x16x32_bf16 v[52:55], a[184:187], a[120:123], v[52:55]
    buffer_load_dwordx4 v2, s[8:11], s38 offen lds
    v_mfma_f32_16x16x32_bf16 v[52:55], a[192:195], v[120:123], v[52:55]
    s_lshl_b32 s56, s3, 4
    ds_read_b64_tr_b16 a[184:185], v10 offset:32768
    v_add_u32 v23, 20480, v22
    v_mfma_f32_16x16x32_bf16 v[52:55], a[196:199], v[124:127], v[52:55]
    s_add_u32 s62, s62, s56
    ds_read_b64_tr_b16 a[186:187], v10 offset:34816
    v_mul_f32 v24, v16, v24
    v_mfma_f32_16x16x32_bf16 v[48:51], a[196:199], a[148:151], v[48:51]
    s_lshl_b32 s62, s62, 2
    ds_read_b64_tr_b16 a[188:189], v10 offset:36864
    v_mul_f32 v25, v16, v25
    v_mfma_f32_16x16x32_bf16 v[48:51], a[192:195], a[144:147], v[48:51]
    s_add_u32 s38, s47, 0
    ds_read_b64_tr_b16 a[190:191], v10 offset:38912
    v_mul_f32 v26, v16, v26
    v_mfma_f32_16x16x32_bf16 v[44:47], a[192:195], a[136:139], v[44:47]
    s_add_u32 s62, s62, 3670016
    v_mul_f32 v27, v16, v27
    v_cvt_pk_bf16_f32 v24, v24, v25
    v_mfma_f32_16x16x32_bf16 v[44:47], a[196:199], a[140:143], v[44:47]
    s_addk_i32 m0, 4096
    v_cvt_pk_bf16_f32 v25, v26, v27
    v_accvgpr_write_b32 a66, v24
    v_mfma_f32_16x16x32_bf16 v[40:43], a[196:199], a[132:135], v[40:43]
    s_lshl_b32 s41, s48, 6
    v_accvgpr_write_b32 a67, v25
    v_mul_f32 v28, v17, v28
    v_mfma_f32_16x16x32_bf16 v[40:43], a[192:195], a[128:131], v[40:43]
    buffer_store_dwordx4 a[64:67], v14, s[20:23], s55 offen offset:0 sc1
    v_mul_f32 v29, v17, v29
    v_mfma_f32_16x16x32_bf16 v[40:43], a[200:203], v[128:131], v[40:43]
    s_lshr_b32 s56, s3, 1
    ds_read_b64_tr_b16 a[192:193], v10 offset:40960
    v_mul_f32 v30, v17, v30
    v_mfma_f32_16x16x32_bf16 v[40:43], a[204:207], v[132:135], v[40:43]
    s_lshl_b32 s56, s56, 5
    ds_read_b64_tr_b16 a[194:195], v10 offset:43008
    v_mul_f32 v31, v17, v31
    v_mfma_f32_16x16x32_bf16 v[44:47], a[204:207], v[140:143], v[44:47]
    s_add_u32 s41, s41, s56
    ds_read_b64_tr_b16 a[196:197], v10 offset:45056
    v_cvt_pk_bf16_f32 v28, v28, v29
    v_mfma_f32_16x16x32_bf16 v[44:47], a[200:203], v[136:139], v[44:47]
    s_waitcnt lgkmcnt(3)
    ds_read_b64_tr_b16 a[198:199], v10 offset:47104
    v_cvt_pk_bf16_f32 v29, v30, v31
    v_mfma_f32_16x16x32_bf16 v[48:51], a[200:203], v[144:147], v[48:51]
    buffer_load_dwordx4 v3, s[8:11], s38 offen lds
    v_mfma_f32_16x16x32_bf16 v[48:51], a[204:207], v[148:151], v[48:51]
    s_and_b32 s56, s3, 1
    v_accvgpr_write_b32 a70, v28
    v_accvgpr_write_b32 a71, v29
    v_mfma_f32_16x16x32_bf16 v[52:55], a[204:207], v[156:159], v[52:55]
    buffer_store_dwordx4 a[68:71], v14, s[20:23], s55 offen offset:1024 sc1
    v_mul_f32 v33, v18, v33
    v_mfma_f32_16x16x32_bf16 v[52:55], a[200:203], v[152:155], v[52:55]
    s_lshl_b32 s56, s56, 2
    ds_read_b64_tr_b16 a[200:201], v10 offset:49152
    v_mul_f32 v34, v18, v34
    v_mfma_f32_16x16x32_bf16 v[52:55], a[208:211], v[184:187], v[52:55]
    s_add_u32 s41, s41, s56
    ds_read_b64_tr_b16 a[202:203], v10 offset:51200
    v_mul_f32 v35, v18, v35
    v_mfma_f32_16x16x32_bf16 v[52:55], a[212:215], v[188:191], v[52:55]
    s_add_u32 s56, s3, 0
    ds_read_b64_tr_b16 a[204:205], v10 offset:53248
    v_cvt_pk_bf16_f32 v32, v32, v33
    v_mfma_f32_16x16x32_bf16 v[48:51], a[212:215], v[180:183], v[48:51]
    s_min_u32 s56, s56, 9
    ds_read_b64_tr_b16 a[206:207], v10 offset:55296
    v_cvt_pk_bf16_f32 v33, v34, v35
    v_mfma_f32_16x16x32_bf16 v[48:51], a[208:211], v[176:179], v[48:51]
    s_mul_i32 s38, s56, 24576
    v_accvgpr_write_b32 a74, v32
    v_accvgpr_write_b32 a75, v33
    v_mfma_f32_16x16x32_bf16 v[44:47], a[208:211], v[168:171], v[44:47]
    buffer_store_dwordx4 a[72:75], v14, s[20:23], s55 offen offset:2048 sc1
    v_mul_f32 v37, v19, v37
    v_mfma_f32_16x16x32_bf16 v[44:47], a[212:215], v[172:175], v[44:47]
    s_lshl_b32 s56, s56, 10
    v_mul_f32 v38, v19, v38
    v_mul_f32 v39, v19, v39
    v_mfma_f32_16x16x32_bf16 v[40:43], a[212:215], v[164:167], v[40:43]
    s_add_u32 m0, s56, 61440
    v_cvt_pk_bf16_f32 v36, v36, v37
    v_cvt_pk_bf16_f32 v37, v38, v39
    v_mfma_f32_16x16x32_bf16 v[40:43], a[208:211], v[160:163], v[40:43]
    s_mul_i32 s41, s41, 1280
    ds_read_b64_tr_b16 a[208:209], v10 offset:57344
    v_accvgpr_write_b32 a78, v36
    v_mfma_f32_16x16x32_bf16 v[40:43], a[184:187], v[192:195], v[40:43]
    s_lshl_b32 s57, s57, 7
    ds_read_b64_tr_b16 a[210:211], v10 offset:59392
    v_accvgpr_write_b32 a79, v37
    v_mfma_f32_16x16x32_bf16 v[40:43], a[188:191], v[196:199], v[40:43]
    buffer_store_dwordx4 a[76:79], v14, s[20:23], s55 offen offset:3072 sc1
    v_mfma_f32_16x16x32_bf16 v[44:47], a[188:191], v[204:207], v[44:47]
    s_add_u32 s56, s3, 4
    ds_read_b64_tr_b16 a[212:213], v10 offset:61440
    s_min_u32 s56, s56, 9
    v_mfma_f32_16x16x32_bf16 v[44:47], a[184:187], v[200:203], v[44:47]
    s_waitcnt lgkmcnt(3)
    ds_read_b64_tr_b16 a[214:215], v10 offset:63488
    v_add_u32 v10, 65536, v10
    v_mfma_f32_16x16x32_bf16 v[48:51], a[184:187], v[208:211], v[48:51]
    s_add_u32 s55, s55, 4096
    s_add_u32 s41, s41, s57
    s_lshl_b32 s57, s48, 10
    v_mfma_f32_16x16x32_bf16 v[48:51], a[188:191], v[212:215], v[48:51]
    s_add_u32 s38, s38, s57
    s_add_u32 s38, s38, 3276800
    s_lshl_b32 s57, s48, 10
    v_mfma_f32_16x16x32_bf16 v[52:55], a[188:191], v[220:223], v[52:55]
    buffer_load_dwordx4 v14, s[24:27], s38 offen sc1 lds
    v_mfma_f32_16x16x32_bf16 v[52:55], a[184:187], v[216:219], v[52:55]
    s_mul_i32 s38, s56, 24576
    ds_read_b64_tr_b16 a[184:185], v11 offset:0
    s_add_u32 s38, s38, s57
    v_mfma_f32_16x16x32_bf16 v[52:55], a[192:195], v[248:251], v[52:55]
    s_add_u32 s38, s38, 3276800
    ds_read_b64_tr_b16 a[186:187], v11 offset:2048
    s_lshl_b32 s56, s56, 10
    v_mfma_f32_16x16x32_bf16 v[52:55], a[196:199], v[252:255], v[52:55]
    s_add_u32 m0, s56, 61440
    ds_read_b64_tr_b16 a[188:189], v11 offset:4096
    s_lshl_b32 s43, s3, 11
    v_mfma_f32_16x16x32_bf16 v[48:51], a[196:199], v[244:247], v[48:51]
    buffer_load_dwordx4 v14, s[24:27], s38 offen sc1 lds
    v_mfma_f32_16x16x32_bf16 v[48:51], a[192:195], v[240:243], v[48:51]
    s_add_u32 s56, s3, 8
    ds_read_b64_tr_b16 a[190:191], v11 offset:6144
    s_min_u32 s56, s56, 9
    v_mfma_f32_16x16x32_bf16 v[44:47], a[192:195], v[232:235], v[44:47]
    s_mul_i32 s38, s56, 24576
    s_lshl_b32 s57, s48, 10
    s_add_u32 s38, s38, s57
    v_mfma_f32_16x16x32_bf16 v[44:47], a[196:199], v[236:239], v[44:47]
    s_add_u32 s38, s38, 3276800
    s_lshl_b32 s56, s56, 10
    s_add_u32 m0, s56, 61440
    v_mfma_f32_16x16x32_bf16 v[40:43], a[196:199], v[228:231], v[40:43]
    s_add_u32 s56, s7, 6
    v_lshrrev_b32 v12, 2, v1
    v_mfma_f32_16x16x32_bf16 v[40:43], a[192:195], v[224:227], v[40:43]
    ds_read_b64_tr_b16 a[192:193], v11 offset:8192
    v_mfma_f32_16x16x32_bf16 v[40:43], a[200:203], v[56:59], v[40:43]
    s_load_dwordx4 s[72:75], s[86:87], s5 glc
    ds_read_b64_tr_b16 a[194:195], v11 offset:10240
    v_mfma_f32_16x16x32_bf16 v[40:43], a[204:207], v[60:63], v[40:43]
    ds_read_b64_tr_b16 a[196:197], v11 offset:12288
    v_mfma_f32_16x16x32_bf16 v[44:47], a[204:207], v[68:71], v[44:47]
    s_waitcnt lgkmcnt(5)
    ds_read_b64_tr_b16 a[198:199], v11 offset:14336
    v_mfma_f32_16x16x32_bf16 v[44:47], a[200:203], v[64:67], v[44:47]
    buffer_load_dwordx4 v14, s[24:27], s38 offen sc1 lds
    v_mfma_f32_16x16x32_bf16 v[48:51], a[200:203], v[72:75], v[48:51]
    v_lshlrev_b32 v12, 6, v12
    v_mfma_f32_16x16x32_bf16 v[48:51], a[204:207], v[76:79], v[48:51]
    v_and_b32 v21, 3, v1
    v_mfma_f32_16x16x32_bf16 v[52:55], a[204:207], v[84:87], v[52:55]
    v_lshl_add_u32 v12, v21, 3, v12
    v_mfma_f32_16x16x32_bf16 v[52:55], a[200:203], v[80:83], v[52:55]
    ds_read_b64_tr_b16 a[200:201], v11 offset:16384
    v_mfma_f32_16x16x32_bf16 v[52:55], a[208:211], v[112:115], v[52:55]
    ds_read_b64_tr_b16 a[202:203], v11 offset:18432
    v_mfma_f32_16x16x32_bf16 v[52:55], a[212:215], v[116:119], v[52:55]
    ds_read_b64_tr_b16 a[204:205], v11 offset:20480
    v_mfma_f32_16x16x32_bf16 v[48:51], a[212:215], v[108:111], v[48:51]
    ds_read_b64_tr_b16 a[206:207], v11 offset:22528
    v_mfma_f32_16x16x32_bf16 v[48:51], a[208:211], v[104:107], v[48:51]
    v_and_b32 v21, 16, v1
    v_mfma_f32_16x16x32_bf16 v[44:47], a[208:211], v[96:99], v[44:47]
    v_lshl_add_u32 v12, v21, 1, v12
    v_mfma_f32_16x16x32_bf16 v[44:47], a[212:215], v[100:103], v[44:47]
    v_mul_f32 v52, v19, v52
    v_mfma_f32_16x16x32_bf16 v[40:43], a[212:215], v[92:95], v[40:43]
    s_waitcnt lgkmcnt(5)
    v_mul_f32 v53, v19, v53
    v_mul_f32 v48, v18, v48
    v_mfma_f32_16x16x32_bf16 v[40:43], a[208:211], v[88:91], v[40:43]
    s_add_u32 s37, s60, 4096
    ds_read_b64_tr_b16 a[208:209], v11 offset:24576
    v_mul_f32 v44, v17, v44
    v_mfma_f32_16x16x32_bf16 v[24:27], a[184:187], a[96:99], 0
    ds_read_b64_tr_b16 a[210:211], v11 offset:26624
    v_mul_f32 v45, v17, v45
    v_mfma_f32_16x16x32_bf16 v[24:27], a[188:191], a[100:103], v[24:27]
    ds_read_b64_tr_b16 a[212:213], v11 offset:28672
    v_mul_f32 v40, v16, v40
    v_mfma_f32_16x16x32_bf16 v[28:31], a[188:191], a[108:111], 0
    ds_read_b64_tr_b16 a[214:215], v11 offset:30720
    v_mul_f32 v41, v16, v41
    v_mfma_f32_16x16x32_bf16 v[28:31], a[184:187], a[104:107], v[28:31]
    v_mul_f32 v42, v16, v42
    v_mul_f32 v43, v16, v43
    v_mfma_f32_16x16x32_bf16 v[32:35], a[184:187], a[112:115], 0
    buffer_load_dwordx4 a[96:99], v14, s[20:23], s37 offen offset:0 sc1
    v_mfma_f32_16x16x32_bf16 v[32:35], a[188:191], a[116:119], v[32:35]
    v_cvt_pk_bf16_f32 v40, v40, v41
    v_cvt_pk_bf16_f32 v41, v42, v43
    v_mfma_f32_16x16x32_bf16 v[36:39], a[188:191], a[124:127], 0
    s_waitcnt lgkmcnt(5)
    v_accvgpr_write_b32 a80, v40
    v_accvgpr_write_b32 a81, v41
    v_mfma_f32_16x16x32_bf16 v[36:39], a[184:187], a[120:123], v[36:39]
    ds_read_b64_tr_b16 a[184:185], v11 offset:32768
    v_mul_f32 v46, v17, v46
    v_mfma_f32_16x16x32_bf16 v[36:39], a[192:195], v[120:123], v[36:39]
    ds_read_b64_tr_b16 a[186:187], v11 offset:34816
    v_mul_f32 v47, v17, v47
    v_mfma_f32_16x16x32_bf16 v[36:39], a[196:199], v[124:127], v[36:39]
    ds_read_b64_tr_b16 a[188:189], v11 offset:36864
    v_cvt_pk_bf16_f32 v44, v44, v45
    v_mfma_f32_16x16x32_bf16 v[32:35], a[196:199], a[148:151], v[32:35]
    ds_read_b64_tr_b16 a[190:191], v11 offset:38912
    v_cvt_pk_bf16_f32 v45, v46, v47
    v_mfma_f32_16x16x32_bf16 v[32:35], a[192:195], a[144:147], v[32:35]
    v_accvgpr_write_b32 a84, v44
    v_accvgpr_write_b32 a85, v45
    v_mfma_f32_16x16x32_bf16 v[28:31], a[192:195], a[136:139], v[28:31]
    v_mul_f32 v49, v18, v49
    v_mul_f32 v50, v18, v50
    v_mfma_f32_16x16x32_bf16 v[28:31], a[196:199], a[140:143], v[28:31]
    v_mul_f32 v51, v18, v51
    v_cvt_pk_bf16_f32 v48, v48, v49
    v_mfma_f32_16x16x32_bf16 v[24:27], a[196:199], a[132:135], v[24:27]
    buffer_load_dwordx4 a[100:103], v14, s[20:23], s37 offen offset:1024 sc1
    v_mfma_f32_16x16x32_bf16 v[24:27], a[192:195], a[128:131], v[24:27]
    s_waitcnt lgkmcnt(4)
    ds_read_b64_tr_b16 a[192:193], v11 offset:40960
    v_cvt_pk_bf16_f32 v49, v50, v51
    v_mfma_f32_16x16x32_bf16 v[24:27], a[200:203], v[128:131], v[24:27]
    ds_read_b64_tr_b16 a[194:195], v11 offset:43008
    v_accvgpr_write_b32 a88, v48
    v_mfma_f32_16x16x32_bf16 v[24:27], a[204:207], v[132:135], v[24:27]
    ds_read_b64_tr_b16 a[196:197], v11 offset:45056
    v_accvgpr_write_b32 a89, v49
    v_mfma_f32_16x16x32_bf16 v[28:31], a[204:207], v[140:143], v[28:31]
    ds_read_b64_tr_b16 a[198:199], v11 offset:47104
    v_mfma_f32_16x16x32_bf16 v[28:31], a[200:203], v[136:139], v[28:31]
    v_mul_f32 v54, v19, v54
    v_mfma_f32_16x16x32_bf16 v[32:35], a[200:203], v[144:147], v[32:35]
    v_mul_f32 v55, v19, v55
    v_cvt_pk_bf16_f32 v52, v52, v53
    v_mfma_f32_16x16x32_bf16 v[32:35], a[204:207], v[148:151], v[32:35]
    v_cvt_pk_bf16_f32 v53, v54, v55
    v_accvgpr_write_b32 a92, v52
    v_mfma_f32_16x16x32_bf16 v[36:39], a[204:207], v[156:159], v[36:39]
    v_accvgpr_write_b32 a93, v53
    v_mfma_f32_16x16x32_bf16 v[36:39], a[200:203], v[152:155], v[36:39]
    ds_read_b64_tr_b16 a[200:201], v11 offset:49152
    v_mfma_f32_16x16x32_bf16 v[36:39], a[208:211], v[184:187], v[36:39]
    buffer_load_dwordx4 a[104:107], v14, s[20:23], s37 offen offset:2048 sc1
    v_mfma_f32_16x16x32_bf16 v[36:39], a[212:215], v[188:191], v[36:39]
    ds_read_b64_tr_b16 a[202:203], v11 offset:51200
    v_mfma_f32_16x16x32_bf16 v[32:35], a[212:215], v[180:183], v[32:35]
    ds_read_b64_tr_b16 a[204:205], v11 offset:53248
    v_mfma_f32_16x16x32_bf16 v[32:35], a[208:211], v[176:179], v[32:35]
    s_waitcnt lgkmcnt(5)
    ds_read_b64_tr_b16 a[206:207], v11 offset:55296
    v_mfma_f32_16x16x32_bf16 v[28:31], a[208:211], v[168:171], v[28:31]
    v_add_u32 v12, 98304, v12
    v_mfma_f32_16x16x32_bf16 v[28:31], a[212:215], v[172:175], v[28:31]
    s_waitcnt vmcnt(6)
    v_lshrrev_b32 v13, 2, v1
    v_mfma_f32_16x16x32_bf16 v[24:27], a[212:215], v[164:167], v[24:27]
    buffer_store_dword v4, v15, s[24:27], s76 offen sc1
    v_mfma_f32_16x16x32_bf16 v[24:27], a[208:211], v[160:163], v[24:27]
    ds_read_b64_tr_b16 a[208:209], v11 offset:57344
    v_mfma_f32_16x16x32_bf16 v[24:27], a[184:187], v[192:195], v[24:27]
    ds_read_b64_tr_b16 a[210:211], v11 offset:59392
    v_mfma_f32_16x16x32_bf16 v[24:27], a[188:191], v[196:199], v[24:27]
    ds_read_b64_tr_b16 a[212:213], v11 offset:61440
    v_mfma_f32_16x16x32_bf16 v[28:31], a[188:191], v[204:207], v[28:31]
    buffer_load_dwordx4 a[108:111], v14, s[20:23], s37 offen offset:3072 sc1
    v_mfma_f32_16x16x32_bf16 v[28:31], a[184:187], v[200:203], v[28:31]
    ds_read_b64_tr_b16 a[214:215], v11 offset:63488
    v_add_u32 v11, 65536, v11
    v_mfma_f32_16x16x32_bf16 v[32:35], a[184:187], v[208:211], v[32:35]
    v_lshlrev_b32 v13, 6, v13
    v_mfma_f32_16x16x32_bf16 v[32:35], a[188:191], v[212:215], v[32:35]
    v_and_b32 v21, 3, v1
    v_mfma_f32_16x16x32_bf16 v[36:39], a[188:191], v[220:223], v[36:39]
    s_waitcnt lgkmcnt(3)
    v_lshl_add_u32 v13, v21, 3, v13
    s_add_u32 s37, s61, 4096
    v_mfma_f32_16x16x32_bf16 v[36:39], a[184:187], v[216:219], v[36:39]
    v_and_b32 v21, 16, v1
    v_mfma_f32_16x16x32_bf16 v[36:39], a[192:195], v[248:251], v[36:39]
    v_lshl_add_u32 v13, v21, 1, v13
    v_mfma_f32_16x16x32_bf16 v[36:39], a[196:199], v[252:255], v[36:39]
    s_waitcnt lgkmcnt(0)
    v_xor_b32 v13, 32, v13
    v_mfma_f32_16x16x32_bf16 v[32:35], a[196:199], v[244:247], v[32:35]
    s_barrier
    v_mfma_f32_16x16x32_bf16 v[32:35], a[192:195], v[240:243], v[32:35]
    ds_read_b64_tr_b16 a[184:185], v12 offset:57344
    v_mfma_f32_16x16x32_bf16 v[28:31], a[192:195], v[232:235], v[28:31]
    buffer_load_dwordx4 a[112:115], v14, s[20:23], s37 offen offset:0 sc1
    v_mfma_f32_16x16x32_bf16 v[28:31], a[196:199], v[236:239], v[28:31]
    ds_read_b64_tr_b16 a[186:187], v12 offset:58368
    v_mfma_f32_16x16x32_bf16 v[24:27], a[196:199], v[228:231], v[24:27]
    ds_read_b64_tr_b16 a[188:189], v12 offset:59392
    v_add_u32 v13, 98304, v13
    v_mfma_f32_16x16x32_bf16 v[24:27], a[192:195], v[224:227], v[24:27]
    ds_read_b64_tr_b16 a[190:191], v12 offset:60416
    v_subrev_u32 v12, 81920, v12
    v_mfma_f32_16x16x32_bf16 v[24:27], a[200:203], v[56:59], v[24:27]
    ds_read_b64_tr_b16 a[192:193], v13 offset:57344
    v_mfma_f32_16x16x32_bf16 v[24:27], a[204:207], v[60:63], v[24:27]
    ds_read_b64_tr_b16 a[194:195], v13 offset:58368
    v_mfma_f32_16x16x32_bf16 v[28:31], a[204:207], v[68:71], v[28:31]
    ds_read_b64_tr_b16 a[196:197], v13 offset:59392
    v_mfma_f32_16x16x32_bf16 v[28:31], a[200:203], v[64:67], v[28:31]
    ds_read_b64_tr_b16 a[198:199], v13 offset:60416
    v_subrev_u32 v13, 81920, v13
    v_mfma_f32_16x16x32_bf16 v[32:35], a[200:203], v[72:75], v[32:35]
    v_mov_b32 v55, s56
    v_mfma_f32_16x16x32_bf16 v[32:35], a[204:207], v[76:79], v[32:35]
    s_lshl_b32 s56, s3, 8
    v_mfma_f32_16x16x32_bf16 v[36:39], a[204:207], v[84:87], v[36:39]
    buffer_load_dwordx4 a[116:119], v14, s[20:23], s37 offen offset:1024 sc1
    v_mfma_f32_16x16x32_bf16 v[36:39], a[200:203], v[80:83], v[36:39]
    s_add_u32 s77, s7, 3
    ds_read_b64_tr_b16 a[200:201], v8 offset:0
    v_mfma_f32_16x16x32_bf16 v[36:39], a[208:211], v[112:115], v[36:39]
    s_add_u32 s56, s56, 71680
    ds_read_b64_tr_b16 a[202:203], v8 offset:2048
    v_mfma_f32_16x16x32_bf16 v[36:39], a[212:215], v[116:119], v[36:39]
    ds_read_b64_tr_b16 a[204:205], v8 offset:8192
    v_mfma_f32_16x16x32_bf16 v[32:35], a[212:215], v[108:111], v[32:35]
    s_waitcnt lgkmcnt(3)
    ds_read_b64_tr_b16 a[206:207], v8 offset:10240
    v_mfma_f32_16x16x32_bf16 v[32:35], a[208:211], v[104:107], v[32:35]
    v_mfma_f32_16x16x32_bf16 v[28:31], a[208:211], v[96:99], v[28:31]
    v_mfma_f32_16x16x32_bf16 v[28:31], a[212:215], v[100:103], v[28:31]
    v_mfma_f32_16x16x32_bf16 v[24:27], a[212:215], v[92:95], v[24:27]
    v_mul_f32 v36, v19, v36
    v_mfma_f32_16x16x32_bf16 v[24:27], a[208:211], v[88:91], v[24:27]
    ds_read_b64_tr_b16 a[208:209], v9 offset:0
    v_mfma_f32_16x16x32_bf16 v[96:99], a[184:187], a[0:3], 0
    buffer_load_dwordx4 a[120:123], v14, s[20:23], s37 offen offset:2048 sc1
    v_mfma_f32_16x16x32_bf16 v[96:99], a[188:191], a[16:19], v[96:99]
    ds_read_b64_tr_b16 a[210:211], v9 offset:2048
    v_mul_f32 v28, v17, v28
    v_mfma_f32_16x16x32_bf16 v[104:107], a[188:191], a[20:23], 0
    ds_read_b64_tr_b16 a[212:213], v9 offset:8192
    v_mul_f32 v24, v16, v24
    v_mfma_f32_16x16x32_bf16 v[104:107], a[184:187], a[4:7], v[104:107]
    ds_read_b64_tr_b16 a[214:215], v9 offset:10240
    v_mul_f32 v25, v16, v25
    v_mfma_f32_16x16x32_bf16 v[112:115], a[184:187], a[8:11], 0
    v_mul_f32 v26, v16, v26
    v_mul_f32 v27, v16, v27
    v_mfma_f32_16x16x32_bf16 v[112:115], a[188:191], a[24:27], v[112:115]
    v_cvt_pk_bf16_f32 v24, v24, v25
    v_cvt_pk_bf16_f32 v25, v26, v27
    v_mfma_f32_16x16x32_bf16 v[120:123], a[188:191], a[28:31], 0
    v_accvgpr_write_b32 a82, v24
    v_accvgpr_write_b32 a83, v25
    v_mfma_f32_16x16x32_bf16 v[120:123], a[184:187], a[12:15], v[120:123]
    buffer_store_dwordx4 a[80:83], v14, s[20:23], s55 offen offset:0 sc1
    v_mul_f32 v29, v17, v29
    v_mfma_f32_16x16x32_bf16 v[124:127], a[192:195], a[12:15], 0
    ds_read_b64_tr_b16 a[184:185], v10 offset:0
    v_mul_f32 v30, v17, v30
    v_mfma_f32_16x16x32_bf16 v[124:127], a[196:199], a[28:31], v[124:127]
    ds_read_b64_tr_b16 a[186:187], v10 offset:2048
    v_mul_f32 v31, v17, v31
    v_mfma_f32_16x16x32_bf16 v[116:119], a[196:199], a[24:27], 0
    buffer_load_dwordx4 a[124:127], v14, s[20:23], s37 offen offset:3072 sc1
    v_mfma_f32_16x16x32_bf16 v[116:119], a[192:195], a[8:11], v[116:119]
    s_sub_u32 s78, s72, s77
    ds_read_b64_tr_b16 a[188:189], v10 offset:8192
    v_cvt_pk_bf16_f32 v28, v28, v29
    v_mfma_f32_16x16x32_bf16 v[108:111], a[192:195], a[4:7], 0
    s_waitcnt lgkmcnt(3)
    ds_read_b64_tr_b16 a[190:191], v10 offset:10240
    v_cvt_pk_bf16_f32 v29, v30, v31
    v_mfma_f32_16x16x32_bf16 v[108:111], a[196:199], a[20:23], v[108:111]
    s_sub_u32 s79, s73, s77
    v_accvgpr_write_b32 a86, v28
    v_accvgpr_write_b32 a87, v29
    v_mfma_f32_16x16x32_bf16 v[100:103], a[196:199], a[16:19], 0
    buffer_store_dwordx4 a[84:87], v14, s[20:23], s55 offen offset:1024 sc1
    v_mul_f32 v32, v18, v32
    v_mfma_f32_16x16x32_bf16 v[100:103], a[192:195], a[0:3], v[100:103]
    s_max_u32 s78, s78, s79
    ds_read_b64_tr_b16 a[192:193], v11 offset:0
    v_mul_f32 v33, v18, v33
    v_mfma_f32_16x16x32_bf16 v[128:131], a[200:203], a[0:3], 0
    s_sub_u32 s79, s74, s77
    ds_read_b64_tr_b16 a[194:195], v11 offset:2048
    v_mul_f32 v34, v18, v34
    v_mfma_f32_16x16x32_bf16 v[128:131], a[204:207], a[16:19], v[128:131]
    s_max_u32 s78, s78, s79
    ds_read_b64_tr_b16 a[196:197], v11 offset:8192
    v_mul_f32 v35, v18, v35
    v_mfma_f32_16x16x32_bf16 v[136:139], a[204:207], a[20:23], 0
    s_sub_u32 s79, s75, s77
    ds_read_b64_tr_b16 a[198:199], v11 offset:10240
    v_cvt_pk_bf16_f32 v32, v32, v33
    v_mfma_f32_16x16x32_bf16 v[136:139], a[200:203], a[4:7], v[136:139]
    s_max_u32 s78, s78, s79
    v_cvt_pk_bf16_f32 v33, v34, v35
    v_accvgpr_write_b32 a90, v32
    v_mfma_f32_16x16x32_bf16 v[144:147], a[200:203], a[8:11], 0
    s_cmp_gt_u32 s78, 3
    s_cbranch_scc1 spin_o2
spin_o2_ret:
    v_accvgpr_write_b32 a91, v33
    v_mfma_f32_16x16x32_bf16 v[144:147], a[204:207], a[24:27], v[144:147]
    buffer_store_dwordx4 a[88:91], v14, s[20:23], s55 offen offset:2048 sc1
    v_mul_f32 v37, v19, v37
    v_mfma_f32_16x16x32_bf16 v[152:155], a[204:207], a[28:31], 0
    s_add_u32 s37, s59, 8192
    v_mul_f32 v38, v19, v38
    v_mul_f32 v39, v19, v39
    v_mfma_f32_16x16x32_bf16 v[152:155], a[200:203], a[12:15], v[152:155]
    buffer_load_dwordx4 a[128:131], v14, s[20:23], s37 offen offset:0 sc1
    v_mfma_f32_16x16x32_bf16 v[156:159], a[208:211], a[12:15], 0
    ds_read_b64_tr_b16 a[200:201], v8 offset:4096
    v_cvt_pk_bf16_f32 v36, v36, v37
    v_mfma_f32_16x16x32_bf16 v[156:159], a[212:215], a[28:31], v[156:159]
    ds_read_b64_tr_b16 a[202:203], v8 offset:6144
    v_cvt_pk_bf16_f32 v37, v38, v39
    v_mfma_f32_16x16x32_bf16 v[148:151], a[212:215], a[24:27], 0
    ds_read_b64_tr_b16 a[204:205], v8 offset:12288
    v_accvgpr_write_b32 a94, v36
    v_mfma_f32_16x16x32_bf16 v[148:151], a[208:211], a[8:11], v[148:151]
    s_waitcnt lgkmcnt(3)
    ds_read_b64_tr_b16 a[206:207], v8 offset:14336
    v_subrev_u32 v8, 139264, v8
    v_mfma_f32_16x16x32_bf16 v[140:143], a[208:211], a[4:7], 0
    v_accvgpr_write_b32 a95, v37
    v_mfma_f32_16x16x32_bf16 v[140:143], a[212:215], a[20:23], v[140:143]
    buffer_store_dwordx4 a[92:95], v14, s[20:23], s55 offen offset:3072 sc1
    v_mfma_f32_16x16x32_bf16 v[132:135], a[212:215], a[16:19], 0
    buffer_load_dwordx4 a[132:135], v14, s[20:23], s37 offen offset:1024 sc1
    v_mfma_f32_16x16x32_bf16 v[132:135], a[208:211], a[0:3], v[132:135]
    s_add_u32 s55, s55, 4096
    ds_read_b64_tr_b16 a[208:209], v9 offset:4096
    v_mfma_f32_16x16x32_bf16 v[160:163], a[184:187], a[0:3], 0
    ds_read_b64_tr_b16 a[210:211], v9 offset:6144
    v_mfma_f32_16x16x32_bf16 v[160:163], a[188:191], a[16:19], v[160:163]
    ds_read_b64_tr_b16 a[212:213], v9 offset:12288
    v_mfma_f32_16x16x32_bf16 v[168:171], a[188:191], a[20:23], 0
    ds_read_b64_tr_b16 a[214:215], v9 offset:14336
    v_subrev_u32 v9, 139264, v9
    v_mfma_f32_16x16x32_bf16 v[168:171], a[184:187], a[4:7], v[168:171]
    v_mfma_f32_16x16x32_bf16 v[176:179], a[184:187], a[8:11], 0
    v_mfma_f32_16x16x32_bf16 v[176:179], a[188:191], a[24:27], v[176:179]
    v_mfma_f32_16x16x32_bf16 v[184:187], a[188:191], a[28:31], 0
    v_mfma_f32_16x16x32_bf16 v[184:187], a[184:187], a[12:15], v[184:187]
    ds_read_b64_tr_b16 a[184:185], v10 offset:4096
    v_mfma_f32_16x16x32_bf16 v[188:191], a[192:195], a[12:15], 0
    buffer_load_dwordx4 a[136:139], v14, s[20:23], s37 offen offset:2048 sc1
    v_mfma_f32_16x16x32_bf16 v[188:191], a[196:199], a[28:31], v[188:191]
    ds_read_b64_tr_b16 a[186:187], v10 offset:6144
    v_mfma_f32_16x16x32_bf16 v[180:183], a[196:199], a[24:27], 0
    ds_read_b64_tr_b16 a[188:189], v10 offset:12288
    v_mfma_f32_16x16x32_bf16 v[180:183], a[192:195], a[8:11], v[180:183]
    s_waitcnt lgkmcnt(3)
    ds_read_b64_tr_b16 a[190:191], v10 offset:14336
    v_subrev_u32 v10, 139264, v10
    v_mfma_f32_16x16x32_bf16 v[172:175], a[192:195], a[4:7], 0
    s_add_u32 m0, s43, 114688
    v_mfma_f32_16x16x32_bf16 v[172:175], a[196:199], a[20:23], v[172:175]
    v_mfma_f32_16x16x32_bf16 v[164:167], a[196:199], a[16:19], 0
    v_mfma_f32_16x16x32_bf16 v[164:167], a[192:195], a[0:3], v[164:167]
    ds_read_b64_tr_b16 a[192:193], v11 offset:4096
    v_mfma_f32_16x16x32_bf16 v[192:195], a[200:203], a[0:3], 0
    ds_read_b64_tr_b16 a[194:195], v11 offset:6144
    v_mfma_f32_16x16x32_bf16 v[192:195], a[204:207], a[16:19], v[192:195]
    ds_read_b64_tr_b16 a[196:197], v11 offset:12288
    v_mfma_f32_16x16x32_bf16 v[200:203], a[204:207], a[20:23], 0
    buffer_load_dwordx4 a[140:143], v14, s[20:23], s37 offen offset:3072 sc1
    v_mfma_f32_16x16x32_bf16 v[200:203], a[200:203], a[4:7], v[200:203]
    ds_read_b64_tr_b16 a[198:199], v11 offset:14336
    v_subrev_u32 v11, 139264, v11
    v_mfma_f32_16x16x32_bf16 v[208:211], a[200:203], a[8:11], 0
    buffer_load_dwordx4 v22, s[28:31], s41 offen lds
    v_mfma_f32_16x16x32_bf16 v[208:211], a[204:207], a[24:27], v[208:211]
    v_mfma_f32_16x16x32_bf16 v[216:219], a[204:207], a[28:31], 0
    v_add_u32 v21, 61440, v14
    v_mfma_f32_16x16x32_bf16 v[216:219], a[200:203], a[12:15], v[216:219]
    v_mfma_f32_16x16x32_bf16 v[220:223], a[208:211], a[12:15], 0
    s_addk_i32 m0, 1024
    v_mfma_f32_16x16x32_bf16 v[220:223], a[212:215], a[28:31], v[220:223]
    s_waitcnt vmcnt(18) lgkmcnt(0)
    v_mfma_f32_16x16x32_bf16 v[212:215], a[212:215], a[24:27], 0
    s_barrier
    v_mfma_f32_16x16x32_bf16 v[212:215], a[208:211], a[8:11], v[212:215]
    ds_read_b64_tr_b16 a[200:201], v12 offset:0
    v_mfma_f32_16x16x32_bf16 v[204:207], a[208:211], a[4:7], 0
    ds_read_b64_tr_b16 a[202:203], v12 offset:1024
    v_mfma_f32_16x16x32_bf16 v[204:207], a[212:215], a[20:23], v[204:207]
    ds_read_b64_tr_b16 a[204:205], v12 offset:2048
    v_mfma_f32_16x16x32_bf16 v[196:199], a[212:215], a[16:19], 0
    buffer_load_dwordx4 v23, s[28:31], s41 offen lds
    v_mfma_f32_16x16x32_bf16 v[196:199], a[208:211], a[0:3], v[196:199]
    s_mov_b64 s[28:29], 0
    ds_read_b64_tr_b16 a[206:207], v12 offset:3072
    v_mfma_f32_16x16x32_bf16 v[224:227], a[184:187], a[0:3], 0
    s_mov_b64 s[30:31], 0
    ds_read_b64_tr_b16 a[208:209], v13 offset:0
    v_mfma_f32_16x16x32_bf16 v[224:227], a[188:191], a[16:19], v[224:227]
    s_mov_b64 s[32:33], 0
    ds_read_b64_tr_b16 a[210:211], v13 offset:1024
    v_mfma_f32_16x16x32_bf16 v[232:235], a[188:191], a[20:23], 0
    s_add_u32 s38, s45, 40960
    ds_read_b64_tr_b16 a[212:213], v13 offset:2048
    s_add_u32 s36, s44, 204800
    v_mfma_f32_16x16x32_bf16 v[232:235], a[184:187], a[4:7], v[232:235]
    s_cmp_lt_u32 s3, 2
    s_cselect_b32 s38, s38, s36
    v_mfma_f32_16x16x32_bf16 v[240:243], a[184:187], a[8:11], 0
    s_add_u32 m0, s63, 90112
    ds_read_b64_tr_b16 a[214:215], v13 offset:3072
    v_mfma_f32_16x16x32_bf16 v[240:243], a[188:191], a[24:27], v[240:243]
    s_mov_b64 s[34:35], 0
    ds_read_b128 v[56:59], v21 offset:0
    v_mfma_f32_16x16x32_bf16 v[248:251], a[188:191], a[28:31], 0
    ds_read_b128 v[60:63], v21 offset:1024
    v_mfma_f32_16x16x32_bf16 v[248:251], a[184:187], a[12:15], v[248:251]
    ds_read_b128 v[64:67], v21 offset:2048
    v_mfma_f32_16x16x32_bf16 v[252:255], a[192:195], a[12:15], 0
    s_waitcnt lgkmcnt(5)
    ds_read_b64_tr_b16 a[184:185], v8 offset:0
    s_load_dwordx4 s[72:75], s[86:87], s5 glc
    v_mfma_f32_16x16x32_bf16 v[252:255], a[196:199], a[28:31], v[252:255]
    ds_read_b64_tr_b16 a[186:187], v8 offset:2048
    v_mfma_f32_16x16x32_bf16 v[244:247], a[196:199], a[24:27], 0
    buffer_load_dwordx4 v7, s[8:11], s38 offen lds
    v_mfma_f32_16x16x32_bf16 v[244:247], a[192:195], a[8:11], v[244:247]
    s_add_u32 s37, s60, 8192
    ds_read_b64_tr_b16 a[188:189], v8 offset:8192
    v_mfma_f32_16x16x32_bf16 v[236:239], a[192:195], a[4:7], 0
    ds_read_b64_tr_b16 a[190:191], v8 offset:10240
    v_mfma_f32_16x16x32_bf16 v[236:239], a[196:199], a[20:23], v[236:239]
    s_waitcnt lgkmcnt(5)
    ds_read_b128 v[68:71], v21 offset:3072
    v_add_f32 v56, v56, v60
    v_mfma_f32_16x16x32_bf16 v[228:231], a[196:199], a[16:19], 0
    s_add_u32 s38, s45, 40960
    ds_read_b128 v[72:75], v21 offset:4096
    v_add_f32 v57, v57, v61
    v_mfma_f32_16x16x32_bf16 v[228:231], a[192:195], a[0:3], v[228:231]
    s_waitcnt lgkmcnt(6)
    ds_read_b128 v[76:79], v21 offset:5120
    v_add_f32 v58, v58, v62
    v_mfma_f32_16x16x32_bf16 v[96:99], a[200:203], a[32:35], v[96:99]
    buffer_load_dwordx4 a[0:3], v14, s[20:23], s37 offen offset:0 sc1
    v_mfma_f32_16x16x32_bf16 v[96:99], a[204:207], a[48:51], v[96:99]
    s_add_u32 m0, s63, 73728
    ds_read_b64_tr_b16 a[192:193], v9 offset:0
    v_add_f32 v59, v59, v63
    v_mfma_f32_16x16x32_bf16 v[104:107], a[204:207], a[52:55], v[104:107]
    ds_read_b64_tr_b16 a[194:195], v9 offset:2048
    v_add_f32 v56, v56, v64
    v_mfma_f32_16x16x32_bf16 v[104:107], a[200:203], a[36:39], v[104:107]
pg_12:
    s_cbranch_execz pg_back
    ds_read_b64_tr_b16 a[196:197], v9 offset:8192
    v_add_f32 v57, v57, v65
    v_mfma_f32_16x16x32_bf16 v[112:115], a[200:203], a[40:43], v[112:115]
    s_waitcnt lgkmcnt(5)
    ds_read_b64_tr_b16 a[198:199], v9 offset:10240
    v_add_f32 v58, v58, v66
    v_mfma_f32_16x16x32_bf16 v[112:115], a[204:207], a[56:59], v[112:115]
    ds_read_b128 v[80:83], v21 offset:6144
    v_add_f32 v59, v59, v67
    v_mfma_f32_16x16x32_bf16 v[120:123], a[204:207], a[60:63], v[120:123]
    buffer_load_dwordx4 v2, s[8:11], s38 offen lds
    v_mfma_f32_16x16x32_bf16 v[120:123], a[200:203], a[44:47], v[120:123]
    ds_read_b128 v[84:87], v21 offset:7168
    v_add_f32 v56, v56, v68
    v_mfma_f32_16x16x32_bf16 v[124:127], a[208:211], a[44:47], v[124:127]
    s_waitcnt lgkmcnt(7)
    ds_read_b64_tr_b16 a[200:201], v10 offset:0
    v_add_f32 v57, v57, v69
    v_mfma_f32_16x16x32_bf16 v[124:127], a[212:215], a[60:63], v[124:127]
    s_waitcnt vmcnt(8)
    ds_read_b64_tr_b16 a[202:203], v10 offset:2048
    v_add_f32 v58, v58, v70
    v_mfma_f32_16x16x32_bf16 v[116:119], a[212:215], a[56:59], v[116:119]
    buffer_store_dword v55, v15, s[24:27], s76 offen sc1
    v_mfma_f32_16x16x32_bf16 v[116:119], a[208:211], a[40:43], v[116:119]
    buffer_load_dwordx4 a[4:7], v14, s[20:23], s37 offen offset:1024 sc1
    v_mfma_f32_16x16x32_bf16 v[108:111], a[208:211], a[36:39], v[108:111]
    s_add_u32 s38, s45, 40960
    ds_read_b64_tr_b16 a[204:205], v10 offset:8192
    v_add_f32 v59, v59, v71
    v_mfma_f32_16x16x32_bf16 v[108:111], a[212:215], a[52:55], v[108:111]
    s_addk_i32 m0, 4096
    ds_read_b64_tr_b16 a[206:207], v10 offset:10240
    v_add_f32 v56, v56, v72
    v_mfma_f32_16x16x32_bf16 v[100:103], a[212:215], a[48:51], v[100:103]
    s_waitcnt lgkmcnt(6)
    ds_read_b128 v[88:91], v21 offset:8192
    v_add_f32 v57, v57, v73
    v_mfma_f32_16x16x32_bf16 v[100:103], a[208:211], a[32:35], v[100:103]
    ds_read_b128 v[92:95], v21 offset:9216
    v_add_f32 v58, v58, v74
    v_mfma_f32_16x16x32_bf16 v[128:131], a[184:187], a[32:35], v[128:131]
    ds_read_b64_tr_b16 a[208:209], v11 offset:0
    v_add_f32 v59, v59, v75
    v_mfma_f32_16x16x32_bf16 v[128:131], a[188:191], a[48:51], v[128:131]
    ds_read_b64_tr_b16 a[210:211], v11 offset:2048
    v_add_f32 v56, v56, v76
    v_mfma_f32_16x16x32_bf16 v[136:139], a[188:191], a[52:55], v[136:139]
    buffer_load_dwordx4 v3, s[8:11], s38 offen lds
    v_mfma_f32_16x16x32_bf16 v[136:139], a[184:187], a[36:39], v[136:139]
    s_waitcnt lgkmcnt(7)
    ds_read_b64_tr_b16 a[212:213], v11 offset:8192
    v_add_f32 v57, v57, v77
    v_mfma_f32_16x16x32_bf16 v[144:147], a[184:187], a[40:43], v[144:147]
    buffer_load_dwordx4 a[8:11], v14, s[20:23], s37 offen offset:2048 sc1
    v_mfma_f32_16x16x32_bf16 v[144:147], a[188:191], a[56:59], v[144:147]
    ds_read_b64_tr_b16 a[214:215], v11 offset:10240
    v_add_f32 v58, v58, v78
    v_mfma_f32_16x16x32_bf16 v[152:155], a[188:191], a[60:63], v[152:155]
    s_add_u32 s38, s44, 204800
    v_add_f32 v59, v59, v79
    v_add_f32 v56, v56, v80
    v_mfma_f32_16x16x32_bf16 v[152:155], a[184:187], a[44:47], v[152:155]
    ds_read_b64_tr_b16 a[184:185], v8 offset:4096
    v_add_f32 v57, v57, v81
    v_mfma_f32_16x16x32_bf16 v[156:159], a[192:195], a[44:47], v[156:159]
    s_addk_i32 m0, 4096
    ds_read_b64_tr_b16 a[186:187], v8 offset:6144
    v_add_f32 v58, v58, v82
    v_mfma_f32_16x16x32_bf16 v[156:159], a[196:199], a[60:63], v[156:159]
    s_waitcnt lgkmcnt(6)
    ds_read_b64_tr_b16 a[188:189], v8 offset:12288
    v_add_f32 v59, v59, v83
    v_mfma_f32_16x16x32_bf16 v[148:151], a[196:199], a[56:59], v[148:151]
    ds_read_b64_tr_b16 a[190:191], v8 offset:14336
    v_add_f32 v56, v56, v84
    v_mfma_f32_16x16x32_bf16 v[148:151], a[192:195], a[40:43], v[148:151]
    v_add_f32 v57, v57, v85
    v_add_f32 v58, v58, v86
    v_mfma_f32_16x16x32_bf16 v[140:143], a[192:195], a[36:39], v[140:143]
    v_add_f32 v59, v59, v87
    v_add_f32 v56, v56, v88
    v_mfma_f32_16x16x32_bf16 v[140:143], a[196:199], a[52:55], v[140:143]
    v_add_f32 v57, v57, v89
    v_add_f32 v58, v58, v90
    v_mfma_f32_16x16x32_bf16 v[132:135], a[196:199], a[48:51], v[132:135]
    buffer_load_dwordx4 a[12:15], v14, s[20:23], s37 offen offset:3072 sc1
    v_mfma_f32_16x16x32_bf16 v[132:135], a[192:195], a[32:35], v[132:135]
    buffer_load_dwordx4 v2, s[8:11], s38 offen lds
    v_mfma_f32_16x16x32_bf16 v[160:163], a[200:203], a[32:35], v[160:163]
    ds_read_b64_tr_b16 a[192:193], v9 offset:4096
    v_add_f32 v59, v59, v91
    v_mfma_f32_16x16x32_bf16 v[160:163], a[204:207], a[48:51], v[160:163]
    ds_read_b64_tr_b16 a[194:195], v9 offset:6144
    v_add_f32 v56, v56, v92
    v_mfma_f32_16x16x32_bf16 v[168:171], a[204:207], a[52:55], v[168:171]
    s_add_u32 s37, s61, 8192
    ds_read_b64_tr_b16 a[196:197], v9 offset:12288
    v_add_f32 v57, v57, v93
    v_mfma_f32_16x16x32_bf16 v[168:171], a[200:203], a[36:39], v[168:171]
    s_waitcnt lgkmcnt(5)
    ds_read_b64_tr_b16 a[198:199], v9 offset:14336
    v_add_f32 v58, v58, v94
    v_mfma_f32_16x16x32_bf16 v[176:179], a[200:203], a[40:43], v[176:179]
    s_add_u32 s38, s44, 204800
    v_add_f32 v59, v59, v95
    v_cvt_pk_bf16_f32 v56, 0, v56
    v_mfma_f32_16x16x32_bf16 v[176:179], a[204:207], a[56:59], v[176:179]
    s_addk_i32 m0, 4096
    v_cvt_pk_bf16_f32 v57, 0, v57
    v_cvt_pk_bf16_f32 v58, 0, v58
    v_mfma_f32_16x16x32_bf16 v[184:187], a[204:207], a[60:63], v[184:187]
    v_cvt_pk_bf16_f32 v59, 0, v59
    v_mul_f32 v60, s92, v56
    v_mfma_f32_16x16x32_bf16 v[184:187], a[200:203], a[44:47], v[184:187]
    ds_read_b64_tr_b16 a[200:201], v10 offset:4096
    v_mul_f32 v61, s92, v57
    v_mfma_f32_16x16x32_bf16 v[188:191], a[208:211], a[44:47], v[188:191]
    buffer_load_dwordx4 a[16:19], v14, s[20:23], s37 offen offset:0 sc1
    v_mfma_f32_16x16x32_bf16 v[188:191], a[212:215], a[60:63], v[188:191]
    ds_read_b64_tr_b16 a[202:203], v10 offset:6144
    v_lshlrev_b32 v64, 1, v1
    v_mfma_f32_16x16x32_bf16 v[180:183], a[212:215], a[56:59], v[180:183]
    buffer_load_dwordx4 v3, s[8:11], s38 offen lds
    v_mfma_f32_16x16x32_bf16 v[180:183], a[208:211], a[40:43], v[180:183]
    ds_read_b64_tr_b16 a[204:205], v10 offset:12288
    v_add_u32 v64, s56, v64
    v_mfma_f32_16x16x32_bf16 v[172:175], a[208:211], a[36:39], v[172:175]
    ds_read_b64_tr_b16 a[206:207], v10 offset:14336
    v_and_b32 v65, 1, v1
    v_mfma_f32_16x16x32_bf16 v[172:175], a[212:215], a[52:55], v[172:175]
    v_exp_f32 v60, v60
    v_mfma_f32_16x16x32_bf16 v[164:167], a[212:215], a[48:51], v[164:167]
    s_waitcnt lgkmcnt(3)
    v_exp_f32 v61, v61
    v_mfma_f32_16x16x32_bf16 v[164:167], a[208:211], a[32:35], v[164:167]
    s_add_u32 s38, s46, 40960
    ds_read_b64_tr_b16 a[208:209], v11 offset:4096
    v_add_f32 v60, 1.0, v60
    v_mfma_f32_16x16x32_bf16 v[192:195], a[184:187], a[32:35], v[192:195]
    s_add_u32 s36, s47, 40960
    ds_read_b64_tr_b16 a[210:211], v11 offset:6144
    v_add_f32 v61, 1.0, v61
    v_mfma_f32_16x16x32_bf16 v[192:195], a[188:191], a[48:51], v[192:195]
    s_cmp_lt_u32 s3, 2
    s_cselect_b32 s38, s38, s36
    v_lshlrev_b32 v65, 7, v65
    v_mfma_f32_16x16x32_bf16 v[200:203], a[188:191], a[52:55], v[200:203]
    s_addk_i32 m0, 24576
    ds_read_b64_tr_b16 a[212:213], v11 offset:12288
    v_lshrrev_b32 v67, 4, v1
    v_mfma_f32_16x16x32_bf16 v[200:203], a[184:187], a[36:39], v[200:203]
    s_add_u32 s77, s7, 4
    ds_read_b64_tr_b16 a[214:215], v11 offset:14336
    v_lshl_add_u32 v65, v67, 4, v65
    v_mfma_f32_16x16x32_bf16 v[208:211], a[184:187], a[40:43], v[208:211]
    buffer_load_dwordx4 a[20:23], v14, s[20:23], s37 offen offset:1024 sc1
    v_mfma_f32_16x16x32_bf16 v[208:211], a[188:191], a[56:59], v[208:211]
    v_rcp_f32 v60, v60
    v_mfma_f32_16x16x32_bf16 v[216:219], a[188:191], a[60:63], v[216:219]
    buffer_load_dwordx4 v7, s[8:11], s38 offen lds
    v_mfma_f32_16x16x32_bf16 v[216:219], a[184:187], a[44:47], v[216:219]
    v_rcp_f32 v61, v61
    v_mfma_f32_16x16x32_bf16 v[220:223], a[192:195], a[44:47], v[220:223]
    v_mul_f32 v56, v56, v60
    v_cvt_pk_bf16_f32 v56, 0, v56
    v_mfma_f32_16x16x32_bf16 v[220:223], a[196:199], a[60:63], v[220:223]
    s_waitcnt lgkmcnt(0)
    v_mul_f32 v56, v56, v58
    v_mul_f32 v57, v57, v61
    v_mfma_f32_16x16x32_bf16 v[212:215], a[196:199], a[56:59], v[212:215]
    s_barrier
    v_mfma_f32_16x16x32_bf16 v[212:215], a[192:195], a[40:43], v[212:215]
    s_add_u32 s38, s46, 40960
    ds_read_b64_tr_b16 a[184:185], v12 offset:20480
    v_cvt_pk_bf16_f32 v57, 0, v57
    v_mfma_f32_16x16x32_bf16 v[204:207], a[192:195], a[36:39], v[204:207]
    buffer_load_dwordx4 a[24:27], v14, s[20:23], s37 offen offset:2048 sc1
    v_mfma_f32_16x16x32_bf16 v[204:207], a[196:199], a[52:55], v[204:207]
    s_addk_i32 m0, -16384
    ds_read_b64_tr_b16 a[186:187], v12 offset:21504
    v_mul_f32 v57, v57, v59
    v_mfma_f32_16x16x32_bf16 v[196:199], a[196:199], a[48:51], v[196:199]
    ds_read_b64_tr_b16 a[188:189], v12 offset:22528
    v_cvt_pk_bf16_f32 v56, v56, v57
    v_mfma_f32_16x16x32_bf16 v[196:199], a[192:195], a[32:35], v[196:199]
    ds_write_b16 v64, v56
    v_mfma_f32_16x16x32_bf16 v[224:227], a[200:203], a[32:35], v[224:227]
    ds_write_b16_d16_hi v64, v56 offset:128
    v_mfma_f32_16x16x32_bf16 v[224:227], a[204:207], a[48:51], v[224:227]
    ds_read_b64_tr_b16 a[190:191], v12 offset:23552
    v_add_u32 v65, s56, v65
    v_mfma_f32_16x16x32_bf16 v[232:235], a[204:207], a[52:55], v[232:235]
    buffer_load_dwordx4 v2, s[8:11], s38 offen lds
    v_mfma_f32_16x16x32_bf16 v[232:235], a[200:203], a[36:39], v[232:235]
    ds_read_b128 v[68:71], v65
    v_bfe_u32 v67, v1, 2, 3
    v_mfma_f32_16x16x32_bf16 v[240:243], a[200:203], a[40:43], v[240:243]
    ds_read_b128 v[72:75], v65 offset:64
    v_lshlrev_b32 v66, 7, v67
    v_mfma_f32_16x16x32_bf16 v[240:243], a[204:207], a[56:59], v[240:243]
    ds_read_b64_tr_b16 a[192:193], v13 offset:20480
    v_lshrrev_b32 v67, 1, v67
    v_mfma_f32_16x16x32_bf16 v[248:251], a[204:207], a[60:63], v[248:251]
    buffer_load_dwordx4 a[28:31], v14, s[20:23], s37 offen offset:3072 sc1
    v_mfma_f32_16x16x32_bf16 v[248:251], a[200:203], a[44:47], v[248:251]
    s_add_u32 s38, s46, 40960
    ds_read_b64_tr_b16 a[194:195], v13 offset:21504
    v_xor_b32 v67, s3, v67
    v_mfma_f32_16x16x32_bf16 v[252:255], a[208:211], a[44:47], v[252:255]
    s_addk_i32 m0, 4096
    ds_read_b64_tr_b16 a[196:197], v13 offset:22528
    v_lshl_add_u32 v66, v67, 5, v66
    v_mfma_f32_16x16x32_bf16 v[252:255], a[212:215], a[60:63], v[252:255]
    s_waitcnt lgkmcnt(5)
    ds_read_b64_tr_b16 a[198:199], v13 offset:23552
    v_and_b32 v67, 3, v1
    v_mfma_f32_16x16x32_bf16 v[244:247], a[212:215], a[56:59], v[244:247]
    s_sub_u32 s78, s72, s77
    ds_read_b64_tr_b16 a[200:201], v8 offset:20480
    v_lshl_add_u32 v66, v67, 3, v66
    v_mfma_f32_16x16x32_bf16 v[244:247], a[208:211], a[40:43], v[244:247]
    s_sub_u32 s79, s73, s77
    ds_read_b64_tr_b16 a[202:203], v8 offset:22528
    v_lshrrev_b32 v67, 5, v1
    v_mfma_f32_16x16x32_bf16 v[236:239], a[208:211], a[36:39], v[236:239]
    s_max_u32 s78, s78, s79
    ds_read_b64_tr_b16 a[204:205], v8 offset:28672
    v_mul_u32_u24 v67, 1024, v67
    v_mfma_f32_16x16x32_bf16 v[236:239], a[212:215], a[52:55], v[236:239]
    s_sub_u32 s79, s74, s77
    ds_read_b64_tr_b16 a[206:207], v8 offset:30720
    v_add_u32 v66, v66, v67
    v_mfma_f32_16x16x32_bf16 v[228:231], a[212:215], a[48:51], v[228:231]
    buffer_load_dwordx4 v3, s[8:11], s38 offen lds
    v_mfma_f32_16x16x32_bf16 v[228:231], a[208:211], a[32:35], v[228:231]
    s_max_u32 s78, s78, s79
    ds_read_b64_tr_b16 a[208:209], v9 offset:20480
    v_add_u32 v66, 114688, v66
    v_mfma_f32_16x16x32_bf16 v[96:99], a[184:187], a[64:67], v[96:99]
    s_waitcnt lgkmcnt(5)
    ds_read_b64_tr_b16 a[210:211], v9 offset:22528
    v_lshlrev_b32 v62, 2, v1
    v_mfma_f32_16x16x32_bf16 v[96:99], a[188:191], a[216:219], v[96:99]
    s_sub_u32 s79, s75, s77
    ds_read_b64_tr_b16 a[212:213], v9 offset:28672
    v_mov_b32 v67, 0x7ffffff0
    v_mfma_f32_16x16x32_bf16 v[104:107], a[188:191], a[220:223], v[104:107]
    s_max_u32 s78, s78, s79
    ds_read_b64_tr_b16 a[214:215], v9 offset:30720
    v_cndmask_b32 v62, v67, v62, vcc
    v_mfma_f32_16x16x32_bf16 v[104:107], a[184:187], a[68:71], v[104:107]
    s_cmp_gt_u32 s78, 2
    s_cbranch_scc1 spin_o3
spin_o3_ret:
    s_load_dwordx4 s[72:75], s[86:87], s5 glc
    v_mfma_f32_16x16x32_bf16 v[112:115], a[184:187], a[72:75], v[112:115]
    s_add_u32 s37, s59, 12288
    s_add_u32 s38, s47, 40960
    s_add_u32 m0, s63, 102400
    v_mfma_f32_16x16x32_bf16 v[112:115], a[188:191], a[224:227], v[112:115]
    buffer_load_dwordx4 a[32:35], v14, s[20:23], s37 offen offset:0 sc1
    v_mfma_f32_16x16x32_bf16 v[120:123], a[188:191], a[228:231], v[120:123]
    v_mfma_f32_16x16x32_bf16 v[120:123], a[184:187], a[76:79], v[120:123]
    ds_read_b64_tr_b16 a[184:185], v10 offset:20480
    v_mfma_f32_16x16x32_bf16 v[124:127], a[192:195], a[76:79], v[124:127]
    ds_read_b64_tr_b16 a[186:187], v10 offset:22528
    v_mfma_f32_16x16x32_bf16 v[124:127], a[196:199], a[228:231], v[124:127]
    ds_read_b64_tr_b16 a[188:189], v10 offset:28672
    v_mfma_f32_16x16x32_bf16 v[116:119], a[196:199], a[224:227], v[116:119]
    s_waitcnt lgkmcnt(5)
    ds_read_b64_tr_b16 a[190:191], v10 offset:30720
    v_mfma_f32_16x16x32_bf16 v[116:119], a[192:195], a[72:75], v[116:119]
    buffer_load_dwordx4 a[36:39], v14, s[20:23], s37 offen offset:1024 sc1
    v_mfma_f32_16x16x32_bf16 v[108:111], a[192:195], a[68:71], v[108:111]
    buffer_load_dwordx4 v2, s[8:11], s38 offen lds
    v_mfma_f32_16x16x32_bf16 v[108:111], a[196:199], a[220:223], v[108:111]
    v_mfma_f32_16x16x32_bf16 v[100:103], a[196:199], a[216:219], v[100:103]
    s_add_u32 s38, s47, 40960
    v_mfma_f32_16x16x32_bf16 v[100:103], a[192:195], a[64:67], v[100:103]
    ds_read_b64_tr_b16 a[192:193], v11 offset:20480
    v_mfma_f32_16x16x32_bf16 v[128:131], a[200:203], a[64:67], v[128:131]
    s_addk_i32 m0, 4096
    ds_read_b64_tr_b16 a[194:195], v11 offset:22528
    v_mfma_f32_16x16x32_bf16 v[128:131], a[204:207], a[216:219], v[128:131]
    ds_read_b64_tr_b16 a[196:197], v11 offset:28672
    v_mfma_f32_16x16x32_bf16 v[136:139], a[204:207], a[220:223], v[136:139]
    ds_read_b64_tr_b16 a[198:199], v11 offset:30720
    v_mfma_f32_16x16x32_bf16 v[136:139], a[200:203], a[68:71], v[136:139]
    v_mfma_f32_16x16x32_bf16 v[144:147], a[200:203], a[72:75], v[144:147]
    buffer_load_dwordx4 a[40:43], v14, s[20:23], s37 offen offset:2048 sc1
    v_mfma_f32_16x16x32_bf16 v[144:147], a[204:207], a[224:227], v[144:147]
    v_mfma_f32_16x16x32_bf16 v[152:155], a[204:207], a[228:231], v[152:155]
    buffer_load_dwordx4 v3, s[8:11], s38 offen lds
    v_mfma_f32_16x16x32_bf16 v[152:155], a[200:203], a[76:79], v[152:155]
    s_waitcnt lgkmcnt(4)
    ds_read_b64_tr_b16 a[200:201], v8 offset:24576
    v_mfma_f32_16x16x32_bf16 v[156:159], a[208:211], a[76:79], v[156:159]
    ds_read_b64_tr_b16 a[202:203], v8 offset:26624
    v_mfma_f32_16x16x32_bf16 v[156:159], a[212:215], a[228:231], v[156:159]
    ds_read_b64_tr_b16 a[204:205], v8 offset:32768
    v_mfma_f32_16x16x32_bf16 v[148:151], a[212:215], a[224:227], v[148:151]
    s_add_u32 s38, s45, 81920
    ds_read_b64_tr_b16 a[206:207], v8 offset:34816
    s_add_u32 s36, s46, 81920
    v_mfma_f32_16x16x32_bf16 v[148:151], a[208:211], a[72:75], v[148:151]
    s_cmp_lt_u32 s3, 2
    s_cselect_b32 s38, s38, s36
    v_mfma_f32_16x16x32_bf16 v[140:143], a[208:211], a[68:71], v[140:143]
    s_add_u32 m0, s63, 139264
    v_mfma_f32_16x16x32_bf16 v[140:143], a[212:215], a[220:223], v[140:143]
    v_mfma_f32_16x16x32_bf16 v[132:135], a[212:215], a[216:219], v[132:135]
    buffer_load_dwordx4 a[44:47], v14, s[20:23], s37 offen offset:3072 sc1
    v_mfma_f32_16x16x32_bf16 v[132:135], a[208:211], a[64:67], v[132:135]
    ds_read_b64_tr_b16 a[208:209], v9 offset:24576
    v_mfma_f32_16x16x32_bf16 v[160:163], a[184:187], a[64:67], v[160:163]
    ds_read_b64_tr_b16 a[210:211], v9 offset:26624
    v_mfma_f32_16x16x32_bf16 v[160:163], a[188:191], a[216:219], v[160:163]
    ds_read_b64_tr_b16 a[212:213], v9 offset:32768
    v_mfma_f32_16x16x32_bf16 v[168:171], a[188:191], a[220:223], v[168:171]
    s_waitcnt lgkmcnt(5)
    ds_read_b64_tr_b16 a[214:215], v9 offset:34816
    s_add_u32 s37, s60, 12288
    v_mfma_f32_16x16x32_bf16 v[168:171], a[184:187], a[68:71], v[168:171]
    buffer_load_dwordx4 v7, s[8:11], s38 offen lds
    v_mfma_f32_16x16x32_bf16 v[176:179], a[184:187], a[72:75], v[176:179]
    v_mfma_f32_16x16x32_bf16 v[176:179], a[188:191], a[224:227], v[176:179]
    v_mfma_f32_16x16x32_bf16 v[184:187], a[188:191], a[228:231], v[184:187]
    v_mfma_f32_16x16x32_bf16 v[184:187], a[184:187], a[76:79], v[184:187]
    ds_read_b64_tr_b16 a[184:185], v10 offset:24576
    v_mfma_f32_16x16x32_bf16 v[188:191], a[192:195], a[76:79], v[188:191]
    buffer_load_dwordx4 a[48:51], v14, s[20:23], s37 offen offset:0 sc1
    v_mfma_f32_16x16x32_bf16 v[188:191], a[196:199], a[228:231], v[188:191]
    s_mov_b32 s16, s84
    ds_read_b64_tr_b16 a[186:187], v10 offset:26624
    v_and_b32 v5, 15, v1
    v_mfma_f32_16x16x32_bf16 v[180:183], a[196:199], a[224:227], v[180:183]
    s_and_b32 s17, s85, 0xffff
    ds_read_b64_tr_b16 a[188:189], v10 offset:32768
    v_add_u32 v5, s6, v5
    v_mfma_f32_16x16x32_bf16 v[180:183], a[192:195], a[72:75], v[180:183]
    s_mov_b32 s18, 2621440
    ds_read_b64_tr_b16 a[190:191], v10 offset:34816
    v_bfe_u32 v50, v1, 4, 1
    v_mfma_f32_16x16x32_bf16 v[172:175], a[192:195], a[68:71], v[172:175]
    s_mov_b32 s19, 0x00020000
    v_bfe_u32 v51, v1, 5, 1
    v_lshl_add_u32 v50, v50, 1, v51
    v_mfma_f32_16x16x32_bf16 v[172:175], a[196:199], a[220:223], v[172:175]
    s_and_b32 s56, s53, 4
    v_mul_u32_u24 v4, 1280, v5
    v_lshl_add_u32 v4, v50, 4, v4
    v_mfma_f32_16x16x32_bf16 v[164:167], a[196:199], a[216:219], v[164:167]
    s_waitcnt lgkmcnt(5)
    v_xor_b32 v51, 16, v5
    v_mul_u32_u24 v35, 1280, v51
    v_mfma_f32_16x16x32_bf16 v[164:167], a[192:195], a[64:67], v[164:167]
    s_add_u32 s38, s47, 81920
    ds_read_b64_tr_b16 a[192:193], v11 offset:24576
    v_lshl_add_u32 v34, v50, 4, v35
    v_mfma_f32_16x16x32_bf16 v[192:195], a[200:203], a[64:67], v[192:195]
    s_add_u32 s36, s45, 122880
    ds_read_b64_tr_b16 a[194:195], v11 offset:26624
    v_and_b32 v51, 0xfffffff7, v51
    v_mfma_f32_16x16x32_bf16 v[192:195], a[204:207], a[216:219], v[192:195]
    s_cmp_lt_u32 s3, 2
    s_cselect_b32 s38, s38, s36
    v_lshrrev_b32 v50, 4, v1
    v_mfma_f32_16x16x32_bf16 v[200:203], a[204:207], a[220:223], v[200:203]
    s_addk_i32 m0, 4096
    ds_read_b64_tr_b16 a[196:197], v11 offset:32768
    s_lshl_b32 s56, s56, 1
    v_mfma_f32_16x16x32_bf16 v[200:203], a[200:203], a[68:71], v[200:203]
    ds_read_b64_tr_b16 a[198:199], v11 offset:34816
    v_or_b32 v37, s56, v51
    v_mfma_f32_16x16x32_bf16 v[208:211], a[200:203], a[72:75], v[208:211]
    buffer_load_dwordx4 a[52:55], v14, s[20:23], s37 offen offset:1024 sc1
    v_mfma_f32_16x16x32_bf16 v[208:211], a[204:207], a[224:227], v[208:211]
    s_xor_b32 s56, s56, 8
    v_mul_u32_u24 v35, 1280, v37
    v_lshl_add_u32 v35, v50, 3, v35
    v_mfma_f32_16x16x32_bf16 v[216:219], a[204:207], a[228:231], v[216:219]
    buffer_load_dwordx4 v7, s[8:11], s38 offen lds
    v_mfma_f32_16x16x32_bf16 v[216:219], a[200:203], a[76:79], v[216:219]
    s_waitcnt lgkmcnt(2)
    v_xor_b32 v50, s56, v1
    v_and_b32 v50, 8, v50
    v_mfma_f32_16x16x32_bf16 v[220:223], a[208:211], a[76:79], v[220:223]
    v_lshl_add_u32 v35, v50, 2, v35
    v_lshlrev_b32 v52, 3, v37
    v_mfma_f32_16x16x32_bf16 v[220:223], a[212:215], a[228:231], v[220:223]
    s_waitcnt vmcnt(27) lgkmcnt(0)
    v_add_u32 v52, 3211264, v52
    v_lshlrev_b32 v50, 3, v5
    v_mfma_f32_16x16x32_bf16 v[212:215], a[212:215], a[224:227], v[212:215]
    s_barrier
    v_mfma_f32_16x16x32_bf16 v[212:215], a[208:211], a[72:75], v[212:215]
    ds_read_b64_tr_b16 a[200:201], v12 offset:40960
    v_add_u32 v50, 3211264, v50
    v_mfma_f32_16x16x32_bf16 v[204:207], a[208:211], a[68:71], v[204:207]
    buffer_load_dwordx4 a[56:59], v14, s[20:23], s37 offen offset:2048 sc1
    v_mfma_f32_16x16x32_bf16 v[204:207], a[212:215], a[220:223], v[204:207]
    ds_read_b64_tr_b16 a[202:203], v12 offset:41984
    v_xor_b32 v51, 128, v50
    v_mfma_f32_16x16x32_bf16 v[196:199], a[212:215], a[216:219], v[196:199]
    ds_read_b64_tr_b16 a[204:205], v12 offset:43008
    v_mfma_f32_16x16x32_bf16 v[196:199], a[208:211], a[64:67], v[196:199]
    ds_read_b64_tr_b16 a[206:207], v12 offset:44032
    v_add_u32 v12, 73728, v12
    v_mfma_f32_16x16x32_bf16 v[224:227], a[184:187], a[64:67], v[224:227]
    ds_read_b64_tr_b16 a[208:209], v13 offset:40960
    v_mfma_f32_16x16x32_bf16 v[224:227], a[188:191], a[216:219], v[224:227]
    ds_read_b64_tr_b16 a[210:211], v13 offset:41984
    v_mfma_f32_16x16x32_bf16 v[232:235], a[188:191], a[220:223], v[232:235]
    s_add_u32 s38, s46, 122880
    ds_read_b64_tr_b16 a[212:213], v13 offset:43008
    s_add_u32 s36, s47, 122880
    v_mfma_f32_16x16x32_bf16 v[232:235], a[184:187], a[68:71], v[232:235]
    s_cmp_lt_u32 s3, 2
    s_cselect_b32 s38, s38, s36
    v_mfma_f32_16x16x32_bf16 v[240:243], a[184:187], a[72:75], v[240:243]
    s_addk_i32 m0, 4096
    ds_read_b64_tr_b16 a[214:215], v13 offset:44032
    v_add_u32 v13, 73728, v13
    v_mfma_f32_16x16x32_bf16 v[240:243], a[188:191], a[224:227], v[240:243]
    v_mfma_f32_16x16x32_bf16 v[248:251], a[188:191], a[228:231], v[248:251]
    buffer_load_dwordx4 a[60:63], v14, s[20:23], s37 offen offset:3072 sc1
    v_mfma_f32_16x16x32_bf16 v[248:251], a[184:187], a[76:79], v[248:251]
    ds_read_b64_tr_b16 a[184:185], v8 offset:40960
    v_mfma_f32_16x16x32_bf16 v[252:255], a[192:195], a[76:79], v[252:255]
    ds_read_b64_tr_b16 a[186:187], v8 offset:43008
    v_mfma_f32_16x16x32_bf16 v[252:255], a[196:199], a[228:231], v[252:255]
    ds_read_b64_tr_b16 a[188:189], v8 offset:49152
    v_mfma_f32_16x16x32_bf16 v[244:247], a[196:199], a[224:227], v[244:247]
    s_waitcnt lgkmcnt(4)
    ds_read_b64_tr_b16 a[190:191], v8 offset:51200
    s_add_u32 s37, s61, 12288
    v_mfma_f32_16x16x32_bf16 v[244:247], a[192:195], a[72:75], v[244:247]
    buffer_load_dwordx4 v7, s[8:11], s38 offen lds
    v_mfma_f32_16x16x32_bf16 v[236:239], a[192:195], a[68:71], v[236:239]
    v_mfma_f32_16x16x32_bf16 v[236:239], a[196:199], a[220:223], v[236:239]
    v_mfma_f32_16x16x32_bf16 v[228:231], a[196:199], a[216:219], v[228:231]
    v_mfma_f32_16x16x32_bf16 v[228:231], a[192:195], a[64:67], v[228:231]
    ds_read_b64_tr_b16 a[192:193], v9 offset:40960
    v_mfma_f32_16x16x32_bf16 v[96:99], a[200:203], a[232:235], v[96:99]
    buffer_load_dwordx4 a[64:67], v14, s[20:23], s37 offen offset:0 sc1
    v_mfma_f32_16x16x32_bf16 v[96:99], a[204:207], a[152:155], v[96:99]
    buffer_load_dwordx2 v[16:17], v50, s[24:27], 0 offen sc1
    v_mfma_f32_16x16x32_bf16 v[104:107], a[204:207], a[156:159], v[104:107]
    ds_read_b64_tr_b16 a[194:195], v9 offset:43008
    v_mfma_f32_16x16x32_bf16 v[104:107], a[200:203], a[236:239], v[104:107]
    ds_read_b64_tr_b16 a[196:197], v9 offset:49152
    v_mfma_f32_16x16x32_bf16 v[112:115], a[200:203], a[240:243], v[112:115]
    ds_read_b64_tr_b16 a[198:199], v9 offset:51200
    v_mfma_f32_16x16x32_bf16 v[112:115], a[204:207], a[160:163], v[112:115]
    ds_read_b64_tr_b16 v[76:77], v66 offset:0
    v_mfma_f32_16x16x32_bf16 v[120:123], a[204:207], a[164:167], v[120:123]
    s_waitcnt lgkmcnt(4)
    ds_read_b64_tr_b16 v[78:79], v66 offset:2048
    s_add_u32 s38, s45, 163840
    v_mfma_f32_16x16x32_bf16 v[120:123], a[200:203], a[244:247], v[120:123]
    s_add_u32 s36, s46, 163840
    ds_read_b64_tr_b16 v[80:81], v66 offset:4096
    v_mfma_f32_16x16x32_bf16 v[124:127], a[208:211], a[244:247], v[124:127]
    s_cmp_lt_u32 s3, 2
    s_cselect_b32 s38, s38, s36
    s_addk_i32 m0, 4096
    v_mfma_f32_16x16x32_bf16 v[124:127], a[212:215], a[164:167], v[124:127]
    ds_read_b64_tr_b16 v[82:83], v66 offset:6144
    v_mfma_f32_16x16x32_bf16 v[116:119], a[212:215], a[160:163], v[116:119]
    buffer_load_dwordx4 a[68:71], v14, s[20:23], s37 offen offset:1024 sc1
    v_mfma_f32_16x16x32_bf16 v[116:119], a[208:211], a[240:243], v[116:119]
    s_add_u32 s77, s7, 5
    ds_read_b64_tr_b16 a[200:201], v10 offset:40960
    v_mfma_f32_16x16x32_bf16 v[108:111], a[208:211], a[236:239], v[108:111]
    ds_read_b64_tr_b16 a[202:203], v10 offset:43008
    v_mfma_f32_16x16x32_bf16 v[108:111], a[212:215], a[156:159], v[108:111]
    ds_read_b64_tr_b16 a[204:205], v10 offset:49152
    v_mfma_f32_16x16x32_bf16 v[100:103], a[212:215], a[152:155], v[100:103]
    buffer_load_dwordx4 v7, s[8:11], s38 offen lds
    v_mfma_f32_16x16x32_bf16 v[100:103], a[208:211], a[232:235], v[100:103]
    buffer_load_dwordx2 v[18:19], v51, s[24:27], 0 offen sc1
    v_mfma_f32_16x16x32_bf16 v[128:131], a[184:187], a[232:235], v[128:131]
    ds_read_b64_tr_b16 a[206:207], v10 offset:51200
    v_mfma_f32_16x16x32_bf16 v[128:131], a[188:191], a[152:155], v[128:131]
    s_waitcnt lgkmcnt(4)
    ds_read_b64_tr_b16 a[208:209], v11 offset:40960
    v_mfma_f32_16x16x32_bf16 v[136:139], a[188:191], a[156:159], v[136:139]
    ds_read_b64_tr_b16 a[210:211], v11 offset:43008
    v_mfma_f32_16x16x32_bf16 v[136:139], a[184:187], a[236:239], v[136:139]
    ds_read_b64_tr_b16 a[212:213], v11 offset:49152
    v_mfma_f32_16x16x32_bf16 v[144:147], a[184:187], a[240:243], v[144:147]
    buffer_load_dwordx4 a[72:75], v14, s[20:23], s37 offen offset:2048 sc1
    v_mfma_f32_16x16x32_bf16 v[144:147], a[188:191], a[160:163], v[144:147]
    ds_read_b64_tr_b16 a[214:215], v11 offset:51200
    v_mfma_f32_16x16x32_bf16 v[152:155], a[188:191], a[164:167], v[152:155]
    v_mfma_f32_16x16x32_bf16 v[152:155], a[184:187], a[244:247], v[152:155]
    ds_read_b64_tr_b16 a[184:185], v8 offset:45056
    v_mfma_f32_16x16x32_bf16 v[156:159], a[192:195], a[244:247], v[156:159]
    ds_read_b64_tr_b16 a[186:187], v8 offset:47104
    v_mfma_f32_16x16x32_bf16 v[156:159], a[196:199], a[164:167], v[156:159]
    ds_read_b64_tr_b16 a[188:189], v8 offset:53248
    v_mfma_f32_16x16x32_bf16 v[148:151], a[196:199], a[160:163], v[148:151]
    s_waitcnt lgkmcnt(4)
    ds_read_b64_tr_b16 a[190:191], v8 offset:55296
    v_add_u32 v8, 73728, v8
    v_mfma_f32_16x16x32_bf16 v[148:151], a[192:195], a[240:243], v[148:151]
    s_add_u32 s38, s47, 163840
    s_add_u32 s36, s45, 204800
    v_mfma_f32_16x16x32_bf16 v[140:143], a[192:195], a[236:239], v[140:143]
    buffer_load_dwordx2 v[38:39], v52, s[24:27], 0 offen sc1
    v_mfma_f32_16x16x32_bf16 v[140:143], a[196:199], a[156:159], v[140:143]
    s_cmp_lt_u32 s3, 2
    s_cselect_b32 s38, s38, s36
    s_addk_i32 m0, 4096
    v_mfma_f32_16x16x32_bf16 v[132:135], a[196:199], a[152:155], v[132:135]
    buffer_load_dwordx4 a[76:79], v14, s[20:23], s37 offen offset:3072 sc1
    v_mfma_f32_16x16x32_bf16 v[132:135], a[192:195], a[232:235], v[132:135]
    s_sub_u32 s78, s72, s77
    ds_read_b64_tr_b16 a[192:193], v9 offset:45056
    s_sub_u32 s79, s73, s77
    v_mfma_f32_16x16x32_bf16 v[84:87], v[68:71], v[76:79], 0
    s_max_u32 s78, s78, s79
    ds_read_b64_tr_b16 a[194:195], v9 offset:47104
    s_sub_u32 s79, s74, s77
    v_mfma_f32_16x16x32_bf16 v[84:87], v[72:75], v[80:83], v[84:87]
    s_max_u32 s78, s78, s79
    ds_read_b64_tr_b16 a[196:197], v9 offset:53248
    s_sub_u32 s79, s75, s77
    v_mfma_f32_16x16x32_bf16 v[160:163], a[200:203], a[232:235], v[160:163]
    buffer_load_dwordx4 v7, s[8:11], s38 offen lds
    v_mfma_f32_16x16x32_bf16 v[160:163], a[204:207], a[152:155], v[160:163]
    s_max_u32 s78, s78, s79
    ds_read_b64_tr_b16 a[198:199], v9 offset:55296
    v_add_u32 v9, 73728, v9
    v_mfma_f32_16x16x32_bf16 v[168:171], a[204:207], a[156:159], v[168:171]
    buffer_store_dword v84, v62, s[24:27], s62 offen sc1
    v_mfma_f32_16x16x32_bf16 v[168:171], a[200:203], a[236:239], v[168:171]
    buffer_store_dword v85, v62, s[24:27], s62 offen offset:2560 sc1
    v_mfma_f32_16x16x32_bf16 v[176:179], a[200:203], a[240:243], v[176:179]
    s_cmp_gt_u32 s78, 1
    s_cbranch_scc1 spin_o4
spin_o4_ret:
    s_add_u32 s37, s59, 16384
    v_mfma_f32_16x16x32_bf16 v[176:179], a[204:207], a[160:163], v[176:179]
    v_mfma_f32_16x16x32_bf16 v[184:187], a[204:207], a[164:167], v[184:187]
    buffer_load_dwordx4 a[216:219], v14, s[20:23], s37 offen offset:0 sc1
    v_mfma_f32_16x16x32_bf16 v[184:187], a[200:203], a[244:247], v[184:187]
    s_waitcnt lgkmcnt(1)
    ds_read_b64_tr_b16 a[200:201], v10 offset:45056
    v_mfma_f32_16x16x32_bf16 v[188:191], a[208:211], a[244:247], v[188:191]
    buffer_load_dwordx2 v[32:33], v35, s[12:15], s68 offen
    v_mfma_f32_16x16x32_bf16 v[188:191], a[212:215], a[164:167], v[188:191]
    ds_read_b64_tr_b16 a[202:203], v10 offset:47104
    v_mfma_f32_16x16x32_bf16 v[180:183], a[212:215], a[160:163], v[180:183]
    ds_read_b64_tr_b16 a[204:205], v10 offset:53248
    v_mfma_f32_16x16x32_bf16 v[180:183], a[208:211], a[240:243], v[180:183]
    ds_read_b64_tr_b16 a[206:207], v10 offset:55296
    v_add_u32 v10, 73728, v10
    v_mfma_f32_16x16x32_bf16 v[172:175], a[208:211], a[236:239], v[172:175]
    s_add_u32 s38, s46, 204800
    s_add_u32 s36, s47, 204800
    v_mfma_f32_16x16x32_bf16 v[172:175], a[212:215], a[156:159], v[172:175]
    s_cmp_lt_u32 s3, 2
    s_cselect_b32 s38, s38, s36
    v_mfma_f32_16x16x32_bf16 v[164:167], a[212:215], a[152:155], v[164:167]
    s_addk_i32 m0, 4096
    v_mfma_f32_16x16x32_bf16 v[164:167], a[208:211], a[232:235], v[164:167]
    ds_read_b64_tr_b16 a[208:209], v11 offset:45056
    v_mfma_f32_16x16x32_bf16 v[192:195], a[184:187], a[232:235], v[192:195]
    buffer_load_dwordx4 a[220:223], v14, s[20:23], s37 offen offset:1024 sc1
    v_mfma_f32_16x16x32_bf16 v[192:195], a[188:191], a[152:155], v[192:195]
    ds_read_b64_tr_b16 a[210:211], v11 offset:47104
    v_mfma_f32_16x16x32_bf16 v[200:203], a[188:191], a[156:159], v[200:203]
    ds_read_b64_tr_b16 a[212:213], v11 offset:53248
    v_mfma_f32_16x16x32_bf16 v[200:203], a[184:187], a[236:239], v[200:203]
    ds_read_b64_tr_b16 a[214:215], v11 offset:55296
    v_add_u32 v11, 73728, v11
    v_mfma_f32_16x16x32_bf16 v[208:211], a[184:187], a[240:243], v[208:211]
    buffer_load_dwordx4 v7, s[8:11], s38 offen lds
    v_mfma_f32_16x16x32_bf16 v[208:211], a[188:191], a[160:163], v[208:211]
    v_mfma_f32_16x16x32_bf16 v[216:219], a[188:191], a[164:167], v[216:219]
    buffer_load_dwordx4 v[24:27], v4, s[12:15], s64 offen
    v_mfma_f32_16x16x32_bf16 v[216:219], a[184:187], a[244:247], v[216:219]
pg_13:
    s_cbranch_execz pg_back
    s_waitcnt lgkmcnt(3)
    v_mfma_f32_16x16x32_bf16 v[220:223], a[192:195], a[244:247], v[220:223]
    v_mfma_f32_16x16x32_bf16 v[220:223], a[196:199], a[164:167], v[220:223]
    s_waitcnt vmcnt(35) lgkmcnt(1)
    v_mfma_f32_16x16x32_bf16 v[212:215], a[196:199], a[160:163], v[212:215]
    s_barrier
    v_mfma_f32_16x16x32_bf16 v[212:215], a[192:195], a[240:243], v[212:215]
    buffer_load_dwordx4 a[224:227], v14, s[20:23], s37 offen offset:2048 sc1
    v_mfma_f32_16x16x32_bf16 v[204:207], a[192:195], a[236:239], v[204:207]
    ds_read_b64_tr_b16 a[184:185], v12 offset:0
    v_mfma_f32_16x16x32_bf16 v[204:207], a[196:199], a[156:159], v[204:207]
    ds_read_b64_tr_b16 a[186:187], v12 offset:1024
    v_mfma_f32_16x16x32_bf16 v[196:199], a[196:199], a[152:155], v[196:199]
    ds_read_b64_tr_b16 a[188:189], v12 offset:2048
    v_mfma_f32_16x16x32_bf16 v[196:199], a[192:195], a[232:235], v[196:199]
    ds_read_b64_tr_b16 a[190:191], v12 offset:3072
    v_mfma_f32_16x16x32_bf16 v[224:227], a[200:203], a[232:235], v[224:227]
    s_add_u32 s38, s45, 81920
    ds_read_b64_tr_b16 a[192:193], v13 offset:0
    v_mfma_f32_16x16x32_bf16 v[224:227], a[204:207], a[152:155], v[224:227]
    ds_read_b64_tr_b16 a[194:195], v13 offset:1024
    v_mfma_f32_16x16x32_bf16 v[232:235], a[204:207], a[156:159], v[232:235]
    s_add_u32 m0, s63, 0
    ds_read_b64_tr_b16 a[196:197], v13 offset:2048
    v_mfma_f32_16x16x32_bf16 v[232:235], a[200:203], a[236:239], v[232:235]
    ds_read_b64_tr_b16 a[198:199], v13 offset:3072
    v_mfma_f32_16x16x32_bf16 v[240:243], a[200:203], a[240:243], v[240:243]
    buffer_load_dwordx4 a[228:231], v14, s[20:23], s37 offen offset:3072 sc1
    v_mfma_f32_16x16x32_bf16 v[240:243], a[204:207], a[160:163], v[240:243]
    buffer_load_dwordx4 v[28:31], v34, s[12:15], s64 offen
    v_mfma_f32_16x16x32_bf16 v[248:251], a[204:207], a[164:167], v[248:251]
    s_waitcnt lgkmcnt(4)
    v_mfma_f32_16x16x32_bf16 v[248:251], a[200:203], a[244:247], v[248:251]
    ds_read_b64_tr_b16 a[200:201], v8 offset:0
    v_mfma_f32_16x16x32_bf16 v[252:255], a[208:211], a[244:247], v[252:255]
    buffer_load_dwordx4 v2, s[8:11], s38 offen lds
    v_mfma_f32_16x16x32_bf16 v[252:255], a[212:215], a[164:167], v[252:255]
    ds_read_b64_tr_b16 a[202:203], v8 offset:2048
    v_mfma_f32_16x16x32_bf16 v[244:247], a[212:215], a[160:163], v[244:247]
    s_add_u32 s37, s60, 16384
    ds_read_b64_tr_b16 a[204:205], v8 offset:8192
    v_mfma_f32_16x16x32_bf16 v[244:247], a[208:211], a[240:243], v[244:247]
    ds_read_b64_tr_b16 a[206:207], v8 offset:10240
    v_mfma_f32_16x16x32_bf16 v[236:239], a[208:211], a[236:239], v[236:239]
    v_mfma_f32_16x16x32_bf16 v[236:239], a[212:215], a[156:159], v[236:239]
    v_mfma_f32_16x16x32_bf16 v[228:231], a[212:215], a[152:155], v[228:231]
    s_add_u32 s38, s46, 81920
    v_mfma_f32_16x16x32_bf16 v[228:231], a[208:211], a[232:235], v[228:231]
    ds_read_b64_tr_b16 a[208:209], v9 offset:0
    v_mfma_f32_16x16x32_bf16 v[96:99], a[184:187], a[168:171], v[96:99]
    buffer_load_dwordx4 a[232:235], v14, s[20:23], s37 offen offset:0 sc1
    v_mfma_f32_16x16x32_bf16 v[96:99], a[188:191], a[80:83], v[96:99]
    s_addk_i32 m0, 4096
    ds_read_b64_tr_b16 a[210:211], v9 offset:2048
    v_mfma_f32_16x16x32_bf16 v[104:107], a[188:191], a[84:87], v[104:107]
    ds_read_b64_tr_b16 a[212:213], v9 offset:8192
    v_mfma_f32_16x16x32_bf16 v[104:107], a[184:187], a[172:175], v[104:107]
    s_waitcnt lgkmcnt(3)
    ds_read_b64_tr_b16 a[214:215], v9 offset:10240
    v_mfma_f32_16x16x32_bf16 v[112:115], a[184:187], a[176:179], v[112:115]
    v_mfma_f32_16x16x32_bf16 v[112:115], a[188:191], a[88:91], v[112:115]
    v_mfma_f32_16x16x32_bf16 v[120:123], a[188:191], a[92:95], v[120:123]
    buffer_load_dwordx4 v2, s[8:11], s38 offen lds
    v_mfma_f32_16x16x32_bf16 v[120:123], a[184:187], a[180:183], v[120:123]
    ds_read_b64_tr_b16 a[184:185], v10 offset:0
    v_mfma_f32_16x16x32_bf16 v[124:127], a[192:195], a[180:183], v[124:127]
    ds_read_b64_tr_b16 a[186:187], v10 offset:2048
    v_mfma_f32_16x16x32_bf16 v[124:127], a[196:199], a[92:95], v[124:127]
    ds_read_b64_tr_b16 a[188:189], v10 offset:8192
    v_mfma_f32_16x16x32_bf16 v[116:119], a[196:199], a[88:91], v[116:119]
    buffer_load_dwordx4 a[236:239], v14, s[20:23], s37 offen offset:1024 sc1
    v_mfma_f32_16x16x32_bf16 v[116:119], a[192:195], a[176:179], v[116:119]
    ds_read_b64_tr_b16 a[190:191], v10 offset:10240
    v_mfma_f32_16x16x32_bf16 v[108:111], a[192:195], a[172:175], v[108:111]
    s_add_u32 s38, s47, 81920
    v_mfma_f32_16x16x32_bf16 v[108:111], a[196:199], a[84:87], v[108:111]
    v_mfma_f32_16x16x32_bf16 v[100:103], a[196:199], a[80:83], v[100:103]
    s_addk_i32 m0, 4096
    v_mfma_f32_16x16x32_bf16 v[100:103], a[192:195], a[168:171], v[100:103]
    ds_read_b64_tr_b16 a[192:193], v11 offset:0
    v_mfma_f32_16x16x32_bf16 v[128:131], a[200:203], a[168:171], v[128:131]
    ds_read_b64_tr_b16 a[194:195], v11 offset:2048
    v_mfma_f32_16x16x32_bf16 v[128:131], a[204:207], a[80:83], v[128:131]
    ds_read_b64_tr_b16 a[196:197], v11 offset:8192
    v_mfma_f32_16x16x32_bf16 v[136:139], a[204:207], a[84:87], v[136:139]
    s_waitcnt lgkmcnt(3)
    ds_read_b64_tr_b16 a[198:199], v11 offset:10240
    v_lshrrev_b32 v65, 1, v1
    v_mfma_f32_16x16x32_bf16 v[136:139], a[200:203], a[172:175], v[136:139]
    s_and_b32 s39, s70, 0x7ff
    v_min_u32 v65, 23, v65
    v_mul_u32_u24 v65, 2560, v65
    v_mfma_f32_16x16x32_bf16 v[144:147], a[200:203], a[176:179], v[144:147]
    buffer_load_dwordx4 a[240:243], v14, s[20:23], s37 offen offset:2048 sc1
    v_mfma_f32_16x16x32_bf16 v[144:147], a[204:207], a[88:91], v[144:147]
    buffer_load_dwordx4 v2, s[8:11], s38 offen lds
    v_mfma_f32_16x16x32_bf16 v[152:155], a[204:207], a[92:95], v[152:155]
    s_sub_u32 s39, 2047, s39
    v_and_b32 v56, 1, v1
    v_lshl_add_u32 v65, v56, 2, v65
    v_mfma_f32_16x16x32_bf16 v[152:155], a[200:203], a[180:183], v[152:155]
    s_and_b32 s40, s71, 0x7ff
    ds_read_b64_tr_b16 a[200:201], v8 offset:4096
    v_cmp_lt_u32 vcc, 31, v1
    v_mfma_f32_16x16x32_bf16 v[156:159], a[208:211], a[180:183], v[156:159]
    s_load_dwordx4 s[72:75], s[86:87], s5 glc
    ds_read_b64_tr_b16 a[202:203], v8 offset:6144
    v_mov_b32 v54, s70
    v_mfma_f32_16x16x32_bf16 v[156:159], a[212:215], a[92:95], v[156:159]
    s_sub_u32 s40, 2047, s40
    ds_read_b64_tr_b16 a[204:205], v8 offset:12288
    v_mov_b32 v64, s71
    v_mfma_f32_16x16x32_bf16 v[148:151], a[212:215], a[88:91], v[148:151]
    s_add_u32 s38, s45, 122880
    ds_read_b64_tr_b16 a[206:207], v8 offset:14336
    v_cndmask_b32 v54, v54, v64, vcc
    v_mfma_f32_16x16x32_bf16 v[148:151], a[208:211], a[176:179], v[148:151]
    s_xor_b32 s56, s39, s6
    v_bfe_i32 v56, v1, 3, 1
    v_and_b32 v57, 7, v1
    v_mfma_f32_16x16x32_bf16 v[140:143], a[208:211], a[172:175], v[140:143]
    s_add_u32 m0, s63, 12288
    s_xor_b32 s57, s40, s6
    s_min_u32 s56, s56, s57
    v_mfma_f32_16x16x32_bf16 v[140:143], a[212:215], a[84:87], v[140:143]
    s_cmp_lt_u32 s56, 32
    s_cselect_b32 s43, 0, 0x70000000
    s_cselect_b32 s58, s7, 0
    v_mfma_f32_16x16x32_bf16 v[132:135], a[212:215], a[80:83], v[132:135]
    buffer_load_dwordx4 a[244:247], v14, s[20:23], s37 offen offset:3072 sc1
    v_mfma_f32_16x16x32_bf16 v[132:135], a[208:211], a[168:171], v[132:135]
    s_lshr_b32 s41, s64, 7
    ds_read_b64_tr_b16 a[208:209], v9 offset:4096
    v_or_b32 v65, s43, v65
    v_mfma_f32_16x16x32_bf16 v[160:163], a[184:187], a[168:171], v[160:163]
    s_lshl_b32 s41, s41, 8
    ds_read_b64_tr_b16 a[210:211], v9 offset:6144
    s_bfe_u32 s56, s64, 0x10006
    v_mfma_f32_16x16x32_bf16 v[160:163], a[188:191], a[80:83], v[160:163]
    s_lshl3_add_u32 s41, s56, s41
    ds_read_b64_tr_b16 a[212:213], v9 offset:12288
    s_add_u32 s41, s41, 3932320
    v_mfma_f32_16x16x32_bf16 v[168:171], a[188:191], a[84:87], v[168:171]
    s_waitcnt lgkmcnt(5)
    ds_read_b64_tr_b16 a[214:215], v9 offset:14336
    s_add_u32 s37, s61, 16384
    v_mfma_f32_16x16x32_bf16 v[168:171], a[184:187], a[172:175], v[168:171]
    buffer_load_dwordx4 v2, s[8:11], s38 offen lds
    v_mfma_f32_16x16x32_bf16 v[176:179], a[184:187], a[176:179], v[176:179]
    s_waitcnt vmcnt(16)
    s_lshr_b32 s42, s68, 7
    s_lshl_b32 s42, s42, 8
    v_mfma_f32_16x16x32_bf16 v[176:179], a[188:191], a[88:91], v[176:179]
    buffer_store_dword v6, v15, s[24:27], s4 offen offset:160 sc1
    v_mfma_f32_16x16x32_bf16 v[184:187], a[188:191], a[92:95], v[184:187]
    s_bfe_u32 s56, s68, 0x10006
    s_lshl3_add_u32 s42, s56, s42
    s_add_u32 s42, s42, 3932320
    v_mfma_f32_16x16x32_bf16 v[184:187], a[184:187], a[180:183], v[184:187]
    s_sub_u32 s56, s68, s64
    ds_read_b64_tr_b16 a[184:185], v10 offset:4096
    v_and_b32 v56, s56, v56
    v_mfma_f32_16x16x32_bf16 v[188:191], a[192:195], a[180:183], v[188:191]
    buffer_load_dwordx4 a[152:155], v14, s[20:23], s37 offen offset:0 sc1
    v_mfma_f32_16x16x32_bf16 v[188:191], a[196:199], a[92:95], v[188:191]
    s_add_u32 s38, s46, 122880
    ds_read_b64_tr_b16 a[186:187], v10 offset:6144
    v_lshl_add_u32 v64, v57, 3, v56
    v_mfma_f32_16x16x32_bf16 v[180:183], a[196:199], a[88:91], v[180:183]
    s_addk_i32 m0, 4096
    ds_read_b64_tr_b16 a[188:189], v10 offset:12288
    v_add_u32 v55, s64, v64
    v_mfma_f32_16x16x32_bf16 v[180:183], a[192:195], a[176:179], v[180:183]
    s_or_b32 s57, s64, s43
    ds_read_b64_tr_b16 a[190:191], v10 offset:14336
    v_add_u32 v64, s57, v64
    v_mfma_f32_16x16x32_bf16 v[172:175], a[192:195], a[172:175], v[172:175]
    s_add_u32 s55, s43, 3670016
    v_lshrrev_b32 v56, 5, v1
    v_bfe_u32 v57, v1, 4, 1
    v_mfma_f32_16x16x32_bf16 v[172:175], a[196:199], a[84:87], v[172:175]
    s_add_u32 s56, s43, 3211264
    v_lshl_add_u32 v56, v57, 1, v56
    v_mul_u32_u24 v56, 2560, v56
    v_mfma_f32_16x16x32_bf16 v[164:167], a[196:199], a[80:83], v[164:167]
    s_waitcnt lgkmcnt(5)
    v_lshl_add_u32 v55, v55, 1, v56
    v_and_b32 v56, 0x7ff, v54
    v_mfma_f32_16x16x32_bf16 v[164:167], a[192:195], a[168:171], v[164:167]
    ds_read_b64_tr_b16 a[192:193], v11 offset:4096
    v_sub_u32 v56, 2047, v56
    v_mfma_f32_16x16x32_bf16 v[192:195], a[200:203], a[168:171], v[192:195]
    buffer_load_dwordx4 v2, s[8:11], s38 offen lds
    v_mfma_f32_16x16x32_bf16 v[192:195], a[204:207], a[80:83], v[192:195]
    ds_read_b64_tr_b16 a[194:195], v11 offset:6144
    v_mul_u32_u24 v57, 1280, v56
    v_mfma_f32_16x16x32_bf16 v[200:203], a[204:207], a[84:87], v[200:203]
    buffer_load_dwordx4 a[156:159], v14, s[20:23], s37 offen offset:1024 sc1
    v_mfma_f32_16x16x32_bf16 v[200:203], a[200:203], a[172:175], v[200:203]
    s_add_u32 s77, s7, 6
    ds_read_b64_tr_b16 a[196:197], v11 offset:12288
    v_add_u32 v57, v57, v64
    v_mfma_f32_16x16x32_bf16 v[208:211], a[200:203], a[176:179], v[208:211]
    buffer_load_dwordx2 v[66:67], v57, s[12:15], 0 offen
    v_mfma_f32_16x16x32_bf16 v[208:211], a[204:207], a[88:91], v[208:211]
    ds_read_b64_tr_b16 a[198:199], v11 offset:14336
    v_lshlrev_b32 v56, 3, v56
    v_mfma_f32_16x16x32_bf16 v[216:219], a[204:207], a[92:95], v[216:219]
    buffer_load_dwordx2 v[68:69], v56, s[24:27], s56 offen sc1
    v_mfma_f32_16x16x32_bf16 v[216:219], a[200:203], a[180:183], v[216:219]
    s_waitcnt lgkmcnt(5)
    v_and_b32 v54, 0xffff0000, v54
    v_ashrrev_i32 v56, 31, v54
    v_mfma_f32_16x16x32_bf16 v[220:223], a[208:211], a[180:183], v[220:223]
    s_add_u32 s38, s47, 122880
    v_not_b32 v56, v56
    v_or_b32 v56, 0x80000000, v56
    v_mfma_f32_16x16x32_bf16 v[220:223], a[212:215], a[92:95], v[220:223]
    s_addk_i32 m0, 4096
    v_xor_b32 v54, v54, v56
    v_and_b32 v54, 0xffff0000, v54
    v_mfma_f32_16x16x32_bf16 v[212:215], a[212:215], a[88:91], v[212:215]
    s_barrier
    v_mfma_f32_16x16x32_bf16 v[212:215], a[208:211], a[176:179], v[212:215]
    ds_read_b64_tr_b16 a[200:201], v12 offset:20480
    v_mul_f32 v54, s92, v54
    v_mfma_f32_16x16x32_bf16 v[204:207], a[208:211], a[172:175], v[204:207]
    buffer_load_dwordx4 a[160:163], v14, s[20:23], s37 offen offset:2048 sc1
    v_mfma_f32_16x16x32_bf16 v[204:207], a[212:215], a[84:87], v[204:207]
    ds_read_b64_tr_b16 a[202:203], v12 offset:21504
    v_mfma_f32_16x16x32_bf16 v[196:199], a[212:215], a[80:83], v[196:199]
    buffer_load_dwordx4 v2, s[8:11], s38 offen lds
    v_mfma_f32_16x16x32_bf16 v[196:199], a[208:211], a[168:171], v[196:199]
    s_waitcnt lgkmcnt(4)
    ds_read_b64_tr_b16 a[204:205], v12 offset:22528
    v_mfma_f32_16x16x32_bf16 v[224:227], a[184:187], a[168:171], v[224:227]
    ds_read_b64_tr_b16 a[206:207], v12 offset:23552
    v_mfma_f32_16x16x32_bf16 v[224:227], a[188:191], a[80:83], v[224:227]
    ds_read_b64_tr_b16 a[208:209], v13 offset:20480
    v_mfma_f32_16x16x32_bf16 v[232:235], a[188:191], a[84:87], v[232:235]
    ds_read_b64_tr_b16 a[210:211], v13 offset:21504
    v_mfma_f32_16x16x32_bf16 v[232:235], a[184:187], a[172:175], v[232:235]
    ds_read_b64_tr_b16 a[212:213], v13 offset:22528
    v_mfma_f32_16x16x32_bf16 v[240:243], a[184:187], a[176:179], v[240:243]
    s_add_u32 s38, s45, 163840
    ds_read_b64_tr_b16 a[214:215], v13 offset:23552
    v_mfma_f32_16x16x32_bf16 v[240:243], a[188:191], a[88:91], v[240:243]
    v_exp_f32 v54, v54
    v_mfma_f32_16x16x32_bf16 v[248:251], a[188:191], a[92:95], v[248:251]
    buffer_load_dwordx4 a[164:167], v14, s[20:23], s37 offen offset:3072 sc1
    v_mfma_f32_16x16x32_bf16 v[248:251], a[184:187], a[180:183], v[248:251]
    s_waitcnt lgkmcnt(6)
    ds_read_b64_tr_b16 a[184:185], v8 offset:20480
    v_add_f32 v54, 1.0, v54
    v_mfma_f32_16x16x32_bf16 v[252:255], a[192:195], a[180:183], v[252:255]
    s_addk_i32 m0, 4096
    ds_read_b64_tr_b16 a[186:187], v8 offset:22528
    s_sub_u32 s78, s72, s77
    v_mfma_f32_16x16x32_bf16 v[252:255], a[196:199], a[92:95], v[252:255]
    s_sub_u32 s79, s73, s77
    ds_read_b64_tr_b16 a[188:189], v8 offset:28672
    s_max_u32 s78, s78, s79
    v_mfma_f32_16x16x32_bf16 v[244:247], a[196:199], a[88:91], v[244:247]
    s_sub_u32 s79, s74, s77
    ds_read_b64_tr_b16 a[190:191], v8 offset:30720
    s_max_u32 s78, s78, s79
    v_mfma_f32_16x16x32_bf16 v[244:247], a[192:195], a[176:179], v[244:247]
    s_sub_u32 s79, s75, s77
    v_rcp_f32 v54, v54
    v_mfma_f32_16x16x32_bf16 v[236:239], a[192:195], a[172:175], v[236:239]
    buffer_load_dwordx4 v2, s[8:11], s38 offen lds
    v_mfma_f32_16x16x32_bf16 v[236:239], a[196:199], a[84:87], v[236:239]
    s_max_u32 s78, s78, s79
    v_cvt_pk_bf16_f32 v54, 0, v54
    s_add_u32 s37, s59, 20480
    v_mfma_f32_16x16x32_bf16 v[228:231], a[196:199], a[80:83], v[228:231]
    s_waitcnt lgkmcnt(3)
    v_mfma_f32_16x16x32_bf16 v[228:231], a[192:195], a[168:171], v[228:231]
    s_waitcnt vmcnt(24)
    ds_read_b64_tr_b16 a[192:193], v9 offset:20480
    v_lshlrev_b32 v20, 16, v32
    v_mfma_f32_16x16x32_bf16 v[96:99], a[200:203], a[96:99], v[96:99]
    s_cmp_gt_u32 s78, 0
    s_cbranch_scc1 spin_o5
spin_o5_ret:
    v_and_b32 v21, 0xffff0000, v32
    v_mfma_f32_16x16x32_bf16 v[96:99], a[204:207], a[112:115], v[96:99]
    buffer_load_dwordx4 a[168:171], v14, s[20:23], s37 offen offset:0 sc1
    v_mfma_f32_16x16x32_bf16 v[104:107], a[204:207], a[116:119], v[104:107]
    s_xor_b32 s77, s50, 2
    ds_read_b64_tr_b16 a[194:195], v9 offset:22528
    v_sub_f32 v20, v20, v38
    v_mfma_f32_16x16x32_bf16 v[104:107], a[200:203], a[100:103], v[104:107]
    s_lshl_b32 s77, s77, 10
    ds_read_b64_tr_b16 a[196:197], v9 offset:28672
    v_sub_f32 v21, v21, v38
    v_mfma_f32_16x16x32_bf16 v[112:115], a[200:203], a[104:107], v[112:115]
    s_add_u32 s38, s46, 163840
    ds_read_b64_tr_b16 a[198:199], v9 offset:30720
    v_cvt_pk_bf16_f32 v20, 0, v20
    v_mfma_f32_16x16x32_bf16 v[112:115], a[204:207], a[120:123], v[112:115]
    s_addk_i32 m0, 4096
    v_cvt_pk_bf16_f32 v21, 0, v21
    v_mul_f32 v20, v20, v39
    v_mfma_f32_16x16x32_bf16 v[120:123], a[204:207], a[124:127], v[120:123]
    s_waitcnt vmcnt(22)
    v_permlane16_swap_b32 v24, v26
    v_mfma_f32_16x16x32_bf16 v[120:123], a[200:203], a[108:111], v[120:123]
    ds_read_b64_tr_b16 a[200:201], v10 offset:20480
    v_mul_f32 v21, v21, v39
    v_mfma_f32_16x16x32_bf16 v[124:127], a[208:211], a[108:111], v[124:127]
    ds_read_b64_tr_b16 a[202:203], v10 offset:22528
    v_cvt_pk_bf16_f32 v20, 0, v20
    v_mfma_f32_16x16x32_bf16 v[124:127], a[212:215], a[124:127], v[124:127]
    ds_read_b64_tr_b16 a[204:205], v10 offset:28672
    v_cvt_pk_bf16_f32 v21, 0, v21
    v_mfma_f32_16x16x32_bf16 v[116:119], a[212:215], a[120:123], v[116:119]
    buffer_load_dwordx4 a[172:175], v14, s[20:23], s37 offen offset:1024 sc1
    v_mfma_f32_16x16x32_bf16 v[116:119], a[208:211], a[104:107], v[116:119]
    buffer_load_dwordx4 v2, s[8:11], s38 offen lds
    v_mfma_f32_16x16x32_bf16 v[108:111], a[208:211], a[100:103], v[108:111]
    ds_read_b64_tr_b16 a[206:207], v10 offset:30720
    v_mul_f32 v23, s92, v20
    v_mfma_f32_16x16x32_bf16 v[108:111], a[212:215], a[116:119], v[108:111]
    s_waitcnt lgkmcnt(4)
    v_exp_f32 v23, v23
    v_mfma_f32_16x16x32_bf16 v[100:103], a[212:215], a[112:115], v[100:103]
    v_permlane16_swap_b32 v25, v27
    v_mfma_f32_16x16x32_bf16 v[100:103], a[208:211], a[96:99], v[100:103]
    ds_read_b64_tr_b16 a[208:209], v11 offset:20480
    v_mul_f32 v36, s92, v21
    v_mfma_f32_16x16x32_bf16 v[128:131], a[184:187], a[96:99], v[128:131]
    s_add_u32 s38, s47, 163840
    ds_read_b64_tr_b16 a[210:211], v11 offset:22528
    v_add_f32 v23, 1.0, v23
    v_mfma_f32_16x16x32_bf16 v[128:131], a[188:191], a[112:115], v[128:131]
    ds_read_b64_tr_b16 a[212:213], v11 offset:28672
    v_mfma_f32_16x16x32_bf16 v[136:139], a[188:191], a[116:119], v[136:139]
    s_addk_i32 m0, 4096
    ds_read_b64_tr_b16 a[214:215], v11 offset:30720
    v_mfma_f32_16x16x32_bf16 v[136:139], a[184:187], a[100:103], v[136:139]
    s_waitcnt vmcnt(21)
    v_exp_f32 v36, v36
    v_mfma_f32_16x16x32_bf16 v[144:147], a[184:187], a[104:107], v[144:147]
    buffer_load_dwordx4 a[176:179], v14, s[20:23], s37 offen offset:2048 sc1
    v_mfma_f32_16x16x32_bf16 v[144:147], a[188:191], a[120:123], v[144:147]
    v_rcp_f32 v23, v23
    v_mfma_f32_16x16x32_bf16 v[152:155], a[188:191], a[124:127], v[152:155]
    v_permlane16_swap_b32 v28, v30
    v_mfma_f32_16x16x32_bf16 v[152:155], a[184:187], a[108:111], v[152:155]
    ds_read_b64_tr_b16 a[184:185], v8 offset:24576
    v_add_f32 v36, 1.0, v36
    v_mfma_f32_16x16x32_bf16 v[156:159], a[192:195], a[108:111], v[156:159]
    buffer_load_dwordx4 v2, s[8:11], s38 offen lds
    v_mfma_f32_16x16x32_bf16 v[156:159], a[196:199], a[124:127], v[156:159]
    ds_read_b64_tr_b16 a[186:187], v8 offset:26624
    v_mul_f32 v20, v20, v23
    v_mfma_f32_16x16x32_bf16 v[148:151], a[196:199], a[120:123], v[148:151]
    ds_read_b64_tr_b16 a[188:189], v8 offset:32768
    v_mfma_f32_16x16x32_bf16 v[148:151], a[192:195], a[104:107], v[148:151]
    s_waitcnt lgkmcnt(3)
    ds_read_b64_tr_b16 a[190:191], v8 offset:34816
    v_subrev_u32 v8, 73728, v8
    v_mfma_f32_16x16x32_bf16 v[140:143], a[192:195], a[100:103], v[140:143]
    v_rcp_f32 v36, v36
    v_mfma_f32_16x16x32_bf16 v[140:143], a[196:199], a[116:119], v[140:143]
    v_permlane16_swap_b32 v29, v31
    v_mfma_f32_16x16x32_bf16 v[132:135], a[196:199], a[112:115], v[132:135]
    buffer_load_dwordx4 a[180:183], v14, s[20:23], s37 offen offset:3072 sc1
    v_mfma_f32_16x16x32_bf16 v[132:135], a[192:195], a[96:99], v[132:135]
    s_add_u32 s38, s45, 204800
    ds_read_b64_tr_b16 a[192:193], v9 offset:24576
    v_mul_f32 v21, v21, v36
    v_mfma_f32_16x16x32_bf16 v[160:163], a[200:203], a[96:99], v[160:163]
    s_addk_i32 m0, 4096
    ds_read_b64_tr_b16 a[194:195], v9 offset:26624
    v_cvt_pk_bf16_f32 v48, v20, v21
    v_mfma_f32_16x16x32_bf16 v[160:163], a[204:207], a[112:115], v[160:163]
    ds_read_b64_tr_b16 a[196:197], v9 offset:32768
    v_lshlrev_b32 v20, 16, v33
    v_mfma_f32_16x16x32_bf16 v[168:171], a[204:207], a[116:119], v[168:171]
    s_add_u32 s37, s60, 20480
    ds_read_b64_tr_b16 a[198:199], v9 offset:34816
    v_subrev_u32 v9, 73728, v9
    v_mfma_f32_16x16x32_bf16 v[168:171], a[200:203], a[100:103], v[168:171]
    v_and_b32 v21, 0xffff0000, v33
    v_sub_f32 v20, v20, v38
    v_mfma_f32_16x16x32_bf16 v[176:179], a[200:203], a[104:107], v[176:179]
    v_sub_f32 v21, v21, v38
    v_cvt_pk_bf16_f32 v20, 0, v20
    v_mfma_f32_16x16x32_bf16 v[176:179], a[204:207], a[120:123], v[176:179]
    v_cvt_pk_bf16_f32 v21, 0, v21
    v_mul_f32 v20, v20, v39
    v_mfma_f32_16x16x32_bf16 v[184:187], a[204:207], a[124:127], v[184:187]
    buffer_load_dwordx4 v2, s[8:11], s38 offen lds
    v_mfma_f32_16x16x32_bf16 v[184:187], a[200:203], a[108:111], v[184:187]
    ds_read_b64_tr_b16 a[200:201], v10 offset:24576
    v_mul_f32 v21, v21, v39
    v_mfma_f32_16x16x32_bf16 v[188:191], a[208:211], a[108:111], v[188:191]
    buffer_load_dwordx4 a[80:83], v14, s[20:23], s37 offen offset:0 sc1
    v_mfma_f32_16x16x32_bf16 v[188:191], a[212:215], a[124:127], v[188:191]
    ds_read_b64_tr_b16 a[202:203], v10 offset:26624
    v_cvt_pk_bf16_f32 v20, 0, v20
    v_mfma_f32_16x16x32_bf16 v[180:183], a[212:215], a[120:123], v[180:183]
    ds_read_b64_tr_b16 a[204:205], v10 offset:32768
    v_cvt_pk_bf16_f32 v21, 0, v21
    v_mfma_f32_16x16x32_bf16 v[180:183], a[208:211], a[104:107], v[180:183]
    s_waitcnt lgkmcnt(3)
    ds_read_b64_tr_b16 a[206:207], v10 offset:34816
    v_subrev_u32 v10, 73728, v10
    v_mfma_f32_16x16x32_bf16 v[172:175], a[208:211], a[100:103], v[172:175]
    s_add_u32 s38, s46, 204800
    v_mul_f32 v23, s92, v20
    v_mul_f32 v36, s92, v21
    v_mfma_f32_16x16x32_bf16 v[172:175], a[212:215], a[116:119], v[172:175]
    v_exp_f32 v23, v23
    v_mfma_f32_16x16x32_bf16 v[164:167], a[212:215], a[112:115], v[164:167]
    s_addk_i32 m0, 4096
    v_exp_f32 v36, v36
    v_mfma_f32_16x16x32_bf16 v[164:167], a[208:211], a[96:99], v[164:167]
    ds_read_b64_tr_b16 a[208:209], v11 offset:24576
    v_add_f32 v23, 1.0, v23
    v_mfma_f32_16x16x32_bf16 v[192:195], a[184:187], a[96:99], v[192:195]
    ds_read_b64_tr_b16 a[210:211], v11 offset:26624
    v_add_f32 v36, 1.0, v36
    v_mfma_f32_16x16x32_bf16 v[192:195], a[188:191], a[112:115], v[192:195]
    ds_read_b64_tr_b16 a[212:213], v11 offset:32768
    v_mfma_f32_16x16x32_bf16 v[200:203], a[188:191], a[116:119], v[200:203]
    buffer_load_dwordx4 a[84:87], v14, s[20:23], s37 offen offset:1024 sc1
    v_mfma_f32_16x16x32_bf16 v[200:203], a[184:187], a[100:103], v[200:203]
    ds_read_b64_tr_b16 a[214:215], v11 offset:34816
    v_subrev_u32 v11, 73728, v11
    v_mfma_f32_16x16x32_bf16 v[208:211], a[184:187], a[104:107], v[208:211]
    buffer_load_dwordx4 v2, s[8:11], s38 offen lds
    v_mfma_f32_16x16x32_bf16 v[208:211], a[188:191], a[120:123], v[208:211]
    v_rcp_f32 v23, v23
    v_mfma_f32_16x16x32_bf16 v[216:219], a[188:191], a[124:127], v[216:219]
    v_rcp_f32 v36, v36
    v_mfma_f32_16x16x32_bf16 v[216:219], a[184:187], a[108:111], v[216:219]
    v_mul_f32 v20, v20, v23
    v_mul_f32 v21, v21, v36
    v_mfma_f32_16x16x32_bf16 v[220:223], a[192:195], a[108:111], v[220:223]
    v_cvt_pk_bf16_f32 v49, v20, v21
    v_lshlrev_b32 v20, 16, v24
    v_mfma_f32_16x16x32_bf16 v[220:223], a[196:199], a[124:127], v[220:223]
    s_waitcnt lgkmcnt(0)
    v_and_b32 v21, 0xffff0000, v24
    v_sub_f32 v20, v20, v16
    v_mfma_f32_16x16x32_bf16 v[212:215], a[196:199], a[120:123], v[212:215]
    s_barrier
    v_mfma_f32_16x16x32_bf16 v[212:215], a[192:195], a[104:107], v[212:215]
    s_add_u32 s38, s47, 204800
    ds_read_b64_tr_b16 a[184:185], v12 offset:49152
    v_sub_f32 v21, v21, v16
    v_mfma_f32_16x16x32_bf16 v[204:207], a[192:195], a[100:103], v[204:207]
    buffer_load_dwordx4 a[88:91], v14, s[20:23], s37 offen offset:2048 sc1
    v_mfma_f32_16x16x32_bf16 v[204:207], a[196:199], a[116:119], v[204:207]
    s_addk_i32 m0, 4096
    ds_read_b64_tr_b16 a[186:187], v12 offset:50176
    v_cvt_pk_bf16_f32 v20, 0, v20
    v_mfma_f32_16x16x32_bf16 v[196:199], a[196:199], a[112:115], v[196:199]
    s_waitcnt vmcnt(16)
    ds_read_b64_tr_b16 a[188:189], v12 offset:51200
    v_cvt_pk_bf16_f32 v21, 0, v21
    v_mfma_f32_16x16x32_bf16 v[196:199], a[192:195], a[96:99], v[196:199]
    ds_read_b64_tr_b16 a[190:191], v12 offset:52224
    v_mul_f32 v20, v20, v17
    v_mfma_f32_16x16x32_bf16 v[224:227], a[200:203], a[96:99], v[224:227]
    ds_read_b64_tr_b16 a[192:193], v13 offset:49152
    v_mul_f32 v21, v21, v17
    v_mfma_f32_16x16x32_bf16 v[224:227], a[204:207], a[112:115], v[224:227]
    ds_read_b64_tr_b16 a[194:195], v13 offset:50176
    v_cvt_pk_bf16_f32 v20, 0, v20
    v_mfma_f32_16x16x32_bf16 v[232:235], a[204:207], a[116:119], v[232:235]
    buffer_load_dwordx4 v2, s[8:11], s38 offen lds
    v_mfma_f32_16x16x32_bf16 v[232:235], a[200:203], a[100:103], v[232:235]
    ds_read_b64_tr_b16 a[196:197], v13 offset:51200
    v_cvt_pk_bf16_f32 v21, 0, v21
    v_mfma_f32_16x16x32_bf16 v[240:243], a[200:203], a[104:107], v[240:243]
    ds_read_b64_tr_b16 a[198:199], v13 offset:52224
    v_mul_f32 v23, s92, v20
    v_mfma_f32_16x16x32_bf16 v[240:243], a[204:207], a[120:123], v[240:243]
    v_exp_f32 v23, v23
    v_mfma_f32_16x16x32_bf16 v[248:251], a[204:207], a[124:127], v[248:251]
    buffer_load_dwordx4 a[92:95], v14, s[20:23], s37 offen offset:3072 sc1
    v_mfma_f32_16x16x32_bf16 v[248:251], a[200:203], a[108:111], v[248:251]
    ds_read_b64_tr_b16 a[200:201], v12 offset:53248
    v_mul_f32 v36, s92, v21
    v_mfma_f32_16x16x32_bf16 v[252:255], a[208:211], a[108:111], v[252:255]
    ds_read_b64_tr_b16 a[202:203], v12 offset:54272
    v_lshlrev_b32 v50, 16, v66
    v_mfma_f32_16x16x32_bf16 v[252:255], a[212:215], a[124:127], v[252:255]
    s_waitcnt vmcnt(17)
    ds_read_b64_tr_b16 a[204:205], v12 offset:55296
    v_and_b32 v51, 0xffff0000, v66
    v_mfma_f32_16x16x32_bf16 v[244:247], a[212:215], a[120:123], v[244:247]
    s_waitcnt lgkmcnt(4)
    ds_read_b64_tr_b16 a[206:207], v12 offset:56320
    v_lshlrev_b32 v52, 16, v67
    v_mfma_f32_16x16x32_bf16 v[244:247], a[208:211], a[104:107], v[244:247]
    s_add_u32 s37, s61, 20480
    v_exp_f32 v36, v36
    v_mfma_f32_16x16x32_bf16 v[236:239], a[208:211], a[100:103], v[236:239]
    v_and_b32 v53, 0xffff0000, v67
    v_sub_f32 v50, v50, v68
    v_mfma_f32_16x16x32_bf16 v[236:239], a[212:215], a[116:119], v[236:239]
    v_sub_f32 v51, v51, v68
    v_sub_f32 v52, v52, v68
    v_mfma_f32_16x16x32_bf16 v[228:231], a[212:215], a[112:115], v[228:231]
    v_sub_f32 v53, v53, v68
    v_cvt_pk_bf16_f32 v50, 0, v50
    v_mfma_f32_16x16x32_bf16 v[228:231], a[208:211], a[96:99], v[228:231]
    ds_read_b64_tr_b16 a[208:209], v13 offset:53248
    v_cvt_pk_bf16_f32 v51, 0, v51
    v_mfma_f32_16x16x32_bf16 v[96:99], a[184:187], a[128:131], v[96:99]
    buffer_load_dwordx4 a[96:99], v14, s[20:23], s37 offen offset:0 sc1
    v_mfma_f32_16x16x32_bf16 v[96:99], a[188:191], a[0:3], v[96:99]
    ds_read_b64_tr_b16 a[210:211], v13 offset:54272
    v_cvt_pk_bf16_f32 v52, 0, v52
    v_mfma_f32_16x16x32_bf16 v[104:107], a[188:191], a[4:7], v[104:107]
    ds_read_b64_tr_b16 a[212:213], v13 offset:55296
    v_cvt_pk_bf16_f32 v53, 0, v53
    v_mfma_f32_16x16x32_bf16 v[104:107], a[184:187], a[132:135], v[104:107]
    ds_read_b64_tr_b16 a[214:215], v13 offset:56320
    v_mul_f32 v50, v50, v69
    v_mfma_f32_16x16x32_bf16 v[112:115], a[184:187], a[136:139], v[112:115]
    v_mul_f32 v51, v51, v69
    v_mul_f32 v52, v52, v69
    v_mfma_f32_16x16x32_bf16 v[112:115], a[188:191], a[8:11], v[112:115]
    v_mul_f32 v53, v53, v69
    v_cvt_pk_bf16_f32 v50, 0, v50
    v_mfma_f32_16x16x32_bf16 v[120:123], a[188:191], a[12:15], v[120:123]
    s_waitcnt lgkmcnt(3)
    v_cvt_pk_bf16_f32 v51, 0, v51
    v_cvt_pk_bf16_f32 v52, 0, v52
    v_mfma_f32_16x16x32_bf16 v[120:123], a[184:187], a[140:143], v[120:123]
    ds_read_b64_tr_b16 a[184:185], v12 offset:57344
    v_cvt_pk_bf16_f32 v53, 0, v53
    v_mfma_f32_16x16x32_bf16 v[124:127], a[192:195], a[140:143], v[124:127]
    ds_read_b64_tr_b16 a[186:187], v12 offset:58368
    v_add_f32 v23, 1.0, v23
    v_mfma_f32_16x16x32_bf16 v[124:127], a[196:199], a[12:15], v[124:127]
    ds_read_b64_tr_b16 a[188:189], v12 offset:59392
    v_add_f32 v36, 1.0, v36
    v_mfma_f32_16x16x32_bf16 v[116:119], a[196:199], a[8:11], v[116:119]
    buffer_load_dwordx4 a[100:103], v14, s[20:23], s37 offen offset:1024 sc1
    v_mfma_f32_16x16x32_bf16 v[116:119], a[192:195], a[136:139], v[116:119]
    s_lshl2_add_u32 s60, s54, s51
    ds_read_b64_tr_b16 a[190:191], v12 offset:60416
    v_lshrrev_b32 v70, 1, v1
    v_mfma_f32_16x16x32_bf16 v[108:111], a[192:195], a[132:135], v[108:111]
    s_mul_i32 s60, s60, 163840
    v_min_u32 v70, 1, v70
    v_and_b32 v39, 7, v1
    v_mfma_f32_16x16x32_bf16 v[108:111], a[196:199], a[4:7], v[108:111]
    s_add_u32 s60, s60, 50331648
    v_rcp_f32 v23, v23
    v_mfma_f32_16x16x32_bf16 v[100:103], a[196:199], a[0:3], v[100:103]
    s_mul_i32 s56, s53, 2560
    v_rcp_f32 v36, v36
    v_mfma_f32_16x16x32_bf16 v[100:103], a[192:195], a[128:131], v[100:103]
    s_add_u32 s59, s60, s56
    ds_read_b64_tr_b16 a[192:193], v13 offset:57344
    v_mul_f32 v20, v20, v23
    v_mfma_f32_16x16x32_bf16 v[96:99], a[200:203], a[16:19], v[96:99]
    s_mul_i32 s56, s53, 20480
    ds_read_b64_tr_b16 a[194:195], v13 offset:58368
    v_mul_f32 v21, v21, v36
    v_mfma_f32_16x16x32_bf16 v[96:99], a[204:207], a[32:35], v[96:99]
    s_add_u32 s60, s60, s56
    ds_read_b64_tr_b16 a[196:197], v13 offset:59392
    v_cvt_pk_bf16_f32 v40, v20, v21
    v_mfma_f32_16x16x32_bf16 v[104:107], a[204:207], a[36:39], v[104:107]
    s_andn2_b32 s61, s2, 7
    ds_read_b64_tr_b16 a[198:199], v13 offset:60416
    v_lshlrev_b32 v20, 16, v25
    v_mfma_f32_16x16x32_bf16 v[104:107], a[200:203], a[20:23], v[104:107]
    s_waitcnt lgkmcnt(4)
    v_and_b32 v21, 0xffff0000, v25
    v_sub_f32 v20, v20, v16
    v_mfma_f32_16x16x32_bf16 v[112:115], a[200:203], a[24:27], v[112:115]
    buffer_load_dwordx4 a[104:107], v14, s[20:23], s37 offen offset:2048 sc1
    v_mfma_f32_16x16x32_bf16 v[112:115], a[204:207], a[40:43], v[112:115]
    s_lshl_b32 s61, s61, 2
    v_sub_f32 v21, v21, v16
    v_cvt_pk_bf16_f32 v20, 0, v20
    v_mfma_f32_16x16x32_bf16 v[120:123], a[204:207], a[44:47], v[120:123]
    s_add_u32 s61, s61, s3
    v_cvt_pk_bf16_f32 v21, 0, v21
    v_mul_f32 v20, v20, v17
    v_mfma_f32_16x16x32_bf16 v[120:123], a[200:203], a[28:31], v[120:123]
pg_14:
    s_cbranch_execz pg_backL
    s_lshl_b32 s61, s61, 7
    ds_read_b64_tr_b16 a[200:201], v12 offset:61440
    v_mul_f32 v21, v21, v17
    v_mfma_f32_16x16x32_bf16 v[124:127], a[208:211], a[28:31], v[124:127]
    s_add_u32 s61, s61, 4194304
    ds_read_b64_tr_b16 a[202:203], v12 offset:62464
    v_cvt_pk_bf16_f32 v20, 0, v20
    v_mfma_f32_16x16x32_bf16 v[124:127], a[212:215], a[44:47], v[124:127]
    s_and_b32 s56, s53, 1
    ds_read_b64_tr_b16 a[204:205], v12 offset:63488
    v_xor_b32 v7, s56, v1
    v_mfma_f32_16x16x32_bf16 v[116:119], a[212:215], a[40:43], v[116:119]
    s_andn2_b32 s56, 4, s53
    ds_read_b64_tr_b16 a[206:207], v12 offset:64512
    v_add_u32 v12, 65536, v12
    v_mfma_f32_16x16x32_bf16 v[116:119], a[208:211], a[24:27], v[116:119]
    s_lshl_b32 s56, s56, 1
    v_add_u32 v2, 1, v7
    v_lshlrev_b32 v7, 2, v7
    v_mfma_f32_16x16x32_bf16 v[108:111], a[208:211], a[20:23], v[108:111]
    s_add_u32 s67, s61, s67
    v_lshl_add_u32 v7, v1, 9, v7
    v_lshl_or_b32 v7, v70, 30, v7
    v_mfma_f32_16x16x32_bf16 v[108:111], a[212:215], a[36:39], v[108:111]
    s_add_u32 s77, s61, s77
    v_lshrrev_b32 v70, 4, v1
    v_lshl_add_u32 v39, v70, 3, v39
    v_mfma_f32_16x16x32_bf16 v[100:103], a[212:215], a[32:35], v[100:103]
    buffer_load_dwordx4 a[108:111], v14, s[20:23], s37 offen offset:3072 sc1
    v_mfma_f32_16x16x32_bf16 v[100:103], a[208:211], a[16:19], v[100:103]
    s_add_u32 s38, s45, 81920
    ds_read_b64_tr_b16 a[208:209], v13 offset:61440
    v_lshlrev_b32 v39, 4, v39
    v_mfma_f32_16x16x32_bf16 v[96:99], a[184:187], a[48:51], v[96:99]
    s_add_u32 m0, s63, 135168
    ds_read_b64_tr_b16 a[210:211], v13 offset:62464
    v_and_b32 v70, 8, v1
    v_mfma_f32_16x16x32_bf16 v[96:99], a[188:191], a[64:67], v[96:99]
    buffer_load_dwordx4 v3, s[8:11], s38 offen lds
    v_mfma_f32_16x16x32_bf16 v[104:107], a[188:191], a[68:71], v[104:107]
    s_add_u32 s38, s46, 81920
    ds_read_b64_tr_b16 a[212:213], v13 offset:63488
    v_mul_u32_u24 v38, 1280, v70
    v_mfma_f32_16x16x32_bf16 v[104:107], a[184:187], a[52:55], v[104:107]
    s_waitcnt lgkmcnt(3)
    ds_read_b64_tr_b16 a[214:215], v13 offset:64512
    v_add_u32 v13, 65536, v13
    v_mfma_f32_16x16x32_bf16 v[112:115], a[184:187], a[56:59], v[112:115]
    s_addk_i32 m0, -4096
    v_add_u32 v38, v38, v39
    v_xor_b32 v70, s56, v70
    v_mfma_f32_16x16x32_bf16 v[112:115], a[188:191], a[72:75], v[112:115]
    buffer_load_dwordx4 v3, s[8:11], s38 offen lds
    v_mfma_f32_16x16x32_bf16 v[120:123], a[188:191], a[76:79], v[120:123]
    s_add_u32 s38, s47, 81920
    v_add_u32 v39, v39, v70
    v_cmp_ne_u32 s[74:75], 0, v70
    v_mfma_f32_16x16x32_bf16 v[120:123], a[184:187], a[60:63], v[120:123]
    s_add_u32 m0, s63, 126976
    ds_read_b64_tr_b16 a[184:185], v12 offset:0
    v_cvt_pk_bf16_f32 v21, 0, v21
    v_mfma_f32_16x16x32_bf16 v[124:127], a[192:195], a[60:63], v[124:127]
    ds_read_b64_tr_b16 a[186:187], v12 offset:1024
    v_mul_f32 v23, s92, v20
    v_mfma_f32_16x16x32_bf16 v[124:127], a[196:199], a[76:79], v[124:127]
    ds_read_b64_tr_b16 a[188:189], v12 offset:2048
    v_mul_f32 v36, s92, v21
    v_mfma_f32_16x16x32_bf16 v[116:119], a[196:199], a[72:75], v[116:119]
    buffer_load_dwordx4 v3, s[8:11], s38 offen lds
    v_mfma_f32_16x16x32_bf16 v[116:119], a[192:195], a[56:59], v[116:119]
    ds_read_b64_tr_b16 a[190:191], v12 offset:3072
    v_mfma_f32_16x16x32_bf16 v[108:111], a[192:195], a[52:55], v[108:111]
    v_exp_f32 v23, v23
    v_mfma_f32_16x16x32_bf16 v[108:111], a[196:199], a[68:71], v[108:111]
    v_exp_f32 v36, v36
    v_mfma_f32_16x16x32_bf16 v[100:103], a[196:199], a[64:67], v[100:103]
    s_add_u32 s38, s45, 122880
    v_add_f32 v23, 1.0, v23
    v_add_f32 v36, 1.0, v36
    v_mfma_f32_16x16x32_bf16 v[100:103], a[192:195], a[48:51], v[100:103]
    ds_read_b64_tr_b16 a[192:193], v13 offset:0
    v_mfma_f32_16x16x32_bf16 v[96:99], a[200:203], a[216:219], v[96:99]
    s_addk_i32 m0, -4096
    ds_read_b64_tr_b16 a[194:195], v13 offset:1024
    v_mfma_f32_16x16x32_bf16 v[96:99], a[204:207], a[232:235], v[96:99]
    ds_read_b64_tr_b16 a[196:197], v13 offset:2048
    v_mfma_f32_16x16x32_bf16 v[104:107], a[204:207], a[236:239], v[104:107]
    s_waitcnt lgkmcnt(3)
    ds_read_b64_tr_b16 a[198:199], v13 offset:3072
    v_mfma_f32_16x16x32_bf16 v[104:107], a[200:203], a[220:223], v[104:107]
    v_rcp_f32 v23, v23
    v_mfma_f32_16x16x32_bf16 v[112:115], a[200:203], a[224:227], v[112:115]
    v_rcp_f32 v36, v36
    v_mfma_f32_16x16x32_bf16 v[112:115], a[204:207], a[240:243], v[112:115]
    v_mul_f32 v20, v20, v23
    v_mul_f32 v21, v21, v36
    v_mfma_f32_16x16x32_bf16 v[120:123], a[204:207], a[244:247], v[120:123]
    buffer_load_dwordx4 v3, s[8:11], s38 offen lds
    v_mfma_f32_16x16x32_bf16 v[120:123], a[200:203], a[228:231], v[120:123]
    ds_read_b64_tr_b16 a[200:201], v12 offset:4096
    v_cvt_pk_bf16_f32 v41, v20, v21
    v_mfma_f32_16x16x32_bf16 v[124:127], a[208:211], a[228:231], v[124:127]
    ds_read_b64_tr_b16 a[202:203], v12 offset:5120
    v_lshlrev_b32 v20, 16, v26
    v_mfma_f32_16x16x32_bf16 v[124:127], a[212:215], a[244:247], v[124:127]
    ds_read_b64_tr_b16 a[204:205], v12 offset:6144
    v_and_b32 v21, 0xffff0000, v26
    v_mfma_f32_16x16x32_bf16 v[116:119], a[212:215], a[240:243], v[116:119]
    buffer_load_dword v58, v65, s[24:27], s41 offen sc1
    v_mfma_f32_16x16x32_bf16 v[116:119], a[208:211], a[224:227], v[116:119]
    buffer_load_dword v59, v65, s[24:27], s42 offen sc1
    v_mfma_f32_16x16x32_bf16 v[108:111], a[208:211], a[220:223], v[108:111]
    s_add_u32 s38, s46, 122880
    ds_read_b64_tr_b16 a[206:207], v12 offset:7168
    v_sub_f32 v20, v20, v16
    v_mfma_f32_16x16x32_bf16 v[108:111], a[212:215], a[236:239], v[108:111]
    s_addk_i32 m0, -4096
    v_sub_f32 v21, v21, v16
    v_cvt_pk_bf16_f32 v20, 0, v20
    v_mfma_f32_16x16x32_bf16 v[100:103], a[212:215], a[232:235], v[100:103]
    s_waitcnt vmcnt(22)
    v_cvt_pk_bf16_f32 v21, 0, v21
    v_mul_f32 v20, v20, v17
    v_mfma_f32_16x16x32_bf16 v[100:103], a[208:211], a[216:219], v[100:103]
    s_waitcnt vmcnt(21)
    ds_read_b64_tr_b16 a[208:209], v13 offset:4096
    v_mul_f32 v21, v21, v17
    v_mfma_f32_16x16x32_bf16 v[96:99], a[184:187], a[152:155], v[96:99]
    ds_read_b64_tr_b16 a[210:211], v13 offset:5120
    v_cvt_pk_bf16_f32 v20, 0, v20
    v_mfma_f32_16x16x32_bf16 v[96:99], a[188:191], a[168:171], v[96:99]
    ds_read_b64_tr_b16 a[212:213], v13 offset:6144
    v_cvt_pk_bf16_f32 v21, 0, v21
    v_mfma_f32_16x16x32_bf16 v[104:107], a[188:191], a[172:175], v[104:107]
    s_waitcnt vmcnt(19) lgkmcnt(4)
    ds_read_b64_tr_b16 a[214:215], v13 offset:7168
    v_mul_f32 v23, s92, v20
    v_mfma_f32_16x16x32_bf16 v[104:107], a[184:187], a[156:159], v[104:107]
    buffer_load_dwordx4 v3, s[8:11], s38 offen lds
    v_mfma_f32_16x16x32_bf16 v[112:115], a[184:187], a[160:163], v[112:115]
    s_waitcnt vmcnt(18)
    v_exp_f32 v23, v23
    v_mfma_f32_16x16x32_bf16 v[112:115], a[188:191], a[176:179], v[112:115]
    v_mul_f32 v36, s92, v21
    v_add_f32 v23, 1.0, v23
    v_mfma_f32_16x16x32_bf16 v[120:123], a[188:191], a[180:183], v[120:123]
    s_add_u32 s38, s47, 122880
    v_exp_f32 v36, v36
    v_mfma_f32_16x16x32_bf16 v[120:123], a[184:187], a[164:167], v[120:123]
    v_rcp_f32 v23, v23
    v_mfma_f32_16x16x32_bf16 v[124:127], a[192:195], a[164:167], v[124:127]
    s_addk_i32 m0, -4096
    v_add_f32 v36, 1.0, v36
    v_mul_f32 v20, v20, v23
    v_mfma_f32_16x16x32_bf16 v[124:127], a[196:199], a[180:183], v[124:127]
    v_rcp_f32 v36, v36
    v_mfma_f32_16x16x32_bf16 v[116:119], a[196:199], a[176:179], v[116:119]
    s_barrier
    v_mfma_f32_16x16x32_bf16 v[116:119], a[192:195], a[160:163], v[116:119]
    ds_read_b64_tr_b16 a[184:185], v8 offset:0
    v_mul_f32 v21, v21, v36
    v_mfma_f32_16x16x32_bf16 v[108:111], a[192:195], a[156:159], v[108:111]
    ds_read_b64_tr_b16 a[186:187], v8 offset:2048
    v_cvt_pk_bf16_f32 v42, v20, v21
    v_mfma_f32_16x16x32_bf16 v[108:111], a[196:199], a[172:175], v[108:111]
    s_waitcnt vmcnt(16)
    ds_read_b64_tr_b16 a[188:189], v8 offset:4096
    v_lshlrev_b32 v20, 16, v27
    v_mfma_f32_16x16x32_bf16 v[100:103], a[196:199], a[168:171], v[100:103]
    buffer_load_dwordx4 v3, s[8:11], s38 offen lds
    v_mfma_f32_16x16x32_bf16 v[100:103], a[192:195], a[152:155], v[100:103]
    s_waitcnt vmcnt(10) lgkmcnt(3)
    ds_read_b64_tr_b16 a[190:191], v8 offset:6144
    v_and_b32 v21, 0xffff0000, v27
    v_mfma_f32_16x16x32_bf16 v[96:99], a[200:203], a[80:83], v[96:99]
    ds_read_b64_tr_b16 a[192:193], v9 offset:0
    v_sub_f32 v20, v20, v16
    v_mfma_f32_16x16x32_bf16 v[96:99], a[204:207], a[96:99], v[96:99]
    ds_read_b64_tr_b16 a[194:195], v9 offset:2048
    v_sub_f32 v21, v21, v16
    v_mfma_f32_16x16x32_bf16 v[104:107], a[204:207], a[100:103], v[104:107]
    s_waitcnt vmcnt(9)
    ds_read_b64_tr_b16 a[196:197], v9 offset:4096
    v_lshlrev_b32 v16, 4, v2
    v_mfma_f32_16x16x32_bf16 v[104:107], a[200:203], a[84:87], v[104:107]
    s_waitcnt vmcnt(8)
    ds_read_b64_tr_b16 a[198:199], v9 offset:6144
    v_cvt_pk_bf16_f32 v96, v96, v97
    v_mfma_f32_16x16x32_bf16 v[112:115], a[200:203], a[88:91], v[112:115]
    s_add_u32 s38, s45, 163840
    v_cvt_pk_bf16_f32 v97, v98, v99
    v_cvt_pk_bf16_f32 v20, 0, v20
    v_mfma_f32_16x16x32_bf16 v[112:115], a[204:207], a[104:107], v[112:115]
    s_xor_b32 s78, s53, 3
    v_cvt_pk_bf16_f32 v104, v104, v105
    v_cvt_pk_bf16_f32 v105, v106, v107
    v_mfma_f32_16x16x32_bf16 v[120:123], a[204:207], a[108:111], v[120:123]
    s_and_b32 s78, s78, 3
    v_cvt_pk_bf16_f32 v21, 0, v21
    v_mul_f32 v20, v20, v17
    v_mfma_f32_16x16x32_bf16 v[120:123], a[200:203], a[92:95], v[120:123]
    s_mul_i32 s78, s78, 2560
    ds_read_b64_tr_b16 a[200:201], v8 offset:8192
    v_cvt_pk_bf16_f32 v112, v112, v113
    v_mfma_f32_16x16x32_bf16 v[124:127], a[208:211], a[92:95], v[124:127]
    s_add_u32 s78, s78, s60
    ds_read_b64_tr_b16 a[202:203], v8 offset:10240
    v_cvt_pk_bf16_f32 v113, v114, v115
    v_mfma_f32_16x16x32_bf16 v[124:127], a[212:215], a[108:111], v[124:127]
    s_xor_b32 s79, s53, 1
    ds_read_b64_tr_b16 a[204:205], v8 offset:12288
    v_mul_f32 v21, v21, v17
    v_mfma_f32_16x16x32_bf16 v[116:119], a[212:215], a[104:107], v[116:119]
    s_waitcnt lgkmcnt(3)
    ds_read_b64_tr_b16 a[206:207], v8 offset:14336
    v_lshlrev_b32 v17, 6, v2
    v_mfma_f32_16x16x32_bf16 v[116:119], a[208:211], a[88:91], v[116:119]
    s_and_b32 s79, s79, 3
    v_cvt_pk_bf16_f32 v20, 0, v20
    v_cvt_pk_bf16_f32 v21, 0, v21
    v_mfma_f32_16x16x32_bf16 v[108:111], a[208:211], a[84:87], v[108:111]
    s_mul_i32 s79, s79, 2560
    v_mul_f32 v23, s92, v20
    v_mul_f32 v36, s92, v21
    v_mfma_f32_16x16x32_bf16 v[108:111], a[212:215], a[100:103], v[108:111]
    s_add_u32 s79, s79, s60
    v_cvt_pk_bf16_f32 v114, v116, v117
    v_cvt_pk_bf16_f32 v115, v118, v119
    v_mfma_f32_16x16x32_bf16 v[100:103], a[212:215], a[96:99], v[100:103]
    s_addk_i32 m0, -4096
    v_mov_b32_dpp v116, v120 row_ror:8 row_mask:0xf bank_mask:0xf
    v_mov_b32_dpp v117, v121 row_ror:8 row_mask:0xf bank_mask:0xf
    v_mfma_f32_16x16x32_bf16 v[100:103], a[208:211], a[80:83], v[100:103]
    buffer_load_dwordx4 v3, s[8:11], s38 offen lds
    v_mfma_f32_16x16x32_bf16 v[128:131], a[184:187], a[128:131], v[128:131]
    s_add_u32 s38, s46, 163840
    ds_read_b64_tr_b16 a[208:209], v9 offset:8192
    v_cvt_pk_bf16_f32 v106, v108, v109
    v_mfma_f32_16x16x32_bf16 v[128:131], a[188:191], a[0:3], v[128:131]
    s_addk_i32 m0, -4096
    ds_read_b64_tr_b16 a[210:211], v9 offset:10240
    v_cvt_pk_bf16_f32 v98, v100, v101
    v_mfma_f32_16x16x32_bf16 v[136:139], a[188:191], a[4:7], v[136:139]
    ds_read_b64_tr_b16 a[212:213], v9 offset:12288
    v_cvt_pk_bf16_f32 v99, v102, v103
    v_mfma_f32_16x16x32_bf16 v[136:139], a[184:187], a[132:135], v[136:139]
    buffer_store_dwordx4 v[96:99], v38, s[24:27], s78 offen offset:2048 sc1
    v_cvt_pk_bf16_f32 v107, v110, v111
    v_mfma_f32_16x16x32_bf16 v[144:147], a[184:187], a[136:139], v[144:147]
    s_xor_b32 s78, s53, 2
    ds_read_b64_tr_b16 a[214:215], v9 offset:14336
    v_mov_b32_dpp v118, v122 row_ror:8 row_mask:0xf bank_mask:0xf
    v_mfma_f32_16x16x32_bf16 v[144:147], a[188:191], a[8:11], v[144:147]
    buffer_store_dwordx4 v[104:107], v38, s[24:27], s79 offen offset:2048 sc1
    v_mov_b32_dpp v119, v123 row_ror:8 row_mask:0xf bank_mask:0xf
    v_mfma_f32_16x16x32_bf16 v[152:155], a[188:191], a[12:15], v[152:155]
    buffer_load_dwordx4 v3, s[8:11], s38 offen lds
    v_mfma_f32_16x16x32_bf16 v[152:155], a[184:187], a[140:143], v[152:155]
    s_and_b32 s78, s78, 3
    ds_read_b64_tr_b16 a[184:185], v8 offset:16384
    v_cvt_pk_bf16_f32 v120, v120, v121
    v_mfma_f32_16x16x32_bf16 v[156:159], a[192:195], a[140:143], v[156:159]
    s_mul_i32 s78, s78, 2560
    ds_read_b64_tr_b16 a[186:187], v8 offset:18432
    v_cvt_pk_bf16_f32 v121, v122, v123
    v_mfma_f32_16x16x32_bf16 v[156:159], a[196:199], a[12:15], v[156:159]
    s_add_u32 s78, s78, s60
    ds_read_b64_tr_b16 a[188:189], v8 offset:20480
    v_cvt_pk_bf16_f32 v122, v124, v125
    v_mfma_f32_16x16x32_bf16 v[148:151], a[196:199], a[8:11], v[148:151]
    s_waitcnt lgkmcnt(4)
    ds_read_b64_tr_b16 a[190:191], v8 offset:22528
    v_cvt_pk_bf16_f32 v123, v126, v127
    v_mfma_f32_16x16x32_bf16 v[148:151], a[192:195], a[136:139], v[148:151]
    buffer_store_dwordx4 v[112:115], v38, s[24:27], s78 offen offset:2048 sc1
    v_cndmask_b32 v124, v116, v124, s[74:75]
    v_mfma_f32_16x16x32_bf16 v[140:143], a[192:195], a[132:135], v[140:143]
    s_xor_b32 s79, s53, 0
    v_exp_f32 v23, v23
    v_mfma_f32_16x16x32_bf16 v[140:143], a[196:199], a[4:7], v[140:143]
    s_and_b32 s79, s79, 3
    v_exp_f32 v36, v36
    v_mfma_f32_16x16x32_bf16 v[132:135], a[196:199], a[0:3], v[132:135]
    s_mul_i32 s79, s79, 2560
    v_add_f32 v23, 1.0, v23
    v_add_f32 v36, 1.0, v36
    v_mfma_f32_16x16x32_bf16 v[132:135], a[192:195], a[128:131], v[132:135]
    s_add_u32 s79, s79, s60
    ds_read_b64_tr_b16 a[192:193], v9 offset:16384
    v_cndmask_b32 v125, v117, v125, s[74:75]
    v_mfma_f32_16x16x32_bf16 v[128:131], a[200:203], a[16:19], v[128:131]
    s_add_u32 s38, s47, 163840
    ds_read_b64_tr_b16 a[194:195], v9 offset:18432
    v_cndmask_b32 v126, v118, v126, s[74:75]
    v_mfma_f32_16x16x32_bf16 v[128:131], a[204:207], a[32:35], v[128:131]
    buffer_store_dwordx4 v[120:123], v38, s[24:27], s79 offen offset:2048 sc1
    v_cndmask_b32 v127, v119, v127, s[74:75]
    v_mfma_f32_16x16x32_bf16 v[136:139], a[204:207], a[36:39], v[136:139]
    s_addk_i32 m0, -4096
    ds_read_b64_tr_b16 a[196:197], v9 offset:20480
    v_mfma_f32_16x16x32_bf16 v[136:139], a[200:203], a[20:23], v[136:139]
    buffer_load_dwordx4 v3, s[8:11], s38 offen lds
    v_mfma_f32_16x16x32_bf16 v[144:147], a[200:203], a[24:27], v[144:147]
    ds_read_b64_tr_b16 a[198:199], v9 offset:22528
    v_mfma_f32_16x16x32_bf16 v[144:147], a[204:207], a[40:43], v[144:147]
    v_rcp_f32 v23, v23
    v_mfma_f32_16x16x32_bf16 v[152:155], a[204:207], a[44:47], v[152:155]
    s_waitcnt lgkmcnt(3)
    v_rcp_f32 v36, v36
    v_mfma_f32_16x16x32_bf16 v[152:155], a[200:203], a[28:31], v[152:155]
    s_add_u32 s38, s45, 204800
    v_mul_f32 v20, v20, v23
    v_mul_f32 v21, v21, v36
    v_mfma_f32_16x16x32_bf16 v[156:159], a[208:211], a[28:31], v[156:159]
    s_addk_i32 m0, -4096
    v_cvt_pk_bf16_f32 v43, v20, v21
    v_lshlrev_b32 v20, 16, v28
    v_mfma_f32_16x16x32_bf16 v[156:159], a[212:215], a[44:47], v[156:159]
    v_and_b32 v21, 0xffff0000, v28
    v_sub_f32 v20, v20, v18
    v_mfma_f32_16x16x32_bf16 v[148:151], a[212:215], a[40:43], v[148:151]
    s_barrier
    v_mfma_f32_16x16x32_bf16 v[148:151], a[208:211], a[24:27], v[148:151]
    s_waitcnt vmcnt(10)
    ds_read_b64_tr_b16 a[200:201], v8 offset:24576
    v_xor_b32 v58, s58, v58
    v_mfma_f32_16x16x32_bf16 v[140:143], a[208:211], a[20:23], v[140:143]
    s_waitcnt vmcnt(9)
    ds_read_b64_tr_b16 a[202:203], v8 offset:26624
    v_xor_b32 v59, s58, v59
    v_mfma_f32_16x16x32_bf16 v[140:143], a[212:215], a[36:39], v[140:143]
    ds_read_b64_tr_b16 a[204:205], v8 offset:28672
    v_or_b32 v58, v58, v59
    v_mfma_f32_16x16x32_bf16 v[132:135], a[212:215], a[32:35], v[132:135]
    buffer_load_dwordx4 v3, s[8:11], s38 offen lds
    v_mfma_f32_16x16x32_bf16 v[132:135], a[208:211], a[16:19], v[132:135]
    ds_read_b64_tr_b16 a[206:207], v8 offset:30720
    v_cmp_ne_u32 vcc, 0, v58
    v_mfma_f32_16x16x32_bf16 v[128:131], a[184:187], a[48:51], v[128:131]
    s_cbranch_vccnz spin_y
spin_y_ret:
    v_sub_f32 v21, v21, v18
    v_mfma_f32_16x16x32_bf16 v[128:131], a[188:191], a[64:67], v[128:131]
    buffer_load_dwordx4 v[116:119], v55, s[24:27], s55 offen sc1
    v_mfma_f32_16x16x32_bf16 v[136:139], a[188:191], a[68:71], v[136:139]
    s_add_u32 s55, s55, 10240
    ds_read_b64_tr_b16 a[208:209], v9 offset:24576
    v_cvt_pk_bf16_f32 v20, 0, v20
    v_mfma_f32_16x16x32_bf16 v[136:139], a[184:187], a[52:55], v[136:139]
    s_add_u32 s38, s46, 204800
    ds_read_b64_tr_b16 a[210:211], v9 offset:26624
    v_cvt_pk_bf16_f32 v21, 0, v21
    v_mfma_f32_16x16x32_bf16 v[144:147], a[184:187], a[56:59], v[144:147]
    buffer_load_dwordx4 v[120:123], v55, s[24:27], s55 offen sc1
    v_mfma_f32_16x16x32_bf16 v[144:147], a[188:191], a[72:75], v[144:147]
    s_waitcnt lgkmcnt(3)
    ds_read_b64_tr_b16 a[212:213], v9 offset:28672
    v_mul_f32 v20, v20, v19
    v_mfma_f32_16x16x32_bf16 v[152:155], a[188:191], a[76:79], v[152:155]
    s_add_u32 s55, s55, 10240
    ds_read_b64_tr_b16 a[214:215], v9 offset:30720
    v_mul_f32 v21, v21, v19
    v_mfma_f32_16x16x32_bf16 v[152:155], a[184:187], a[60:63], v[152:155]
    s_addk_i32 m0, -4096
    ds_read_b64_tr_b16 a[184:185], v8 offset:32768
    v_cvt_pk_bf16_f32 v20, 0, v20
    v_mfma_f32_16x16x32_bf16 v[156:159], a[192:195], a[60:63], v[156:159]
    buffer_load_dwordx4 v[56:59], v55, s[24:27], s55 offen sc1
    v_mfma_f32_16x16x32_bf16 v[156:159], a[196:199], a[76:79], v[156:159]
    s_add_u32 s55, s55, 10240
    ds_read_b64_tr_b16 a[186:187], v8 offset:34816
    v_cvt_pk_bf16_f32 v21, 0, v21
    v_mfma_f32_16x16x32_bf16 v[148:151], a[196:199], a[72:75], v[148:151]
    buffer_load_dwordx4 v3, s[8:11], s38 offen lds
    v_mfma_f32_16x16x32_bf16 v[148:151], a[192:195], a[56:59], v[148:151]
    ds_read_b64_tr_b16 a[188:189], v8 offset:36864
    v_mul_f32 v23, s92, v20
    v_mfma_f32_16x16x32_bf16 v[140:143], a[192:195], a[52:55], v[140:143]
    buffer_load_dwordx4 v[60:63], v55, s[24:27], s55 offen sc1
    v_mfma_f32_16x16x32_bf16 v[140:143], a[196:199], a[68:71], v[140:143]
    s_add_u32 s55, s55, 10240
    ds_read_b64_tr_b16 a[190:191], v8 offset:38912
    v_mul_f32 v36, s92, v21
    v_mfma_f32_16x16x32_bf16 v[132:135], a[196:199], a[64:67], v[132:135]
    s_waitcnt lgkmcnt(3)
    v_exp_f32 v23, v23
    v_mfma_f32_16x16x32_bf16 v[132:135], a[192:195], a[48:51], v[132:135]
    s_add_u32 s38, s47, 204800
    ds_read_b64_tr_b16 a[192:193], v9 offset:32768
    v_add_f32 v23, 1.0, v23
    v_mfma_f32_16x16x32_bf16 v[128:131], a[200:203], a[216:219], v[128:131]
    buffer_load_dwordx4 v[64:67], v55, s[24:27], s55 offen sc1
    v_mfma_f32_16x16x32_bf16 v[128:131], a[204:207], a[232:235], v[128:131]
    s_add_u32 s55, s55, 10240
    ds_read_b64_tr_b16 a[194:195], v9 offset:34816
    s_addk_i32 m0, -4096
    v_mfma_f32_16x16x32_bf16 v[136:139], a[204:207], a[236:239], v[136:139]
    ds_read_b64_tr_b16 a[196:197], v9 offset:36864
    v_mfma_f32_16x16x32_bf16 v[136:139], a[200:203], a[220:223], v[136:139]
    ds_read_b64_tr_b16 a[198:199], v9 offset:38912
    v_mfma_f32_16x16x32_bf16 v[144:147], a[200:203], a[224:227], v[144:147]
    buffer_load_dwordx4 v[68:71], v55, s[24:27], s55 offen sc1
    v_mfma_f32_16x16x32_bf16 v[144:147], a[204:207], a[240:243], v[144:147]
    s_add_u32 s55, s55, 10240
    v_exp_f32 v36, v36
    v_mfma_f32_16x16x32_bf16 v[152:155], a[204:207], a[244:247], v[152:155]
    buffer_load_dwordx4 v3, s[8:11], s38 offen lds
    v_mfma_f32_16x16x32_bf16 v[152:155], a[200:203], a[228:231], v[152:155]
    ds_read_b64_tr_b16 a[200:201], v8 offset:40960
    v_add_f32 v36, 1.0, v36
    v_mfma_f32_16x16x32_bf16 v[156:159], a[208:211], a[228:231], v[156:159]
    buffer_load_dwordx4 v[72:75], v55, s[24:27], s55 offen sc1
    v_mfma_f32_16x16x32_bf16 v[156:159], a[212:215], a[244:247], v[156:159]
    s_add_u32 s55, s55, 10240
    ds_read_b64_tr_b16 a[202:203], v8 offset:43008
    v_mfma_f32_16x16x32_bf16 v[148:151], a[212:215], a[240:243], v[148:151]
    ds_read_b64_tr_b16 a[204:205], v8 offset:45056
    v_mfma_f32_16x16x32_bf16 v[148:151], a[208:211], a[224:227], v[148:151]
    ds_read_b64_tr_b16 a[206:207], v8 offset:47104
    v_add_u32 v8, 90112, v8
    v_mfma_f32_16x16x32_bf16 v[140:143], a[208:211], a[220:223], v[140:143]
    s_waitcnt lgkmcnt(4)
    v_rcp_f32 v23, v23
    v_mfma_f32_16x16x32_bf16 v[140:143], a[212:215], a[236:239], v[140:143]
    buffer_load_dwordx4 v[76:79], v55, s[24:27], s55 offen sc1
    v_mfma_f32_16x16x32_bf16 v[132:135], a[212:215], a[232:235], v[132:135]
    s_add_u32 s55, s55, 10240
    v_rcp_f32 v36, v36
    v_mfma_f32_16x16x32_bf16 v[132:135], a[208:211], a[216:219], v[132:135]
    ds_read_b64_tr_b16 a[208:209], v9 offset:40960
    v_mul_f32 v20, v20, v23
    v_mfma_f32_16x16x32_bf16 v[128:131], a[184:187], a[152:155], v[128:131]
    buffer_load_dwordx4 v[80:83], v55, s[24:27], s55 offen sc1
    v_mfma_f32_16x16x32_bf16 v[128:131], a[188:191], a[168:171], v[128:131]
    s_add_u32 s55, s55, 10240
    ds_read_b64_tr_b16 a[210:211], v9 offset:43008
    v_mul_f32 v21, v21, v36
    v_mfma_f32_16x16x32_bf16 v[136:139], a[188:191], a[172:175], v[136:139]
    ds_read_b64_tr_b16 a[212:213], v9 offset:45056
    v_cvt_pk_bf16_f32 v44, v20, v21
    v_mfma_f32_16x16x32_bf16 v[136:139], a[184:187], a[156:159], v[136:139]
    ds_read_b64_tr_b16 a[214:215], v9 offset:47104
    v_add_u32 v9, 90112, v9
    v_mfma_f32_16x16x32_bf16 v[144:147], a[184:187], a[160:163], v[144:147]
    buffer_load_dwordx4 v[84:87], v55, s[24:27], s55 offen sc1
    v_mfma_f32_16x16x32_bf16 v[144:147], a[188:191], a[176:179], v[144:147]
    s_add_u32 s55, s55, 10240
    v_lshlrev_b32 v20, 16, v29
    v_and_b32 v21, 0xffff0000, v29
    v_mfma_f32_16x16x32_bf16 v[152:155], a[188:191], a[180:183], v[152:155]
    v_sub_f32 v20, v20, v18
    v_sub_f32 v21, v21, v18
    v_mfma_f32_16x16x32_bf16 v[152:155], a[184:187], a[164:167], v[152:155]
    ds_read_b64_tr_b16 a[184:185], v10 offset:0
    v_cvt_pk_bf16_f32 v20, 0, v20
    v_mfma_f32_16x16x32_bf16 v[156:159], a[192:195], a[164:167], v[156:159]
    buffer_load_dwordx4 v[88:91], v55, s[24:27], s55 offen sc1
    v_mfma_f32_16x16x32_bf16 v[156:159], a[196:199], a[180:183], v[156:159]
    s_add_u32 s55, s55, 10240
    ds_read_b64_tr_b16 a[186:187], v10 offset:2048
    v_cvt_pk_bf16_f32 v21, 0, v21
    v_mfma_f32_16x16x32_bf16 v[148:151], a[196:199], a[176:179], v[148:151]
    ds_read_b64_tr_b16 a[188:189], v10 offset:4096
    v_mul_f32 v20, v20, v19
    v_mfma_f32_16x16x32_bf16 v[148:151], a[192:195], a[160:163], v[148:151]
    s_waitcnt lgkmcnt(3)
    ds_read_b64_tr_b16 a[190:191], v10 offset:6144
    v_mul_f32 v21, v21, v19
    v_mfma_f32_16x16x32_bf16 v[140:143], a[192:195], a[156:159], v[140:143]
    buffer_load_dwordx4 v[92:95], v55, s[24:27], s55 offen sc1
    v_mfma_f32_16x16x32_bf16 v[140:143], a[196:199], a[172:175], v[140:143]
    v_cvt_pk_bf16_f32 v20, 0, v20
    v_cvt_pk_bf16_f32 v21, 0, v21
    v_mfma_f32_16x16x32_bf16 v[132:135], a[196:199], a[168:171], v[132:135]
    v_mul_f32 v23, s92, v20
    v_mul_f32 v36, s92, v21
    v_mfma_f32_16x16x32_bf16 v[132:135], a[192:195], a[152:155], v[132:135]
    ds_read_b64_tr_b16 a[192:193], v11 offset:0
    v_mfma_f32_16x16x32_bf16 v[128:131], a[200:203], a[80:83], v[128:131]
    ds_read_b64_tr_b16 a[194:195], v11 offset:2048
    v_mfma_f32_16x16x32_bf16 v[128:131], a[204:207], a[96:99], v[128:131]
    ds_read_b64_tr_b16 a[196:197], v11 offset:4096
    v_mfma_f32_16x16x32_bf16 v[136:139], a[204:207], a[100:103], v[136:139]
    s_load_dwordx8 s[28:35], s[86:87], s93 glc
    ds_read_b64_tr_b16 a[198:199], v11 offset:6144
    v_mfma_f32_16x16x32_bf16 v[136:139], a[200:203], a[84:87], v[136:139]
    v_exp_f32 v23, v23
    v_mfma_f32_16x16x32_bf16 v[144:147], a[200:203], a[88:91], v[144:147]
    v_exp_f32 v36, v36
    v_mfma_f32_16x16x32_bf16 v[144:147], a[204:207], a[104:107], v[144:147]
    s_xor_b32 s78, s53, 7
    v_cvt_pk_bf16_f32 v128, v128, v129
    v_cvt_pk_bf16_f32 v129, v130, v131
    v_mfma_f32_16x16x32_bf16 v[152:155], a[204:207], a[108:111], v[152:155]
    s_mul_i32 s78, s78, 2560
    v_cvt_pk_bf16_f32 v136, v136, v137
    v_cvt_pk_bf16_f32 v137, v138, v139
    v_mfma_f32_16x16x32_bf16 v[152:155], a[200:203], a[92:95], v[152:155]
    s_add_u32 s78, s78, s60
    ds_read_b64_tr_b16 a[200:201], v10 offset:8192
    v_cvt_pk_bf16_f32 v144, v144, v145
    v_mfma_f32_16x16x32_bf16 v[156:159], a[208:211], a[92:95], v[156:159]
    s_xor_b32 s79, s53, 6
    ds_read_b64_tr_b16 a[202:203], v10 offset:10240
    v_cvt_pk_bf16_f32 v145, v146, v147
    v_mfma_f32_16x16x32_bf16 v[156:159], a[212:215], a[108:111], v[156:159]
    s_mul_i32 s79, s79, 2560
    ds_read_b64_tr_b16 a[204:205], v10 offset:12288
    v_cvt_pk_bf16_f32 v152, v152, v153
    v_mfma_f32_16x16x32_bf16 v[148:151], a[212:215], a[104:107], v[148:151]
    s_waitcnt lgkmcnt(5)
    ds_read_b64_tr_b16 a[206:207], v10 offset:14336
    v_cvt_pk_bf16_f32 v153, v154, v155
    v_mfma_f32_16x16x32_bf16 v[148:151], a[208:211], a[88:91], v[148:151]
    s_add_u32 s79, s79, s60
    v_cvt_pk_bf16_f32 v154, v156, v157
    v_cvt_pk_bf16_f32 v155, v158, v159
    v_mfma_f32_16x16x32_bf16 v[140:143], a[208:211], a[84:87], v[140:143]
    s_lshl_b32 s56, s3, 9
    v_add_f32 v23, 1.0, v23
    v_add_f32 v36, 1.0, v36
    v_mfma_f32_16x16x32_bf16 v[140:143], a[212:215], a[100:103], v[140:143]
    s_add_u32 s56, s56, 61440
    v_cvt_pk_bf16_f32 v146, v148, v149
    v_cvt_pk_bf16_f32 v147, v150, v151
    v_mfma_f32_16x16x32_bf16 v[132:135], a[212:215], a[96:99], v[132:135]
    v_rcp_f32 v23, v23
    v_mfma_f32_16x16x32_bf16 v[132:135], a[208:211], a[80:83], v[132:135]
    ds_read_b64_tr_b16 a[208:209], v11 offset:8192
    v_mul_f32 v20, v20, v23
    v_mfma_f32_16x16x32_bf16 v[160:163], a[184:187], a[128:131], v[160:163]
    ds_read_b64_tr_b16 a[210:211], v11 offset:10240
    v_cvt_pk_bf16_f32 v138, v140, v141
    v_mfma_f32_16x16x32_bf16 v[160:163], a[188:191], a[0:3], v[160:163]
    ds_read_b64_tr_b16 a[212:213], v11 offset:12288
    v_cvt_pk_bf16_f32 v139, v142, v143
    v_mfma_f32_16x16x32_bf16 v[168:171], a[188:191], a[4:7], v[168:171]
    ds_read_b64_tr_b16 a[214:215], v11 offset:14336
    v_cvt_pk_bf16_f32 v130, v132, v133
    v_mfma_f32_16x16x32_bf16 v[168:171], a[184:187], a[132:135], v[168:171]
    v_cvt_pk_bf16_f32 v131, v134, v135
    v_cmp_eq_u32 s[8:9], s39, v5
    v_mfma_f32_16x16x32_bf16 v[176:179], a[184:187], a[136:139], v[176:179]
    buffer_store_dwordx4 v[128:131], v14, s[24:27], s78 offen offset:1024 sc1
    v_cmp_eq_u32 s[20:21], s40, v5
    v_mfma_f32_16x16x32_bf16 v[176:179], a[188:191], a[8:11], v[176:179]
    buffer_store_dwordx4 v[136:139], v14, s[24:27], s78 offen offset:0 sc1
    v_lshl_add_u32 v12, v1, 3, s56
    v_mfma_f32_16x16x32_bf16 v[184:187], a[188:191], a[12:15], v[184:187]
    s_waitcnt lgkmcnt(5)
    v_rcp_f32 v36, v36
    v_mfma_f32_16x16x32_bf16 v[184:187], a[184:187], a[140:143], v[184:187]
    s_or_b64 s[8:9], s[8:9], s[20:21]
    ds_read_b64_tr_b16 a[184:185], v10 offset:16384
    v_mul_f32 v21, v21, v36
    v_mfma_f32_16x16x32_bf16 v[188:191], a[192:195], a[140:143], v[188:191]
    ds_read_b64_tr_b16 a[186:187], v10 offset:18432
    v_cvt_pk_bf16_f32 v45, v20, v21
    v_mfma_f32_16x16x32_bf16 v[188:191], a[196:199], a[12:15], v[188:191]
    ds_read_b64_tr_b16 a[188:189], v10 offset:20480
    v_lshlrev_b32 v20, 16, v30
    v_mfma_f32_16x16x32_bf16 v[180:183], a[196:199], a[8:11], v[180:183]
    s_waitcnt vmcnt(14)
    ds_read_b64_tr_b16 a[190:191], v10 offset:22528
    v_and_b32 v21, 0xffff0000, v30
    v_mfma_f32_16x16x32_bf16 v[180:183], a[192:195], a[136:139], v[180:183]
    buffer_store_dwordx4 v[144:147], v14, s[24:27], s79 offen offset:1024 sc1
    v_sub_f32 v20, v20, v18
    v_mfma_f32_16x16x32_bf16 v[172:175], a[192:195], a[132:135], v[172:175]
    v_sub_f32 v21, v21, v18
    v_cvt_pk_bf16_f32 v20, 0, v20
    v_mfma_f32_16x16x32_bf16 v[172:175], a[196:199], a[4:7], v[172:175]
    s_or_b64 s[88:89], s[28:29], s[30:31]
    v_cvt_pk_bf16_f32 v21, 0, v21
    v_mul_f32 v20, v20, v19
    v_mfma_f32_16x16x32_bf16 v[164:167], a[196:199], a[0:3], v[164:167]
    s_waitcnt lgkmcnt(5)
    v_mul_f32 v21, v21, v19
    v_cvt_pk_bf16_f32 v20, 0, v20
    v_mfma_f32_16x16x32_bf16 v[164:167], a[192:195], a[128:131], v[164:167]
    s_or_b64 s[88:89], s[88:89], s[32:33]
    ds_read_b64_tr_b16 a[192:193], v11 offset:16384
    v_cvt_pk_bf16_f32 v21, 0, v21
    v_mfma_f32_16x16x32_bf16 v[160:163], a[200:203], a[16:19], v[160:163]
    s_load_dwordx8 s[28:35], s[86:87], s93 glc
    ds_read_b64_tr_b16 a[194:195], v11 offset:18432
    v_mul_f32 v23, s92, v20
    v_mfma_f32_16x16x32_bf16 v[160:163], a[204:207], a[32:35], v[160:163]
pg_15:
    s_cbranch_execz pg_backL
    buffer_store_dwordx4 v[152:155], v14, s[24:27], s79 offen offset:0 sc1
    v_mul_f32 v36, s92, v21
    v_mfma_f32_16x16x32_bf16 v[168:171], a[204:207], a[36:39], v[168:171]
    s_or_b64 s[88:89], s[88:89], s[34:35]
    ds_read_b64_tr_b16 a[196:197], v11 offset:20480
    v_add_f32 v116, v116, v120
    v_mfma_f32_16x16x32_bf16 v[168:171], a[200:203], a[20:23], v[168:171]
    s_or_b32 s66, s88, s89
    ds_read_b64_tr_b16 a[198:199], v11 offset:22528
    v_add_f32 v117, v117, v121
    v_mfma_f32_16x16x32_bf16 v[176:179], a[200:203], a[24:27], v[176:179]
    s_andn2_b32 s69, s66, s80
    s_cselect_b32 s65, s59, 0x70000000
    v_add_f32 v118, v118, v122
    v_mfma_f32_16x16x32_bf16 v[176:179], a[204:207], a[40:43], v[176:179]
    s_ff1_i32_b32 s69, s69
    v_exp_f32 v23, v23
    v_mfma_f32_16x16x32_bf16 v[184:187], a[204:207], a[44:47], v[184:187]
    s_waitcnt lgkmcnt(7)
    v_exp_f32 v36, v36
    v_mfma_f32_16x16x32_bf16 v[184:187], a[200:203], a[28:31], v[184:187]
    s_xor_b32 s81, s53, s69
    ds_read_b64_tr_b16 a[200:201], v10 offset:24576
    v_add_f32 v23, 1.0, v23
    v_mfma_f32_16x16x32_bf16 v[188:191], a[208:211], a[28:31], v[188:191]
    s_mul_i32 s81, s81, 20480
    ds_read_b64_tr_b16 a[202:203], v10 offset:26624
    v_add_f32 v36, 1.0, v36
    v_mfma_f32_16x16x32_bf16 v[188:191], a[212:215], a[44:47], v[188:191]
    s_add_u32 s81, s81, s65
    ds_read_b64_tr_b16 a[204:205], v10 offset:28672
    v_add_f32 v119, v119, v123
    v_mfma_f32_16x16x32_bf16 v[180:183], a[212:215], a[40:43], v[180:183]
    s_bitset1_b32 s80, s69
    ds_read_b64_tr_b16 a[206:207], v10 offset:30720
    v_mfma_f32_16x16x32_bf16 v[180:183], a[208:211], a[24:27], v[180:183]
    s_waitcnt lgkmcnt(8)
    v_rcp_f32 v23, v23
    v_mfma_f32_16x16x32_bf16 v[172:175], a[208:211], a[20:23], v[172:175]
    s_waitcnt vmcnt(15)
    v_rcp_f32 v36, v36
    v_mfma_f32_16x16x32_bf16 v[172:175], a[212:215], a[36:39], v[172:175]
    v_mul_f32 v20, v20, v23
    v_mul_f32 v21, v21, v36
    v_mfma_f32_16x16x32_bf16 v[164:167], a[212:215], a[32:35], v[164:167]
    v_cvt_pk_bf16_f32 v46, v20, v21
    v_lshlrev_b32 v20, 16, v31
    v_mfma_f32_16x16x32_bf16 v[164:167], a[208:211], a[16:19], v[164:167]
    buffer_load_dwordx4 v[98:101], v14, s[24:27], s81 offen sc1
    v_mfma_f32_16x16x32_bf16 v[160:163], a[184:187], a[48:51], v[160:163]
    ds_read_b64_tr_b16 a[208:209], v11 offset:24576
    v_and_b32 v21, 0xffff0000, v31
    v_mfma_f32_16x16x32_bf16 v[160:163], a[188:191], a[64:67], v[160:163]
    ds_read_b64_tr_b16 a[210:211], v11 offset:26624
    v_sub_f32 v20, v20, v18
    v_mfma_f32_16x16x32_bf16 v[168:171], a[188:191], a[68:71], v[168:171]
    buffer_load_dwordx4 v[102:105], v14, s[24:27], s81 offen offset:1024 sc1
    v_mfma_f32_16x16x32_bf16 v[168:171], a[184:187], a[52:55], v[168:171]
    ds_read_b64_tr_b16 a[212:213], v11 offset:28672
    v_sub_f32 v21, v21, v18
    v_mfma_f32_16x16x32_bf16 v[176:179], a[184:187], a[56:59], v[176:179]
    s_waitcnt lgkmcnt(7)
    ds_read_b64_tr_b16 a[214:215], v11 offset:30720
    v_cvt_pk_bf16_f32 v20, 0, v20
    v_mfma_f32_16x16x32_bf16 v[176:179], a[188:191], a[72:75], v[176:179]
    buffer_load_dwordx2 v[96:97], v39, s[24:27], s81 offen offset:2048 sc1
    v_mfma_f32_16x16x32_bf16 v[184:187], a[188:191], a[76:79], v[184:187]
    v_cvt_pk_bf16_f32 v21, 0, v21
    v_mul_f32 v20, v20, v19
    v_mfma_f32_16x16x32_bf16 v[184:187], a[184:187], a[60:63], v[184:187]
    ds_read_b64_tr_b16 a[184:185], v10 offset:32768
    v_mul_f32 v21, v21, v19
    v_mfma_f32_16x16x32_bf16 v[188:191], a[192:195], a[60:63], v[188:191]
    ds_read_b64_tr_b16 a[186:187], v10 offset:34816
    v_cvt_pk_bf16_f32 v20, 0, v20
    v_mfma_f32_16x16x32_bf16 v[188:191], a[196:199], a[76:79], v[188:191]
    ds_read_b64_tr_b16 a[188:189], v10 offset:36864
    v_cvt_pk_bf16_f32 v21, 0, v21
    v_mfma_f32_16x16x32_bf16 v[180:183], a[196:199], a[72:75], v[180:183]
    s_waitcnt lgkmcnt(6)
    ds_read_b64_tr_b16 a[190:191], v10 offset:38912
    v_mul_f32 v23, s92, v20
    v_mfma_f32_16x16x32_bf16 v[180:183], a[192:195], a[56:59], v[180:183]
    v_exp_f32 v23, v23
    v_mfma_f32_16x16x32_bf16 v[172:175], a[192:195], a[52:55], v[172:175]
    v_mul_f32 v36, s92, v21
    v_add_f32 v23, 1.0, v23
    v_mfma_f32_16x16x32_bf16 v[172:175], a[196:199], a[68:71], v[172:175]
    v_exp_f32 v36, v36
    v_mfma_f32_16x16x32_bf16 v[164:167], a[196:199], a[64:67], v[164:167]
    v_rcp_f32 v23, v23
    v_mfma_f32_16x16x32_bf16 v[164:167], a[192:195], a[48:51], v[164:167]
    ds_read_b64_tr_b16 a[192:193], v11 offset:32768
    v_add_f32 v36, 1.0, v36
    v_mfma_f32_16x16x32_bf16 v[160:163], a[200:203], a[216:219], v[160:163]
    s_or_b64 s[88:89], s[28:29], s[30:31]
    ds_read_b64_tr_b16 a[194:195], v11 offset:34816
    v_mul_f32 v20, v20, v23
    v_mfma_f32_16x16x32_bf16 v[160:163], a[204:207], a[232:235], v[160:163]
    s_or_b64 s[88:89], s[88:89], s[32:33]
    ds_read_b64_tr_b16 a[196:197], v11 offset:36864
    v_add_f32 v116, v116, v56
    v_mfma_f32_16x16x32_bf16 v[168:171], a[204:207], a[236:239], v[168:171]
    s_or_b64 s[88:89], s[88:89], s[34:35]
    ds_read_b64_tr_b16 a[198:199], v11 offset:38912
    v_add_f32 v117, v117, v57
    v_mfma_f32_16x16x32_bf16 v[168:171], a[200:203], a[220:223], v[168:171]
    s_waitcnt lgkmcnt(6)
    v_rcp_f32 v36, v36
    v_mfma_f32_16x16x32_bf16 v[176:179], a[200:203], a[224:227], v[176:179]
    s_or_b32 s66, s88, s89
    v_mul_f32 v21, v21, v36
    v_cvt_pk_bf16_f32 v47, v20, v21
    v_mfma_f32_16x16x32_bf16 v[176:179], a[204:207], a[240:243], v[176:179]
    s_waitcnt vmcnt(16)
    v_add_f32 v118, v118, v58
    v_add_f32 v119, v119, v59
    v_mfma_f32_16x16x32_bf16 v[184:187], a[204:207], a[244:247], v[184:187]
    s_andn2_b32 s69, s66, s80
    s_cselect_b32 s65, s59, 0x70000000
    v_add_f32 v116, v116, v60
    v_mfma_f32_16x16x32_bf16 v[184:187], a[200:203], a[228:231], v[184:187]
    s_ff1_i32_b32 s69, s69
    ds_read_b64_tr_b16 a[200:201], v10 offset:40960
    v_add_f32 v117, v117, v61
    v_mfma_f32_16x16x32_bf16 v[188:191], a[208:211], a[228:231], v[188:191]
    s_xor_b32 s72, s53, s69
    ds_read_b64_tr_b16 a[202:203], v10 offset:43008
    v_add_f32 v118, v118, v62
    v_mfma_f32_16x16x32_bf16 v[188:191], a[212:215], a[244:247], v[188:191]
    s_mul_i32 s72, s72, 20480
    ds_read_b64_tr_b16 a[204:205], v10 offset:45056
    v_add_f32 v119, v119, v63
    v_mfma_f32_16x16x32_bf16 v[180:183], a[212:215], a[240:243], v[180:183]
    s_add_u32 s72, s72, s65
    ds_read_b64_tr_b16 a[206:207], v10 offset:47104
    v_add_u32 v10, 90112, v10
    v_mfma_f32_16x16x32_bf16 v[180:183], a[208:211], a[224:227], v[180:183]
    s_bitset1_b32 s80, s69
    v_xor_b32 v20, 16, v5
    v_cmp_eq_u32 s[10:11], s39, v20
    v_mfma_f32_16x16x32_bf16 v[172:175], a[208:211], a[220:223], v[172:175]
    s_waitcnt vmcnt(15)
    v_add_f32 v116, v116, v64
    v_add_f32 v117, v117, v65
    v_mfma_f32_16x16x32_bf16 v[172:175], a[212:215], a[236:239], v[172:175]
    s_waitcnt vmcnt(14)
    v_add_f32 v118, v118, v66
    v_add_f32 v119, v119, v67
    v_mfma_f32_16x16x32_bf16 v[164:167], a[212:215], a[232:235], v[164:167]
    s_waitcnt lgkmcnt(5)
    v_add_f32 v116, v116, v68
    v_add_f32 v117, v117, v69
    v_mfma_f32_16x16x32_bf16 v[164:167], a[208:211], a[216:219], v[164:167]
    s_waitcnt vmcnt(12)
    ds_read_b64_tr_b16 a[208:209], v11 offset:40960
    v_add_f32 v118, v118, v70
    v_mfma_f32_16x16x32_bf16 v[160:163], a[184:187], a[152:155], v[160:163]
    ds_read_b64_tr_b16 a[210:211], v11 offset:43008
    v_add_f32 v119, v119, v71
    v_mfma_f32_16x16x32_bf16 v[160:163], a[188:191], a[168:171], v[160:163]
    ds_read_b64_tr_b16 a[212:213], v11 offset:45056
    v_add_f32 v116, v116, v72
    v_mfma_f32_16x16x32_bf16 v[168:171], a[188:191], a[172:175], v[168:171]
    buffer_load_dwordx4 v[108:111], v14, s[24:27], s72 offen sc1
    v_mfma_f32_16x16x32_bf16 v[168:171], a[184:187], a[156:159], v[168:171]
    s_waitcnt vmcnt(4)
    ds_read_b64_tr_b16 a[214:215], v11 offset:47104
    v_add_u32 v11, 90112, v11
    v_mfma_f32_16x16x32_bf16 v[176:179], a[184:187], a[160:163], v[176:179]
    buffer_store_dword v17, v7, s[24:27], s67 offen offset:24 sc1
    v_mfma_f32_16x16x32_bf16 v[176:179], a[188:191], a[176:179], v[176:179]
    buffer_load_dwordx4 v[112:115], v14, s[24:27], s72 offen offset:1024 sc1
    v_mfma_f32_16x16x32_bf16 v[184:187], a[188:191], a[180:183], v[184:187]
    s_waitcnt lgkmcnt(3)
    v_lshlrev_b32 v17, 2, v2
    v_add_f32 v117, v117, v73
    v_mfma_f32_16x16x32_bf16 v[184:187], a[184:187], a[164:167], v[184:187]
    s_xor_b32 s67, s50, 1
    v_add_f32 v118, v118, v74
    v_add_f32 v119, v119, v75
    v_mfma_f32_16x16x32_bf16 v[188:191], a[192:195], a[164:167], v[188:191]
    buffer_load_dwordx2 v[106:107], v39, s[24:27], s72 offen offset:2048 sc1
    v_mfma_f32_16x16x32_bf16 v[188:191], a[196:199], a[180:183], v[188:191]
    s_lshl_b32 s67, s67, 10
    v_add_f32 v116, v116, v76
    v_add_f32 v117, v117, v77
    v_mfma_f32_16x16x32_bf16 v[180:183], a[196:199], a[176:179], v[180:183]
    s_barrier
    v_mfma_f32_16x16x32_bf16 v[180:183], a[192:195], a[160:163], v[180:183]
    s_add_u32 s67, s61, s67
    ds_read_b64_tr_b16 a[184:185], v8 offset:45056
    v_add_f32 v118, v118, v78
    v_mfma_f32_16x16x32_bf16 v[172:175], a[192:195], a[156:159], v[172:175]
    ds_read_b64_tr_b16 a[186:187], v8 offset:47104
    v_add_f32 v119, v119, v79
    v_mfma_f32_16x16x32_bf16 v[172:175], a[196:199], a[172:175], v[172:175]
    ds_read_b64_tr_b16 a[188:189], v8 offset:40960
    v_add_f32 v116, v116, v80
    v_mfma_f32_16x16x32_bf16 v[164:167], a[196:199], a[168:171], v[164:167]
    ds_read_b64_tr_b16 a[190:191], v8 offset:43008
    v_add_f32 v117, v117, v81
    v_mfma_f32_16x16x32_bf16 v[164:167], a[192:195], a[152:155], v[164:167]
    ds_read_b64_tr_b16 a[192:193], v9 offset:45056
    v_add_f32 v118, v118, v82
    v_mfma_f32_16x16x32_bf16 v[160:163], a[200:203], a[80:83], v[160:163]
    s_load_dwordx8 s[28:35], s[86:87], s93 glc
    ds_read_b64_tr_b16 a[194:195], v9 offset:47104
    v_add_f32 v119, v119, v83
    v_mfma_f32_16x16x32_bf16 v[160:163], a[204:207], a[96:99], v[160:163]
    ds_read_b64_tr_b16 a[196:197], v9 offset:40960
    v_add_f32 v116, v116, v84
    v_mfma_f32_16x16x32_bf16 v[168:171], a[204:207], a[100:103], v[168:171]
    ds_read_b64_tr_b16 a[198:199], v9 offset:43008
    v_add_f32 v117, v117, v85
    v_mfma_f32_16x16x32_bf16 v[168:171], a[200:203], a[84:87], v[168:171]
    s_waitcnt lgkmcnt(8)
    v_add_f32 v118, v118, v86
    v_cvt_pk_bf16_f32 v160, v160, v161
    v_mfma_f32_16x16x32_bf16 v[176:179], a[200:203], a[88:91], v[176:179]
    v_cvt_pk_bf16_f32 v161, v162, v163
    v_add_f32 v119, v119, v87
    v_mfma_f32_16x16x32_bf16 v[176:179], a[204:207], a[104:107], v[176:179]
    s_xor_b32 s78, s53, 5
    v_cvt_pk_bf16_f32 v168, v168, v169
    v_cvt_pk_bf16_f32 v169, v170, v171
    v_mfma_f32_16x16x32_bf16 v[184:187], a[204:207], a[108:111], v[184:187]
    s_mul_i32 s78, s78, 2560
    v_add_f32 v116, v116, v88
    v_add_f32 v117, v117, v89
    v_mfma_f32_16x16x32_bf16 v[184:187], a[200:203], a[92:95], v[184:187]
    s_add_u32 s78, s78, s60
    ds_read_b64_tr_b16 a[200:201], v8 offset:36864
    v_cvt_pk_bf16_f32 v176, v176, v177
    v_mfma_f32_16x16x32_bf16 v[188:191], a[208:211], a[92:95], v[188:191]
    s_xor_b32 s79, s53, 4
    ds_read_b64_tr_b16 a[202:203], v8 offset:38912
    v_cvt_pk_bf16_f32 v177, v178, v179
    v_mfma_f32_16x16x32_bf16 v[188:191], a[212:215], a[108:111], v[188:191]
    s_mul_i32 s79, s79, 2560
    ds_read_b64_tr_b16 a[204:205], v8 offset:32768
    v_cvt_pk_bf16_f32 v184, v184, v185
    v_mfma_f32_16x16x32_bf16 v[180:183], a[212:215], a[104:107], v[180:183]
    s_waitcnt lgkmcnt(5)
    ds_read_b64_tr_b16 a[206:207], v8 offset:34816
    v_cvt_pk_bf16_f32 v185, v186, v187
    v_mfma_f32_16x16x32_bf16 v[180:183], a[208:211], a[88:91], v[180:183]
    s_add_u32 s79, s79, s60
    v_cvt_pk_bf16_f32 v186, v188, v189
    v_cvt_pk_bf16_f32 v187, v190, v191
    v_mfma_f32_16x16x32_bf16 v[172:175], a[208:211], a[84:87], v[172:175]
    v_add_f32 v118, v118, v90
    v_add_f32 v119, v119, v91
    v_mfma_f32_16x16x32_bf16 v[172:175], a[212:215], a[100:103], v[172:175]
    v_add_f32 v116, v116, v92
    v_cvt_pk_bf16_f32 v178, v180, v181
    v_mfma_f32_16x16x32_bf16 v[164:167], a[212:215], a[96:99], v[164:167]
    v_cvt_pk_bf16_f32 v179, v182, v183
    v_add_f32 v117, v117, v93
    v_mfma_f32_16x16x32_bf16 v[164:167], a[208:211], a[80:83], v[164:167]
    ds_read_b64_tr_b16 a[208:209], v9 offset:36864
    v_add_f32 v118, v118, v94
    v_mfma_f32_16x16x32_bf16 v[192:195], a[184:187], a[128:131], v[192:195]
    ds_read_b64_tr_b16 a[210:211], v9 offset:38912
    v_cvt_pk_bf16_f32 v170, v172, v173
    v_mfma_f32_16x16x32_bf16 v[192:195], a[188:191], a[0:3], v[192:195]
    ds_read_b64_tr_b16 a[212:213], v9 offset:32768
    v_cvt_pk_bf16_f32 v171, v174, v175
    v_mfma_f32_16x16x32_bf16 v[200:203], a[188:191], a[4:7], v[200:203]
    ds_read_b64_tr_b16 a[214:215], v9 offset:34816
    v_cvt_pk_bf16_f32 v162, v164, v165
    v_mfma_f32_16x16x32_bf16 v[200:203], a[184:187], a[132:135], v[200:203]
    v_cvt_pk_bf16_f32 v163, v166, v167
    v_add_f32 v119, v119, v95
    v_mfma_f32_16x16x32_bf16 v[208:211], a[184:187], a[136:139], v[208:211]
    buffer_store_dwordx4 v[160:163], v14, s[24:27], s78 offen offset:0 sc1
    v_mov_b32 v120, v116
    v_mfma_f32_16x16x32_bf16 v[208:211], a[188:191], a[8:11], v[208:211]
    buffer_store_dwordx4 v[168:171], v14, s[24:27], s78 offen offset:1024 sc1
    v_mov_b32 v121, v117
    v_mfma_f32_16x16x32_bf16 v[216:219], a[188:191], a[12:15], v[216:219]
    s_waitcnt lgkmcnt(5)
    v_permlane16_swap_b32 v116, v120
    v_mfma_f32_16x16x32_bf16 v[216:219], a[184:187], a[140:143], v[216:219]
    ds_read_b64_tr_b16 a[184:185], v8 offset:28672
    v_mov_b32 v122, v118
    v_mfma_f32_16x16x32_bf16 v[220:223], a[192:195], a[140:143], v[220:223]
    ds_read_b64_tr_b16 a[186:187], v8 offset:30720
    v_mov_b32 v123, v119
    v_mfma_f32_16x16x32_bf16 v[220:223], a[196:199], a[12:15], v[220:223]
    ds_read_b64_tr_b16 a[188:189], v8 offset:24576
    v_add_f32 v116, v116, v120
    v_mfma_f32_16x16x32_bf16 v[212:215], a[196:199], a[8:11], v[212:215]
    ds_read_b64_tr_b16 a[190:191], v8 offset:26624
    v_cvt_pk_bf16_f32 v116, 0, v116
    v_mfma_f32_16x16x32_bf16 v[212:215], a[192:195], a[136:139], v[212:215]
    buffer_store_dwordx4 v[176:179], v14, s[24:27], s79 offen offset:0 sc1
    v_mul_f32 v116, v116, v54
    v_mfma_f32_16x16x32_bf16 v[204:207], a[192:195], a[132:135], v[204:207]
    s_or_b64 s[88:89], s[28:29], s[30:31]
    v_permlane16_swap_b32 v117, v121
    v_mfma_f32_16x16x32_bf16 v[204:207], a[196:199], a[4:7], v[204:207]
    s_or_b64 s[88:89], s[88:89], s[32:33]
    v_permlane16_swap_b32 v118, v122
    v_mfma_f32_16x16x32_bf16 v[196:199], a[196:199], a[0:3], v[196:199]
    s_waitcnt lgkmcnt(5)
    v_permlane16_swap_b32 v119, v123
    v_mfma_f32_16x16x32_bf16 v[196:199], a[192:195], a[128:131], v[196:199]
    s_load_dwordx8 s[28:35], s[86:87], s93 glc
    ds_read_b64_tr_b16 a[192:193], v9 offset:28672
    v_add_f32 v117, v117, v121
    v_mfma_f32_16x16x32_bf16 v[192:195], a[200:203], a[16:19], v[192:195]
    s_or_b64 s[88:89], s[88:89], s[34:35]
    ds_read_b64_tr_b16 a[194:195], v9 offset:30720
    v_add_f32 v118, v118, v122
    v_mfma_f32_16x16x32_bf16 v[192:195], a[204:207], a[32:35], v[192:195]
    buffer_store_dwordx4 v[184:187], v14, s[24:27], s79 offen offset:1024 sc1
    v_add_f32 v119, v119, v123
    v_mfma_f32_16x16x32_bf16 v[200:203], a[204:207], a[36:39], v[200:203]
    s_or_b32 s66, s88, s89
    ds_read_b64_tr_b16 a[196:197], v9 offset:24576
    v_cvt_pk_bf16_f32 v117, 0, v117
    v_mfma_f32_16x16x32_bf16 v[200:203], a[200:203], a[20:23], v[200:203]
    s_andn2_b32 s69, s66, s80
    s_cselect_b32 s65, s59, 0x70000000
    v_cvt_pk_bf16_f32 v118, 0, v118
    v_mfma_f32_16x16x32_bf16 v[208:211], a[200:203], a[24:27], v[208:211]
    s_ff1_i32_b32 s69, s69
    ds_read_b64_tr_b16 a[198:199], v9 offset:26624
    v_cvt_pk_bf16_f32 v119, 0, v119
    v_mfma_f32_16x16x32_bf16 v[208:211], a[204:207], a[40:43], v[208:211]
    s_xor_b32 s73, s53, s69
    v_mul_f32 v117, v117, v54
    v_mul_f32 v118, v118, v54
    v_mfma_f32_16x16x32_bf16 v[216:219], a[204:207], a[44:47], v[216:219]
    s_waitcnt lgkmcnt(7)
    v_mul_f32 v119, v119, v54
    v_cvt_pk_bf16_f32 v116, 0, v116
    v_mfma_f32_16x16x32_bf16 v[216:219], a[200:203], a[28:31], v[216:219]
    s_mul_i32 s73, s73, 20480
    v_cvt_pk_bf16_f32 v117, 0, v117
    v_cvt_pk_bf16_f32 v118, 0, v118
    v_mfma_f32_16x16x32_bf16 v[220:223], a[208:211], a[28:31], v[220:223]
    s_add_u32 s73, s73, s65
    v_cvt_pk_bf16_f32 v119, 0, v119
    v_add_f32 v116, v116, v50
    v_mfma_f32_16x16x32_bf16 v[220:223], a[212:215], a[44:47], v[220:223]
    s_bitset1_b32 s80, s69
    v_add_f32 v117, v117, v51
    v_add_f32 v118, v118, v52
    v_mfma_f32_16x16x32_bf16 v[212:215], a[212:215], a[40:43], v[212:215]
    s_barrier
    v_mfma_f32_16x16x32_bf16 v[212:215], a[208:211], a[24:27], v[212:215]
    ds_read_b64_tr_b16 a[200:201], v8 offset:20480
    v_add_f32 v119, v119, v53
    v_mfma_f32_16x16x32_bf16 v[204:207], a[208:211], a[20:23], v[204:207]
    ds_read_b64_tr_b16 a[202:203], v8 offset:22528
    v_cvt_pk_bf16_f32 v116, 0, v116
    v_mfma_f32_16x16x32_bf16 v[204:207], a[212:215], a[36:39], v[204:207]
    s_waitcnt lgkmcnt(6)
    ds_read_b64_tr_b16 a[204:205], v8 offset:16384
    v_cvt_pk_bf16_f32 v117, 0, v117
    v_mfma_f32_16x16x32_bf16 v[196:199], a[212:215], a[32:35], v[196:199]
    buffer_load_dwordx4 v[130:133], v14, s[24:27], s73 offen sc1
    v_mfma_f32_16x16x32_bf16 v[196:199], a[208:211], a[16:19], v[196:199]
    ds_read_b64_tr_b16 a[206:207], v8 offset:18432
    v_cvt_pk_bf16_f32 v118, 0, v118
    v_mfma_f32_16x16x32_bf16 v[192:195], a[184:187], a[48:51], v[192:195]
    ds_read_b64_tr_b16 a[208:209], v9 offset:20480
    v_cvt_pk_bf16_f32 v119, 0, v119
    v_mfma_f32_16x16x32_bf16 v[192:195], a[188:191], a[64:67], v[192:195]
    buffer_load_dwordx4 v[134:137], v14, s[24:27], s73 offen offset:1024 sc1
    v_mfma_f32_16x16x32_bf16 v[200:203], a[188:191], a[68:71], v[200:203]
    ds_read_b64_tr_b16 a[210:211], v9 offset:22528
    v_mul_f32 v120, s92, v116
    v_mfma_f32_16x16x32_bf16 v[200:203], a[184:187], a[52:55], v[200:203]
    ds_read_b64_tr_b16 a[212:213], v9 offset:16384
    v_mul_f32 v121, s92, v117
    v_mfma_f32_16x16x32_bf16 v[208:211], a[184:187], a[56:59], v[208:211]
    s_waitcnt lgkmcnt(6)
    ds_read_b64_tr_b16 a[214:215], v9 offset:18432
    v_mul_f32 v122, s92, v118
    v_mfma_f32_16x16x32_bf16 v[208:211], a[188:191], a[72:75], v[208:211]
    buffer_load_dwordx2 v[128:129], v39, s[24:27], s73 offen offset:2048 sc1
    v_mfma_f32_16x16x32_bf16 v[216:219], a[188:191], a[76:79], v[216:219]
    v_exp_f32 v120, v120
    v_mfma_f32_16x16x32_bf16 v[216:219], a[184:187], a[60:63], v[216:219]
    ds_read_b64_tr_b16 a[184:185], v8 offset:12288
    v_mul_f32 v123, s92, v119
    v_mfma_f32_16x16x32_bf16 v[220:223], a[192:195], a[60:63], v[220:223]
    ds_read_b64_tr_b16 a[186:187], v8 offset:14336
    v_add_f32 v120, 1.0, v120
    v_mfma_f32_16x16x32_bf16 v[220:223], a[196:199], a[76:79], v[220:223]
    ds_read_b64_tr_b16 a[188:189], v8 offset:8192
    v_cmp_eq_u32 s[22:23], s40, v20
    v_mfma_f32_16x16x32_bf16 v[212:215], a[196:199], a[72:75], v[212:215]
    s_or_b64 s[10:11], s[10:11], s[22:23]
    ds_read_b64_tr_b16 a[190:191], v8 offset:10240
    v_lshrrev_b32 v21, 4, v1
    v_mfma_f32_16x16x32_bf16 v[212:215], a[192:195], a[56:59], v[212:215]
    s_waitcnt lgkmcnt(6)
    v_exp_f32 v121, v121
    v_mfma_f32_16x16x32_bf16 v[204:207], a[192:195], a[52:55], v[204:207]
    v_exp_f32 v122, v122
    v_mfma_f32_16x16x32_bf16 v[204:207], a[196:199], a[68:71], v[204:207]
    v_exp_f32 v123, v123
    v_mfma_f32_16x16x32_bf16 v[196:199], a[196:199], a[64:67], v[196:199]
    v_rcp_f32 v120, v120
    v_mfma_f32_16x16x32_bf16 v[196:199], a[192:195], a[48:51], v[196:199]
    s_or_b64 s[88:89], s[28:29], s[30:31]
    ds_read_b64_tr_b16 a[192:193], v9 offset:12288
    v_add_f32 v121, 1.0, v121
    v_mfma_f32_16x16x32_bf16 v[192:195], a[200:203], a[216:219], v[192:195]
    s_or_b64 s[88:89], s[88:89], s[32:33]
    ds_read_b64_tr_b16 a[194:195], v9 offset:14336
    v_add_f32 v122, 1.0, v122
    v_mfma_f32_16x16x32_bf16 v[192:195], a[204:207], a[232:235], v[192:195]
    s_or_b64 s[88:89], s[88:89], s[34:35]
    ds_read_b64_tr_b16 a[196:197], v9 offset:8192
    v_add_f32 v123, 1.0, v123
    v_mfma_f32_16x16x32_bf16 v[200:203], a[204:207], a[236:239], v[200:203]
    s_or_b32 s66, s88, s89
    ds_read_b64_tr_b16 a[198:199], v9 offset:10240
    v_mul_f32 v116, v116, v120
    v_mfma_f32_16x16x32_bf16 v[200:203], a[200:203], a[220:223], v[200:203]
    v_rcp_f32 v121, v121
    v_mfma_f32_16x16x32_bf16 v[208:211], a[200:203], a[224:227], v[208:211]
    v_rcp_f32 v122, v122
    v_mfma_f32_16x16x32_bf16 v[208:211], a[204:207], a[240:243], v[208:211]
    s_andn2_b32 s69, s66, s80
    s_cselect_b32 s65, s59, 0x70000000
    v_mul_f32 v117, v117, v121
    v_mfma_f32_16x16x32_bf16 v[216:219], a[204:207], a[244:247], v[216:219]
    s_waitcnt lgkmcnt(5)
    v_rcp_f32 v123, v123
    v_mfma_f32_16x16x32_bf16 v[216:219], a[200:203], a[228:231], v[216:219]
    s_ff1_i32_b32 s69, s69
    ds_read_b64_tr_b16 a[200:201], v8 offset:4096
    v_mul_f32 v118, v118, v122
    v_mfma_f32_16x16x32_bf16 v[220:223], a[208:211], a[228:231], v[220:223]
    s_xor_b32 s81, s53, s69
    ds_read_b64_tr_b16 a[202:203], v8 offset:6144
    v_mul_f32 v119, v119, v123
    v_mfma_f32_16x16x32_bf16 v[220:223], a[212:215], a[244:247], v[220:223]
    s_mul_i32 s81, s81, 20480
    ds_read_b64_tr_b16 a[204:205], v8 offset:0
    v_cvt_pk_bf16_f32 v116, v116, v117
    v_mfma_f32_16x16x32_bf16 v[212:215], a[212:215], a[240:243], v[212:215]
    s_add_u32 s81, s81, s65
    ds_read_b64_tr_b16 a[206:207], v8 offset:2048
    v_cvt_pk_bf16_f32 v117, v118, v119
    v_mfma_f32_16x16x32_bf16 v[212:215], a[208:211], a[224:227], v[212:215]
    ds_write_b64 v12, v[116:117]
    v_mfma_f32_16x16x32_bf16 v[204:207], a[208:211], a[220:223], v[204:207]
    s_bitset1_b32 s80, s69
    v_lshl_add_u32 v21, v21, 3, s56
    v_add_u32 v20, 256, v21
    v_mfma_f32_16x16x32_bf16 v[204:207], a[212:215], a[236:239], v[204:207]
    v_cndmask_b32 v22, v21, v20, s[20:21]
    v_cndmask_b32 v23, v21, v20, s[22:23]
    v_mfma_f32_16x16x32_bf16 v[196:199], a[212:215], a[232:235], v[196:199]
    s_mov_b64 exec, s[8:9]
    ds_read2_b64 v[40:43], v22 offset0:0 offset1:4
    s_mov_b64 exec, -1
    v_mfma_f32_16x16x32_bf16 v[196:199], a[208:211], a[216:219], v[196:199]
    s_mov_b64 exec, s[10:11]
    ds_read2_b64 v[44:47], v23 offset0:0 offset1:4
    s_mov_b64 exec, -1
    v_mfma_f32_16x16x32_bf16 v[192:195], a[184:187], a[152:155], v[192:195]
    s_waitcnt lgkmcnt(6)
    ds_read_b64_tr_b16 a[208:209], v9 offset:4096
    v_cmp_eq_u32 s[20:21], s39, v37
    v_mfma_f32_16x16x32_bf16 v[192:195], a[188:191], a[168:171], v[192:195]
    buffer_load_dwordx4 v[140:143], v14, s[24:27], s81 offen sc1
    v_mfma_f32_16x16x32_bf16 v[200:203], a[188:191], a[172:175], v[200:203]
    ds_read_b64_tr_b16 a[210:211], v9 offset:6144
    v_cmp_eq_u32 s[22:23], s40, v37
    v_mfma_f32_16x16x32_bf16 v[200:203], a[184:187], a[156:159], v[200:203]
    s_waitcnt vmcnt(4)
    ds_read_b64_tr_b16 a[212:213], v9 offset:0
    v_cndmask_b32 v13, v21, v20, s[22:23]
    v_mfma_f32_16x16x32_bf16 v[208:211], a[184:187], a[160:163], v[208:211]
    buffer_store_dword v16, v7, s[24:27], s77 offen offset:16 sc1
    v_mfma_f32_16x16x32_bf16 v[208:211], a[188:191], a[176:179], v[208:211]
    buffer_load_dwordx4 v[144:147], v14, s[24:27], s81 offen offset:1024 sc1
    v_mfma_f32_16x16x32_bf16 v[216:219], a[188:191], a[180:183], v[216:219]
    s_xor_b32 s77, s50, 0
    ds_read_b64_tr_b16 a[214:215], v9 offset:2048
    v_lshlrev_b32 v16, 0, v2
    v_mfma_f32_16x16x32_bf16 v[216:219], a[184:187], a[164:167], v[216:219]
    buffer_load_dwordx2 v[138:139], v39, s[24:27], s81 offen offset:2048 sc1
    v_mfma_f32_16x16x32_bf16 v[220:223], a[192:195], a[164:167], v[220:223]
    s_lshl_b32 s77, s77, 10
    ds_read_b64_tr_b16 a[184:185], v10 offset:45056
    v_and_b32 v20, 8, v39
    v_mfma_f32_16x16x32_bf16 v[220:223], a[196:199], a[180:183], v[220:223]
    s_waitcnt lgkmcnt(3)
    ds_read_b64_tr_b16 a[186:187], v10 offset:47104
    v_lshl_add_u32 v13, v20, 2, v13
    v_mfma_f32_16x16x32_bf16 v[212:215], a[196:199], a[176:179], v[212:215]
    s_add_u32 s77, s61, s77
    ds_read_b64_tr_b16 a[188:189], v10 offset:40960
    v_bfe_u32 v20, v1, 2, 2
    v_mfma_f32_16x16x32_bf16 v[212:215], a[192:195], a[160:163], v[212:215]
    s_or_b64 s[20:21], s[20:21], s[22:23]
    ds_read_b64_tr_b16 a[190:191], v10 offset:43008
    v_lshrrev_b32 v21, 4, v1
    v_mfma_f32_16x16x32_bf16 v[204:207], a[192:195], a[156:159], v[204:207]
    s_mov_b64 exec, s[20:21]
    ds_read_b64 v[48:49], v13 offset:64
    s_mov_b64 exec, -1
    v_mfma_f32_16x16x32_bf16 v[204:207], a[196:199], a[172:175], v[204:207]
    v_cmp_eq_u32 vcc, v20, v21
    v_and_b32 v20, 1, v1
    v_mfma_f32_16x16x32_bf16 v[196:199], a[196:199], a[168:171], v[196:199]
    v_lshlrev_b32 v20, 4, v20
    v_mov_b32 v21, 0x3f80
    v_mfma_f32_16x16x32_bf16 v[196:199], a[192:195], a[152:155], v[196:199]
    ds_read_b64_tr_b16 a[192:193], v11 offset:45056
    v_lshlrev_b32 v20, v20, v21
    v_mfma_f32_16x16x32_bf16 v[192:195], a[200:203], a[80:83], v[192:195]
    ds_read_b64_tr_b16 a[194:195], v11 offset:47104
    v_cndmask_b32 v20, 0, v20, vcc
    v_mfma_f32_16x16x32_bf16 v[192:195], a[204:207], a[96:99], v[192:195]
    ds_read_b64_tr_b16 a[196:197], v11 offset:40960
    v_and_b32 v21, 2, v1
    v_mfma_f32_16x16x32_bf16 v[200:203], a[204:207], a[100:103], v[200:203]
    ds_read_b64_tr_b16 a[198:199], v11 offset:43008
    v_cmp_eq_u32 vcc, 0, v21
    v_mfma_f32_16x16x32_bf16 v[200:203], a[200:203], a[84:87], v[200:203]
    s_waitcnt lgkmcnt(4)
    v_cndmask_b32 v184, 0, v20, vcc
    v_cvt_pk_bf16_f32 v192, v192, v193
    v_mfma_f32_16x16x32_bf16 v[208:211], a[200:203], a[88:91], v[208:211]
    v_cvt_pk_bf16_f32 v193, v194, v195
    v_sub_u32 v185, v20, v184
    v_mfma_f32_16x16x32_bf16 v[208:211], a[204:207], a[104:107], v[208:211]
    s_xor_b32 s78, s53, 3
    v_cvt_pk_bf16_f32 v200, v200, v201
    v_cvt_pk_bf16_f32 v201, v202, v203
    v_mfma_f32_16x16x32_bf16 v[216:219], a[204:207], a[108:111], v[216:219]
    s_mul_i32 s78, s78, 2560
    v_mov_b32 v186, v184
    v_mov_b32 v187, v185
    v_mfma_f32_16x16x32_bf16 v[216:219], a[200:203], a[92:95], v[216:219]
    s_add_u32 s78, s78, s60
    ds_read_b64_tr_b16 a[200:201], v10 offset:36864
    v_cvt_pk_bf16_f32 v208, v208, v209
    v_mfma_f32_16x16x32_bf16 v[220:223], a[208:211], a[92:95], v[220:223]
    s_xor_b32 s79, s53, 2
    ds_read_b64_tr_b16 a[202:203], v10 offset:38912
    v_cvt_pk_bf16_f32 v209, v210, v211
    v_mfma_f32_16x16x32_bf16 v[220:223], a[212:215], a[108:111], v[220:223]
    s_mul_i32 s79, s79, 2560
    ds_read_b64_tr_b16 a[204:205], v10 offset:32768
    v_cvt_pk_bf16_f32 v216, v216, v217
    v_mfma_f32_16x16x32_bf16 v[212:215], a[212:215], a[104:107], v[212:215]
    s_add_u32 s79, s79, s60
    ds_read_b64_tr_b16 a[206:207], v10 offset:34816
    v_cvt_pk_bf16_f32 v217, v218, v219
    v_mfma_f32_16x16x32_bf16 v[212:215], a[208:211], a[88:91], v[212:215]
    v_cvt_pk_bf16_f32 v218, v220, v221
    v_cvt_pk_bf16_f32 v219, v222, v223
    v_mfma_f32_16x16x32_bf16 v[204:207], a[208:211], a[84:87], v[204:207]
    v_mov_b32 v188, 0
    v_mov_b32 v189, 0
    v_mfma_f32_16x16x32_bf16 v[204:207], a[212:215], a[100:103], v[204:207]
    v_mov_b32 v190, v184
    v_mov_b32 v191, v185
    v_mfma_f32_16x16x32_bf16 v[196:199], a[212:215], a[96:99], v[196:199]
    v_cvt_pk_bf16_f32 v210, v212, v213
    v_cvt_pk_bf16_f32 v211, v214, v215
    v_mfma_f32_16x16x32_bf16 v[196:199], a[208:211], a[80:83], v[196:199]
    s_load_dwordx8 s[28:35], s[86:87], s93 glc
    ds_read_b64_tr_b16 a[208:209], v11 offset:36864
    v_cvt_pk_bf16_f32 v202, v204, v205
    v_mfma_f32_16x16x32_bf16 v[224:227], a[184:187], a[128:131], v[224:227]
    ds_read_b64_tr_b16 a[210:211], v11 offset:38912
    v_cvt_pk_bf16_f32 v203, v206, v207
    v_mfma_f32_16x16x32_bf16 v[224:227], a[188:191], a[0:3], v[224:227]
    s_waitcnt lgkmcnt(4)
    ds_read_b64_tr_b16 a[212:213], v11 offset:32768
    v_cvt_pk_bf16_f32 v194, v196, v197
    v_mfma_f32_16x16x32_bf16 v[232:235], a[188:191], a[4:7], v[232:235]
    ds_read_b64_tr_b16 a[214:215], v11 offset:34816
    v_cvt_pk_bf16_f32 v195, v198, v199
    v_mfma_f32_16x16x32_bf16 v[232:235], a[184:187], a[132:135], v[232:235]
    buffer_store_dwordx4 v[192:195], v14, s[24:27], s78 offen offset:1024 sc1
    v_lshlrev_b32 v196, 16, v26
    v_mfma_f32_16x16x32_bf16 v[236:239], a[192:195], a[132:135], v[236:239]
    ds_read_b64_tr_b16 a[184:185], v10 offset:28672
    v_lshlrev_b32 v192, 16, v24
    v_mfma_f32_16x16x32_bf16 v[236:239], a[196:199], a[4:7], v[236:239]
    ds_read_b64_tr_b16 a[186:187], v10 offset:30720
    v_and_b32 v193, 0xffff0000, v24
    v_mfma_f32_16x16x32_bf16 v[228:231], a[196:199], a[0:3], v[228:231]
    s_waitcnt lgkmcnt(6)
    ds_read_b64_tr_b16 a[188:189], v10 offset:24576
    v_lshlrev_b32 v194, 16, v25
    v_mfma_f32_16x16x32_bf16 v[228:231], a[192:195], a[128:131], v[228:231]
    buffer_store_dwordx4 v[200:203], v14, s[24:27], s78 offen offset:0 sc1
    v_and_b32 v195, 0xffff0000, v25
    v_mfma_f32_16x16x32_bf16 v[224:227], a[200:203], a[16:19], v[224:227]
    ds_read_b64_tr_b16 a[190:191], v10 offset:26624
    v_and_b32 v197, 0xffff0000, v26
    v_mfma_f32_16x16x32_bf16 v[224:227], a[204:207], a[32:35], v[224:227]
    s_waitcnt lgkmcnt(6)
    ds_read_b64_tr_b16 a[192:193], v11 offset:28672
    v_lshlrev_b32 v212, 16, v42
    v_mfma_f32_16x16x32_bf16 v[232:235], a[204:207], a[36:39], v[232:235]
    s_waitcnt lgkmcnt(5)
    ds_read_b64_tr_b16 a[194:195], v11 offset:30720
    v_and_b32 v213, 0xffff0000, v42
    v_mfma_f32_16x16x32_bf16 v[232:235], a[200:203], a[20:23], v[232:235]
    ds_read_b64_tr_b16 a[196:197], v11 offset:24576
    v_lshlrev_b32 v198, 16, v27
    v_mfma_f32_16x16x32_bf16 v[236:239], a[208:211], a[20:23], v[236:239]
    ds_read_b64_tr_b16 a[198:199], v11 offset:26624
    v_and_b32 v199, 0xffff0000, v27
    v_mfma_f32_16x16x32_bf16 v[236:239], a[212:215], a[36:39], v[236:239]
    s_waitcnt lgkmcnt(6)
    ds_read_b64_tr_b16 a[200:201], v10 offset:20480
    v_lshlrev_b32 v214, 16, v43
    v_mfma_f32_16x16x32_bf16 v[228:231], a[212:215], a[32:35], v[228:231]
pg_last:
    s_cbranch_execz pg_back2
    ds_read_b64_tr_b16 a[202:203], v10 offset:22528
    v_and_b32 v215, 0xffff0000, v43
    v_mfma_f32_16x16x32_bf16 v[228:231], a[208:211], a[16:19], v[228:231]
    buffer_store_dwordx4 v[208:211], v14, s[24:27], s79 offen offset:1024 sc1
    v_lshlrev_b32 v200, 16, v28
    v_mfma_f32_16x16x32_bf16 v[224:227], a[184:187], a[48:51], v[224:227]
    s_waitcnt lgkmcnt(6)
    ds_read_b64_tr_b16 a[204:205], v10 offset:16384
    v_lshlrev_b32 v208, 16, v40
    v_mfma_f32_16x16x32_bf16 v[224:227], a[188:191], a[64:67], v[224:227]
    s_waitcnt lgkmcnt(5)
    ds_read_b64_tr_b16 a[206:207], v10 offset:18432
    v_and_b32 v209, 0xffff0000, v40
    v_mfma_f32_16x16x32_bf16 v[232:235], a[188:191], a[68:71], v[232:235]
    ds_read_b64_tr_b16 a[208:209], v11 offset:20480
    v_lshlrev_b32 v210, 16, v41
    v_mfma_f32_16x16x32_bf16 v[232:235], a[184:187], a[52:55], v[232:235]
    s_waitcnt lgkmcnt(5)
    ds_read_b64_tr_b16 a[210:211], v11 offset:22528
    v_and_b32 v211, 0xffff0000, v41
    v_mfma_f32_16x16x32_bf16 v[236:239], a[192:195], a[52:55], v[236:239]
    ds_read_b64_tr_b16 a[212:213], v11 offset:16384
    v_and_b32 v201, 0xffff0000, v28
    v_mfma_f32_16x16x32_bf16 v[236:239], a[196:199], a[68:71], v[236:239]
    s_waitcnt lgkmcnt(5)
    ds_read_b64_tr_b16 a[214:215], v11 offset:18432
    v_lshlrev_b32 v202, 16, v29
    v_mfma_f32_16x16x32_bf16 v[228:231], a[196:199], a[64:67], v[228:231]
    ds_read_b64_tr_b16 a[184:185], v10 offset:12288
    v_and_b32 v203, 0xffff0000, v29
    v_mfma_f32_16x16x32_bf16 v[228:231], a[192:195], a[48:51], v[228:231]
    buffer_store_dwordx4 v[216:219], v14, s[24:27], s79 offen offset:0 sc1
    v_lshlrev_b32 v204, 16, v30
    v_mfma_f32_16x16x32_bf16 v[224:227], a[200:203], a[216:219], v[224:227]
    s_waitcnt lgkmcnt(5)
    ds_read_b64_tr_b16 a[186:187], v10 offset:14336
    v_lshlrev_b32 v216, 16, v44
    v_mfma_f32_16x16x32_bf16 v[224:227], a[204:207], a[232:235], v[224:227]
    ds_read_b64_tr_b16 a[188:189], v10 offset:8192
    v_and_b32 v217, 0xffff0000, v44
    v_mfma_f32_16x16x32_bf16 v[232:235], a[204:207], a[236:239], v[232:235]
    s_waitcnt lgkmcnt(5)
    ds_read_b64_tr_b16 a[190:191], v10 offset:10240
    v_lshlrev_b32 v218, 16, v45
    v_mfma_f32_16x16x32_bf16 v[232:235], a[200:203], a[220:223], v[232:235]
    ds_read_b64_tr_b16 a[192:193], v11 offset:12288
    v_and_b32 v219, 0xffff0000, v45
    v_mfma_f32_16x16x32_bf16 v[236:239], a[208:211], a[220:223], v[236:239]
    s_waitcnt lgkmcnt(5)
    ds_read_b64_tr_b16 a[194:195], v11 offset:14336
    v_and_b32 v205, 0xffff0000, v30
    v_mfma_f32_16x16x32_bf16 v[236:239], a[212:215], a[236:239], v[236:239]
    ds_read_b64_tr_b16 a[196:197], v11 offset:8192
    v_lshlrev_b32 v220, 16, v46
    v_mfma_f32_16x16x32_bf16 v[228:231], a[212:215], a[232:235], v[228:231]
    ds_read_b64_tr_b16 a[198:199], v11 offset:10240
    v_and_b32 v221, 0xffff0000, v46
    v_mfma_f32_16x16x32_bf16 v[228:231], a[208:211], a[216:219], v[228:231]
    s_waitcnt lgkmcnt(6)
    ds_read_b64_tr_b16 a[200:201], v10 offset:4096
    v_lshlrev_b32 v206, 16, v31
    v_mfma_f32_16x16x32_bf16 v[224:227], a[184:187], a[152:155], v[224:227]
    s_waitcnt lgkmcnt(5)
    ds_read_b64_tr_b16 a[202:203], v10 offset:6144
    v_and_b32 v207, 0xffff0000, v31
    v_mfma_f32_16x16x32_bf16 v[224:227], a[188:191], a[168:171], v[224:227]
    ds_read_b64_tr_b16 a[204:205], v10 offset:0
    v_lshlrev_b32 v222, 16, v47
    v_mfma_f32_16x16x32_bf16 v[232:235], a[188:191], a[172:175], v[232:235]
    ds_read_b64_tr_b16 a[206:207], v10 offset:2048
    v_and_b32 v223, 0xffff0000, v47
    v_mfma_f32_16x16x32_bf16 v[232:235], a[184:187], a[156:159], v[232:235]
    s_waitcnt lgkmcnt(6)
    ds_read_b64_tr_b16 a[208:209], v11 offset:4096
    v_lshlrev_b32 v50, 16, v32
    v_mfma_f32_16x16x32_bf16 v[236:239], a[192:195], a[156:159], v[236:239]
    s_waitcnt lgkmcnt(5)
    ds_read_b64_tr_b16 a[210:211], v11 offset:6144
    v_and_b32 v51, 0xffff0000, v32
    v_mfma_f32_16x16x32_bf16 v[236:239], a[196:199], a[172:175], v[236:239]
    s_xor_b32 s78, s53, 1
    ds_read_b64_tr_b16 a[212:213], v11 offset:0
    v_lshlrev_b32 v116, 16, v48
    v_mfma_f32_16x16x32_bf16 v[228:231], a[196:199], a[168:171], v[228:231]
    s_mul_i32 s78, s78, 2560
    ds_read_b64_tr_b16 a[214:215], v11 offset:2048
    v_and_b32 v117, 0xffff0000, v48
    v_mfma_f32_16x16x32_bf16 v[228:231], a[192:195], a[152:155], v[228:231]
    s_waitcnt lgkmcnt(6)
    ds_read_b64_tr_b16 a[184:185], v10 offset:45056
    v_lshlrev_b32 v52, 16, v33
    v_mfma_f32_16x16x32_bf16 v[224:227], a[200:203], a[80:83], v[224:227]
    s_waitcnt lgkmcnt(5)
    ds_read_b64_tr_b16 a[186:187], v10 offset:47104
    v_and_b32 v53, 0xffff0000, v33
    v_mfma_f32_16x16x32_bf16 v[224:227], a[204:207], a[96:99], v[224:227]
    s_add_u32 s78, s78, s60
    ds_read_b64_tr_b16 a[188:189], v10 offset:40960
    v_lshlrev_b32 v118, 16, v49
    v_mfma_f32_16x16x32_bf16 v[232:235], a[204:207], a[100:103], v[232:235]
    ds_read_b64_tr_b16 a[190:191], v10 offset:43008
    v_and_b32 v119, 0xffff0000, v49
    v_mfma_f32_16x16x32_bf16 v[232:235], a[200:203], a[84:87], v[232:235]
    s_waitcnt lgkmcnt(6)
    ds_read_b64_tr_b16 a[192:193], v11 offset:45056
    v_cvt_pk_bf16_f32 v224, v224, v225
    v_mfma_f32_16x16x32_bf16 v[236:239], a[208:211], a[84:87], v[236:239]
    s_waitcnt lgkmcnt(5)
    ds_read_b64_tr_b16 a[194:195], v11 offset:47104
    v_cvt_pk_bf16_f32 v225, v226, v227
    v_mfma_f32_16x16x32_bf16 v[236:239], a[212:215], a[100:103], v[236:239]
    ds_read_b64_tr_b16 a[196:197], v11 offset:40960
    v_cvt_pk_bf16_f32 v232, v232, v233
    v_mfma_f32_16x16x32_bf16 v[228:231], a[212:215], a[96:99], v[228:231]
    s_or_b64 s[88:89], s[28:29], s[30:31]
    ds_read_b64_tr_b16 a[198:199], v11 offset:43008
    v_cvt_pk_bf16_f32 v233, v234, v235
    v_mfma_f32_16x16x32_bf16 v[228:231], a[208:211], a[80:83], v[228:231]
    s_waitcnt lgkmcnt(6)
    ds_read_b64_tr_b16 a[200:201], v10 offset:36864
    v_cvt_pk_bf16_f32 v234, v236, v237
    v_mfma_f32_16x16x32_bf16 v[240:243], a[184:187], a[136:139], v[240:243]
    s_waitcnt lgkmcnt(5)
    ds_read_b64_tr_b16 a[202:203], v10 offset:38912
    v_cvt_pk_bf16_f32 v235, v238, v239
    v_mfma_f32_16x16x32_bf16 v[240:243], a[188:191], a[8:11], v[240:243]
    s_or_b64 s[88:89], s[88:89], s[32:33]
    ds_read_b64_tr_b16 a[204:205], v10 offset:32768
    v_cvt_pk_bf16_f32 v226, v228, v229
    v_mfma_f32_16x16x32_bf16 v[248:251], a[188:191], a[12:15], v[248:251]
    s_or_b64 s[88:89], s[88:89], s[34:35]
    ds_read_b64_tr_b16 a[206:207], v10 offset:34816
    v_cvt_pk_bf16_f32 v227, v230, v231
    v_mfma_f32_16x16x32_bf16 v[248:251], a[184:187], a[140:143], v[248:251]
    s_waitcnt lgkmcnt(6)
    buffer_store_dwordx4 v[224:227], v14, s[24:27], s78 offen offset:0 sc1
    v_mfma_f32_16x16x32_bf16 v[252:255], a[192:195], a[140:143], v[252:255]
    s_waitcnt lgkmcnt(4)
    buffer_store_dwordx4 v[232:235], v14, s[24:27], s78 offen offset:1024 sc1
    v_mfma_f32_16x16x32_bf16 v[252:255], a[196:199], a[12:15], v[252:255]
    s_or_b32 s66, s88, s89
    ds_read_b64_tr_b16 a[208:209], v11 offset:36864
    ds_read_b64_tr_b16 a[210:211], v11 offset:38912
    ds_read_b64_tr_b16 a[212:213], v11 offset:32768
    v_mfma_f32_16x16x32_bf16 v[244:247], a[196:199], a[8:11], v[244:247]
    s_andn2_b32 s69, s66, s80
    s_cselect_b32 s65, s59, 0x70000000
    s_ff1_i32_b32 s69, s69
    ds_read_b64_tr_b16 a[214:215], v11 offset:34816
    v_mfma_f32_16x16x32_bf16 v[244:247], a[192:195], a[136:139], v[244:247]
    s_waitcnt lgkmcnt(6)
    ds_read_b64_tr_b16 a[184:185], v10 offset:28672
    s_xor_b32 s72, s53, s69
    v_mfma_f32_16x16x32_bf16 v[240:243], a[200:203], a[24:27], v[240:243]
    s_waitcnt lgkmcnt(5)
    ds_read_b64_tr_b16 a[186:187], v10 offset:30720
    s_mul_i32 s72, s72, 20480
    v_mfma_f32_16x16x32_bf16 v[240:243], a[204:207], a[40:43], v[240:243]
    s_add_u32 s72, s72, s65
    ds_read_b64_tr_b16 a[188:189], v10 offset:24576
    s_bitset1_b32 s80, s69
    v_mfma_f32_16x16x32_bf16 v[248:251], a[204:207], a[44:47], v[248:251]
    ds_read_b64_tr_b16 a[190:191], v10 offset:26624
    v_mfma_f32_16x16x32_bf16 v[248:251], a[200:203], a[28:31], v[248:251]
    s_waitcnt lgkmcnt(6)
    ds_read_b64_tr_b16 a[192:193], v11 offset:28672
    v_mfma_f32_16x16x32_bf16 v[252:255], a[208:211], a[28:31], v[252:255]
    s_waitcnt lgkmcnt(5)
    ds_read_b64_tr_b16 a[194:195], v11 offset:30720
    v_mfma_f32_16x16x32_bf16 v[252:255], a[212:215], a[44:47], v[252:255]
    ds_read_b64_tr_b16 a[196:197], v11 offset:24576
    v_mfma_f32_16x16x32_bf16 v[244:247], a[212:215], a[40:43], v[244:247]
    ds_read_b64_tr_b16 a[198:199], v11 offset:26624
    v_mfma_f32_16x16x32_bf16 v[244:247], a[208:211], a[24:27], v[244:247]
    s_waitcnt lgkmcnt(6)
    ds_read_b64_tr_b16 a[200:201], v10 offset:20480
    v_mfma_f32_16x16x32_bf16 v[240:243], a[184:187], a[56:59], v[240:243]
    s_waitcnt lgkmcnt(5)
    ds_read_b64_tr_b16 a[202:203], v10 offset:22528
    v_mfma_f32_16x16x32_bf16 v[240:243], a[188:191], a[72:75], v[240:243]
    ds_read_b64_tr_b16 a[204:205], v10 offset:16384
    v_mfma_f32_16x16x32_bf16 v[248:251], a[188:191], a[76:79], v[248:251]
    ds_read_b64_tr_b16 a[206:207], v10 offset:18432
    v_mfma_f32_16x16x32_bf16 v[248:251], a[184:187], a[60:63], v[248:251]
    s_waitcnt lgkmcnt(6)
    ds_read_b64_tr_b16 a[208:209], v11 offset:20480
    v_mfma_f32_16x16x32_bf16 v[252:255], a[192:195], a[60:63], v[252:255]
    s_waitcnt lgkmcnt(5)
    ds_read_b64_tr_b16 a[210:211], v11 offset:22528
    v_mfma_f32_16x16x32_bf16 v[252:255], a[196:199], a[76:79], v[252:255]
    ds_read_b64_tr_b16 a[212:213], v11 offset:16384
    v_mfma_f32_16x16x32_bf16 v[244:247], a[196:199], a[72:75], v[244:247]
    buffer_load_dwordx4 v[58:61], v14, s[24:27], s72 offen sc1
    ds_read_b64_tr_b16 a[214:215], v11 offset:18432
    v_mfma_f32_16x16x32_bf16 v[244:247], a[192:195], a[56:59], v[244:247]
    s_waitcnt lgkmcnt(6)
    ds_read_b64_tr_b16 a[184:185], v10 offset:12288
    v_mfma_f32_16x16x32_bf16 v[240:243], a[200:203], a[224:227], v[240:243]
    s_waitcnt lgkmcnt(5)
    ds_read_b64_tr_b16 a[186:187], v10 offset:14336
    v_mfma_f32_16x16x32_bf16 v[240:243], a[204:207], a[240:243], v[240:243]
    buffer_load_dwordx4 v[62:65], v14, s[24:27], s72 offen offset:1024 sc1
    ds_read_b64_tr_b16 a[188:189], v10 offset:8192
    v_mfma_f32_16x16x32_bf16 v[248:251], a[204:207], a[244:247], v[248:251]
    s_waitcnt vmcnt(4)
    ds_read_b64_tr_b16 a[190:191], v10 offset:10240
    v_mfma_f32_16x16x32_bf16 v[248:251], a[200:203], a[228:231], v[248:251]
    s_waitcnt lgkmcnt(6)
    buffer_store_dword v17, v7, s[24:27], s67 offen offset:8 sc1
    v_mfma_f32_16x16x32_bf16 v[252:255], a[208:211], a[228:231], v[252:255]
    s_waitcnt lgkmcnt(4)
    buffer_load_dwordx2 v[56:57], v39, s[24:27], s72 offen offset:2048 sc1
    ds_read_b64_tr_b16 a[192:193], v11 offset:12288
    v_mfma_f32_16x16x32_bf16 v[252:255], a[212:215], a[244:247], v[252:255]
    ds_read_b64_tr_b16 a[194:195], v11 offset:14336
    ds_read_b64_tr_b16 a[196:197], v11 offset:8192
    v_mfma_f32_16x16x32_bf16 v[244:247], a[212:215], a[240:243], v[244:247]
    ds_read_b64_tr_b16 a[198:199], v11 offset:10240
    v_mfma_f32_16x16x32_bf16 v[244:247], a[208:211], a[224:227], v[244:247]
    s_waitcnt lgkmcnt(6)
    ds_read_b64_tr_b16 a[200:201], v10 offset:4096
    v_mfma_f32_16x16x32_bf16 v[240:243], a[184:187], a[160:163], v[240:243]
    s_waitcnt lgkmcnt(5)
    ds_read_b64_tr_b16 a[202:203], v10 offset:6144
    v_mfma_f32_16x16x32_bf16 v[240:243], a[188:191], a[176:179], v[240:243]
    ds_read_b64_tr_b16 a[204:205], v10 offset:0
    v_mfma_f32_16x16x32_bf16 v[248:251], a[188:191], a[180:183], v[248:251]
    ds_read_b64_tr_b16 a[206:207], v10 offset:2048
    v_mfma_f32_16x16x32_bf16 v[248:251], a[184:187], a[164:167], v[248:251]
    s_waitcnt lgkmcnt(6)
    ds_read_b64_tr_b16 a[208:209], v11 offset:4096
    v_mfma_f32_16x16x32_bf16 v[252:255], a[192:195], a[164:167], v[252:255]
    s_waitcnt lgkmcnt(5)
    ds_read_b64_tr_b16 a[210:211], v11 offset:6144
    v_mfma_f32_16x16x32_bf16 v[252:255], a[196:199], a[180:183], v[252:255]
    ds_read_b64_tr_b16 a[212:213], v11 offset:0
    v_mfma_f32_16x16x32_bf16 v[244:247], a[196:199], a[176:179], v[244:247]
    ds_read_b64_tr_b16 a[214:215], v11 offset:2048
    v_mfma_f32_16x16x32_bf16 v[244:247], a[192:195], a[160:163], v[244:247]
    s_waitcnt lgkmcnt(6)
    v_mfma_f32_16x16x32_bf16 v[240:243], a[200:203], a[88:91], v[240:243]
    s_waitcnt lgkmcnt(4)
    v_mfma_f32_16x16x32_bf16 v[240:243], a[204:207], a[104:107], v[240:243]
    v_mfma_f32_16x16x32_bf16 v[248:251], a[204:207], a[108:111], v[248:251]
    v_mfma_f32_16x16x32_bf16 v[248:251], a[200:203], a[92:95], v[248:251]
    s_waitcnt lgkmcnt(2)
    v_mfma_f32_16x16x32_bf16 v[252:255], a[208:211], a[92:95], v[252:255]
    s_waitcnt lgkmcnt(0)
    v_mfma_f32_16x16x32_bf16 v[252:255], a[212:215], a[108:111], v[252:255]
    s_waitcnt vmcnt(4)
    s_load_dwordx8 s[28:35], s[86:87], s93 glc
    v_mfma_f32_16x16x32_bf16 v[244:247], a[212:215], a[104:107], v[244:247]
    buffer_store_dword v16, v7, s[24:27], s77 offen offset:0 sc1
    v_mfma_f32_16x16x32_bf16 v[244:247], a[208:211], a[88:91], v[244:247]
    v_mfma_f32_16x16x32_bf16 v[124:127], v[186:189], v[96:99], v[124:127]
    v_mfma_f32_16x16x32_bf16 v[240:243], v[186:189], v[98:101], v[240:243]
    v_mfma_f32_16x16x32_bf16 v[244:247], v[188:191], v[98:101], v[244:247]
    v_mfma_f32_16x16x32_bf16 v[252:255], v[188:191], v[102:105], v[252:255]
    v_mfma_f32_16x16x32_bf16 v[248:251], v[186:189], v[102:105], v[248:251]
    v_mfma_f32_16x16x32_bf16 v[124:127], v[186:189], v[106:109], v[124:127]
    v_mfma_f32_16x16x32_bf16 v[240:243], v[186:189], v[108:111], v[240:243]
    v_mfma_f32_16x16x32_bf16 v[244:247], v[188:191], v[108:111], v[244:247]
    v_mfma_f32_16x16x32_bf16 v[252:255], v[188:191], v[112:115], v[252:255]
    v_mfma_f32_16x16x32_bf16 v[248:251], v[186:189], v[112:115], v[248:251]
    v_mfma_f32_16x16x32_bf16 v[124:127], v[186:189], v[128:131], v[124:127]
    v_mfma_f32_16x16x32_bf16 v[240:243], v[186:189], v[130:133], v[240:243]
    v_mfma_f32_16x16x32_bf16 v[244:247], v[188:191], v[130:133], v[244:247]
    v_mfma_f32_16x16x32_bf16 v[252:255], v[188:191], v[134:137], v[252:255]
    v_mfma_f32_16x16x32_bf16 v[248:251], v[186:189], v[134:137], v[248:251]
    v_mfma_f32_16x16x32_bf16 v[124:127], v[186:189], v[138:141], v[124:127]
    v_mfma_f32_16x16x32_bf16 v[240:243], v[186:189], v[140:143], v[240:243]
    v_mfma_f32_16x16x32_bf16 v[244:247], v[188:191], v[140:143], v[244:247]
    v_mfma_f32_16x16x32_bf16 v[252:255], v[188:191], v[144:147], v[252:255]
    v_mfma_f32_16x16x32_bf16 v[248:251], v[186:189], v[144:147], v[248:251]
post_code:
    s_cmp_eq_u32 s80, -1
    s_cbranch_scc1 ev_st
    s_or_b64 s[88:89], s[28:29], s[30:31]
    s_or_b64 s[88:89], s[88:89], s[32:33]
    s_or_b64 s[88:89], s[88:89], s[34:35]
    s_or_b32 s66, s88, s89
    s_andn2_b32 s69, s66, s80
    s_cbranch_scc1 ev_i1
    s_branch ev_w1
ev_st:
    s_waitcnt vmcnt(1)
    v_mfma_f32_16x16x32_bf16 v[124:127], v[186:189], v[56:59], v[124:127]
    v_mfma_f32_16x16x32_bf16 v[240:243], v[186:189], v[58:61], v[240:243]
    v_mfma_f32_16x16x32_bf16 v[244:247], v[188:191], v[58:61], v[244:247]
    v_mfma_f32_16x16x32_bf16 v[252:255], v[188:191], v[62:65], v[252:255]
    v_mfma_f32_16x16x32_bf16 v[248:251], v[186:189], v[62:65], v[248:251]
    s_branch ev_sum
ev_w0:
    s_waitcnt lgkmcnt(0)
    s_load_dwordx8 s[28:35], s[86:87], s93 glc
    s_add_u32 s101, s101, 1
    s_cmp_gt_u32 s101, 0x2000000
    s_cbranch_scc1 ev_done
    s_or_b64 s[88:89], s[28:29], s[30:31]
    s_or_b64 s[88:89], s[88:89], s[32:33]
    s_or_b64 s[88:89], s[88:89], s[34:35]
    s_or_b32 s66, s88, s89
    s_andn2_b32 s69, s66, s80
    s_cbranch_scc0 ev_w0
ev_i0:
    s_ff1_i32_b32 s69, s69
    s_xor_b32 s81, s53, s69
    s_mul_i32 s81, s81, 20480
    s_add_u32 s81, s81, s59
    s_bitset1_b32 s80, s69
    s_cmp_eq_u32 s80, -1
    s_cbranch_scc0 ev_n0
    buffer_load_dwordx4 a[122:125], v14, s[24:27], s81 offen sc1
    buffer_load_dwordx4 a[126:129], v14, s[24:27], s81 offen offset:1024 sc1
    buffer_load_dwordx2 a[120:121], v39, s[24:27], s81 offen offset:2048 sc1
    s_branch ev_z
ev_n0:
    buffer_load_dwordx4 v[58:61], v14, s[24:27], s81 offen sc1
    buffer_load_dwordx4 v[62:65], v14, s[24:27], s81 offen offset:1024 sc1
    buffer_load_dwordx2 v[56:57], v39, s[24:27], s81 offen offset:2048 sc1
    s_andn2_b32 s69, s66, s80
    s_cbranch_scc0 ev_w1
ev_i1:
    s_ff1_i32_b32 s69, s69
    s_xor_b32 s81, s53, s69
    s_mul_i32 s81, s81, 20480
    s_add_u32 s81, s81, s59
    s_bitset1_b32 s80, s69
    s_cmp_eq_u32 s80, -1
    s_cbranch_scc1 ev_l1
    buffer_load_dwordx4 a[2:5], v14, s[24:27], s81 offen sc1
    buffer_load_dwordx4 a[6:9], v14, s[24:27], s81 offen offset:1024 sc1
    buffer_load_dwordx2 a[0:1], v39, s[24:27], s81 offen offset:2048 sc1
    s_andn2_b32 s69, s66, s80
    s_cbranch_scc0 ev_w2
ev_i2:
    s_ff1_i32_b32 s69, s69
    s_xor_b32 s81, s53, s69
    s_mul_i32 s81, s81, 20480
    s_add_u32 s81, s81, s59
    s_bitset1_b32 s80, s69
    s_cmp_eq_u32 s80, -1
    s_cbranch_scc1 ev_l2
    buffer_load_dwordx4 a[12:15], v14, s[24:27], s81 offen sc1
    buffer_load_dwordx4 a[16:19], v14, s[24:27], s81 offen offset:1024 sc1
    buffer_load_dwordx2 a[10:11], v39, s[24:27], s81 offen offset:2048 sc1
    s_andn2_b32 s69, s66, s80
    s_cbranch_scc0 ev_w3
ev_i3:
    s_ff1_i32_b32 s69, s69
    s_xor_b32 s81, s53, s69
    s_mul_i32 s81, s81, 20480
    s_add_u32 s81, s81, s59
    s_bitset1_b32 s80, s69
    s_cmp_eq_u32 s80, -1
    s_cbranch_scc1 ev_l3
    buffer_load_dwordx4 a[22:25], v14, s[24:27], s81 offen sc1
    buffer_load_dwordx4 a[26:29], v14, s[24:27], s81 offen offset:1024 sc1
    buffer_load_dwordx2 a[20:21], v39, s[24:27], s81 offen offset:2048 sc1
    s_andn2_b32 s69, s66, s80
    s_cbranch_scc0 ev_w4
ev_i4:
    s_ff1_i32_b32 s69, s69
    s_xor_b32 s81, s53, s69
    s_mul_i32 s81, s81, 20480
    s_add_u32 s81, s81, s59
    s_bitset1_b32 s80, s69
    s_cmp_eq_u32 s80, -1
    s_cbranch_scc1 ev_l4
    buffer_load_dwordx4 a[32:35], v14, s[24:27], s81 offen sc1
    buffer_load_dwordx4 a[36:39], v14, s[24:27], s81 offen offset:1024 sc1
    buffer_load_dwordx2 a[30:31], v39, s[24:27], s81 offen offset:2048 sc1
    s_waitcnt vmcnt(0)
ev_c5:
    v_mfma_f32_16x16x32_bf16 v[124:127], v[186:189], a[30:33], v[124:127]
    v_mfma_f32_16x16x32_bf16 v[240:243], v[186:189], a[32:35], v[240:243]
    v_mfma_f32_16x16x32_bf16 v[244:247], v[188:191], a[32:35], v[244:247]
    v_mfma_f32_16x16x32_bf16 v[252:255], v[188:191], a[36:39], v[252:255]
    v_mfma_f32_16x16x32_bf16 v[248:251], v[186:189], a[36:39], v[248:251]
ev_c4:
    v_mfma_f32_16x16x32_bf16 v[124:127], v[186:189], a[20:23], v[124:127]
    v_mfma_f32_16x16x32_bf16 v[240:243], v[186:189], a[22:25], v[240:243]
    v_mfma_f32_16x16x32_bf16 v[244:247], v[188:191], a[22:25], v[244:247]
    v_mfma_f32_16x16x32_bf16 v[252:255], v[188:191], a[26:29], v[252:255]
    v_mfma_f32_16x16x32_bf16 v[248:251], v[186:189], a[26:29], v[248:251]
ev_c3:
    v_mfma_f32_16x16x32_bf16 v[124:127], v[186:189], a[10:13], v[124:127]
    v_mfma_f32_16x16x32_bf16 v[240:243], v[186:189], a[12:15], v[240:243]
    v_mfma_f32_16x16x32_bf16 v[244:247], v[188:191], a[12:15], v[244:247]
    v_mfma_f32_16x16x32_bf16 v[252:255], v[188:191], a[16:19], v[252:255]
    v_mfma_f32_16x16x32_bf16 v[248:251], v[186:189], a[16:19], v[248:251]
ev_c2:
    v_mfma_f32_16x16x32_bf16 v[124:127], v[186:189], a[0:3], v[124:127]
    v_mfma_f32_16x16x32_bf16 v[240:243], v[186:189], a[2:5], v[240:243]
    v_mfma_f32_16x16x32_bf16 v[244:247], v[188:191], a[2:5], v[244:247]
    v_mfma_f32_16x16x32_bf16 v[252:255], v[188:191], a[6:9], v[252:255]
    v_mfma_f32_16x16x32_bf16 v[248:251], v[186:189], a[6:9], v[248:251]
ev_c1:
    v_mfma_f32_16x16x32_bf16 v[124:127], v[186:189], v[56:59], v[124:127]
    v_mfma_f32_16x16x32_bf16 v[240:243], v[186:189], v[58:61], v[240:243]
    v_mfma_f32_16x16x32_bf16 v[244:247], v[188:191], v[58:61], v[244:247]
    v_mfma_f32_16x16x32_bf16 v[252:255], v[188:191], v[62:65], v[252:255]
    v_mfma_f32_16x16x32_bf16 v[248:251], v[186:189], v[62:65], v[248:251]
    s_cmp_lg_u32 s80, -1
    s_cbranch_scc1 ev_w0
ev_z:
    s_waitcnt vmcnt(0)
    v_mfma_f32_16x16x32_bf16 v[124:127], v[186:189], a[120:123], v[124:127]
    v_mfma_f32_16x16x32_bf16 v[240:243], v[186:189], a[122:125], v[240:243]
    v_mfma_f32_16x16x32_bf16 v[244:247], v[188:191], a[122:125], v[244:247]
    v_mfma_f32_16x16x32_bf16 v[252:255], v[188:191], a[126:129], v[252:255]
    v_mfma_f32_16x16x32_bf16 v[248:251], v[186:189], a[126:129], v[248:251]
ev_sum:
    s_nop 4
    v_pk_fma_f32 v[124:125], v[124:125], v[116:117], v[50:51]
    v_pk_fma_f32 v[126:127], v[126:127], v[118:119], v[52:53]
    v_cvt_pk_bf16_f32 v124, v124, v125
    v_cvt_pk_bf16_f32 v125, v126, v127
    buffer_store_dwordx2 v[124:125], v35, s[16:19], s68 offen sc1
    v_pk_fma_f32 v[240:241], v[240:241], v[208:209], v[192:193]
    v_pk_fma_f32 v[242:243], v[242:243], v[210:211], v[194:195]
    v_pk_fma_f32 v[244:245], v[244:245], v[212:213], v[196:197]
    v_pk_fma_f32 v[246:247], v[246:247], v[214:215], v[198:199]
    v_cvt_pk_bf16_f32 v240, v240, v241
    v_cvt_pk_bf16_f32 v241, v242, v243
    v_cvt_pk_bf16_f32 v242, v244, v245
    v_cvt_pk_bf16_f32 v243, v246, v247
    s_nop 1
    v_permlane16_swap_b32 v240, v242
    v_permlane16_swap_b32 v241, v243
    buffer_store_dwordx4 v[240:243], v4, s[16:19], s64 offen sc1
    v_pk_fma_f32 v[248:249], v[248:249], v[216:217], v[200:201]
    v_pk_fma_f32 v[250:251], v[250:251], v[218:219], v[202:203]
    v_pk_fma_f32 v[252:253], v[252:253], v[220:221], v[204:205]
    v_pk_fma_f32 v[254:255], v[254:255], v[222:223], v[206:207]
    v_cvt_pk_bf16_f32 v248, v248, v249
    v_cvt_pk_bf16_f32 v249, v250, v251
    v_cvt_pk_bf16_f32 v250, v252, v253
    v_cvt_pk_bf16_f32 v251, v254, v255
    s_nop 1
    v_permlane16_swap_b32 v248, v250
    v_permlane16_swap_b32 v249, v251
    buffer_store_dwordx4 v[248:251], v34, s[16:19], s64 offen sc1
ev_done:
    s_or_b32 s56, s2, s3
    s_cmp_eq_u32 s56, 0
    s_cselect_b32 s56, 0, 0x7ffffff0
    s_add_u32 s56, s56, 3203072
    buffer_store_dword v6, v15, s[24:27], s56 offen
main_fin:
main_end:
    s_endpgm
ev_w1:
    s_getreg_b32 s56, hwreg(HW_REG_IB_STS, 0, 4)
    s_cmp_eq_u32 s56, 0
    s_cbranch_scc1 ev_d1
    s_waitcnt lgkmcnt(0)
    s_load_dwordx8 s[28:35], s[86:87], s93 glc
    s_add_u32 s101, s101, 1
    s_cmp_gt_u32 s101, 0x2000000
    s_cbranch_scc1 ev_done
    s_or_b64 s[88:89], s[28:29], s[30:31]
    s_or_b64 s[88:89], s[88:89], s[32:33]
    s_or_b64 s[88:89], s[88:89], s[34:35]
    s_or_b32 s66, s88, s89
    s_andn2_b32 s69, s66, s80
    s_cbranch_scc0 ev_w1
    s_branch ev_i1
ev_d1:
    s_waitcnt vmcnt(0)
    s_branch ev_c1
ev_l1:
    buffer_load_dwordx4 a[122:125], v14, s[24:27], s81 offen sc1
    buffer_load_dwordx4 a[126:129], v14, s[24:27], s81 offen offset:1024 sc1
    buffer_load_dwordx2 a[120:121], v39, s[24:27], s81 offen offset:2048 sc1
    s_waitcnt vmcnt(3)
    s_branch ev_c1
ev_w2:
    s_getreg_b32 s56, hwreg(HW_REG_IB_STS, 0, 4)
    s_cmp_eq_u32 s56, 0
    s_cbranch_scc1 ev_d2
    s_waitcnt lgkmcnt(0)
    s_load_dwordx8 s[28:35], s[86:87], s93 glc
    s_add_u32 s101, s101, 1
    s_cmp_gt_u32 s101, 0x2000000
    s_cbranch_scc1 ev_done
    s_or_b64 s[88:89], s[28:29], s[30:31]
    s_or_b64 s[88:89], s[88:89], s[32:33]
    s_or_b64 s[88:89], s[88:89], s[34:35]
    s_or_b32 s66, s88, s89
    s_andn2_b32 s69, s66, s80
    s_cbranch_scc0 ev_w2
    s_branch ev_i2
ev_d2:
    s_waitcnt vmcnt(0)
    s_branch ev_c2
ev_l2:
    buffer_load_dwordx4 a[122:125], v14, s[24:27], s81 offen sc1
    buffer_load_dwordx4 a[126:129], v14, s[24:27], s81 offen offset:1024 sc1
    buffer_load_dwordx2 a[120:121], v39, s[24:27], s81 offen offset:2048 sc1
    s_waitcnt vmcnt(3)
    s_branch ev_c2
ev_w3:
    s_getreg_b32 s56, hwreg(HW_REG_IB_STS, 0, 4)
    s_cmp_eq_u32 s56, 0
    s_cbranch_scc1 ev_d3
    s_waitcnt lgkmcnt(0)
    s_load_dwordx8 s[28:35], s[86:87], s93 glc
    s_add_u32 s101, s101, 1
    s_cmp_gt_u32 s101, 0x2000000
    s_cbranch_scc1 ev_done
    s_or_b64 s[88:89], s[28:29], s[30:31]
    s_or_b64 s[88:89], s[88:89], s[32:33]
    s_or_b64 s[88:89], s[88:89], s[34:35]
    s_or_b32 s66, s88, s89
    s_andn2_b32 s69, s66, s80
    s_cbranch_scc0 ev_w3
    s_branch ev_i3
ev_d3:
    s_waitcnt vmcnt(0)
    s_branch ev_c3
ev_l3:
    buffer_load_dwordx4 a[122:125], v14, s[24:27], s81 offen sc1
    buffer_load_dwordx4 a[126:129], v14, s[24:27], s81 offen offset:1024 sc1
    buffer_load_dwordx2 a[120:121], v39, s[24:27], s81 offen offset:2048 sc1
    s_waitcnt vmcnt(3)
    s_branch ev_c3
ev_w4:
    s_getreg_b32 s56, hwreg(HW_REG_IB_STS, 0, 4)
    s_cmp_eq_u32 s56, 0
    s_cbranch_scc1 ev_d4
    s_waitcnt lgkmcnt(0)
    s_load_dwordx8 s[28:35], s[86:87], s93 glc
    s_add_u32 s101, s101, 1
    s_cmp_gt_u32 s101, 0x2000000
    s_cbranch_scc1 ev_done
    s_or_b64 s[88:89], s[28:29], s[30:31]
    s_or_b64 s[88:89], s[88:89], s[32:33]
    s_or_b64 s[88:89], s[88:89], s[34:35]
    s_or_b32 s66, s88, s89
    s_andn2_b32 s69, s66, s80
    s_cbranch_scc0 ev_w4
    s_branch ev_i4
ev_d4:
    s_waitcnt vmcnt(0)
    s_branch ev_c4
ev_l4:
    buffer_load_dwordx4 a[122:125], v14, s[24:27], s81 offen sc1
    buffer_load_dwordx4 a[126:129], v14, s[24:27], s81 offen offset:1024 sc1
    buffer_load_dwordx2 a[120:121], v39, s[24:27], s81 offen offset:2048 sc1
    s_waitcnt vmcnt(3)
    s_branch ev_c4
spin_o0:
    s_load_dwordx4 s[72:75], s[86:87], s5 glc
    s_add_u32 s101, s101, 1
    s_cmp_gt_u32 s101, 0x2000000
    s_waitcnt lgkmcnt(0)
    s_cbranch_scc1 spin_o0_ret
    s_sub_u32 s78, s72, s77
    s_sub_u32 s79, s73, s77
    s_max_u32 s78, s78, s79
    s_sub_u32 s79, s74, s77
    s_max_u32 s78, s78, s79
    s_sub_u32 s79, s75, s77
    s_max_u32 s78, s78, s79
    s_cmp_gt_u32 s78, 5
    s_cbranch_scc1 spin_o0
    s_branch spin_o0_ret
spin_o1:
    s_load_dwordx4 s[72:75], s[86:87], s5 glc
    s_add_u32 s101, s101, 1
    s_cmp_gt_u32 s101, 0x2000000
    s_waitcnt lgkmcnt(0)
    s_cbranch_scc1 spin_o1_ret
    s_sub_u32 s78, s72, s77
    s_sub_u32 s79, s73, s77
    s_max_u32 s78, s78, s79
    s_sub_u32 s79, s74, s77
    s_max_u32 s78, s78, s79
    s_sub_u32 s79, s75, s77
    s_max_u32 s78, s78, s79
    s_cmp_gt_u32 s78, 4
    s_cbranch_scc1 spin_o1
    s_branch spin_o1_ret
spin_o2:
    s_load_dwordx4 s[72:75], s[86:87], s5 glc
    s_add_u32 s101, s101, 1
    s_cmp_gt_u32 s101, 0x2000000
    s_waitcnt lgkmcnt(0)
    s_cbranch_scc1 spin_o2_ret
    s_sub_u32 s78, s72, s77
    s_sub_u32 s79, s73, s77
    s_max_u32 s78, s78, s79
    s_sub_u32 s79, s74, s77
    s_max_u32 s78, s78, s79
    s_sub_u32 s79, s75, s77
    s_max_u32 s78, s78, s79
    s_cmp_gt_u32 s78, 3
    s_cbranch_scc1 spin_o2
    s_branch spin_o2_ret
spin_o3:
    s_load_dwordx4 s[72:75], s[86:87], s5 glc
    s_add_u32 s101, s101, 1
    s_cmp_gt_u32 s101, 0x2000000
    s_waitcnt lgkmcnt(0)
    s_cbranch_scc1 spin_o3_ret
    s_sub_u32 s78, s72, s77
    s_sub_u32 s79, s73, s77
    s_max_u32 s78, s78, s79
    s_sub_u32 s79, s74, s77
    s_max_u32 s78, s78, s79
    s_sub_u32 s79, s75, s77
    s_max_u32 s78, s78, s79
    s_cmp_gt_u32 s78, 2
    s_cbranch_scc1 spin_o3
    s_branch spin_o3_ret
spin_o4:
    s_load_dwordx4 s[72:75], s[86:87], s5 glc
    s_add_u32 s101, s101, 1
    s_cmp_gt_u32 s101, 0x2000000
    s_waitcnt lgkmcnt(0)
    s_cbranch_scc1 spin_o4_ret
    s_sub_u32 s78, s72, s77
    s_sub_u32 s79, s73, s77
    s_max_u32 s78, s78, s79
    s_sub_u32 s79, s74, s77
    s_max_u32 s78, s78, s79
    s_sub_u32 s79, s75, s77
    s_max_u32 s78, s78, s79
    s_cmp_gt_u32 s78, 1
    s_cbranch_scc1 spin_o4
    s_branch spin_o4_ret
spin_o5:
    s_load_dwordx4 s[72:75], s[86:87], s5 glc
    s_add_u32 s101, s101, 1
    s_cmp_gt_u32 s101, 0x2000000
    s_waitcnt lgkmcnt(0)
    s_cbranch_scc1 spin_o5_ret
    s_sub_u32 s78, s72, s77
    s_sub_u32 s79, s73, s77
    s_max_u32 s78, s78, s79
    s_sub_u32 s79, s74, s77
    s_max_u32 s78, s78, s79
    s_sub_u32 s79, s75, s77
    s_max_u32 s78, s78, s79
    s_cmp_gt_u32 s78, 0
    s_cbranch_scc1 spin_o5
    s_branch spin_o5_ret
ln_exact:
    v_mov_b32 v146, 0
    v_lshlrev_b32 v156, 16, v64
    v_and_b32 v157, s42, v64
    v_sub_f32 v156, v156, v150
    v_sub_f32 v157, v157, v150
    v_fmac_f32 v146, v156, v156
    v_fmac_f32 v146, v157, v157
    v_lshlrev_b32 v156, 16, v65
    v_and_b32 v157, s42, v65
    v_sub_f32 v156, v156, v150
    v_sub_f32 v157, v157, v150
    v_fmac_f32 v146, v156, v156
    v_fmac_f32 v146, v157, v157
    v_lshlrev_b32 v156, 16, v66
    v_and_b32 v157, s42, v66
    v_sub_f32 v156, v156, v150
    v_sub_f32 v157, v157, v150
    v_fmac_f32 v146, v156, v156
    v_fmac_f32 v146, v157, v157
    v_lshlrev_b32 v156, 16, v67
    v_and_b32 v157, s42, v67
    v_sub_f32 v156, v156, v150
    v_sub_f32 v157, v157, v150
    v_fmac_f32 v146, v156, v156
    v_fmac_f32 v146, v157, v157
    v_lshlrev_b32 v156, 16, v68
    v_and_b32 v157, s42, v68
    v_sub_f32 v156, v156, v150
    v_sub_f32 v157, v157, v150
    v_fmac_f32 v146, v156, v156
    v_fmac_f32 v146, v157, v157
    v_lshlrev_b32 v156, 16, v69
    v_and_b32 v157, s42, v69
    v_sub_f32 v156, v156, v150
    v_sub_f32 v157, v157, v150
    v_fmac_f32 v146, v156, v156
    v_fmac_f32 v146, v157, v157
    v_lshlrev_b32 v156, 16, v70
    v_and_b32 v157, s42, v70
    v_sub_f32 v156, v156, v150
    v_sub_f32 v157, v157, v150
    v_fmac_f32 v146, v156, v156
    v_fmac_f32 v146, v157, v157
    v_lshlrev_b32 v156, 16, v71
    v_and_b32 v157, s42, v71
    v_sub_f32 v156, v156, v150
    v_sub_f32 v157, v157, v150
    v_fmac_f32 v146, v156, v156
    v_fmac_f32 v146, v157, v157
    v_lshlrev_b32 v156, 16, v72
    v_and_b32 v157, s42, v72
    v_sub_f32 v156, v156, v150
    v_sub_f32 v157, v157, v150
    v_fmac_f32 v146, v156, v156
    v_fmac_f32 v146, v157, v157
    v_lshlrev_b32 v156, 16, v73
    v_and_b32 v157, s42, v73
    v_sub_f32 v156, v156, v150
    v_sub_f32 v157, v157, v150
    v_fmac_f32 v146, v156, v156
    v_fmac_f32 v146, v157, v157
    v_lshlrev_b32 v156, 16, v74
    v_and_b32 v157, s42, v74
    v_sub_f32 v156, v156, v150
    v_sub_f32 v157, v157, v150
    v_fmac_f32 v146, v156, v156
    v_fmac_f32 v146, v157, v157
    v_lshlrev_b32 v156, 16, v75
    v_and_b32 v157, s42, v75
    v_sub_f32 v156, v156, v150
    v_sub_f32 v157, v157, v150
    v_fmac_f32 v146, v156, v156
    v_fmac_f32 v146, v157, v157
    v_lshlrev_b32 v156, 16, v76
    v_and_b32 v157, s42, v76
    v_sub_f32 v156, v156, v150
    v_sub_f32 v157, v157, v150
    v_fmac_f32 v146, v156, v156
    v_fmac_f32 v146, v157, v157
    v_lshlrev_b32 v156, 16, v77
    v_and_b32 v157, s42, v77
    v_sub_f32 v156, v156, v150
    v_sub_f32 v157, v157, v150
    v_fmac_f32 v146, v156, v156
    v_fmac_f32 v146, v157, v157
    v_lshlrev_b32 v156, 16, v78
    v_and_b32 v157, s42, v78
    v_sub_f32 v156, v156, v150
    v_sub_f32 v157, v157, v150
    v_fmac_f32 v146, v156, v156
    v_fmac_f32 v146, v157, v157
    v_lshlrev_b32 v156, 16, v79
    v_and_b32 v157, s42, v79
    v_sub_f32 v156, v156, v150
    v_sub_f32 v157, v157, v150
    v_fmac_f32 v146, v156, v156
    v_fmac_f32 v146, v157, v157
    v_lshlrev_b32 v156, 16, v80
    v_and_b32 v157, s42, v80
    v_sub_f32 v156, v156, v150
    v_sub_f32 v157, v157, v150
    v_fmac_f32 v146, v156, v156
    v_fmac_f32 v146, v157, v157
    v_lshlrev_b32 v156, 16, v81
    v_and_b32 v157, s42, v81
    v_sub_f32 v156, v156, v150
    v_sub_f32 v157, v157, v150
    v_fmac_f32 v146, v156, v156
    v_fmac_f32 v146, v157, v157
    v_lshlrev_b32 v156, 16, v82
    v_and_b32 v157, s42, v82
    v_sub_f32 v156, v156, v150
    v_sub_f32 v157, v157, v150
    v_fmac_f32 v146, v156, v156
    v_fmac_f32 v146, v157, v157
    v_lshlrev_b32 v156, 16, v83
    v_and_b32 v157, s42, v83
    v_sub_f32 v156, v156, v150
    v_sub_f32 v157, v157, v150
    v_fmac_f32 v146, v156, v156
    v_fmac_f32 v146, v157, v157
    s_nop 0
    s_nop 0
    v_add_f32_dpp v146, v146, v146 quad_perm:[1,0,3,2] row_mask:0xf bank_mask:0xf
    s_nop 0
    s_nop 0
    v_add_f32_dpp v146, v146, v146 row_ror:8 row_mask:0xf bank_mask:0xf
    v_mov_b32 v148, v146
    s_nop 0
    s_nop 0
    v_permlane16_swap_b32 v146, v148
    s_nop 0
    s_nop 0
    v_add_f32 v146, v146, v148
    v_mov_b32 v148, v146
    s_nop 0
    s_nop 0
    v_permlane32_swap_b32 v146, v148
    s_nop 0
    s_nop 0
    v_add_f32 v146, v146, v148
    v_mul_f32 v154, s38, v146
    s_branch ln_back
spin_y:
    s_add_u32 s101, s101, 1
    s_cmp_gt_u32 s101, 0x2000000
    s_cbranch_scc1 spin_y_x
    buffer_load_dword v58, v65, s[24:27], s41 offen sc1
    buffer_load_dword v59, v65, s[24:27], s42 offen sc1
    s_waitcnt vmcnt(0)
    v_xor_b32 v58, s58, v58
    v_xor_b32 v59, s58, v59
    v_or_b32 v58, v58, v59
    v_cmp_ne_u32 vcc, 0, v58
    s_cbranch_vccnz spin_y
spin_y_x:
    s_branch spin_y_ret
spin_rec:
    s_add_u32 s101, s101, 1
    s_cmp_gt_u32 s101, 0x2000000
    s_cbranch_scc1 spin_rec_x
    buffer_load_dwordx4 v[32:35], v17, s[24:27], s47 offen offset:0 sc1
    buffer_load_dwordx4 v[36:39], v17, s[24:27], s47 offen offset:1024 sc1
    buffer_load_dwordx4 v[40:43], v17, s[24:27], s47 offen offset:2048 sc1
    buffer_load_dwordx4 v[44:47], v17, s[24:27], s47 offen offset:3072 sc1
    s_waitcnt vmcnt(0)
    v_xor_b32 v34, s7, v34
    v_xor_b32 v38, s7, v38
    v_xor_b32 v42, s7, v42
    v_xor_b32 v46, s7, v46
    v_or3_b32 v34, v34, v38, v42
    v_or_b32 v34, v34, v46
    v_cmp_ne_u32 vcc, 0, v34
    s_cbranch_vccnz spin_rec
spin_rec_x:
    s_branch spin_rec_ret
spin_gu:
    s_add_u32 s101, s101, 1
    s_cmp_gt_u32 s101, 0x2000000
    s_cbranch_scc1 spin_gu_x
    buffer_load_dword v23, v22, s[24:27], s42 offen sc1
    s_waitcnt vmcnt(0)
    v_cmp_ne_u32 vcc, s7, v23
    s_cbranch_vccnz spin_gu
spin_gu_x:
    s_branch spin_gu_ret
rare:
    s_nop 7
    s_nop 7
    v_and_b32 v21, 15, v1
    v_mul_u32_u24 v21, 384, v21
    v_bfe_u32 v22, v1, 4, 1
    v_bfe_u32 v23, v1, 5, 1
    v_lshl_add_u32 v22, v22, 1, v23
    v_lshl_add_u32 v21, v22, 4, v21
    v_mov_b32 v24, 0
    v_mov_b32 v25, 0
    v_mov_b32 v26, 0
    v_mov_b32 v27, 0
    v_mov_b32 v28, 0
    v_mov_b32 v29, 0
    v_mov_b32 v30, 0
    v_mov_b32 v31, 0
    v_mov_b32 v32, 0
    v_mov_b32 v33, 0
    v_mov_b32 v34, 0
    v_mov_b32 v35, 0
    v_mov_b32 v36, 0
    v_mov_b32 v37, 0
    v_mov_b32 v38, 0
    v_mov_b32 v39, 0
    v_mov_b32 v16, 0xff800000
    v_mov_b32 v17, 0xff800000
    v_mov_b32 v18, 0xff800000
    v_mov_b32 v19, 0xff800000
    s_mov_b32 s78, 0
rare_pass:
    s_mov_b32 s77, 0
rare_loop:
    buffer_load_dwordx4 a[216:219], v21, s[12:15], s77 offen offset:0
    buffer_load_dwordx4 a[220:223], v21, s[12:15], s77 offen offset:64
    buffer_load_dwordx4 a[224:227], v21, s[12:15], s77 offen offset:128
    buffer_load_dwordx4 a[228:231], v21, s[12:15], s77 offen offset:192
    buffer_load_dwordx4 a[232:235], v21, s[12:15], s77 offen offset:256
    buffer_load_dwordx4 a[236:239], v21, s[12:15], s77 offen offset:320
    s_waitcnt vmcnt(0)
    v_mfma_f32_16x16x32_bf16 v[40:43], a[216:219], a[0:3], v[24:27]
    v_mfma_f32_16x16x32_bf16 v[44:47], a[216:219], a[4:7], v[28:31]
    v_mfma_f32_16x16x32_bf16 v[48:51], a[216:219], a[8:11], v[32:35]
    v_mfma_f32_16x16x32_bf16 v[52:55], a[216:219], a[12:15], v[36:39]
    v_mfma_f32_16x16x32_bf16 v[40:43], a[220:223], a[16:19], v[40:43]
    v_mfma_f32_16x16x32_bf16 v[44:47], a[220:223], a[20:23], v[44:47]
    v_mfma_f32_16x16x32_bf16 v[48:51], a[220:223], a[24:27], v[48:51]
    v_mfma_f32_16x16x32_bf16 v[52:55], a[220:223], a[28:31], v[52:55]
    v_mfma_f32_16x16x32_bf16 v[40:43], a[224:227], a[32:35], v[40:43]
    v_mfma_f32_16x16x32_bf16 v[44:47], a[224:227], a[36:39], v[44:47]
    v_mfma_f32_16x16x32_bf16 v[48:51], a[224:227], a[40:43], v[48:51]
    v_mfma_f32_16x16x32_bf16 v[52:55], a[224:227], a[44:47], v[52:55]
    v_mfma_f32_16x16x32_bf16 v[40:43], a[228:231], a[48:51], v[40:43]
    v_mfma_f32_16x16x32_bf16 v[44:47], a[228:231], a[52:55], v[44:47]
    v_mfma_f32_16x16x32_bf16 v[48:51], a[228:231], a[56:59], v[48:51]
    v_mfma_f32_16x16x32_bf16 v[52:55], a[228:231], a[60:63], v[52:55]
    v_mfma_f32_16x16x32_bf16 v[40:43], a[232:235], a[64:67], v[40:43]
    v_mfma_f32_16x16x32_bf16 v[44:47], a[232:235], a[68:71], v[44:47]
    v_mfma_f32_16x16x32_bf16 v[48:51], a[232:235], a[72:75], v[48:51]
    v_mfma_f32_16x16x32_bf16 v[52:55], a[232:235], a[76:79], v[52:55]
    v_mfma_f32_16x16x32_bf16 v[40:43], a[236:239], a[80:83], v[40:43]
    v_mfma_f32_16x16x32_bf16 v[44:47], a[236:239], a[84:87], v[44:47]
    v_mfma_f32_16x16x32_bf16 v[48:51], a[236:239], a[88:91], v[48:51]
    v_mfma_f32_16x16x32_bf16 v[52:55], a[236:239], a[92:95], v[52:55]
    s_nop 7
    s_cmp_eq_u32 s78, 0
    s_cbranch_scc0 rare_p2
    v_max3_f32 v16, v16, v40, v41
    v_max3_f32 v16, v16, v42, v43
    v_max3_f32 v17, v17, v44, v45
    v_max3_f32 v17, v17, v46, v47
    v_max3_f32 v18, v18, v48, v49
    v_max3_f32 v18, v18, v50, v51
    v_max3_f32 v19, v19, v52, v53
    v_max3_f32 v19, v19, v54, v55
    s_add_u32 s77, s77, 6144
    s_cmp_lt_u32 s77, 196608
    s_cbranch_scc1 rare_loop
    v_mov_b32 v22, v16
    s_nop 1
    v_permlane16_swap_b32 v16, v22
    s_nop 1
    v_max_f32 v16, v16, v22
    v_mov_b32 v22, v16
    s_nop 1
    v_permlane32_swap_b32 v16, v22
    s_nop 1
    v_max_f32 v16, v16, v22
    v_sub_f32 v24, 0, v16
    v_sub_f32 v25, 0, v16
    v_sub_f32 v26, 0, v16
    v_sub_f32 v27, 0, v16
    v_mov_b32 v22, v17
    s_nop 1
    v_permlane16_swap_b32 v17, v22
    s_nop 1
    v_max_f32 v17, v17, v22
    v_mov_b32 v22, v17
    s_nop 1
    v_permlane32_swap_b32 v17, v22
    s_nop 1
    v_max_f32 v17, v17, v22
    v_sub_f32 v28, 0, v17
    v_sub_f32 v29, 0, v17
    v_sub_f32 v30, 0, v17
    v_sub_f32 v31, 0, v17
    v_mov_b32 v22, v18
    s_nop 1
    v_permlane16_swap_b32 v18, v22
    s_nop 1
    v_max_f32 v18, v18, v22
    v_mov_b32 v22, v18
    s_nop 1
    v_permlane32_swap_b32 v18, v22
    s_nop 1
    v_max_f32 v18, v18, v22
    v_sub_f32 v32, 0, v18
    v_sub_f32 v33, 0, v18
    v_sub_f32 v34, 0, v18
    v_sub_f32 v35, 0, v18
    v_mov_b32 v22, v19
    s_nop 1
    v_permlane16_swap_b32 v19, v22
    s_nop 1
    v_max_f32 v19, v19, v22
    v_mov_b32 v22, v19
    s_nop 1
    v_permlane32_swap_b32 v19, v22
    s_nop 1
    v_max_f32 v19, v19, v22
    v_sub_f32 v36, 0, v19
    v_sub_f32 v37, 0, v19
    v_sub_f32 v38, 0, v19
    v_sub_f32 v39, 0, v19
    s_mov_b32 s78, 1
    s_branch rare_pass
rare_p2:
    v_exp_f32 v40, v40
    v_exp_f32 v41, v41
    v_exp_f32 v42, v42
    v_exp_f32 v43, v43
    v_exp_f32 v44, v44
    v_exp_f32 v45, v45
    v_exp_f32 v46, v46
    v_exp_f32 v47, v47
    v_exp_f32 v48, v48
    v_exp_f32 v49, v49
    v_exp_f32 v50, v50
    v_exp_f32 v51, v51
    v_exp_f32 v52, v52
    v_exp_f32 v53, v53
    v_exp_f32 v54, v54
    v_exp_f32 v55, v55
    s_cmp_eq_u32 s77, 0
    s_cbranch_scc0 rare_d0
    v_cvt_pk_bf16_f32 v22, v40, v41
    v_cvt_pk_bf16_f32 v23, v42, v43
    v_accvgpr_write_b32 a96, v22
    v_accvgpr_write_b32 a97, v23
    v_cvt_pk_bf16_f32 v22, v44, v45
    v_cvt_pk_bf16_f32 v23, v46, v47
    v_accvgpr_write_b32 a104, v22
    v_accvgpr_write_b32 a105, v23
    v_cvt_pk_bf16_f32 v22, v48, v49
    v_cvt_pk_bf16_f32 v23, v50, v51
    v_accvgpr_write_b32 a112, v22
    v_accvgpr_write_b32 a113, v23
    v_cvt_pk_bf16_f32 v22, v52, v53
    v_cvt_pk_bf16_f32 v23, v54, v55
    v_accvgpr_write_b32 a120, v22
    v_accvgpr_write_b32 a121, v23
rare_d0:
    s_cmp_eq_u32 s77, 6144
    s_cbranch_scc0 rare_d1
    v_cvt_pk_bf16_f32 v22, v40, v41
    v_cvt_pk_bf16_f32 v23, v42, v43
    v_accvgpr_write_b32 a98, v22
    v_accvgpr_write_b32 a99, v23
    v_cvt_pk_bf16_f32 v22, v44, v45
    v_cvt_pk_bf16_f32 v23, v46, v47
    v_accvgpr_write_b32 a106, v22
    v_accvgpr_write_b32 a107, v23
    v_cvt_pk_bf16_f32 v22, v48, v49
    v_cvt_pk_bf16_f32 v23, v50, v51
    v_accvgpr_write_b32 a114, v22
    v_accvgpr_write_b32 a115, v23
    v_cvt_pk_bf16_f32 v22, v52, v53
    v_cvt_pk_bf16_f32 v23, v54, v55
    v_accvgpr_write_b32 a122, v22
    v_accvgpr_write_b32 a123, v23
rare_d1:
    s_cmp_eq_u32 s77, 12288
    s_cbranch_scc0 rare_d2
    v_cvt_pk_bf16_f32 v22, v40, v41
    v_cvt_pk_bf16_f32 v23, v42, v43
    v_accvgpr_write_b32 a100, v22
    v_accvgpr_write_b32 a101, v23
    v_cvt_pk_bf16_f32 v22, v44, v45
    v_cvt_pk_bf16_f32 v23, v46, v47
    v_accvgpr_write_b32 a108, v22
    v_accvgpr_write_b32 a109, v23
    v_cvt_pk_bf16_f32 v22, v48, v49
    v_cvt_pk_bf16_f32 v23, v50, v51
    v_accvgpr_write_b32 a116, v22
    v_accvgpr_write_b32 a117, v23
    v_cvt_pk_bf16_f32 v22, v52, v53
    v_cvt_pk_bf16_f32 v23, v54, v55
    v_accvgpr_write_b32 a124, v22
    v_accvgpr_write_b32 a125, v23
rare_d2:
    s_cmp_eq_u32 s77, 18432
    s_cbranch_scc0 rare_d3
    v_cvt_pk_bf16_f32 v22, v40, v41
    v_cvt_pk_bf16_f32 v23, v42, v43
    v_accvgpr_write_b32 a102, v22
    v_accvgpr_write_b32 a103, v23
    v_cvt_pk_bf16_f32 v22, v44, v45
    v_cvt_pk_bf16_f32 v23, v46, v47
    v_accvgpr_write_b32 a110, v22
    v_accvgpr_write_b32 a111, v23
    v_cvt_pk_bf16_f32 v22, v48, v49
    v_cvt_pk_bf16_f32 v23, v50, v51
    v_accvgpr_write_b32 a118, v22
    v_accvgpr_write_b32 a119, v23
    v_cvt_pk_bf16_f32 v22, v52, v53
    v_cvt_pk_bf16_f32 v23, v54, v55
    v_accvgpr_write_b32 a126, v22
    v_accvgpr_write_b32 a127, v23
rare_d3:
    s_cmp_eq_u32 s77, 24576
    s_cbranch_scc0 rare_d4
    v_cvt_pk_bf16_f32 v22, v40, v41
    v_cvt_pk_bf16_f32 v23, v42, v43
    v_accvgpr_write_b32 a128, v22
    v_accvgpr_write_b32 a129, v23
    v_cvt_pk_bf16_f32 v22, v44, v45
    v_cvt_pk_bf16_f32 v23, v46, v47
    v_accvgpr_write_b32 a136, v22
    v_accvgpr_write_b32 a137, v23
    v_cvt_pk_bf16_f32 v22, v48, v49
    v_cvt_pk_bf16_f32 v23, v50, v51
    v_accvgpr_write_b32 a144, v22
    v_accvgpr_write_b32 a145, v23
    v_cvt_pk_bf16_f32 v120, v52, v53
    v_cvt_pk_bf16_f32 v121, v54, v55
rare_d4:
    s_cmp_eq_u32 s77, 30720
    s_cbranch_scc0 rare_d5
    v_cvt_pk_bf16_f32 v22, v40, v41
    v_cvt_pk_bf16_f32 v23, v42, v43
    v_accvgpr_write_b32 a130, v22
    v_accvgpr_write_b32 a131, v23
    v_cvt_pk_bf16_f32 v22, v44, v45
    v_cvt_pk_bf16_f32 v23, v46, v47
    v_accvgpr_write_b32 a138, v22
    v_accvgpr_write_b32 a139, v23
    v_cvt_pk_bf16_f32 v22, v48, v49
    v_cvt_pk_bf16_f32 v23, v50, v51
    v_accvgpr_write_b32 a146, v22
    v_accvgpr_write_b32 a147, v23
    v_cvt_pk_bf16_f32 v122, v52, v53
    v_cvt_pk_bf16_f32 v123, v54, v55
rare_d5:
    s_cmp_eq_u32 s77, 36864
    s_cbranch_scc0 rare_d6
    v_cvt_pk_bf16_f32 v22, v40, v41
    v_cvt_pk_bf16_f32 v23, v42, v43
    v_accvgpr_write_b32 a132, v22
    v_accvgpr_write_b32 a133, v23
    v_cvt_pk_bf16_f32 v22, v44, v45
    v_cvt_pk_bf16_f32 v23, v46, v47
    v_accvgpr_write_b32 a140, v22
    v_accvgpr_write_b32 a141, v23
    v_cvt_pk_bf16_f32 v22, v48, v49
    v_cvt_pk_bf16_f32 v23, v50, v51
    v_accvgpr_write_b32 a148, v22
    v_accvgpr_write_b32 a149, v23
    v_cvt_pk_bf16_f32 v124, v52, v53
    v_cvt_pk_bf16_f32 v125, v54, v55
rare_d6:
    s_cmp_eq_u32 s77, 43008
    s_cbranch_scc0 rare_d7
    v_cvt_pk_bf16_f32 v22, v40, v41
    v_cvt_pk_bf16_f32 v23, v42, v43
    v_accvgpr_write_b32 a134, v22
    v_accvgpr_write_b32 a135, v23
    v_cvt_pk_bf16_f32 v22, v44, v45
    v_cvt_pk_bf16_f32 v23, v46, v47
    v_accvgpr_write_b32 a142, v22
    v_accvgpr_write_b32 a143, v23
    v_cvt_pk_bf16_f32 v22, v48, v49
    v_cvt_pk_bf16_f32 v23, v50, v51
    v_accvgpr_write_b32 a150, v22
    v_accvgpr_write_b32 a151, v23
    v_cvt_pk_bf16_f32 v126, v52, v53
    v_cvt_pk_bf16_f32 v127, v54, v55
rare_d7:
    s_cmp_eq_u32 s77, 49152
    s_cbranch_scc0 rare_d8
    v_cvt_pk_bf16_f32 v128, v40, v41
    v_cvt_pk_bf16_f32 v129, v42, v43
    v_cvt_pk_bf16_f32 v136, v44, v45
    v_cvt_pk_bf16_f32 v137, v46, v47
    v_cvt_pk_bf16_f32 v144, v48, v49
    v_cvt_pk_bf16_f32 v145, v50, v51
    v_cvt_pk_bf16_f32 v152, v52, v53
    v_cvt_pk_bf16_f32 v153, v54, v55
rare_d8:
    s_cmp_eq_u32 s77, 55296
    s_cbranch_scc0 rare_d9
    v_cvt_pk_bf16_f32 v130, v40, v41
    v_cvt_pk_bf16_f32 v131, v42, v43
    v_cvt_pk_bf16_f32 v138, v44, v45
    v_cvt_pk_bf16_f32 v139, v46, v47
    v_cvt_pk_bf16_f32 v146, v48, v49
    v_cvt_pk_bf16_f32 v147, v50, v51
    v_cvt_pk_bf16_f32 v154, v52, v53
    v_cvt_pk_bf16_f32 v155, v54, v55
rare_d9:
    s_cmp_eq_u32 s77, 61440
    s_cbranch_scc0 rare_d10
    v_cvt_pk_bf16_f32 v132, v40, v41
    v_cvt_pk_bf16_f32 v133, v42, v43
    v_cvt_pk_bf16_f32 v140, v44, v45
    v_cvt_pk_bf16_f32 v141, v46, v47
    v_cvt_pk_bf16_f32 v148, v48, v49
    v_cvt_pk_bf16_f32 v149, v50, v51
    v_cvt_pk_bf16_f32 v156, v52, v53
    v_cvt_pk_bf16_f32 v157, v54, v55
rare_d10:
    s_cmp_eq_u32 s77, 67584
    s_cbranch_scc0 rare_d11
    v_cvt_pk_bf16_f32 v134, v40, v41
    v_cvt_pk_bf16_f32 v135, v42, v43
    v_cvt_pk_bf16_f32 v142, v44, v45
    v_cvt_pk_bf16_f32 v143, v46, v47
    v_cvt_pk_bf16_f32 v150, v48, v49
    v_cvt_pk_bf16_f32 v151, v50, v51
    v_cvt_pk_bf16_f32 v158, v52, v53
    v_cvt_pk_bf16_f32 v159, v54, v55
rare_d11:
    s_cmp_eq_u32 s77, 73728
    s_cbranch_scc0 rare_d12
    v_cvt_pk_bf16_f32 v160, v40, v41
    v_cvt_pk_bf16_f32 v161, v42, v43
    v_cvt_pk_bf16_f32 v168, v44, v45
    v_cvt_pk_bf16_f32 v169, v46, v47
    v_cvt_pk_bf16_f32 v176, v48, v49
    v_cvt_pk_bf16_f32 v177, v50, v51
    v_cvt_pk_bf16_f32 v184, v52, v53
    v_cvt_pk_bf16_f32 v185, v54, v55
rare_d12:
    s_cmp_eq_u32 s77, 79872
    s_cbranch_scc0 rare_d13
    v_cvt_pk_bf16_f32 v162, v40, v41
    v_cvt_pk_bf16_f32 v163, v42, v43
    v_cvt_pk_bf16_f32 v170, v44, v45
    v_cvt_pk_bf16_f32 v171, v46, v47
    v_cvt_pk_bf16_f32 v178, v48, v49
    v_cvt_pk_bf16_f32 v179, v50, v51
    v_cvt_pk_bf16_f32 v186, v52, v53
    v_cvt_pk_bf16_f32 v187, v54, v55
rare_d13:
    s_cmp_eq_u32 s77, 86016
    s_cbranch_scc0 rare_d14
    v_cvt_pk_bf16_f32 v164, v40, v41
    v_cvt_pk_bf16_f32 v165, v42, v43
    v_cvt_pk_bf16_f32 v172, v44, v45
    v_cvt_pk_bf16_f32 v173, v46, v47
    v_cvt_pk_bf16_f32 v180, v48, v49
    v_cvt_pk_bf16_f32 v181, v50, v51
    v_cvt_pk_bf16_f32 v188, v52, v53
    v_cvt_pk_bf16_f32 v189, v54, v55
rare_d14:
    s_cmp_eq_u32 s77, 92160
    s_cbranch_scc0 rare_d15
    v_cvt_pk_bf16_f32 v166, v40, v41
    v_cvt_pk_bf16_f32 v167, v42, v43
    v_cvt_pk_bf16_f32 v174, v44, v45
    v_cvt_pk_bf16_f32 v175, v46, v47
    v_cvt_pk_bf16_f32 v182, v48, v49
    v_cvt_pk_bf16_f32 v183, v50, v51
    v_cvt_pk_bf16_f32 v190, v52, v53
    v_cvt_pk_bf16_f32 v191, v54, v55
rare_d15:
    s_cmp_eq_u32 s77, 98304
    s_cbranch_scc0 rare_d16
    v_cvt_pk_bf16_f32 v192, v40, v41
    v_cvt_pk_bf16_f32 v193, v42, v43
    v_cvt_pk_bf16_f32 v200, v44, v45
    v_cvt_pk_bf16_f32 v201, v46, v47
    v_cvt_pk_bf16_f32 v208, v48, v49
    v_cvt_pk_bf16_f32 v209, v50, v51
    v_cvt_pk_bf16_f32 v216, v52, v53
    v_cvt_pk_bf16_f32 v217, v54, v55
rare_d16:
    s_cmp_eq_u32 s77, 104448
    s_cbranch_scc0 rare_d17
    v_cvt_pk_bf16_f32 v194, v40, v41
    v_cvt_pk_bf16_f32 v195, v42, v43
    v_cvt_pk_bf16_f32 v202, v44, v45
    v_cvt_pk_bf16_f32 v203, v46, v47
    v_cvt_pk_bf16_f32 v210, v48, v49
    v_cvt_pk_bf16_f32 v211, v50, v51
    v_cvt_pk_bf16_f32 v218, v52, v53
    v_cvt_pk_bf16_f32 v219, v54, v55
rare_d17:
    s_cmp_eq_u32 s77, 110592
    s_cbranch_scc0 rare_d18
    v_cvt_pk_bf16_f32 v196, v40, v41
    v_cvt_pk_bf16_f32 v197, v42, v43
    v_cvt_pk_bf16_f32 v204, v44, v45
    v_cvt_pk_bf16_f32 v205, v46, v47
    v_cvt_pk_bf16_f32 v212, v48, v49
    v_cvt_pk_bf16_f32 v213, v50, v51
    v_cvt_pk_bf16_f32 v220, v52, v53
    v_cvt_pk_bf16_f32 v221, v54, v55
rare_d18:
    s_cmp_eq_u32 s77, 116736
    s_cbranch_scc0 rare_d19
    v_cvt_pk_bf16_f32 v198, v40, v41
    v_cvt_pk_bf16_f32 v199, v42, v43
    v_cvt_pk_bf16_f32 v206, v44, v45
    v_cvt_pk_bf16_f32 v207, v46, v47
    v_cvt_pk_bf16_f32 v214, v48, v49
    v_cvt_pk_bf16_f32 v215, v50, v51
    v_cvt_pk_bf16_f32 v222, v52, v53
    v_cvt_pk_bf16_f32 v223, v54, v55
rare_d19:
    s_cmp_eq_u32 s77, 122880
    s_cbranch_scc0 rare_d20
    v_cvt_pk_bf16_f32 v224, v40, v41
    v_cvt_pk_bf16_f32 v225, v42, v43
    v_cvt_pk_bf16_f32 v232, v44, v45
    v_cvt_pk_bf16_f32 v233, v46, v47
    v_cvt_pk_bf16_f32 v240, v48, v49
    v_cvt_pk_bf16_f32 v241, v50, v51
    v_cvt_pk_bf16_f32 v248, v52, v53
    v_cvt_pk_bf16_f32 v249, v54, v55
rare_d20:
    s_cmp_eq_u32 s77, 129024
    s_cbranch_scc0 rare_d21
    v_cvt_pk_bf16_f32 v226, v40, v41
    v_cvt_pk_bf16_f32 v227, v42, v43
    v_cvt_pk_bf16_f32 v234, v44, v45
    v_cvt_pk_bf16_f32 v235, v46, v47
    v_cvt_pk_bf16_f32 v242, v48, v49
    v_cvt_pk_bf16_f32 v243, v50, v51
    v_cvt_pk_bf16_f32 v250, v52, v53
    v_cvt_pk_bf16_f32 v251, v54, v55
rare_d21:
    s_cmp_eq_u32 s77, 135168
    s_cbranch_scc0 rare_d22
    v_cvt_pk_bf16_f32 v228, v40, v41
    v_cvt_pk_bf16_f32 v229, v42, v43
    v_cvt_pk_bf16_f32 v236, v44, v45
    v_cvt_pk_bf16_f32 v237, v46, v47
    v_cvt_pk_bf16_f32 v244, v48, v49
    v_cvt_pk_bf16_f32 v245, v50, v51
    v_cvt_pk_bf16_f32 v252, v52, v53
    v_cvt_pk_bf16_f32 v253, v54, v55
rare_d22:
    s_cmp_eq_u32 s77, 141312
    s_cbranch_scc0 rare_d23
    v_cvt_pk_bf16_f32 v230, v40, v41
    v_cvt_pk_bf16_f32 v231, v42, v43
    v_cvt_pk_bf16_f32 v238, v44, v45
    v_cvt_pk_bf16_f32 v239, v46, v47
    v_cvt_pk_bf16_f32 v246, v48, v49
    v_cvt_pk_bf16_f32 v247, v50, v51
    v_cvt_pk_bf16_f32 v254, v52, v53
    v_cvt_pk_bf16_f32 v255, v54, v55
rare_d23:
    s_cmp_eq_u32 s77, 147456
    s_cbranch_scc0 rare_d24
    v_cvt_pk_bf16_f32 v56, v40, v41
    v_cvt_pk_bf16_f32 v57, v42, v43
    v_cvt_pk_bf16_f32 v64, v44, v45
    v_cvt_pk_bf16_f32 v65, v46, v47
    v_cvt_pk_bf16_f32 v72, v48, v49
    v_cvt_pk_bf16_f32 v73, v50, v51
    v_cvt_pk_bf16_f32 v80, v52, v53
    v_cvt_pk_bf16_f32 v81, v54, v55
rare_d24:
    s_cmp_eq_u32 s77, 153600
    s_cbranch_scc0 rare_d25
    v_cvt_pk_bf16_f32 v58, v40, v41
    v_cvt_pk_bf16_f32 v59, v42, v43
    v_cvt_pk_bf16_f32 v66, v44, v45
    v_cvt_pk_bf16_f32 v67, v46, v47
    v_cvt_pk_bf16_f32 v74, v48, v49
    v_cvt_pk_bf16_f32 v75, v50, v51
    v_cvt_pk_bf16_f32 v82, v52, v53
    v_cvt_pk_bf16_f32 v83, v54, v55
rare_d25:
    s_cmp_eq_u32 s77, 159744
    s_cbranch_scc0 rare_d26
    v_cvt_pk_bf16_f32 v60, v40, v41
    v_cvt_pk_bf16_f32 v61, v42, v43
    v_cvt_pk_bf16_f32 v68, v44, v45
    v_cvt_pk_bf16_f32 v69, v46, v47
    v_cvt_pk_bf16_f32 v76, v48, v49
    v_cvt_pk_bf16_f32 v77, v50, v51
    v_cvt_pk_bf16_f32 v84, v52, v53
    v_cvt_pk_bf16_f32 v85, v54, v55
rare_d26:
    s_cmp_eq_u32 s77, 165888
    s_cbranch_scc0 rare_d27
    v_cvt_pk_bf16_f32 v62, v40, v41
    v_cvt_pk_bf16_f32 v63, v42, v43
    v_cvt_pk_bf16_f32 v70, v44, v45
    v_cvt_pk_bf16_f32 v71, v46, v47
    v_cvt_pk_bf16_f32 v78, v48, v49
    v_cvt_pk_bf16_f32 v79, v50, v51
    v_cvt_pk_bf16_f32 v86, v52, v53
    v_cvt_pk_bf16_f32 v87, v54, v55
rare_d27:
    s_cmp_eq_u32 s77, 172032
    s_cbranch_scc0 rare_d28
    v_cvt_pk_bf16_f32 v88, v40, v41
    v_cvt_pk_bf16_f32 v89, v42, v43
    v_cvt_pk_bf16_f32 v96, v44, v45
    v_cvt_pk_bf16_f32 v97, v46, v47
    v_cvt_pk_bf16_f32 v104, v48, v49
    v_cvt_pk_bf16_f32 v105, v50, v51
    v_cvt_pk_bf16_f32 v112, v52, v53
    v_cvt_pk_bf16_f32 v113, v54, v55
rare_d28:
    s_cmp_eq_u32 s77, 178176
    s_cbranch_scc0 rare_d29
    v_cvt_pk_bf16_f32 v90, v40, v41
    v_cvt_pk_bf16_f32 v91, v42, v43
    v_cvt_pk_bf16_f32 v98, v44, v45
    v_cvt_pk_bf16_f32 v99, v46, v47
    v_cvt_pk_bf16_f32 v106, v48, v49
    v_cvt_pk_bf16_f32 v107, v50, v51
    v_cvt_pk_bf16_f32 v114, v52, v53
    v_cvt_pk_bf16_f32 v115, v54, v55
rare_d29:
    s_cmp_eq_u32 s77, 184320
    s_cbranch_scc0 rare_d30
    v_cvt_pk_bf16_f32 v92, v40, v41
    v_cvt_pk_bf16_f32 v93, v42, v43
    v_cvt_pk_bf16_f32 v100, v44, v45
    v_cvt_pk_bf16_f32 v101, v46, v47
    v_cvt_pk_bf16_f32 v108, v48, v49
    v_cvt_pk_bf16_f32 v109, v50, v51
    v_cvt_pk_bf16_f32 v116, v52, v53
    v_cvt_pk_bf16_f32 v117, v54, v55
rare_d30:
    s_cmp_eq_u32 s77, 190464
    s_cbranch_scc0 rare_d31
    v_cvt_pk_bf16_f32 v94, v40, v41
    v_cvt_pk_bf16_f32 v95, v42, v43
    v_cvt_pk_bf16_f32 v102, v44, v45
    v_cvt_pk_bf16_f32 v103, v46, v47
    v_cvt_pk_bf16_f32 v110, v48, v49
    v_cvt_pk_bf16_f32 v111, v50, v51
    v_cvt_pk_bf16_f32 v118, v52, v53
    v_cvt_pk_bf16_f32 v119, v54, v55
rare_d31:
    s_add_u32 s77, s77, 6144
    s_cmp_lt_u32 s77, 196608
    s_cbranch_scc1 rare_loop
    ds_read_b64_tr_b16 a[216:217], v8 offset:0
    ds_read_b64_tr_b16 a[218:219], v8 offset:2048
    ds_read_b64_tr_b16 a[220:221], v9 offset:0
    ds_read_b64_tr_b16 a[222:223], v9 offset:2048
    s_waitcnt lgkmcnt(0)
    v_mfma_f32_16x16x32_bf16 a[152:155], a[216:219], a[96:99], 0
    v_mfma_f32_16x16x32_bf16 a[156:159], a[216:219], a[104:107], 0
    v_mfma_f32_16x16x32_bf16 a[160:163], a[216:219], a[112:115], 0
    v_mfma_f32_16x16x32_bf16 a[164:167], a[216:219], a[120:123], 0
    v_mfma_f32_16x16x32_bf16 a[168:171], a[220:223], a[96:99], 0
    v_mfma_f32_16x16x32_bf16 a[172:175], a[220:223], a[104:107], 0
    v_mfma_f32_16x16x32_bf16 a[176:179], a[220:223], a[112:115], 0
    v_mfma_f32_16x16x32_bf16 a[180:183], a[220:223], a[120:123], 0
    ds_read_b64_tr_b16 a[216:217], v8 offset:4096
    ds_read_b64_tr_b16 a[218:219], v8 offset:6144
    ds_read_b64_tr_b16 a[220:221], v9 offset:4096
    ds_read_b64_tr_b16 a[222:223], v9 offset:6144
    s_waitcnt lgkmcnt(0)
    v_mfma_f32_16x16x32_bf16 a[152:155], a[216:219], a[100:103], a[152:155]
    v_mfma_f32_16x16x32_bf16 a[156:159], a[216:219], a[108:111], a[156:159]
    v_mfma_f32_16x16x32_bf16 a[160:163], a[216:219], a[116:119], a[160:163]
    v_mfma_f32_16x16x32_bf16 a[164:167], a[216:219], a[124:127], a[164:167]
    v_mfma_f32_16x16x32_bf16 a[168:171], a[220:223], a[100:103], a[168:171]
    v_mfma_f32_16x16x32_bf16 a[172:175], a[220:223], a[108:111], a[172:175]
    v_mfma_f32_16x16x32_bf16 a[176:179], a[220:223], a[116:119], a[176:179]
    v_mfma_f32_16x16x32_bf16 a[180:183], a[220:223], a[124:127], a[180:183]
    ds_read_b64_tr_b16 a[216:217], v8 offset:8192
    ds_read_b64_tr_b16 a[218:219], v8 offset:10240
    ds_read_b64_tr_b16 a[220:221], v9 offset:8192
    ds_read_b64_tr_b16 a[222:223], v9 offset:10240
    s_waitcnt lgkmcnt(0)
    v_mfma_f32_16x16x32_bf16 a[152:155], a[216:219], a[128:131], a[152:155]
    v_mfma_f32_16x16x32_bf16 a[156:159], a[216:219], a[136:139], a[156:159]
    v_mfma_f32_16x16x32_bf16 a[160:163], a[216:219], a[144:147], a[160:163]
    v_mfma_f32_16x16x32_bf16 a[164:167], a[216:219], v[120:123], a[164:167]
    v_mfma_f32_16x16x32_bf16 a[168:171], a[220:223], a[128:131], a[168:171]
    v_mfma_f32_16x16x32_bf16 a[172:175], a[220:223], a[136:139], a[172:175]
    v_mfma_f32_16x16x32_bf16 a[176:179], a[220:223], a[144:147], a[176:179]
    v_mfma_f32_16x16x32_bf16 a[180:183], a[220:223], v[120:123], a[180:183]
    ds_read_b64_tr_b16 a[216:217], v8 offset:12288
    ds_read_b64_tr_b16 a[218:219], v8 offset:14336
    ds_read_b64_tr_b16 a[220:221], v9 offset:12288
    ds_read_b64_tr_b16 a[222:223], v9 offset:14336
    s_waitcnt lgkmcnt(0)
    v_mfma_f32_16x16x32_bf16 a[152:155], a[216:219], a[132:135], a[152:155]
    v_mfma_f32_16x16x32_bf16 a[156:159], a[216:219], a[140:143], a[156:159]
    v_mfma_f32_16x16x32_bf16 a[160:163], a[216:219], a[148:151], a[160:163]
    v_mfma_f32_16x16x32_bf16 a[164:167], a[216:219], v[124:127], a[164:167]
    v_mfma_f32_16x16x32_bf16 a[168:171], a[220:223], a[132:135], a[168:171]
    v_mfma_f32_16x16x32_bf16 a[172:175], a[220:223], a[140:143], a[172:175]
    v_mfma_f32_16x16x32_bf16 a[176:179], a[220:223], a[148:151], a[176:179]
    v_mfma_f32_16x16x32_bf16 a[180:183], a[220:223], v[124:127], a[180:183]
    ds_read_b64_tr_b16 a[216:217], v8 offset:16384
    ds_read_b64_tr_b16 a[218:219], v8 offset:18432
    ds_read_b64_tr_b16 a[220:221], v9 offset:16384
    ds_read_b64_tr_b16 a[222:223], v9 offset:18432
    s_waitcnt lgkmcnt(0)
    v_mfma_f32_16x16x32_bf16 a[152:155], a[216:219], v[128:131], a[152:155]
    v_mfma_f32_16x16x32_bf16 a[156:159], a[216:219], v[136:139], a[156:159]
    v_mfma_f32_16x16x32_bf16 a[160:163], a[216:219], v[144:147], a[160:163]
    v_mfma_f32_16x16x32_bf16 a[164:167], a[216:219], v[152:155], a[164:167]
    v_mfma_f32_16x16x32_bf16 a[168:171], a[220:223], v[128:131], a[168:171]
    v_mfma_f32_16x16x32_bf16 a[172:175], a[220:223], v[136:139], a[172:175]
    v_mfma_f32_16x16x32_bf16 a[176:179], a[220:223], v[144:147], a[176:179]
    v_mfma_f32_16x16x32_bf16 a[180:183], a[220:223], v[152:155], a[180:183]
    ds_read_b64_tr_b16 a[216:217], v8 offset:20480
    ds_read_b64_tr_b16 a[218:219], v8 offset:22528
    ds_read_b64_tr_b16 a[220:221], v9 offset:20480
    ds_read_b64_tr_b16 a[222:223], v9 offset:22528
    s_waitcnt lgkmcnt(0)
    v_mfma_f32_16x16x32_bf16 a[152:155], a[216:219], v[132:135], a[152:155]
    v_mfma_f32_16x16x32_bf16 a[156:159], a[216:219], v[140:143], a[156:159]
    v_mfma_f32_16x16x32_bf16 a[160:163], a[216:219], v[148:151], a[160:163]
    v_mfma_f32_16x16x32_bf16 a[164:167], a[216:219], v[156:159], a[164:167]
    v_mfma_f32_16x16x32_bf16 a[168:171], a[220:223], v[132:135], a[168:171]
    v_mfma_f32_16x16x32_bf16 a[172:175], a[220:223], v[140:143], a[172:175]
    v_mfma_f32_16x16x32_bf16 a[176:179], a[220:223], v[148:151], a[176:179]
    v_mfma_f32_16x16x32_bf16 a[180:183], a[220:223], v[156:159], a[180:183]
    ds_read_b64_tr_b16 a[216:217], v8 offset:24576
    ds_read_b64_tr_b16 a[218:219], v8 offset:26624
    ds_read_b64_tr_b16 a[220:221], v9 offset:24576
    ds_read_b64_tr_b16 a[222:223], v9 offset:26624
    s_waitcnt lgkmcnt(0)
    v_mfma_f32_16x16x32_bf16 a[152:155], a[216:219], v[160:163], a[152:155]
    v_mfma_f32_16x16x32_bf16 a[156:159], a[216:219], v[168:171], a[156:159]
    v_mfma_f32_16x16x32_bf16 a[160:163], a[216:219], v[176:179], a[160:163]
    v_mfma_f32_16x16x32_bf16 a[164:167], a[216:219], v[184:187], a[164:167]
    v_mfma_f32_16x16x32_bf16 a[168:171], a[220:223], v[160:163], a[168:171]
    v_mfma_f32_16x16x32_bf16 a[172:175], a[220:223], v[168:171], a[172:175]
    v_mfma_f32_16x16x32_bf16 a[176:179], a[220:223], v[176:179], a[176:179]
    v_mfma_f32_16x16x32_bf16 a[180:183], a[220:223], v[184:187], a[180:183]
    ds_read_b64_tr_b16 a[216:217], v8 offset:28672
    ds_read_b64_tr_b16 a[218:219], v8 offset:30720
    ds_read_b64_tr_b16 a[220:221], v9 offset:28672
    ds_read_b64_tr_b16 a[222:223], v9 offset:30720
    s_waitcnt lgkmcnt(0)
    v_mfma_f32_16x16x32_bf16 a[152:155], a[216:219], v[164:167], a[152:155]
    v_mfma_f32_16x16x32_bf16 a[156:159], a[216:219], v[172:175], a[156:159]
    v_mfma_f32_16x16x32_bf16 a[160:163], a[216:219], v[180:183], a[160:163]
    v_mfma_f32_16x16x32_bf16 a[164:167], a[216:219], v[188:191], a[164:167]
    v_mfma_f32_16x16x32_bf16 a[168:171], a[220:223], v[164:167], a[168:171]
    v_mfma_f32_16x16x32_bf16 a[172:175], a[220:223], v[172:175], a[172:175]
    v_mfma_f32_16x16x32_bf16 a[176:179], a[220:223], v[180:183], a[176:179]
    v_mfma_f32_16x16x32_bf16 a[180:183], a[220:223], v[188:191], a[180:183]
    ds_read_b64_tr_b16 a[216:217], v8 offset:32768
    ds_read_b64_tr_b16 a[218:219], v8 offset:34816
    ds_read_b64_tr_b16 a[220:221], v9 offset:32768
    ds_read_b64_tr_b16 a[222:223], v9 offset:34816
    s_waitcnt lgkmcnt(0)
    v_mfma_f32_16x16x32_bf16 a[152:155], a[216:219], v[192:195], a[152:155]
    v_mfma_f32_16x16x32_bf16 a[156:159], a[216:219], v[200:203], a[156:159]
    v_mfma_f32_16x16x32_bf16 a[160:163], a[216:219], v[208:211], a[160:163]
    v_mfma_f32_16x16x32_bf16 a[164:167], a[216:219], v[216:219], a[164:167]
    v_mfma_f32_16x16x32_bf16 a[168:171], a[220:223], v[192:195], a[168:171]
    v_mfma_f32_16x16x32_bf16 a[172:175], a[220:223], v[200:203], a[172:175]
    v_mfma_f32_16x16x32_bf16 a[176:179], a[220:223], v[208:211], a[176:179]
    v_mfma_f32_16x16x32_bf16 a[180:183], a[220:223], v[216:219], a[180:183]
    ds_read_b64_tr_b16 a[216:217], v8 offset:36864
    ds_read_b64_tr_b16 a[218:219], v8 offset:38912
    ds_read_b64_tr_b16 a[220:221], v9 offset:36864
    ds_read_b64_tr_b16 a[222:223], v9 offset:38912
    s_waitcnt lgkmcnt(0)
    v_mfma_f32_16x16x32_bf16 a[152:155], a[216:219], v[196:199], a[152:155]
    v_mfma_f32_16x16x32_bf16 a[156:159], a[216:219], v[204:207], a[156:159]
    v_mfma_f32_16x16x32_bf16 a[160:163], a[216:219], v[212:215], a[160:163]
    v_mfma_f32_16x16x32_bf16 a[164:167], a[216:219], v[220:223], a[164:167]
    v_mfma_f32_16x16x32_bf16 a[168:171], a[220:223], v[196:199], a[168:171]
    v_mfma_f32_16x16x32_bf16 a[172:175], a[220:223], v[204:207], a[172:175]
    v_mfma_f32_16x16x32_bf16 a[176:179], a[220:223], v[212:215], a[176:179]
    v_mfma_f32_16x16x32_bf16 a[180:183], a[220:223], v[220:223], a[180:183]
    ds_read_b64_tr_b16 a[216:217], v8 offset:40960
    ds_read_b64_tr_b16 a[218:219], v8 offset:43008
    ds_read_b64_tr_b16 a[220:221], v9 offset:40960
    ds_read_b64_tr_b16 a[222:223], v9 offset:43008
    s_waitcnt lgkmcnt(0)
    v_mfma_f32_16x16x32_bf16 a[152:155], a[216:219], v[224:227], a[152:155]
    v_mfma_f32_16x16x32_bf16 a[156:159], a[216:219], v[232:235], a[156:159]
    v_mfma_f32_16x16x32_bf16 a[160:163], a[216:219], v[240:243], a[160:163]
    v_mfma_f32_16x16x32_bf16 a[164:167], a[216:219], v[248:251], a[164:167]
    v_mfma_f32_16x16x32_bf16 a[168:171], a[220:223], v[224:227], a[168:171]
    v_mfma_f32_16x16x32_bf16 a[172:175], a[220:223], v[232:235], a[172:175]
    v_mfma_f32_16x16x32_bf16 a[176:179], a[220:223], v[240:243], a[176:179]
    v_mfma_f32_16x16x32_bf16 a[180:183], a[220:223], v[248:251], a[180:183]
    ds_read_b64_tr_b16 a[216:217], v8 offset:45056
    ds_read_b64_tr_b16 a[218:219], v8 offset:47104
    ds_read_b64_tr_b16 a[220:221], v9 offset:45056
    ds_read_b64_tr_b16 a[222:223], v9 offset:47104
    s_waitcnt lgkmcnt(0)
    v_mfma_f32_16x16x32_bf16 a[152:155], a[216:219], v[228:231], a[152:155]
    v_mfma_f32_16x16x32_bf16 a[156:159], a[216:219], v[236:239], a[156:159]
    v_mfma_f32_16x16x32_bf16 a[160:163], a[216:219], v[244:247], a[160:163]
    v_mfma_f32_16x16x32_bf16 a[164:167], a[216:219], v[252:255], a[164:167]
    v_mfma_f32_16x16x32_bf16 a[168:171], a[220:223], v[228:231], a[168:171]
    v_mfma_f32_16x16x32_bf16 a[172:175], a[220:223], v[236:239], a[172:175]
    v_mfma_f32_16x16x32_bf16 a[176:179], a[220:223], v[244:247], a[176:179]
    v_mfma_f32_16x16x32_bf16 a[180:183], a[220:223], v[252:255], a[180:183]
    ds_read_b64_tr_b16 a[216:217], v8 offset:49152
    ds_read_b64_tr_b16 a[218:219], v8 offset:51200
    ds_read_b64_tr_b16 a[220:221], v9 offset:49152
    ds_read_b64_tr_b16 a[222:223], v9 offset:51200
    s_waitcnt lgkmcnt(0)
    v_mfma_f32_16x16x32_bf16 a[152:155], a[216:219], v[56:59], a[152:155]
    v_mfma_f32_16x16x32_bf16 a[156:159], a[216:219], v[64:67], a[156:159]
    v_mfma_f32_16x16x32_bf16 a[160:163], a[216:219], v[72:75], a[160:163]
    v_mfma_f32_16x16x32_bf16 a[164:167], a[216:219], v[80:83], a[164:167]
    v_mfma_f32_16x16x32_bf16 a[168:171], a[220:223], v[56:59], a[168:171]
    v_mfma_f32_16x16x32_bf16 a[172:175], a[220:223], v[64:67], a[172:175]
    v_mfma_f32_16x16x32_bf16 a[176:179], a[220:223], v[72:75], a[176:179]
    v_mfma_f32_16x16x32_bf16 a[180:183], a[220:223], v[80:83], a[180:183]
    ds_read_b64_tr_b16 a[216:217], v8 offset:53248
    ds_read_b64_tr_b16 a[218:219], v8 offset:55296
    ds_read_b64_tr_b16 a[220:221], v9 offset:53248
    ds_read_b64_tr_b16 a[222:223], v9 offset:55296
    s_waitcnt lgkmcnt(0)
    v_mfma_f32_16x16x32_bf16 a[152:155], a[216:219], v[60:63], a[152:155]
    v_mfma_f32_16x16x32_bf16 a[156:159], a[216:219], v[68:71], a[156:159]
    v_mfma_f32_16x16x32_bf16 a[160:163], a[216:219], v[76:79], a[160:163]
    v_mfma_f32_16x16x32_bf16 a[164:167], a[216:219], v[84:87], a[164:167]
    v_mfma_f32_16x16x32_bf16 a[168:171], a[220:223], v[60:63], a[168:171]
    v_mfma_f32_16x16x32_bf16 a[172:175], a[220:223], v[68:71], a[172:175]
    v_mfma_f32_16x16x32_bf16 a[176:179], a[220:223], v[76:79], a[176:179]
    v_mfma_f32_16x16x32_bf16 a[180:183], a[220:223], v[84:87], a[180:183]
    ds_read_b64_tr_b16 a[216:217], v8 offset:57344
    ds_read_b64_tr_b16 a[218:219], v8 offset:59392
    ds_read_b64_tr_b16 a[220:221], v9 offset:57344
    ds_read_b64_tr_b16 a[222:223], v9 offset:59392
    s_waitcnt lgkmcnt(0)
    v_mfma_f32_16x16x32_bf16 a[152:155], a[216:219], v[88:91], a[152:155]
    v_mfma_f32_16x16x32_bf16 a[156:159], a[216:219], v[96:99], a[156:159]
    v_mfma_f32_16x16x32_bf16 a[160:163], a[216:219], v[104:107], a[160:163]
    v_mfma_f32_16x16x32_bf16 a[164:167], a[216:219], v[112:115], a[164:167]
    v_mfma_f32_16x16x32_bf16 a[168:171], a[220:223], v[88:91], a[168:171]
    v_mfma_f32_16x16x32_bf16 a[172:175], a[220:223], v[96:99], a[172:175]
    v_mfma_f32_16x16x32_bf16 a[176:179], a[220:223], v[104:107], a[176:179]
    v_mfma_f32_16x16x32_bf16 a[180:183], a[220:223], v[112:115], a[180:183]
    ds_read_b64_tr_b16 a[216:217], v8 offset:61440
    ds_read_b64_tr_b16 a[218:219], v8 offset:63488
    ds_read_b64_tr_b16 a[220:221], v9 offset:61440
    ds_read_b64_tr_b16 a[222:223], v9 offset:63488
    s_waitcnt lgkmcnt(0)
    v_mfma_f32_16x16x32_bf16 a[152:155], a[216:219], v[92:95], a[152:155]
    v_mfma_f32_16x16x32_bf16 a[156:159], a[216:219], v[100:103], a[156:159]
    v_mfma_f32_16x16x32_bf16 a[160:163], a[216:219], v[108:111], a[160:163]
    v_mfma_f32_16x16x32_bf16 a[164:167], a[216:219], v[116:119], a[164:167]
    v_mfma_f32_16x16x32_bf16 a[168:171], a[220:223], v[92:95], a[168:171]
    v_mfma_f32_16x16x32_bf16 a[172:175], a[220:223], v[100:103], a[172:175]
    v_mfma_f32_16x16x32_bf16 a[176:179], a[220:223], v[108:111], a[176:179]
    v_mfma_f32_16x16x32_bf16 a[180:183], a[220:223], v[116:119], a[180:183]
    v_mov_b32 v24, 0
    v_mov_b32 v25, 0
    v_mov_b32 v26, 0
    v_mov_b32 v27, 0
    v_mov_b32 v28, 0
    v_mov_b32 v29, 0
    v_mov_b32 v30, 0
    v_mov_b32 v31, 0
    v_mov_b32 v32, 0
    v_mov_b32 v33, 0
    v_mov_b32 v34, 0
    v_mov_b32 v35, 0
    v_mov_b32 v36, 0
    v_mov_b32 v37, 0
    v_mov_b32 v38, 0
    v_mov_b32 v39, 0
    s_nop 1
    v_smfmac_f32_16x16x64_bf16 v[24:27], a[248:251], a[96:103], v20
    v_smfmac_f32_16x16x64_bf16 v[28:31], a[248:251], a[104:111], v20
    v_smfmac_f32_16x16x64_bf16 v[32:35], a[248:251], a[112:119], v20
    v_smfmac_f32_16x16x64_bf16 v[36:39], a[248:251], a[120:127], v20
    v_smfmac_f32_16x16x64_bf16 v[24:27], a[248:251], a[128:135], v20
    v_smfmac_f32_16x16x64_bf16 v[28:31], a[248:251], a[136:143], v20
    v_smfmac_f32_16x16x64_bf16 v[32:35], a[248:251], a[144:151], v20
    v_smfmac_f32_16x16x64_bf16 v[36:39], a[248:251], v[120:127], v20
    v_smfmac_f32_16x16x64_bf16 v[24:27], a[248:251], v[128:135], v20
    v_smfmac_f32_16x16x64_bf16 v[28:31], a[248:251], v[136:143], v20
    v_smfmac_f32_16x16x64_bf16 v[32:35], a[248:251], v[144:151], v20
    v_smfmac_f32_16x16x64_bf16 v[36:39], a[248:251], v[152:159], v20
    v_smfmac_f32_16x16x64_bf16 v[24:27], a[248:251], v[160:167], v20
    v_smfmac_f32_16x16x64_bf16 v[28:31], a[248:251], v[168:175], v20
    v_smfmac_f32_16x16x64_bf16 v[32:35], a[248:251], v[176:183], v20
    v_smfmac_f32_16x16x64_bf16 v[36:39], a[248:251], v[184:191], v20
    v_smfmac_f32_16x16x64_bf16 v[24:27], a[248:251], v[192:199], v20
    v_smfmac_f32_16x16x64_bf16 v[28:31], a[248:251], v[200:207], v20
    v_smfmac_f32_16x16x64_bf16 v[32:35], a[248:251], v[208:215], v20
    v_smfmac_f32_16x16x64_bf16 v[36:39], a[248:251], v[216:223], v20
    v_smfmac_f32_16x16x64_bf16 v[24:27], a[248:251], v[224:231], v20
    v_smfmac_f32_16x16x64_bf16 v[28:31], a[248:251], v[232:239], v20
    v_smfmac_f32_16x16x64_bf16 v[32:35], a[248:251], v[240:247], v20
    v_smfmac_f32_16x16x64_bf16 v[36:39], a[248:251], v[248:255], v20
    v_smfmac_f32_16x16x64_bf16 v[24:27], a[248:251], v[56:63], v20
    v_smfmac_f32_16x16x64_bf16 v[28:31], a[248:251], v[64:71], v20
    v_smfmac_f32_16x16x64_bf16 v[32:35], a[248:251], v[72:79], v20
    v_smfmac_f32_16x16x64_bf16 v[36:39], a[248:251], v[80:87], v20
    v_smfmac_f32_16x16x64_bf16 v[24:27], a[248:251], v[88:95], v20
    v_smfmac_f32_16x16x64_bf16 v[28:31], a[248:251], v[96:103], v20
    v_smfmac_f32_16x16x64_bf16 v[32:35], a[248:251], v[104:111], v20
    v_smfmac_f32_16x16x64_bf16 v[36:39], a[248:251], v[112:119], v20
    s_nop 15
    v_add_f32 v24, v24, v25
    v_add_f32 v28, v28, v29
    v_add_f32 v32, v32, v33
    v_add_f32 v36, v36, v37
    v_rcp_f32 v16, v24
    v_rcp_f32 v17, v28
    v_rcp_f32 v18, v32
    v_rcp_f32 v19, v36
    s_nop 1
    s_branch rare_ret
code_end:
    s_endpgm
.section .rodata,"a"
.p2align 6
.amdhsa_kernel recurrent_scan__sliding_block_cached__moe_arch_mod__prompt_kernel
  .amdhsa_next_free_vgpr 512
  .amdhsa_next_free_sgpr 102
  .amdhsa_accum_offset 256
  .amdhsa_group_segment_fixed_size 0
  .amdhsa_kernarg_size 104
  .amdhsa_user_sgpr_count 2
  .amdhsa_user_sgpr_kernarg_segment_ptr 1
  .amdhsa_system_sgpr_workgroup_id_x 1
  .amdhsa_float_denorm_mode_32 3
.end_amdhsa_kernel
```
